```python
import torch

def _softmax(x, axis=-1):
    return torch.softmax(x, dim=axis)
def _gelu(x):
    return torch.nn.functional.gelu(x, approximate="tanh")
def _silu(x):
    return torch.nn.functional.silu(x)
def _sigmoid(x):
    return torch.sigmoid(x)
def _layernorm(x, axis=-1, eps=1e-5):
    m = x.mean(dim=axis, keepdim=True)
    v = x.var(dim=axis, keepdim=True, unbiased=False)
    return (x - m) / torch.sqrt(v + eps)
def _scatter_add(tgt, idx, src, axis=0):
    return tgt.clone().index_add_(axis, idx, src)
def _segment_sum(src, seg, n):
    out = torch.zeros((n,) + src.shape[1:], dtype=src.dtype)
    return out.index_add_(0, seg, src)
def _pad(x, pw):
    flat = tuple(v for pair in reversed(pw) for v in pair)
    return torch.nn.functional.pad(x, flat)

kernel_name = 'concat_heads__mha_block_cached__mha_block_cached__near_ridge'

def setup_inputs():

    _w = (lambda a: (lambda t: t.to(torch.bfloat16) if t.is_floating_point() else t)(torch.as_tensor(a)))
    def _A_setup():
        B, Sq, D = 8, 240, 576
        H, Sk, Dh = 32, 1024, 128
        return {
            "x": _w((lambda *s: torch.randn(*s, dtype=torch.bfloat16) * 0.8)(B, Sq, D)),
            "k_cache": _w((lambda *s: torch.randn(*s, dtype=torch.bfloat16) * 0.8)(B, H, Sk, Dh)),
            "v_cache": _w((lambda *s: torch.randn(*s, dtype=torch.bfloat16) * 0.05)(B, H, Sk, Dh)),
            "wq": _w((lambda *s: torch.randn(*s, dtype=torch.bfloat16) * 0.8)(D, H * Dh) * (D ** -0.5)),
            "wo": _w((lambda *s: torch.randn(*s, dtype=torch.bfloat16) * 0.05)(H * Dh, D) * ((H * Dh) ** -0.5)),
        }
    _A_in = _A_setup()

    def _B_setup():
        B, Sq, D = 8, 240, 576
        H, Sk, Dh = 32, 1024, 128
        return {
            "x": _w((lambda *s: torch.randn(*s, dtype=torch.bfloat16) * 0.8)(B, Sq, D)),
            "k_cache": _w((lambda *s: torch.randn(*s, dtype=torch.bfloat16) * 0.8)(B, H, Sk, Dh)),
            "v_cache": _w((lambda *s: torch.randn(*s, dtype=torch.bfloat16) * 0.05)(B, H, Sk, Dh)),
            "wq": _w((lambda *s: torch.randn(*s, dtype=torch.bfloat16) * 0.8)(D, H * Dh) * (D ** -0.5)),
            "wo": _w((lambda *s: torch.randn(*s, dtype=torch.bfloat16) * 0.05)(H * Dh, D) * ((H * Dh) ** -0.5)),
        }
    _B_in = _B_setup()

    return {
        "A_x": _A_in["x"],
        "A_k_cache": _A_in["k_cache"],
        "A_v_cache": _A_in["v_cache"],
        "A_wq": _A_in["wq"],
        "A_wo": _A_in["wo"],
        "B_x": _B_in["x"],
        "B_k_cache": _B_in["k_cache"],
        "B_v_cache": _B_in["v_cache"],
        "B_wq": _B_in["wq"],
        "B_wo": _B_in["wo"],
    }

def reference(A_x, A_k_cache, A_v_cache, A_wq, A_wo, B_x, B_k_cache, B_v_cache, B_wq, B_wo):
    def _A_ref(x, k_cache, v_cache, wq, wo):
        B, Sq, D = x.shape
        H, Dh = 32, 128
        q = (lambda x, *d: x.permute(*d))((x @ wq).reshape(B, Sq, H, Dh), 0, 2, 1, 3)
        scores = torch.einsum("bhqd,bhkd->bhqk", q, k_cache) * (Dh ** -0.5)
        p = _softmax(scores, axis=-1)
        o = torch.einsum("bhqk,bhkd->bhqd", p, v_cache)
        return (lambda x, *d: x.permute(*d))(o, 0, 2, 1, 3).reshape(B, Sq, H * Dh) @ wo

    def _B_ref(x, k_cache, v_cache, wq, wo):
        B, Sq, D = x.shape
        H, Dh = 32, 128
        q = (lambda x, *d: x.permute(*d))((x @ wq).reshape(B, Sq, H, Dh), 0, 2, 1, 3)
        scores = torch.einsum("bhqd,bhkd->bhqk", q, k_cache) * (Dh ** -0.5)
        p = _softmax(scores, axis=-1)
        o = torch.einsum("bhqk,bhkd->bhqd", p, v_cache)
        return (lambda x, *d: x.permute(*d))(o, 0, 2, 1, 3).reshape(B, Sq, H * Dh) @ wo

    a = _A_ref(A_x, A_k_cache, A_v_cache, A_wq, A_wo)
    b = _B_ref(B_x, B_k_cache, B_v_cache, B_wq, B_wo)
    return torch.concatenate([a, b], axis=-1)
```

```asm
; @launch grid=(256,1,1) block=(256,1,1) lds=163840
.amdgcn_target "amdgcn-amd-amdhsa--gfx950"
.text
.globl concat_heads__mha_block_cached__mha_block_cached__near_ridge_kernel
.p2align 8
.type concat_heads__mha_block_cached__mha_block_cached__near_ridge_kernel,@function
concat_heads__mha_block_cached__mha_block_cached__near_ridge_kernel:
 s_load_dwordx2 s[40:41],s[0:1],0
 s_load_dwordx2 s[46:47],s[0:1],24
 s_load_dwordx2 s[50:51],s[0:1],40
 s_load_dwordx2 s[56:57],s[0:1],64
 s_cmp_ge_u32 s2,256
 s_cbranch_scc0 K1_go
 s_endpgm
K1_go:
 v_lshrrev_b32 v1,6,v0
 v_and_b32 v0,63,v0
 s_getpc_b64 s[72:73]
K1_pc:
 v_readfirstlane_b32 s24,v1
 s_mov_b32 s74,K1_end-K1_pc
 s_mov_b32 s75,0x20000
 v_lshlrev_b32 v57,7,v0
 s_lshl_b32 s26,s24,13
 s_add_u32 s69,s26,K1_w3-K1_pc-16384
 s_cmp_lt_u32 s24,2
 s_cselect_b32 s69,s26,s69
 buffer_load_dword v255,v57,s[72:75],s69 offen
 s_and_b32 s62,s2,7
 s_xor_b32 s62,s62,0
 s_lshr_b32 s63,s2,3
 v_lshrrev_b32 v50,4,v0
 s_bfe_u32 s65,s62,0x10001
 v_lshrrev_b32 v53,3,v0
 s_lshl_b32 s65,s65,2
 v_lshl_add_u32 v53,v1,6,v53
 s_and_b32 s66,s63,3
 v_mul_u32_u24 v53,1152,v53
 s_add_u32 s65,s65,s66
 v_and_b32 v54,7,v0
 s_and_b32 s66,s62,1
 v_xor_b32 v55,v54,v50
 s_lshl_b32 s66,s66,4
 v_lshl_add_u32 v34,v55,4,v53
 s_lshr_b32 s67,s63,2
 v_xor_b32 v55,4,v55
 s_lshl_b32 s67,s67,1
 v_lshl_add_u32 v35,v55,4,v53
 s_add_u32 s37,s66,s67
 v_and_b32 v51,15,v0
 s_lshl_b32 s25,s24,12
 v_lshl_add_u32 v52,v1,4,v50
 s_mov_b32 s29,0
 v_lshlrev_b32 v54,1,v50
 s_mov_b32 s30,0
 v_xor_b32 v54,v54,v51
 s_mul_i32 s68,s65,276480
 v_lshlrev_b32 v55,13,v52
 s_lshl_b32 s70,s37,8
 v_lshl_add_u32 v32,v54,4,v55
 s_mov_b32 s6,276480
 v_xor_b32 v56,8,v54
 s_mov_b32 s7,0x20000
 v_lshl_add_u32 v33,v56,4,v55
 s_sub_u32 s10,4718592,s70
 s_mov_b32 s11,0x20000
 s_cmp_lt_u32 s62,4
 s_waitcnt lgkmcnt(0)
 s_cselect_b32 s40,s40,s50
 s_cselect_b32 s41,s41,s51
 s_cselect_b32 s46,s46,s56
 s_cselect_b32 s47,s47,s57
 s_add_u32 s4,s40,s68
 s_addc_u32 s5,s41,0
 s_add_u32 s8,s46,s70
 s_addc_u32 s9,s47,0
 s_add_u32 m0,s26,131072
 s_nop 0
 s_add_u32 s35,s30,0
 buffer_load_dwordx4 v34,s[4:7],s35 offen offset:0 lds
 s_add_u32 s35,s30,8192
 buffer_load_dwordx4 v35,s[4:7],s35 offen offset:1024 lds
 s_add_u32 s35,s30,16384
 buffer_load_dwordx4 v34,s[4:7],s35 offen offset:2048 lds
 s_add_u32 s35,s30,24576
 buffer_load_dwordx4 v35,s[4:7],s35 offen offset:3072 lds
 s_add_u32 m0,s26,135168
 s_nop 0
 s_add_u32 s35,s30,36864
 buffer_load_dwordx4 v34,s[4:7],s35 offen offset:0 lds
 s_add_u32 s35,s30,45056
 buffer_load_dwordx4 v35,s[4:7],s35 offen offset:1024 lds
 s_add_u32 s35,s30,53248
 buffer_load_dwordx4 v34,s[4:7],s35 offen offset:2048 lds
 s_add_u32 s35,s30,61440
 buffer_load_dwordx4 v35,s[4:7],s35 offen offset:3072 lds
 s_add_u32 m0,s25,81920
 s_nop 0
 s_add_u32 s34,s29,0
 buffer_load_dwordx4 v32,s[8:11],s34 offen offset:0 lds
 s_add_u32 s34,s29,31744
 buffer_load_dwordx4 v32,s[8:11],s34 offen offset:1024 lds
 s_add_u32 s34,s29,63488
 buffer_load_dwordx4 v33,s[8:11],s34 offen offset:2048 lds
 s_add_u32 s34,s29,95232
 buffer_load_dwordx4 v33,s[8:11],s34 offen offset:3072 lds
 s_load_dwordx4 s[40:43],s[0:1],8
 s_load_dwordx2 s[48:49],s[0:1],32
 s_load_dwordx4 s[52:55],s[0:1],48
 s_load_dwordx2 s[58:59],s[0:1],72
 s_load_dwordx2 s[60:61],s[0:1],96
 s_load_dwordx4 s[76:79],s[0:1],80
 s_add_u32 m0,s26,32768
 s_nop 0
 s_add_u32 s35,s30,128
 buffer_load_dwordx4 v34,s[4:7],s35 offen offset:0 lds
 s_add_u32 s35,s30,8320
 buffer_load_dwordx4 v35,s[4:7],s35 offen offset:1024 lds
 s_add_u32 s35,s30,16512
 buffer_load_dwordx4 v34,s[4:7],s35 offen offset:2048 lds
 s_add_u32 s35,s30,24704
 buffer_load_dwordx4 v35,s[4:7],s35 offen offset:3072 lds
 s_add_u32 m0,s26,36864
 s_nop 0
 s_add_u32 s35,s30,36992
 buffer_load_dwordx4 v34,s[4:7],s35 offen offset:0 lds
 s_add_u32 s35,s30,45184
 buffer_load_dwordx4 v35,s[4:7],s35 offen offset:1024 lds
 s_add_u32 s35,s30,53376
 buffer_load_dwordx4 v34,s[4:7],s35 offen offset:2048 lds
 s_add_u32 s35,s30,61568
 buffer_load_dwordx4 v35,s[4:7],s35 offen offset:3072 lds
 s_add_u32 m0,s25,98304
 s_nop 0
 s_add_u32 s34,s29,524288
 buffer_load_dwordx4 v32,s[8:11],s34 offen offset:0 lds
 s_add_u32 s34,s29,556032
 buffer_load_dwordx4 v32,s[8:11],s34 offen offset:1024 lds
 s_add_u32 s34,s29,587776
 buffer_load_dwordx4 v33,s[8:11],s34 offen offset:2048 lds
 s_add_u32 s34,s29,619520
 buffer_load_dwordx4 v33,s[8:11],s34 offen offset:3072 lds
 s_bfe_u32 s70,s2,0x30003
 s_lshl_b32 s70,s70,15
 s_add_u32 s70,s70,s26
 buffer_load_dword v255,v57,s[72:75],s70 offen
 s_lshr_b32 s64,s62,2
 s_mov_b32 s98,1073741824
 s_mov_b32 s33,0
 s_mov_b32 s36,0x3e0293ee
 v_lshlrev_b32 v55,8,v52
 v_lshl_add_u32 v30,v54,4,v55
 v_lshl_add_u32 v31,v56,4,v55
 v_xor_b32 v54,v50,v51
 v_xor_b32 v56,0,v54
 v_lshl_add_u32 v26,v56,4,v55
 v_xor_b32 v56,4,v54
 v_lshl_add_u32 v27,v56,4,v55
 v_xor_b32 v56,8,v54
 v_lshl_add_u32 v28,v56,4,v55
 v_xor_b32 v56,12,v54
 v_lshl_add_u32 v29,v56,4,v55
 v_lshlrev_b32 v252,4,v0
 s_lshr_b32 s68,s63,2
 s_mul_i32 s68,s68,34560
 v_lshrrev_b32 v57,3,v0
 v_lshl_add_u32 v57,v1,3,v57
 v_min_u32 v57,29,v57
 v_mul_u32_u24 v57,1152,v57
 v_and_b32 v58,7,v0
 v_lshl_add_u32 v57,v58,4,v57
 v_add_u32 v37,s68,v57
 s_and_b32 s68,s63,3
 s_lshl_b32 s68,s68,17
 v_lshl_add_u32 v57,v1,2,v50
 v_lshlrev_b32 v57,13,v57
 v_lshl_add_u32 v57,v51,4,v57
 v_add_u32 v38,s68,v57
 v_lshlrev_b32 v55,8,v51
 v_xor_b32 v56,0,v54
 v_lshl_add_u32 v2,v56,4,v55
 v_xor_b32 v56,4,v54
 v_lshl_add_u32 v3,v56,4,v55
 v_xor_b32 v56,8,v54
 v_lshl_add_u32 v4,v56,4,v55
 v_xor_b32 v56,12,v54
 v_lshl_add_u32 v5,v56,4,v55
 v_lshrrev_b32 v56,2,v51
 v_and_b32 v57,1,v50
 v_lshl_add_u32 v57,v57,2,v56
 v_lshlrev_b32 v57,1,v57
 v_bfe_u32 v58,v0,1,1
 v_xor_b32 v57,v57,v58
 v_and_b32 v58,1,v0
 v_lshlrev_b32 v58,3,v58
 v_lshl_add_u32 v58,v57,4,v58
 v_lshl_add_u32 v59,v50,2,v56
 v_lshl_add_u32 v59,v59,8,v58
 v_add_u32 v59,0x10000,v59
 v_lshlrev_b32 v60,10,v50
 v_add_u32 v60,v60,v59
 v_xor_b32 v6,0,v59
 v_xor_b32 v14,0,v60
 v_xor_b32 v7,32,v59
 v_xor_b32 v15,32,v60
 v_xor_b32 v8,64,v59
 v_xor_b32 v16,64,v60
 v_xor_b32 v9,96,v59
 v_xor_b32 v17,96,v60
 v_xor_b32 v10,128,v59
 v_xor_b32 v18,128,v60
 v_xor_b32 v11,160,v59
 v_xor_b32 v19,160,v60
 v_xor_b32 v12,192,v59
 v_xor_b32 v20,192,v60
 v_xor_b32 v13,224,v59
 v_xor_b32 v21,224,v60
 v_lshrrev_b32 v56,1,v51
 v_xor_b32 v56,v56,v50
 v_lshlrev_b32 v57,7,v51
 v_lshl_add_u32 v57,v1,13,v57
 v_lshl_add_u32 v58,v56,4,v57
 v_add_u32 v22,131072,v58
 v_add_u32 v24,32768,v58
 v_xor_b32 v23,64,v22
 v_xor_b32 v25,64,v24
 v_lshl_add_u32 v36,v1,19,v252
 v_cmp_eq_u32 vcc,0,v0
 v_mov_b32 v253,1073741824
 v_mov_b32 v1,1
 v_cndmask_b32 v253,v253,0,vcc
 v_mov_b32 v240,0
 s_waitcnt lgkmcnt(0)
 s_cmp_eq_u32 s64,0
 s_cselect_b32 s40,s40,s52
 s_cselect_b32 s41,s41,s53
 s_cselect_b32 s42,s42,s54
 s_cselect_b32 s43,s43,s55
 s_cselect_b32 s70,s48,s58
 s_cselect_b32 s71,s49,s59
 s_lshl_b32 s68,s65,5
 s_add_u32 s68,s68,s37
 s_lshl_b32 s68,s68,18
 s_add_u32 s12,s40,s68
 s_addc_u32 s13,s41,0
 s_mov_b32 s14,524288
 s_mov_b32 s15,0x20000
 s_add_u32 s16,s42,s68
 s_addc_u32 s17,s43,0
 s_mov_b32 s18,524288
 s_mov_b32 s19,0x20000
 s_mul_i32 s68,s64,120
 s_mul_i32 s69,s65,15
 s_add_u32 s68,s68,s69
 s_lshl_b32 s68,s68,17
 s_add_u32 s20,s60,s68
 s_addc_u32 s21,s61,0
 s_mov_b32 s22,1966080
 s_mov_b32 s23,0x20000
 s_mov_b32 s88,s70
 s_mov_b32 s89,s71
 s_lshl_b32 s68,s64,2
 s_add_u32 s40,s78,s68
 s_addc_u32 s41,s79,0
 s_sub_u32 s42,256,s68
 s_mov_b32 s43,0x20000
 s_mul_i32 s66,s63,86
 s_lshr_b32 s66,s66,8
 s_mul_i32 s67,s66,3
 s_sub_u32 s67,s63,s67
 s_bfe_u32 s68,s62,0x10001
 s_mul_i32 s68,s68,10
 s_add_u32 s66,s66,s68
 s_mul_i32 s68,s64,120
 s_mul_i32 s69,s66,6
 s_add_u32 s68,s68,s69
 s_lshl_b32 s68,s68,17
 s_add_u32 s48,s60,s68
 s_addc_u32 s49,s61,0
 s_mov_b32 s51,0x20000
 s_mul_i32 s69,s67,384
 s_add_u32 s44,s88,s69
 s_addc_u32 s45,s89,0
 s_sub_u32 s70,4718592,s69
 s_mov_b32 s47,0x20000
 s_mov_b32 s90,4718592
 s_mov_b32 s91,0x20000
 s_and_b32 s86,s62,1
 s_mul_i32 s68,s66,221184
 s_add_u32 s68,s68,s69
 s_mul_i32 s69,s64,1152
 s_add_u32 s68,s68,s69
 s_mul_i32 s69,s86,192
 s_add_u32 s68,s68,s69
 s_add_u32 s52,s76,s68
 s_addc_u32 s53,s77,0
 s_sub_u32 s71,4423680,s68
 s_mov_b32 s55,0x20000
 s_cmp_lt_u32 s63,30
 s_cselect_b32 s59,1,0
 s_cselect_b32 s50,786432,0
 s_cselect_b32 s46,s70,0
 s_cselect_b32 s54,s71,0
 s_lshl_b32 s68,s86,3
 s_add_u32 s68,s68,s24
 s_mul_i32 s56,s68,36864
 s_lshl_b32 s57,s68,10
 s_lshr_b32 s69,s63,2
 s_lshl_b32 s69,s69,4
 s_add_u32 s68,s68,s69
 s_mul_i32 s68,s68,36864
 s_lshr_b32 s69,s63,1
 s_and_b32 s69,s69,1
 s_mul_i32 s69,s69,147456
 s_add_u32 s68,s68,s69
 s_and_b32 s69,s63,1
 s_mul_i32 s69,s69,18432
 s_add_u32 s93,s68,s69
 s_lshl_b32 s68,s65,4
 s_cmp_eq_u32 s24,0
 s_cselect_b32 s58,128,1073741824
 s_cselect_b32 s100,s68,1073741824
 s_mul_i32 s62,s66,410
 s_lshr_b32 s62,s62,10
 s_mul_i32 s63,s66,96
 s_add_u32 s63,s63,95
 s_mul_i32 s63,s63,273
 s_lshr_b32 s63,s63,16
 s_add_u32 s80,s60,58720256
 s_addc_u32 s81,s61,0
 s_mov_b32 s82,65536
 s_mov_b32 s83,0x20000
 s_lshl_b32 s68,s24,6
 s_lshl_b32 s87,s2,8
 s_add_u32 s87,s87,s68
 s_xor_b32 s99,s87,256
 s_mul_i32 s92,s24,12288
 s_mul_i32 s68,s86,12
 s_sub_u32 s101,12,s68
 s_mov_b32 s66,1073741824
 s_mov_b32 s94,1073741824
 s_mov_b32 s96,0x07060302
 s_mov_b32 s27,0
 s_mov_b32 s28,0
 s_cmp_eq_u32 s24,3
 s_cselect_b32 s27,0,32768
 s_cselect_b32 s28,0,16384
 s_cmp_eq_u32 s24,3
 s_cbranch_scc1 K1_w3
 s_waitcnt vmcnt(13)
 s_waitcnt lgkmcnt(0)
 s_barrier
 ds_read_b128 a[128:131],v22 offset:0
 ds_read_b128 a[144:147],v23 offset:0
 ds_read_b128 a[132:135],v22 offset:2048
 ds_read_b128 a[148:151],v23 offset:2048
 ds_read_b128 a[136:139],v22 offset:4096
 ds_read_b128 a[152:155],v23 offset:4096
 ds_read_b128 a[140:143],v22 offset:6144
 ds_read_b128 a[156:159],v23 offset:6144
 ds_read_b64_tr_b16 a[192:193],v14 offset:16384
 ds_read_b64_tr_b16 a[194:195],v14 offset:17408
 ds_read_b64_tr_b16 a[196:197],v14 offset:24576
 ds_read_b64_tr_b16 a[198:199],v14 offset:25600
 ds_read_b64_tr_b16 a[200:201],v15 offset:16384
 ds_read_b64_tr_b16 a[202:203],v15 offset:17408
 ds_read_b64_tr_b16 a[204:205],v15 offset:24576
 ds_read_b64_tr_b16 a[206:207],v15 offset:25600
 ds_read_b64_tr_b16 a[208:209],v16 offset:16384
 ds_read_b64_tr_b16 a[210:211],v16 offset:17408
 ds_read_b64_tr_b16 a[212:213],v16 offset:24576
 ds_read_b64_tr_b16 a[214:215],v16 offset:25600
 s_waitcnt lgkmcnt(12)
 s_add_u32 m0,s26,131072
 s_nop 0
 s_add_u32 s35,s30,256
 buffer_load_dwordx4 v34,s[4:7],s35 offen offset:0 lds
 s_add_u32 s35,s30,8448
 buffer_load_dwordx4 v35,s[4:7],s35 offen offset:1024 lds
 s_add_u32 s35,s30,16640
 buffer_load_dwordx4 v34,s[4:7],s35 offen offset:2048 lds
 s_add_u32 s35,s30,24832
 buffer_load_dwordx4 v35,s[4:7],s35 offen offset:3072 lds
 s_add_u32 m0,s26,135168
 s_nop 0
 s_add_u32 s35,s30,37120
 buffer_load_dwordx4 v34,s[4:7],s35 offen offset:0 lds
 s_add_u32 s35,s30,45312
 buffer_load_dwordx4 v35,s[4:7],s35 offen offset:1024 lds
 s_add_u32 s35,s30,53504
 buffer_load_dwordx4 v34,s[4:7],s35 offen offset:2048 lds
 s_add_u32 s35,s30,61696
 buffer_load_dwordx4 v35,s[4:7],s35 offen offset:3072 lds
 s_waitcnt lgkmcnt(10)
 v_mfma_f32_16x16x32_bf16 v[64:67],a[192:195],a[128:131],0
 s_waitcnt lgkmcnt(8)
 ds_read_b64_tr_b16 a[216:217],v17 offset:16384
 v_mfma_f32_16x16x32_bf16 v[64:67],a[196:199],a[144:147],v[64:67]
 s_waitcnt lgkmcnt(7)
 s_add_u32 m0,s25,114688
 ds_read_b64_tr_b16 a[218:219],v17 offset:17408
 v_mfma_f32_16x16x32_bf16 v[68:71],a[200:203],a[128:131],0
 s_waitcnt lgkmcnt(6)
 s_add_u32 s34,s29,1048576
 buffer_load_dwordx4 v32,s[8:11],s34 offen offset:0 lds
 v_mfma_f32_16x16x32_bf16 v[68:71],a[204:207],a[144:147],v[68:71]
 ds_read_b64_tr_b16 a[220:221],v17 offset:24576
 v_mfma_f32_16x16x32_bf16 v[72:75],a[192:195],a[132:135],0
 ds_read_b64_tr_b16 a[222:223],v17 offset:25600
 v_mfma_f32_16x16x32_bf16 v[72:75],a[196:199],a[148:151],v[72:75]
 ds_read_b64_tr_b16 a[224:225],v18 offset:16384
 v_mfma_f32_16x16x32_bf16 v[76:79],a[200:203],a[132:135],0
 s_add_u32 s34,s29,1080320
 ds_read_b64_tr_b16 a[226:227],v18 offset:17408
 buffer_load_dwordx4 v32,s[8:11],s34 offen offset:1024 lds
 v_mfma_f32_16x16x32_bf16 v[76:79],a[204:207],a[148:151],v[76:79]
 v_mfma_f32_16x16x32_bf16 v[80:83],a[192:195],a[136:139],0
 ds_read_b64_tr_b16 a[228:229],v18 offset:24576
 v_mfma_f32_16x16x32_bf16 v[80:83],a[196:199],a[152:155],v[80:83]
 ds_read_b64_tr_b16 a[230:231],v18 offset:25600
 v_mfma_f32_16x16x32_bf16 v[84:87],a[200:203],a[136:139],0
 s_waitcnt vmcnt(15)
 ds_read_b128 a[160:163],v24 offset:0
 v_mfma_f32_16x16x32_bf16 v[84:87],a[204:207],a[152:155],v[84:87]
 s_add_u32 s34,s29,1112064
 buffer_load_dwordx4 v33,s[8:11],s34 offen offset:2048 lds
 v_mfma_f32_16x16x32_bf16 v[88:91],a[192:195],a[140:143],0
 ds_read_b128 a[176:179],v25 offset:0
 v_mfma_f32_16x16x32_bf16 v[88:91],a[196:199],a[156:159],v[88:91]
 ds_read_b128 a[164:167],v24 offset:2048
 v_mfma_f32_16x16x32_bf16 v[92:95],a[200:203],a[140:143],0
 ds_read_b128 a[180:183],v25 offset:2048
 v_mfma_f32_16x16x32_bf16 v[92:95],a[204:207],a[156:159],v[92:95]
 s_waitcnt lgkmcnt(14)
 s_add_u32 s34,s29,1143808
 buffer_load_dwordx4 v33,s[8:11],s34 offen offset:3072 lds
 v_mfma_f32_16x16x32_bf16 v[96:99],a[208:211],a[128:131],0
 s_waitcnt lgkmcnt(12)
 ds_read_b128 a[168:171],v24 offset:4096
 ds_read_b128 a[184:187],v25 offset:4096
 v_mfma_f32_16x16x32_bf16 v[96:99],a[212:215],a[144:147],v[96:99]
 s_waitcnt lgkmcnt(12)
 v_mfma_f32_16x16x32_bf16 v[100:103],a[216:219],a[128:131],0
 s_waitcnt lgkmcnt(10)
 s_mov_b32 m0,162816
 ds_read_b128 a[172:175],v24 offset:6144
 v_mfma_f32_16x16x32_bf16 v[100:103],a[220:223],a[144:147],v[100:103]
 ds_read_b128 a[188:191],v25 offset:6144
 v_mfma_f32_16x16x32_bf16 v[104:107],a[208:211],a[132:135],0
 s_mov_b32 s35,384
 buffer_load_dwordx4 v37,s[4:7],s35 offen lds
 v_mfma_f32_16x16x32_bf16 v[104:107],a[212:215],a[148:151],v[104:107]
 ds_read_b64_tr_b16 a[232:233],v19 offset:16384
 ds_read_b64_tr_b16 a[234:235],v19 offset:17408
 v_mfma_f32_16x16x32_bf16 v[108:111],a[216:219],a[132:135],0
 v_mfma_f32_16x16x32_bf16 v[108:111],a[220:223],a[148:151],v[108:111]
 ds_read_b64_tr_b16 a[236:237],v19 offset:24576
 ds_read_b64_tr_b16 a[238:239],v19 offset:25600
 v_mfma_f32_16x16x32_bf16 v[112:115],a[208:211],a[136:139],0
 s_mov_b32 s35,1572864
 buffer_load_dwordx4 v38,s[8:11],s35 offen lds
 v_mfma_f32_16x16x32_bf16 v[112:115],a[212:215],a[152:155],v[112:115]
 ds_read_b64_tr_b16 a[240:241],v20 offset:16384
 v_mfma_f32_16x16x32_bf16 v[116:119],a[216:219],a[136:139],0
 ds_read_b64_tr_b16 a[242:243],v20 offset:17408
 v_mfma_f32_16x16x32_bf16 v[116:119],a[220:223],a[152:155],v[116:119]
 s_waitcnt lgkmcnt(6)
 s_add_u32 m0,s26,32768
 v_mfma_f32_16x16x32_bf16 v[120:123],a[208:211],a[140:143],0
 ds_read_b64_tr_b16 a[244:245],v20 offset:24576
 v_mfma_f32_16x16x32_bf16 v[120:123],a[212:215],a[156:159],v[120:123]
 s_add_u32 s35,s30,384
 ds_read_b64_tr_b16 a[246:247],v20 offset:25600
 buffer_load_dwordx4 v34,s[4:7],s35 offen offset:0 lds
 v_mfma_f32_16x16x32_bf16 v[124:127],a[216:219],a[140:143],0
 ds_read_b64_tr_b16 a[248:249],v21 offset:16384
 v_mfma_f32_16x16x32_bf16 v[124:127],a[220:223],a[156:159],v[124:127]
 ds_read_b64_tr_b16 a[250:251],v21 offset:17408
 v_mfma_f32_16x16x32_bf16 v[128:131],a[224:227],a[128:131],0
 ds_read_b64_tr_b16 a[252:253],v21 offset:24576
 v_mfma_f32_16x16x32_bf16 v[128:131],a[228:231],a[144:147],v[128:131]
 s_waitcnt lgkmcnt(9)
 s_add_u32 s35,s30,8576
 buffer_load_dwordx4 v35,s[4:7],s35 offen offset:1024 lds
 v_mfma_f32_16x16x32_bf16 v[132:135],a[232:235],a[128:131],0
 s_waitcnt lgkmcnt(7)
 ds_read_b64_tr_b16 a[254:255],v21 offset:25600
 v_mfma_f32_16x16x32_bf16 v[132:135],a[236:239],a[144:147],v[132:135]
 v_mfma_f32_16x16x32_bf16 v[136:139],a[224:227],a[132:135],0
 v_mfma_f32_16x16x32_bf16 v[136:139],a[228:231],a[148:151],v[136:139]
 v_mfma_f32_16x16x32_bf16 v[140:143],a[232:235],a[132:135],0
 s_add_u32 s35,s30,16768
 buffer_load_dwordx4 v34,s[4:7],s35 offen offset:2048 lds
 v_mfma_f32_16x16x32_bf16 v[140:143],a[236:239],a[148:151],v[140:143]
 v_mfma_f32_16x16x32_bf16 v[144:147],a[224:227],a[136:139],0
 v_mfma_f32_16x16x32_bf16 v[144:147],a[228:231],a[152:155],v[144:147]
 v_mfma_f32_16x16x32_bf16 v[148:151],a[232:235],a[136:139],0
 s_waitcnt vmcnt(18)
 s_waitcnt lgkmcnt(0)
 s_barrier
 v_mfma_f32_16x16x32_bf16 v[148:151],a[236:239],a[152:155],v[148:151]
 s_add_u32 s35,s30,24960
 buffer_load_dwordx4 v35,s[4:7],s35 offen offset:3072 lds
 v_mfma_f32_16x16x32_bf16 v[152:155],a[224:227],a[140:143],0
 ds_read_b64_tr_b16 a[192:193],v14 offset:32768
 v_mfma_f32_16x16x32_bf16 v[152:155],a[228:231],a[156:159],v[152:155]
 ds_read_b64_tr_b16 a[194:195],v14 offset:33792
 v_mfma_f32_16x16x32_bf16 v[156:159],a[232:235],a[140:143],0
 s_add_u32 m0,s26,36864
 ds_read_b64_tr_b16 a[196:197],v14 offset:40960
 v_mfma_f32_16x16x32_bf16 v[156:159],a[236:239],a[156:159],v[156:159]
 s_add_u32 s35,s30,37248
 buffer_load_dwordx4 v34,s[4:7],s35 offen offset:0 lds
 v_mfma_f32_16x16x32_bf16 v[160:163],a[240:243],a[128:131],0
 ds_read_b64_tr_b16 a[198:199],v14 offset:41984
 v_mfma_f32_16x16x32_bf16 v[160:163],a[244:247],a[144:147],v[160:163]
 v_mfma_f32_16x16x32_bf16 v[164:167],a[248:251],a[128:131],0
 ds_read_b64_tr_b16 a[200:201],v15 offset:32768
 v_mfma_f32_16x16x32_bf16 v[164:167],a[252:255],a[144:147],v[164:167]
 ds_read_b64_tr_b16 a[202:203],v15 offset:33792
 v_mfma_f32_16x16x32_bf16 v[168:171],a[240:243],a[132:135],0
 s_add_u32 s35,s30,45440
 buffer_load_dwordx4 v35,s[4:7],s35 offen offset:1024 lds
 v_mfma_f32_16x16x32_bf16 v[168:171],a[244:247],a[148:151],v[168:171]
 ds_read_b64_tr_b16 a[204:205],v15 offset:40960
 v_mfma_f32_16x16x32_bf16 v[172:175],a[248:251],a[132:135],0
 ds_read_b64_tr_b16 a[206:207],v15 offset:41984
 v_mfma_f32_16x16x32_bf16 v[172:175],a[252:255],a[148:151],v[172:175]
 v_mfma_f32_16x16x32_bf16 v[176:179],a[240:243],a[136:139],0
 ds_read_b64_tr_b16 a[208:209],v16 offset:32768
 v_mfma_f32_16x16x32_bf16 v[176:179],a[244:247],a[152:155],v[176:179]
 s_add_u32 s35,s30,53632
 buffer_load_dwordx4 v34,s[4:7],s35 offen offset:2048 lds
 v_mfma_f32_16x16x32_bf16 v[180:183],a[248:251],a[136:139],0
 ds_read_b64_tr_b16 a[210:211],v16 offset:33792
 v_mfma_f32_16x16x32_bf16 v[180:183],a[252:255],a[152:155],v[180:183]
 ds_read_b64_tr_b16 a[212:213],v16 offset:40960
 v_mfma_f32_16x16x32_bf16 v[184:187],a[240:243],a[140:143],0
 v_mfma_f32_16x16x32_bf16 v[184:187],a[244:247],a[156:159],v[184:187]
 ds_read_b64_tr_b16 a[214:215],v16 offset:41984
 v_mfma_f32_16x16x32_bf16 v[188:191],a[248:251],a[140:143],0
 s_add_u32 s35,s30,61824
 buffer_load_dwordx4 v35,s[4:7],s35 offen offset:3072 lds
 v_mfma_f32_16x16x32_bf16 v[188:191],a[252:255],a[156:159],v[188:191]
 s_waitcnt lgkmcnt(10)
 v_mfma_f32_16x16x32_bf16 v[64:67],a[192:195],a[160:163],v[64:67]
 s_waitcnt lgkmcnt(8)
 ds_read_b64_tr_b16 a[216:217],v17 offset:32768
 v_mfma_f32_16x16x32_bf16 v[64:67],a[196:199],a[176:179],v[64:67]
 s_waitcnt lgkmcnt(7)
 s_add_u32 m0,s25,81920
 ds_read_b64_tr_b16 a[218:219],v17 offset:33792
 v_mfma_f32_16x16x32_bf16 v[68:71],a[200:203],a[160:163],v[68:71]
 s_waitcnt lgkmcnt(6)
 s_add_u32 s34,s29,1572864
 buffer_load_dwordx4 v32,s[8:11],s34 offen offset:0 lds
 v_mfma_f32_16x16x32_bf16 v[68:71],a[204:207],a[176:179],v[68:71]
 ds_read_b64_tr_b16 a[220:221],v17 offset:40960
 v_mfma_f32_16x16x32_bf16 v[72:75],a[192:195],a[164:167],v[72:75]
 ds_read_b64_tr_b16 a[222:223],v17 offset:41984
 v_mfma_f32_16x16x32_bf16 v[72:75],a[196:199],a[180:183],v[72:75]
 ds_read_b64_tr_b16 a[224:225],v18 offset:32768
 v_mfma_f32_16x16x32_bf16 v[76:79],a[200:203],a[164:167],v[76:79]
 s_add_u32 s34,s29,1604608
 ds_read_b64_tr_b16 a[226:227],v18 offset:33792
 buffer_load_dwordx4 v32,s[8:11],s34 offen offset:1024 lds
 v_mfma_f32_16x16x32_bf16 v[76:79],a[204:207],a[180:183],v[76:79]
 v_mfma_f32_16x16x32_bf16 v[80:83],a[192:195],a[168:171],v[80:83]
 ds_read_b64_tr_b16 a[228:229],v18 offset:40960
 v_mfma_f32_16x16x32_bf16 v[80:83],a[196:199],a[184:187],v[80:83]
 s_add_u32 s34,s29,1636352
 ds_read_b64_tr_b16 a[230:231],v18 offset:41984
 buffer_load_dwordx4 v33,s[8:11],s34 offen offset:2048 lds
 v_mfma_f32_16x16x32_bf16 v[84:87],a[200:203],a[168:171],v[84:87]
 s_waitcnt vmcnt(17)
 ds_read_b128 a[128:131],v22 offset:0
 v_mfma_f32_16x16x32_bf16 v[84:87],a[204:207],a[184:187],v[84:87]
 ds_read_b128 a[144:147],v23 offset:0
 v_mfma_f32_16x16x32_bf16 v[88:91],a[192:195],a[172:175],v[88:91]
 v_mfma_f32_16x16x32_bf16 v[88:91],a[196:199],a[188:191],v[88:91]
 s_add_u32 s34,s29,1668096
 ds_read_b128 a[132:135],v22 offset:2048
 buffer_load_dwordx4 v33,s[8:11],s34 offen offset:3072 lds
 v_mfma_f32_16x16x32_bf16 v[92:95],a[200:203],a[172:175],v[92:95]
 ds_read_b128 a[148:151],v23 offset:2048
 v_mfma_f32_16x16x32_bf16 v[92:95],a[204:207],a[188:191],v[92:95]
 s_waitcnt lgkmcnt(14)
 ds_read_b128 a[136:139],v22 offset:4096
 v_mfma_f32_16x16x32_bf16 v[96:99],a[208:211],a[160:163],v[96:99]
 s_waitcnt lgkmcnt(13)
 s_mov_b32 m0,162816
 ds_read_b128 a[152:155],v23 offset:4096
 v_mfma_f32_16x16x32_bf16 v[96:99],a[212:215],a[176:179],v[96:99]
 s_waitcnt lgkmcnt(12)
 s_mov_b32 s35,512
 buffer_load_dwordx4 v37,s[4:7],s35 offen lds
 v_mfma_f32_16x16x32_bf16 v[100:103],a[216:219],a[160:163],v[100:103]
 s_waitcnt lgkmcnt(10)
 ds_read_b128 a[140:143],v22 offset:6144
 v_mfma_f32_16x16x32_bf16 v[100:103],a[220:223],a[176:179],v[100:103]
 ds_read_b128 a[156:159],v23 offset:6144
 v_mfma_f32_16x16x32_bf16 v[104:107],a[208:211],a[164:167],v[104:107]
 ds_read_b64_tr_b16 a[232:233],v19 offset:32768
 v_mfma_f32_16x16x32_bf16 v[104:107],a[212:215],a[180:183],v[104:107]
 s_mov_b32 s35,2097152
 ds_read_b64_tr_b16 a[234:235],v19 offset:33792
 buffer_load_dwordx4 v38,s[8:11],s35 offen lds
 v_mfma_f32_16x16x32_bf16 v[108:111],a[216:219],a[164:167],v[108:111]
 v_mfma_f32_16x16x32_bf16 v[108:111],a[220:223],a[180:183],v[108:111]
 ds_read_b64_tr_b16 a[236:237],v19 offset:40960
 v_mfma_f32_16x16x32_bf16 v[112:115],a[208:211],a[168:171],v[112:115]
 ds_read_b64_tr_b16 a[238:239],v19 offset:41984
 v_mfma_f32_16x16x32_bf16 v[112:115],a[212:215],a[184:187],v[112:115]
 s_mov_b32 s35,640
 ds_read_b64_tr_b16 a[240:241],v20 offset:32768
 buffer_load_dwordx4 v37,s[4:7],s35 offen lds
 v_mfma_f32_16x16x32_bf16 v[116:119],a[216:219],a[168:171],v[116:119]
 ds_read_b64_tr_b16 a[242:243],v20 offset:33792
 v_mfma_f32_16x16x32_bf16 v[116:119],a[220:223],a[184:187],v[116:119]
 v_mfma_f32_16x16x32_bf16 v[120:123],a[208:211],a[172:175],v[120:123]
 ds_read_b64_tr_b16 a[244:245],v20 offset:40960
 v_mfma_f32_16x16x32_bf16 v[120:123],a[212:215],a[188:191],v[120:123]
 s_mov_b32 s35,2621440
 ds_read_b64_tr_b16 a[246:247],v20 offset:41984
 buffer_load_dwordx4 v38,s[8:11],s35 offen lds
 v_mfma_f32_16x16x32_bf16 v[124:127],a[216:219],a[172:175],v[124:127]
 ds_read_b64_tr_b16 a[248:249],v21 offset:32768
 v_mfma_f32_16x16x32_bf16 v[124:127],a[220:223],a[188:191],v[124:127]
 s_waitcnt lgkmcnt(9)
 s_add_u32 m0,s26,131072
 v_mfma_f32_16x16x32_bf16 v[128:131],a[224:227],a[160:163],v[128:131]
 ds_read_b64_tr_b16 a[250:251],v21 offset:33792
 ds_read_b64_tr_b16 a[252:253],v21 offset:40960
 v_mfma_f32_16x16x32_bf16 v[128:131],a[228:231],a[176:179],v[128:131]
 s_waitcnt lgkmcnt(9)
 s_add_u32 s35,s30,512
 buffer_load_dwordx4 v34,s[4:7],s35 offen offset:0 lds
 v_mfma_f32_16x16x32_bf16 v[132:135],a[232:235],a[160:163],v[132:135]
 s_waitcnt lgkmcnt(7)
 ds_read_b64_tr_b16 a[254:255],v21 offset:41984
 v_mfma_f32_16x16x32_bf16 v[132:135],a[236:239],a[176:179],v[132:135]
 v_mfma_f32_16x16x32_bf16 v[136:139],a[224:227],a[164:167],v[136:139]
 v_mfma_f32_16x16x32_bf16 v[136:139],a[228:231],a[180:183],v[136:139]
 s_add_u32 s35,s30,8704
 buffer_load_dwordx4 v35,s[4:7],s35 offen offset:1024 lds
 v_mfma_f32_16x16x32_bf16 v[140:143],a[232:235],a[164:167],v[140:143]
 v_mfma_f32_16x16x32_bf16 v[140:143],a[236:239],a[180:183],v[140:143]
 v_mfma_f32_16x16x32_bf16 v[144:147],a[224:227],a[168:171],v[144:147]
 v_mfma_f32_16x16x32_bf16 v[144:147],a[228:231],a[184:187],v[144:147]
 s_add_u32 s35,s30,16896
 buffer_load_dwordx4 v34,s[4:7],s35 offen offset:2048 lds
 v_mfma_f32_16x16x32_bf16 v[148:151],a[232:235],a[168:171],v[148:151]
 s_waitcnt vmcnt(21)
 s_waitcnt lgkmcnt(0)
 s_barrier
 v_mfma_f32_16x16x32_bf16 v[148:151],a[236:239],a[184:187],v[148:151]
 ds_read_b64_tr_b16 a[192:193],v14 offset:49152
 v_mfma_f32_16x16x32_bf16 v[152:155],a[224:227],a[172:175],v[152:155]
 v_mfma_f32_16x16x32_bf16 v[152:155],a[228:231],a[188:191],v[152:155]
 s_add_u32 s35,s30,25088
 ds_read_b64_tr_b16 a[194:195],v14 offset:50176
 buffer_load_dwordx4 v35,s[4:7],s35 offen offset:3072 lds
 v_mfma_f32_16x16x32_bf16 v[156:159],a[232:235],a[172:175],v[156:159]
 ds_read_b64_tr_b16 a[196:197],v14 offset:57344
 v_mfma_f32_16x16x32_bf16 v[156:159],a[236:239],a[188:191],v[156:159]
 v_mfma_f32_16x16x32_bf16 v[160:163],a[240:243],a[160:163],v[160:163]
 s_add_u32 m0,s26,135168
 ds_read_b64_tr_b16 a[198:199],v14 offset:58368
 v_mfma_f32_16x16x32_bf16 v[160:163],a[244:247],a[176:179],v[160:163]
 s_add_u32 s35,s30,37376
 buffer_load_dwordx4 v34,s[4:7],s35 offen offset:0 lds
 v_mfma_f32_16x16x32_bf16 v[164:167],a[248:251],a[160:163],v[164:167]
 ds_read_b64_tr_b16 a[200:201],v15 offset:49152
 v_mfma_f32_16x16x32_bf16 v[164:167],a[252:255],a[176:179],v[164:167]
 ds_read_b64_tr_b16 a[202:203],v15 offset:50176
 v_mfma_f32_16x16x32_bf16 v[168:171],a[240:243],a[164:167],v[168:171]
 v_mfma_f32_16x16x32_bf16 v[168:171],a[244:247],a[180:183],v[168:171]
 ds_read_b64_tr_b16 a[204:205],v15 offset:57344
 v_mfma_f32_16x16x32_bf16 v[172:175],a[248:251],a[164:167],v[172:175]
 s_add_u32 s35,s30,45568
 ds_read_b64_tr_b16 a[206:207],v15 offset:58368
 buffer_load_dwordx4 v35,s[4:7],s35 offen offset:1024 lds
 v_mfma_f32_16x16x32_bf16 v[172:175],a[252:255],a[180:183],v[172:175]
 v_mfma_f32_16x16x32_bf16 v[176:179],a[240:243],a[168:171],v[176:179]
 ds_read_b64_tr_b16 a[208:209],v16 offset:49152
 v_mfma_f32_16x16x32_bf16 v[176:179],a[244:247],a[184:187],v[176:179]
 v_mfma_f32_16x16x32_bf16 v[180:183],a[248:251],a[168:171],v[180:183]
 s_add_u32 s35,s30,53760
 ds_read_b64_tr_b16 a[210:211],v16 offset:50176
 buffer_load_dwordx4 v34,s[4:7],s35 offen offset:2048 lds
 v_mfma_f32_16x16x32_bf16 v[180:183],a[252:255],a[184:187],v[180:183]
 ds_read_b64_tr_b16 a[212:213],v16 offset:57344
 v_mfma_f32_16x16x32_bf16 v[184:187],a[240:243],a[172:175],v[184:187]
 v_mfma_f32_16x16x32_bf16 v[184:187],a[244:247],a[188:191],v[184:187]
 ds_read_b64_tr_b16 a[214:215],v16 offset:58368
 v_mfma_f32_16x16x32_bf16 v[188:191],a[248:251],a[172:175],v[188:191]
 s_add_u32 s35,s30,61952
 buffer_load_dwordx4 v35,s[4:7],s35 offen offset:3072 lds
 v_mfma_f32_16x16x32_bf16 v[188:191],a[252:255],a[188:191],v[188:191]
 s_waitcnt lgkmcnt(10)
 v_mfma_f32_16x16x32_bf16 v[64:67],a[192:195],a[128:131],v[64:67]
 s_waitcnt lgkmcnt(8)
 ds_read_b64_tr_b16 a[216:217],v17 offset:49152
 v_mfma_f32_16x16x32_bf16 v[64:67],a[196:199],a[144:147],v[64:67]
 s_waitcnt lgkmcnt(7)
 s_add_u32 m0,s25,98304
 ds_read_b64_tr_b16 a[218:219],v17 offset:50176
 v_mfma_f32_16x16x32_bf16 v[68:71],a[200:203],a[128:131],v[68:71]
 s_waitcnt lgkmcnt(6)
 s_add_u32 s34,s29,2097152
 buffer_load_dwordx4 v32,s[8:11],s34 offen offset:0 lds
 v_mfma_f32_16x16x32_bf16 v[68:71],a[204:207],a[144:147],v[68:71]
 ds_read_b64_tr_b16 a[220:221],v17 offset:57344
 v_mfma_f32_16x16x32_bf16 v[72:75],a[192:195],a[132:135],v[72:75]
 ds_read_b64_tr_b16 a[222:223],v17 offset:58368
 v_mfma_f32_16x16x32_bf16 v[72:75],a[196:199],a[148:151],v[72:75]
 ds_read_b64_tr_b16 a[224:225],v18 offset:49152
 v_mfma_f32_16x16x32_bf16 v[76:79],a[200:203],a[132:135],v[76:79]
 s_add_u32 s34,s29,2128896
 ds_read_b64_tr_b16 a[226:227],v18 offset:50176
 buffer_load_dwordx4 v32,s[8:11],s34 offen offset:1024 lds
 v_mfma_f32_16x16x32_bf16 v[76:79],a[204:207],a[148:151],v[76:79]
 v_mfma_f32_16x16x32_bf16 v[80:83],a[192:195],a[136:139],v[80:83]
 ds_read_b64_tr_b16 a[228:229],v18 offset:57344
 v_mfma_f32_16x16x32_bf16 v[80:83],a[196:199],a[152:155],v[80:83]
 s_add_u32 s34,s29,2160640
 ds_read_b64_tr_b16 a[230:231],v18 offset:58368
 buffer_load_dwordx4 v33,s[8:11],s34 offen offset:2048 lds
 v_mfma_f32_16x16x32_bf16 v[84:87],a[200:203],a[136:139],v[84:87]
 s_waitcnt vmcnt(19)
 ds_read_b128 a[160:163],v24 offset:0
 v_mfma_f32_16x16x32_bf16 v[84:87],a[204:207],a[152:155],v[84:87]
 ds_read_b128 a[176:179],v25 offset:0
 v_mfma_f32_16x16x32_bf16 v[88:91],a[192:195],a[140:143],v[88:91]
 v_mfma_f32_16x16x32_bf16 v[88:91],a[196:199],a[156:159],v[88:91]
 ds_read_b128 a[164:167],v24 offset:2048
 v_mfma_f32_16x16x32_bf16 v[92:95],a[200:203],a[140:143],v[92:95]
 s_add_u32 s34,s29,2192384
 ds_read_b128 a[180:183],v25 offset:2048
 buffer_load_dwordx4 v33,s[8:11],s34 offen offset:3072 lds
 v_mfma_f32_16x16x32_bf16 v[92:95],a[204:207],a[156:159],v[92:95]
 s_waitcnt lgkmcnt(14)
 ds_read_b128 a[168:171],v24 offset:4096
 v_mfma_f32_16x16x32_bf16 v[96:99],a[208:211],a[128:131],v[96:99]
 s_waitcnt lgkmcnt(13)
 ds_read_b128 a[184:187],v25 offset:4096
 v_mfma_f32_16x16x32_bf16 v[96:99],a[212:215],a[144:147],v[96:99]
 s_waitcnt lgkmcnt(12)
 s_mov_b32 m0,162816
 ds_read_b128 a[172:175],v24 offset:6144
 v_mfma_f32_16x16x32_bf16 v[100:103],a[216:219],a[128:131],v[100:103]
 s_waitcnt lgkmcnt(11)
 s_mov_b32 s35,768
 buffer_load_dwordx4 v37,s[4:7],s35 offen lds
 v_mfma_f32_16x16x32_bf16 v[100:103],a[220:223],a[144:147],v[100:103]
 ds_read_b128 a[188:191],v25 offset:6144
 v_mfma_f32_16x16x32_bf16 v[104:107],a[208:211],a[132:135],v[104:107]
 ds_read_b64_tr_b16 a[232:233],v19 offset:49152
 v_mfma_f32_16x16x32_bf16 v[104:107],a[212:215],a[148:151],v[104:107]
 ds_read_b64_tr_b16 a[234:235],v19 offset:50176
 v_mfma_f32_16x16x32_bf16 v[108:111],a[216:219],a[132:135],v[108:111]
 s_mov_b32 s35,3145728
 buffer_load_dwordx4 v38,s[8:11],s35 offen lds
 v_mfma_f32_16x16x32_bf16 v[108:111],a[220:223],a[148:151],v[108:111]
 ds_read_b64_tr_b16 a[236:237],v19 offset:57344
 v_mfma_f32_16x16x32_bf16 v[112:115],a[208:211],a[136:139],v[112:115]
 ds_read_b64_tr_b16 a[238:239],v19 offset:58368
 v_mfma_f32_16x16x32_bf16 v[112:115],a[212:215],a[152:155],v[112:115]
 ds_read_b64_tr_b16 a[240:241],v20 offset:49152
 v_mfma_f32_16x16x32_bf16 v[116:119],a[216:219],a[136:139],v[116:119]
 ds_read_b64_tr_b16 a[242:243],v20 offset:50176
 buffer_store_dword v240,v253,s[80:83],s87 offen sc0 sc1
 v_mfma_f32_16x16x32_bf16 v[116:119],a[220:223],a[152:155],v[116:119]
 v_mfma_f32_16x16x32_bf16 v[120:123],a[208:211],a[140:143],v[120:123]
 ds_read_b64_tr_b16 a[244:245],v20 offset:57344
 v_mfma_f32_16x16x32_bf16 v[120:123],a[212:215],a[156:159],v[120:123]
 ds_read_b64_tr_b16 a[246:247],v20 offset:58368
 s_waitcnt lgkmcnt(8)
 s_add_u32 m0,s26,32768
 v_mfma_f32_16x16x32_bf16 v[124:127],a[216:219],a[140:143],v[124:127]
 s_add_u32 s35,s30,640
 ds_read_b64_tr_b16 a[248:249],v21 offset:49152
 buffer_load_dwordx4 v34,s[4:7],s35 offen offset:0 lds
 v_mfma_f32_16x16x32_bf16 v[124:127],a[220:223],a[156:159],v[124:127]
 ds_read_b64_tr_b16 a[250:251],v21 offset:50176
 v_mfma_f32_16x16x32_bf16 v[128:131],a[224:227],a[128:131],v[128:131]
 v_mfma_f32_16x16x32_bf16 v[128:131],a[228:231],a[144:147],v[128:131]
 s_waitcnt lgkmcnt(8)
 ds_read_b64_tr_b16 a[252:253],v21 offset:57344
 v_mfma_f32_16x16x32_bf16 v[132:135],a[232:235],a[128:131],v[132:135]
 s_waitcnt lgkmcnt(7)
 ds_read_b64_tr_b16 a[254:255],v21 offset:58368
 v_mfma_f32_16x16x32_bf16 v[132:135],a[236:239],a[144:147],v[132:135]
 s_add_u32 s35,s30,8832
 buffer_load_dwordx4 v35,s[4:7],s35 offen offset:1024 lds
 v_mfma_f32_16x16x32_bf16 v[136:139],a[224:227],a[132:135],v[136:139]
 v_mfma_f32_16x16x32_bf16 v[136:139],a[228:231],a[148:151],v[136:139]
 v_mfma_f32_16x16x32_bf16 v[140:143],a[232:235],a[132:135],v[140:143]
 v_mfma_f32_16x16x32_bf16 v[140:143],a[236:239],a[148:151],v[140:143]
 s_add_u32 s35,s30,17024
 buffer_load_dwordx4 v34,s[4:7],s35 offen offset:2048 lds
 v_mfma_f32_16x16x32_bf16 v[144:147],a[224:227],a[136:139],v[144:147]
 v_mfma_f32_16x16x32_bf16 v[144:147],a[228:231],a[152:155],v[144:147]
 v_mfma_f32_16x16x32_bf16 v[148:151],a[232:235],a[136:139],v[148:151]
 s_waitcnt vmcnt(22)
 s_waitcnt lgkmcnt(0)
 s_barrier
 v_mfma_f32_16x16x32_bf16 v[148:151],a[236:239],a[152:155],v[148:151]
 ds_read_b64_tr_b16 a[192:193],v14 offset:16384
 v_mfma_f32_16x16x32_bf16 v[152:155],a[224:227],a[140:143],v[152:155]
 s_add_u32 s35,s30,25216
 buffer_load_dwordx4 v35,s[4:7],s35 offen offset:3072 lds
 v_mfma_f32_16x16x32_bf16 v[152:155],a[228:231],a[156:159],v[152:155]
 ds_read_b64_tr_b16 a[194:195],v14 offset:17408
 v_mfma_f32_16x16x32_bf16 v[156:159],a[232:235],a[140:143],v[156:159]
 ds_read_b64_tr_b16 a[196:197],v14 offset:24576
 v_mfma_f32_16x16x32_bf16 v[156:159],a[236:239],a[156:159],v[156:159]
 s_add_u32 m0,s26,36864
 v_mfma_f32_16x16x32_bf16 v[160:163],a[240:243],a[128:131],v[160:163]
 ds_read_b64_tr_b16 a[198:199],v14 offset:25600
 v_mfma_f32_16x16x32_bf16 v[160:163],a[244:247],a[144:147],v[160:163]
 s_add_u32 s35,s30,37504
 buffer_load_dwordx4 v34,s[4:7],s35 offen offset:0 lds
 v_mfma_f32_16x16x32_bf16 v[164:167],a[248:251],a[128:131],v[164:167]
 ds_read_b64_tr_b16 a[200:201],v15 offset:16384
 v_mfma_f32_16x16x32_bf16 v[164:167],a[252:255],a[144:147],v[164:167]
 ds_read_b64_tr_b16 a[202:203],v15 offset:17408
 v_mfma_f32_16x16x32_bf16 v[168:171],a[240:243],a[132:135],v[168:171]
 v_mfma_f32_16x16x32_bf16 v[168:171],a[244:247],a[148:151],v[168:171]
 s_add_u32 s35,s30,45696
 ds_read_b64_tr_b16 a[204:205],v15 offset:24576
 buffer_load_dwordx4 v35,s[4:7],s35 offen offset:1024 lds
 v_mfma_f32_16x16x32_bf16 v[172:175],a[248:251],a[132:135],v[172:175]
 ds_read_b64_tr_b16 a[206:207],v15 offset:25600
 v_mfma_f32_16x16x32_bf16 v[172:175],a[252:255],a[148:151],v[172:175]
 v_mfma_f32_16x16x32_bf16 v[176:179],a[240:243],a[136:139],v[176:179]
 ds_read_b64_tr_b16 a[208:209],v16 offset:16384
 v_mfma_f32_16x16x32_bf16 v[176:179],a[244:247],a[152:155],v[176:179]
 s_add_u32 s35,s30,53888
 buffer_load_dwordx4 v34,s[4:7],s35 offen offset:2048 lds
 v_mfma_f32_16x16x32_bf16 v[180:183],a[248:251],a[136:139],v[180:183]
 ds_read_b64_tr_b16 a[210:211],v16 offset:17408
 v_mfma_f32_16x16x32_bf16 v[180:183],a[252:255],a[152:155],v[180:183]
 ds_read_b64_tr_b16 a[212:213],v16 offset:24576
 v_mfma_f32_16x16x32_bf16 v[184:187],a[240:243],a[140:143],v[184:187]
 v_mfma_f32_16x16x32_bf16 v[184:187],a[244:247],a[156:159],v[184:187]
 ds_read_b64_tr_b16 a[214:215],v16 offset:25600
 v_mfma_f32_16x16x32_bf16 v[188:191],a[248:251],a[140:143],v[188:191]
 s_add_u32 s35,s30,62080
 buffer_load_dwordx4 v35,s[4:7],s35 offen offset:3072 lds
 v_mfma_f32_16x16x32_bf16 v[188:191],a[252:255],a[156:159],v[188:191]
 s_waitcnt lgkmcnt(10)
 v_mfma_f32_16x16x32_bf16 v[64:67],a[192:195],a[160:163],v[64:67]
 s_waitcnt lgkmcnt(8)
 ds_read_b64_tr_b16 a[216:217],v17 offset:16384
 v_mfma_f32_16x16x32_bf16 v[64:67],a[196:199],a[176:179],v[64:67]
 s_waitcnt lgkmcnt(7)
 s_add_u32 m0,s25,114688
 ds_read_b64_tr_b16 a[218:219],v17 offset:17408
 v_mfma_f32_16x16x32_bf16 v[68:71],a[200:203],a[160:163],v[68:71]
 s_waitcnt lgkmcnt(6)
 s_add_u32 s34,s29,2621440
 buffer_load_dwordx4 v32,s[8:11],s34 offen offset:0 lds
 v_mfma_f32_16x16x32_bf16 v[68:71],a[204:207],a[176:179],v[68:71]
 ds_read_b64_tr_b16 a[220:221],v17 offset:24576
 v_mfma_f32_16x16x32_bf16 v[72:75],a[192:195],a[164:167],v[72:75]
 ds_read_b64_tr_b16 a[222:223],v17 offset:25600
 v_mfma_f32_16x16x32_bf16 v[72:75],a[196:199],a[180:183],v[72:75]
 ds_read_b64_tr_b16 a[224:225],v18 offset:16384
 v_mfma_f32_16x16x32_bf16 v[76:79],a[200:203],a[164:167],v[76:79]
 s_add_u32 s34,s29,2653184
 ds_read_b64_tr_b16 a[226:227],v18 offset:17408
 buffer_load_dwordx4 v32,s[8:11],s34 offen offset:1024 lds
 v_mfma_f32_16x16x32_bf16 v[76:79],a[204:207],a[180:183],v[76:79]
 v_mfma_f32_16x16x32_bf16 v[80:83],a[192:195],a[168:171],v[80:83]
 ds_read_b64_tr_b16 a[228:229],v18 offset:24576
 v_mfma_f32_16x16x32_bf16 v[80:83],a[196:199],a[184:187],v[80:83]
 ds_read_b64_tr_b16 a[230:231],v18 offset:25600
 v_mfma_f32_16x16x32_bf16 v[84:87],a[200:203],a[168:171],v[84:87]
 s_waitcnt vmcnt(17)
 ds_read_b128 a[128:131],v22 offset:0
 v_mfma_f32_16x16x32_bf16 v[84:87],a[204:207],a[184:187],v[84:87]
 s_add_u32 s34,s29,2684928
 buffer_load_dwordx4 v33,s[8:11],s34 offen offset:2048 lds
 v_mfma_f32_16x16x32_bf16 v[88:91],a[192:195],a[172:175],v[88:91]
 ds_read_b128 a[144:147],v23 offset:0
 v_mfma_f32_16x16x32_bf16 v[88:91],a[196:199],a[188:191],v[88:91]
 ds_read_b128 a[132:135],v22 offset:2048
 v_mfma_f32_16x16x32_bf16 v[92:95],a[200:203],a[172:175],v[92:95]
 ds_read_b128 a[148:151],v23 offset:2048
 v_mfma_f32_16x16x32_bf16 v[92:95],a[204:207],a[188:191],v[92:95]
 s_waitcnt lgkmcnt(14)
 s_add_u32 s34,s29,2716672
 buffer_load_dwordx4 v33,s[8:11],s34 offen offset:3072 lds
 v_mfma_f32_16x16x32_bf16 v[96:99],a[208:211],a[160:163],v[96:99]
 s_waitcnt lgkmcnt(12)
 ds_read_b128 a[136:139],v22 offset:4096
 ds_read_b128 a[152:155],v23 offset:4096
 v_mfma_f32_16x16x32_bf16 v[96:99],a[212:215],a[176:179],v[96:99]
 s_waitcnt lgkmcnt(12)
 v_mfma_f32_16x16x32_bf16 v[100:103],a[216:219],a[160:163],v[100:103]
 s_waitcnt lgkmcnt(10)
 s_mov_b32 m0,162816
 ds_read_b128 a[140:143],v22 offset:6144
 v_mfma_f32_16x16x32_bf16 v[100:103],a[220:223],a[176:179],v[100:103]
 ds_read_b128 a[156:159],v23 offset:6144
 v_mfma_f32_16x16x32_bf16 v[104:107],a[208:211],a[164:167],v[104:107]
 s_mov_b32 s35,896
 buffer_load_dwordx4 v37,s[4:7],s35 offen lds
 v_mfma_f32_16x16x32_bf16 v[104:107],a[212:215],a[180:183],v[104:107]
 ds_read_b64_tr_b16 a[232:233],v19 offset:16384
 ds_read_b64_tr_b16 a[234:235],v19 offset:17408
 v_mfma_f32_16x16x32_bf16 v[108:111],a[216:219],a[164:167],v[108:111]
 v_mfma_f32_16x16x32_bf16 v[108:111],a[220:223],a[180:183],v[108:111]
 ds_read_b64_tr_b16 a[236:237],v19 offset:24576
 ds_read_b64_tr_b16 a[238:239],v19 offset:25600
 v_mfma_f32_16x16x32_bf16 v[112:115],a[208:211],a[168:171],v[112:115]
 s_mov_b32 s35,3670016
 buffer_load_dwordx4 v38,s[8:11],s35 offen lds
 v_mfma_f32_16x16x32_bf16 v[112:115],a[212:215],a[184:187],v[112:115]
 ds_read_b64_tr_b16 a[240:241],v20 offset:16384
 v_mfma_f32_16x16x32_bf16 v[116:119],a[216:219],a[168:171],v[116:119]
 ds_read_b64_tr_b16 a[242:243],v20 offset:17408
 v_mfma_f32_16x16x32_bf16 v[116:119],a[220:223],a[184:187],v[116:119]
 s_waitcnt lgkmcnt(6)
 s_add_u32 m0,s26,131072
 v_mfma_f32_16x16x32_bf16 v[120:123],a[208:211],a[172:175],v[120:123]
 ds_read_b64_tr_b16 a[244:245],v20 offset:24576
 v_mfma_f32_16x16x32_bf16 v[120:123],a[212:215],a[188:191],v[120:123]
 s_add_u32 s35,s30,768
 ds_read_b64_tr_b16 a[246:247],v20 offset:25600
 buffer_load_dwordx4 v34,s[4:7],s35 offen offset:0 lds
 v_mfma_f32_16x16x32_bf16 v[124:127],a[216:219],a[172:175],v[124:127]
 ds_read_b64_tr_b16 a[248:249],v21 offset:16384
 v_mfma_f32_16x16x32_bf16 v[124:127],a[220:223],a[188:191],v[124:127]
 ds_read_b64_tr_b16 a[250:251],v21 offset:17408
 v_mfma_f32_16x16x32_bf16 v[128:131],a[224:227],a[160:163],v[128:131]
 ds_read_b64_tr_b16 a[252:253],v21 offset:24576
 v_mfma_f32_16x16x32_bf16 v[128:131],a[228:231],a[176:179],v[128:131]
 s_waitcnt lgkmcnt(9)
 s_add_u32 s35,s30,8960
 buffer_load_dwordx4 v35,s[4:7],s35 offen offset:1024 lds
 v_mfma_f32_16x16x32_bf16 v[132:135],a[232:235],a[160:163],v[132:135]
 s_waitcnt lgkmcnt(7)
 ds_read_b64_tr_b16 a[254:255],v21 offset:25600
 v_mfma_f32_16x16x32_bf16 v[132:135],a[236:239],a[176:179],v[132:135]
 v_mfma_f32_16x16x32_bf16 v[136:139],a[224:227],a[164:167],v[136:139]
 v_mfma_f32_16x16x32_bf16 v[136:139],a[228:231],a[180:183],v[136:139]
 v_mfma_f32_16x16x32_bf16 v[140:143],a[232:235],a[164:167],v[140:143]
 s_add_u32 s35,s30,17152
 buffer_load_dwordx4 v34,s[4:7],s35 offen offset:2048 lds
 v_mfma_f32_16x16x32_bf16 v[140:143],a[236:239],a[180:183],v[140:143]
 v_mfma_f32_16x16x32_bf16 v[144:147],a[224:227],a[168:171],v[144:147]
 v_mfma_f32_16x16x32_bf16 v[144:147],a[228:231],a[184:187],v[144:147]
 v_mfma_f32_16x16x32_bf16 v[148:151],a[232:235],a[168:171],v[148:151]
 s_waitcnt vmcnt(20)
 s_waitcnt lgkmcnt(0)
 s_barrier
 v_mfma_f32_16x16x32_bf16 v[148:151],a[236:239],a[184:187],v[148:151]
 s_add_u32 s35,s30,25344
 buffer_load_dwordx4 v35,s[4:7],s35 offen offset:3072 lds
 v_mfma_f32_16x16x32_bf16 v[152:155],a[224:227],a[172:175],v[152:155]
 ds_read_b64_tr_b16 a[192:193],v14 offset:32768
 v_mfma_f32_16x16x32_bf16 v[152:155],a[228:231],a[188:191],v[152:155]
 ds_read_b64_tr_b16 a[194:195],v14 offset:33792
 v_mfma_f32_16x16x32_bf16 v[156:159],a[232:235],a[172:175],v[156:159]
 s_add_u32 m0,s26,135168
 ds_read_b64_tr_b16 a[196:197],v14 offset:40960
 v_mfma_f32_16x16x32_bf16 v[156:159],a[236:239],a[188:191],v[156:159]
 s_add_u32 s35,s30,37632
 buffer_load_dwordx4 v34,s[4:7],s35 offen offset:0 lds
 v_mfma_f32_16x16x32_bf16 v[160:163],a[240:243],a[160:163],v[160:163]
 ds_read_b64_tr_b16 a[198:199],v14 offset:41984
 v_mfma_f32_16x16x32_bf16 v[160:163],a[244:247],a[176:179],v[160:163]
 v_mfma_f32_16x16x32_bf16 v[164:167],a[248:251],a[160:163],v[164:167]
 ds_read_b64_tr_b16 a[200:201],v15 offset:32768
 v_mfma_f32_16x16x32_bf16 v[164:167],a[252:255],a[176:179],v[164:167]
 ds_read_b64_tr_b16 a[202:203],v15 offset:33792
 v_mfma_f32_16x16x32_bf16 v[168:171],a[240:243],a[164:167],v[168:171]
 s_add_u32 s35,s30,45824
 buffer_load_dwordx4 v35,s[4:7],s35 offen offset:1024 lds
 v_mfma_f32_16x16x32_bf16 v[168:171],a[244:247],a[180:183],v[168:171]
 ds_read_b64_tr_b16 a[204:205],v15 offset:40960
 v_mfma_f32_16x16x32_bf16 v[172:175],a[248:251],a[164:167],v[172:175]
 ds_read_b64_tr_b16 a[206:207],v15 offset:41984
 v_mfma_f32_16x16x32_bf16 v[172:175],a[252:255],a[180:183],v[172:175]
 v_mfma_f32_16x16x32_bf16 v[176:179],a[240:243],a[168:171],v[176:179]
 ds_read_b64_tr_b16 a[208:209],v16 offset:32768
 v_mfma_f32_16x16x32_bf16 v[176:179],a[244:247],a[184:187],v[176:179]
 s_add_u32 s35,s30,54016
 buffer_load_dwordx4 v34,s[4:7],s35 offen offset:2048 lds
 v_mfma_f32_16x16x32_bf16 v[180:183],a[248:251],a[168:171],v[180:183]
 ds_read_b64_tr_b16 a[210:211],v16 offset:33792
 v_mfma_f32_16x16x32_bf16 v[180:183],a[252:255],a[184:187],v[180:183]
 ds_read_b64_tr_b16 a[212:213],v16 offset:40960
 v_mfma_f32_16x16x32_bf16 v[184:187],a[240:243],a[172:175],v[184:187]
 v_mfma_f32_16x16x32_bf16 v[184:187],a[244:247],a[188:191],v[184:187]
 ds_read_b64_tr_b16 a[214:215],v16 offset:41984
 v_mfma_f32_16x16x32_bf16 v[188:191],a[248:251],a[172:175],v[188:191]
 s_add_u32 s35,s30,62208
 buffer_load_dwordx4 v35,s[4:7],s35 offen offset:3072 lds
 v_mfma_f32_16x16x32_bf16 v[188:191],a[252:255],a[188:191],v[188:191]
 s_waitcnt lgkmcnt(10)
 v_mfma_f32_16x16x32_bf16 v[64:67],a[192:195],a[128:131],v[64:67]
 s_waitcnt lgkmcnt(8)
 ds_read_b64_tr_b16 a[216:217],v17 offset:32768
 v_mfma_f32_16x16x32_bf16 v[64:67],a[196:199],a[144:147],v[64:67]
 s_waitcnt lgkmcnt(7)
 s_add_u32 m0,s25,81920
 ds_read_b64_tr_b16 a[218:219],v17 offset:33792
 v_mfma_f32_16x16x32_bf16 v[68:71],a[200:203],a[128:131],v[68:71]
 s_waitcnt lgkmcnt(6)
 s_add_u32 s34,s29,3145728
 buffer_load_dwordx4 v32,s[8:11],s34 offen offset:0 lds
 v_mfma_f32_16x16x32_bf16 v[68:71],a[204:207],a[144:147],v[68:71]
 ds_read_b64_tr_b16 a[220:221],v17 offset:40960
 v_mfma_f32_16x16x32_bf16 v[72:75],a[192:195],a[132:135],v[72:75]
 ds_read_b64_tr_b16 a[222:223],v17 offset:41984
 v_mfma_f32_16x16x32_bf16 v[72:75],a[196:199],a[148:151],v[72:75]
 ds_read_b64_tr_b16 a[224:225],v18 offset:32768
 v_mfma_f32_16x16x32_bf16 v[76:79],a[200:203],a[132:135],v[76:79]
 s_add_u32 s34,s29,3177472
 ds_read_b64_tr_b16 a[226:227],v18 offset:33792
 buffer_load_dwordx4 v32,s[8:11],s34 offen offset:1024 lds
 v_mfma_f32_16x16x32_bf16 v[76:79],a[204:207],a[148:151],v[76:79]
 v_mfma_f32_16x16x32_bf16 v[80:83],a[192:195],a[136:139],v[80:83]
 ds_read_b64_tr_b16 a[228:229],v18 offset:40960
 v_mfma_f32_16x16x32_bf16 v[80:83],a[196:199],a[152:155],v[80:83]
 ds_read_b64_tr_b16 a[230:231],v18 offset:41984
 v_mfma_f32_16x16x32_bf16 v[84:87],a[200:203],a[136:139],v[84:87]
 s_waitcnt vmcnt(16)
 ds_read_b128 a[160:163],v24 offset:0
 v_mfma_f32_16x16x32_bf16 v[84:87],a[204:207],a[152:155],v[84:87]
 s_add_u32 s34,s29,3209216
 buffer_load_dwordx4 v33,s[8:11],s34 offen offset:2048 lds
 v_mfma_f32_16x16x32_bf16 v[88:91],a[192:195],a[140:143],v[88:91]
 ds_read_b128 a[176:179],v25 offset:0
 v_mfma_f32_16x16x32_bf16 v[88:91],a[196:199],a[156:159],v[88:91]
 ds_read_b128 a[164:167],v24 offset:2048
 v_mfma_f32_16x16x32_bf16 v[92:95],a[200:203],a[140:143],v[92:95]
 ds_read_b128 a[180:183],v25 offset:2048
 v_mfma_f32_16x16x32_bf16 v[92:95],a[204:207],a[156:159],v[92:95]
 s_waitcnt lgkmcnt(14)
 s_add_u32 s34,s29,3240960
 buffer_load_dwordx4 v33,s[8:11],s34 offen offset:3072 lds
 v_mfma_f32_16x16x32_bf16 v[96:99],a[208:211],a[128:131],v[96:99]
 s_waitcnt lgkmcnt(12)
 ds_read_b128 a[168:171],v24 offset:4096
 ds_read_b128 a[184:187],v25 offset:4096
 v_mfma_f32_16x16x32_bf16 v[96:99],a[212:215],a[144:147],v[96:99]
 s_waitcnt lgkmcnt(12)
 v_mfma_f32_16x16x32_bf16 v[100:103],a[216:219],a[128:131],v[100:103]
 s_waitcnt lgkmcnt(10)
 s_mov_b32 m0,162816
 ds_read_b128 a[172:175],v24 offset:6144
 v_mfma_f32_16x16x32_bf16 v[100:103],a[220:223],a[144:147],v[100:103]
 ds_read_b128 a[188:191],v25 offset:6144
 v_mfma_f32_16x16x32_bf16 v[104:107],a[208:211],a[132:135],v[104:107]
 s_mov_b32 s35,1024
 buffer_load_dwordx4 v37,s[4:7],s35 offen lds
 v_mfma_f32_16x16x32_bf16 v[104:107],a[212:215],a[148:151],v[104:107]
 ds_read_b64_tr_b16 a[232:233],v19 offset:32768
 ds_read_b64_tr_b16 a[234:235],v19 offset:33792
 v_mfma_f32_16x16x32_bf16 v[108:111],a[216:219],a[132:135],v[108:111]
 v_mfma_f32_16x16x32_bf16 v[108:111],a[220:223],a[148:151],v[108:111]
 ds_read_b64_tr_b16 a[236:237],v19 offset:40960
 ds_read_b64_tr_b16 a[238:239],v19 offset:41984
 v_mfma_f32_16x16x32_bf16 v[112:115],a[208:211],a[136:139],v[112:115]
 s_mov_b32 s35,4194304
 buffer_load_dwordx4 v38,s[8:11],s35 offen lds
 v_mfma_f32_16x16x32_bf16 v[112:115],a[212:215],a[152:155],v[112:115]
 ds_read_b64_tr_b16 a[240:241],v20 offset:32768
 v_mfma_f32_16x16x32_bf16 v[116:119],a[216:219],a[136:139],v[116:119]
 ds_read_b64_tr_b16 a[242:243],v20 offset:33792
 v_mfma_f32_16x16x32_bf16 v[116:119],a[220:223],a[152:155],v[116:119]
 s_waitcnt lgkmcnt(6)
 s_add_u32 m0,s26,32768
 v_mfma_f32_16x16x32_bf16 v[120:123],a[208:211],a[140:143],v[120:123]
 ds_read_b64_tr_b16 a[244:245],v20 offset:40960
 v_mfma_f32_16x16x32_bf16 v[120:123],a[212:215],a[156:159],v[120:123]
 s_add_u32 s35,s30,896
 ds_read_b64_tr_b16 a[246:247],v20 offset:41984
 buffer_load_dwordx4 v34,s[4:7],s35 offen offset:0 lds
 v_mfma_f32_16x16x32_bf16 v[124:127],a[216:219],a[140:143],v[124:127]
 ds_read_b64_tr_b16 a[248:249],v21 offset:32768
 v_mfma_f32_16x16x32_bf16 v[124:127],a[220:223],a[156:159],v[124:127]
 ds_read_b64_tr_b16 a[250:251],v21 offset:33792
 v_mfma_f32_16x16x32_bf16 v[128:131],a[224:227],a[128:131],v[128:131]
 ds_read_b64_tr_b16 a[252:253],v21 offset:40960
 v_mfma_f32_16x16x32_bf16 v[128:131],a[228:231],a[144:147],v[128:131]
 s_waitcnt lgkmcnt(9)
 s_add_u32 s35,s30,9088
 buffer_load_dwordx4 v35,s[4:7],s35 offen offset:1024 lds
 v_mfma_f32_16x16x32_bf16 v[132:135],a[232:235],a[128:131],v[132:135]
 s_waitcnt lgkmcnt(7)
 ds_read_b64_tr_b16 a[254:255],v21 offset:41984
 v_mfma_f32_16x16x32_bf16 v[132:135],a[236:239],a[144:147],v[132:135]
 v_mfma_f32_16x16x32_bf16 v[136:139],a[224:227],a[132:135],v[136:139]
 v_mfma_f32_16x16x32_bf16 v[136:139],a[228:231],a[148:151],v[136:139]
 v_mfma_f32_16x16x32_bf16 v[140:143],a[232:235],a[132:135],v[140:143]
 s_add_u32 s35,s30,17280
 buffer_load_dwordx4 v34,s[4:7],s35 offen offset:2048 lds
 v_mfma_f32_16x16x32_bf16 v[140:143],a[236:239],a[148:151],v[140:143]
 v_mfma_f32_16x16x32_bf16 v[144:147],a[224:227],a[136:139],v[144:147]
 v_mfma_f32_16x16x32_bf16 v[144:147],a[228:231],a[152:155],v[144:147]
 v_mfma_f32_16x16x32_bf16 v[148:151],a[232:235],a[136:139],v[148:151]
 s_waitcnt vmcnt(19)
 s_waitcnt lgkmcnt(0)
 s_barrier
 v_mfma_f32_16x16x32_bf16 v[148:151],a[236:239],a[152:155],v[148:151]
 s_add_u32 s35,s30,25472
 buffer_load_dwordx4 v35,s[4:7],s35 offen offset:3072 lds
 v_mfma_f32_16x16x32_bf16 v[152:155],a[224:227],a[140:143],v[152:155]
 ds_read_b64_tr_b16 a[192:193],v14 offset:49152
 v_mfma_f32_16x16x32_bf16 v[152:155],a[228:231],a[156:159],v[152:155]
 ds_read_b64_tr_b16 a[194:195],v14 offset:50176
 v_mfma_f32_16x16x32_bf16 v[156:159],a[232:235],a[140:143],v[156:159]
 s_add_u32 m0,s26,36864
 ds_read_b64_tr_b16 a[196:197],v14 offset:57344
 v_mfma_f32_16x16x32_bf16 v[156:159],a[236:239],a[156:159],v[156:159]
 s_add_u32 s35,s30,37760
 buffer_load_dwordx4 v34,s[4:7],s35 offen offset:0 lds
 v_mfma_f32_16x16x32_bf16 v[160:163],a[240:243],a[128:131],v[160:163]
 ds_read_b64_tr_b16 a[198:199],v14 offset:58368
 v_mfma_f32_16x16x32_bf16 v[160:163],a[244:247],a[144:147],v[160:163]
 v_mfma_f32_16x16x32_bf16 v[164:167],a[248:251],a[128:131],v[164:167]
 ds_read_b64_tr_b16 a[200:201],v15 offset:49152
 v_mfma_f32_16x16x32_bf16 v[164:167],a[252:255],a[144:147],v[164:167]
 ds_read_b64_tr_b16 a[202:203],v15 offset:50176
 v_mfma_f32_16x16x32_bf16 v[168:171],a[240:243],a[132:135],v[168:171]
 s_add_u32 s35,s30,45952
 buffer_load_dwordx4 v35,s[4:7],s35 offen offset:1024 lds
 v_mfma_f32_16x16x32_bf16 v[168:171],a[244:247],a[148:151],v[168:171]
 ds_read_b64_tr_b16 a[204:205],v15 offset:57344
 v_mfma_f32_16x16x32_bf16 v[172:175],a[248:251],a[132:135],v[172:175]
 ds_read_b64_tr_b16 a[206:207],v15 offset:58368
 v_mfma_f32_16x16x32_bf16 v[172:175],a[252:255],a[148:151],v[172:175]
 v_mfma_f32_16x16x32_bf16 v[176:179],a[240:243],a[136:139],v[176:179]
 ds_read_b64_tr_b16 a[208:209],v16 offset:49152
 v_mfma_f32_16x16x32_bf16 v[176:179],a[244:247],a[152:155],v[176:179]
 s_add_u32 s35,s30,54144
 buffer_load_dwordx4 v34,s[4:7],s35 offen offset:2048 lds
 v_mfma_f32_16x16x32_bf16 v[180:183],a[248:251],a[136:139],v[180:183]
 ds_read_b64_tr_b16 a[210:211],v16 offset:50176
 v_mfma_f32_16x16x32_bf16 v[180:183],a[252:255],a[152:155],v[180:183]
 ds_read_b64_tr_b16 a[212:213],v16 offset:57344
 v_mfma_f32_16x16x32_bf16 v[184:187],a[240:243],a[140:143],v[184:187]
 v_mfma_f32_16x16x32_bf16 v[184:187],a[244:247],a[156:159],v[184:187]
 ds_read_b64_tr_b16 a[214:215],v16 offset:58368
 v_mfma_f32_16x16x32_bf16 v[188:191],a[248:251],a[140:143],v[188:191]
 s_add_u32 s35,s30,62336
 buffer_load_dwordx4 v35,s[4:7],s35 offen offset:3072 lds
 v_mfma_f32_16x16x32_bf16 v[188:191],a[252:255],a[156:159],v[188:191]
 s_waitcnt lgkmcnt(10)
 v_mfma_f32_16x16x32_bf16 v[64:67],a[192:195],a[160:163],v[64:67]
 s_waitcnt lgkmcnt(8)
 ds_read_b64_tr_b16 a[216:217],v17 offset:49152
 v_mfma_f32_16x16x32_bf16 v[64:67],a[196:199],a[176:179],v[64:67]
 s_waitcnt lgkmcnt(7)
 s_add_u32 m0,s25,98304
 ds_read_b64_tr_b16 a[218:219],v17 offset:50176
 v_mfma_f32_16x16x32_bf16 v[68:71],a[200:203],a[160:163],v[68:71]
 s_waitcnt lgkmcnt(6)
 s_add_u32 s34,s29,3670016
 buffer_load_dwordx4 v32,s[8:11],s34 offen offset:0 lds
 v_mfma_f32_16x16x32_bf16 v[68:71],a[204:207],a[176:179],v[68:71]
 ds_read_b64_tr_b16 a[220:221],v17 offset:57344
 v_mfma_f32_16x16x32_bf16 v[72:75],a[192:195],a[164:167],v[72:75]
 ds_read_b64_tr_b16 a[222:223],v17 offset:58368
 v_mfma_f32_16x16x32_bf16 v[72:75],a[196:199],a[180:183],v[72:75]
 ds_read_b64_tr_b16 a[224:225],v18 offset:49152
 v_mfma_f32_16x16x32_bf16 v[76:79],a[200:203],a[164:167],v[76:79]
 ds_read_b64_tr_b16 a[226:227],v18 offset:50176
 v_mfma_f32_16x16x32_bf16 v[76:79],a[204:207],a[180:183],v[76:79]
 s_add_u32 s34,s29,3701760
 buffer_load_dwordx4 v32,s[8:11],s34 offen offset:1024 lds
 v_mfma_f32_16x16x32_bf16 v[80:83],a[192:195],a[168:171],v[80:83]
 ds_read_b64_tr_b16 a[228:229],v18 offset:57344
 v_mfma_f32_16x16x32_bf16 v[80:83],a[196:199],a[184:187],v[80:83]
 ds_read_b64_tr_b16 a[230:231],v18 offset:58368
 v_mfma_f32_16x16x32_bf16 v[84:87],a[200:203],a[168:171],v[84:87]
 s_waitcnt vmcnt(16)
 ds_read_b128 a[128:131],v22 offset:0
 v_mfma_f32_16x16x32_bf16 v[84:87],a[204:207],a[184:187],v[84:87]
 ds_read_b128 a[144:147],v23 offset:0
 v_mfma_f32_16x16x32_bf16 v[88:91],a[192:195],a[172:175],v[88:91]
 s_add_u32 s34,s29,3733504
 buffer_load_dwordx4 v33,s[8:11],s34 offen offset:2048 lds
 v_mfma_f32_16x16x32_bf16 v[88:91],a[196:199],a[188:191],v[88:91]
 ds_read_b128 a[132:135],v22 offset:2048
 v_mfma_f32_16x16x32_bf16 v[92:95],a[200:203],a[172:175],v[92:95]
 ds_read_b128 a[148:151],v23 offset:2048
 v_mfma_f32_16x16x32_bf16 v[92:95],a[204:207],a[188:191],v[92:95]
 s_waitcnt lgkmcnt(14)
 ds_read_b128 a[136:139],v22 offset:4096
 v_mfma_f32_16x16x32_bf16 v[96:99],a[208:211],a[160:163],v[96:99]
 s_waitcnt lgkmcnt(13)
 ds_read_b128 a[152:155],v23 offset:4096
 v_mfma_f32_16x16x32_bf16 v[96:99],a[212:215],a[176:179],v[96:99]
 s_waitcnt lgkmcnt(12)
 s_add_u32 s34,s29,3765248
 buffer_load_dwordx4 v33,s[8:11],s34 offen offset:3072 lds
 v_mfma_f32_16x16x32_bf16 v[100:103],a[216:219],a[160:163],v[100:103]
 s_waitcnt lgkmcnt(10)
 ds_read_b128 a[140:143],v22 offset:6144
 v_mfma_f32_16x16x32_bf16 v[100:103],a[220:223],a[176:179],v[100:103]
 ds_read_b128 a[156:159],v23 offset:6144
 v_mfma_f32_16x16x32_bf16 v[104:107],a[208:211],a[164:167],v[104:107]
 ds_read_b64_tr_b16 a[232:233],v19 offset:49152
 v_mfma_f32_16x16x32_bf16 v[104:107],a[212:215],a[180:183],v[104:107]
 ds_read_b64_tr_b16 a[234:235],v19 offset:50176
 v_mfma_f32_16x16x32_bf16 v[108:111],a[216:219],a[164:167],v[108:111]
 v_mfma_f32_16x16x32_bf16 v[108:111],a[220:223],a[180:183],v[108:111]
 ds_read_b64_tr_b16 a[236:237],v19 offset:57344
 v_mfma_f32_16x16x32_bf16 v[112:115],a[208:211],a[168:171],v[112:115]
 ds_read_b64_tr_b16 a[238:239],v19 offset:58368
 v_mfma_f32_16x16x32_bf16 v[112:115],a[212:215],a[184:187],v[112:115]
 ds_read_b64_tr_b16 a[240:241],v20 offset:49152
 s_waitcnt lgkmcnt(5)
 s_add_u32 m0,s26,131072
 v_mfma_f32_16x16x32_bf16 v[116:119],a[216:219],a[168:171],v[116:119]
 s_add_u32 s35,s30,1024
 ds_read_b64_tr_b16 a[242:243],v20 offset:50176
 buffer_load_dwordx4 v34,s[4:7],s35 offen offset:0 lds
 v_mfma_f32_16x16x32_bf16 v[116:119],a[220:223],a[184:187],v[116:119]
 v_mfma_f32_16x16x32_bf16 v[120:123],a[208:211],a[172:175],v[120:123]
 ds_read_b64_tr_b16 a[244:245],v20 offset:57344
 v_mfma_f32_16x16x32_bf16 v[120:123],a[212:215],a[188:191],v[120:123]
 ds_read_b64_tr_b16 a[246:247],v20 offset:58368
 v_mfma_f32_16x16x32_bf16 v[124:127],a[216:219],a[172:175],v[124:127]
 ds_read_b64_tr_b16 a[248:249],v21 offset:49152
 v_mfma_f32_16x16x32_bf16 v[124:127],a[220:223],a[188:191],v[124:127]
 s_add_u32 s35,s30,9216
 buffer_load_dwordx4 v35,s[4:7],s35 offen offset:1024 lds
 v_mfma_f32_16x16x32_bf16 v[128:131],a[224:227],a[160:163],v[128:131]
 ds_read_b64_tr_b16 a[250:251],v21 offset:50176
 v_mfma_f32_16x16x32_bf16 v[128:131],a[228:231],a[176:179],v[128:131]
 s_waitcnt lgkmcnt(8)
 ds_read_b64_tr_b16 a[252:253],v21 offset:57344
 v_mfma_f32_16x16x32_bf16 v[132:135],a[232:235],a[160:163],v[132:135]
 s_waitcnt lgkmcnt(7)
 ds_read_b64_tr_b16 a[254:255],v21 offset:58368
 v_mfma_f32_16x16x32_bf16 v[132:135],a[236:239],a[176:179],v[132:135]
 v_mfma_f32_16x16x32_bf16 v[136:139],a[224:227],a[164:167],v[136:139]
 s_add_u32 s35,s30,17408
 buffer_load_dwordx4 v34,s[4:7],s35 offen offset:2048 lds
 v_mfma_f32_16x16x32_bf16 v[136:139],a[228:231],a[180:183],v[136:139]
 v_mfma_f32_16x16x32_bf16 v[140:143],a[232:235],a[164:167],v[140:143]
 v_mfma_f32_16x16x32_bf16 v[140:143],a[236:239],a[180:183],v[140:143]
 v_mfma_f32_16x16x32_bf16 v[144:147],a[224:227],a[168:171],v[144:147]
 v_mfma_f32_16x16x32_bf16 v[144:147],a[228:231],a[184:187],v[144:147]
 s_add_u32 s35,s30,25600
 buffer_load_dwordx4 v35,s[4:7],s35 offen offset:3072 lds
 v_mfma_f32_16x16x32_bf16 v[148:151],a[232:235],a[168:171],v[148:151]
 s_waitcnt vmcnt(18)
 s_waitcnt lgkmcnt(0)
 s_barrier
 v_mfma_f32_16x16x32_bf16 v[148:151],a[236:239],a[184:187],v[148:151]
 ds_read_b64_tr_b16 a[192:193],v14 offset:16384
 v_mfma_f32_16x16x32_bf16 v[152:155],a[224:227],a[172:175],v[152:155]
 v_mfma_f32_16x16x32_bf16 v[152:155],a[228:231],a[188:191],v[152:155]
 ds_read_b64_tr_b16 a[194:195],v14 offset:17408
 v_mfma_f32_16x16x32_bf16 v[156:159],a[232:235],a[172:175],v[156:159]
 s_add_u32 m0,s26,135168
 ds_read_b64_tr_b16 a[196:197],v14 offset:24576
 v_mfma_f32_16x16x32_bf16 v[156:159],a[236:239],a[188:191],v[156:159]
 s_add_u32 s35,s30,37888
 buffer_load_dwordx4 v34,s[4:7],s35 offen offset:0 lds
 v_mfma_f32_16x16x32_bf16 v[160:163],a[240:243],a[160:163],v[160:163]
 ds_read_b64_tr_b16 a[198:199],v14 offset:25600
 v_mfma_f32_16x16x32_bf16 v[160:163],a[244:247],a[176:179],v[160:163]
 v_mfma_f32_16x16x32_bf16 v[164:167],a[248:251],a[160:163],v[164:167]
 ds_read_b64_tr_b16 a[200:201],v15 offset:16384
 v_mfma_f32_16x16x32_bf16 v[164:167],a[252:255],a[176:179],v[164:167]
 ds_read_b64_tr_b16 a[202:203],v15 offset:17408
 v_mfma_f32_16x16x32_bf16 v[168:171],a[240:243],a[164:167],v[168:171]
 s_add_u32 s35,s30,46080
 buffer_load_dwordx4 v35,s[4:7],s35 offen offset:1024 lds
 v_mfma_f32_16x16x32_bf16 v[168:171],a[244:247],a[180:183],v[168:171]
 ds_read_b64_tr_b16 a[204:205],v15 offset:24576
 v_mfma_f32_16x16x32_bf16 v[172:175],a[248:251],a[164:167],v[172:175]
 ds_read_b64_tr_b16 a[206:207],v15 offset:25600
 v_mfma_f32_16x16x32_bf16 v[172:175],a[252:255],a[180:183],v[172:175]
 v_mfma_f32_16x16x32_bf16 v[176:179],a[240:243],a[168:171],v[176:179]
 ds_read_b64_tr_b16 a[208:209],v16 offset:16384
 v_mfma_f32_16x16x32_bf16 v[176:179],a[244:247],a[184:187],v[176:179]
 s_add_u32 s35,s30,54272
 buffer_load_dwordx4 v34,s[4:7],s35 offen offset:2048 lds
 v_mfma_f32_16x16x32_bf16 v[180:183],a[248:251],a[168:171],v[180:183]
 ds_read_b64_tr_b16 a[210:211],v16 offset:17408
 v_mfma_f32_16x16x32_bf16 v[180:183],a[252:255],a[184:187],v[180:183]
 ds_read_b64_tr_b16 a[212:213],v16 offset:24576
 v_mfma_f32_16x16x32_bf16 v[184:187],a[240:243],a[172:175],v[184:187]
 v_mfma_f32_16x16x32_bf16 v[184:187],a[244:247],a[188:191],v[184:187]
 ds_read_b64_tr_b16 a[214:215],v16 offset:25600
 v_mfma_f32_16x16x32_bf16 v[188:191],a[248:251],a[172:175],v[188:191]
 s_add_u32 s35,s30,62464
 buffer_load_dwordx4 v35,s[4:7],s35 offen offset:3072 lds
 v_mfma_f32_16x16x32_bf16 v[188:191],a[252:255],a[188:191],v[188:191]
 s_waitcnt lgkmcnt(10)
 v_mfma_f32_16x16x32_bf16 v[64:67],a[192:195],a[128:131],v[64:67]
 s_waitcnt lgkmcnt(8)
 ds_read_b64_tr_b16 a[216:217],v17 offset:16384
 v_mfma_f32_16x16x32_bf16 v[64:67],a[196:199],a[144:147],v[64:67]
 s_waitcnt lgkmcnt(7)
 s_add_u32 m0,s25,114688
 ds_read_b64_tr_b16 a[218:219],v17 offset:17408
 v_mfma_f32_16x16x32_bf16 v[68:71],a[200:203],a[128:131],v[68:71]
 s_waitcnt lgkmcnt(6)
 s_add_u32 s34,s29,4194304
 buffer_load_dwordx4 v32,s[8:11],s34 offen offset:0 lds
 v_mfma_f32_16x16x32_bf16 v[68:71],a[204:207],a[144:147],v[68:71]
 ds_read_b64_tr_b16 a[220:221],v17 offset:24576
 v_mfma_f32_16x16x32_bf16 v[72:75],a[192:195],a[132:135],v[72:75]
 ds_read_b64_tr_b16 a[222:223],v17 offset:25600
 v_mfma_f32_16x16x32_bf16 v[72:75],a[196:199],a[148:151],v[72:75]
 ds_read_b64_tr_b16 a[224:225],v18 offset:16384
 v_mfma_f32_16x16x32_bf16 v[76:79],a[200:203],a[132:135],v[76:79]
 ds_read_b64_tr_b16 a[226:227],v18 offset:17408
 v_mfma_f32_16x16x32_bf16 v[76:79],a[204:207],a[148:151],v[76:79]
 v_mfma_f32_16x16x32_bf16 v[80:83],a[192:195],a[136:139],v[80:83]
 ds_read_b64_tr_b16 a[228:229],v18 offset:24576
 v_mfma_f32_16x16x32_bf16 v[80:83],a[196:199],a[152:155],v[80:83]
 s_add_u32 s34,s29,4226048
 ds_read_b64_tr_b16 a[230:231],v18 offset:25600
 buffer_load_dwordx4 v32,s[8:11],s34 offen offset:1024 lds
 v_mfma_f32_16x16x32_bf16 v[84:87],a[200:203],a[136:139],v[84:87]
 s_waitcnt vmcnt(14)
 ds_read_b128 a[160:163],v24 offset:0
 v_mfma_f32_16x16x32_bf16 v[84:87],a[204:207],a[152:155],v[84:87]
 ds_read_b128 a[176:179],v25 offset:0
 v_mfma_f32_16x16x32_bf16 v[88:91],a[192:195],a[140:143],v[88:91]
 v_mfma_f32_16x16x32_bf16 v[88:91],a[196:199],a[156:159],v[88:91]
 ds_read_b128 a[164:167],v24 offset:2048
 v_mfma_f32_16x16x32_bf16 v[92:95],a[200:203],a[140:143],v[92:95]
 ds_read_b128 a[180:183],v25 offset:2048
 v_mfma_f32_16x16x32_bf16 v[92:95],a[204:207],a[156:159],v[92:95]
 s_waitcnt lgkmcnt(14)
 ds_read_b128 a[168:171],v24 offset:4096
 v_mfma_f32_16x16x32_bf16 v[96:99],a[208:211],a[128:131],v[96:99]
 s_waitcnt lgkmcnt(13)
 ds_read_b128 a[184:187],v25 offset:4096
 v_mfma_f32_16x16x32_bf16 v[96:99],a[212:215],a[144:147],v[96:99]
 s_waitcnt lgkmcnt(12)
 ds_read_b128 a[172:175],v24 offset:6144
 v_mfma_f32_16x16x32_bf16 v[100:103],a[216:219],a[128:131],v[100:103]
 s_waitcnt lgkmcnt(11)
 s_add_u32 s34,s29,4257792
 buffer_load_dwordx4 v33,s[8:11],s34 offen offset:2048 lds
 v_mfma_f32_16x16x32_bf16 v[100:103],a[220:223],a[144:147],v[100:103]
 ds_read_b128 a[188:191],v25 offset:6144
 v_mfma_f32_16x16x32_bf16 v[104:107],a[208:211],a[132:135],v[104:107]
 ds_read_b64_tr_b16 a[232:233],v19 offset:16384
 v_mfma_f32_16x16x32_bf16 v[104:107],a[212:215],a[148:151],v[104:107]
 ds_read_b64_tr_b16 a[234:235],v19 offset:17408
 v_mfma_f32_16x16x32_bf16 v[108:111],a[216:219],a[132:135],v[108:111]
 v_mfma_f32_16x16x32_bf16 v[108:111],a[220:223],a[148:151],v[108:111]
 ds_read_b64_tr_b16 a[236:237],v19 offset:24576
 v_mfma_f32_16x16x32_bf16 v[112:115],a[208:211],a[136:139],v[112:115]
 ds_read_b64_tr_b16 a[238:239],v19 offset:25600
 v_mfma_f32_16x16x32_bf16 v[112:115],a[212:215],a[152:155],v[112:115]
 ds_read_b64_tr_b16 a[240:241],v20 offset:16384
 v_mfma_f32_16x16x32_bf16 v[116:119],a[216:219],a[136:139],v[116:119]
 s_add_u32 s34,s29,4289536
 ds_read_b64_tr_b16 a[242:243],v20 offset:17408
 buffer_load_dwordx4 v33,s[8:11],s34 offen offset:3072 lds
 v_mfma_f32_16x16x32_bf16 v[116:119],a[220:223],a[152:155],v[116:119]
 v_mfma_f32_16x16x32_bf16 v[120:123],a[208:211],a[140:143],v[120:123]
 ds_read_b64_tr_b16 a[244:245],v20 offset:24576
 v_mfma_f32_16x16x32_bf16 v[120:123],a[212:215],a[156:159],v[120:123]
 ds_read_b64_tr_b16 a[246:247],v20 offset:25600
 v_mfma_f32_16x16x32_bf16 v[124:127],a[216:219],a[140:143],v[124:127]
 ds_read_b64_tr_b16 a[248:249],v21 offset:16384
 v_mfma_f32_16x16x32_bf16 v[124:127],a[220:223],a[156:159],v[124:127]
 s_waitcnt lgkmcnt(15)
 ds_read_b64_tr_b16 a[250:251],v21 offset:17408
 v_mfma_f32_16x16x32_bf16 v[128:131],a[224:227],a[128:131],v[128:131]
 s_waitcnt lgkmcnt(15)
 v_mfma_f32_16x16x32_bf16 v[128:131],a[228:231],a[144:147],v[128:131]
 s_waitcnt lgkmcnt(8)
 ds_read_b64_tr_b16 a[252:253],v21 offset:24576
 v_mfma_f32_16x16x32_bf16 v[132:135],a[232:235],a[128:131],v[132:135]
 s_waitcnt lgkmcnt(7)
 ds_read_b64_tr_b16 a[254:255],v21 offset:25600
 v_mfma_f32_16x16x32_bf16 v[132:135],a[236:239],a[144:147],v[132:135]
 v_mfma_f32_16x16x32_bf16 v[136:139],a[224:227],a[132:135],v[136:139]
 v_mfma_f32_16x16x32_bf16 v[136:139],a[228:231],a[148:151],v[136:139]
 v_mfma_f32_16x16x32_bf16 v[140:143],a[232:235],a[132:135],v[140:143]
 v_mfma_f32_16x16x32_bf16 v[140:143],a[236:239],a[148:151],v[140:143]
 v_mfma_f32_16x16x32_bf16 v[144:147],a[224:227],a[136:139],v[144:147]
 v_mfma_f32_16x16x32_bf16 v[144:147],a[228:231],a[152:155],v[144:147]
 v_mfma_f32_16x16x32_bf16 v[148:151],a[232:235],a[136:139],v[148:151]
 s_waitcnt vmcnt(12)
 s_waitcnt lgkmcnt(0)
 s_barrier
 v_mfma_f32_16x16x32_bf16 v[148:151],a[236:239],a[152:155],v[148:151]
 ds_read_b64_tr_b16 a[192:193],v14 offset:32768
 v_mfma_f32_16x16x32_bf16 v[152:155],a[224:227],a[140:143],v[152:155]
 v_mfma_f32_16x16x32_bf16 v[152:155],a[228:231],a[156:159],v[152:155]
 ds_read_b64_tr_b16 a[194:195],v14 offset:33792
 v_mfma_f32_16x16x32_bf16 v[156:159],a[232:235],a[140:143],v[156:159]
 ds_read_b64_tr_b16 a[196:197],v14 offset:40960
 v_mfma_f32_16x16x32_bf16 v[156:159],a[236:239],a[156:159],v[156:159]
 v_mfma_f32_16x16x32_bf16 v[160:163],a[240:243],a[128:131],v[160:163]
 ds_read_b64_tr_b16 a[198:199],v14 offset:41984
 v_mfma_f32_16x16x32_bf16 v[160:163],a[244:247],a[144:147],v[160:163]
 v_mfma_f32_16x16x32_bf16 v[164:167],a[248:251],a[128:131],v[164:167]
 ds_read_b64_tr_b16 a[200:201],v15 offset:32768
 v_mfma_f32_16x16x32_bf16 v[164:167],a[252:255],a[144:147],v[164:167]
 ds_read_b64_tr_b16 a[202:203],v15 offset:33792
 v_mfma_f32_16x16x32_bf16 v[168:171],a[240:243],a[132:135],v[168:171]
 v_mfma_f32_16x16x32_bf16 v[168:171],a[244:247],a[148:151],v[168:171]
 ds_read_b64_tr_b16 a[204:205],v15 offset:40960
 v_mfma_f32_16x16x32_bf16 v[172:175],a[248:251],a[132:135],v[172:175]
 ds_read_b64_tr_b16 a[206:207],v15 offset:41984
 v_mfma_f32_16x16x32_bf16 v[172:175],a[252:255],a[148:151],v[172:175]
 v_mfma_f32_16x16x32_bf16 v[176:179],a[240:243],a[136:139],v[176:179]
 ds_read_b64_tr_b16 a[208:209],v16 offset:32768
 v_mfma_f32_16x16x32_bf16 v[176:179],a[244:247],a[152:155],v[176:179]
 v_mfma_f32_16x16x32_bf16 v[180:183],a[248:251],a[136:139],v[180:183]
 ds_read_b64_tr_b16 a[210:211],v16 offset:33792
 v_mfma_f32_16x16x32_bf16 v[180:183],a[252:255],a[152:155],v[180:183]
 ds_read_b64_tr_b16 a[212:213],v16 offset:40960
 v_mfma_f32_16x16x32_bf16 v[184:187],a[240:243],a[140:143],v[184:187]
 v_mfma_f32_16x16x32_bf16 v[184:187],a[244:247],a[156:159],v[184:187]
 ds_read_b64_tr_b16 a[214:215],v16 offset:41984
 v_mfma_f32_16x16x32_bf16 v[188:191],a[248:251],a[140:143],v[188:191]
 v_mfma_f32_16x16x32_bf16 v[188:191],a[252:255],a[156:159],v[188:191]
 s_waitcnt lgkmcnt(10)
 v_mfma_f32_16x16x32_bf16 v[64:67],a[192:195],a[160:163],v[64:67]
 s_waitcnt lgkmcnt(8)
 ds_read_b64_tr_b16 a[216:217],v17 offset:32768
 v_mfma_f32_16x16x32_bf16 v[64:67],a[196:199],a[176:179],v[64:67]
 s_waitcnt lgkmcnt(7)
 s_add_u32 m0,s25,81920
 ds_read_b64_tr_b16 a[218:219],v17 offset:33792
 v_mfma_f32_16x16x32_bf16 v[68:71],a[200:203],a[160:163],v[68:71]
 s_waitcnt lgkmcnt(6)
 buffer_load_dwordx4 v30,s[16:19],s28 offen offset:0 sc1 nt lds
 v_mfma_f32_16x16x32_bf16 v[68:71],a[204:207],a[176:179],v[68:71]
 ds_read_b64_tr_b16 a[220:221],v17 offset:40960
 v_mfma_f32_16x16x32_bf16 v[72:75],a[192:195],a[164:167],v[72:75]
 ds_read_b64_tr_b16 a[222:223],v17 offset:41984
 v_mfma_f32_16x16x32_bf16 v[72:75],a[196:199],a[180:183],v[72:75]
 ds_read_b64_tr_b16 a[224:225],v18 offset:32768
 v_mfma_f32_16x16x32_bf16 v[76:79],a[200:203],a[164:167],v[76:79]
 ds_read_b64_tr_b16 a[226:227],v18 offset:33792
 v_mfma_f32_16x16x32_bf16 v[76:79],a[204:207],a[180:183],v[76:79]
 v_mfma_f32_16x16x32_bf16 v[80:83],a[192:195],a[168:171],v[80:83]
 ds_read_b64_tr_b16 a[228:229],v18 offset:40960
 v_mfma_f32_16x16x32_bf16 v[80:83],a[196:199],a[184:187],v[80:83]
 ds_read_b64_tr_b16 a[230:231],v18 offset:41984
 v_mfma_f32_16x16x32_bf16 v[84:87],a[200:203],a[168:171],v[84:87]
 s_waitcnt vmcnt(5)
 ds_read_b128 a[128:131],v22 offset:0
 buffer_load_dwordx4 v31,s[16:19],s28 offen offset:1024 sc1 nt lds
 v_mfma_f32_16x16x32_bf16 v[84:87],a[204:207],a[184:187],v[84:87]
 ds_read_b128 a[144:147],v23 offset:0
 v_mfma_f32_16x16x32_bf16 v[88:91],a[192:195],a[172:175],v[88:91]
 v_mfma_f32_16x16x32_bf16 v[88:91],a[196:199],a[188:191],v[88:91]
 ds_read_b128 a[132:135],v22 offset:2048
 v_mfma_f32_16x16x32_bf16 v[92:95],a[200:203],a[172:175],v[92:95]
 ds_read_b128 a[148:151],v23 offset:2048
 v_mfma_f32_16x16x32_bf16 v[92:95],a[204:207],a[188:191],v[92:95]
 s_waitcnt lgkmcnt(14)
 ds_read_b128 a[136:139],v22 offset:4096
 v_mfma_f32_16x16x32_bf16 v[96:99],a[208:211],a[160:163],v[96:99]
 s_waitcnt lgkmcnt(13)
 ds_read_b128 a[152:155],v23 offset:4096
 v_mfma_f32_16x16x32_bf16 v[96:99],a[212:215],a[176:179],v[96:99]
 s_waitcnt lgkmcnt(12)
 buffer_load_dwordx4 v30,s[16:19],s28 offen offset:2048 sc1 nt lds
 v_mfma_f32_16x16x32_bf16 v[100:103],a[216:219],a[160:163],v[100:103]
 s_waitcnt lgkmcnt(10)
 ds_read_b128 a[140:143],v22 offset:6144
 v_mfma_f32_16x16x32_bf16 v[100:103],a[220:223],a[176:179],v[100:103]
 ds_read_b128 a[156:159],v23 offset:6144
 v_mfma_f32_16x16x32_bf16 v[104:107],a[208:211],a[164:167],v[104:107]
 ds_read_b64_tr_b16 a[232:233],v19 offset:32768
 v_mfma_f32_16x16x32_bf16 v[104:107],a[212:215],a[180:183],v[104:107]
 ds_read_b64_tr_b16 a[234:235],v19 offset:33792
 v_mfma_f32_16x16x32_bf16 v[108:111],a[216:219],a[164:167],v[108:111]
 v_mfma_f32_16x16x32_bf16 v[108:111],a[220:223],a[180:183],v[108:111]
 ds_read_b64_tr_b16 a[236:237],v19 offset:40960
 v_mfma_f32_16x16x32_bf16 v[112:115],a[208:211],a[168:171],v[112:115]
 ds_read_b64_tr_b16 a[238:239],v19 offset:41984
 v_mfma_f32_16x16x32_bf16 v[112:115],a[212:215],a[184:187],v[112:115]
 ds_read_b64_tr_b16 a[240:241],v20 offset:32768
 buffer_load_dwordx4 v31,s[16:19],s28 offen offset:3072 sc1 nt lds
 s_add_u32 s28,s28,16384
 v_mfma_f32_16x16x32_bf16 v[116:119],a[216:219],a[168:171],v[116:119]
 ds_read_b64_tr_b16 a[242:243],v20 offset:33792
 v_mfma_f32_16x16x32_bf16 v[116:119],a[220:223],a[184:187],v[116:119]
 v_mfma_f32_16x16x32_bf16 v[120:123],a[208:211],a[172:175],v[120:123]
 ds_read_b64_tr_b16 a[244:245],v20 offset:40960
 v_mfma_f32_16x16x32_bf16 v[120:123],a[212:215],a[188:191],v[120:123]
 ds_read_b64_tr_b16 a[246:247],v20 offset:41984
 v_mfma_f32_16x16x32_bf16 v[124:127],a[216:219],a[172:175],v[124:127]
 ds_read_b64_tr_b16 a[248:249],v21 offset:32768
 v_mfma_f32_16x16x32_bf16 v[124:127],a[220:223],a[188:191],v[124:127]
 s_waitcnt lgkmcnt(15)
 s_add_u32 m0,s25,32768
 ds_read_b64_tr_b16 a[250:251],v21 offset:33792
 v_mfma_f32_16x16x32_bf16 v[128:131],a[224:227],a[160:163],v[128:131]
 s_waitcnt lgkmcnt(15)
 v_mfma_f32_16x16x32_bf16 v[128:131],a[228:231],a[176:179],v[128:131]
 s_waitcnt lgkmcnt(8)
 ds_read_b64_tr_b16 a[252:253],v21 offset:40960
 buffer_load_dwordx4 v26,s[12:15],s27 offen offset:0 sc1 nt lds
 v_mfma_f32_16x16x32_bf16 v[132:135],a[232:235],a[160:163],v[132:135]
 s_waitcnt lgkmcnt(7)
 ds_read_b64_tr_b16 a[254:255],v21 offset:41984
 v_mfma_f32_16x16x32_bf16 v[132:135],a[236:239],a[176:179],v[132:135]
 v_mfma_f32_16x16x32_bf16 v[136:139],a[224:227],a[164:167],v[136:139]
 v_mfma_f32_16x16x32_bf16 v[136:139],a[228:231],a[180:183],v[136:139]
 v_mfma_f32_16x16x32_bf16 v[140:143],a[232:235],a[164:167],v[140:143]
 v_mfma_f32_16x16x32_bf16 v[140:143],a[236:239],a[180:183],v[140:143]
 v_mfma_f32_16x16x32_bf16 v[144:147],a[224:227],a[168:171],v[144:147]
 buffer_load_dwordx4 v27,s[12:15],s27 offen offset:1024 sc1 nt lds
 v_mfma_f32_16x16x32_bf16 v[144:147],a[228:231],a[184:187],v[144:147]
 v_mfma_f32_16x16x32_bf16 v[148:151],a[232:235],a[168:171],v[148:151]
 s_waitcnt vmcnt(6)
 s_waitcnt lgkmcnt(0)
 s_barrier
 v_mfma_f32_16x16x32_bf16 v[148:151],a[236:239],a[184:187],v[148:151]
 ds_read_b64_tr_b16 a[192:193],v14 offset:49152
 v_mfma_f32_16x16x32_bf16 v[152:155],a[224:227],a[172:175],v[152:155]
 v_mfma_f32_16x16x32_bf16 v[152:155],a[228:231],a[188:191],v[152:155]
 ds_read_b64_tr_b16 a[194:195],v14 offset:50176
 v_mfma_f32_16x16x32_bf16 v[156:159],a[232:235],a[172:175],v[156:159]
 ds_read_b64_tr_b16 a[196:197],v14 offset:57344
 v_mfma_f32_16x16x32_bf16 v[156:159],a[236:239],a[188:191],v[156:159]
 v_mfma_f32_16x16x32_bf16 v[160:163],a[240:243],a[160:163],v[160:163]
 ds_read_b64_tr_b16 a[198:199],v14 offset:58368
 buffer_load_dwordx4 v28,s[12:15],s27 offen offset:2048 sc1 nt lds
 v_mfma_f32_16x16x32_bf16 v[160:163],a[244:247],a[176:179],v[160:163]
 v_mfma_f32_16x16x32_bf16 v[164:167],a[248:251],a[160:163],v[164:167]
 ds_read_b64_tr_b16 a[200:201],v15 offset:49152
 v_mfma_f32_16x16x32_bf16 v[164:167],a[252:255],a[176:179],v[164:167]
 ds_read_b64_tr_b16 a[202:203],v15 offset:50176
 v_mfma_f32_16x16x32_bf16 v[168:171],a[240:243],a[164:167],v[168:171]
 v_mfma_f32_16x16x32_bf16 v[168:171],a[244:247],a[180:183],v[168:171]
 ds_read_b64_tr_b16 a[204:205],v15 offset:57344
 v_mfma_f32_16x16x32_bf16 v[172:175],a[248:251],a[164:167],v[172:175]
 ds_read_b64_tr_b16 a[206:207],v15 offset:58368
 v_mfma_f32_16x16x32_bf16 v[172:175],a[252:255],a[180:183],v[172:175]
 buffer_load_dwordx4 v29,s[12:15],s27 offen offset:3072 sc1 nt lds
 s_add_u32 s27,s27,16384
 v_mfma_f32_16x16x32_bf16 v[176:179],a[240:243],a[168:171],v[176:179]
 ds_read_b64_tr_b16 a[208:209],v16 offset:49152
 v_mfma_f32_16x16x32_bf16 v[176:179],a[244:247],a[184:187],v[176:179]
 v_mfma_f32_16x16x32_bf16 v[180:183],a[248:251],a[168:171],v[180:183]
 ds_read_b64_tr_b16 a[210:211],v16 offset:50176
 v_mfma_f32_16x16x32_bf16 v[180:183],a[252:255],a[184:187],v[180:183]
 ds_read_b64_tr_b16 a[212:213],v16 offset:57344
 v_mfma_f32_16x16x32_bf16 v[184:187],a[240:243],a[172:175],v[184:187]
 v_mfma_f32_16x16x32_bf16 v[184:187],a[244:247],a[188:191],v[184:187]
 ds_read_b64_tr_b16 a[214:215],v16 offset:58368
 v_mfma_f32_16x16x32_bf16 v[188:191],a[248:251],a[172:175],v[188:191]
 v_mfma_f32_16x16x32_bf16 v[188:191],a[252:255],a[188:191],v[188:191]
 s_waitcnt lgkmcnt(10)
 s_lshl_b32 s31,s37,12
 s_bitcmp1_b32 s2,3
 s_mov_b32 s95,K1_tail-K1_pc+2048
 s_cselect_b32 s95,K1_tailc-K1_pc+2048,s95
 s_add_u32 s95,s95,s26
 s_mov_b32 s29,256
 v_mfma_f32_16x16x32_bf16 v[64:67],a[192:195],a[128:131],v[64:67]
 s_waitcnt lgkmcnt(8)
 ds_read_b64_tr_b16 a[216:217],v17 offset:49152
 ds_read_b64_tr_b16 a[218:219],v17 offset:50176
 v_mfma_f32_16x16x32_bf16 v[64:67],a[196:199],a[144:147],v[64:67]
 s_waitcnt lgkmcnt(8)
 s_add_u32 m0,s25,98304
 ds_read_b64_tr_b16 a[220:221],v17 offset:57344
 ds_read_b64_tr_b16 a[222:223],v17 offset:58368
 v_mfma_f32_16x16x32_bf16 v[68:71],a[200:203],a[128:131],v[68:71]
 s_waitcnt lgkmcnt(8)
 ds_read_b64_tr_b16 a[224:225],v18 offset:49152
 buffer_load_dwordx4 v30,s[16:19],s28 offen offset:0 sc1 nt lds
 v_mfma_f32_16x16x32_bf16 v[68:71],a[204:207],a[144:147],v[68:71]
 ds_read_b64_tr_b16 a[226:227],v18 offset:50176
 ds_read_b64_tr_b16 a[228:229],v18 offset:57344
 v_mfma_f32_16x16x32_bf16 v[72:75],a[192:195],a[132:135],v[72:75]
 ds_read_b64_tr_b16 a[230:231],v18 offset:58368
 ds_read_b64_tr_b16 a[232:233],v19 offset:49152
 v_mfma_f32_16x16x32_bf16 v[72:75],a[196:199],a[148:151],v[72:75]
 ds_read_b64_tr_b16 a[234:235],v19 offset:50176
 ds_read_b64_tr_b16 a[236:237],v19 offset:57344
 v_mfma_f32_16x16x32_bf16 v[76:79],a[200:203],a[132:135],v[76:79]
 ds_read_b64_tr_b16 a[238:239],v19 offset:58368
 ds_read_b64_tr_b16 a[240:241],v20 offset:49152
 ds_read_b64_tr_b16 a[242:243],v20 offset:50176
 v_mfma_f32_16x16x32_bf16 v[76:79],a[204:207],a[148:151],v[76:79]
 s_waitcnt lgkmcnt(15)
 v_mul_f32 v64,s36,v64
 v_mul_f32 v65,s36,v65
 v_mul_f32 v66,s36,v66
 v_mul_f32 v67,s36,v67
 v_mfma_f32_16x16x32_bf16 v[96:99],a[208:211],a[128:131],v[96:99]
 s_waitcnt lgkmcnt(14)
 v_mul_f32 v68,s36,v68
 v_mul_f32 v69,s36,v69
 v_mul_f32 v70,s36,v70
 v_mul_f32 v71,s36,v71
 v_mfma_f32_16x16x32_bf16 v[96:99],a[212:215],a[144:147],v[96:99]
 s_waitcnt lgkmcnt(12)
 v_cvt_pk_bf16_f32 v64,v64,v65
 v_cvt_pk_bf16_f32 v65,v66,v67
 v_cvt_pk_bf16_f32 v66,v68,v69
 v_cvt_pk_bf16_f32 v67,v70,v71
 v_mfma_f32_16x16x32_bf16 v[100:103],a[216:219],a[128:131],v[100:103]
 s_waitcnt lgkmcnt(10)
 ds_read_b64_tr_b16 a[244:245],v20 offset:57344
 ds_read_b64_tr_b16 a[246:247],v20 offset:58368
 ds_read_b64_tr_b16 a[248:249],v21 offset:49152
 buffer_load_dwordx4 v31,s[16:19],s28 offen offset:1024 sc1 nt lds
 v_mfma_f32_16x16x32_bf16 v[100:103],a[220:223],a[144:147],v[100:103]
 v_mul_f32 v72,s36,v72
 v_mul_f32 v73,s36,v73
 v_mul_f32 v74,s36,v74
 v_mul_f32 v75,s36,v75
 v_mfma_f32_16x16x32_bf16 v[104:107],a[208:211],a[132:135],v[104:107]
 v_mul_f32 v76,s36,v76
 v_mul_f32 v77,s36,v77
 v_mul_f32 v78,s36,v78
 v_mul_f32 v79,s36,v79
 v_mfma_f32_16x16x32_bf16 v[104:107],a[212:215],a[148:151],v[104:107]
 v_permlane32_swap_b32 v64,v66
 v_permlane32_swap_b32 v65,v67
 v_mfma_f32_16x16x32_bf16 v[108:111],a[216:219],a[132:135],v[108:111]
 v_cvt_pk_bf16_f32 v72,v72,v73
 v_cvt_pk_bf16_f32 v73,v74,v75
 v_cvt_pk_bf16_f32 v74,v76,v77
 v_cvt_pk_bf16_f32 v75,v78,v79
 v_mfma_f32_16x16x32_bf16 v[108:111],a[220:223],a[148:151],v[108:111]
 s_waitcnt lgkmcnt(11)
 ds_read_b64_tr_b16 a[250:251],v21 offset:50176
 ds_read_b64_tr_b16 a[252:253],v21 offset:57344
 v_permlane16_swap_b32 v64,v66
 v_mfma_f32_16x16x32_bf16 v[128:131],a[224:227],a[128:131],v[128:131]
 s_waitcnt lgkmcnt(11)
 ds_read_b64_tr_b16 a[254:255],v21 offset:58368
 v_permlane16_swap_b32 v65,v67
 v_mul_f32 v96,s36,v96
 v_mfma_f32_16x16x32_bf16 v[128:131],a[228:231],a[144:147],v[128:131]
 s_waitcnt lgkmcnt(10)
 v_mul_f32 v97,s36,v97
 v_mul_f32 v98,s36,v98
 v_mul_f32 v99,s36,v99
 v_mul_f32 v100,s36,v100
 v_mfma_f32_16x16x32_bf16 v[132:135],a[232:235],a[128:131],v[132:135]
 s_waitcnt lgkmcnt(8)
 buffer_load_dwordx4 v30,s[16:19],s28 offen offset:2048 sc1 nt lds
 v_mul_f32 v101,s36,v101
 v_mul_f32 v102,s36,v102
 v_mul_f32 v103,s36,v103
 v_mfma_f32_16x16x32_bf16 v[132:135],a[236:239],a[144:147],v[132:135]
 v_permlane32_swap_b32 v72,v74
 v_permlane32_swap_b32 v73,v75
 v_mfma_f32_16x16x32_bf16 v[136:139],a[224:227],a[132:135],v[136:139]
 v_cvt_pk_bf16_f32 v96,v96,v97
 v_cvt_pk_bf16_f32 v97,v98,v99
 v_cvt_pk_bf16_f32 v98,v100,v101
 v_cvt_pk_bf16_f32 v99,v102,v103
 v_mfma_f32_16x16x32_bf16 v[136:139],a[228:231],a[148:151],v[136:139]
 v_permlane16_swap_b32 v72,v74
 v_permlane16_swap_b32 v73,v75
 v_mfma_f32_16x16x32_bf16 v[140:143],a[232:235],a[132:135],v[140:143]
 v_mul_f32 v104,s36,v104
 v_mul_f32 v105,s36,v105
 v_mul_f32 v106,s36,v106
 v_mul_f32 v107,s36,v107
 v_mfma_f32_16x16x32_bf16 v[140:143],a[236:239],a[148:151],v[140:143]
 s_waitcnt lgkmcnt(6)
 v_mul_f32 v108,s36,v108
 v_mul_f32 v109,s36,v109
 v_mul_f32 v110,s36,v110
 v_mul_f32 v111,s36,v111
 v_mfma_f32_16x16x32_bf16 v[160:163],a[240:243],a[128:131],v[160:163]
 s_waitcnt lgkmcnt(4)
 v_permlane32_swap_b32 v96,v98
 v_permlane32_swap_b32 v97,v99
 v_mfma_f32_16x16x32_bf16 v[160:163],a[244:247],a[144:147],v[160:163]
 s_waitcnt lgkmcnt(2)
 buffer_load_dwordx4 v31,s[16:19],s28 offen offset:3072 sc1 nt lds
 s_add_u32 s28,s28,16384
 v_cvt_pk_bf16_f32 v104,v104,v105
 v_cvt_pk_bf16_f32 v105,v106,v107
 v_mfma_f32_16x16x32_bf16 v[164:167],a[248:251],a[128:131],v[164:167]
 s_waitcnt vmcnt(63)
 s_waitcnt lgkmcnt(0)
 s_barrier
 v_cvt_pk_bf16_f32 v106,v108,v109
 v_mfma_f32_16x16x32_bf16 v[164:167],a[252:255],a[144:147],v[164:167]
 v_cvt_pk_bf16_f32 v107,v110,v111
 v_permlane16_swap_b32 v96,v98
 v_mfma_f32_16x16x32_bf16 v[168:171],a[240:243],a[132:135],v[168:171]
 v_permlane16_swap_b32 v97,v99
 v_mfma_f32_16x16x32_bf16 v[168:171],a[244:247],a[148:151],v[168:171]
 ds_read_b128 a[160:163],v2 offset:0
 v_mul_f32 v128,s36,v128
 v_mfma_f32_16x16x32_bf16 v[172:175],a[248:251],a[132:135],v[172:175]
 v_mul_f32 v129,s36,v129
 v_mul_f32 v130,s36,v130
 v_mfma_f32_16x16x32_bf16 v[172:175],a[252:255],a[148:151],v[172:175]
 v_mul_f32 v131,s36,v131
 v_mul_f32 v132,s36,v132
 v_mfma_f32_16x16x32_bf16 v[80:83],a[192:195],a[136:139],v[80:83]
 s_add_u32 m0,s25,49152
 ds_read_b128 a[164:167],v3 offset:0
 v_mul_f32 v133,s36,v133
 v_mfma_f32_16x16x32_bf16 v[80:83],a[196:199],a[152:155],v[80:83]
 ds_read_b128 a[168:171],v4 offset:0
 buffer_load_dwordx4 v26,s[12:15],s27 offen offset:0 sc1 nt lds
 v_mfma_f32_16x16x32_bf16 v[84:87],a[200:203],a[136:139],v[84:87]
 v_mul_f32 v134,s36,v134
 v_mul_f32 v135,s36,v135
 v_mfma_f32_16x16x32_bf16 v[84:87],a[204:207],a[152:155],v[84:87]
 v_permlane32_swap_b32 v104,v106
 v_permlane32_swap_b32 v105,v107
 v_mfma_f32_16x16x32_bf16 v[88:91],a[192:195],a[140:143],v[88:91]
 v_cvt_pk_bf16_f32 v128,v128,v129
 v_cvt_pk_bf16_f32 v129,v130,v131
 v_cvt_pk_bf16_f32 v130,v132,v133
 v_cvt_pk_bf16_f32 v131,v134,v135
 v_mfma_f32_16x16x32_bf16 v[88:91],a[196:199],a[156:159],v[88:91]
 v_permlane16_swap_b32 v104,v106
 v_mfma_f32_16x16x32_bf16 v[92:95],a[200:203],a[140:143],v[92:95]
 v_permlane16_swap_b32 v105,v107
 v_mfma_f32_16x16x32_bf16 v[92:95],a[204:207],a[156:159],v[92:95]
 v_mul_f32 v136,s36,v136
 v_mul_f32 v137,s36,v137
 v_mfma_f32_16x16x32_bf16 v[112:115],a[208:211],a[136:139],v[112:115]
 ds_read_b128 a[172:175],v5 offset:0
 v_mul_f32 v138,s36,v138
 v_mfma_f32_16x16x32_bf16 v[112:115],a[212:215],a[152:155],v[112:115]
 ds_read_b128 a[176:179],v2 offset:4096
 buffer_load_dwordx4 v27,s[12:15],s27 offen offset:1024 sc1 nt lds
 v_mfma_f32_16x16x32_bf16 v[116:119],a[216:219],a[136:139],v[116:119]
 v_mul_f32 v139,s36,v139
 v_mul_f32 v140,s36,v140
 v_mfma_f32_16x16x32_bf16 v[116:119],a[220:223],a[152:155],v[116:119]
 v_mul_f32 v141,s36,v141
 v_mul_f32 v142,s36,v142
 v_mul_f32 v143,s36,v143
 v_mfma_f32_16x16x32_bf16 v[120:123],a[208:211],a[140:143],v[120:123]
 v_permlane32_swap_b32 v128,v130
 v_permlane32_swap_b32 v129,v131
 v_mfma_f32_16x16x32_bf16 v[120:123],a[212:215],a[156:159],v[120:123]
 v_cvt_pk_bf16_f32 v136,v136,v137
 v_cvt_pk_bf16_f32 v137,v138,v139
 v_cvt_pk_bf16_f32 v138,v140,v141
 v_mfma_f32_16x16x32_bf16 v[124:127],a[216:219],a[140:143],v[124:127]
 ds_read_b128 a[180:183],v3 offset:4096
 v_cvt_pk_bf16_f32 v139,v142,v143
 v_mfma_f32_16x16x32_bf16 v[124:127],a[220:223],a[156:159],v[124:127]
 v_permlane16_swap_b32 v128,v130
 v_mfma_f32_16x16x32_bf16 v[144:147],a[224:227],a[136:139],v[144:147]
 v_permlane16_swap_b32 v129,v131
 v_mfma_f32_16x16x32_bf16 v[144:147],a[228:231],a[152:155],v[144:147]
 buffer_load_dwordx4 v28,s[12:15],s27 offen offset:2048 sc1 nt lds
 v_mul_f32 v160,s36,v160
 v_mfma_f32_16x16x32_bf16 v[148:151],a[232:235],a[136:139],v[148:151]
 v_mul_f32 v161,s36,v161
 v_mul_f32 v162,s36,v162
 v_mfma_f32_16x16x32_bf16 v[148:151],a[236:239],a[152:155],v[148:151]
 ds_read_b128 a[184:187],v4 offset:4096
 v_mul_f32 v163,s36,v163
 v_mfma_f32_16x16x32_bf16 v[152:155],a[224:227],a[140:143],v[152:155]
 v_mul_f32 v164,s36,v164
 v_mul_f32 v165,s36,v165
 v_mfma_f32_16x16x32_bf16 v[152:155],a[228:231],a[156:159],v[152:155]
 v_mul_f32 v166,s36,v166
 v_mul_f32 v167,s36,v167
 v_mfma_f32_16x16x32_bf16 v[156:159],a[232:235],a[140:143],v[156:159]
 v_permlane32_swap_b32 v136,v138
 v_mfma_f32_16x16x32_bf16 v[156:159],a[236:239],a[156:159],v[156:159]
 v_permlane32_swap_b32 v137,v139
 v_mfma_f32_16x16x32_bf16 v[176:179],a[240:243],a[136:139],v[176:179]
 ds_read_b128 a[188:191],v5 offset:4096
 ds_read_b128 a[224:227],v2 offset:8192
 v_mfma_f32_16x16x32_bf16 v[176:179],a[244:247],a[152:155],v[176:179]
 ds_read_b128 a[228:231],v3 offset:8192
 buffer_load_dwordx4 v29,s[12:15],s27 offen offset:3072 sc1 nt lds
 s_add_u32 s27,s27,16384
 v_mfma_f32_16x16x32_bf16 v[180:183],a[248:251],a[136:139],v[180:183]
 v_cvt_pk_bf16_f32 v160,v160,v161
 v_cvt_pk_bf16_f32 v161,v162,v163
 v_mfma_f32_16x16x32_bf16 v[180:183],a[252:255],a[152:155],v[180:183]
 v_cvt_pk_bf16_f32 v162,v164,v165
 v_cvt_pk_bf16_f32 v163,v166,v167
 v_permlane16_swap_b32 v136,v138
 v_mfma_f32_16x16x32_bf16 v[184:187],a[240:243],a[140:143],v[184:187]
 v_permlane16_swap_b32 v137,v139
 v_mul_f32 v168,s36,v168
 v_mul_f32 v169,s36,v169
 v_mfma_f32_16x16x32_bf16 v[184:187],a[244:247],a[156:159],v[184:187]
 v_mul_f32 v170,s36,v170
 v_mul_f32 v171,s36,v171
 v_mul_f32 v172,s36,v172
 v_mul_f32 v173,s36,v173
 v_mfma_f32_16x16x32_bf16 v[188:191],a[248:251],a[140:143],v[188:191]
 ds_read_b128 a[232:235],v4 offset:8192
 ds_read_b128 a[236:239],v5 offset:8192
 v_mul_f32 v174,s36,v174
 v_mul_f32 v175,s36,v175
 v_permlane32_swap_b32 v160,v162
 v_permlane32_swap_b32 v161,v163
 v_cvt_pk_bf16_f32 v168,v168,v169
 v_cvt_pk_bf16_f32 v169,v170,v171
 v_cvt_pk_bf16_f32 v170,v172,v173
 v_cvt_pk_bf16_f32 v171,v174,v175
 v_permlane16_swap_b32 v160,v162
 v_permlane16_swap_b32 v161,v163
 v_mfma_f32_16x16x32_bf16 v[188:191],a[252:255],a[156:159],v[188:191]
 s_waitcnt lgkmcnt(11)
 v_mul_f32 v80,s36,v80
 v_mul_f32 v81,s36,v81
 v_mul_f32 v82,s36,v82
 v_mul_f32 v83,s36,v83
 v_mfma_f32_16x16x32_bf16 v[68:71],a[160:163],v[64:67],0
 s_waitcnt lgkmcnt(10)
 v_mul_f32 v84,s36,v84
 v_mul_f32 v85,s36,v85
 v_mul_f32 v86,s36,v86
 v_mul_f32 v87,s36,v87
 v_mfma_f32_16x16x32_bf16 v[68:71],a[164:167],v[96:99],v[68:71]
 s_waitcnt lgkmcnt(9)
 ds_read_b128 a[240:243],v2 offset:12288
 ds_read_b128 a[244:247],v3 offset:12288
 v_permlane32_swap_b32 v168,v170
 v_mfma_f32_16x16x32_bf16 v[68:71],a[168:171],v[128:131],v[68:71]
 s_waitcnt lgkmcnt(10)
 ds_read_b128 a[248:251],v4 offset:12288
 v_permlane32_swap_b32 v169,v171
 v_cvt_pk_bf16_f32 v80,v80,v81
 v_mfma_f32_16x16x32_bf16 v[68:71],a[172:175],v[160:163],v[68:71]
 s_waitcnt lgkmcnt(10)
 ds_read_b128 a[252:255],v5 offset:12288
 v_cvt_pk_bf16_f32 v81,v82,v83
 v_cvt_pk_bf16_f32 v82,v84,v85
 v_cvt_pk_bf16_f32 v83,v86,v87
 v_mfma_f32_16x16x32_bf16 v[100:103],a[176:179],v[64:67],0
 s_waitcnt lgkmcnt(10)
 v_permlane16_swap_b32 v168,v170
 v_permlane16_swap_b32 v169,v171
 v_mfma_f32_16x16x32_bf16 v[100:103],a[180:183],v[96:99],v[100:103]
 s_waitcnt lgkmcnt(9)
 v_mul_f32 v88,s36,v88
 v_mul_f32 v89,s36,v89
 v_mul_f32 v90,s36,v90
 v_mul_f32 v91,s36,v91
 v_mfma_f32_16x16x32_bf16 v[100:103],a[184:187],v[128:131],v[100:103]
 s_waitcnt lgkmcnt(8)
 v_mul_f32 v92,s36,v92
 v_mul_f32 v93,s36,v93
 v_mul_f32 v94,s36,v94
 v_mul_f32 v95,s36,v95
 v_mfma_f32_16x16x32_bf16 v[100:103],a[188:191],v[160:163],v[100:103]
 v_permlane32_swap_b32 v80,v82
 v_permlane32_swap_b32 v81,v83
 v_mfma_f32_16x16x32_bf16 v[76:79],a[160:163],v[72:75],0
 v_cvt_pk_bf16_f32 v88,v88,v89
 v_cvt_pk_bf16_f32 v89,v90,v91
 v_cvt_pk_bf16_f32 v90,v92,v93
 v_cvt_pk_bf16_f32 v91,v94,v95
 v_mfma_f32_16x16x32_bf16 v[76:79],a[164:167],v[104:107],v[76:79]
 v_permlane16_swap_b32 v80,v82
 v_permlane16_swap_b32 v81,v83
 v_mfma_f32_16x16x32_bf16 v[76:79],a[168:171],v[136:139],v[76:79]
 v_mul_f32 v112,s36,v112
 v_mul_f32 v113,s36,v113
 v_mul_f32 v114,s36,v114
 v_mul_f32 v115,s36,v115
 v_mfma_f32_16x16x32_bf16 v[76:79],a[172:175],v[168:171],v[76:79]
 s_waitcnt vmcnt(63)
 s_waitcnt lgkmcnt(0)
 s_barrier
 v_mul_f32 v116,s36,v116
 v_mfma_f32_16x16x32_bf16 v[108:111],a[176:179],v[72:75],0
 v_mul_f32 v117,s36,v117
 v_mul_f32 v118,s36,v118
 v_mfma_f32_16x16x32_bf16 v[108:111],a[180:183],v[104:107],v[108:111]
 ds_read_b128 a[192:195],v2 offset:16384
 v_mul_f32 v119,s36,v119
 v_mfma_f32_16x16x32_bf16 v[108:111],a[184:187],v[136:139],v[108:111]
 v_permlane32_swap_b32 v88,v90
 v_permlane32_swap_b32 v89,v91
 v_cvt_pk_bf16_f32 v112,v112,v113
 v_cvt_pk_bf16_f32 v113,v114,v115
 v_cvt_pk_bf16_f32 v114,v116,v117
 v_cvt_pk_bf16_f32 v115,v118,v119
 v_permlane16_swap_b32 v88,v90
 v_permlane16_swap_b32 v89,v91
 v_mul_f32 v120,s36,v120
 v_mul_f32 v121,s36,v121
 v_mul_f32 v122,s36,v122
 v_mul_f32 v123,s36,v123
 v_mul_f32 v124,s36,v124
 v_mul_f32 v125,s36,v125
 v_mul_f32 v126,s36,v126
 v_mul_f32 v127,s36,v127
 v_permlane32_swap_b32 v112,v114
 v_permlane32_swap_b32 v113,v115
 v_cvt_pk_bf16_f32 v120,v120,v121
 v_cvt_pk_bf16_f32 v121,v122,v123
 v_cvt_pk_bf16_f32 v122,v124,v125
 v_cvt_pk_bf16_f32 v123,v126,v127
 v_permlane16_swap_b32 v112,v114
 v_permlane16_swap_b32 v113,v115
 v_mul_f32 v144,s36,v144
 v_mul_f32 v145,s36,v145
 v_mul_f32 v146,s36,v146
 v_mul_f32 v147,s36,v147
 v_mul_f32 v148,s36,v148
 v_mul_f32 v149,s36,v149
 v_mul_f32 v150,s36,v150
 v_mul_f32 v151,s36,v151
 v_permlane32_swap_b32 v120,v122
 v_permlane32_swap_b32 v121,v123
 v_cvt_pk_bf16_f32 v144,v144,v145
 v_cvt_pk_bf16_f32 v145,v146,v147
 v_cvt_pk_bf16_f32 v146,v148,v149
 v_cvt_pk_bf16_f32 v147,v150,v151
 v_permlane16_swap_b32 v120,v122
 v_permlane16_swap_b32 v121,v123
 v_mul_f32 v152,s36,v152
 v_mul_f32 v153,s36,v153
 v_mul_f32 v154,s36,v154
 v_mul_f32 v155,s36,v155
 v_mul_f32 v156,s36,v156
 v_mul_f32 v157,s36,v157
 v_mul_f32 v158,s36,v158
 v_mul_f32 v159,s36,v159
 v_permlane32_swap_b32 v144,v146
 v_permlane32_swap_b32 v145,v147
 v_cvt_pk_bf16_f32 v152,v152,v153
 v_cvt_pk_bf16_f32 v153,v154,v155
 v_cvt_pk_bf16_f32 v154,v156,v157
 v_cvt_pk_bf16_f32 v155,v158,v159
 v_permlane16_swap_b32 v144,v146
 v_permlane16_swap_b32 v145,v147
 v_mul_f32 v176,s36,v176
 v_mul_f32 v177,s36,v177
 v_mul_f32 v178,s36,v178
 v_mul_f32 v179,s36,v179
 v_mul_f32 v180,s36,v180
 v_mul_f32 v181,s36,v181
 v_mul_f32 v182,s36,v182
 v_mul_f32 v183,s36,v183
 v_permlane32_swap_b32 v152,v154
 v_permlane32_swap_b32 v153,v155
 v_cvt_pk_bf16_f32 v176,v176,v177
 v_cvt_pk_bf16_f32 v177,v178,v179
 v_cvt_pk_bf16_f32 v178,v180,v181
 v_cvt_pk_bf16_f32 v179,v182,v183
 v_permlane16_swap_b32 v152,v154
 v_permlane16_swap_b32 v153,v155
 v_mul_f32 v184,s36,v184
 v_mul_f32 v185,s36,v185
 v_mul_f32 v186,s36,v186
 v_mul_f32 v187,s36,v187
 v_mul_f32 v188,s36,v188
 v_mul_f32 v189,s36,v189
 v_mul_f32 v190,s36,v190
 v_mul_f32 v191,s36,v191
 v_permlane32_swap_b32 v176,v178
 v_permlane32_swap_b32 v177,v179
 v_cvt_pk_bf16_f32 v184,v184,v185
 v_cvt_pk_bf16_f32 v185,v186,v187
 v_cvt_pk_bf16_f32 v186,v188,v189
 v_cvt_pk_bf16_f32 v187,v190,v191
 v_permlane16_swap_b32 v176,v178
 v_permlane16_swap_b32 v177,v179
 v_mfma_f32_16x16x32_bf16 v[108:111],a[188:191],v[168:171],v[108:111]
 s_nop 1
 v_permlane32_swap_b32 v184,v186
 v_mfma_f32_16x16x32_bf16 v[84:87],a[160:163],v[80:83],0
 v_permlane32_swap_b32 v185,v187
 s_nop 1
 v_mfma_f32_16x16x32_bf16 v[84:87],a[164:167],v[112:115],v[84:87]
 v_permlane16_swap_b32 v184,v186
 v_mfma_f32_16x16x32_bf16 v[84:87],a[168:171],v[144:147],v[84:87]
 v_permlane16_swap_b32 v185,v187
 s_nop 0
 v_mfma_f32_16x16x32_bf16 v[84:87],a[172:175],v[176:179],v[84:87]
 ds_read_b128 a[196:199],v3 offset:16384
 ds_read_b128 a[200:203],v4 offset:16384
 v_mfma_f32_16x16x32_bf16 v[116:119],a[176:179],v[80:83],0
 v_max3_f32 v40,v68,v69,v70
 v_max3_f32 v41,v76,v77,v78
 v_max3_f32 v44,v71,v100,v101
 v_max3_f32 v45,v79,v108,v109
 v_mfma_f32_16x16x32_bf16 v[116:119],a[180:183],v[112:115],v[116:119]
 v_max3_f32 v40,v40,v102,v103
 v_max3_f32 v41,v41,v110,v111
 v_max_f32 v40,v40,v44
 v_max_f32 v41,v41,v45
 v_mfma_f32_16x16x32_bf16 v[116:119],a[184:187],v[144:147],v[116:119]
 v_mov_b32 v44,v40
 v_mov_b32 v45,v41
 s_nop 0
 v_permlane32_swap_b32 v40,v44
 v_mfma_f32_16x16x32_bf16 v[116:119],a[188:191],v[176:179],v[116:119]
 v_permlane32_swap_b32 v41,v45
 v_max_f32 v40,v40,v44
 v_max_f32 v41,v41,v45
 v_mfma_f32_16x16x32_bf16 v[92:95],a[160:163],v[88:91],0
 v_mov_b32 v44,v40
 v_mov_b32 v45,v41
 s_nop 0
 v_permlane16_swap_b32 v40,v44
 v_mfma_f32_16x16x32_bf16 v[92:95],a[164:167],v[120:123],v[92:95]
 v_permlane16_swap_b32 v41,v45
 v_max_f32 v40,v40,v44
 v_max_f32 v41,v41,v45
 v_mfma_f32_16x16x32_bf16 v[92:95],a[168:171],v[152:155],v[92:95]
 v_sub_f32 v224,0,v40
 v_sub_f32 v225,0,v40
 v_sub_f32 v226,0,v40
 v_mfma_f32_16x16x32_bf16 v[92:95],a[172:175],v[184:187],v[92:95]
 v_sub_f32 v227,0,v40
 v_sub_f32 v228,0,v41
 v_mfma_f32_16x16x32_bf16 v[124:127],a[176:179],v[88:91],0
 v_sub_f32 v229,0,v41
 v_sub_f32 v230,0,v41
 v_mfma_f32_16x16x32_bf16 v[124:127],a[180:183],v[120:123],v[124:127]
 v_sub_f32 v231,0,v41
 v_sub_f32 v68,v68,v40
 v_mfma_f32_16x16x32_bf16 v[124:127],a[184:187],v[152:155],v[124:127]
 v_sub_f32 v69,v69,v40
 v_sub_f32 v70,v70,v40
 v_mfma_f32_16x16x32_bf16 v[124:127],a[188:191],v[184:187],v[124:127]
 v_exp_f32 v68,v68
 v_mfma_f32_16x16x32_bf16 v[132:135],a[224:227],v[64:67],v[224:227]
 ds_read_b128 a[204:207],v5 offset:16384
 v_sub_f32 v71,v71,v40
 v_mfma_f32_16x16x32_bf16 v[132:135],a[228:231],v[96:99],v[132:135]
 v_exp_f32 v69,v69
 v_mfma_f32_16x16x32_bf16 v[132:135],a[232:235],v[128:131],v[132:135]
 ds_read_b128 a[208:211],v2 offset:20480
 v_sub_f32 v100,v100,v40
 v_mfma_f32_16x16x32_bf16 v[132:135],a[236:239],v[160:163],v[132:135]
 v_exp_f32 v70,v70
 v_mfma_f32_16x16x32_bf16 v[164:167],a[240:243],v[64:67],v[224:227]
 v_mov_b32 v48,0x3f803f80
 v_accvgpr_write_b32 a188,v48
 v_accvgpr_write_b32 a189,v48
 v_accvgpr_write_b32 a190,v48
 v_mfma_f32_16x16x32_bf16 v[164:167],a[244:247],v[96:99],v[164:167]
 v_accvgpr_write_b32 a191,v48
 v_max3_f32 v42,v84,v85,v86
 v_max3_f32 v43,v92,v93,v94
 v_max3_f32 v46,v87,v116,v117
 v_mfma_f32_16x16x32_bf16 v[164:167],a[248:251],v[128:131],v[164:167]
 v_max3_f32 v47,v95,v124,v125
 v_max3_f32 v42,v42,v118,v119
 v_max3_f32 v43,v43,v126,v127
 v_mfma_f32_16x16x32_bf16 v[164:167],a[252:255],v[160:163],v[164:167]
 v_max_f32 v42,v42,v46
 v_max_f32 v43,v43,v47
 v_mfma_f32_16x16x32_bf16 v[140:143],a[224:227],v[72:75],v[228:231]
 v_mov_b32 v46,v42
 v_mov_b32 v47,v43
 v_mfma_f32_16x16x32_bf16 v[140:143],a[228:231],v[104:107],v[140:143]
 s_nop 0
 v_permlane32_swap_b32 v42,v46
 v_mfma_f32_16x16x32_bf16 v[140:143],a[232:235],v[136:139],v[140:143]
 v_permlane32_swap_b32 v43,v47
 v_max_f32 v42,v42,v46
 v_mfma_f32_16x16x32_bf16 v[140:143],a[236:239],v[168:171],v[140:143]
 ds_read_b128 a[212:215],v3 offset:20480
 v_max_f32 v43,v43,v47
 v_mfma_f32_16x16x32_bf16 v[172:175],a[240:243],v[72:75],v[228:231]
 v_mov_b32 v46,v42
 v_mov_b32 v47,v43
 v_mfma_f32_16x16x32_bf16 v[172:175],a[244:247],v[104:107],v[172:175]
 s_nop 0
 v_permlane16_swap_b32 v42,v46
 v_permlane16_swap_b32 v43,v47
 v_max_f32 v42,v42,v46
 v_max_f32 v43,v43,v47
 v_sub_f32 v232,0,v42
 v_sub_f32 v233,0,v42
 v_sub_f32 v234,0,v42
 v_sub_f32 v235,0,v42
 v_mfma_f32_16x16x32_bf16 v[172:175],a[248:251],v[136:139],v[172:175]
 v_sub_f32 v236,0,v43
 v_sub_f32 v237,0,v43
 v_sub_f32 v238,0,v43
 v_mfma_f32_16x16x32_bf16 v[172:175],a[252:255],v[168:171],v[172:175]
 v_sub_f32 v239,0,v43
 v_sub_f32 v84,v84,v42
 v_mfma_f32_16x16x32_bf16 v[148:151],a[224:227],v[80:83],v[232:235]
 v_sub_f32 v85,v85,v42
 v_sub_f32 v86,v86,v42
 v_mfma_f32_16x16x32_bf16 v[148:151],a[228:231],v[112:115],v[148:151]
 v_exp_f32 v84,v84
 v_mfma_f32_16x16x32_bf16 v[148:151],a[232:235],v[144:147],v[148:151]
 ds_read_b128 a[216:219],v4 offset:20480
 v_sub_f32 v87,v87,v42
 v_mfma_f32_16x16x32_bf16 v[148:151],a[236:239],v[176:179],v[148:151]
 v_exp_f32 v85,v85
 v_sub_f32 v116,v116,v42
 v_mfma_f32_16x16x32_bf16 v[180:183],a[240:243],v[80:83],v[232:235]
 v_exp_f32 v86,v86
 v_sub_f32 v117,v117,v42
 v_mfma_f32_16x16x32_bf16 v[180:183],a[244:247],v[112:115],v[180:183]
 v_exp_f32 v87,v87
 v_mfma_f32_16x16x32_bf16 v[180:183],a[248:251],v[144:147],v[180:183]
 v_cvt_pk_bf16_f32 v200,v84,v85
 v_sub_f32 v118,v118,v42
 v_mfma_f32_16x16x32_bf16 v[180:183],a[252:255],v[176:179],v[180:183]
 v_exp_f32 v116,v116
 v_sub_f32 v119,v119,v42
 v_mfma_f32_16x16x32_bf16 v[156:159],a[224:227],v[88:91],v[236:239]
 ds_read_b128 a[220:223],v5 offset:20480
 v_exp_f32 v117,v117
 v_mfma_f32_16x16x32_bf16 v[156:159],a[228:231],v[120:123],v[156:159]
 v_cvt_pk_bf16_f32 v201,v86,v87
 v_sub_f32 v92,v92,v43
 v_mfma_f32_16x16x32_bf16 v[156:159],a[232:235],v[152:155],v[156:159]
 v_exp_f32 v118,v118
 v_sub_f32 v93,v93,v43
 v_mfma_f32_16x16x32_bf16 v[156:159],a[236:239],v[184:187],v[156:159]
 v_exp_f32 v119,v119
 v_mfma_f32_16x16x32_bf16 v[188:191],a[240:243],v[88:91],v[236:239]
 v_cvt_pk_bf16_f32 v202,v116,v117
 v_sub_f32 v94,v94,v43
 v_mfma_f32_16x16x32_bf16 v[188:191],a[244:247],v[120:123],v[188:191]
 v_exp_f32 v92,v92
 v_mfma_f32_16x16x32_bf16 v[188:191],a[248:251],v[152:155],v[188:191]
 v_sub_f32 v95,v95,v43
 v_exp_f32 v93,v93
 v_mfma_f32_16x16x32_bf16 v[188:191],a[252:255],v[184:187],v[188:191]
 v_sub_f32 v101,v101,v40
 v_exp_f32 v71,v71
 v_cvt_pk_bf16_f32 v192,v68,v69
 v_sub_f32 v102,v102,v40
 v_exp_f32 v100,v100
 v_sub_f32 v103,v103,v40
 v_exp_f32 v101,v101
 v_cvt_pk_bf16_f32 v193,v70,v71
 v_sub_f32 v76,v76,v41
 v_exp_f32 v102,v102
 v_sub_f32 v77,v77,v41
 v_exp_f32 v103,v103
 v_cvt_pk_bf16_f32 v194,v100,v101
 v_sub_f32 v78,v78,v41
 v_exp_f32 v76,v76
 v_sub_f32 v79,v79,v41
 v_exp_f32 v77,v77
 v_cvt_pk_bf16_f32 v195,v102,v103
 v_sub_f32 v108,v108,v41
 v_exp_f32 v78,v78
 v_sub_f32 v109,v109,v41
 v_exp_f32 v79,v79
 v_cvt_pk_bf16_f32 v196,v76,v77
 v_sub_f32 v110,v110,v41
 v_exp_f32 v108,v108
 v_sub_f32 v111,v111,v41
 v_exp_f32 v109,v109
 v_cvt_pk_bf16_f32 v197,v78,v79
 v_exp_f32 v110,v110
 v_exp_f32 v111,v111
 v_cvt_pk_bf16_f32 v198,v108,v109
 v_cvt_pk_bf16_f32 v199,v110,v111
 v_cvt_pk_bf16_f32 v203,v118,v119
 v_sub_f32 v124,v124,v43
 v_exp_f32 v94,v94
 v_sub_f32 v125,v125,v43
 v_exp_f32 v95,v95
 v_cvt_pk_bf16_f32 v204,v92,v93
 v_sub_f32 v126,v126,v43
 v_exp_f32 v124,v124
 v_sub_f32 v127,v127,v43
 v_exp_f32 v125,v125
 v_cvt_pk_bf16_f32 v205,v94,v95
 v_exp_f32 v126,v126
 v_exp_f32 v127,v127
 v_cvt_pk_bf16_f32 v206,v124,v125
 v_cvt_pk_bf16_f32 v207,v126,v127
K1_attn:
 v_accvgpr_write_b32 a180,v26
 v_accvgpr_write_b32 a181,v27
 v_accvgpr_write_b32 a182,v28
 v_accvgpr_write_b32 a183,v29
 s_waitcnt lgkmcnt(7)
 v_mfma_f32_16x16x32_bf16 v[68:71],a[192:195],v[64:67],v[224:227]
 s_waitcnt lgkmcnt(6)
 v_exp_f32 v132,v132
 v_mfma_f32_16x16x32_bf16 v[68:71],a[196:199],v[96:99],v[68:71]
 s_waitcnt lgkmcnt(5)
 v_exp_f32 v133,v133
 v_mfma_f32_16x16x32_bf16 v[68:71],a[200:203],v[128:131],v[68:71]
 s_waitcnt lgkmcnt(4)
 ds_read_b64_tr_b16 a[224:225],v6 offset:0
 ds_read_b64_tr_b16 a[226:227],v6 offset:4096
 v_mfma_f32_16x16x32_bf16 v[68:71],a[204:207],v[160:163],v[68:71]
 v_exp_f32 v134,v134
 v_mfma_f32_16x16x32_bf16 v[76:79],a[192:195],v[72:75],v[228:231]
 v_exp_f32 v135,v135
 v_mfma_f32_16x16x32_bf16 v[76:79],a[196:199],v[104:107],v[76:79]
 ds_read_b64_tr_b16 a[228:229],v6 offset:8192
 v_cvt_pk_bf16_f32 v208,v132,v133
 v_mfma_f32_16x16x32_bf16 v[76:79],a[200:203],v[136:139],v[76:79]
 v_exp_f32 v140,v140
 v_mfma_f32_16x16x32_bf16 v[76:79],a[204:207],v[168:171],v[76:79]
 v_exp_f32 v141,v141
 v_mfma_f32_16x16x32_bf16 v[84:87],a[192:195],v[80:83],v[232:235]
 ds_read_b64_tr_b16 a[230:231],v6 offset:12288
 v_mfma_f32_16x16x32_bf16 v[84:87],a[196:199],v[112:115],v[84:87]
 v_cvt_pk_bf16_f32 v209,v134,v135
 v_mfma_f32_16x16x32_bf16 v[84:87],a[200:203],v[144:147],v[84:87]
 v_exp_f32 v142,v142
 v_mfma_f32_16x16x32_bf16 v[84:87],a[204:207],v[176:179],v[84:87]
 ds_read_b64_tr_b16 a[232:233],v7 offset:0
 v_mfma_f32_16x16x32_bf16 v[92:95],a[192:195],v[88:91],v[236:239]
 v_exp_f32 v143,v143
 v_mfma_f32_16x16x32_bf16 v[92:95],a[196:199],v[120:123],v[92:95]
 ds_read_b64_tr_b16 a[234:235],v7 offset:4096
 v_cvt_pk_bf16_f32 v212,v140,v141
 v_mfma_f32_16x16x32_bf16 v[92:95],a[200:203],v[152:155],v[92:95]
 v_exp_f32 v148,v148
 v_mfma_f32_16x16x32_bf16 v[92:95],a[204:207],v[184:187],v[92:95]
 s_waitcnt lgkmcnt(9)
 v_exp_f32 v149,v149
 v_mfma_f32_16x16x32_bf16 v[100:103],a[208:211],v[64:67],v[224:227]
 s_waitcnt lgkmcnt(8)
 ds_read_b128 a[192:195],v2 offset:24576
 v_cvt_pk_bf16_f32 v213,v142,v143
 v_mfma_f32_16x16x32_bf16 v[100:103],a[212:215],v[96:99],v[100:103]
 s_waitcnt lgkmcnt(8)
 v_exp_f32 v150,v150
 v_mfma_f32_16x16x32_bf16 v[100:103],a[216:219],v[128:131],v[100:103]
 s_waitcnt lgkmcnt(7)
 v_exp_f32 v151,v151
 v_mfma_f32_16x16x32_bf16 v[100:103],a[220:223],v[160:163],v[100:103]
 ds_read_b128 a[196:199],v3 offset:24576
 v_cvt_pk_bf16_f32 v216,v148,v149
 v_mfma_f32_16x16x32_bf16 v[108:111],a[208:211],v[72:75],v[228:231]
 v_exp_f32 v156,v156
 v_mfma_f32_16x16x32_bf16 v[108:111],a[212:215],v[104:107],v[108:111]
 ds_read_b128 a[200:203],v4 offset:24576
 v_mfma_f32_16x16x32_bf16 v[108:111],a[216:219],v[136:139],v[108:111]
 v_exp_f32 v157,v157
 v_mfma_f32_16x16x32_bf16 v[108:111],a[220:223],v[168:171],v[108:111]
 ds_read_b128 a[204:207],v5 offset:24576
 v_cvt_pk_bf16_f32 v217,v150,v151
 v_mfma_f32_16x16x32_bf16 v[116:119],a[208:211],v[80:83],v[232:235]
 v_exp_f32 v158,v158
 v_mfma_f32_16x16x32_bf16 v[116:119],a[212:215],v[112:115],v[116:119]
 v_exp_f32 v159,v159
 v_mfma_f32_16x16x32_bf16 v[116:119],a[216:219],v[144:147],v[116:119]
 v_mfma_f32_16x16x32_bf16 v[116:119],a[220:223],v[176:179],v[116:119]
 ds_read_b64_tr_b16 a[236:237],v7 offset:8192
 v_cvt_pk_bf16_f32 v220,v156,v157
 v_mfma_f32_16x16x32_bf16 v[124:127],a[208:211],v[88:91],v[236:239]
 v_exp_f32 v164,v164
 v_mfma_f32_16x16x32_bf16 v[124:127],a[212:215],v[120:123],v[124:127]
 v_exp_f32 v165,v165
 v_mfma_f32_16x16x32_bf16 v[124:127],a[216:219],v[152:155],v[124:127]
 ds_read_b64_tr_b16 a[238:239],v7 offset:12288
 v_cvt_pk_bf16_f32 v221,v158,v159
 v_mfma_f32_16x16x32_bf16 v[124:127],a[220:223],v[184:187],v[124:127]
 s_waitcnt lgkmcnt(5)
 v_exp_f32 v166,v166
 v_mfma_f32_16x16x32_bf16 v[132:135],a[192:195],v[64:67],v[224:227]
 s_waitcnt lgkmcnt(4)
 v_exp_f32 v167,v167
 v_mfma_f32_16x16x32_bf16 v[132:135],a[196:199],v[96:99],v[132:135]
 s_waitcnt lgkmcnt(3)
 ds_read_b128 a[208:211],v2 offset:28672
 v_cvt_pk_bf16_f32 v210,v164,v165
 v_mfma_f32_16x16x32_bf16 v[132:135],a[200:203],v[128:131],v[132:135]
 s_waitcnt lgkmcnt(3)
 v_exp_f32 v172,v172
 v_mfma_f32_16x16x32_bf16 v[132:135],a[204:207],v[160:163],v[132:135]
 ds_read_b128 a[212:215],v3 offset:28672
 v_mfma_f32_16x16x32_bf16 v[140:143],a[192:195],v[72:75],v[228:231]
 v_exp_f32 v173,v173
 v_mfma_f32_16x16x32_bf16 v[140:143],a[196:199],v[104:107],v[140:143]
 ds_read_b128 a[216:219],v4 offset:28672
 v_cvt_pk_bf16_f32 v211,v166,v167
 v_mfma_f32_16x16x32_bf16 v[140:143],a[200:203],v[136:139],v[140:143]
 v_exp_f32 v174,v174
 v_mfma_f32_16x16x32_bf16 v[140:143],a[204:207],v[168:171],v[140:143]
 v_exp_f32 v175,v175
 v_mfma_f32_16x16x32_bf16 v[148:151],a[192:195],v[80:83],v[232:235]
 ds_read_b128 a[220:223],v5 offset:28672
 v_cvt_pk_bf16_f32 v214,v172,v173
 v_mfma_f32_16x16x32_bf16 v[148:151],a[196:199],v[112:115],v[148:151]
 v_exp_f32 v180,v180
 v_mfma_f32_16x16x32_bf16 v[148:151],a[200:203],v[144:147],v[148:151]
 v_mfma_f32_16x16x32_bf16 v[148:151],a[204:207],v[176:179],v[148:151]
 v_exp_f32 v181,v181
 v_mfma_f32_16x16x32_bf16 v[156:159],a[192:195],v[88:91],v[236:239]
 ds_read_b64_tr_b16 a[240:241],v8 offset:0
 v_cvt_pk_bf16_f32 v215,v174,v175
 v_mfma_f32_16x16x32_bf16 v[156:159],a[196:199],v[120:123],v[156:159]
 v_exp_f32 v182,v182
 v_mfma_f32_16x16x32_bf16 v[156:159],a[200:203],v[152:155],v[156:159]
 v_exp_f32 v183,v183
 v_mfma_f32_16x16x32_bf16 v[156:159],a[204:207],v[184:187],v[156:159]
 s_waitcnt lgkmcnt(4)
 ds_read_b64_tr_b16 a[242:243],v8 offset:4096
 v_cvt_pk_bf16_f32 v218,v180,v181
 v_mfma_f32_16x16x32_bf16 v[164:167],a[208:211],v[64:67],v[224:227]
 s_waitcnt lgkmcnt(4)
 v_exp_f32 v188,v188
 v_mfma_f32_16x16x32_bf16 v[164:167],a[212:215],v[96:99],v[164:167]
 s_waitcnt lgkmcnt(3)
 v_mfma_f32_16x16x32_bf16 v[164:167],a[216:219],v[128:131],v[164:167]
 s_waitcnt lgkmcnt(2)
 v_exp_f32 v189,v189
 v_mfma_f32_16x16x32_bf16 v[164:167],a[220:223],v[160:163],v[164:167]
 ds_read_b64_tr_b16 a[244:245],v8 offset:8192
 v_cvt_pk_bf16_f32 v219,v182,v183
 v_mfma_f32_16x16x32_bf16 v[172:175],a[208:211],v[72:75],v[228:231]
 v_exp_f32 v190,v190
 v_mfma_f32_16x16x32_bf16 v[172:175],a[212:215],v[104:107],v[172:175]
 v_exp_f32 v191,v191
 v_mfma_f32_16x16x32_bf16 v[172:175],a[216:219],v[136:139],v[172:175]
 ds_read_b64_tr_b16 a[246:247],v8 offset:12288
 v_mfma_f32_16x16x32_bf16 v[172:175],a[220:223],v[168:171],v[172:175]
 v_cvt_pk_bf16_f32 v222,v188,v189
 v_cvt_pk_bf16_f32 v223,v190,v191
 v_mfma_f32_16x16x32_bf16 v[180:183],a[208:211],v[80:83],v[232:235]
 v_exp_f32 v68,v68
 v_mfma_f32_16x16x32_bf16 v[180:183],a[212:215],v[112:115],v[180:183]
 ds_read_b64_tr_b16 a[248:249],v9 offset:0
 v_mfma_f32_16x16x32_bf16 v[180:183],a[216:219],v[144:147],v[180:183]
 v_exp_f32 v69,v69
 v_mfma_f32_16x16x32_bf16 v[180:183],a[220:223],v[176:179],v[180:183]
 v_mfma_f32_16x16x32_bf16 v[188:191],a[208:211],v[88:91],v[236:239]
 v_exp_f32 v70,v70
 v_mfma_f32_16x16x32_bf16 v[188:191],a[212:215],v[120:123],v[188:191]
 ds_read_b64_tr_b16 a[250:251],v9 offset:4096
 v_mfma_f32_16x16x32_bf16 v[188:191],a[216:219],v[152:155],v[188:191]
 v_exp_f32 v71,v71
 v_mfma_f32_16x16x32_bf16 v[188:191],a[220:223],v[184:187],v[188:191]
 v_mfma_f32_16x16x32_bf16 a[0:3],a[224:227],v[192:195],0
 ds_read_b64_tr_b16 a[252:253],v9 offset:8192
 v_cvt_pk_bf16_f32 v48,v68,v69
 v_mfma_f32_16x16x32_bf16 a[0:3],a[228:231],v[208:211],a[0:3]
 v_exp_f32 v100,v100
 v_mfma_f32_16x16x32_bf16 a[4:7],a[224:227],v[196:199],0
 v_mfma_f32_16x16x32_bf16 a[4:7],a[228:231],v[212:215],a[4:7]
 v_exp_f32 v101,v101
 v_mfma_f32_16x16x32_bf16 a[8:11],a[224:227],v[200:203],0
 ds_read_b64_tr_b16 a[254:255],v9 offset:12288
 v_mfma_f32_16x16x32_bf16 a[8:11],a[228:231],v[216:219],a[8:11]
 v_cvt_pk_bf16_f32 v49,v70,v71
 v_mfma_f32_16x16x32_bf16 a[12:15],a[224:227],v[204:207],0
 v_exp_f32 v102,v102
 v_mfma_f32_16x16x32_bf16 a[12:15],a[228:231],v[220:223],a[12:15]
 ds_read_b64_tr_b16 a[224:225],v10 offset:0
 v_mfma_f32_16x16x32_bf16 a[16:19],a[232:235],v[192:195],0
 v_exp_f32 v103,v103
 v_mfma_f32_16x16x32_bf16 a[16:19],a[236:239],v[208:211],a[16:19]
 ds_read_b64_tr_b16 a[226:227],v10 offset:4096
 v_mfma_f32_16x16x32_bf16 a[20:23],a[232:235],v[196:199],0
 ds_read_b64_tr_b16 a[228:229],v10 offset:8192
 v_cvt_pk_bf16_f32 v50,v100,v101
 v_mfma_f32_16x16x32_bf16 a[20:23],a[236:239],v[212:215],a[20:23]
 v_exp_f32 v76,v76
 v_mfma_f32_16x16x32_bf16 a[24:27],a[232:235],v[200:203],0
 ds_read_b64_tr_b16 a[230:231],v10 offset:12288
 v_mfma_f32_16x16x32_bf16 a[24:27],a[236:239],v[216:219],a[24:27]
 v_exp_f32 v77,v77
 v_mfma_f32_16x16x32_bf16 a[28:31],a[232:235],v[204:207],0
 v_mfma_f32_16x16x32_bf16 a[28:31],a[236:239],v[220:223],a[28:31]
 s_waitcnt lgkmcnt(10)
 ds_read_b64_tr_b16 a[232:233],v11 offset:0
 v_cvt_pk_bf16_f32 v51,v102,v103
 v_mfma_f32_16x16x32_bf16 a[32:35],a[240:243],v[192:195],0
 s_waitcnt lgkmcnt(9)
 v_exp_f32 v78,v78
 v_mfma_f32_16x16x32_bf16 a[32:35],a[244:247],v[208:211],a[32:35]
 ds_read_b64_tr_b16 a[234:235],v11 offset:4096
 v_mfma_f32_16x16x32_bf16 a[36:39],a[240:243],v[196:199],0
 v_exp_f32 v79,v79
 v_mfma_f32_16x16x32_bf16 a[36:39],a[244:247],v[212:215],a[36:39]
 ds_read_b64_tr_b16 a[236:237],v11 offset:8192
 v_mfma_f32_16x16x32_bf16 a[40:43],a[240:243],v[200:203],0
 ds_read_b64_tr_b16 a[238:239],v11 offset:12288
 v_cvt_pk_bf16_f32 v52,v76,v77
 v_mfma_f32_16x16x32_bf16 a[40:43],a[244:247],v[216:219],a[40:43]
 v_exp_f32 v108,v108
 v_mfma_f32_16x16x32_bf16 a[44:47],a[240:243],v[204:207],0
 v_mfma_f32_16x16x32_bf16 a[44:47],a[244:247],v[220:223],a[44:47]
 s_waitcnt lgkmcnt(10)
 v_exp_f32 v109,v109
 v_mfma_f32_16x16x32_bf16 a[48:51],a[248:251],v[192:195],0
 s_waitcnt lgkmcnt(8)
 ds_read_b64_tr_b16 a[240:241],v12 offset:0
 v_mfma_f32_16x16x32_bf16 a[48:51],a[252:255],v[208:211],a[48:51]
 ds_read_b64_tr_b16 a[242:243],v12 offset:4096
 v_cvt_pk_bf16_f32 v53,v78,v79
 v_mfma_f32_16x16x32_bf16 a[52:55],a[248:251],v[196:199],0
 v_exp_f32 v110,v110
 v_mfma_f32_16x16x32_bf16 a[52:55],a[252:255],v[212:215],a[52:55]
 ds_read_b64_tr_b16 a[244:245],v12 offset:8192
 ds_read_b64_tr_b16 a[246:247],v12 offset:12288
 v_mfma_f32_16x16x32_bf16 a[56:59],a[248:251],v[200:203],0
 v_exp_f32 v111,v111
 v_mfma_f32_16x16x32_bf16 a[56:59],a[252:255],v[216:219],a[56:59]
 v_mfma_f32_16x16x32_bf16 a[60:63],a[248:251],v[204:207],0
 v_cvt_pk_bf16_f32 v54,v108,v109
 v_mfma_f32_16x16x32_bf16 a[60:63],a[252:255],v[220:223],a[60:63]
 s_waitcnt lgkmcnt(10)
 v_exp_f32 v84,v84
 v_mfma_f32_16x16x32_bf16 a[64:67],a[224:227],v[192:195],0
 s_waitcnt lgkmcnt(8)
 ds_read_b64_tr_b16 a[248:249],v13 offset:0
 ds_read_b64_tr_b16 a[250:251],v13 offset:4096
 v_mfma_f32_16x16x32_bf16 a[64:67],a[228:231],v[208:211],a[64:67]
 v_exp_f32 v85,v85
 v_mfma_f32_16x16x32_bf16 a[68:71],a[224:227],v[196:199],0
 ds_read_b64_tr_b16 a[252:253],v13 offset:8192
 v_mfma_f32_16x16x32_bf16 a[68:71],a[228:231],v[212:215],a[68:71]
 ds_read_b64_tr_b16 a[254:255],v13 offset:12288
 v_cvt_pk_bf16_f32 v55,v110,v111
 v_mfma_f32_16x16x32_bf16 a[72:75],a[224:227],v[200:203],0
 v_exp_f32 v86,v86
 v_mfma_f32_16x16x32_bf16 a[72:75],a[228:231],v[216:219],a[72:75]
 v_mfma_f32_16x16x32_bf16 a[76:79],a[224:227],v[204:207],0
 v_exp_f32 v87,v87
 v_mfma_f32_16x16x32_bf16 a[76:79],a[228:231],v[220:223],a[76:79]
 s_waitcnt lgkmcnt(10)
 v_mfma_f32_16x16x32_bf16 a[80:83],a[232:235],v[192:195],0
 s_waitcnt lgkmcnt(8)
 v_cvt_pk_bf16_f32 v60,v84,v85
 v_mfma_f32_16x16x32_bf16 a[80:83],a[236:239],v[208:211],a[80:83]
 v_exp_f32 v116,v116
 v_mfma_f32_16x16x32_bf16 a[84:87],a[232:235],v[196:199],0
 v_mfma_f32_16x16x32_bf16 a[84:87],a[236:239],v[212:215],a[84:87]
 v_exp_f32 v117,v117
 v_mfma_f32_16x16x32_bf16 a[88:91],a[232:235],v[200:203],0
 v_mfma_f32_16x16x32_bf16 a[88:91],a[236:239],v[216:219],a[88:91]
 s_waitcnt vmcnt(8)
 s_waitcnt lgkmcnt(0)
 s_barrier
 v_cvt_pk_bf16_f32 v61,v86,v87
 v_mfma_f32_16x16x32_bf16 a[92:95],a[232:235],v[204:207],0
 v_exp_f32 v118,v118
 v_mfma_f32_16x16x32_bf16 a[92:95],a[236:239],v[220:223],a[92:95]
 ds_read_b128 a[192:195],v2 offset:32768
 v_mfma_f32_16x16x32_bf16 a[96:99],a[240:243],v[192:195],0
 v_exp_f32 v119,v119
 v_mfma_f32_16x16x32_bf16 a[96:99],a[244:247],v[208:211],a[96:99]
 ds_read_b128 a[196:199],v3 offset:32768
 v_mfma_f32_16x16x32_bf16 a[100:103],a[240:243],v[196:199],0
 v_cvt_pk_bf16_f32 v62,v116,v117
 v_mfma_f32_16x16x32_bf16 a[100:103],a[244:247],v[212:215],a[100:103]
 v_exp_f32 v92,v92
 v_mfma_f32_16x16x32_bf16 a[104:107],a[240:243],v[200:203],0
 ds_read_b128 a[200:203],v4 offset:32768
 v_mfma_f32_16x16x32_bf16 a[104:107],a[244:247],v[216:219],a[104:107]
 v_exp_f32 v93,v93
 v_mfma_f32_16x16x32_bf16 a[108:111],a[240:243],v[204:207],0
 v_mfma_f32_16x16x32_bf16 a[108:111],a[244:247],v[220:223],a[108:111]
 ds_read_b128 a[204:207],v5 offset:32768
 v_cvt_pk_bf16_f32 v63,v118,v119
 v_mfma_f32_16x16x32_bf16 a[112:115],a[248:251],v[192:195],0
 v_exp_f32 v94,v94
 v_mfma_f32_16x16x32_bf16 a[112:115],a[252:255],v[208:211],a[112:115]
 v_mfma_f32_16x16x32_bf16 a[116:119],a[248:251],v[196:199],0
 v_exp_f32 v95,v95
 v_mfma_f32_16x16x32_bf16 a[116:119],a[252:255],v[212:215],a[116:119]
 ds_read_b128 a[208:211],v2 offset:36864
 v_mfma_f32_16x16x32_bf16 a[120:123],a[248:251],v[200:203],0
 v_cvt_pk_bf16_f32 v26,v92,v93
 v_mfma_f32_16x16x32_bf16 a[120:123],a[252:255],v[216:219],a[120:123]
 v_exp_f32 v124,v124
 v_mfma_f32_16x16x32_bf16 a[124:127],a[248:251],v[204:207],0
 ds_read_b128 a[212:215],v3 offset:36864
 v_mfma_f32_16x16x32_bf16 a[124:127],a[252:255],v[220:223],a[124:127]
 v_exp_f32 v125,v125
 v_mfma_f32_16x16x32_bf16 v[248:251],a[188:191],v[192:195],0
 v_mfma_f32_16x16x32_bf16 v[248:251],a[188:191],v[208:211],v[248:251]
 ds_read_b128 a[216:219],v4 offset:36864
 v_cvt_pk_bf16_f32 v27,v94,v95
 v_mfma_f32_16x16x32_bf16 v[240:243],a[188:191],v[196:199],0
 v_exp_f32 v126,v126
 v_mfma_f32_16x16x32_bf16 v[240:243],a[188:191],v[212:215],v[240:243]
 v_mfma_f32_16x16x32_bf16 v[244:247],a[188:191],v[200:203],0
 ds_read_b128 a[220:223],v5 offset:36864
 v_mfma_f32_16x16x32_bf16 v[244:247],a[188:191],v[216:219],v[244:247]
 v_exp_f32 v127,v127
 v_mfma_f32_16x16x32_bf16 v[56:59],a[188:191],v[204:207],0
 v_cvt_pk_bf16_f32 v28,v124,v125
 v_mfma_f32_16x16x32_bf16 v[56:59],a[188:191],v[220:223],v[56:59]
 v_cvt_pk_bf16_f32 v29,v126,v127
 s_mov_b32 s32,3
 s_mov_b32 s98,1073741824
 .p2align 3
K1_loop:
 s_waitcnt lgkmcnt(7)
 v_mfma_f32_16x16x32_bf16 v[68:71],a[192:195],v[64:67],v[224:227]
 s_waitcnt lgkmcnt(6)
 v_exp_f32 v132,v132
 v_mfma_f32_16x16x32_bf16 v[68:71],a[196:199],v[96:99],v[68:71]
 s_waitcnt lgkmcnt(5)
 v_exp_f32 v133,v133
 v_mfma_f32_16x16x32_bf16 v[68:71],a[200:203],v[128:131],v[68:71]
 s_waitcnt lgkmcnt(4)
 ds_read_b64_tr_b16 a[224:225],v6 offset:16384
 ds_read_b64_tr_b16 a[226:227],v6 offset:20480
 v_mfma_f32_16x16x32_bf16 v[68:71],a[204:207],v[160:163],v[68:71]
 v_exp_f32 v134,v134
 v_mfma_f32_16x16x32_bf16 v[76:79],a[192:195],v[72:75],v[228:231]
 v_exp_f32 v135,v135
 v_mfma_f32_16x16x32_bf16 v[76:79],a[196:199],v[104:107],v[76:79]
 ds_read_b64_tr_b16 a[228:229],v6 offset:24576
 v_cvt_pk_bf16_f32 v208,v132,v133
 v_mfma_f32_16x16x32_bf16 v[76:79],a[200:203],v[136:139],v[76:79]
 v_exp_f32 v140,v140
 v_mfma_f32_16x16x32_bf16 v[76:79],a[204:207],v[168:171],v[76:79]
 v_exp_f32 v141,v141
 v_mfma_f32_16x16x32_bf16 v[84:87],a[192:195],v[80:83],v[232:235]
 ds_read_b64_tr_b16 a[230:231],v6 offset:28672
 v_mfma_f32_16x16x32_bf16 v[84:87],a[196:199],v[112:115],v[84:87]
 v_cvt_pk_bf16_f32 v209,v134,v135
 v_mfma_f32_16x16x32_bf16 v[84:87],a[200:203],v[144:147],v[84:87]
 v_exp_f32 v142,v142
 v_mfma_f32_16x16x32_bf16 v[84:87],a[204:207],v[176:179],v[84:87]
 ds_read_b64_tr_b16 a[232:233],v7 offset:16384
 v_mfma_f32_16x16x32_bf16 v[92:95],a[192:195],v[88:91],v[236:239]
 v_exp_f32 v143,v143
 v_mfma_f32_16x16x32_bf16 v[92:95],a[196:199],v[120:123],v[92:95]
 ds_read_b64_tr_b16 a[234:235],v7 offset:20480
 v_cvt_pk_bf16_f32 v212,v140,v141
 v_mfma_f32_16x16x32_bf16 v[92:95],a[200:203],v[152:155],v[92:95]
 v_exp_f32 v148,v148
 v_mfma_f32_16x16x32_bf16 v[92:95],a[204:207],v[184:187],v[92:95]
 s_waitcnt lgkmcnt(9)
 v_exp_f32 v149,v149
 v_mfma_f32_16x16x32_bf16 v[100:103],a[208:211],v[64:67],v[224:227]
 s_waitcnt lgkmcnt(8)
 ds_read_b128 a[192:195],v2 offset:40960
 v_cvt_pk_bf16_f32 v213,v142,v143
 v_mfma_f32_16x16x32_bf16 v[100:103],a[212:215],v[96:99],v[100:103]
 s_waitcnt lgkmcnt(8)
 v_exp_f32 v150,v150
 v_mfma_f32_16x16x32_bf16 v[100:103],a[216:219],v[128:131],v[100:103]
 s_waitcnt lgkmcnt(7)
 v_exp_f32 v151,v151
 v_mfma_f32_16x16x32_bf16 v[100:103],a[220:223],v[160:163],v[100:103]
 ds_read_b128 a[196:199],v3 offset:40960
 v_cvt_pk_bf16_f32 v216,v148,v149
 v_mfma_f32_16x16x32_bf16 v[108:111],a[208:211],v[72:75],v[228:231]
 v_exp_f32 v156,v156
 v_mfma_f32_16x16x32_bf16 v[108:111],a[212:215],v[104:107],v[108:111]
 ds_read_b128 a[200:203],v4 offset:40960
 v_mfma_f32_16x16x32_bf16 v[108:111],a[216:219],v[136:139],v[108:111]
 v_exp_f32 v157,v157
 v_mfma_f32_16x16x32_bf16 v[108:111],a[220:223],v[168:171],v[108:111]
 ds_read_b128 a[204:207],v5 offset:40960
 v_cvt_pk_bf16_f32 v217,v150,v151
 v_mfma_f32_16x16x32_bf16 v[116:119],a[208:211],v[80:83],v[232:235]
 v_exp_f32 v158,v158
 v_mfma_f32_16x16x32_bf16 v[116:119],a[212:215],v[112:115],v[116:119]
 v_exp_f32 v159,v159
 v_mfma_f32_16x16x32_bf16 v[116:119],a[216:219],v[144:147],v[116:119]
 v_mfma_f32_16x16x32_bf16 v[116:119],a[220:223],v[176:179],v[116:119]
 ds_read_b64_tr_b16 a[236:237],v7 offset:24576
 v_cvt_pk_bf16_f32 v220,v156,v157
 v_mfma_f32_16x16x32_bf16 v[124:127],a[208:211],v[88:91],v[236:239]
 v_exp_f32 v164,v164
 v_mfma_f32_16x16x32_bf16 v[124:127],a[212:215],v[120:123],v[124:127]
 v_exp_f32 v165,v165
 v_mfma_f32_16x16x32_bf16 v[124:127],a[216:219],v[152:155],v[124:127]
 ds_read_b64_tr_b16 a[238:239],v7 offset:28672
 v_cvt_pk_bf16_f32 v221,v158,v159
 v_mfma_f32_16x16x32_bf16 v[124:127],a[220:223],v[184:187],v[124:127]
 s_waitcnt lgkmcnt(5)
 v_exp_f32 v166,v166
 v_mfma_f32_16x16x32_bf16 v[132:135],a[192:195],v[64:67],v[224:227]
 s_waitcnt lgkmcnt(4)
 v_exp_f32 v167,v167
 v_mfma_f32_16x16x32_bf16 v[132:135],a[196:199],v[96:99],v[132:135]
 s_waitcnt lgkmcnt(3)
 ds_read_b128 a[208:211],v2 offset:45056
 v_cvt_pk_bf16_f32 v210,v164,v165
 v_mfma_f32_16x16x32_bf16 v[132:135],a[200:203],v[128:131],v[132:135]
 s_waitcnt lgkmcnt(3)
 v_exp_f32 v172,v172
 v_mfma_f32_16x16x32_bf16 v[132:135],a[204:207],v[160:163],v[132:135]
 ds_read_b128 a[212:215],v3 offset:45056
 v_mfma_f32_16x16x32_bf16 v[140:143],a[192:195],v[72:75],v[228:231]
 v_exp_f32 v173,v173
 v_mfma_f32_16x16x32_bf16 v[140:143],a[196:199],v[104:107],v[140:143]
 ds_read_b128 a[216:219],v4 offset:45056
 v_cvt_pk_bf16_f32 v211,v166,v167
 v_mfma_f32_16x16x32_bf16 v[140:143],a[200:203],v[136:139],v[140:143]
 v_exp_f32 v174,v174
 v_mfma_f32_16x16x32_bf16 v[140:143],a[204:207],v[168:171],v[140:143]
 v_exp_f32 v175,v175
 v_mfma_f32_16x16x32_bf16 v[148:151],a[192:195],v[80:83],v[232:235]
 ds_read_b128 a[220:223],v5 offset:45056
 v_cvt_pk_bf16_f32 v214,v172,v173
 v_mfma_f32_16x16x32_bf16 v[148:151],a[196:199],v[112:115],v[148:151]
 v_exp_f32 v180,v180
 v_mfma_f32_16x16x32_bf16 v[148:151],a[200:203],v[144:147],v[148:151]
 v_mfma_f32_16x16x32_bf16 v[148:151],a[204:207],v[176:179],v[148:151]
 v_exp_f32 v181,v181
 v_mfma_f32_16x16x32_bf16 v[156:159],a[192:195],v[88:91],v[236:239]
 ds_read_b64_tr_b16 a[240:241],v8 offset:16384
 v_cvt_pk_bf16_f32 v215,v174,v175
 v_mfma_f32_16x16x32_bf16 v[156:159],a[196:199],v[120:123],v[156:159]
 v_exp_f32 v182,v182
 v_mfma_f32_16x16x32_bf16 v[156:159],a[200:203],v[152:155],v[156:159]
 v_exp_f32 v183,v183
 v_mfma_f32_16x16x32_bf16 v[156:159],a[204:207],v[184:187],v[156:159]
 s_waitcnt lgkmcnt(4)
 ds_read_b64_tr_b16 a[242:243],v8 offset:20480
 v_cvt_pk_bf16_f32 v218,v180,v181
 v_mfma_f32_16x16x32_bf16 v[164:167],a[208:211],v[64:67],v[224:227]
 s_waitcnt lgkmcnt(4)
 v_exp_f32 v188,v188
 v_mfma_f32_16x16x32_bf16 v[164:167],a[212:215],v[96:99],v[164:167]
 s_waitcnt lgkmcnt(3)
 v_mfma_f32_16x16x32_bf16 v[164:167],a[216:219],v[128:131],v[164:167]
 s_waitcnt lgkmcnt(2)
 v_exp_f32 v189,v189
 v_mfma_f32_16x16x32_bf16 v[164:167],a[220:223],v[160:163],v[164:167]
 ds_read_b64_tr_b16 a[244:245],v8 offset:24576
 v_cvt_pk_bf16_f32 v219,v182,v183
 v_mfma_f32_16x16x32_bf16 v[172:175],a[208:211],v[72:75],v[228:231]
 v_exp_f32 v190,v190
 v_mfma_f32_16x16x32_bf16 v[172:175],a[212:215],v[104:107],v[172:175]
 v_exp_f32 v191,v191
 v_mfma_f32_16x16x32_bf16 v[172:175],a[216:219],v[136:139],v[172:175]
 ds_read_b64_tr_b16 a[246:247],v8 offset:28672
 v_mfma_f32_16x16x32_bf16 v[172:175],a[220:223],v[168:171],v[172:175]
 v_cvt_pk_bf16_f32 v222,v188,v189
 v_cvt_pk_bf16_f32 v223,v190,v191
 v_mfma_f32_16x16x32_bf16 v[180:183],a[208:211],v[80:83],v[232:235]
 v_exp_f32 v68,v68
 v_mfma_f32_16x16x32_bf16 v[180:183],a[212:215],v[112:115],v[180:183]
 ds_read_b64_tr_b16 a[248:249],v9 offset:16384
 v_mfma_f32_16x16x32_bf16 v[180:183],a[216:219],v[144:147],v[180:183]
 v_exp_f32 v69,v69
 v_mfma_f32_16x16x32_bf16 v[180:183],a[220:223],v[176:179],v[180:183]
 v_mfma_f32_16x16x32_bf16 v[188:191],a[208:211],v[88:91],v[236:239]
 v_exp_f32 v70,v70
 v_mfma_f32_16x16x32_bf16 v[188:191],a[212:215],v[120:123],v[188:191]
 ds_read_b64_tr_b16 a[250:251],v9 offset:20480
 v_mfma_f32_16x16x32_bf16 v[188:191],a[216:219],v[152:155],v[188:191]
 v_exp_f32 v71,v71
 v_mfma_f32_16x16x32_bf16 v[188:191],a[220:223],v[184:187],v[188:191]
 v_mfma_f32_16x16x32_bf16 a[0:3],a[224:227],v[48:51],a[0:3]
 ds_read_b64_tr_b16 a[252:253],v9 offset:24576
 v_cvt_pk_bf16_f32 v192,v68,v69
 v_mfma_f32_16x16x32_bf16 a[0:3],a[228:231],v[208:211],a[0:3]
 v_exp_f32 v100,v100
 v_mfma_f32_16x16x32_bf16 a[4:7],a[224:227],v[52:55],a[4:7]
 v_mfma_f32_16x16x32_bf16 a[4:7],a[228:231],v[212:215],a[4:7]
 v_exp_f32 v101,v101
 v_mfma_f32_16x16x32_bf16 a[8:11],a[224:227],v[60:63],a[8:11]
 ds_read_b64_tr_b16 a[254:255],v9 offset:28672
 v_mfma_f32_16x16x32_bf16 a[8:11],a[228:231],v[216:219],a[8:11]
 v_cvt_pk_bf16_f32 v193,v70,v71
 v_mfma_f32_16x16x32_bf16 a[12:15],a[224:227],v[26:29],a[12:15]
 v_exp_f32 v102,v102
 v_mfma_f32_16x16x32_bf16 a[12:15],a[228:231],v[220:223],a[12:15]
 ds_read_b64_tr_b16 a[224:225],v10 offset:16384
 v_mfma_f32_16x16x32_bf16 a[16:19],a[232:235],v[48:51],a[16:19]
 v_exp_f32 v103,v103
 v_mfma_f32_16x16x32_bf16 a[16:19],a[236:239],v[208:211],a[16:19]
 ds_read_b64_tr_b16 a[226:227],v10 offset:20480
 v_mfma_f32_16x16x32_bf16 a[20:23],a[232:235],v[52:55],a[20:23]
 ds_read_b64_tr_b16 a[228:229],v10 offset:24576
 v_cvt_pk_bf16_f32 v194,v100,v101
 v_mfma_f32_16x16x32_bf16 a[20:23],a[236:239],v[212:215],a[20:23]
 v_exp_f32 v76,v76
 v_mfma_f32_16x16x32_bf16 a[24:27],a[232:235],v[60:63],a[24:27]
 ds_read_b64_tr_b16 a[230:231],v10 offset:28672
 v_mfma_f32_16x16x32_bf16 a[24:27],a[236:239],v[216:219],a[24:27]
 v_exp_f32 v77,v77
 v_mfma_f32_16x16x32_bf16 a[28:31],a[232:235],v[26:29],a[28:31]
 v_mfma_f32_16x16x32_bf16 a[28:31],a[236:239],v[220:223],a[28:31]
 s_waitcnt lgkmcnt(10)
 ds_read_b64_tr_b16 a[232:233],v11 offset:16384
 v_cvt_pk_bf16_f32 v195,v102,v103
 v_mfma_f32_16x16x32_bf16 a[32:35],a[240:243],v[48:51],a[32:35]
 s_waitcnt lgkmcnt(9)
 v_exp_f32 v78,v78
 v_mfma_f32_16x16x32_bf16 a[32:35],a[244:247],v[208:211],a[32:35]
 ds_read_b64_tr_b16 a[234:235],v11 offset:20480
 v_mfma_f32_16x16x32_bf16 a[36:39],a[240:243],v[52:55],a[36:39]
 v_exp_f32 v79,v79
 v_mfma_f32_16x16x32_bf16 a[36:39],a[244:247],v[212:215],a[36:39]
 ds_read_b64_tr_b16 a[236:237],v11 offset:24576
 v_mfma_f32_16x16x32_bf16 a[40:43],a[240:243],v[60:63],a[40:43]
 ds_read_b64_tr_b16 a[238:239],v11 offset:28672
 v_cvt_pk_bf16_f32 v196,v76,v77
 v_mfma_f32_16x16x32_bf16 a[40:43],a[244:247],v[216:219],a[40:43]
 v_exp_f32 v108,v108
 v_mfma_f32_16x16x32_bf16 a[44:47],a[240:243],v[26:29],a[44:47]
 v_mfma_f32_16x16x32_bf16 a[44:47],a[244:247],v[220:223],a[44:47]
 s_waitcnt lgkmcnt(10)
 v_exp_f32 v109,v109
 v_mfma_f32_16x16x32_bf16 a[48:51],a[248:251],v[48:51],a[48:51]
 s_waitcnt lgkmcnt(8)
 ds_read_b64_tr_b16 a[240:241],v12 offset:16384
 v_mfma_f32_16x16x32_bf16 a[48:51],a[252:255],v[208:211],a[48:51]
 ds_read_b64_tr_b16 a[242:243],v12 offset:20480
 v_cvt_pk_bf16_f32 v197,v78,v79
 v_mfma_f32_16x16x32_bf16 a[52:55],a[248:251],v[52:55],a[52:55]
 v_exp_f32 v110,v110
 v_mfma_f32_16x16x32_bf16 a[52:55],a[252:255],v[212:215],a[52:55]
 ds_read_b64_tr_b16 a[244:245],v12 offset:24576
 ds_read_b64_tr_b16 a[246:247],v12 offset:28672
 v_mfma_f32_16x16x32_bf16 a[56:59],a[248:251],v[60:63],a[56:59]
 v_exp_f32 v111,v111
 v_mfma_f32_16x16x32_bf16 a[56:59],a[252:255],v[216:219],a[56:59]
 v_mfma_f32_16x16x32_bf16 a[60:63],a[248:251],v[26:29],a[60:63]
 v_cvt_pk_bf16_f32 v198,v108,v109
 v_mfma_f32_16x16x32_bf16 a[60:63],a[252:255],v[220:223],a[60:63]
 s_waitcnt lgkmcnt(10)
 v_exp_f32 v84,v84
 v_mfma_f32_16x16x32_bf16 a[64:67],a[224:227],v[48:51],a[64:67]
 s_waitcnt lgkmcnt(8)
 ds_read_b64_tr_b16 a[248:249],v13 offset:16384
 ds_read_b64_tr_b16 a[250:251],v13 offset:20480
 v_mfma_f32_16x16x32_bf16 a[64:67],a[228:231],v[208:211],a[64:67]
 v_exp_f32 v85,v85
 v_mfma_f32_16x16x32_bf16 a[68:71],a[224:227],v[52:55],a[68:71]
 ds_read_b64_tr_b16 a[252:253],v13 offset:24576
 v_mfma_f32_16x16x32_bf16 a[68:71],a[228:231],v[212:215],a[68:71]
 ds_read_b64_tr_b16 a[254:255],v13 offset:28672
 v_cvt_pk_bf16_f32 v199,v110,v111
 v_mfma_f32_16x16x32_bf16 a[72:75],a[224:227],v[60:63],a[72:75]
 v_exp_f32 v86,v86
 v_mfma_f32_16x16x32_bf16 a[72:75],a[228:231],v[216:219],a[72:75]
 v_mfma_f32_16x16x32_bf16 a[76:79],a[224:227],v[26:29],a[76:79]
 v_exp_f32 v87,v87
 v_mfma_f32_16x16x32_bf16 a[76:79],a[228:231],v[220:223],a[76:79]
 s_waitcnt lgkmcnt(10)
 v_mfma_f32_16x16x32_bf16 a[80:83],a[232:235],v[48:51],a[80:83]
 s_waitcnt lgkmcnt(8)
 v_cvt_pk_bf16_f32 v200,v84,v85
 v_mfma_f32_16x16x32_bf16 a[80:83],a[236:239],v[208:211],a[80:83]
 v_exp_f32 v116,v116
 v_mfma_f32_16x16x32_bf16 a[84:87],a[232:235],v[52:55],a[84:87]
 v_mfma_f32_16x16x32_bf16 a[84:87],a[236:239],v[212:215],a[84:87]
 v_exp_f32 v117,v117
 v_mfma_f32_16x16x32_bf16 a[88:91],a[232:235],v[60:63],a[88:91]
 v_mfma_f32_16x16x32_bf16 a[88:91],a[236:239],v[216:219],a[88:91]
 s_waitcnt vmcnt(0)
 s_waitcnt lgkmcnt(0)
 s_barrier
 v_cvt_pk_bf16_f32 v201,v86,v87
 v_mfma_f32_16x16x32_bf16 a[92:95],a[232:235],v[26:29],a[92:95]
 v_exp_f32 v118,v118
 v_mfma_f32_16x16x32_bf16 a[92:95],a[236:239],v[220:223],a[92:95]
 ds_read_b128 a[192:195],v2 offset:49152
 v_mfma_f32_16x16x32_bf16 a[96:99],a[240:243],v[48:51],a[96:99]
 v_exp_f32 v119,v119
 v_mfma_f32_16x16x32_bf16 a[96:99],a[244:247],v[208:211],a[96:99]
 ds_read_b128 a[196:199],v3 offset:49152
 v_mfma_f32_16x16x32_bf16 a[100:103],a[240:243],v[52:55],a[100:103]
 v_cvt_pk_bf16_f32 v202,v116,v117
 v_mfma_f32_16x16x32_bf16 a[100:103],a[244:247],v[212:215],a[100:103]
 v_exp_f32 v92,v92
 v_mfma_f32_16x16x32_bf16 a[104:107],a[240:243],v[60:63],a[104:107]
 ds_read_b128 a[200:203],v4 offset:49152
 v_mfma_f32_16x16x32_bf16 a[104:107],a[244:247],v[216:219],a[104:107]
 v_exp_f32 v93,v93
 v_mfma_f32_16x16x32_bf16 a[108:111],a[240:243],v[26:29],a[108:111]
 v_mfma_f32_16x16x32_bf16 a[108:111],a[244:247],v[220:223],a[108:111]
 ds_read_b128 a[204:207],v5 offset:49152
 v_cvt_pk_bf16_f32 v203,v118,v119
 v_mfma_f32_16x16x32_bf16 a[112:115],a[248:251],v[48:51],a[112:115]
 v_exp_f32 v94,v94
 v_mfma_f32_16x16x32_bf16 a[112:115],a[252:255],v[208:211],a[112:115]
 v_mfma_f32_16x16x32_bf16 a[116:119],a[248:251],v[52:55],a[116:119]
 v_exp_f32 v95,v95
 v_mfma_f32_16x16x32_bf16 a[116:119],a[252:255],v[212:215],a[116:119]
 ds_read_b128 a[208:211],v2 offset:53248
 v_mfma_f32_16x16x32_bf16 a[120:123],a[248:251],v[60:63],a[120:123]
 v_cvt_pk_bf16_f32 v204,v92,v93
 v_mfma_f32_16x16x32_bf16 a[120:123],a[252:255],v[216:219],a[120:123]
 v_exp_f32 v124,v124
 v_mfma_f32_16x16x32_bf16 a[124:127],a[248:251],v[26:29],a[124:127]
 ds_read_b128 a[212:215],v3 offset:53248
 v_mfma_f32_16x16x32_bf16 a[124:127],a[252:255],v[220:223],a[124:127]
 v_exp_f32 v125,v125
 v_mfma_f32_16x16x32_bf16 v[248:251],a[188:191],v[48:51],v[248:251]
 v_mfma_f32_16x16x32_bf16 v[248:251],a[188:191],v[208:211],v[248:251]
 ds_read_b128 a[216:219],v4 offset:53248
 v_cvt_pk_bf16_f32 v205,v94,v95
 v_mfma_f32_16x16x32_bf16 v[240:243],a[188:191],v[52:55],v[240:243]
 v_exp_f32 v126,v126
 v_mfma_f32_16x16x32_bf16 v[240:243],a[188:191],v[212:215],v[240:243]
 v_mfma_f32_16x16x32_bf16 v[244:247],a[188:191],v[60:63],v[244:247]
 ds_read_b128 a[220:223],v5 offset:53248
 v_mfma_f32_16x16x32_bf16 v[244:247],a[188:191],v[216:219],v[244:247]
 v_exp_f32 v127,v127
 v_mfma_f32_16x16x32_bf16 v[56:59],a[188:191],v[26:29],v[56:59]
 v_cvt_pk_bf16_f32 v206,v124,v125
 v_mfma_f32_16x16x32_bf16 v[56:59],a[188:191],v[220:223],v[56:59]
 s_waitcnt lgkmcnt(7)
 v_cvt_pk_bf16_f32 v207,v126,v127
 v_mfma_f32_16x16x32_bf16 v[68:71],a[192:195],v[64:67],v[224:227]
 s_waitcnt lgkmcnt(6)
 v_exp_f32 v132,v132
 v_mfma_f32_16x16x32_bf16 v[68:71],a[196:199],v[96:99],v[68:71]
 s_waitcnt lgkmcnt(5)
 v_exp_f32 v133,v133
 v_mfma_f32_16x16x32_bf16 v[68:71],a[200:203],v[128:131],v[68:71]
 s_waitcnt lgkmcnt(4)
 ds_read_b64_tr_b16 a[224:225],v6 offset:32768
 ds_read_b64_tr_b16 a[226:227],v6 offset:36864
 v_mfma_f32_16x16x32_bf16 v[68:71],a[204:207],v[160:163],v[68:71]
 v_exp_f32 v134,v134
 v_mfma_f32_16x16x32_bf16 v[76:79],a[192:195],v[72:75],v[228:231]
 v_exp_f32 v135,v135
 v_mfma_f32_16x16x32_bf16 v[76:79],a[196:199],v[104:107],v[76:79]
 ds_read_b64_tr_b16 a[228:229],v6 offset:40960
 v_cvt_pk_bf16_f32 v208,v132,v133
 v_mfma_f32_16x16x32_bf16 v[76:79],a[200:203],v[136:139],v[76:79]
 v_exp_f32 v140,v140
 v_mfma_f32_16x16x32_bf16 v[76:79],a[204:207],v[168:171],v[76:79]
 v_exp_f32 v141,v141
 v_mfma_f32_16x16x32_bf16 v[84:87],a[192:195],v[80:83],v[232:235]
 ds_read_b64_tr_b16 a[230:231],v6 offset:45056
 v_mfma_f32_16x16x32_bf16 v[84:87],a[196:199],v[112:115],v[84:87]
 v_cvt_pk_bf16_f32 v209,v134,v135
 v_mfma_f32_16x16x32_bf16 v[84:87],a[200:203],v[144:147],v[84:87]
 v_exp_f32 v142,v142
 v_mfma_f32_16x16x32_bf16 v[84:87],a[204:207],v[176:179],v[84:87]
 ds_read_b64_tr_b16 a[232:233],v7 offset:32768
 v_mfma_f32_16x16x32_bf16 v[92:95],a[192:195],v[88:91],v[236:239]
 v_exp_f32 v143,v143
 v_mfma_f32_16x16x32_bf16 v[92:95],a[196:199],v[120:123],v[92:95]
 ds_read_b64_tr_b16 a[234:235],v7 offset:36864
 v_cvt_pk_bf16_f32 v212,v140,v141
 v_mfma_f32_16x16x32_bf16 v[92:95],a[200:203],v[152:155],v[92:95]
 v_exp_f32 v148,v148
 v_mfma_f32_16x16x32_bf16 v[92:95],a[204:207],v[184:187],v[92:95]
 s_waitcnt lgkmcnt(9)
 v_exp_f32 v149,v149
 v_mfma_f32_16x16x32_bf16 v[100:103],a[208:211],v[64:67],v[224:227]
 s_waitcnt lgkmcnt(8)
 ds_read_b128 a[192:195],v2 offset:57344
 v_cvt_pk_bf16_f32 v213,v142,v143
 v_mfma_f32_16x16x32_bf16 v[100:103],a[212:215],v[96:99],v[100:103]
 s_waitcnt lgkmcnt(8)
 v_exp_f32 v150,v150
 v_mfma_f32_16x16x32_bf16 v[100:103],a[216:219],v[128:131],v[100:103]
 s_waitcnt lgkmcnt(7)
 v_exp_f32 v151,v151
 v_mfma_f32_16x16x32_bf16 v[100:103],a[220:223],v[160:163],v[100:103]
 ds_read_b128 a[196:199],v3 offset:57344
 v_cvt_pk_bf16_f32 v216,v148,v149
 v_mfma_f32_16x16x32_bf16 v[108:111],a[208:211],v[72:75],v[228:231]
 v_exp_f32 v156,v156
 v_mfma_f32_16x16x32_bf16 v[108:111],a[212:215],v[104:107],v[108:111]
 ds_read_b128 a[200:203],v4 offset:57344
 v_mfma_f32_16x16x32_bf16 v[108:111],a[216:219],v[136:139],v[108:111]
 v_exp_f32 v157,v157
 v_mfma_f32_16x16x32_bf16 v[108:111],a[220:223],v[168:171],v[108:111]
 ds_read_b128 a[204:207],v5 offset:57344
 v_cvt_pk_bf16_f32 v217,v150,v151
 v_mfma_f32_16x16x32_bf16 v[116:119],a[208:211],v[80:83],v[232:235]
 v_exp_f32 v158,v158
 v_mfma_f32_16x16x32_bf16 v[116:119],a[212:215],v[112:115],v[116:119]
 v_exp_f32 v159,v159
 v_mfma_f32_16x16x32_bf16 v[116:119],a[216:219],v[144:147],v[116:119]
 v_mfma_f32_16x16x32_bf16 v[116:119],a[220:223],v[176:179],v[116:119]
 ds_read_b64_tr_b16 a[236:237],v7 offset:40960
 v_cvt_pk_bf16_f32 v220,v156,v157
 v_mfma_f32_16x16x32_bf16 v[124:127],a[208:211],v[88:91],v[236:239]
 v_exp_f32 v164,v164
 v_mfma_f32_16x16x32_bf16 v[124:127],a[212:215],v[120:123],v[124:127]
 v_exp_f32 v165,v165
 v_mfma_f32_16x16x32_bf16 v[124:127],a[216:219],v[152:155],v[124:127]
 ds_read_b64_tr_b16 a[238:239],v7 offset:45056
 v_cvt_pk_bf16_f32 v221,v158,v159
 v_mfma_f32_16x16x32_bf16 v[124:127],a[220:223],v[184:187],v[124:127]
 s_waitcnt lgkmcnt(5)
 v_exp_f32 v166,v166
 v_mfma_f32_16x16x32_bf16 v[132:135],a[192:195],v[64:67],v[224:227]
 s_waitcnt lgkmcnt(4)
 v_exp_f32 v167,v167
 v_mfma_f32_16x16x32_bf16 v[132:135],a[196:199],v[96:99],v[132:135]
 s_waitcnt lgkmcnt(3)
 ds_read_b128 a[208:211],v2 offset:61440
 v_cvt_pk_bf16_f32 v210,v164,v165
 v_mfma_f32_16x16x32_bf16 v[132:135],a[200:203],v[128:131],v[132:135]
 s_waitcnt lgkmcnt(3)
 v_exp_f32 v172,v172
 v_mfma_f32_16x16x32_bf16 v[132:135],a[204:207],v[160:163],v[132:135]
 ds_read_b128 a[212:215],v3 offset:61440
 v_mfma_f32_16x16x32_bf16 v[140:143],a[192:195],v[72:75],v[228:231]
 v_exp_f32 v173,v173
 v_mfma_f32_16x16x32_bf16 v[140:143],a[196:199],v[104:107],v[140:143]
 ds_read_b128 a[216:219],v4 offset:61440
 v_cvt_pk_bf16_f32 v211,v166,v167
 v_mfma_f32_16x16x32_bf16 v[140:143],a[200:203],v[136:139],v[140:143]
 v_exp_f32 v174,v174
 v_mfma_f32_16x16x32_bf16 v[140:143],a[204:207],v[168:171],v[140:143]
 v_exp_f32 v175,v175
 v_mfma_f32_16x16x32_bf16 v[148:151],a[192:195],v[80:83],v[232:235]
 ds_read_b128 a[220:223],v5 offset:61440
 v_cvt_pk_bf16_f32 v214,v172,v173
 v_mfma_f32_16x16x32_bf16 v[148:151],a[196:199],v[112:115],v[148:151]
 v_exp_f32 v180,v180
 v_mfma_f32_16x16x32_bf16 v[148:151],a[200:203],v[144:147],v[148:151]
 v_mfma_f32_16x16x32_bf16 v[148:151],a[204:207],v[176:179],v[148:151]
 v_exp_f32 v181,v181
 v_mfma_f32_16x16x32_bf16 v[156:159],a[192:195],v[88:91],v[236:239]
 ds_read_b64_tr_b16 a[240:241],v8 offset:32768
 v_cvt_pk_bf16_f32 v215,v174,v175
 v_mfma_f32_16x16x32_bf16 v[156:159],a[196:199],v[120:123],v[156:159]
 v_exp_f32 v182,v182
 v_mfma_f32_16x16x32_bf16 v[156:159],a[200:203],v[152:155],v[156:159]
 v_exp_f32 v183,v183
 v_mfma_f32_16x16x32_bf16 v[156:159],a[204:207],v[184:187],v[156:159]
 s_waitcnt lgkmcnt(4)
 ds_read_b64_tr_b16 a[242:243],v8 offset:36864
 v_cvt_pk_bf16_f32 v218,v180,v181
 v_mfma_f32_16x16x32_bf16 v[164:167],a[208:211],v[64:67],v[224:227]
 s_waitcnt lgkmcnt(4)
 v_exp_f32 v188,v188
 v_mfma_f32_16x16x32_bf16 v[164:167],a[212:215],v[96:99],v[164:167]
 s_waitcnt lgkmcnt(3)
 v_mfma_f32_16x16x32_bf16 v[164:167],a[216:219],v[128:131],v[164:167]
 s_waitcnt lgkmcnt(2)
 v_exp_f32 v189,v189
 v_mfma_f32_16x16x32_bf16 v[164:167],a[220:223],v[160:163],v[164:167]
 ds_read_b64_tr_b16 a[244:245],v8 offset:40960
 v_cvt_pk_bf16_f32 v219,v182,v183
 v_mfma_f32_16x16x32_bf16 v[172:175],a[208:211],v[72:75],v[228:231]
 v_exp_f32 v190,v190
 v_mfma_f32_16x16x32_bf16 v[172:175],a[212:215],v[104:107],v[172:175]
 v_exp_f32 v191,v191
 v_mfma_f32_16x16x32_bf16 v[172:175],a[216:219],v[136:139],v[172:175]
 ds_read_b64_tr_b16 a[246:247],v8 offset:45056
 v_mfma_f32_16x16x32_bf16 v[172:175],a[220:223],v[168:171],v[172:175]
 v_cvt_pk_bf16_f32 v222,v188,v189
 v_cvt_pk_bf16_f32 v223,v190,v191
 v_mfma_f32_16x16x32_bf16 v[180:183],a[208:211],v[80:83],v[232:235]
 v_exp_f32 v68,v68
 v_mfma_f32_16x16x32_bf16 v[180:183],a[212:215],v[112:115],v[180:183]
 ds_read_b64_tr_b16 a[248:249],v9 offset:32768
 v_mfma_f32_16x16x32_bf16 v[180:183],a[216:219],v[144:147],v[180:183]
 v_exp_f32 v69,v69
 v_mfma_f32_16x16x32_bf16 v[180:183],a[220:223],v[176:179],v[180:183]
 v_mfma_f32_16x16x32_bf16 v[188:191],a[208:211],v[88:91],v[236:239]
 v_exp_f32 v70,v70
 v_mfma_f32_16x16x32_bf16 v[188:191],a[212:215],v[120:123],v[188:191]
 ds_read_b64_tr_b16 a[250:251],v9 offset:36864
 v_mfma_f32_16x16x32_bf16 v[188:191],a[216:219],v[152:155],v[188:191]
 v_exp_f32 v71,v71
 v_mfma_f32_16x16x32_bf16 v[188:191],a[220:223],v[184:187],v[188:191]
 v_mfma_f32_16x16x32_bf16 a[0:3],a[224:227],v[192:195],a[0:3]
 ds_read_b64_tr_b16 a[252:253],v9 offset:40960
 v_cvt_pk_bf16_f32 v48,v68,v69
 v_mfma_f32_16x16x32_bf16 a[0:3],a[228:231],v[208:211],a[0:3]
 v_exp_f32 v100,v100
 v_mfma_f32_16x16x32_bf16 a[4:7],a[224:227],v[196:199],a[4:7]
 v_mfma_f32_16x16x32_bf16 a[4:7],a[228:231],v[212:215],a[4:7]
 v_exp_f32 v101,v101
 v_mfma_f32_16x16x32_bf16 a[8:11],a[224:227],v[200:203],a[8:11]
 ds_read_b64_tr_b16 a[254:255],v9 offset:45056
 v_mfma_f32_16x16x32_bf16 a[8:11],a[228:231],v[216:219],a[8:11]
 v_cvt_pk_bf16_f32 v49,v70,v71
 v_mfma_f32_16x16x32_bf16 a[12:15],a[224:227],v[204:207],a[12:15]
 v_exp_f32 v102,v102
 v_mfma_f32_16x16x32_bf16 a[12:15],a[228:231],v[220:223],a[12:15]
 ds_read_b64_tr_b16 a[224:225],v10 offset:32768
 v_mfma_f32_16x16x32_bf16 a[16:19],a[232:235],v[192:195],a[16:19]
 v_exp_f32 v103,v103
 v_mfma_f32_16x16x32_bf16 a[16:19],a[236:239],v[208:211],a[16:19]
 ds_read_b64_tr_b16 a[226:227],v10 offset:36864
 v_mfma_f32_16x16x32_bf16 a[20:23],a[232:235],v[196:199],a[20:23]
 ds_read_b64_tr_b16 a[228:229],v10 offset:40960
 v_cvt_pk_bf16_f32 v50,v100,v101
 v_mfma_f32_16x16x32_bf16 a[20:23],a[236:239],v[212:215],a[20:23]
 v_exp_f32 v76,v76
 v_mfma_f32_16x16x32_bf16 a[24:27],a[232:235],v[200:203],a[24:27]
 ds_read_b64_tr_b16 a[230:231],v10 offset:45056
 v_mfma_f32_16x16x32_bf16 a[24:27],a[236:239],v[216:219],a[24:27]
 v_exp_f32 v77,v77
 v_mfma_f32_16x16x32_bf16 a[28:31],a[232:235],v[204:207],a[28:31]
 v_mfma_f32_16x16x32_bf16 a[28:31],a[236:239],v[220:223],a[28:31]
 s_waitcnt lgkmcnt(10)
 ds_read_b64_tr_b16 a[232:233],v11 offset:32768
 v_cvt_pk_bf16_f32 v51,v102,v103
 v_mfma_f32_16x16x32_bf16 a[32:35],a[240:243],v[192:195],a[32:35]
 s_waitcnt lgkmcnt(9)
 v_exp_f32 v78,v78
 v_mfma_f32_16x16x32_bf16 a[32:35],a[244:247],v[208:211],a[32:35]
 ds_read_b64_tr_b16 a[234:235],v11 offset:36864
 v_mfma_f32_16x16x32_bf16 a[36:39],a[240:243],v[196:199],a[36:39]
 v_exp_f32 v79,v79
 v_mfma_f32_16x16x32_bf16 a[36:39],a[244:247],v[212:215],a[36:39]
 ds_read_b64_tr_b16 a[236:237],v11 offset:40960
 v_mfma_f32_16x16x32_bf16 a[40:43],a[240:243],v[200:203],a[40:43]
 ds_read_b64_tr_b16 a[238:239],v11 offset:45056
 v_cvt_pk_bf16_f32 v52,v76,v77
 v_mfma_f32_16x16x32_bf16 a[40:43],a[244:247],v[216:219],a[40:43]
 v_exp_f32 v108,v108
 v_mfma_f32_16x16x32_bf16 a[44:47],a[240:243],v[204:207],a[44:47]
 v_mfma_f32_16x16x32_bf16 a[44:47],a[244:247],v[220:223],a[44:47]
 s_waitcnt lgkmcnt(10)
 v_exp_f32 v109,v109
 v_mfma_f32_16x16x32_bf16 a[48:51],a[248:251],v[192:195],a[48:51]
 s_waitcnt lgkmcnt(8)
 ds_read_b64_tr_b16 a[240:241],v12 offset:32768
 v_mfma_f32_16x16x32_bf16 a[48:51],a[252:255],v[208:211],a[48:51]
 ds_read_b64_tr_b16 a[242:243],v12 offset:36864
 v_cvt_pk_bf16_f32 v53,v78,v79
 v_mfma_f32_16x16x32_bf16 a[52:55],a[248:251],v[196:199],a[52:55]
 v_exp_f32 v110,v110
 v_mfma_f32_16x16x32_bf16 a[52:55],a[252:255],v[212:215],a[52:55]
 ds_read_b64_tr_b16 a[244:245],v12 offset:40960
 ds_read_b64_tr_b16 a[246:247],v12 offset:45056
 v_mfma_f32_16x16x32_bf16 a[56:59],a[248:251],v[200:203],a[56:59]
 v_exp_f32 v111,v111
 v_mfma_f32_16x16x32_bf16 a[56:59],a[252:255],v[216:219],a[56:59]
 v_mfma_f32_16x16x32_bf16 a[60:63],a[248:251],v[204:207],a[60:63]
 v_cvt_pk_bf16_f32 v54,v108,v109
 v_mfma_f32_16x16x32_bf16 a[60:63],a[252:255],v[220:223],a[60:63]
 s_waitcnt lgkmcnt(10)
 v_exp_f32 v84,v84
 v_mfma_f32_16x16x32_bf16 a[64:67],a[224:227],v[192:195],a[64:67]
 s_waitcnt lgkmcnt(8)
 ds_read_b64_tr_b16 a[248:249],v13 offset:32768
 ds_read_b64_tr_b16 a[250:251],v13 offset:36864
 v_mfma_f32_16x16x32_bf16 a[64:67],a[228:231],v[208:211],a[64:67]
 v_exp_f32 v85,v85
 v_mfma_f32_16x16x32_bf16 a[68:71],a[224:227],v[196:199],a[68:71]
 ds_read_b64_tr_b16 a[252:253],v13 offset:40960
 v_mfma_f32_16x16x32_bf16 a[68:71],a[228:231],v[212:215],a[68:71]
 ds_read_b64_tr_b16 a[254:255],v13 offset:45056
 v_cvt_pk_bf16_f32 v55,v110,v111
 v_mfma_f32_16x16x32_bf16 a[72:75],a[224:227],v[200:203],a[72:75]
 v_exp_f32 v86,v86
 v_mfma_f32_16x16x32_bf16 a[72:75],a[228:231],v[216:219],a[72:75]
 v_mfma_f32_16x16x32_bf16 a[76:79],a[224:227],v[204:207],a[76:79]
 v_exp_f32 v87,v87
 v_mfma_f32_16x16x32_bf16 a[76:79],a[228:231],v[220:223],a[76:79]
 s_waitcnt lgkmcnt(10)
 v_mfma_f32_16x16x32_bf16 a[80:83],a[232:235],v[192:195],a[80:83]
 s_waitcnt lgkmcnt(8)
 v_cvt_pk_bf16_f32 v60,v84,v85
 v_mfma_f32_16x16x32_bf16 a[80:83],a[236:239],v[208:211],a[80:83]
 v_exp_f32 v116,v116
 v_mfma_f32_16x16x32_bf16 a[84:87],a[232:235],v[196:199],a[84:87]
 v_mfma_f32_16x16x32_bf16 a[84:87],a[236:239],v[212:215],a[84:87]
 v_exp_f32 v117,v117
 v_mfma_f32_16x16x32_bf16 a[88:91],a[232:235],v[200:203],a[88:91]
 v_mfma_f32_16x16x32_bf16 a[88:91],a[236:239],v[216:219],a[88:91]
 s_waitcnt vmcnt(16)
 s_waitcnt lgkmcnt(0)
 s_barrier
 v_cvt_pk_bf16_f32 v61,v86,v87
 v_mfma_f32_16x16x32_bf16 a[92:95],a[232:235],v[204:207],a[92:95]
 v_exp_f32 v118,v118
 v_mfma_f32_16x16x32_bf16 a[92:95],a[236:239],v[220:223],a[92:95]
 ds_read_b128 a[192:195],v2 offset:0
 buffer_atomic_add v1,v253,s[40:43],s98 offen sc1
 v_mfma_f32_16x16x32_bf16 a[96:99],a[240:243],v[192:195],a[96:99]
 v_exp_f32 v119,v119
 v_mfma_f32_16x16x32_bf16 a[96:99],a[244:247],v[208:211],a[96:99]
 ds_read_b128 a[196:199],v3 offset:0
 v_mfma_f32_16x16x32_bf16 a[100:103],a[240:243],v[196:199],a[100:103]
 v_cvt_pk_bf16_f32 v62,v116,v117
 v_mfma_f32_16x16x32_bf16 a[100:103],a[244:247],v[212:215],a[100:103]
 v_exp_f32 v92,v92
 v_mfma_f32_16x16x32_bf16 a[104:107],a[240:243],v[200:203],a[104:107]
 ds_read_b128 a[200:203],v4 offset:0
 v_mfma_f32_16x16x32_bf16 a[104:107],a[244:247],v[216:219],a[104:107]
 v_exp_f32 v93,v93
 v_mfma_f32_16x16x32_bf16 a[108:111],a[240:243],v[204:207],a[108:111]
 v_mfma_f32_16x16x32_bf16 a[108:111],a[244:247],v[220:223],a[108:111]
 ds_read_b128 a[204:207],v5 offset:0
 v_cvt_pk_bf16_f32 v63,v118,v119
 v_mfma_f32_16x16x32_bf16 a[112:115],a[248:251],v[192:195],a[112:115]
 v_exp_f32 v94,v94
 v_mfma_f32_16x16x32_bf16 a[112:115],a[252:255],v[208:211],a[112:115]
 v_mfma_f32_16x16x32_bf16 a[116:119],a[248:251],v[196:199],a[116:119]
 v_exp_f32 v95,v95
 v_mfma_f32_16x16x32_bf16 a[116:119],a[252:255],v[212:215],a[116:119]
 ds_read_b128 a[208:211],v2 offset:4096
 v_mfma_f32_16x16x32_bf16 a[120:123],a[248:251],v[200:203],a[120:123]
 v_cvt_pk_bf16_f32 v26,v92,v93
 v_mfma_f32_16x16x32_bf16 a[120:123],a[252:255],v[216:219],a[120:123]
 v_exp_f32 v124,v124
 v_mfma_f32_16x16x32_bf16 a[124:127],a[248:251],v[204:207],a[124:127]
 ds_read_b128 a[212:215],v3 offset:4096
 v_mfma_f32_16x16x32_bf16 a[124:127],a[252:255],v[220:223],a[124:127]
 v_exp_f32 v125,v125
 v_mfma_f32_16x16x32_bf16 v[248:251],a[188:191],v[192:195],v[248:251]
 v_mfma_f32_16x16x32_bf16 v[248:251],a[188:191],v[208:211],v[248:251]
 ds_read_b128 a[216:219],v4 offset:4096
 v_cvt_pk_bf16_f32 v27,v94,v95
 v_mfma_f32_16x16x32_bf16 v[240:243],a[188:191],v[196:199],v[240:243]
 v_exp_f32 v126,v126
 v_mfma_f32_16x16x32_bf16 v[240:243],a[188:191],v[212:215],v[240:243]
 v_mfma_f32_16x16x32_bf16 v[244:247],a[188:191],v[200:203],v[244:247]
 ds_read_b128 a[220:223],v5 offset:4096
 v_mfma_f32_16x16x32_bf16 v[244:247],a[188:191],v[216:219],v[244:247]
 v_exp_f32 v127,v127
 v_mfma_f32_16x16x32_bf16 v[56:59],a[188:191],v[204:207],v[56:59]
 v_cvt_pk_bf16_f32 v28,v124,v125
 v_mfma_f32_16x16x32_bf16 v[56:59],a[188:191],v[220:223],v[56:59]
 s_waitcnt lgkmcnt(7)
 v_cvt_pk_bf16_f32 v29,v126,v127
 v_mfma_f32_16x16x32_bf16 v[68:71],a[192:195],v[64:67],v[224:227]
 s_waitcnt lgkmcnt(6)
 v_exp_f32 v132,v132
 v_mfma_f32_16x16x32_bf16 v[68:71],a[196:199],v[96:99],v[68:71]
 s_waitcnt lgkmcnt(5)
 v_exp_f32 v133,v133
 v_mfma_f32_16x16x32_bf16 v[68:71],a[200:203],v[128:131],v[68:71]
 s_waitcnt lgkmcnt(4)
 ds_read_b64_tr_b16 a[224:225],v6 offset:49152
 ds_read_b64_tr_b16 a[226:227],v6 offset:53248
 v_mfma_f32_16x16x32_bf16 v[68:71],a[204:207],v[160:163],v[68:71]
 v_exp_f32 v134,v134
 v_mfma_f32_16x16x32_bf16 v[76:79],a[192:195],v[72:75],v[228:231]
 v_exp_f32 v135,v135
 v_mfma_f32_16x16x32_bf16 v[76:79],a[196:199],v[104:107],v[76:79]
 ds_read_b64_tr_b16 a[228:229],v6 offset:57344
 v_cvt_pk_bf16_f32 v208,v132,v133
 v_mfma_f32_16x16x32_bf16 v[76:79],a[200:203],v[136:139],v[76:79]
 v_exp_f32 v140,v140
 v_mfma_f32_16x16x32_bf16 v[76:79],a[204:207],v[168:171],v[76:79]
 v_exp_f32 v141,v141
 v_mfma_f32_16x16x32_bf16 v[84:87],a[192:195],v[80:83],v[232:235]
 ds_read_b64_tr_b16 a[230:231],v6 offset:61440
 v_mfma_f32_16x16x32_bf16 v[84:87],a[196:199],v[112:115],v[84:87]
 v_cvt_pk_bf16_f32 v209,v134,v135
 v_mfma_f32_16x16x32_bf16 v[84:87],a[200:203],v[144:147],v[84:87]
 v_exp_f32 v142,v142
 v_mfma_f32_16x16x32_bf16 v[84:87],a[204:207],v[176:179],v[84:87]
 ds_read_b64_tr_b16 a[232:233],v7 offset:49152
 v_mfma_f32_16x16x32_bf16 v[92:95],a[192:195],v[88:91],v[236:239]
 v_exp_f32 v143,v143
 v_mfma_f32_16x16x32_bf16 v[92:95],a[196:199],v[120:123],v[92:95]
 ds_read_b64_tr_b16 a[234:235],v7 offset:53248
 v_cvt_pk_bf16_f32 v212,v140,v141
 v_mfma_f32_16x16x32_bf16 v[92:95],a[200:203],v[152:155],v[92:95]
 v_exp_f32 v148,v148
 v_mfma_f32_16x16x32_bf16 v[92:95],a[204:207],v[184:187],v[92:95]
 s_waitcnt lgkmcnt(9)
 v_exp_f32 v149,v149
 v_mfma_f32_16x16x32_bf16 v[100:103],a[208:211],v[64:67],v[224:227]
 s_waitcnt lgkmcnt(8)
 ds_read_b128 a[192:195],v2 offset:8192
 v_cvt_pk_bf16_f32 v213,v142,v143
 v_mfma_f32_16x16x32_bf16 v[100:103],a[212:215],v[96:99],v[100:103]
 s_waitcnt lgkmcnt(8)
 v_exp_f32 v150,v150
 v_mfma_f32_16x16x32_bf16 v[100:103],a[216:219],v[128:131],v[100:103]
 s_waitcnt lgkmcnt(7)
 v_exp_f32 v151,v151
 v_mfma_f32_16x16x32_bf16 v[100:103],a[220:223],v[160:163],v[100:103]
 ds_read_b128 a[196:199],v3 offset:8192
 v_cvt_pk_bf16_f32 v216,v148,v149
 v_mfma_f32_16x16x32_bf16 v[108:111],a[208:211],v[72:75],v[228:231]
 v_exp_f32 v156,v156
 v_mfma_f32_16x16x32_bf16 v[108:111],a[212:215],v[104:107],v[108:111]
 ds_read_b128 a[200:203],v4 offset:8192
 v_mfma_f32_16x16x32_bf16 v[108:111],a[216:219],v[136:139],v[108:111]
 v_exp_f32 v157,v157
 v_mfma_f32_16x16x32_bf16 v[108:111],a[220:223],v[168:171],v[108:111]
 ds_read_b128 a[204:207],v5 offset:8192
 v_cvt_pk_bf16_f32 v217,v150,v151
 v_mfma_f32_16x16x32_bf16 v[116:119],a[208:211],v[80:83],v[232:235]
 v_exp_f32 v158,v158
 v_mfma_f32_16x16x32_bf16 v[116:119],a[212:215],v[112:115],v[116:119]
 v_exp_f32 v159,v159
 v_mfma_f32_16x16x32_bf16 v[116:119],a[216:219],v[144:147],v[116:119]
 v_mfma_f32_16x16x32_bf16 v[116:119],a[220:223],v[176:179],v[116:119]
 ds_read_b64_tr_b16 a[236:237],v7 offset:57344
 v_cvt_pk_bf16_f32 v220,v156,v157
 v_mfma_f32_16x16x32_bf16 v[124:127],a[208:211],v[88:91],v[236:239]
 v_exp_f32 v164,v164
 v_mfma_f32_16x16x32_bf16 v[124:127],a[212:215],v[120:123],v[124:127]
 v_exp_f32 v165,v165
 v_mfma_f32_16x16x32_bf16 v[124:127],a[216:219],v[152:155],v[124:127]
 ds_read_b64_tr_b16 a[238:239],v7 offset:61440
 v_cvt_pk_bf16_f32 v221,v158,v159
 v_mfma_f32_16x16x32_bf16 v[124:127],a[220:223],v[184:187],v[124:127]
 s_waitcnt lgkmcnt(5)
 v_exp_f32 v166,v166
 v_mfma_f32_16x16x32_bf16 v[132:135],a[192:195],v[64:67],v[224:227]
 s_waitcnt lgkmcnt(4)
 v_exp_f32 v167,v167
 v_mfma_f32_16x16x32_bf16 v[132:135],a[196:199],v[96:99],v[132:135]
 s_waitcnt lgkmcnt(3)
 ds_read_b128 a[208:211],v2 offset:12288
 v_cvt_pk_bf16_f32 v210,v164,v165
 v_mfma_f32_16x16x32_bf16 v[132:135],a[200:203],v[128:131],v[132:135]
 s_waitcnt lgkmcnt(3)
 v_exp_f32 v172,v172
 v_mfma_f32_16x16x32_bf16 v[132:135],a[204:207],v[160:163],v[132:135]
 ds_read_b128 a[212:215],v3 offset:12288
 v_mfma_f32_16x16x32_bf16 v[140:143],a[192:195],v[72:75],v[228:231]
 v_exp_f32 v173,v173
 v_mfma_f32_16x16x32_bf16 v[140:143],a[196:199],v[104:107],v[140:143]
 ds_read_b128 a[216:219],v4 offset:12288
 v_cvt_pk_bf16_f32 v211,v166,v167
 v_mfma_f32_16x16x32_bf16 v[140:143],a[200:203],v[136:139],v[140:143]
 v_exp_f32 v174,v174
 v_mfma_f32_16x16x32_bf16 v[140:143],a[204:207],v[168:171],v[140:143]
 v_exp_f32 v175,v175
 v_mfma_f32_16x16x32_bf16 v[148:151],a[192:195],v[80:83],v[232:235]
 ds_read_b128 a[220:223],v5 offset:12288
 v_cvt_pk_bf16_f32 v214,v172,v173
 v_mfma_f32_16x16x32_bf16 v[148:151],a[196:199],v[112:115],v[148:151]
 v_exp_f32 v180,v180
 v_mfma_f32_16x16x32_bf16 v[148:151],a[200:203],v[144:147],v[148:151]
 v_mfma_f32_16x16x32_bf16 v[148:151],a[204:207],v[176:179],v[148:151]
 v_exp_f32 v181,v181
 v_mfma_f32_16x16x32_bf16 v[156:159],a[192:195],v[88:91],v[236:239]
 ds_read_b64_tr_b16 a[240:241],v8 offset:49152
 v_cvt_pk_bf16_f32 v215,v174,v175
 v_mfma_f32_16x16x32_bf16 v[156:159],a[196:199],v[120:123],v[156:159]
 v_exp_f32 v182,v182
 v_mfma_f32_16x16x32_bf16 v[156:159],a[200:203],v[152:155],v[156:159]
 v_exp_f32 v183,v183
 v_mfma_f32_16x16x32_bf16 v[156:159],a[204:207],v[184:187],v[156:159]
 s_waitcnt lgkmcnt(4)
 ds_read_b64_tr_b16 a[242:243],v8 offset:53248
 v_cvt_pk_bf16_f32 v218,v180,v181
 v_mfma_f32_16x16x32_bf16 v[164:167],a[208:211],v[64:67],v[224:227]
 s_waitcnt lgkmcnt(4)
 v_exp_f32 v188,v188
 v_mfma_f32_16x16x32_bf16 v[164:167],a[212:215],v[96:99],v[164:167]
 s_waitcnt lgkmcnt(3)
 v_mfma_f32_16x16x32_bf16 v[164:167],a[216:219],v[128:131],v[164:167]
 s_waitcnt lgkmcnt(2)
 v_exp_f32 v189,v189
 v_mfma_f32_16x16x32_bf16 v[164:167],a[220:223],v[160:163],v[164:167]
 ds_read_b64_tr_b16 a[244:245],v8 offset:57344
 v_cvt_pk_bf16_f32 v219,v182,v183
 v_mfma_f32_16x16x32_bf16 v[172:175],a[208:211],v[72:75],v[228:231]
 v_exp_f32 v190,v190
 v_mfma_f32_16x16x32_bf16 v[172:175],a[212:215],v[104:107],v[172:175]
 v_exp_f32 v191,v191
 v_mfma_f32_16x16x32_bf16 v[172:175],a[216:219],v[136:139],v[172:175]
 ds_read_b64_tr_b16 a[246:247],v8 offset:61440
 v_mfma_f32_16x16x32_bf16 v[172:175],a[220:223],v[168:171],v[172:175]
 v_cvt_pk_bf16_f32 v222,v188,v189
 v_cvt_pk_bf16_f32 v223,v190,v191
 v_mfma_f32_16x16x32_bf16 v[180:183],a[208:211],v[80:83],v[232:235]
 v_exp_f32 v68,v68
 v_mfma_f32_16x16x32_bf16 v[180:183],a[212:215],v[112:115],v[180:183]
 ds_read_b64_tr_b16 a[248:249],v9 offset:49152
 v_mfma_f32_16x16x32_bf16 v[180:183],a[216:219],v[144:147],v[180:183]
 v_exp_f32 v69,v69
 v_mfma_f32_16x16x32_bf16 v[180:183],a[220:223],v[176:179],v[180:183]
 v_mfma_f32_16x16x32_bf16 v[188:191],a[208:211],v[88:91],v[236:239]
 v_exp_f32 v70,v70
 v_mfma_f32_16x16x32_bf16 v[188:191],a[212:215],v[120:123],v[188:191]
 ds_read_b64_tr_b16 a[250:251],v9 offset:53248
 v_mfma_f32_16x16x32_bf16 v[188:191],a[216:219],v[152:155],v[188:191]
 v_exp_f32 v71,v71
 v_mfma_f32_16x16x32_bf16 v[188:191],a[220:223],v[184:187],v[188:191]
 v_mfma_f32_16x16x32_bf16 a[0:3],a[224:227],v[48:51],a[0:3]
 ds_read_b64_tr_b16 a[252:253],v9 offset:57344
 v_cvt_pk_bf16_f32 v192,v68,v69
 v_mfma_f32_16x16x32_bf16 a[0:3],a[228:231],v[208:211],a[0:3]
 v_exp_f32 v100,v100
 v_mfma_f32_16x16x32_bf16 a[4:7],a[224:227],v[52:55],a[4:7]
 v_mfma_f32_16x16x32_bf16 a[4:7],a[228:231],v[212:215],a[4:7]
 v_exp_f32 v101,v101
 v_mfma_f32_16x16x32_bf16 a[8:11],a[224:227],v[60:63],a[8:11]
 ds_read_b64_tr_b16 a[254:255],v9 offset:61440
 v_mfma_f32_16x16x32_bf16 a[8:11],a[228:231],v[216:219],a[8:11]
 v_cvt_pk_bf16_f32 v193,v70,v71
 v_mfma_f32_16x16x32_bf16 a[12:15],a[224:227],v[26:29],a[12:15]
 v_exp_f32 v102,v102
 v_mfma_f32_16x16x32_bf16 a[12:15],a[228:231],v[220:223],a[12:15]
 ds_read_b64_tr_b16 a[224:225],v10 offset:49152
 v_mfma_f32_16x16x32_bf16 a[16:19],a[232:235],v[48:51],a[16:19]
 v_exp_f32 v103,v103
 v_mfma_f32_16x16x32_bf16 a[16:19],a[236:239],v[208:211],a[16:19]
 ds_read_b64_tr_b16 a[226:227],v10 offset:53248
 v_mfma_f32_16x16x32_bf16 a[20:23],a[232:235],v[52:55],a[20:23]
 ds_read_b64_tr_b16 a[228:229],v10 offset:57344
 v_cvt_pk_bf16_f32 v194,v100,v101
 v_mfma_f32_16x16x32_bf16 a[20:23],a[236:239],v[212:215],a[20:23]
 v_exp_f32 v76,v76
 v_mfma_f32_16x16x32_bf16 a[24:27],a[232:235],v[60:63],a[24:27]
 ds_read_b64_tr_b16 a[230:231],v10 offset:61440
 v_mfma_f32_16x16x32_bf16 a[24:27],a[236:239],v[216:219],a[24:27]
 v_exp_f32 v77,v77
 v_mfma_f32_16x16x32_bf16 a[28:31],a[232:235],v[26:29],a[28:31]
 v_mfma_f32_16x16x32_bf16 a[28:31],a[236:239],v[220:223],a[28:31]
 s_waitcnt lgkmcnt(10)
 ds_read_b64_tr_b16 a[232:233],v11 offset:49152
 v_cvt_pk_bf16_f32 v195,v102,v103
 v_mfma_f32_16x16x32_bf16 a[32:35],a[240:243],v[48:51],a[32:35]
 s_waitcnt lgkmcnt(9)
 v_exp_f32 v78,v78
 v_mfma_f32_16x16x32_bf16 a[32:35],a[244:247],v[208:211],a[32:35]
 ds_read_b64_tr_b16 a[234:235],v11 offset:53248
 v_mfma_f32_16x16x32_bf16 a[36:39],a[240:243],v[52:55],a[36:39]
 v_exp_f32 v79,v79
 v_mfma_f32_16x16x32_bf16 a[36:39],a[244:247],v[212:215],a[36:39]
 ds_read_b64_tr_b16 a[236:237],v11 offset:57344
 v_mfma_f32_16x16x32_bf16 a[40:43],a[240:243],v[60:63],a[40:43]
 ds_read_b64_tr_b16 a[238:239],v11 offset:61440
 v_cvt_pk_bf16_f32 v196,v76,v77
 v_mfma_f32_16x16x32_bf16 a[40:43],a[244:247],v[216:219],a[40:43]
 v_exp_f32 v108,v108
 v_mfma_f32_16x16x32_bf16 a[44:47],a[240:243],v[26:29],a[44:47]
 v_mfma_f32_16x16x32_bf16 a[44:47],a[244:247],v[220:223],a[44:47]
 s_waitcnt lgkmcnt(10)
 v_exp_f32 v109,v109
 v_mfma_f32_16x16x32_bf16 a[48:51],a[248:251],v[48:51],a[48:51]
 s_waitcnt lgkmcnt(8)
 ds_read_b64_tr_b16 a[240:241],v12 offset:49152
 v_mfma_f32_16x16x32_bf16 a[48:51],a[252:255],v[208:211],a[48:51]
 ds_read_b64_tr_b16 a[242:243],v12 offset:53248
 v_cvt_pk_bf16_f32 v197,v78,v79
 v_mfma_f32_16x16x32_bf16 a[52:55],a[248:251],v[52:55],a[52:55]
 v_exp_f32 v110,v110
 v_mfma_f32_16x16x32_bf16 a[52:55],a[252:255],v[212:215],a[52:55]
 ds_read_b64_tr_b16 a[244:245],v12 offset:57344
 ds_read_b64_tr_b16 a[246:247],v12 offset:61440
 v_mfma_f32_16x16x32_bf16 a[56:59],a[248:251],v[60:63],a[56:59]
 v_exp_f32 v111,v111
 v_mfma_f32_16x16x32_bf16 a[56:59],a[252:255],v[216:219],a[56:59]
 v_mfma_f32_16x16x32_bf16 a[60:63],a[248:251],v[26:29],a[60:63]
 v_cvt_pk_bf16_f32 v198,v108,v109
 v_mfma_f32_16x16x32_bf16 a[60:63],a[252:255],v[220:223],a[60:63]
 s_waitcnt lgkmcnt(10)
 v_exp_f32 v84,v84
 v_mfma_f32_16x16x32_bf16 a[64:67],a[224:227],v[48:51],a[64:67]
 s_waitcnt lgkmcnt(8)
 ds_read_b64_tr_b16 a[248:249],v13 offset:49152
 ds_read_b64_tr_b16 a[250:251],v13 offset:53248
 v_mfma_f32_16x16x32_bf16 a[64:67],a[228:231],v[208:211],a[64:67]
 v_exp_f32 v85,v85
 v_mfma_f32_16x16x32_bf16 a[68:71],a[224:227],v[52:55],a[68:71]
 ds_read_b64_tr_b16 a[252:253],v13 offset:57344
 v_mfma_f32_16x16x32_bf16 a[68:71],a[228:231],v[212:215],a[68:71]
 ds_read_b64_tr_b16 a[254:255],v13 offset:61440
 v_cvt_pk_bf16_f32 v199,v110,v111
 v_mfma_f32_16x16x32_bf16 a[72:75],a[224:227],v[60:63],a[72:75]
 v_exp_f32 v86,v86
 v_mfma_f32_16x16x32_bf16 a[72:75],a[228:231],v[216:219],a[72:75]
 v_mfma_f32_16x16x32_bf16 a[76:79],a[224:227],v[26:29],a[76:79]
 v_exp_f32 v87,v87
 v_mfma_f32_16x16x32_bf16 a[76:79],a[228:231],v[220:223],a[76:79]
 s_waitcnt lgkmcnt(10)
 v_mfma_f32_16x16x32_bf16 a[80:83],a[232:235],v[48:51],a[80:83]
 s_waitcnt lgkmcnt(8)
 v_cvt_pk_bf16_f32 v200,v84,v85
 v_mfma_f32_16x16x32_bf16 a[80:83],a[236:239],v[208:211],a[80:83]
 v_exp_f32 v116,v116
 v_mfma_f32_16x16x32_bf16 a[84:87],a[232:235],v[52:55],a[84:87]
 v_mfma_f32_16x16x32_bf16 a[84:87],a[236:239],v[212:215],a[84:87]
 v_exp_f32 v117,v117
 v_mfma_f32_16x16x32_bf16 a[88:91],a[232:235],v[60:63],a[88:91]
 v_mfma_f32_16x16x32_bf16 a[88:91],a[236:239],v[216:219],a[88:91]
 s_waitcnt vmcnt(63)
 s_waitcnt lgkmcnt(0)
 s_barrier
 v_cvt_pk_bf16_f32 v201,v86,v87
 v_mfma_f32_16x16x32_bf16 a[92:95],a[232:235],v[26:29],a[92:95]
 v_exp_f32 v118,v118
 v_mfma_f32_16x16x32_bf16 a[92:95],a[236:239],v[220:223],a[92:95]
 ds_read_b128 a[192:195],v2 offset:16384
 v_mfma_f32_16x16x32_bf16 a[96:99],a[240:243],v[48:51],a[96:99]
 v_exp_f32 v119,v119
 v_mfma_f32_16x16x32_bf16 a[96:99],a[244:247],v[208:211],a[96:99]
 ds_read_b128 a[196:199],v3 offset:16384
 v_mfma_f32_16x16x32_bf16 a[100:103],a[240:243],v[52:55],a[100:103]
 v_cvt_pk_bf16_f32 v202,v116,v117
 v_mfma_f32_16x16x32_bf16 a[100:103],a[244:247],v[212:215],a[100:103]
 v_exp_f32 v92,v92
 v_mfma_f32_16x16x32_bf16 a[104:107],a[240:243],v[60:63],a[104:107]
 ds_read_b128 a[200:203],v4 offset:16384
 v_mfma_f32_16x16x32_bf16 a[104:107],a[244:247],v[216:219],a[104:107]
 v_exp_f32 v93,v93
 v_mfma_f32_16x16x32_bf16 a[108:111],a[240:243],v[26:29],a[108:111]
 v_mfma_f32_16x16x32_bf16 a[108:111],a[244:247],v[220:223],a[108:111]
 ds_read_b128 a[204:207],v5 offset:16384
 v_cvt_pk_bf16_f32 v203,v118,v119
 v_mfma_f32_16x16x32_bf16 a[112:115],a[248:251],v[48:51],a[112:115]
 v_exp_f32 v94,v94
 v_mfma_f32_16x16x32_bf16 a[112:115],a[252:255],v[208:211],a[112:115]
 v_mfma_f32_16x16x32_bf16 a[116:119],a[248:251],v[52:55],a[116:119]
 v_exp_f32 v95,v95
 v_mfma_f32_16x16x32_bf16 a[116:119],a[252:255],v[212:215],a[116:119]
 ds_read_b128 a[208:211],v2 offset:20480
 v_mfma_f32_16x16x32_bf16 a[120:123],a[248:251],v[60:63],a[120:123]
 v_cvt_pk_bf16_f32 v204,v92,v93
 v_mfma_f32_16x16x32_bf16 a[120:123],a[252:255],v[216:219],a[120:123]
 v_exp_f32 v124,v124
 v_mfma_f32_16x16x32_bf16 a[124:127],a[248:251],v[26:29],a[124:127]
 ds_read_b128 a[212:215],v3 offset:20480
 v_mfma_f32_16x16x32_bf16 a[124:127],a[252:255],v[220:223],a[124:127]
 v_exp_f32 v125,v125
 v_mfma_f32_16x16x32_bf16 v[248:251],a[188:191],v[48:51],v[248:251]
 v_mfma_f32_16x16x32_bf16 v[248:251],a[188:191],v[208:211],v[248:251]
 ds_read_b128 a[216:219],v4 offset:20480
 v_cvt_pk_bf16_f32 v205,v94,v95
 v_mfma_f32_16x16x32_bf16 v[240:243],a[188:191],v[52:55],v[240:243]
 v_exp_f32 v126,v126
 v_mfma_f32_16x16x32_bf16 v[240:243],a[188:191],v[212:215],v[240:243]
 v_mfma_f32_16x16x32_bf16 v[244:247],a[188:191],v[60:63],v[244:247]
 ds_read_b128 a[220:223],v5 offset:20480
 v_mfma_f32_16x16x32_bf16 v[244:247],a[188:191],v[216:219],v[244:247]
 v_exp_f32 v127,v127
 v_mfma_f32_16x16x32_bf16 v[56:59],a[188:191],v[26:29],v[56:59]
 v_cvt_pk_bf16_f32 v206,v124,v125
 v_mfma_f32_16x16x32_bf16 v[56:59],a[188:191],v[220:223],v[56:59]
 s_waitcnt lgkmcnt(7)
 v_cvt_pk_bf16_f32 v207,v126,v127
 v_mfma_f32_16x16x32_bf16 v[68:71],a[192:195],v[64:67],v[224:227]
 s_waitcnt lgkmcnt(6)
 v_exp_f32 v132,v132
 v_mfma_f32_16x16x32_bf16 v[68:71],a[196:199],v[96:99],v[68:71]
 s_waitcnt lgkmcnt(5)
 v_exp_f32 v133,v133
 v_mfma_f32_16x16x32_bf16 v[68:71],a[200:203],v[128:131],v[68:71]
 s_waitcnt lgkmcnt(4)
 ds_read_b64_tr_b16 a[224:225],v6 offset:0
 ds_read_b64_tr_b16 a[226:227],v6 offset:4096
 v_mfma_f32_16x16x32_bf16 v[68:71],a[204:207],v[160:163],v[68:71]
 v_exp_f32 v134,v134
 v_mfma_f32_16x16x32_bf16 v[76:79],a[192:195],v[72:75],v[228:231]
 v_exp_f32 v135,v135
 v_mfma_f32_16x16x32_bf16 v[76:79],a[196:199],v[104:107],v[76:79]
 ds_read_b64_tr_b16 a[228:229],v6 offset:8192
 v_cvt_pk_bf16_f32 v208,v132,v133
 v_mfma_f32_16x16x32_bf16 v[76:79],a[200:203],v[136:139],v[76:79]
 v_exp_f32 v140,v140
 v_mfma_f32_16x16x32_bf16 v[76:79],a[204:207],v[168:171],v[76:79]
 v_exp_f32 v141,v141
 v_mfma_f32_16x16x32_bf16 v[84:87],a[192:195],v[80:83],v[232:235]
 ds_read_b64_tr_b16 a[230:231],v6 offset:12288
 v_mfma_f32_16x16x32_bf16 v[84:87],a[196:199],v[112:115],v[84:87]
 v_cvt_pk_bf16_f32 v209,v134,v135
 v_mfma_f32_16x16x32_bf16 v[84:87],a[200:203],v[144:147],v[84:87]
 v_exp_f32 v142,v142
 v_mfma_f32_16x16x32_bf16 v[84:87],a[204:207],v[176:179],v[84:87]
 ds_read_b64_tr_b16 a[232:233],v7 offset:0
 v_mfma_f32_16x16x32_bf16 v[92:95],a[192:195],v[88:91],v[236:239]
 v_exp_f32 v143,v143
 v_mfma_f32_16x16x32_bf16 v[92:95],a[196:199],v[120:123],v[92:95]
 ds_read_b64_tr_b16 a[234:235],v7 offset:4096
 v_cvt_pk_bf16_f32 v212,v140,v141
 v_mfma_f32_16x16x32_bf16 v[92:95],a[200:203],v[152:155],v[92:95]
 v_exp_f32 v148,v148
 v_mfma_f32_16x16x32_bf16 v[92:95],a[204:207],v[184:187],v[92:95]
 s_waitcnt lgkmcnt(9)
 v_exp_f32 v149,v149
 v_mfma_f32_16x16x32_bf16 v[100:103],a[208:211],v[64:67],v[224:227]
 s_waitcnt lgkmcnt(8)
 ds_read_b128 a[192:195],v2 offset:24576
 v_cvt_pk_bf16_f32 v213,v142,v143
 v_mfma_f32_16x16x32_bf16 v[100:103],a[212:215],v[96:99],v[100:103]
 s_waitcnt lgkmcnt(8)
 v_exp_f32 v150,v150
 v_mfma_f32_16x16x32_bf16 v[100:103],a[216:219],v[128:131],v[100:103]
 s_waitcnt lgkmcnt(7)
 v_exp_f32 v151,v151
 v_mfma_f32_16x16x32_bf16 v[100:103],a[220:223],v[160:163],v[100:103]
 ds_read_b128 a[196:199],v3 offset:24576
 v_cvt_pk_bf16_f32 v216,v148,v149
 v_mfma_f32_16x16x32_bf16 v[108:111],a[208:211],v[72:75],v[228:231]
 v_exp_f32 v156,v156
 v_mfma_f32_16x16x32_bf16 v[108:111],a[212:215],v[104:107],v[108:111]
 ds_read_b128 a[200:203],v4 offset:24576
 v_mfma_f32_16x16x32_bf16 v[108:111],a[216:219],v[136:139],v[108:111]
 v_exp_f32 v157,v157
 v_mfma_f32_16x16x32_bf16 v[108:111],a[220:223],v[168:171],v[108:111]
 ds_read_b128 a[204:207],v5 offset:24576
 v_cvt_pk_bf16_f32 v217,v150,v151
 v_mfma_f32_16x16x32_bf16 v[116:119],a[208:211],v[80:83],v[232:235]
 v_exp_f32 v158,v158
 v_mfma_f32_16x16x32_bf16 v[116:119],a[212:215],v[112:115],v[116:119]
 v_exp_f32 v159,v159
 v_mfma_f32_16x16x32_bf16 v[116:119],a[216:219],v[144:147],v[116:119]
 v_mfma_f32_16x16x32_bf16 v[116:119],a[220:223],v[176:179],v[116:119]
 ds_read_b64_tr_b16 a[236:237],v7 offset:8192
 v_cvt_pk_bf16_f32 v220,v156,v157
 v_mfma_f32_16x16x32_bf16 v[124:127],a[208:211],v[88:91],v[236:239]
 v_exp_f32 v164,v164
 v_mfma_f32_16x16x32_bf16 v[124:127],a[212:215],v[120:123],v[124:127]
 v_exp_f32 v165,v165
 v_mfma_f32_16x16x32_bf16 v[124:127],a[216:219],v[152:155],v[124:127]
 ds_read_b64_tr_b16 a[238:239],v7 offset:12288
 v_cvt_pk_bf16_f32 v221,v158,v159
 v_mfma_f32_16x16x32_bf16 v[124:127],a[220:223],v[184:187],v[124:127]
 s_waitcnt lgkmcnt(5)
 v_exp_f32 v166,v166
 v_mfma_f32_16x16x32_bf16 v[132:135],a[192:195],v[64:67],v[224:227]
 s_waitcnt lgkmcnt(4)
 v_exp_f32 v167,v167
 v_mfma_f32_16x16x32_bf16 v[132:135],a[196:199],v[96:99],v[132:135]
 s_waitcnt lgkmcnt(3)
 ds_read_b128 a[208:211],v2 offset:28672
 v_cvt_pk_bf16_f32 v210,v164,v165
 v_mfma_f32_16x16x32_bf16 v[132:135],a[200:203],v[128:131],v[132:135]
 s_waitcnt lgkmcnt(3)
 v_exp_f32 v172,v172
 v_mfma_f32_16x16x32_bf16 v[132:135],a[204:207],v[160:163],v[132:135]
 ds_read_b128 a[212:215],v3 offset:28672
 v_mfma_f32_16x16x32_bf16 v[140:143],a[192:195],v[72:75],v[228:231]
 v_exp_f32 v173,v173
 v_mfma_f32_16x16x32_bf16 v[140:143],a[196:199],v[104:107],v[140:143]
 ds_read_b128 a[216:219],v4 offset:28672
 v_cvt_pk_bf16_f32 v211,v166,v167
 v_mfma_f32_16x16x32_bf16 v[140:143],a[200:203],v[136:139],v[140:143]
 v_exp_f32 v174,v174
 v_mfma_f32_16x16x32_bf16 v[140:143],a[204:207],v[168:171],v[140:143]
 v_exp_f32 v175,v175
 v_mfma_f32_16x16x32_bf16 v[148:151],a[192:195],v[80:83],v[232:235]
 ds_read_b128 a[220:223],v5 offset:28672
 v_cvt_pk_bf16_f32 v214,v172,v173
 v_mfma_f32_16x16x32_bf16 v[148:151],a[196:199],v[112:115],v[148:151]
 v_exp_f32 v180,v180
 v_mfma_f32_16x16x32_bf16 v[148:151],a[200:203],v[144:147],v[148:151]
 v_mfma_f32_16x16x32_bf16 v[148:151],a[204:207],v[176:179],v[148:151]
 v_exp_f32 v181,v181
 v_mfma_f32_16x16x32_bf16 v[156:159],a[192:195],v[88:91],v[236:239]
 ds_read_b64_tr_b16 a[240:241],v8 offset:0
 v_cvt_pk_bf16_f32 v215,v174,v175
 v_mfma_f32_16x16x32_bf16 v[156:159],a[196:199],v[120:123],v[156:159]
 v_exp_f32 v182,v182
 v_mfma_f32_16x16x32_bf16 v[156:159],a[200:203],v[152:155],v[156:159]
 v_exp_f32 v183,v183
 v_mfma_f32_16x16x32_bf16 v[156:159],a[204:207],v[184:187],v[156:159]
 s_waitcnt lgkmcnt(4)
 ds_read_b64_tr_b16 a[242:243],v8 offset:4096
 v_cvt_pk_bf16_f32 v218,v180,v181
 v_mfma_f32_16x16x32_bf16 v[164:167],a[208:211],v[64:67],v[224:227]
 s_waitcnt lgkmcnt(4)
 v_exp_f32 v188,v188
 v_mfma_f32_16x16x32_bf16 v[164:167],a[212:215],v[96:99],v[164:167]
 s_waitcnt lgkmcnt(3)
 v_mfma_f32_16x16x32_bf16 v[164:167],a[216:219],v[128:131],v[164:167]
 s_waitcnt lgkmcnt(2)
 v_exp_f32 v189,v189
 v_mfma_f32_16x16x32_bf16 v[164:167],a[220:223],v[160:163],v[164:167]
 ds_read_b64_tr_b16 a[244:245],v8 offset:8192
 v_cvt_pk_bf16_f32 v219,v182,v183
 v_mfma_f32_16x16x32_bf16 v[172:175],a[208:211],v[72:75],v[228:231]
 v_exp_f32 v190,v190
 v_mfma_f32_16x16x32_bf16 v[172:175],a[212:215],v[104:107],v[172:175]
 v_exp_f32 v191,v191
 v_mfma_f32_16x16x32_bf16 v[172:175],a[216:219],v[136:139],v[172:175]
 ds_read_b64_tr_b16 a[246:247],v8 offset:12288
 v_mfma_f32_16x16x32_bf16 v[172:175],a[220:223],v[168:171],v[172:175]
 v_cvt_pk_bf16_f32 v222,v188,v189
 v_cvt_pk_bf16_f32 v223,v190,v191
 v_mfma_f32_16x16x32_bf16 v[180:183],a[208:211],v[80:83],v[232:235]
 v_exp_f32 v68,v68
 v_mfma_f32_16x16x32_bf16 v[180:183],a[212:215],v[112:115],v[180:183]
 ds_read_b64_tr_b16 a[248:249],v9 offset:0
 v_mfma_f32_16x16x32_bf16 v[180:183],a[216:219],v[144:147],v[180:183]
 v_exp_f32 v69,v69
 v_mfma_f32_16x16x32_bf16 v[180:183],a[220:223],v[176:179],v[180:183]
 v_mfma_f32_16x16x32_bf16 v[188:191],a[208:211],v[88:91],v[236:239]
 v_exp_f32 v70,v70
 v_mfma_f32_16x16x32_bf16 v[188:191],a[212:215],v[120:123],v[188:191]
 ds_read_b64_tr_b16 a[250:251],v9 offset:4096
 v_mfma_f32_16x16x32_bf16 v[188:191],a[216:219],v[152:155],v[188:191]
 v_exp_f32 v71,v71
 v_mfma_f32_16x16x32_bf16 v[188:191],a[220:223],v[184:187],v[188:191]
 v_mfma_f32_16x16x32_bf16 a[0:3],a[224:227],v[192:195],a[0:3]
 ds_read_b64_tr_b16 a[252:253],v9 offset:8192
 v_cvt_pk_bf16_f32 v48,v68,v69
 v_mfma_f32_16x16x32_bf16 a[0:3],a[228:231],v[208:211],a[0:3]
 v_exp_f32 v100,v100
 v_mfma_f32_16x16x32_bf16 a[4:7],a[224:227],v[196:199],a[4:7]
 v_mfma_f32_16x16x32_bf16 a[4:7],a[228:231],v[212:215],a[4:7]
 v_exp_f32 v101,v101
 v_mfma_f32_16x16x32_bf16 a[8:11],a[224:227],v[200:203],a[8:11]
 ds_read_b64_tr_b16 a[254:255],v9 offset:12288
 v_mfma_f32_16x16x32_bf16 a[8:11],a[228:231],v[216:219],a[8:11]
 v_cvt_pk_bf16_f32 v49,v70,v71
 v_mfma_f32_16x16x32_bf16 a[12:15],a[224:227],v[204:207],a[12:15]
 v_exp_f32 v102,v102
 v_mfma_f32_16x16x32_bf16 a[12:15],a[228:231],v[220:223],a[12:15]
 ds_read_b64_tr_b16 a[224:225],v10 offset:0
 v_mfma_f32_16x16x32_bf16 a[16:19],a[232:235],v[192:195],a[16:19]
 v_exp_f32 v103,v103
 v_mfma_f32_16x16x32_bf16 a[16:19],a[236:239],v[208:211],a[16:19]
 ds_read_b64_tr_b16 a[226:227],v10 offset:4096
 v_mfma_f32_16x16x32_bf16 a[20:23],a[232:235],v[196:199],a[20:23]
 ds_read_b64_tr_b16 a[228:229],v10 offset:8192
 v_cvt_pk_bf16_f32 v50,v100,v101
 v_mfma_f32_16x16x32_bf16 a[20:23],a[236:239],v[212:215],a[20:23]
 v_exp_f32 v76,v76
 v_mfma_f32_16x16x32_bf16 a[24:27],a[232:235],v[200:203],a[24:27]
 ds_read_b64_tr_b16 a[230:231],v10 offset:12288
 v_mfma_f32_16x16x32_bf16 a[24:27],a[236:239],v[216:219],a[24:27]
 v_exp_f32 v77,v77
 v_mfma_f32_16x16x32_bf16 a[28:31],a[232:235],v[204:207],a[28:31]
 v_mfma_f32_16x16x32_bf16 a[28:31],a[236:239],v[220:223],a[28:31]
 s_waitcnt lgkmcnt(10)
 ds_read_b64_tr_b16 a[232:233],v11 offset:0
 v_cvt_pk_bf16_f32 v51,v102,v103
 v_mfma_f32_16x16x32_bf16 a[32:35],a[240:243],v[192:195],a[32:35]
 s_waitcnt lgkmcnt(9)
 v_exp_f32 v78,v78
 v_mfma_f32_16x16x32_bf16 a[32:35],a[244:247],v[208:211],a[32:35]
 ds_read_b64_tr_b16 a[234:235],v11 offset:4096
 v_mfma_f32_16x16x32_bf16 a[36:39],a[240:243],v[196:199],a[36:39]
 v_exp_f32 v79,v79
 v_mfma_f32_16x16x32_bf16 a[36:39],a[244:247],v[212:215],a[36:39]
 ds_read_b64_tr_b16 a[236:237],v11 offset:8192
 v_mfma_f32_16x16x32_bf16 a[40:43],a[240:243],v[200:203],a[40:43]
 ds_read_b64_tr_b16 a[238:239],v11 offset:12288
 v_cvt_pk_bf16_f32 v52,v76,v77
 v_mfma_f32_16x16x32_bf16 a[40:43],a[244:247],v[216:219],a[40:43]
 v_exp_f32 v108,v108
 v_mfma_f32_16x16x32_bf16 a[44:47],a[240:243],v[204:207],a[44:47]
 v_mfma_f32_16x16x32_bf16 a[44:47],a[244:247],v[220:223],a[44:47]
 s_waitcnt lgkmcnt(10)
 v_exp_f32 v109,v109
 v_mfma_f32_16x16x32_bf16 a[48:51],a[248:251],v[192:195],a[48:51]
 s_waitcnt lgkmcnt(8)
 ds_read_b64_tr_b16 a[240:241],v12 offset:0
 v_mfma_f32_16x16x32_bf16 a[48:51],a[252:255],v[208:211],a[48:51]
 ds_read_b64_tr_b16 a[242:243],v12 offset:4096
 v_cvt_pk_bf16_f32 v53,v78,v79
 v_mfma_f32_16x16x32_bf16 a[52:55],a[248:251],v[196:199],a[52:55]
 v_exp_f32 v110,v110
 v_mfma_f32_16x16x32_bf16 a[52:55],a[252:255],v[212:215],a[52:55]
 ds_read_b64_tr_b16 a[244:245],v12 offset:8192
 ds_read_b64_tr_b16 a[246:247],v12 offset:12288
 v_mfma_f32_16x16x32_bf16 a[56:59],a[248:251],v[200:203],a[56:59]
 v_exp_f32 v111,v111
 v_mfma_f32_16x16x32_bf16 a[56:59],a[252:255],v[216:219],a[56:59]
 v_mfma_f32_16x16x32_bf16 a[60:63],a[248:251],v[204:207],a[60:63]
 v_cvt_pk_bf16_f32 v54,v108,v109
 v_mfma_f32_16x16x32_bf16 a[60:63],a[252:255],v[220:223],a[60:63]
 s_waitcnt lgkmcnt(10)
 v_exp_f32 v84,v84
 v_mfma_f32_16x16x32_bf16 a[64:67],a[224:227],v[192:195],a[64:67]
 s_waitcnt lgkmcnt(8)
 ds_read_b64_tr_b16 a[248:249],v13 offset:0
 ds_read_b64_tr_b16 a[250:251],v13 offset:4096
 v_mfma_f32_16x16x32_bf16 a[64:67],a[228:231],v[208:211],a[64:67]
 v_exp_f32 v85,v85
 v_mfma_f32_16x16x32_bf16 a[68:71],a[224:227],v[196:199],a[68:71]
 ds_read_b64_tr_b16 a[252:253],v13 offset:8192
 v_mfma_f32_16x16x32_bf16 a[68:71],a[228:231],v[212:215],a[68:71]
 ds_read_b64_tr_b16 a[254:255],v13 offset:12288
 v_cvt_pk_bf16_f32 v55,v110,v111
 v_mfma_f32_16x16x32_bf16 a[72:75],a[224:227],v[200:203],a[72:75]
 v_exp_f32 v86,v86
 v_mfma_f32_16x16x32_bf16 a[72:75],a[228:231],v[216:219],a[72:75]
 v_mfma_f32_16x16x32_bf16 a[76:79],a[224:227],v[204:207],a[76:79]
 v_exp_f32 v87,v87
 v_mfma_f32_16x16x32_bf16 a[76:79],a[228:231],v[220:223],a[76:79]
 s_waitcnt lgkmcnt(10)
 v_mfma_f32_16x16x32_bf16 a[80:83],a[232:235],v[192:195],a[80:83]
 s_waitcnt lgkmcnt(8)
 v_cvt_pk_bf16_f32 v60,v84,v85
 v_mfma_f32_16x16x32_bf16 a[80:83],a[236:239],v[208:211],a[80:83]
 v_exp_f32 v116,v116
 v_mfma_f32_16x16x32_bf16 a[84:87],a[232:235],v[196:199],a[84:87]
 v_mfma_f32_16x16x32_bf16 a[84:87],a[236:239],v[212:215],a[84:87]
 v_exp_f32 v117,v117
 v_mfma_f32_16x16x32_bf16 a[88:91],a[232:235],v[200:203],a[88:91]
 v_mfma_f32_16x16x32_bf16 a[88:91],a[236:239],v[216:219],a[88:91]
 s_waitcnt vmcnt(9)
 s_waitcnt lgkmcnt(0)
 s_barrier
 v_cvt_pk_bf16_f32 v61,v86,v87
 v_mfma_f32_16x16x32_bf16 a[92:95],a[232:235],v[204:207],a[92:95]
 v_exp_f32 v118,v118
 v_mfma_f32_16x16x32_bf16 a[92:95],a[236:239],v[220:223],a[92:95]
 ds_read_b128 a[192:195],v2 offset:32768
 v_mfma_f32_16x16x32_bf16 a[96:99],a[240:243],v[192:195],a[96:99]
 v_exp_f32 v119,v119
 v_mfma_f32_16x16x32_bf16 a[96:99],a[244:247],v[208:211],a[96:99]
 ds_read_b128 a[196:199],v3 offset:32768
 v_mfma_f32_16x16x32_bf16 a[100:103],a[240:243],v[196:199],a[100:103]
 v_cvt_pk_bf16_f32 v62,v116,v117
 v_mfma_f32_16x16x32_bf16 a[100:103],a[244:247],v[212:215],a[100:103]
 v_exp_f32 v92,v92
 v_mfma_f32_16x16x32_bf16 a[104:107],a[240:243],v[200:203],a[104:107]
 ds_read_b128 a[200:203],v4 offset:32768
 v_mfma_f32_16x16x32_bf16 a[104:107],a[244:247],v[216:219],a[104:107]
 v_exp_f32 v93,v93
 v_mfma_f32_16x16x32_bf16 a[108:111],a[240:243],v[204:207],a[108:111]
 v_mfma_f32_16x16x32_bf16 a[108:111],a[244:247],v[220:223],a[108:111]
 ds_read_b128 a[204:207],v5 offset:32768
 v_cvt_pk_bf16_f32 v63,v118,v119
 v_mfma_f32_16x16x32_bf16 a[112:115],a[248:251],v[192:195],a[112:115]
 v_exp_f32 v94,v94
 v_mfma_f32_16x16x32_bf16 a[112:115],a[252:255],v[208:211],a[112:115]
 v_mfma_f32_16x16x32_bf16 a[116:119],a[248:251],v[196:199],a[116:119]
 v_exp_f32 v95,v95
 v_mfma_f32_16x16x32_bf16 a[116:119],a[252:255],v[212:215],a[116:119]
 ds_read_b128 a[208:211],v2 offset:36864
 v_mfma_f32_16x16x32_bf16 a[120:123],a[248:251],v[200:203],a[120:123]
 v_cvt_pk_bf16_f32 v26,v92,v93
 v_mfma_f32_16x16x32_bf16 a[120:123],a[252:255],v[216:219],a[120:123]
 v_exp_f32 v124,v124
 v_mfma_f32_16x16x32_bf16 a[124:127],a[248:251],v[204:207],a[124:127]
 ds_read_b128 a[212:215],v3 offset:36864
 v_mfma_f32_16x16x32_bf16 a[124:127],a[252:255],v[220:223],a[124:127]
 v_exp_f32 v125,v125
 v_mfma_f32_16x16x32_bf16 v[248:251],a[188:191],v[192:195],v[248:251]
 v_mfma_f32_16x16x32_bf16 v[248:251],a[188:191],v[208:211],v[248:251]
 ds_read_b128 a[216:219],v4 offset:36864
 v_cvt_pk_bf16_f32 v27,v94,v95
 v_mfma_f32_16x16x32_bf16 v[240:243],a[188:191],v[196:199],v[240:243]
 v_exp_f32 v126,v126
 v_mfma_f32_16x16x32_bf16 v[240:243],a[188:191],v[212:215],v[240:243]
 v_mfma_f32_16x16x32_bf16 v[244:247],a[188:191],v[200:203],v[244:247]
 ds_read_b128 a[220:223],v5 offset:36864
 v_mfma_f32_16x16x32_bf16 v[244:247],a[188:191],v[216:219],v[244:247]
 v_exp_f32 v127,v127
 v_mfma_f32_16x16x32_bf16 v[56:59],a[188:191],v[204:207],v[56:59]
 v_cvt_pk_bf16_f32 v28,v124,v125
 v_mfma_f32_16x16x32_bf16 v[56:59],a[188:191],v[220:223],v[56:59]
 v_cvt_pk_bf16_f32 v29,v126,v127
 s_sub_u32 s32,s32,1
 s_cmp_eq_u32 s32,2
 s_cselect_b32 s98,s66,1073741824
 s_cmp_lg_u32 s32,0
 s_cbranch_scc1 K1_loop
K1_tail:
 s_mov_b32 s28,262144
 s_cmp_lg_u32 s33,0
 s_cbranch_scc1 K1_fin
 s_waitcnt lgkmcnt(7)
 v_mfma_f32_16x16x32_bf16 v[68:71],a[192:195],v[64:67],v[224:227]
 s_waitcnt lgkmcnt(6)
 v_exp_f32 v132,v132
 v_mfma_f32_16x16x32_bf16 v[68:71],a[196:199],v[96:99],v[68:71]
 s_waitcnt lgkmcnt(5)
 v_exp_f32 v133,v133
 v_mfma_f32_16x16x32_bf16 v[68:71],a[200:203],v[128:131],v[68:71]
 s_waitcnt lgkmcnt(4)
 s_add_u32 m0,s25,65536
 ds_read_b64_tr_b16 a[224:225],v6 offset:16384
 v_mfma_f32_16x16x32_bf16 v[68:71],a[204:207],v[160:163],v[68:71]
 ds_read_b64_tr_b16 a[226:227],v6 offset:20480
 buffer_load_dwordx4 v30,s[16:19],s28 offen offset:0 sc1 nt lds
 v_mfma_f32_16x16x32_bf16 v[76:79],a[192:195],v[72:75],v[228:231]
 v_exp_f32 v134,v134
 v_mfma_f32_16x16x32_bf16 v[76:79],a[196:199],v[104:107],v[76:79]
 v_exp_f32 v135,v135
 v_mfma_f32_16x16x32_bf16 v[76:79],a[200:203],v[136:139],v[76:79]
 ds_read_b64_tr_b16 a[228:229],v6 offset:24576
 v_cvt_pk_bf16_f32 v208,v132,v133
 v_mfma_f32_16x16x32_bf16 v[76:79],a[204:207],v[168:171],v[76:79]
 v_exp_f32 v140,v140
 v_mfma_f32_16x16x32_bf16 v[84:87],a[192:195],v[80:83],v[232:235]
 v_exp_f32 v141,v141
 v_mfma_f32_16x16x32_bf16 v[84:87],a[196:199],v[112:115],v[84:87]
 ds_read_b64_tr_b16 a[230:231],v6 offset:28672
 v_cvt_pk_bf16_f32 v209,v134,v135
 v_mfma_f32_16x16x32_bf16 v[84:87],a[200:203],v[144:147],v[84:87]
 v_exp_f32 v142,v142
 v_mfma_f32_16x16x32_bf16 v[84:87],a[204:207],v[176:179],v[84:87]
 ds_read_b64_tr_b16 a[232:233],v7 offset:16384
 buffer_load_dwordx4 v31,s[16:19],s28 offen offset:1024 sc1 nt lds
 v_mfma_f32_16x16x32_bf16 v[92:95],a[192:195],v[88:91],v[236:239]
 v_exp_f32 v143,v143
 v_mfma_f32_16x16x32_bf16 v[92:95],a[196:199],v[120:123],v[92:95]
 ds_read_b64_tr_b16 a[234:235],v7 offset:20480
 v_cvt_pk_bf16_f32 v212,v140,v141
 v_mfma_f32_16x16x32_bf16 v[92:95],a[200:203],v[152:155],v[92:95]
 v_exp_f32 v148,v148
 v_mfma_f32_16x16x32_bf16 v[92:95],a[204:207],v[184:187],v[92:95]
 s_waitcnt lgkmcnt(9)
 v_exp_f32 v149,v149
 v_mfma_f32_16x16x32_bf16 v[100:103],a[208:211],v[64:67],v[224:227]
 s_waitcnt lgkmcnt(8)
 ds_read_b128 a[192:195],v2 offset:40960
 v_cvt_pk_bf16_f32 v213,v142,v143
 v_mfma_f32_16x16x32_bf16 v[100:103],a[212:215],v[96:99],v[100:103]
 s_waitcnt lgkmcnt(8)
 v_exp_f32 v150,v150
 v_mfma_f32_16x16x32_bf16 v[100:103],a[216:219],v[128:131],v[100:103]
 s_waitcnt lgkmcnt(7)
 v_exp_f32 v151,v151
 v_mfma_f32_16x16x32_bf16 v[100:103],a[220:223],v[160:163],v[100:103]
 ds_read_b128 a[196:199],v3 offset:40960
 buffer_load_dwordx4 v30,s[16:19],s28 offen offset:2048 sc1 nt lds
 v_mfma_f32_16x16x32_bf16 v[108:111],a[208:211],v[72:75],v[228:231]
 ds_read_b128 a[200:203],v4 offset:40960
 v_cvt_pk_bf16_f32 v216,v148,v149
 v_mfma_f32_16x16x32_bf16 v[108:111],a[212:215],v[104:107],v[108:111]
 v_exp_f32 v156,v156
 v_mfma_f32_16x16x32_bf16 v[108:111],a[216:219],v[136:139],v[108:111]
 v_exp_f32 v157,v157
 v_mfma_f32_16x16x32_bf16 v[108:111],a[220:223],v[168:171],v[108:111]
 ds_read_b128 a[204:207],v5 offset:40960
 v_cvt_pk_bf16_f32 v217,v150,v151
 v_mfma_f32_16x16x32_bf16 v[116:119],a[208:211],v[80:83],v[232:235]
 v_exp_f32 v158,v158
 v_mfma_f32_16x16x32_bf16 v[116:119],a[212:215],v[112:115],v[116:119]
 v_exp_f32 v159,v159
 v_mfma_f32_16x16x32_bf16 v[116:119],a[216:219],v[144:147],v[116:119]
 buffer_load_dwordx4 v31,s[16:19],s28 offen offset:3072 sc1 nt lds
 s_add_u32 s28,s28,16384
 v_mfma_f32_16x16x32_bf16 v[116:119],a[220:223],v[176:179],v[116:119]
 ds_read_b64_tr_b16 a[236:237],v7 offset:24576
 v_cvt_pk_bf16_f32 v220,v156,v157
 v_mfma_f32_16x16x32_bf16 v[124:127],a[208:211],v[88:91],v[236:239]
 v_exp_f32 v164,v164
 v_mfma_f32_16x16x32_bf16 v[124:127],a[212:215],v[120:123],v[124:127]
 v_exp_f32 v165,v165
 v_mfma_f32_16x16x32_bf16 v[124:127],a[216:219],v[152:155],v[124:127]
 ds_read_b64_tr_b16 a[238:239],v7 offset:28672
 v_cvt_pk_bf16_f32 v221,v158,v159
 v_mfma_f32_16x16x32_bf16 v[124:127],a[220:223],v[184:187],v[124:127]
 s_waitcnt lgkmcnt(5)
 v_exp_f32 v166,v166
 v_mfma_f32_16x16x32_bf16 v[132:135],a[192:195],v[64:67],v[224:227]
 s_waitcnt lgkmcnt(4)
 v_exp_f32 v167,v167
 v_mfma_f32_16x16x32_bf16 v[132:135],a[196:199],v[96:99],v[132:135]
 s_waitcnt lgkmcnt(3)
 ds_read_b128 a[208:211],v2 offset:45056
 v_cvt_pk_bf16_f32 v210,v164,v165
 v_mfma_f32_16x16x32_bf16 v[132:135],a[200:203],v[128:131],v[132:135]
 s_waitcnt lgkmcnt(3)
 v_exp_f32 v172,v172
 v_mfma_f32_16x16x32_bf16 v[132:135],a[204:207],v[160:163],v[132:135]
 s_add_u32 m0,s26,131072
 v_exp_f32 v173,v173
 v_mfma_f32_16x16x32_bf16 v[140:143],a[192:195],v[72:75],v[228:231]
 s_add_u32 s35,s30,0
 ds_read_b128 a[212:215],v3 offset:45056
 buffer_load_dwordx4 v34,s[4:7],s35 offen offset:0 lds
 v_mfma_f32_16x16x32_bf16 v[140:143],a[196:199],v[104:107],v[140:143]
 ds_read_b128 a[216:219],v4 offset:45056
 v_cvt_pk_bf16_f32 v211,v166,v167
 v_mfma_f32_16x16x32_bf16 v[140:143],a[200:203],v[136:139],v[140:143]
 v_exp_f32 v174,v174
 v_mfma_f32_16x16x32_bf16 v[140:143],a[204:207],v[168:171],v[140:143]
 v_exp_f32 v175,v175
 v_mfma_f32_16x16x32_bf16 v[148:151],a[192:195],v[80:83],v[232:235]
 ds_read_b128 a[220:223],v5 offset:45056
 v_cvt_pk_bf16_f32 v214,v172,v173
 v_mfma_f32_16x16x32_bf16 v[148:151],a[196:199],v[112:115],v[148:151]
 v_exp_f32 v180,v180
 v_mfma_f32_16x16x32_bf16 v[148:151],a[200:203],v[144:147],v[148:151]
 s_add_u32 s35,s30,8192
 buffer_load_dwordx4 v35,s[4:7],s35 offen offset:1024 lds
 v_mfma_f32_16x16x32_bf16 v[148:151],a[204:207],v[176:179],v[148:151]
 v_exp_f32 v181,v181
 v_mfma_f32_16x16x32_bf16 v[156:159],a[192:195],v[88:91],v[236:239]
 ds_read_b64_tr_b16 a[240:241],v8 offset:16384
 v_cvt_pk_bf16_f32 v215,v174,v175
 v_mfma_f32_16x16x32_bf16 v[156:159],a[196:199],v[120:123],v[156:159]
 v_exp_f32 v182,v182
 v_mfma_f32_16x16x32_bf16 v[156:159],a[200:203],v[152:155],v[156:159]
 v_exp_f32 v183,v183
 v_mfma_f32_16x16x32_bf16 v[156:159],a[204:207],v[184:187],v[156:159]
 s_waitcnt lgkmcnt(4)
 ds_read_b64_tr_b16 a[242:243],v8 offset:20480
 v_cvt_pk_bf16_f32 v218,v180,v181
 v_mfma_f32_16x16x32_bf16 v[164:167],a[208:211],v[64:67],v[224:227]
 s_waitcnt lgkmcnt(4)
 v_exp_f32 v188,v188
 v_mfma_f32_16x16x32_bf16 v[164:167],a[212:215],v[96:99],v[164:167]
 s_waitcnt lgkmcnt(3)
 v_exp_f32 v189,v189
 v_mfma_f32_16x16x32_bf16 v[164:167],a[216:219],v[128:131],v[164:167]
 s_waitcnt lgkmcnt(2)
 s_add_u32 s35,s30,16384
 buffer_load_dwordx4 v34,s[4:7],s35 offen offset:2048 lds
 v_mfma_f32_16x16x32_bf16 v[164:167],a[220:223],v[160:163],v[164:167]
 ds_read_b64_tr_b16 a[244:245],v8 offset:24576
 v_cvt_pk_bf16_f32 v219,v182,v183
 v_mfma_f32_16x16x32_bf16 v[172:175],a[208:211],v[72:75],v[228:231]
 v_exp_f32 v190,v190
 v_mfma_f32_16x16x32_bf16 v[172:175],a[212:215],v[104:107],v[172:175]
 v_exp_f32 v191,v191
 v_mfma_f32_16x16x32_bf16 v[172:175],a[216:219],v[136:139],v[172:175]
 ds_read_b64_tr_b16 a[246:247],v8 offset:28672
 v_mfma_f32_16x16x32_bf16 v[172:175],a[220:223],v[168:171],v[172:175]
 v_cvt_pk_bf16_f32 v222,v188,v189
 v_cvt_pk_bf16_f32 v223,v190,v191
 v_mfma_f32_16x16x32_bf16 v[180:183],a[208:211],v[80:83],v[232:235]
 v_exp_f32 v68,v68
 v_mfma_f32_16x16x32_bf16 v[180:183],a[212:215],v[112:115],v[180:183]
 v_mfma_f32_16x16x32_bf16 v[180:183],a[216:219],v[144:147],v[180:183]
 s_add_u32 s35,s30,24576
 ds_read_b64_tr_b16 a[248:249],v9 offset:16384
 buffer_load_dwordx4 v35,s[4:7],s35 offen offset:3072 lds
 v_mfma_f32_16x16x32_bf16 v[180:183],a[220:223],v[176:179],v[180:183]
 v_exp_f32 v69,v69
 v_mfma_f32_16x16x32_bf16 v[188:191],a[208:211],v[88:91],v[236:239]
 v_exp_f32 v70,v70
 v_mfma_f32_16x16x32_bf16 v[188:191],a[212:215],v[120:123],v[188:191]
 ds_read_b64_tr_b16 a[250:251],v9 offset:20480
 v_mfma_f32_16x16x32_bf16 v[188:191],a[216:219],v[152:155],v[188:191]
 v_exp_f32 v71,v71
 v_mfma_f32_16x16x32_bf16 v[188:191],a[220:223],v[184:187],v[188:191]
 v_mfma_f32_16x16x32_bf16 a[0:3],a[224:227],v[48:51],a[0:3]
 ds_read_b64_tr_b16 a[252:253],v9 offset:24576
 v_cvt_pk_bf16_f32 v192,v68,v69
 v_mfma_f32_16x16x32_bf16 a[0:3],a[228:231],v[208:211],a[0:3]
 s_add_u32 m0,s26,135168
 v_exp_f32 v100,v100
 v_mfma_f32_16x16x32_bf16 a[4:7],a[224:227],v[52:55],a[4:7]
 s_add_u32 s35,s30,36864
 buffer_load_dwordx4 v34,s[4:7],s35 offen offset:0 lds
 v_mfma_f32_16x16x32_bf16 a[4:7],a[228:231],v[212:215],a[4:7]
 v_exp_f32 v101,v101
 v_mfma_f32_16x16x32_bf16 a[8:11],a[224:227],v[60:63],a[8:11]
 ds_read_b64_tr_b16 a[254:255],v9 offset:28672
 v_mfma_f32_16x16x32_bf16 a[8:11],a[228:231],v[216:219],a[8:11]
 v_cvt_pk_bf16_f32 v193,v70,v71
 v_mfma_f32_16x16x32_bf16 a[12:15],a[224:227],v[26:29],a[12:15]
 v_exp_f32 v102,v102
 v_mfma_f32_16x16x32_bf16 a[12:15],a[228:231],v[220:223],a[12:15]
 ds_read_b64_tr_b16 a[224:225],v10 offset:16384
 v_mfma_f32_16x16x32_bf16 a[16:19],a[232:235],v[48:51],a[16:19]
 v_exp_f32 v103,v103
 v_mfma_f32_16x16x32_bf16 a[16:19],a[236:239],v[208:211],a[16:19]
 s_add_u32 s35,s30,45056
 ds_read_b64_tr_b16 a[226:227],v10 offset:20480
 buffer_load_dwordx4 v35,s[4:7],s35 offen offset:1024 lds
 v_mfma_f32_16x16x32_bf16 a[20:23],a[232:235],v[52:55],a[20:23]
 ds_read_b64_tr_b16 a[228:229],v10 offset:24576
 v_cvt_pk_bf16_f32 v194,v100,v101
 v_mfma_f32_16x16x32_bf16 a[20:23],a[236:239],v[212:215],a[20:23]
 v_exp_f32 v76,v76
 v_mfma_f32_16x16x32_bf16 a[24:27],a[232:235],v[60:63],a[24:27]
 ds_read_b64_tr_b16 a[230:231],v10 offset:28672
 v_mfma_f32_16x16x32_bf16 a[24:27],a[236:239],v[216:219],a[24:27]
 v_exp_f32 v77,v77
 v_mfma_f32_16x16x32_bf16 a[28:31],a[232:235],v[26:29],a[28:31]
 v_mfma_f32_16x16x32_bf16 a[28:31],a[236:239],v[220:223],a[28:31]
 s_waitcnt lgkmcnt(10)
 ds_read_b64_tr_b16 a[232:233],v11 offset:16384
 v_cvt_pk_bf16_f32 v195,v102,v103
 v_mfma_f32_16x16x32_bf16 a[32:35],a[240:243],v[48:51],a[32:35]
 s_waitcnt lgkmcnt(9)
 v_exp_f32 v78,v78
 v_mfma_f32_16x16x32_bf16 a[32:35],a[244:247],v[208:211],a[32:35]
 s_add_u32 s35,s30,53248
 ds_read_b64_tr_b16 a[234:235],v11 offset:20480
 buffer_load_dwordx4 v34,s[4:7],s35 offen offset:2048 lds
 v_mfma_f32_16x16x32_bf16 a[36:39],a[240:243],v[52:55],a[36:39]
 v_exp_f32 v79,v79
 v_mfma_f32_16x16x32_bf16 a[36:39],a[244:247],v[212:215],a[36:39]
 ds_read_b64_tr_b16 a[236:237],v11 offset:24576
 v_mfma_f32_16x16x32_bf16 a[40:43],a[240:243],v[60:63],a[40:43]
 ds_read_b64_tr_b16 a[238:239],v11 offset:28672
 v_cvt_pk_bf16_f32 v196,v76,v77
 v_mfma_f32_16x16x32_bf16 a[40:43],a[244:247],v[216:219],a[40:43]
 v_exp_f32 v108,v108
 v_mfma_f32_16x16x32_bf16 a[44:47],a[240:243],v[26:29],a[44:47]
 v_mfma_f32_16x16x32_bf16 a[44:47],a[244:247],v[220:223],a[44:47]
 s_waitcnt lgkmcnt(10)
 v_exp_f32 v109,v109
 v_mfma_f32_16x16x32_bf16 a[48:51],a[248:251],v[48:51],a[48:51]
 s_waitcnt lgkmcnt(8)
 ds_read_b64_tr_b16 a[240:241],v12 offset:16384
 ds_read_b64_tr_b16 a[242:243],v12 offset:20480
 v_mfma_f32_16x16x32_bf16 a[48:51],a[252:255],v[208:211],a[48:51]
 s_add_u32 s35,s30,61440
 buffer_load_dwordx4 v35,s[4:7],s35 offen offset:3072 lds
 v_cvt_pk_bf16_f32 v197,v78,v79
 v_mfma_f32_16x16x32_bf16 a[52:55],a[248:251],v[52:55],a[52:55]
 v_exp_f32 v110,v110
 v_mfma_f32_16x16x32_bf16 a[52:55],a[252:255],v[212:215],a[52:55]
 ds_read_b64_tr_b16 a[244:245],v12 offset:24576
 ds_read_b64_tr_b16 a[246:247],v12 offset:28672
 v_mfma_f32_16x16x32_bf16 a[56:59],a[248:251],v[60:63],a[56:59]
 v_exp_f32 v111,v111
 v_mfma_f32_16x16x32_bf16 a[56:59],a[252:255],v[216:219],a[56:59]
 v_mfma_f32_16x16x32_bf16 a[60:63],a[248:251],v[26:29],a[60:63]
 v_cvt_pk_bf16_f32 v198,v108,v109
 v_mfma_f32_16x16x32_bf16 a[60:63],a[252:255],v[220:223],a[60:63]
 s_waitcnt lgkmcnt(10)
 v_exp_f32 v84,v84
 v_mfma_f32_16x16x32_bf16 a[64:67],a[224:227],v[48:51],a[64:67]
 s_waitcnt lgkmcnt(8)
 ds_read_b64_tr_b16 a[248:249],v13 offset:16384
 ds_read_b64_tr_b16 a[250:251],v13 offset:20480
 v_mfma_f32_16x16x32_bf16 a[64:67],a[228:231],v[208:211],a[64:67]
 s_mov_b32 m0,162816
 v_exp_f32 v85,v85
 v_mfma_f32_16x16x32_bf16 a[68:71],a[224:227],v[52:55],a[68:71]
 s_add_u32 s35,s29,1048576
 ds_read_b64_tr_b16 a[252:253],v13 offset:24576
 buffer_load_dwordx4 v38,s[8:11],s35 offen lds
 v_mfma_f32_16x16x32_bf16 a[68:71],a[228:231],v[212:215],a[68:71]
 ds_read_b64_tr_b16 a[254:255],v13 offset:28672
 v_cvt_pk_bf16_f32 v199,v110,v111
 v_mfma_f32_16x16x32_bf16 a[72:75],a[224:227],v[60:63],a[72:75]
 v_exp_f32 v86,v86
 v_mfma_f32_16x16x32_bf16 a[72:75],a[228:231],v[216:219],a[72:75]
 v_mfma_f32_16x16x32_bf16 a[76:79],a[224:227],v[26:29],a[76:79]
 v_exp_f32 v87,v87
 v_mfma_f32_16x16x32_bf16 a[76:79],a[228:231],v[220:223],a[76:79]
 s_waitcnt lgkmcnt(10)
 v_mfma_f32_16x16x32_bf16 a[80:83],a[232:235],v[48:51],a[80:83]
 s_waitcnt lgkmcnt(8)
 v_cvt_pk_bf16_f32 v200,v84,v85
 v_mfma_f32_16x16x32_bf16 a[80:83],a[236:239],v[208:211],a[80:83]
 s_add_u32 s35,s29,1572864
 buffer_load_dwordx4 v38,s[8:11],s35 offen lds
 v_mfma_f32_16x16x32_bf16 a[84:87],a[232:235],v[52:55],a[84:87]
 v_exp_f32 v116,v116
 v_mfma_f32_16x16x32_bf16 a[84:87],a[236:239],v[212:215],a[84:87]
 v_exp_f32 v117,v117
 v_mfma_f32_16x16x32_bf16 a[88:91],a[232:235],v[60:63],a[88:91]
 v_cvt_pk_bf16_f32 v201,v86,v87
 v_mfma_f32_16x16x32_bf16 a[88:91],a[236:239],v[216:219],a[88:91]
 s_waitcnt vmcnt(17)
 s_waitcnt lgkmcnt(0)
 s_barrier
 ds_read_b128 a[192:195],v2 offset:49152
 v_mfma_f32_16x16x32_bf16 a[92:95],a[232:235],v[26:29],a[92:95]
 s_mov_b32 m0,162816
 v_exp_f32 v118,v118
 v_mfma_f32_16x16x32_bf16 a[92:95],a[236:239],v[220:223],a[92:95]
 s_add_u32 s35,s29,2097152
 buffer_load_dwordx4 v38,s[8:11],s35 offen lds
 v_mfma_f32_16x16x32_bf16 a[96:99],a[240:243],v[48:51],a[96:99]
 v_exp_f32 v119,v119
 v_mfma_f32_16x16x32_bf16 a[96:99],a[244:247],v[208:211],a[96:99]
 ds_read_b128 a[196:199],v3 offset:49152
 v_mfma_f32_16x16x32_bf16 a[100:103],a[240:243],v[52:55],a[100:103]
 v_cvt_pk_bf16_f32 v202,v116,v117
 v_mfma_f32_16x16x32_bf16 a[100:103],a[244:247],v[212:215],a[100:103]
 v_exp_f32 v92,v92
 v_mfma_f32_16x16x32_bf16 a[104:107],a[240:243],v[60:63],a[104:107]
 ds_read_b128 a[200:203],v4 offset:49152
 v_mfma_f32_16x16x32_bf16 a[104:107],a[244:247],v[216:219],a[104:107]
 v_exp_f32 v93,v93
 v_mfma_f32_16x16x32_bf16 a[108:111],a[240:243],v[26:29],a[108:111]
 v_mfma_f32_16x16x32_bf16 a[108:111],a[244:247],v[220:223],a[108:111]
 ds_read_b128 a[204:207],v5 offset:49152
 v_cvt_pk_bf16_f32 v203,v118,v119
 v_mfma_f32_16x16x32_bf16 a[112:115],a[248:251],v[48:51],a[112:115]
 v_exp_f32 v94,v94
 v_mfma_f32_16x16x32_bf16 a[112:115],a[252:255],v[208:211],a[112:115]
 v_mfma_f32_16x16x32_bf16 a[116:119],a[248:251],v[52:55],a[116:119]
 v_exp_f32 v95,v95
 v_mfma_f32_16x16x32_bf16 a[116:119],a[252:255],v[212:215],a[116:119]
 ds_read_b128 a[208:211],v2 offset:53248
 v_mfma_f32_16x16x32_bf16 a[120:123],a[248:251],v[60:63],a[120:123]
 v_cvt_pk_bf16_f32 v204,v92,v93
 v_mfma_f32_16x16x32_bf16 a[120:123],a[252:255],v[216:219],a[120:123]
 v_exp_f32 v124,v124
 v_mfma_f32_16x16x32_bf16 a[124:127],a[248:251],v[26:29],a[124:127]
 ds_read_b128 a[212:215],v3 offset:53248
 v_mfma_f32_16x16x32_bf16 a[124:127],a[252:255],v[220:223],a[124:127]
 v_exp_f32 v125,v125
 v_mfma_f32_16x16x32_bf16 v[248:251],a[188:191],v[48:51],v[248:251]
 v_mfma_f32_16x16x32_bf16 v[248:251],a[188:191],v[208:211],v[248:251]
 ds_read_b128 a[216:219],v4 offset:53248
 v_cvt_pk_bf16_f32 v205,v94,v95
 v_mfma_f32_16x16x32_bf16 v[240:243],a[188:191],v[52:55],v[240:243]
 v_exp_f32 v126,v126
 v_mfma_f32_16x16x32_bf16 v[240:243],a[188:191],v[212:215],v[240:243]
 v_mfma_f32_16x16x32_bf16 v[244:247],a[188:191],v[60:63],v[244:247]
 v_exp_f32 v127,v127
 v_mfma_f32_16x16x32_bf16 v[244:247],a[188:191],v[216:219],v[244:247]
 s_add_u32 s35,s29,2621440
 ds_read_b128 a[220:223],v5 offset:53248
 buffer_load_dwordx4 v38,s[8:11],s35 offen lds
 v_mfma_f32_16x16x32_bf16 v[56:59],a[188:191],v[26:29],v[56:59]
 v_cvt_pk_bf16_f32 v206,v124,v125
 v_mfma_f32_16x16x32_bf16 v[56:59],a[188:191],v[220:223],v[56:59]
 s_waitcnt lgkmcnt(7)
 v_cvt_pk_bf16_f32 v207,v126,v127
 v_mfma_f32_16x16x32_bf16 v[68:71],a[192:195],v[64:67],v[224:227]
 s_waitcnt lgkmcnt(6)
 v_exp_f32 v132,v132
 v_mfma_f32_16x16x32_bf16 v[68:71],a[196:199],v[96:99],v[68:71]
 s_waitcnt lgkmcnt(5)
 ds_read_b64_tr_b16 a[224:225],v6 offset:32768
 ds_read_b64_tr_b16 a[226:227],v6 offset:36864
 v_mfma_f32_16x16x32_bf16 v[68:71],a[200:203],v[128:131],v[68:71]
 s_waitcnt lgkmcnt(6)
 v_exp_f32 v133,v133
 v_mfma_f32_16x16x32_bf16 v[68:71],a[204:207],v[160:163],v[68:71]
 v_exp_f32 v134,v134
 v_mfma_f32_16x16x32_bf16 v[76:79],a[192:195],v[72:75],v[228:231]
 ds_read_b64_tr_b16 a[228:229],v7 offset:32768
 v_accvgpr_read_b32 v26,a180
 v_mfma_f32_16x16x32_bf16 v[76:79],a[196:199],v[104:107],v[76:79]
 v_exp_f32 v135,v135
 v_mfma_f32_16x16x32_bf16 v[76:79],a[200:203],v[136:139],v[76:79]
 s_add_u32 m0,s25,81920
 ds_read_b64_tr_b16 a[230:231],v7 offset:36864
 v_cvt_pk_bf16_f32 v208,v132,v133
 v_mfma_f32_16x16x32_bf16 v[76:79],a[204:207],v[168:171],v[76:79]
 v_exp_f32 v164,v164
 v_mfma_f32_16x16x32_bf16 v[84:87],a[192:195],v[80:83],v[232:235]
 s_add_u32 s34,s29,0
 ds_read_b64_tr_b16 a[232:233],v8 offset:32768
 buffer_load_dwordx4 v32,s[8:11],s34 offen offset:0 lds
 v_mfma_f32_16x16x32_bf16 v[84:87],a[196:199],v[112:115],v[84:87]
 v_exp_f32 v165,v165
 v_mfma_f32_16x16x32_bf16 v[84:87],a[200:203],v[144:147],v[84:87]
 ds_read_b64_tr_b16 a[234:235],v8 offset:36864
 v_cvt_pk_bf16_f32 v209,v134,v135
 v_mfma_f32_16x16x32_bf16 v[84:87],a[204:207],v[176:179],v[84:87]
 v_exp_f32 v166,v166
 v_mfma_f32_16x16x32_bf16 v[92:95],a[192:195],v[88:91],v[236:239]
 ds_read_b64_tr_b16 a[236:237],v9 offset:32768
 v_mfma_f32_16x16x32_bf16 v[92:95],a[196:199],v[120:123],v[92:95]
 v_exp_f32 v167,v167
 v_mfma_f32_16x16x32_bf16 v[92:95],a[200:203],v[152:155],v[92:95]
 ds_read_b64_tr_b16 a[238:239],v9 offset:36864
 v_cvt_pk_bf16_f32 v210,v164,v165
 v_mfma_f32_16x16x32_bf16 v[92:95],a[204:207],v[184:187],v[92:95]
 s_waitcnt lgkmcnt(11)
 v_exp_f32 v140,v140
 v_mfma_f32_16x16x32_bf16 v[100:103],a[208:211],v[64:67],v[224:227]
 s_waitcnt lgkmcnt(10)
 ds_read_b64_tr_b16 a[240:241],v10 offset:32768
 v_mfma_f32_16x16x32_bf16 v[100:103],a[212:215],v[96:99],v[100:103]
 s_waitcnt lgkmcnt(10)
 v_exp_f32 v141,v141
 v_mfma_f32_16x16x32_bf16 v[100:103],a[216:219],v[128:131],v[100:103]
 s_waitcnt lgkmcnt(9)
 ds_read_b64_tr_b16 a[242:243],v10 offset:36864
 v_cvt_pk_bf16_f32 v211,v166,v167
 v_mfma_f32_16x16x32_bf16 v[100:103],a[220:223],v[160:163],v[100:103]
 v_exp_f32 v142,v142
 v_mfma_f32_16x16x32_bf16 v[108:111],a[208:211],v[72:75],v[228:231]
 ds_read_b64_tr_b16 a[244:245],v11 offset:32768
 v_mfma_f32_16x16x32_bf16 v[108:111],a[212:215],v[104:107],v[108:111]
 v_exp_f32 v143,v143
 v_mfma_f32_16x16x32_bf16 v[108:111],a[216:219],v[136:139],v[108:111]
 s_add_u32 s34,s29,31744
 ds_read_b64_tr_b16 a[246:247],v11 offset:36864
 buffer_load_dwordx4 v32,s[8:11],s34 offen offset:1024 lds
 v_mfma_f32_16x16x32_bf16 v[108:111],a[220:223],v[168:171],v[108:111]
 ds_read_b64_tr_b16 a[248:249],v12 offset:32768
 v_cvt_pk_bf16_f32 v212,v140,v141
 v_mfma_f32_16x16x32_bf16 v[116:119],a[208:211],v[80:83],v[232:235]
 v_exp_f32 v172,v172
 v_mfma_f32_16x16x32_bf16 v[116:119],a[212:215],v[112:115],v[116:119]
 v_exp_f32 v173,v173
 v_mfma_f32_16x16x32_bf16 v[116:119],a[216:219],v[144:147],v[116:119]
 ds_read_b64_tr_b16 a[250:251],v12 offset:36864
 v_cvt_pk_bf16_f32 v213,v142,v143
 v_mfma_f32_16x16x32_bf16 v[116:119],a[220:223],v[176:179],v[116:119]
 ds_read_b64_tr_b16 a[252:253],v13 offset:32768
 v_mfma_f32_16x16x32_bf16 v[124:127],a[208:211],v[88:91],v[236:239]
 v_exp_f32 v174,v174
 v_mfma_f32_16x16x32_bf16 v[124:127],a[212:215],v[120:123],v[124:127]
 v_exp_f32 v175,v175
 v_mfma_f32_16x16x32_bf16 v[124:127],a[216:219],v[152:155],v[124:127]
 ds_read_b64_tr_b16 a[254:255],v13 offset:36864
 v_cvt_pk_bf16_f32 v214,v172,v173
 v_mfma_f32_16x16x32_bf16 v[124:127],a[220:223],v[184:187],v[124:127]
 s_waitcnt lgkmcnt(14)
 v_exp_f32 v148,v148
 v_mfma_f32_16x16x32_bf16 a[0:3],a[224:227],v[192:195],a[0:3]
 v_mfma_f32_16x16x32_bf16 a[4:7],a[224:227],v[196:199],a[4:7]
 v_exp_f32 v149,v149
 v_mfma_f32_16x16x32_bf16 a[8:11],a[224:227],v[200:203],a[8:11]
 v_cvt_pk_bf16_f32 v215,v174,v175
 v_accvgpr_read_b32 v27,a181
 v_mfma_f32_16x16x32_bf16 a[12:15],a[224:227],v[204:207],a[12:15]
 s_waitcnt lgkmcnt(12)
 v_exp_f32 v150,v150
 v_mfma_f32_16x16x32_bf16 a[16:19],a[228:231],v[192:195],a[16:19]
 s_add_u32 s34,s29,63488
 ds_read_b128 a[192:195],v2 offset:57344
 buffer_load_dwordx4 v33,s[8:11],s34 offen offset:2048 lds
 v_mfma_f32_16x16x32_bf16 a[20:23],a[228:231],v[196:199],a[20:23]
 v_exp_f32 v151,v151
 v_mfma_f32_16x16x32_bf16 a[24:27],a[228:231],v[200:203],a[24:27]
 ds_read_b128 a[196:199],v3 offset:57344
 v_cvt_pk_bf16_f32 v216,v148,v149
 v_mfma_f32_16x16x32_bf16 a[28:31],a[228:231],v[204:207],a[28:31]
 s_waitcnt lgkmcnt(12)
 v_exp_f32 v180,v180
 v_mfma_f32_16x16x32_bf16 a[32:35],a[232:235],v[192:195],a[32:35]
 v_mfma_f32_16x16x32_bf16 a[36:39],a[232:235],v[196:199],a[36:39]
 v_exp_f32 v181,v181
 v_mfma_f32_16x16x32_bf16 a[40:43],a[232:235],v[200:203],a[40:43]
 ds_read_b128 a[200:203],v4 offset:57344
 v_cvt_pk_bf16_f32 v217,v150,v151
 v_mfma_f32_16x16x32_bf16 a[44:47],a[232:235],v[204:207],a[44:47]
 s_waitcnt lgkmcnt(11)
 v_exp_f32 v182,v182
 v_mfma_f32_16x16x32_bf16 a[48:51],a[236:239],v[192:195],a[48:51]
 ds_read_b128 a[204:207],v5 offset:57344
 v_mfma_f32_16x16x32_bf16 a[52:55],a[236:239],v[196:199],a[52:55]
 v_exp_f32 v183,v183
 v_mfma_f32_16x16x32_bf16 a[56:59],a[236:239],v[200:203],a[56:59]
 v_cvt_pk_bf16_f32 v218,v180,v181
 v_mfma_f32_16x16x32_bf16 a[60:63],a[236:239],v[204:207],a[60:63]
 s_waitcnt lgkmcnt(10)
 v_exp_f32 v156,v156
 v_mfma_f32_16x16x32_bf16 a[64:67],a[240:243],v[192:195],a[64:67]
 ds_read_b128 a[208:211],v2 offset:61440
 v_mfma_f32_16x16x32_bf16 a[68:71],a[240:243],v[196:199],a[68:71]
 v_exp_f32 v157,v157
 v_mfma_f32_16x16x32_bf16 a[72:75],a[240:243],v[200:203],a[72:75]
 ds_read_b128 a[212:215],v3 offset:61440
 v_cvt_pk_bf16_f32 v219,v182,v183
 v_mfma_f32_16x16x32_bf16 a[76:79],a[240:243],v[204:207],a[76:79]
 s_waitcnt lgkmcnt(10)
 v_exp_f32 v158,v158
 v_mfma_f32_16x16x32_bf16 a[80:83],a[244:247],v[192:195],a[80:83]
 s_add_u32 s34,s29,95232
 buffer_load_dwordx4 v33,s[8:11],s34 offen offset:3072 lds
 v_mfma_f32_16x16x32_bf16 a[84:87],a[244:247],v[196:199],a[84:87]
 v_exp_f32 v159,v159
 v_mfma_f32_16x16x32_bf16 a[88:91],a[244:247],v[200:203],a[88:91]
 ds_read_b128 a[216:219],v4 offset:61440
 v_cvt_pk_bf16_f32 v220,v156,v157
 v_mfma_f32_16x16x32_bf16 a[92:95],a[244:247],v[204:207],a[92:95]
 s_waitcnt lgkmcnt(9)
 v_exp_f32 v188,v188
 v_mfma_f32_16x16x32_bf16 a[96:99],a[248:251],v[192:195],a[96:99]
 v_exp_f32 v189,v189
 v_mfma_f32_16x16x32_bf16 a[100:103],a[248:251],v[196:199],a[100:103]
 ds_read_b128 a[220:223],v5 offset:61440
 v_mfma_f32_16x16x32_bf16 a[104:107],a[248:251],v[200:203],a[104:107]
 v_cvt_pk_bf16_f32 v221,v158,v159
 v_mfma_f32_16x16x32_bf16 a[108:111],a[248:251],v[204:207],a[108:111]
 s_waitcnt lgkmcnt(8)
 v_exp_f32 v190,v190
 v_mfma_f32_16x16x32_bf16 a[112:115],a[252:255],v[192:195],a[112:115]
 v_exp_f32 v191,v191
 v_mfma_f32_16x16x32_bf16 a[116:119],a[252:255],v[196:199],a[116:119]
 ds_read_b64_tr_b16 a[224:225],v6 offset:40960
 v_mfma_f32_16x16x32_bf16 a[120:123],a[252:255],v[200:203],a[120:123]
 v_cvt_pk_bf16_f32 v222,v188,v189
 v_mfma_f32_16x16x32_bf16 a[124:127],a[252:255],v[204:207],a[124:127]
 v_mfma_f32_16x16x32_bf16 v[248:251],a[188:191],v[192:195],v[248:251]
 v_mfma_f32_16x16x32_bf16 v[240:243],a[188:191],v[196:199],v[240:243]
 v_mfma_f32_16x16x32_bf16 v[244:247],a[188:191],v[200:203],v[244:247]
 ds_read_b64_tr_b16 a[226:227],v6 offset:45056
 v_mfma_f32_16x16x32_bf16 v[56:59],a[188:191],v[204:207],v[56:59]
 s_waitcnt lgkmcnt(9)
 v_cvt_pk_bf16_f32 v223,v190,v191
 v_accvgpr_read_b32 v28,a182
 v_mfma_f32_16x16x32_bf16 v[132:135],a[192:195],v[64:67],v[224:227]
 s_waitcnt lgkmcnt(8)
 v_exp_f32 v68,v68
 v_mfma_f32_16x16x32_bf16 v[132:135],a[196:199],v[96:99],v[132:135]
 s_waitcnt lgkmcnt(7)
 v_exp_f32 v69,v69
 v_mfma_f32_16x16x32_bf16 v[132:135],a[200:203],v[128:131],v[132:135]
 s_waitcnt lgkmcnt(6)
 s_mov_b32 m0,162816
 ds_read_b64_tr_b16 a[228:229],v7 offset:40960
 v_mfma_f32_16x16x32_bf16 v[132:135],a[204:207],v[160:163],v[132:135]
 s_add_u32 s35,s29,3145728
 ds_read_b64_tr_b16 a[230:231],v7 offset:45056
 buffer_load_dwordx4 v38,s[8:11],s35 offen lds
 v_mfma_f32_16x16x32_bf16 v[140:143],a[192:195],v[72:75],v[228:231]
 v_exp_f32 v70,v70
 v_mfma_f32_16x16x32_bf16 v[140:143],a[196:199],v[104:107],v[140:143]
 v_exp_f32 v71,v71
 v_mfma_f32_16x16x32_bf16 v[140:143],a[200:203],v[136:139],v[140:143]
 ds_read_b64_tr_b16 a[232:233],v8 offset:40960
 v_cvt_pk_bf16_f32 v192,v68,v69
 v_mfma_f32_16x16x32_bf16 v[140:143],a[204:207],v[168:171],v[140:143]
 v_exp_f32 v100,v100
 v_mfma_f32_16x16x32_bf16 v[148:151],a[192:195],v[80:83],v[232:235]
 ds_read_b64_tr_b16 a[234:235],v8 offset:45056
 v_mfma_f32_16x16x32_bf16 v[148:151],a[196:199],v[112:115],v[148:151]
 v_exp_f32 v101,v101
 v_mfma_f32_16x16x32_bf16 v[148:151],a[200:203],v[144:147],v[148:151]
 ds_read_b64_tr_b16 a[236:237],v9 offset:40960
 v_cvt_pk_bf16_f32 v193,v70,v71
 v_mfma_f32_16x16x32_bf16 v[148:151],a[204:207],v[176:179],v[148:151]
 v_exp_f32 v102,v102
 v_mfma_f32_16x16x32_bf16 v[156:159],a[192:195],v[88:91],v[236:239]
 ds_read_b64_tr_b16 a[238:239],v9 offset:45056
 v_mfma_f32_16x16x32_bf16 v[156:159],a[196:199],v[120:123],v[156:159]
 v_exp_f32 v103,v103
 v_mfma_f32_16x16x32_bf16 v[156:159],a[200:203],v[152:155],v[156:159]
 ds_read_b64_tr_b16 a[240:241],v10 offset:40960
 v_cvt_pk_bf16_f32 v194,v100,v101
 v_mfma_f32_16x16x32_bf16 v[156:159],a[204:207],v[184:187],v[156:159]
 s_waitcnt lgkmcnt(12)
 v_exp_f32 v76,v76
 v_mfma_f32_16x16x32_bf16 v[164:167],a[208:211],v[64:67],v[224:227]
 s_waitcnt lgkmcnt(11)
 ds_read_b64_tr_b16 a[242:243],v10 offset:45056
 v_mfma_f32_16x16x32_bf16 v[164:167],a[212:215],v[96:99],v[164:167]
 s_waitcnt lgkmcnt(11)
 v_exp_f32 v77,v77
 v_mfma_f32_16x16x32_bf16 v[164:167],a[216:219],v[128:131],v[164:167]
 s_waitcnt lgkmcnt(10)
 ds_read_b64_tr_b16 a[244:245],v11 offset:40960
 v_cvt_pk_bf16_f32 v195,v102,v103
 v_mfma_f32_16x16x32_bf16 v[164:167],a[220:223],v[160:163],v[164:167]
 v_exp_f32 v78,v78
 v_mfma_f32_16x16x32_bf16 v[172:175],a[208:211],v[72:75],v[228:231]
 s_add_u32 s35,s29,3670016
 ds_read_b64_tr_b16 a[246:247],v11 offset:45056
 buffer_load_dwordx4 v38,s[8:11],s35 offen lds
 v_mfma_f32_16x16x32_bf16 v[172:175],a[212:215],v[104:107],v[172:175]
 v_exp_f32 v79,v79
 v_mfma_f32_16x16x32_bf16 v[172:175],a[216:219],v[136:139],v[172:175]
 ds_read_b64_tr_b16 a[248:249],v12 offset:40960
 v_cvt_pk_bf16_f32 v196,v76,v77
 v_mfma_f32_16x16x32_bf16 v[172:175],a[220:223],v[168:171],v[172:175]
 v_exp_f32 v108,v108
 v_mfma_f32_16x16x32_bf16 v[180:183],a[208:211],v[80:83],v[232:235]
 ds_read_b64_tr_b16 a[250:251],v12 offset:45056
 v_mfma_f32_16x16x32_bf16 v[180:183],a[212:215],v[112:115],v[180:183]
 v_exp_f32 v109,v109
 v_mfma_f32_16x16x32_bf16 v[180:183],a[216:219],v[144:147],v[180:183]
 ds_read_b64_tr_b16 a[252:253],v13 offset:40960
 v_cvt_pk_bf16_f32 v197,v78,v79
 v_mfma_f32_16x16x32_bf16 v[180:183],a[220:223],v[176:179],v[180:183]
 v_exp_f32 v110,v110
 v_mfma_f32_16x16x32_bf16 v[188:191],a[208:211],v[88:91],v[236:239]
 v_exp_f32 v111,v111
 v_mfma_f32_16x16x32_bf16 v[188:191],a[212:215],v[120:123],v[188:191]
 ds_read_b64_tr_b16 a[254:255],v13 offset:45056
 v_accvgpr_read_b32 v29,a183
 v_mfma_f32_16x16x32_bf16 v[188:191],a[216:219],v[152:155],v[188:191]
 v_cvt_pk_bf16_f32 v198,v108,v109
 v_mfma_f32_16x16x32_bf16 v[188:191],a[220:223],v[184:187],v[188:191]
 s_waitcnt lgkmcnt(14)
 v_exp_f32 v84,v84
 v_mfma_f32_16x16x32_bf16 a[0:3],a[224:227],v[208:211],a[0:3]
 v_exp_f32 v85,v85
 v_mfma_f32_16x16x32_bf16 a[4:7],a[224:227],v[212:215],a[4:7]
 s_add_u32 s35,s29,4194304
 buffer_load_dwordx4 v38,s[8:11],s35 offen lds
 v_cvt_pk_bf16_f32 v199,v110,v111
 v_mfma_f32_16x16x32_bf16 a[8:11],a[224:227],v[216:219],a[8:11]
 v_exp_f32 v86,v86
 v_mfma_f32_16x16x32_bf16 a[12:15],a[224:227],v[220:223],a[12:15]
 s_waitcnt lgkmcnt(12)
 v_exp_f32 v87,v87
 v_mfma_f32_16x16x32_bf16 a[16:19],a[228:231],v[208:211],a[16:19]
 v_cvt_pk_bf16_f32 v200,v84,v85
 v_mfma_f32_16x16x32_bf16 a[20:23],a[228:231],v[212:215],a[20:23]
 s_waitcnt vmcnt(42)
 s_waitcnt lgkmcnt(0)
 s_barrier
 ds_read_b64_tr_b16 a[192:193],v6 offset:49152
 v_mfma_f32_16x16x32_bf16 a[24:27],a[228:231],v[216:219],a[24:27]
 s_add_u32 m0,s26,32768
 v_exp_f32 v116,v116
 v_mfma_f32_16x16x32_bf16 a[28:31],a[228:231],v[220:223],a[28:31]
 v_exp_f32 v117,v117
 v_mfma_f32_16x16x32_bf16 a[32:35],a[232:235],v[208:211],a[32:35]
 s_add_u32 s35,s30,128
 ds_read_b64_tr_b16 a[194:195],v6 offset:53248
 buffer_load_dwordx4 v34,s[4:7],s35 offen offset:0 lds
 v_mfma_f32_16x16x32_bf16 a[36:39],a[232:235],v[212:215],a[36:39]
 ds_read_b64_tr_b16 a[196:197],v7 offset:49152
 ds_read_b64_tr_b16 a[198:199],v7 offset:53248
 v_mfma_f32_16x16x32_bf16 a[40:43],a[232:235],v[216:219],a[40:43]
 s_add_u32 s35,s30,8320
 buffer_load_dwordx4 v35,s[4:7],s35 offen offset:1024 lds
 v_cvt_pk_bf16_f32 v201,v86,v87
 v_mfma_f32_16x16x32_bf16 a[44:47],a[232:235],v[220:223],a[44:47]
 v_exp_f32 v118,v118
 v_mfma_f32_16x16x32_bf16 a[48:51],a[236:239],v[208:211],a[48:51]
 s_add_u32 s35,s30,16512
 ds_read_b64_tr_b16 a[200:201],v8 offset:49152
 buffer_load_dwordx4 v34,s[4:7],s35 offen offset:2048 lds
 v_mfma_f32_16x16x32_bf16 a[52:55],a[236:239],v[212:215],a[52:55]
 v_exp_f32 v119,v119
 v_mfma_f32_16x16x32_bf16 a[56:59],a[236:239],v[216:219],a[56:59]
 s_add_u32 s35,s30,24704
 ds_read_b64_tr_b16 a[202:203],v8 offset:53248
 buffer_load_dwordx4 v35,s[4:7],s35 offen offset:3072 lds
 v_mfma_f32_16x16x32_bf16 a[60:63],a[236:239],v[220:223],a[60:63]
 ds_read_b64_tr_b16 a[204:205],v9 offset:49152
 v_cvt_pk_bf16_f32 v202,v116,v117
 v_mfma_f32_16x16x32_bf16 a[64:67],a[240:243],v[208:211],a[64:67]
 s_add_u32 m0,s26,36864
 v_exp_f32 v92,v92
 v_mfma_f32_16x16x32_bf16 a[68:71],a[240:243],v[212:215],a[68:71]
 s_add_u32 s35,s30,36992
 ds_read_b64_tr_b16 a[206:207],v9 offset:53248
 buffer_load_dwordx4 v34,s[4:7],s35 offen offset:0 lds
 v_mfma_f32_16x16x32_bf16 a[72:75],a[240:243],v[216:219],a[72:75]
 v_exp_f32 v93,v93
 v_mfma_f32_16x16x32_bf16 a[76:79],a[240:243],v[220:223],a[76:79]
 ds_read_b64_tr_b16 a[208:209],v10 offset:49152
 v_cvt_pk_bf16_f32 v203,v118,v119
 v_mfma_f32_16x16x32_bf16 a[80:83],a[244:247],v[208:211],a[80:83]
 s_add_u32 s35,s30,45184
 ds_read_b64_tr_b16 a[210:211],v10 offset:53248
 buffer_load_dwordx4 v35,s[4:7],s35 offen offset:1024 lds
 v_mfma_f32_16x16x32_bf16 a[84:87],a[244:247],v[212:215],a[84:87]
 v_exp_f32 v94,v94
 v_mfma_f32_16x16x32_bf16 a[88:91],a[244:247],v[216:219],a[88:91]
 s_add_u32 s35,s30,53376
 ds_read_b64_tr_b16 a[212:213],v11 offset:49152
 buffer_load_dwordx4 v34,s[4:7],s35 offen offset:2048 lds
 v_mfma_f32_16x16x32_bf16 a[92:95],a[244:247],v[220:223],a[92:95]
 ds_read_b64_tr_b16 a[214:215],v11 offset:53248
 ds_read_b64_tr_b16 a[216:217],v12 offset:49152
 v_mfma_f32_16x16x32_bf16 a[96:99],a[248:251],v[208:211],a[96:99]
 s_add_u32 s35,s30,61568
 ds_read_b64_tr_b16 a[218:219],v12 offset:53248
 buffer_load_dwordx4 v35,s[4:7],s35 offen offset:3072 lds
 v_mfma_f32_16x16x32_bf16 a[100:103],a[248:251],v[212:215],a[100:103]
 v_exp_f32 v95,v95
 v_mfma_f32_16x16x32_bf16 a[104:107],a[248:251],v[216:219],a[104:107]
 ds_read_b64_tr_b16 a[220:221],v13 offset:49152
 v_cvt_pk_bf16_f32 v204,v92,v93
 v_mfma_f32_16x16x32_bf16 a[108:111],a[248:251],v[220:223],a[108:111]
 v_exp_f32 v124,v124
 v_mfma_f32_16x16x32_bf16 a[112:115],a[252:255],v[208:211],a[112:115]
 v_exp_f32 v125,v125
 v_mfma_f32_16x16x32_bf16 a[116:119],a[252:255],v[212:215],a[116:119]
 ds_read_b64_tr_b16 a[222:223],v13 offset:53248
 v_cvt_pk_bf16_f32 v205,v94,v95
 v_mfma_f32_16x16x32_bf16 a[120:123],a[252:255],v[216:219],a[120:123]
 v_exp_f32 v126,v126
 v_mfma_f32_16x16x32_bf16 a[124:127],a[252:255],v[220:223],a[124:127]
 v_exp_f32 v127,v127
 v_mfma_f32_16x16x32_bf16 v[248:251],a[188:191],v[208:211],v[248:251]
 v_cvt_pk_bf16_f32 v206,v124,v125
 v_mfma_f32_16x16x32_bf16 v[240:243],a[188:191],v[212:215],v[240:243]
 v_mfma_f32_16x16x32_bf16 v[244:247],a[188:191],v[216:219],v[244:247]
 v_mfma_f32_16x16x32_bf16 v[56:59],a[188:191],v[220:223],v[56:59]
 s_waitcnt lgkmcnt(14)
 v_cvt_pk_bf16_f32 v207,v126,v127
 v_mfma_f32_16x16x32_bf16 a[0:3],a[192:195],v[192:195],a[0:3]
 v_exp_f32 v132,v132
 v_mfma_f32_16x16x32_bf16 a[4:7],a[192:195],v[196:199],a[4:7]
 ds_read_b64_tr_b16 a[224:225],v6 offset:57344
 ds_read_b64_tr_b16 a[226:227],v6 offset:61440
 v_mfma_f32_16x16x32_bf16 a[8:11],a[192:195],v[200:203],a[8:11]
 s_add_u32 m0,s25,98304
 v_exp_f32 v133,v133
 v_mfma_f32_16x16x32_bf16 a[12:15],a[192:195],v[204:207],a[12:15]
 s_waitcnt lgkmcnt(14)
 s_add_u32 s34,s29,524288
 ds_read_b64_tr_b16 a[228:229],v7 offset:57344
 buffer_load_dwordx4 v32,s[8:11],s34 offen offset:0 lds
 v_mfma_f32_16x16x32_bf16 a[16:19],a[196:199],v[192:195],a[16:19]
 v_exp_f32 v134,v134
 v_mfma_f32_16x16x32_bf16 a[20:23],a[196:199],v[196:199],a[20:23]
 ds_read_b64_tr_b16 a[230:231],v7 offset:61440
 ds_read_b64_tr_b16 a[232:233],v8 offset:57344
 v_mfma_f32_16x16x32_bf16 a[24:27],a[196:199],v[200:203],a[24:27]
 v_exp_f32 v135,v135
 v_mfma_f32_16x16x32_bf16 a[28:31],a[196:199],v[204:207],a[28:31]
 s_waitcnt lgkmcnt(15)
 ds_read_b64_tr_b16 a[234:235],v8 offset:61440
 v_cvt_pk_bf16_f32 v208,v132,v133
 v_mfma_f32_16x16x32_bf16 a[32:35],a[200:203],v[192:195],a[32:35]
 ds_read_b64_tr_b16 a[236:237],v9 offset:57344
 ds_read_b64_tr_b16 a[238:239],v9 offset:61440
 v_mfma_f32_16x16x32_bf16 a[36:39],a[200:203],v[196:199],a[36:39]
 v_exp_f32 v164,v164
 v_mfma_f32_16x16x32_bf16 a[40:43],a[200:203],v[200:203],a[40:43]
 s_add_u32 s34,s29,556032
 ds_read_b64_tr_b16 a[240:241],v10 offset:57344
 buffer_load_dwordx4 v32,s[8:11],s34 offen offset:1024 lds
 v_mfma_f32_16x16x32_bf16 a[44:47],a[200:203],v[204:207],a[44:47]
 s_waitcnt lgkmcnt(15)
 v_exp_f32 v165,v165
 v_mfma_f32_16x16x32_bf16 a[48:51],a[204:207],v[192:195],a[48:51]
 ds_read_b64_tr_b16 a[242:243],v10 offset:61440
 v_cvt_pk_bf16_f32 v209,v134,v135
 v_mfma_f32_16x16x32_bf16 a[52:55],a[204:207],v[196:199],a[52:55]
 ds_read_b64_tr_b16 a[244:245],v11 offset:57344
 ds_read_b64_tr_b16 a[246:247],v11 offset:61440
 v_mfma_f32_16x16x32_bf16 a[56:59],a[204:207],v[200:203],a[56:59]
 v_exp_f32 v166,v166
 v_mfma_f32_16x16x32_bf16 a[60:63],a[204:207],v[204:207],a[60:63]
 s_waitcnt lgkmcnt(15)
 v_exp_f32 v167,v167
 v_mfma_f32_16x16x32_bf16 a[64:67],a[208:211],v[192:195],a[64:67]
 ds_read_b64_tr_b16 a[248:249],v12 offset:57344
 v_cvt_pk_bf16_f32 v210,v164,v165
 v_mfma_f32_16x16x32_bf16 a[68:71],a[208:211],v[196:199],a[68:71]
 s_add_u32 s34,s29,587776
 ds_read_b64_tr_b16 a[250:251],v12 offset:61440
 buffer_load_dwordx4 v33,s[8:11],s34 offen offset:2048 lds
 v_mfma_f32_16x16x32_bf16 a[72:75],a[208:211],v[200:203],a[72:75]
 ds_read_b64_tr_b16 a[252:253],v13 offset:57344
 v_exp_f32 v140,v140
 v_mfma_f32_16x16x32_bf16 a[76:79],a[208:211],v[204:207],a[76:79]
 s_waitcnt lgkmcnt(15)
 v_exp_f32 v141,v141
 v_mfma_f32_16x16x32_bf16 a[80:83],a[212:215],v[192:195],a[80:83]
 ds_read_b64_tr_b16 a[254:255],v13 offset:61440
 v_cvt_pk_bf16_f32 v211,v166,v167
 v_mfma_f32_16x16x32_bf16 a[84:87],a[212:215],v[196:199],a[84:87]
 v_exp_f32 v142,v142
 v_mfma_f32_16x16x32_bf16 a[88:91],a[212:215],v[200:203],a[88:91]
 v_exp_f32 v143,v143
 v_mfma_f32_16x16x32_bf16 a[92:95],a[212:215],v[204:207],a[92:95]
 s_waitcnt lgkmcnt(15)
 s_add_u32 s34,s29,619520
 buffer_load_dwordx4 v33,s[8:11],s34 offen offset:3072 lds
 v_cvt_pk_bf16_f32 v212,v140,v141
 v_mfma_f32_16x16x32_bf16 a[96:99],a[216:219],v[192:195],a[96:99]
 v_exp_f32 v172,v172
 v_mfma_f32_16x16x32_bf16 a[100:103],a[216:219],v[196:199],a[100:103]
 v_exp_f32 v173,v173
 v_mfma_f32_16x16x32_bf16 a[104:107],a[216:219],v[200:203],a[104:107]
 s_waitcnt vmcnt(15)
 s_waitcnt lgkmcnt(0)
 s_barrier
 v_cvt_pk_bf16_f32 v213,v142,v143
 v_mfma_f32_16x16x32_bf16 a[108:111],a[216:219],v[204:207],a[108:111]
 v_exp_f32 v174,v174
 v_mfma_f32_16x16x32_bf16 a[112:115],a[220:223],v[192:195],a[112:115]
 v_exp_f32 v175,v175
 v_mfma_f32_16x16x32_bf16 a[116:119],a[220:223],v[196:199],a[116:119]
 ds_read_b128 a[128:131],v22 offset:0
 v_cvt_pk_bf16_f32 v214,v172,v173
 v_mfma_f32_16x16x32_bf16 a[120:123],a[220:223],v[200:203],a[120:123]
 v_exp_f32 v148,v148
 v_mfma_f32_16x16x32_bf16 a[124:127],a[220:223],v[204:207],a[124:127]
 v_exp_f32 v149,v149
 v_mfma_f32_16x16x32_bf16 v[248:251],a[188:191],v[192:195],v[248:251]
 ds_read_b128 a[144:147],v23 offset:0
 v_cvt_pk_bf16_f32 v215,v174,v175
 v_mfma_f32_16x16x32_bf16 v[240:243],a[188:191],v[196:199],v[240:243]
 v_exp_f32 v150,v150
 v_mfma_f32_16x16x32_bf16 v[244:247],a[188:191],v[200:203],v[244:247]
 ds_read_b128 a[132:135],v22 offset:2048
 ds_read_b128 a[148:151],v23 offset:2048
 v_mfma_f32_16x16x32_bf16 v[56:59],a[188:191],v[204:207],v[56:59]
 v_exp_f32 v151,v151
 v_mfma_f32_16x16x32_bf16 a[0:3],a[224:227],v[208:211],a[0:3]
 ds_read_b128 a[136:139],v22 offset:4096
 ds_read_b128 a[152:155],v23 offset:4096
 v_mfma_f32_16x16x32_bf16 a[16:19],a[228:231],v[208:211],a[16:19]
 ds_read_b128 a[140:143],v22 offset:6144
 ds_read_b128 a[156:159],v23 offset:6144
 v_mfma_f32_16x16x32_bf16 a[32:35],a[232:235],v[208:211],a[32:35]
 v_cvt_pk_bf16_f32 v216,v148,v149
 v_mfma_f32_16x16x32_bf16 a[48:51],a[236:239],v[208:211],a[48:51]
 v_exp_f32 v180,v180
 v_mfma_f32_16x16x32_bf16 a[64:67],a[240:243],v[208:211],a[64:67]
 v_exp_f32 v181,v181
 v_mfma_f32_16x16x32_bf16 a[80:83],a[244:247],v[208:211],a[80:83]
 ds_read_b64_tr_b16 a[192:193],v14 offset:16384
 v_cvt_pk_bf16_f32 v217,v150,v151
 v_mfma_f32_16x16x32_bf16 a[96:99],a[248:251],v[208:211],a[96:99]
 v_exp_f32 v182,v182
 v_mfma_f32_16x16x32_bf16 a[112:115],a[252:255],v[208:211],a[112:115]
 v_exp_f32 v183,v183
 v_mfma_f32_16x16x32_bf16 a[4:7],a[224:227],v[212:215],a[4:7]
 s_waitcnt lgkmcnt(1)
 s_add_u32 m0,s26,131072
 v_cvt_pk_bf16_f32 v218,v180,v181
 v_mfma_f32_16x16x32_bf16 a[20:23],a[228:231],v[212:215],a[20:23]
 v_exp_f32 v156,v156
 v_mfma_f32_16x16x32_bf16 a[36:39],a[232:235],v[212:215],a[36:39]
 s_add_u32 s35,s30,256
 ds_read_b64_tr_b16 a[194:195],v14 offset:17408
 buffer_load_dwordx4 v34,s[4:7],s35 offen offset:0 lds
 v_mfma_f32_16x16x32_bf16 a[52:55],a[236:239],v[212:215],a[52:55]
 v_exp_f32 v157,v157
 v_mfma_f32_16x16x32_bf16 a[68:71],a[240:243],v[212:215],a[68:71]
 s_add_u32 s35,s30,8448
 buffer_load_dwordx4 v35,s[4:7],s35 offen offset:1024 lds
 v_cvt_pk_bf16_f32 v219,v182,v183
 v_mfma_f32_16x16x32_bf16 a[84:87],a[244:247],v[212:215],a[84:87]
 v_exp_f32 v158,v158
 v_mfma_f32_16x16x32_bf16 a[100:103],a[248:251],v[212:215],a[100:103]
 v_exp_f32 v159,v159
 v_mfma_f32_16x16x32_bf16 a[116:119],a[252:255],v[212:215],a[116:119]
 ds_read_b64_tr_b16 a[196:197],v14 offset:24576
 v_cvt_pk_bf16_f32 v220,v156,v157
 v_mfma_f32_16x16x32_bf16 a[8:11],a[224:227],v[216:219],a[8:11]
 v_exp_f32 v188,v188
 v_mfma_f32_16x16x32_bf16 a[24:27],a[228:231],v[216:219],a[24:27]
 v_exp_f32 v189,v189
 v_mfma_f32_16x16x32_bf16 a[40:43],a[232:235],v[216:219],a[40:43]
 s_add_u32 s35,s30,16640
 buffer_load_dwordx4 v34,s[4:7],s35 offen offset:2048 lds
 v_cvt_pk_bf16_f32 v221,v158,v159
 v_mfma_f32_16x16x32_bf16 a[56:59],a[236:239],v[216:219],a[56:59]
 v_exp_f32 v190,v190
 v_mfma_f32_16x16x32_bf16 a[72:75],a[240:243],v[216:219],a[72:75]
 v_exp_f32 v191,v191
 v_mfma_f32_16x16x32_bf16 a[88:91],a[244:247],v[216:219],a[88:91]
 v_cvt_pk_bf16_f32 v222,v188,v189
 v_cvt_pk_bf16_f32 v223,v190,v191
 v_mfma_f32_16x16x32_bf16 a[104:107],a[248:251],v[216:219],a[104:107]
 s_add_u32 s35,s30,24832
 ds_read_b64_tr_b16 a[198:199],v14 offset:25600
 buffer_load_dwordx4 v35,s[4:7],s35 offen offset:3072 lds
 v_mfma_f32_16x16x32_bf16 a[120:123],a[252:255],v[216:219],a[120:123]
 s_add_u32 m0,s26,135168
 ds_read_b64_tr_b16 a[200:201],v15 offset:16384
 ds_read_b64_tr_b16 a[202:203],v15 offset:17408
 v_mfma_f32_16x16x32_bf16 v[248:251],a[188:191],v[208:211],v[248:251]
 s_add_u32 s35,s30,37120
 ds_read_b64_tr_b16 a[204:205],v15 offset:24576
 buffer_load_dwordx4 v34,s[4:7],s35 offen offset:0 lds
 v_mfma_f32_16x16x32_bf16 v[240:243],a[188:191],v[212:215],v[240:243]
 ds_read_b64_tr_b16 a[206:207],v15 offset:25600
 v_mfma_f32_16x16x32_bf16 v[244:247],a[188:191],v[216:219],v[244:247]
 ds_read_b64_tr_b16 a[208:209],v16 offset:16384
 v_mfma_f32_16x16x32_bf16 v[56:59],a[188:191],v[220:223],v[56:59]
 v_mfma_f32_16x16x32_bf16 a[12:15],a[224:227],v[220:223],a[12:15]
 s_add_u32 s35,s30,45312
 buffer_load_dwordx4 v35,s[4:7],s35 offen offset:1024 lds
 v_mfma_f32_16x16x32_bf16 a[28:31],a[228:231],v[220:223],a[28:31]
 ds_read_b64_tr_b16 a[210:211],v16 offset:17408
 v_mfma_f32_16x16x32_bf16 a[44:47],a[232:235],v[220:223],a[44:47]
 v_mfma_f32_16x16x32_bf16 a[60:63],a[236:239],v[220:223],a[60:63]
 s_add_u32 s35,s30,53504
 ds_read_b64_tr_b16 a[212:213],v16 offset:24576
 buffer_load_dwordx4 v34,s[4:7],s35 offen offset:2048 lds
 v_mfma_f32_16x16x32_bf16 a[76:79],a[240:243],v[220:223],a[76:79]
 v_mfma_f32_16x16x32_bf16 a[92:95],a[244:247],v[220:223],a[92:95]
 ds_read_b64_tr_b16 a[214:215],v16 offset:25600
 s_nop 0
 v_mfma_f32_16x16x32_bf16 a[108:111],a[248:251],v[220:223],a[108:111]
 s_add_u32 s35,s30,61696
 buffer_load_dwordx4 v35,s[4:7],s35 offen offset:3072 lds
 s_nop 0
 v_mfma_f32_16x16x32_bf16 a[124:127],a[252:255],v[220:223],a[124:127]
 s_mov_b32 s68,0x4e800000
 v_mov_b32 v249,v240
 v_mov_b32 v250,v244
 v_mov_b32 v251,v56
 v_add_f32 v41,v248,v249
 v_add_f32 v41,v41,v250
 v_add_f32 v41,v41,v251
 v_cmp_ngt_f32 vcc,s68,v41
 s_nop 0
 s_cbranch_vccnz K1_slow
K1_back:
 v_rcp_f32 v248,v248
 v_rcp_f32 v249,v249
 v_rcp_f32 v250,v250
 v_rcp_f32 v251,v251
 s_mov_b32 s27,294912
 s_waitcnt lgkmcnt(10)
 v_mfma_f32_16x16x32_bf16 v[64:67],a[192:195],a[128:131],0
 s_waitcnt lgkmcnt(8)
 ds_read_b64_tr_b16 a[216:217],v17 offset:16384
 v_accvgpr_read_b32 v40,a0
 v_mfma_f32_16x16x32_bf16 v[64:67],a[196:199],a[144:147],v[64:67]
 s_waitcnt lgkmcnt(7)
 s_add_u32 m0,s25,114688
 ds_read_b64_tr_b16 a[218:219],v17 offset:17408
 v_accvgpr_read_b32 v41,a1
 v_mfma_f32_16x16x32_bf16 v[68:71],a[200:203],a[128:131],0
 s_waitcnt lgkmcnt(6)
 s_add_u32 s34,s29,1048576
 buffer_load_dwordx4 v32,s[8:11],s34 offen offset:0 lds
 v_accvgpr_read_b32 v42,a2
 v_accvgpr_read_b32 v43,a3
 v_mfma_f32_16x16x32_bf16 v[68:71],a[204:207],a[144:147],v[68:71]
 ds_read_b64_tr_b16 a[220:221],v17 offset:24576
 v_accvgpr_read_b32 v44,a16
 v_mfma_f32_16x16x32_bf16 v[72:75],a[192:195],a[132:135],0
 ds_read_b64_tr_b16 a[222:223],v17 offset:25600
 v_accvgpr_read_b32 v45,a17
 v_mfma_f32_16x16x32_bf16 v[72:75],a[196:199],a[148:151],v[72:75]
 ds_read_b64_tr_b16 a[224:225],v18 offset:16384
 v_accvgpr_read_b32 v46,a18
 v_mfma_f32_16x16x32_bf16 v[76:79],a[200:203],a[132:135],0
 s_add_u32 s34,s29,1080320
 ds_read_b64_tr_b16 a[226:227],v18 offset:17408
 buffer_load_dwordx4 v32,s[8:11],s34 offen offset:1024 lds
 v_accvgpr_read_b32 v47,a19
 v_mfma_f32_16x16x32_bf16 v[76:79],a[204:207],a[148:151],v[76:79]
 v_mul_f32 v40,v248,v40
 v_mul_f32 v41,v248,v41
 v_mfma_f32_16x16x32_bf16 v[80:83],a[192:195],a[136:139],0
 ds_read_b64_tr_b16 a[228:229],v18 offset:24576
 v_mul_f32 v42,v248,v42
 v_mfma_f32_16x16x32_bf16 v[80:83],a[196:199],a[152:155],v[80:83]
 ds_read_b64_tr_b16 a[230:231],v18 offset:25600
 v_mul_f32 v43,v248,v43
 v_mfma_f32_16x16x32_bf16 v[84:87],a[200:203],a[136:139],0
 s_waitcnt vmcnt(14)
 ds_read_b128 a[160:163],v24 offset:0
 v_mul_f32 v44,v248,v44
 v_mul_f32 v45,v248,v45
 v_mfma_f32_16x16x32_bf16 v[84:87],a[204:207],a[152:155],v[84:87]
 ds_read_b128 a[176:179],v25 offset:0
 v_mul_f32 v46,v248,v46
 v_mfma_f32_16x16x32_bf16 v[88:91],a[192:195],a[140:143],0
 ds_read_b128 a[164:167],v24 offset:2048
 v_mul_f32 v47,v248,v47
 v_mfma_f32_16x16x32_bf16 v[88:91],a[196:199],a[156:159],v[88:91]
 s_add_u32 s34,s29,1112064
 buffer_load_dwordx4 v33,s[8:11],s34 offen offset:2048 lds
 v_cvt_pk_bf16_f32 v192,v40,v41
 v_mfma_f32_16x16x32_bf16 v[92:95],a[200:203],a[140:143],0
 ds_read_b128 a[180:183],v25 offset:2048
 v_cvt_pk_bf16_f32 v193,v42,v43
 v_cvt_pk_bf16_f32 v194,v44,v45
 v_mfma_f32_16x16x32_bf16 v[92:95],a[204:207],a[156:159],v[92:95]
 s_waitcnt lgkmcnt(14)
 ds_read_b128 a[168:171],v24 offset:4096
 v_cvt_pk_bf16_f32 v195,v46,v47
 v_mfma_f32_16x16x32_bf16 v[96:99],a[208:211],a[128:131],0
 s_waitcnt lgkmcnt(13)
 ds_read_b128 a[184:187],v25 offset:4096
 v_accvgpr_read_b32 v40,a32
 v_mfma_f32_16x16x32_bf16 v[96:99],a[212:215],a[144:147],v[96:99]
 s_waitcnt lgkmcnt(12)
 s_add_u32 s34,s29,1143808
 buffer_load_dwordx4 v33,s[8:11],s34 offen offset:3072 lds
 v_accvgpr_read_b32 v41,a33
 v_mfma_f32_16x16x32_bf16 v[100:103],a[216:219],a[128:131],0
 s_waitcnt lgkmcnt(10)
 ds_read_b128 a[172:175],v24 offset:6144
 v_accvgpr_read_b32 v42,a34
 v_mfma_f32_16x16x32_bf16 v[100:103],a[220:223],a[144:147],v[100:103]
 ds_read_b128 a[188:191],v25 offset:6144
 v_accvgpr_read_b32 v43,a35
 v_mfma_f32_16x16x32_bf16 v[104:107],a[208:211],a[132:135],0
 v_accvgpr_read_b32 v44,a48
 v_accvgpr_read_b32 v45,a49
 v_mfma_f32_16x16x32_bf16 v[104:107],a[212:215],a[148:151],v[104:107]
 ds_read_b64_tr_b16 a[232:233],v19 offset:16384
 v_accvgpr_read_b32 v46,a50
 v_mfma_f32_16x16x32_bf16 v[108:111],a[216:219],a[132:135],0
 ds_read_b64_tr_b16 a[234:235],v19 offset:17408
 v_accvgpr_read_b32 v47,a51
 v_mfma_f32_16x16x32_bf16 v[108:111],a[220:223],a[148:151],v[108:111]
 ds_read_b64_tr_b16 a[236:237],v19 offset:24576
 v_mul_f32 v40,v248,v40
 v_mfma_f32_16x16x32_bf16 v[112:115],a[208:211],a[136:139],0
 v_mul_f32 v41,v248,v41
 v_mul_f32 v42,v248,v42
 v_mfma_f32_16x16x32_bf16 v[112:115],a[212:215],a[152:155],v[112:115]
 ds_read_b64_tr_b16 a[238:239],v19 offset:25600
 v_mul_f32 v43,v248,v43
 v_mfma_f32_16x16x32_bf16 v[116:119],a[216:219],a[136:139],0
 ds_read_b64_tr_b16 a[240:241],v20 offset:16384
 s_waitcnt lgkmcnt(5)
 s_add_u32 m0,s26,32768
 v_mul_f32 v44,v248,v44
 v_mfma_f32_16x16x32_bf16 v[116:119],a[220:223],a[152:155],v[116:119]
 s_add_u32 s35,s30,384
 buffer_load_dwordx4 v34,s[4:7],s35 offen offset:0 lds
 v_mul_f32 v45,v248,v45
 v_mfma_f32_16x16x32_bf16 v[120:123],a[208:211],a[140:143],0
 v_mul_f32 v46,v248,v46
 v_mul_f32 v47,v248,v47
 v_mfma_f32_16x16x32_bf16 v[120:123],a[212:215],a[156:159],v[120:123]
 ds_read_b64_tr_b16 a[242:243],v20 offset:17408
 v_cvt_pk_bf16_f32 v196,v40,v41
 v_mfma_f32_16x16x32_bf16 v[124:127],a[216:219],a[140:143],0
 s_add_u32 s35,s30,8576
 buffer_load_dwordx4 v35,s[4:7],s35 offen offset:1024 lds
 v_cvt_pk_bf16_f32 v197,v42,v43
 v_mfma_f32_16x16x32_bf16 v[124:127],a[220:223],a[156:159],v[124:127]
 ds_read_b64_tr_b16 a[244:245],v20 offset:24576
 v_cvt_pk_bf16_f32 v198,v44,v45
 v_mfma_f32_16x16x32_bf16 v[128:131],a[224:227],a[128:131],0
 ds_read_b64_tr_b16 a[246:247],v20 offset:25600
 v_cvt_pk_bf16_f32 v199,v46,v47
 v_mfma_f32_16x16x32_bf16 v[128:131],a[228:231],a[144:147],v[128:131]
 s_waitcnt lgkmcnt(6)
 ds_read_b64_tr_b16 a[248:249],v21 offset:16384
 v_accvgpr_read_b32 v40,a64
 v_accvgpr_read_b32 v41,a65
 v_mfma_f32_16x16x32_bf16 v[132:135],a[232:235],a[128:131],0
 s_waitcnt lgkmcnt(5)
 ds_read_b64_tr_b16 a[250:251],v21 offset:17408
 v_accvgpr_read_b32 v42,a66
 v_mfma_f32_16x16x32_bf16 v[132:135],a[236:239],a[144:147],v[132:135]
 ds_read_b64_tr_b16 a[252:253],v21 offset:24576
 v_accvgpr_read_b32 v43,a67
 v_mfma_f32_16x16x32_bf16 v[136:139],a[224:227],a[132:135],0
 ds_read_b64_tr_b16 a[254:255],v21 offset:25600
 v_accvgpr_read_b32 v44,a80
 v_mfma_f32_16x16x32_bf16 v[136:139],a[228:231],a[148:151],v[136:139]
 s_add_u32 s35,s30,16768
 buffer_load_dwordx4 v34,s[4:7],s35 offen offset:2048 lds
 v_accvgpr_read_b32 v45,a81
 v_mfma_f32_16x16x32_bf16 v[140:143],a[232:235],a[132:135],0
 v_accvgpr_read_b32 v46,a82
 v_accvgpr_read_b32 v47,a83
 v_mfma_f32_16x16x32_bf16 v[140:143],a[236:239],a[148:151],v[140:143]
 v_mul_f32 v40,v248,v40
 v_mul_f32 v41,v248,v41
 v_mfma_f32_16x16x32_bf16 v[144:147],a[224:227],a[136:139],0
 v_mul_f32 v42,v248,v42
 v_mul_f32 v43,v248,v43
 v_mfma_f32_16x16x32_bf16 v[144:147],a[228:231],a[152:155],v[144:147]
 s_add_u32 s35,s30,24960
 buffer_load_dwordx4 v35,s[4:7],s35 offen offset:3072 lds
 v_mul_f32 v44,v248,v44
 v_mfma_f32_16x16x32_bf16 v[148:151],a[232:235],a[136:139],0
 s_waitcnt vmcnt(16)
 s_waitcnt lgkmcnt(0)
 s_barrier
 v_mul_f32 v45,v248,v45
 v_mfma_f32_16x16x32_bf16 v[148:151],a[236:239],a[152:155],v[148:151]
 ds_read_b64_tr_b16 a[192:193],v14 offset:32768
 v_mul_f32 v46,v248,v46
 v_mfma_f32_16x16x32_bf16 v[152:155],a[224:227],a[140:143],0
 ds_read_b64_tr_b16 a[194:195],v14 offset:33792
 v_mul_f32 v47,v248,v47
 v_mfma_f32_16x16x32_bf16 v[152:155],a[228:231],a[156:159],v[152:155]
 s_add_u32 m0,s26,36864
 v_cvt_pk_bf16_f32 v200,v40,v41
 v_cvt_pk_bf16_f32 v201,v42,v43
 v_mfma_f32_16x16x32_bf16 v[156:159],a[232:235],a[140:143],0
 s_add_u32 s35,s30,37248
 ds_read_b64_tr_b16 a[196:197],v14 offset:40960
 buffer_load_dwordx4 v34,s[4:7],s35 offen offset:0 lds
 v_mfma_f32_16x16x32_bf16 v[156:159],a[236:239],a[156:159],v[156:159]
 v_cvt_pk_bf16_f32 v202,v44,v45
 v_cvt_pk_bf16_f32 v203,v46,v47
 v_mfma_f32_16x16x32_bf16 v[160:163],a[240:243],a[128:131],0
 ds_read_b64_tr_b16 a[198:199],v14 offset:41984
 v_accvgpr_read_b32 v40,a96
 v_mfma_f32_16x16x32_bf16 v[160:163],a[244:247],a[144:147],v[160:163]
 ds_read_b64_tr_b16 a[200:201],v15 offset:32768
 v_accvgpr_read_b32 v41,a97
 v_mfma_f32_16x16x32_bf16 v[164:167],a[248:251],a[128:131],0
 v_accvgpr_read_b32 v42,a98
 v_accvgpr_read_b32 v43,a99
 v_mfma_f32_16x16x32_bf16 v[164:167],a[252:255],a[144:147],v[164:167]
 ds_read_b64_tr_b16 a[202:203],v15 offset:33792
 v_accvgpr_read_b32 v44,a112
 v_mfma_f32_16x16x32_bf16 v[168:171],a[240:243],a[132:135],0
 v_accvgpr_read_b32 v45,a113
 v_accvgpr_read_b32 v46,a114
 v_mfma_f32_16x16x32_bf16 v[168:171],a[244:247],a[148:151],v[168:171]
 s_add_u32 s35,s30,45440
 ds_read_b64_tr_b16 a[204:205],v15 offset:40960
 buffer_load_dwordx4 v35,s[4:7],s35 offen offset:1024 lds
 v_mfma_f32_16x16x32_bf16 v[172:175],a[248:251],a[132:135],0
 v_accvgpr_read_b32 v47,a115
 v_mul_f32 v40,v248,v40
 v_mfma_f32_16x16x32_bf16 v[172:175],a[252:255],a[148:151],v[172:175]
 ds_read_b64_tr_b16 a[206:207],v15 offset:41984
 v_mul_f32 v41,v248,v41
 v_mfma_f32_16x16x32_bf16 v[176:179],a[240:243],a[136:139],0
 ds_read_b64_tr_b16 a[208:209],v16 offset:32768
 v_mul_f32 v42,v248,v42
 v_mfma_f32_16x16x32_bf16 v[176:179],a[244:247],a[152:155],v[176:179]
 s_add_u32 s35,s30,53632
 buffer_load_dwordx4 v34,s[4:7],s35 offen offset:2048 lds
 v_mul_f32 v43,v248,v43
 v_mfma_f32_16x16x32_bf16 v[180:183],a[248:251],a[136:139],0
 ds_read_b64_tr_b16 a[210:211],v16 offset:33792
 v_mul_f32 v44,v248,v44
 v_mfma_f32_16x16x32_bf16 v[180:183],a[252:255],a[152:155],v[180:183]
 v_mul_f32 v45,v248,v45
 v_mul_f32 v46,v248,v46
 v_mfma_f32_16x16x32_bf16 v[184:187],a[240:243],a[140:143],0
 ds_read_b64_tr_b16 a[212:213],v16 offset:40960
 v_mul_f32 v47,v248,v47
 v_mfma_f32_16x16x32_bf16 v[184:187],a[244:247],a[156:159],v[184:187]
 ds_read_b64_tr_b16 a[214:215],v16 offset:41984
 v_cvt_pk_bf16_f32 v204,v40,v41
 v_mfma_f32_16x16x32_bf16 v[188:191],a[248:251],a[140:143],0
 s_add_u32 s35,s30,61824
 buffer_load_dwordx4 v35,s[4:7],s35 offen offset:3072 lds
 v_cvt_pk_bf16_f32 v205,v42,v43
 v_mfma_f32_16x16x32_bf16 v[188:191],a[252:255],a[156:159],v[188:191]
 s_waitcnt lgkmcnt(10)
 v_cvt_pk_bf16_f32 v206,v44,v45
 v_cvt_pk_bf16_f32 v207,v46,v47
 v_mfma_f32_16x16x32_bf16 v[64:67],a[192:195],a[160:163],v[64:67]
 s_waitcnt lgkmcnt(8)
 ds_read_b64_tr_b16 a[216:217],v17 offset:32768
 v_accvgpr_read_b32 v40,a4
 v_mfma_f32_16x16x32_bf16 v[64:67],a[196:199],a[176:179],v[64:67]
 s_waitcnt lgkmcnt(7)
 s_add_u32 m0,s25,81920
 ds_read_b64_tr_b16 a[218:219],v17 offset:33792
 v_accvgpr_read_b32 v41,a5
 v_mfma_f32_16x16x32_bf16 v[68:71],a[200:203],a[160:163],v[68:71]
 s_waitcnt lgkmcnt(6)
 s_add_u32 s34,s29,1572864
 buffer_load_dwordx4 v32,s[8:11],s34 offen offset:0 lds
 v_accvgpr_read_b32 v42,a6
 v_accvgpr_read_b32 v43,a7
 v_mfma_f32_16x16x32_bf16 v[68:71],a[204:207],a[176:179],v[68:71]
 ds_read_b64_tr_b16 a[220:221],v17 offset:40960
 v_accvgpr_read_b32 v44,a20
 v_mfma_f32_16x16x32_bf16 v[72:75],a[192:195],a[164:167],v[72:75]
 ds_read_b64_tr_b16 a[222:223],v17 offset:41984
 v_accvgpr_read_b32 v45,a21
 v_mfma_f32_16x16x32_bf16 v[72:75],a[196:199],a[180:183],v[72:75]
 ds_read_b64_tr_b16 a[224:225],v18 offset:32768
 v_accvgpr_read_b32 v46,a22
 v_mfma_f32_16x16x32_bf16 v[76:79],a[200:203],a[164:167],v[76:79]
 s_add_u32 s34,s29,1604608
 ds_read_b64_tr_b16 a[226:227],v18 offset:33792
 buffer_load_dwordx4 v32,s[8:11],s34 offen offset:1024 lds
 v_accvgpr_read_b32 v47,a23
 v_mfma_f32_16x16x32_bf16 v[76:79],a[204:207],a[180:183],v[76:79]
 v_mul_f32 v40,v249,v40
 v_mul_f32 v41,v249,v41
 v_mfma_f32_16x16x32_bf16 v[80:83],a[192:195],a[168:171],v[80:83]
 ds_read_b64_tr_b16 a[228:229],v18 offset:40960
 v_mul_f32 v42,v249,v42
 v_mfma_f32_16x16x32_bf16 v[80:83],a[196:199],a[184:187],v[80:83]
 s_add_u32 s34,s29,1636352
 ds_read_b64_tr_b16 a[230:231],v18 offset:41984
 buffer_load_dwordx4 v33,s[8:11],s34 offen offset:2048 lds
 v_mul_f32 v43,v249,v43
 v_mfma_f32_16x16x32_bf16 v[84:87],a[200:203],a[168:171],v[84:87]
 s_waitcnt vmcnt(15)
 ds_read_b128 a[128:131],v22 offset:0
 v_mul_f32 v44,v249,v44
 v_mul_f32 v45,v249,v45
 v_mfma_f32_16x16x32_bf16 v[84:87],a[204:207],a[184:187],v[84:87]
 ds_read_b128 a[144:147],v23 offset:0
 v_mul_f32 v46,v249,v46
 v_mfma_f32_16x16x32_bf16 v[88:91],a[192:195],a[172:175],v[88:91]
 ds_read_b128 a[132:135],v22 offset:2048
 v_mul_f32 v47,v249,v47
 v_mfma_f32_16x16x32_bf16 v[88:91],a[196:199],a[188:191],v[88:91]
 s_add_u32 s34,s29,1668096
 buffer_load_dwordx4 v33,s[8:11],s34 offen offset:3072 lds
 v_cvt_pk_bf16_f32 v208,v40,v41
 v_mfma_f32_16x16x32_bf16 v[92:95],a[200:203],a[172:175],v[92:95]
 ds_read_b128 a[148:151],v23 offset:2048
 v_cvt_pk_bf16_f32 v209,v42,v43
 v_cvt_pk_bf16_f32 v210,v44,v45
 v_mfma_f32_16x16x32_bf16 v[92:95],a[204:207],a[188:191],v[92:95]
 s_waitcnt lgkmcnt(14)
 ds_read_b128 a[136:139],v22 offset:4096
 v_cvt_pk_bf16_f32 v211,v46,v47
 v_mfma_f32_16x16x32_bf16 v[96:99],a[208:211],a[160:163],v[96:99]
 s_waitcnt lgkmcnt(13)
 ds_read_b128 a[152:155],v23 offset:4096
 v_accvgpr_read_b32 v40,a36
 v_mfma_f32_16x16x32_bf16 v[96:99],a[212:215],a[176:179],v[96:99]
 s_waitcnt lgkmcnt(12)
 v_accvgpr_read_b32 v41,a37
 v_accvgpr_read_b32 v42,a38
 v_mfma_f32_16x16x32_bf16 v[100:103],a[216:219],a[160:163],v[100:103]
 s_waitcnt lgkmcnt(10)
 ds_read_b128 a[140:143],v22 offset:6144
 v_accvgpr_read_b32 v43,a39
 v_mfma_f32_16x16x32_bf16 v[100:103],a[220:223],a[176:179],v[100:103]
 s_add_u32 s38,s31,0
 ds_read_b128 a[156:159],v23 offset:6144
 buffer_store_dwordx4 v[192:195],v36,s[20:23],s38 offen offset:0 sc0 sc1
 v_accvgpr_read_b32 v44,a52
 v_mfma_f32_16x16x32_bf16 v[104:107],a[208:211],a[164:167],v[104:107]
 ds_read_b64_tr_b16 a[232:233],v19 offset:32768
 v_accvgpr_read_b32 v45,a53
 v_mfma_f32_16x16x32_bf16 v[104:107],a[212:215],a[180:183],v[104:107]
 s_add_u32 s38,s31,0
 ds_read_b64_tr_b16 a[234:235],v19 offset:33792
 buffer_store_dwordx4 v[196:199],v36,s[20:23],s38 offen offset:1024 sc0 sc1
 v_accvgpr_read_b32 v46,a54
 v_mfma_f32_16x16x32_bf16 v[108:111],a[216:219],a[164:167],v[108:111]
 v_accvgpr_read_b32 v47,a55
 v_mul_f32 v40,v249,v40
 v_mfma_f32_16x16x32_bf16 v[108:111],a[220:223],a[180:183],v[108:111]
 ds_read_b64_tr_b16 a[236:237],v19 offset:40960
 v_mul_f32 v41,v249,v41
 v_mfma_f32_16x16x32_bf16 v[112:115],a[208:211],a[168:171],v[112:115]
 ds_read_b64_tr_b16 a[238:239],v19 offset:41984
 v_mul_f32 v42,v249,v42
 v_mfma_f32_16x16x32_bf16 v[112:115],a[212:215],a[184:187],v[112:115]
 s_add_u32 s38,s31,0
 ds_read_b64_tr_b16 a[240:241],v20 offset:32768
 buffer_store_dwordx4 v[200:203],v36,s[20:23],s38 offen offset:2048 sc0 sc1
 v_mul_f32 v43,v249,v43
 v_mfma_f32_16x16x32_bf16 v[116:119],a[216:219],a[168:171],v[116:119]
 v_mul_f32 v44,v249,v44
 v_mul_f32 v45,v249,v45
 v_mfma_f32_16x16x32_bf16 v[116:119],a[220:223],a[184:187],v[116:119]
 ds_read_b64_tr_b16 a[242:243],v20 offset:33792
 v_mul_f32 v46,v249,v46
 v_mfma_f32_16x16x32_bf16 v[120:123],a[208:211],a[172:175],v[120:123]
 ds_read_b64_tr_b16 a[244:245],v20 offset:40960
 v_mul_f32 v47,v249,v47
 v_mfma_f32_16x16x32_bf16 v[120:123],a[212:215],a[188:191],v[120:123]
 s_add_u32 s38,s31,0
 ds_read_b64_tr_b16 a[246:247],v20 offset:41984
 buffer_store_dwordx4 v[204:207],v36,s[20:23],s38 offen offset:3072 sc0 sc1
 v_cvt_pk_bf16_f32 v212,v40,v41
 v_mfma_f32_16x16x32_bf16 v[124:127],a[216:219],a[172:175],v[124:127]
 ds_read_b64_tr_b16 a[248:249],v21 offset:32768
 s_waitcnt lgkmcnt(9)
 s_add_u32 m0,s26,131072
 v_cvt_pk_bf16_f32 v213,v42,v43
 v_mfma_f32_16x16x32_bf16 v[124:127],a[220:223],a[188:191],v[124:127]
 v_cvt_pk_bf16_f32 v214,v44,v45
 v_cvt_pk_bf16_f32 v215,v46,v47
 v_mfma_f32_16x16x32_bf16 v[128:131],a[224:227],a[160:163],v[128:131]
 ds_read_b64_tr_b16 a[250:251],v21 offset:33792
 v_accvgpr_read_b32 v40,a68
 v_mfma_f32_16x16x32_bf16 v[128:131],a[228:231],a[176:179],v[128:131]
 s_waitcnt lgkmcnt(8)
 ds_read_b64_tr_b16 a[252:253],v21 offset:40960
 v_accvgpr_read_b32 v41,a69
 v_mfma_f32_16x16x32_bf16 v[132:135],a[232:235],a[160:163],v[132:135]
 s_waitcnt lgkmcnt(7)
 s_add_u32 s35,s30,512
 buffer_load_dwordx4 v34,s[4:7],s35 offen offset:0 lds
 v_mfma_f32_16x16x32_bf16 v[132:135],a[236:239],a[176:179],v[132:135]
 v_accvgpr_read_b32 v42,a70
 v_accvgpr_read_b32 v43,a71
 v_mfma_f32_16x16x32_bf16 v[136:139],a[224:227],a[164:167],v[136:139]
 ds_read_b64_tr_b16 a[254:255],v21 offset:41984
 v_accvgpr_read_b32 v44,a84
 v_mfma_f32_16x16x32_bf16 v[136:139],a[228:231],a[180:183],v[136:139]
 v_accvgpr_read_b32 v45,a85
 v_accvgpr_read_b32 v46,a86
 v_mfma_f32_16x16x32_bf16 v[140:143],a[232:235],a[164:167],v[140:143]
 s_add_u32 s35,s30,8704
 buffer_load_dwordx4 v35,s[4:7],s35 offen offset:1024 lds
 v_accvgpr_read_b32 v47,a87
 v_mfma_f32_16x16x32_bf16 v[140:143],a[236:239],a[180:183],v[140:143]
 v_mul_f32 v40,v249,v40
 v_mul_f32 v41,v249,v41
 v_mfma_f32_16x16x32_bf16 v[144:147],a[224:227],a[168:171],v[144:147]
 v_mul_f32 v42,v249,v42
 v_mul_f32 v43,v249,v43
 v_mfma_f32_16x16x32_bf16 v[144:147],a[228:231],a[184:187],v[144:147]
 s_add_u32 s35,s30,16896
 buffer_load_dwordx4 v34,s[4:7],s35 offen offset:2048 lds
 v_mul_f32 v44,v249,v44
 v_mfma_f32_16x16x32_bf16 v[148:151],a[232:235],a[168:171],v[148:151]
 s_waitcnt vmcnt(19)
 s_waitcnt lgkmcnt(0)
 s_barrier
 v_mul_f32 v45,v249,v45
 v_mfma_f32_16x16x32_bf16 v[148:151],a[236:239],a[184:187],v[148:151]
 ds_read_b64_tr_b16 a[192:193],v14 offset:49152
 v_mul_f32 v46,v249,v46
 v_mfma_f32_16x16x32_bf16 v[152:155],a[224:227],a[172:175],v[152:155]
 ds_read_b64_tr_b16 a[194:195],v14 offset:50176
 v_mul_f32 v47,v249,v47
 v_mfma_f32_16x16x32_bf16 v[152:155],a[228:231],a[188:191],v[152:155]
 s_add_u32 s35,s30,25088
 buffer_load_dwordx4 v35,s[4:7],s35 offen offset:3072 lds
 v_cvt_pk_bf16_f32 v216,v40,v41
 v_mfma_f32_16x16x32_bf16 v[156:159],a[232:235],a[172:175],v[156:159]
 ds_read_b64_tr_b16 a[196:197],v14 offset:57344
 v_cvt_pk_bf16_f32 v217,v42,v43
 v_mfma_f32_16x16x32_bf16 v[156:159],a[236:239],a[188:191],v[156:159]
 v_cvt_pk_bf16_f32 v218,v44,v45
 v_cvt_pk_bf16_f32 v219,v46,v47
 v_mfma_f32_16x16x32_bf16 v[160:163],a[240:243],a[160:163],v[160:163]
 s_add_u32 m0,s26,135168
 ds_read_b64_tr_b16 a[198:199],v14 offset:58368
 v_accvgpr_read_b32 v40,a100
 v_mfma_f32_16x16x32_bf16 v[160:163],a[244:247],a[176:179],v[160:163]
 ds_read_b64_tr_b16 a[200:201],v15 offset:49152
 v_accvgpr_read_b32 v41,a101
 v_mfma_f32_16x16x32_bf16 v[164:167],a[248:251],a[160:163],v[164:167]
 s_add_u32 s35,s30,37376
 buffer_load_dwordx4 v34,s[4:7],s35 offen offset:0 lds
 v_accvgpr_read_b32 v42,a102
 v_accvgpr_read_b32 v43,a103
 v_mfma_f32_16x16x32_bf16 v[164:167],a[252:255],a[176:179],v[164:167]
 ds_read_b64_tr_b16 a[202:203],v15 offset:50176
 v_accvgpr_read_b32 v44,a116
 v_mfma_f32_16x16x32_bf16 v[168:171],a[240:243],a[164:167],v[168:171]
 v_accvgpr_read_b32 v45,a117
 v_accvgpr_read_b32 v46,a118
 v_mfma_f32_16x16x32_bf16 v[168:171],a[244:247],a[180:183],v[168:171]
 s_add_u32 s35,s30,45568
 ds_read_b64_tr_b16 a[204:205],v15 offset:57344
 buffer_load_dwordx4 v35,s[4:7],s35 offen offset:1024 lds
 v_mfma_f32_16x16x32_bf16 v[172:175],a[248:251],a[164:167],v[172:175]
 v_accvgpr_read_b32 v47,a119
 v_mul_f32 v40,v249,v40
 v_mfma_f32_16x16x32_bf16 v[172:175],a[252:255],a[180:183],v[172:175]
 ds_read_b64_tr_b16 a[206:207],v15 offset:58368
 v_mul_f32 v41,v249,v41
 v_mfma_f32_16x16x32_bf16 v[176:179],a[240:243],a[168:171],v[176:179]
 ds_read_b64_tr_b16 a[208:209],v16 offset:49152
 v_mul_f32 v42,v249,v42
 v_mfma_f32_16x16x32_bf16 v[176:179],a[244:247],a[184:187],v[176:179]
 v_mul_f32 v43,v249,v43
 v_mul_f32 v44,v249,v44
 v_mfma_f32_16x16x32_bf16 v[180:183],a[248:251],a[168:171],v[180:183]
 s_add_u32 s35,s30,53760
 ds_read_b64_tr_b16 a[210:211],v16 offset:50176
 buffer_load_dwordx4 v34,s[4:7],s35 offen offset:2048 lds
 v_mfma_f32_16x16x32_bf16 v[180:183],a[252:255],a[184:187],v[180:183]
 v_mul_f32 v45,v249,v45
 v_mul_f32 v46,v249,v46
 v_mfma_f32_16x16x32_bf16 v[184:187],a[240:243],a[172:175],v[184:187]
 ds_read_b64_tr_b16 a[212:213],v16 offset:57344
 v_mul_f32 v47,v249,v47
 v_mfma_f32_16x16x32_bf16 v[184:187],a[244:247],a[188:191],v[184:187]
 ds_read_b64_tr_b16 a[214:215],v16 offset:58368
 v_cvt_pk_bf16_f32 v220,v40,v41
 v_mfma_f32_16x16x32_bf16 v[188:191],a[248:251],a[172:175],v[188:191]
 s_add_u32 s35,s30,61952
 buffer_load_dwordx4 v35,s[4:7],s35 offen offset:3072 lds
 v_cvt_pk_bf16_f32 v221,v42,v43
 v_mfma_f32_16x16x32_bf16 v[188:191],a[252:255],a[188:191],v[188:191]
 s_waitcnt lgkmcnt(10)
 v_cvt_pk_bf16_f32 v222,v44,v45
 v_cvt_pk_bf16_f32 v223,v46,v47
 v_mfma_f32_16x16x32_bf16 v[64:67],a[192:195],a[128:131],v[64:67]
 s_waitcnt lgkmcnt(8)
 ds_read_b64_tr_b16 a[216:217],v17 offset:49152
 v_accvgpr_read_b32 v40,a8
 v_mfma_f32_16x16x32_bf16 v[64:67],a[196:199],a[144:147],v[64:67]
 s_waitcnt lgkmcnt(7)
 s_add_u32 m0,s25,98304
 ds_read_b64_tr_b16 a[218:219],v17 offset:50176
 v_accvgpr_read_b32 v41,a9
 v_mfma_f32_16x16x32_bf16 v[68:71],a[200:203],a[128:131],v[68:71]
 s_waitcnt lgkmcnt(6)
 s_add_u32 s34,s29,2097152
 buffer_load_dwordx4 v32,s[8:11],s34 offen offset:0 lds
 v_accvgpr_read_b32 v42,a10
 v_accvgpr_read_b32 v43,a11
 v_mfma_f32_16x16x32_bf16 v[68:71],a[204:207],a[144:147],v[68:71]
 ds_read_b64_tr_b16 a[220:221],v17 offset:57344
 v_accvgpr_read_b32 v44,a24
 v_mfma_f32_16x16x32_bf16 v[72:75],a[192:195],a[132:135],v[72:75]
 ds_read_b64_tr_b16 a[222:223],v17 offset:58368
 v_accvgpr_read_b32 v45,a25
 v_mfma_f32_16x16x32_bf16 v[72:75],a[196:199],a[148:151],v[72:75]
 ds_read_b64_tr_b16 a[224:225],v18 offset:49152
 v_accvgpr_read_b32 v46,a26
 v_mfma_f32_16x16x32_bf16 v[76:79],a[200:203],a[132:135],v[76:79]
 s_add_u32 s34,s29,2128896
 ds_read_b64_tr_b16 a[226:227],v18 offset:50176
 buffer_load_dwordx4 v32,s[8:11],s34 offen offset:1024 lds
 v_accvgpr_read_b32 v47,a27
 v_mfma_f32_16x16x32_bf16 v[76:79],a[204:207],a[148:151],v[76:79]
 v_mul_f32 v40,v250,v40
 v_mul_f32 v41,v250,v41
 v_mfma_f32_16x16x32_bf16 v[80:83],a[192:195],a[136:139],v[80:83]
 ds_read_b64_tr_b16 a[228:229],v18 offset:57344
 v_mul_f32 v42,v250,v42
 v_mfma_f32_16x16x32_bf16 v[80:83],a[196:199],a[152:155],v[80:83]
 s_add_u32 s34,s29,2160640
 ds_read_b64_tr_b16 a[230:231],v18 offset:58368
 buffer_load_dwordx4 v33,s[8:11],s34 offen offset:2048 lds
 v_mul_f32 v43,v250,v43
 v_mfma_f32_16x16x32_bf16 v[84:87],a[200:203],a[136:139],v[84:87]
 s_waitcnt vmcnt(19)
 ds_read_b128 a[160:163],v24 offset:0
 v_mul_f32 v44,v250,v44
 v_mul_f32 v45,v250,v45
 v_mfma_f32_16x16x32_bf16 v[84:87],a[204:207],a[152:155],v[84:87]
 ds_read_b128 a[176:179],v25 offset:0
 v_mul_f32 v46,v250,v46
 v_mfma_f32_16x16x32_bf16 v[88:91],a[192:195],a[140:143],v[88:91]
 ds_read_b128 a[164:167],v24 offset:2048
 v_mul_f32 v47,v250,v47
 v_mfma_f32_16x16x32_bf16 v[88:91],a[196:199],a[156:159],v[88:91]
 s_add_u32 s34,s29,2192384
 buffer_load_dwordx4 v33,s[8:11],s34 offen offset:3072 lds
 v_cvt_pk_bf16_f32 v224,v40,v41
 v_mfma_f32_16x16x32_bf16 v[92:95],a[200:203],a[140:143],v[92:95]
 ds_read_b128 a[180:183],v25 offset:2048
 v_cvt_pk_bf16_f32 v225,v42,v43
 v_cvt_pk_bf16_f32 v226,v44,v45
 v_mfma_f32_16x16x32_bf16 v[92:95],a[204:207],a[156:159],v[92:95]
 s_waitcnt lgkmcnt(14)
 ds_read_b128 a[168:171],v24 offset:4096
 v_cvt_pk_bf16_f32 v227,v46,v47
 v_mfma_f32_16x16x32_bf16 v[96:99],a[208:211],a[128:131],v[96:99]
 s_waitcnt lgkmcnt(13)
 ds_read_b128 a[184:187],v25 offset:4096
 v_accvgpr_read_b32 v40,a40
 v_mfma_f32_16x16x32_bf16 v[96:99],a[212:215],a[144:147],v[96:99]
 s_waitcnt lgkmcnt(12)
 v_accvgpr_read_b32 v41,a41
 v_accvgpr_read_b32 v42,a42
 v_mfma_f32_16x16x32_bf16 v[100:103],a[216:219],a[128:131],v[100:103]
 s_waitcnt lgkmcnt(10)
 ds_read_b128 a[172:175],v24 offset:6144
 v_accvgpr_read_b32 v43,a43
 v_mfma_f32_16x16x32_bf16 v[100:103],a[220:223],a[144:147],v[100:103]
 s_add_u32 s38,s31,131072
 ds_read_b128 a[188:191],v25 offset:6144
 buffer_store_dwordx4 v[208:211],v36,s[20:23],s38 offen offset:0 sc0 sc1
 v_accvgpr_read_b32 v44,a56
 v_mfma_f32_16x16x32_bf16 v[104:107],a[208:211],a[132:135],v[104:107]
 ds_read_b64_tr_b16 a[232:233],v19 offset:49152
 v_accvgpr_read_b32 v45,a57
 v_mfma_f32_16x16x32_bf16 v[104:107],a[212:215],a[148:151],v[104:107]
 s_add_u32 s38,s31,131072
 ds_read_b64_tr_b16 a[234:235],v19 offset:50176
 buffer_store_dwordx4 v[212:215],v36,s[20:23],s38 offen offset:1024 sc0 sc1
 v_accvgpr_read_b32 v46,a58
 v_mfma_f32_16x16x32_bf16 v[108:111],a[216:219],a[132:135],v[108:111]
 v_accvgpr_read_b32 v47,a59
 v_mul_f32 v40,v250,v40
 v_mfma_f32_16x16x32_bf16 v[108:111],a[220:223],a[148:151],v[108:111]
 ds_read_b64_tr_b16 a[236:237],v19 offset:57344
 v_mul_f32 v41,v250,v41
 v_mfma_f32_16x16x32_bf16 v[112:115],a[208:211],a[136:139],v[112:115]
 ds_read_b64_tr_b16 a[238:239],v19 offset:58368
 v_mul_f32 v42,v250,v42
 v_mfma_f32_16x16x32_bf16 v[112:115],a[212:215],a[152:155],v[112:115]
 s_add_u32 s38,s31,131072
 ds_read_b64_tr_b16 a[240:241],v20 offset:49152
 buffer_store_dwordx4 v[216:219],v36,s[20:23],s38 offen offset:2048 sc0 sc1
 v_mul_f32 v43,v250,v43
 v_mfma_f32_16x16x32_bf16 v[116:119],a[216:219],a[136:139],v[116:119]
 v_mul_f32 v44,v250,v44
 v_mul_f32 v45,v250,v45
 v_mfma_f32_16x16x32_bf16 v[116:119],a[220:223],a[152:155],v[116:119]
 ds_read_b64_tr_b16 a[242:243],v20 offset:50176
 v_mul_f32 v46,v250,v46
 v_mfma_f32_16x16x32_bf16 v[120:123],a[208:211],a[140:143],v[120:123]
 ds_read_b64_tr_b16 a[244:245],v20 offset:57344
 v_mul_f32 v47,v250,v47
 v_mfma_f32_16x16x32_bf16 v[120:123],a[212:215],a[156:159],v[120:123]
 s_add_u32 s38,s31,131072
 ds_read_b64_tr_b16 a[246:247],v20 offset:58368
 buffer_store_dwordx4 v[220:223],v36,s[20:23],s38 offen offset:3072 sc0 sc1
 v_cvt_pk_bf16_f32 v228,v40,v41
 v_mfma_f32_16x16x32_bf16 v[124:127],a[216:219],a[140:143],v[124:127]
 ds_read_b64_tr_b16 a[248:249],v21 offset:49152
 s_waitcnt lgkmcnt(9)
 s_add_u32 m0,s26,32768
 v_cvt_pk_bf16_f32 v229,v42,v43
 v_mfma_f32_16x16x32_bf16 v[124:127],a[220:223],a[156:159],v[124:127]
 v_cvt_pk_bf16_f32 v230,v44,v45
 v_cvt_pk_bf16_f32 v231,v46,v47
 v_mfma_f32_16x16x32_bf16 v[128:131],a[224:227],a[128:131],v[128:131]
 ds_read_b64_tr_b16 a[250:251],v21 offset:50176
 v_accvgpr_read_b32 v40,a72
 v_mfma_f32_16x16x32_bf16 v[128:131],a[228:231],a[144:147],v[128:131]
 s_waitcnt lgkmcnt(8)
 ds_read_b64_tr_b16 a[252:253],v21 offset:57344
 v_accvgpr_read_b32 v41,a73
 v_mfma_f32_16x16x32_bf16 v[132:135],a[232:235],a[128:131],v[132:135]
 s_waitcnt lgkmcnt(7)
 s_add_u32 s35,s30,640
 buffer_load_dwordx4 v34,s[4:7],s35 offen offset:0 lds
 v_mfma_f32_16x16x32_bf16 v[132:135],a[236:239],a[144:147],v[132:135]
 v_accvgpr_read_b32 v42,a74
 v_accvgpr_read_b32 v43,a75
 v_mfma_f32_16x16x32_bf16 v[136:139],a[224:227],a[132:135],v[136:139]
 ds_read_b64_tr_b16 a[254:255],v21 offset:58368
 v_accvgpr_read_b32 v44,a88
 v_mfma_f32_16x16x32_bf16 v[136:139],a[228:231],a[148:151],v[136:139]
 v_accvgpr_read_b32 v45,a89
 v_accvgpr_read_b32 v46,a90
 v_mfma_f32_16x16x32_bf16 v[140:143],a[232:235],a[132:135],v[140:143]
 s_add_u32 s35,s30,8832
 buffer_load_dwordx4 v35,s[4:7],s35 offen offset:1024 lds
 v_accvgpr_read_b32 v47,a91
 v_mfma_f32_16x16x32_bf16 v[140:143],a[236:239],a[148:151],v[140:143]
 v_mul_f32 v40,v250,v40
 v_mul_f32 v41,v250,v41
 v_mfma_f32_16x16x32_bf16 v[144:147],a[224:227],a[136:139],v[144:147]
 v_mul_f32 v42,v250,v42
 v_mul_f32 v43,v250,v43
 v_mfma_f32_16x16x32_bf16 v[144:147],a[228:231],a[152:155],v[144:147]
 s_add_u32 s35,s30,17024
 buffer_load_dwordx4 v34,s[4:7],s35 offen offset:2048 lds
 v_mul_f32 v44,v250,v44
 v_mfma_f32_16x16x32_bf16 v[148:151],a[232:235],a[136:139],v[148:151]
 s_waitcnt vmcnt(23)
 s_waitcnt lgkmcnt(0)
 s_barrier
 v_mul_f32 v45,v250,v45
 v_mfma_f32_16x16x32_bf16 v[148:151],a[236:239],a[152:155],v[148:151]
 ds_read_b64_tr_b16 a[192:193],v14 offset:16384
 v_mul_f32 v46,v250,v46
 v_mfma_f32_16x16x32_bf16 v[152:155],a[224:227],a[140:143],v[152:155]
 ds_read_b64_tr_b16 a[194:195],v14 offset:17408
 v_mul_f32 v47,v250,v47
 v_mfma_f32_16x16x32_bf16 v[152:155],a[228:231],a[156:159],v[152:155]
 s_add_u32 s35,s30,25216
 buffer_load_dwordx4 v35,s[4:7],s35 offen offset:3072 lds
 v_cvt_pk_bf16_f32 v232,v40,v41
 v_mfma_f32_16x16x32_bf16 v[156:159],a[232:235],a[140:143],v[156:159]
 ds_read_b64_tr_b16 a[196:197],v14 offset:24576
 v_cvt_pk_bf16_f32 v233,v42,v43
 v_mfma_f32_16x16x32_bf16 v[156:159],a[236:239],a[156:159],v[156:159]
 v_cvt_pk_bf16_f32 v234,v44,v45
 v_cvt_pk_bf16_f32 v235,v46,v47
 v_mfma_f32_16x16x32_bf16 v[160:163],a[240:243],a[128:131],v[160:163]
 s_add_u32 m0,s26,36864
 ds_read_b64_tr_b16 a[198:199],v14 offset:25600
 v_accvgpr_read_b32 v40,a104
 v_mfma_f32_16x16x32_bf16 v[160:163],a[244:247],a[144:147],v[160:163]
 ds_read_b64_tr_b16 a[200:201],v15 offset:16384
 v_accvgpr_read_b32 v41,a105
 v_mfma_f32_16x16x32_bf16 v[164:167],a[248:251],a[128:131],v[164:167]
 s_add_u32 s35,s30,37504
 buffer_load_dwordx4 v34,s[4:7],s35 offen offset:0 lds
 v_accvgpr_read_b32 v42,a106
 v_accvgpr_read_b32 v43,a107
 v_mfma_f32_16x16x32_bf16 v[164:167],a[252:255],a[144:147],v[164:167]
 ds_read_b64_tr_b16 a[202:203],v15 offset:17408
 v_accvgpr_read_b32 v44,a120
 v_mfma_f32_16x16x32_bf16 v[168:171],a[240:243],a[132:135],v[168:171]
 v_accvgpr_read_b32 v45,a121
 v_accvgpr_read_b32 v46,a122
 v_mfma_f32_16x16x32_bf16 v[168:171],a[244:247],a[148:151],v[168:171]
 s_add_u32 s35,s30,45696
 ds_read_b64_tr_b16 a[204:205],v15 offset:24576
 buffer_load_dwordx4 v35,s[4:7],s35 offen offset:1024 lds
 v_mfma_f32_16x16x32_bf16 v[172:175],a[248:251],a[132:135],v[172:175]
 v_accvgpr_read_b32 v47,a123
 v_mul_f32 v40,v250,v40
 v_mfma_f32_16x16x32_bf16 v[172:175],a[252:255],a[148:151],v[172:175]
 ds_read_b64_tr_b16 a[206:207],v15 offset:25600
 v_mul_f32 v41,v250,v41
 v_mfma_f32_16x16x32_bf16 v[176:179],a[240:243],a[136:139],v[176:179]
 ds_read_b64_tr_b16 a[208:209],v16 offset:16384
 v_mul_f32 v42,v250,v42
 v_mfma_f32_16x16x32_bf16 v[176:179],a[244:247],a[152:155],v[176:179]
 v_mul_f32 v43,v250,v43
 v_mul_f32 v44,v250,v44
 v_mfma_f32_16x16x32_bf16 v[180:183],a[248:251],a[136:139],v[180:183]
 s_add_u32 s35,s30,53888
 ds_read_b64_tr_b16 a[210:211],v16 offset:17408
 buffer_load_dwordx4 v34,s[4:7],s35 offen offset:2048 lds
 v_mfma_f32_16x16x32_bf16 v[180:183],a[252:255],a[152:155],v[180:183]
 v_mul_f32 v45,v250,v45
 v_mul_f32 v46,v250,v46
 v_mfma_f32_16x16x32_bf16 v[184:187],a[240:243],a[140:143],v[184:187]
 ds_read_b64_tr_b16 a[212:213],v16 offset:24576
 v_mul_f32 v47,v250,v47
 v_mfma_f32_16x16x32_bf16 v[184:187],a[244:247],a[156:159],v[184:187]
 ds_read_b64_tr_b16 a[214:215],v16 offset:25600
 v_cvt_pk_bf16_f32 v236,v40,v41
 v_mfma_f32_16x16x32_bf16 v[188:191],a[248:251],a[140:143],v[188:191]
 s_add_u32 s35,s30,62080
 buffer_load_dwordx4 v35,s[4:7],s35 offen offset:3072 lds
 v_cvt_pk_bf16_f32 v237,v42,v43
 v_mfma_f32_16x16x32_bf16 v[188:191],a[252:255],a[156:159],v[188:191]
 s_waitcnt lgkmcnt(10)
 v_cvt_pk_bf16_f32 v238,v44,v45
 v_cvt_pk_bf16_f32 v239,v46,v47
 v_mfma_f32_16x16x32_bf16 v[64:67],a[192:195],a[160:163],v[64:67]
 s_waitcnt lgkmcnt(8)
 ds_read_b64_tr_b16 a[216:217],v17 offset:16384
 v_accvgpr_read_b32 v40,a12
 v_mfma_f32_16x16x32_bf16 v[64:67],a[196:199],a[176:179],v[64:67]
 s_waitcnt lgkmcnt(7)
 s_add_u32 m0,s25,114688
 ds_read_b64_tr_b16 a[218:219],v17 offset:17408
 v_accvgpr_read_b32 v41,a13
 v_mfma_f32_16x16x32_bf16 v[68:71],a[200:203],a[160:163],v[68:71]
 s_waitcnt lgkmcnt(6)
 s_add_u32 s34,s29,2621440
 buffer_load_dwordx4 v32,s[8:11],s34 offen offset:0 lds
 v_accvgpr_read_b32 v42,a14
 v_accvgpr_read_b32 v43,a15
 v_mfma_f32_16x16x32_bf16 v[68:71],a[204:207],a[176:179],v[68:71]
 ds_read_b64_tr_b16 a[220:221],v17 offset:24576
 v_accvgpr_read_b32 v44,a28
 v_mfma_f32_16x16x32_bf16 v[72:75],a[192:195],a[164:167],v[72:75]
 ds_read_b64_tr_b16 a[222:223],v17 offset:25600
 v_accvgpr_read_b32 v45,a29
 v_mfma_f32_16x16x32_bf16 v[72:75],a[196:199],a[180:183],v[72:75]
 ds_read_b64_tr_b16 a[224:225],v18 offset:16384
 v_accvgpr_read_b32 v46,a30
 v_mfma_f32_16x16x32_bf16 v[76:79],a[200:203],a[164:167],v[76:79]
 s_add_u32 s34,s29,2653184
 ds_read_b64_tr_b16 a[226:227],v18 offset:17408
 buffer_load_dwordx4 v32,s[8:11],s34 offen offset:1024 lds
 v_accvgpr_read_b32 v47,a31
 v_mfma_f32_16x16x32_bf16 v[76:79],a[204:207],a[180:183],v[76:79]
 v_mul_f32 v40,v251,v40
 v_mul_f32 v41,v251,v41
 v_mfma_f32_16x16x32_bf16 v[80:83],a[192:195],a[168:171],v[80:83]
 ds_read_b64_tr_b16 a[228:229],v18 offset:24576
 v_mul_f32 v42,v251,v42
 v_mfma_f32_16x16x32_bf16 v[80:83],a[196:199],a[184:187],v[80:83]
 s_add_u32 s34,s29,2684928
 ds_read_b64_tr_b16 a[230:231],v18 offset:25600
 buffer_load_dwordx4 v33,s[8:11],s34 offen offset:2048 lds
 v_mul_f32 v43,v251,v43
 v_mfma_f32_16x16x32_bf16 v[84:87],a[200:203],a[168:171],v[84:87]
 s_waitcnt vmcnt(19)
 ds_read_b128 a[128:131],v22 offset:0
 v_mul_f32 v44,v251,v44
 v_mul_f32 v45,v251,v45
 v_mfma_f32_16x16x32_bf16 v[84:87],a[204:207],a[184:187],v[84:87]
 ds_read_b128 a[144:147],v23 offset:0
 v_mul_f32 v46,v251,v46
 v_mfma_f32_16x16x32_bf16 v[88:91],a[192:195],a[172:175],v[88:91]
 ds_read_b128 a[132:135],v22 offset:2048
 v_mul_f32 v47,v251,v47
 v_mfma_f32_16x16x32_bf16 v[88:91],a[196:199],a[188:191],v[88:91]
 s_add_u32 s34,s29,2716672
 buffer_load_dwordx4 v33,s[8:11],s34 offen offset:3072 lds
 v_cvt_pk_bf16_f32 v48,v40,v41
 v_mfma_f32_16x16x32_bf16 v[92:95],a[200:203],a[172:175],v[92:95]
 ds_read_b128 a[148:151],v23 offset:2048
 v_cvt_pk_bf16_f32 v49,v42,v43
 v_cvt_pk_bf16_f32 v50,v44,v45
 v_mfma_f32_16x16x32_bf16 v[92:95],a[204:207],a[188:191],v[92:95]
 s_waitcnt lgkmcnt(14)
 ds_read_b128 a[136:139],v22 offset:4096
 v_cvt_pk_bf16_f32 v51,v46,v47
 v_mfma_f32_16x16x32_bf16 v[96:99],a[208:211],a[160:163],v[96:99]
 s_waitcnt lgkmcnt(13)
 ds_read_b128 a[152:155],v23 offset:4096
 v_accvgpr_read_b32 v40,a44
 v_mfma_f32_16x16x32_bf16 v[96:99],a[212:215],a[176:179],v[96:99]
 s_waitcnt lgkmcnt(12)
 v_accvgpr_read_b32 v41,a45
 v_accvgpr_read_b32 v42,a46
 v_mfma_f32_16x16x32_bf16 v[100:103],a[216:219],a[160:163],v[100:103]
 s_waitcnt lgkmcnt(10)
 ds_read_b128 a[140:143],v22 offset:6144
 v_accvgpr_read_b32 v43,a47
 v_mfma_f32_16x16x32_bf16 v[100:103],a[220:223],a[176:179],v[100:103]
 s_add_u32 s38,s31,262144
 ds_read_b128 a[156:159],v23 offset:6144
 buffer_store_dwordx4 v[224:227],v36,s[20:23],s38 offen offset:0 sc0 sc1
 v_accvgpr_read_b32 v44,a60
 v_mfma_f32_16x16x32_bf16 v[104:107],a[208:211],a[164:167],v[104:107]
 ds_read_b64_tr_b16 a[232:233],v19 offset:16384
 v_accvgpr_read_b32 v45,a61
 v_mfma_f32_16x16x32_bf16 v[104:107],a[212:215],a[180:183],v[104:107]
 s_add_u32 s38,s31,262144
 ds_read_b64_tr_b16 a[234:235],v19 offset:17408
 buffer_store_dwordx4 v[228:231],v36,s[20:23],s38 offen offset:1024 sc0 sc1
 v_accvgpr_read_b32 v46,a62
 v_mfma_f32_16x16x32_bf16 v[108:111],a[216:219],a[164:167],v[108:111]
 v_accvgpr_read_b32 v47,a63
 v_mul_f32 v40,v251,v40
 v_mfma_f32_16x16x32_bf16 v[108:111],a[220:223],a[180:183],v[108:111]
 ds_read_b64_tr_b16 a[236:237],v19 offset:24576
 v_mul_f32 v41,v251,v41
 v_mfma_f32_16x16x32_bf16 v[112:115],a[208:211],a[168:171],v[112:115]
 ds_read_b64_tr_b16 a[238:239],v19 offset:25600
 v_mul_f32 v42,v251,v42
 v_mfma_f32_16x16x32_bf16 v[112:115],a[212:215],a[184:187],v[112:115]
 s_add_u32 s38,s31,262144
 ds_read_b64_tr_b16 a[240:241],v20 offset:16384
 buffer_store_dwordx4 v[232:235],v36,s[20:23],s38 offen offset:2048 sc0 sc1
 v_mul_f32 v43,v251,v43
 v_mfma_f32_16x16x32_bf16 v[116:119],a[216:219],a[168:171],v[116:119]
 v_mul_f32 v44,v251,v44
 v_mul_f32 v45,v251,v45
 v_mfma_f32_16x16x32_bf16 v[116:119],a[220:223],a[184:187],v[116:119]
 ds_read_b64_tr_b16 a[242:243],v20 offset:17408
 v_mul_f32 v46,v251,v46
 v_mfma_f32_16x16x32_bf16 v[120:123],a[208:211],a[172:175],v[120:123]
 ds_read_b64_tr_b16 a[244:245],v20 offset:24576
 v_mul_f32 v47,v251,v47
 v_mfma_f32_16x16x32_bf16 v[120:123],a[212:215],a[188:191],v[120:123]
 s_add_u32 s38,s31,262144
 ds_read_b64_tr_b16 a[246:247],v20 offset:25600
 buffer_store_dwordx4 v[236:239],v36,s[20:23],s38 offen offset:3072 sc0 sc1
 v_cvt_pk_bf16_f32 v52,v40,v41
 v_mfma_f32_16x16x32_bf16 v[124:127],a[216:219],a[172:175],v[124:127]
 ds_read_b64_tr_b16 a[248:249],v21 offset:16384
 s_waitcnt lgkmcnt(9)
 s_add_u32 m0,s26,131072
 v_cvt_pk_bf16_f32 v53,v42,v43
 v_mfma_f32_16x16x32_bf16 v[124:127],a[220:223],a[188:191],v[124:127]
 v_cvt_pk_bf16_f32 v54,v44,v45
 v_cvt_pk_bf16_f32 v55,v46,v47
 v_mfma_f32_16x16x32_bf16 v[128:131],a[224:227],a[160:163],v[128:131]
 ds_read_b64_tr_b16 a[250:251],v21 offset:17408
 v_accvgpr_read_b32 v40,a76
 v_mfma_f32_16x16x32_bf16 v[128:131],a[228:231],a[176:179],v[128:131]
 s_waitcnt lgkmcnt(8)
 ds_read_b64_tr_b16 a[252:253],v21 offset:24576
 v_accvgpr_read_b32 v41,a77
 v_mfma_f32_16x16x32_bf16 v[132:135],a[232:235],a[160:163],v[132:135]
 s_waitcnt lgkmcnt(7)
 s_add_u32 s35,s30,768
 buffer_load_dwordx4 v34,s[4:7],s35 offen offset:0 lds
 v_mfma_f32_16x16x32_bf16 v[132:135],a[236:239],a[176:179],v[132:135]
 v_accvgpr_read_b32 v42,a78
 v_accvgpr_read_b32 v43,a79
 v_mfma_f32_16x16x32_bf16 v[136:139],a[224:227],a[164:167],v[136:139]
 ds_read_b64_tr_b16 a[254:255],v21 offset:25600
 v_accvgpr_read_b32 v44,a92
 v_mfma_f32_16x16x32_bf16 v[136:139],a[228:231],a[180:183],v[136:139]
 v_accvgpr_read_b32 v45,a93
 v_accvgpr_read_b32 v46,a94
 v_mfma_f32_16x16x32_bf16 v[140:143],a[232:235],a[164:167],v[140:143]
 s_add_u32 s35,s30,8960
 buffer_load_dwordx4 v35,s[4:7],s35 offen offset:1024 lds
 v_accvgpr_read_b32 v47,a95
 v_mfma_f32_16x16x32_bf16 v[140:143],a[236:239],a[180:183],v[140:143]
 v_mul_f32 v40,v251,v40
 v_mul_f32 v41,v251,v41
 v_mfma_f32_16x16x32_bf16 v[144:147],a[224:227],a[168:171],v[144:147]
 v_mul_f32 v42,v251,v42
 v_mul_f32 v43,v251,v43
 v_mfma_f32_16x16x32_bf16 v[144:147],a[228:231],a[184:187],v[144:147]
 s_add_u32 s35,s30,17152
 buffer_load_dwordx4 v34,s[4:7],s35 offen offset:2048 lds
 v_mul_f32 v44,v251,v44
 v_mfma_f32_16x16x32_bf16 v[148:151],a[232:235],a[168:171],v[148:151]
 s_waitcnt vmcnt(23)
 s_waitcnt lgkmcnt(0)
 s_barrier
 v_mul_f32 v45,v251,v45
 v_mfma_f32_16x16x32_bf16 v[148:151],a[236:239],a[184:187],v[148:151]
 ds_read_b64_tr_b16 a[192:193],v14 offset:32768
 v_mul_f32 v46,v251,v46
 v_mfma_f32_16x16x32_bf16 v[152:155],a[224:227],a[172:175],v[152:155]
 ds_read_b64_tr_b16 a[194:195],v14 offset:33792
 v_mul_f32 v47,v251,v47
 v_mfma_f32_16x16x32_bf16 v[152:155],a[228:231],a[188:191],v[152:155]
 s_add_u32 s35,s30,25344
 buffer_load_dwordx4 v35,s[4:7],s35 offen offset:3072 lds
 v_cvt_pk_bf16_f32 v56,v40,v41
 v_mfma_f32_16x16x32_bf16 v[156:159],a[232:235],a[172:175],v[156:159]
 ds_read_b64_tr_b16 a[196:197],v14 offset:40960
 v_cvt_pk_bf16_f32 v57,v42,v43
 v_mfma_f32_16x16x32_bf16 v[156:159],a[236:239],a[188:191],v[156:159]
 v_cvt_pk_bf16_f32 v58,v44,v45
 v_cvt_pk_bf16_f32 v59,v46,v47
 v_mfma_f32_16x16x32_bf16 v[160:163],a[240:243],a[160:163],v[160:163]
 s_add_u32 m0,s26,135168
 ds_read_b64_tr_b16 a[198:199],v14 offset:41984
 v_accvgpr_read_b32 v40,a108
 v_mfma_f32_16x16x32_bf16 v[160:163],a[244:247],a[176:179],v[160:163]
 ds_read_b64_tr_b16 a[200:201],v15 offset:32768
 v_accvgpr_read_b32 v41,a109
 v_mfma_f32_16x16x32_bf16 v[164:167],a[248:251],a[160:163],v[164:167]
 s_add_u32 s35,s30,37632
 buffer_load_dwordx4 v34,s[4:7],s35 offen offset:0 lds
 v_accvgpr_read_b32 v42,a110
 v_accvgpr_read_b32 v43,a111
 v_mfma_f32_16x16x32_bf16 v[164:167],a[252:255],a[176:179],v[164:167]
 ds_read_b64_tr_b16 a[202:203],v15 offset:33792
 v_accvgpr_read_b32 v44,a124
 v_mfma_f32_16x16x32_bf16 v[168:171],a[240:243],a[164:167],v[168:171]
 v_accvgpr_read_b32 v45,a125
 v_accvgpr_read_b32 v46,a126
 v_mfma_f32_16x16x32_bf16 v[168:171],a[244:247],a[180:183],v[168:171]
 s_add_u32 s35,s30,45824
 ds_read_b64_tr_b16 a[204:205],v15 offset:40960
 buffer_load_dwordx4 v35,s[4:7],s35 offen offset:1024 lds
 v_mfma_f32_16x16x32_bf16 v[172:175],a[248:251],a[164:167],v[172:175]
 v_accvgpr_read_b32 v47,a127
 v_mul_f32 v40,v251,v40
 v_mfma_f32_16x16x32_bf16 v[172:175],a[252:255],a[180:183],v[172:175]
 ds_read_b64_tr_b16 a[206:207],v15 offset:41984
 v_mul_f32 v41,v251,v41
 v_mfma_f32_16x16x32_bf16 v[176:179],a[240:243],a[168:171],v[176:179]
 ds_read_b64_tr_b16 a[208:209],v16 offset:32768
 v_mul_f32 v42,v251,v42
 v_mfma_f32_16x16x32_bf16 v[176:179],a[244:247],a[184:187],v[176:179]
 v_mul_f32 v43,v251,v43
 v_mul_f32 v44,v251,v44
 v_mfma_f32_16x16x32_bf16 v[180:183],a[248:251],a[168:171],v[180:183]
 s_add_u32 s35,s30,54016
 ds_read_b64_tr_b16 a[210:211],v16 offset:33792
 buffer_load_dwordx4 v34,s[4:7],s35 offen offset:2048 lds
 v_mfma_f32_16x16x32_bf16 v[180:183],a[252:255],a[184:187],v[180:183]
 v_mul_f32 v45,v251,v45
 v_mul_f32 v46,v251,v46
 v_mfma_f32_16x16x32_bf16 v[184:187],a[240:243],a[172:175],v[184:187]
 ds_read_b64_tr_b16 a[212:213],v16 offset:40960
 v_mul_f32 v47,v251,v47
 v_mfma_f32_16x16x32_bf16 v[184:187],a[244:247],a[188:191],v[184:187]
 ds_read_b64_tr_b16 a[214:215],v16 offset:41984
 v_cvt_pk_bf16_f32 v60,v40,v41
 v_mfma_f32_16x16x32_bf16 v[188:191],a[248:251],a[172:175],v[188:191]
 s_add_u32 s35,s30,62208
 buffer_load_dwordx4 v35,s[4:7],s35 offen offset:3072 lds
 v_cvt_pk_bf16_f32 v61,v42,v43
 v_mfma_f32_16x16x32_bf16 v[188:191],a[252:255],a[188:191],v[188:191]
 s_waitcnt lgkmcnt(10)
 v_cvt_pk_bf16_f32 v62,v44,v45
 v_cvt_pk_bf16_f32 v63,v46,v47
 v_mfma_f32_16x16x32_bf16 v[64:67],a[192:195],a[128:131],v[64:67]
 s_waitcnt lgkmcnt(8)
 ds_read_b64_tr_b16 a[216:217],v17 offset:32768
 v_mfma_f32_16x16x32_bf16 v[64:67],a[196:199],a[144:147],v[64:67]
 s_waitcnt lgkmcnt(7)
 s_add_u32 m0,s25,81920
 ds_read_b64_tr_b16 a[218:219],v17 offset:33792
 v_mfma_f32_16x16x32_bf16 v[68:71],a[200:203],a[128:131],v[68:71]
 s_waitcnt lgkmcnt(6)
 s_add_u32 s34,s29,3145728
 buffer_load_dwordx4 v32,s[8:11],s34 offen offset:0 lds
 v_mfma_f32_16x16x32_bf16 v[68:71],a[204:207],a[144:147],v[68:71]
 ds_read_b64_tr_b16 a[220:221],v17 offset:40960
 v_mfma_f32_16x16x32_bf16 v[72:75],a[192:195],a[132:135],v[72:75]
 ds_read_b64_tr_b16 a[222:223],v17 offset:41984
 v_mfma_f32_16x16x32_bf16 v[72:75],a[196:199],a[148:151],v[72:75]
 ds_read_b64_tr_b16 a[224:225],v18 offset:32768
 v_mfma_f32_16x16x32_bf16 v[76:79],a[200:203],a[132:135],v[76:79]
 s_add_u32 s34,s29,3177472
 ds_read_b64_tr_b16 a[226:227],v18 offset:33792
 buffer_load_dwordx4 v32,s[8:11],s34 offen offset:1024 lds
 v_mfma_f32_16x16x32_bf16 v[76:79],a[204:207],a[148:151],v[76:79]
 v_mfma_f32_16x16x32_bf16 v[80:83],a[192:195],a[136:139],v[80:83]
 ds_read_b64_tr_b16 a[228:229],v18 offset:40960
 v_mfma_f32_16x16x32_bf16 v[80:83],a[196:199],a[152:155],v[80:83]
 s_add_u32 s34,s29,3209216
 ds_read_b64_tr_b16 a[230:231],v18 offset:41984
 buffer_load_dwordx4 v33,s[8:11],s34 offen offset:2048 lds
 v_mfma_f32_16x16x32_bf16 v[84:87],a[200:203],a[136:139],v[84:87]
 s_waitcnt vmcnt(19)
 ds_read_b128 a[160:163],v24 offset:0
 v_mfma_f32_16x16x32_bf16 v[84:87],a[204:207],a[152:155],v[84:87]
 ds_read_b128 a[176:179],v25 offset:0
 v_mfma_f32_16x16x32_bf16 v[88:91],a[192:195],a[140:143],v[88:91]
 v_mfma_f32_16x16x32_bf16 v[88:91],a[196:199],a[156:159],v[88:91]
 s_add_u32 s34,s29,3240960
 ds_read_b128 a[164:167],v24 offset:2048
 buffer_load_dwordx4 v33,s[8:11],s34 offen offset:3072 lds
 v_mfma_f32_16x16x32_bf16 v[92:95],a[200:203],a[140:143],v[92:95]
 ds_read_b128 a[180:183],v25 offset:2048
 v_mfma_f32_16x16x32_bf16 v[92:95],a[204:207],a[156:159],v[92:95]
 s_waitcnt lgkmcnt(14)
 ds_read_b128 a[168:171],v24 offset:4096
 v_mfma_f32_16x16x32_bf16 v[96:99],a[208:211],a[128:131],v[96:99]
 s_waitcnt lgkmcnt(13)
 ds_read_b128 a[184:187],v25 offset:4096
 v_mfma_f32_16x16x32_bf16 v[96:99],a[212:215],a[144:147],v[96:99]
 s_waitcnt lgkmcnt(12)
 s_add_u32 s38,s31,393216
 buffer_store_dwordx4 v[48:51],v36,s[20:23],s38 offen offset:0 sc0 sc1
 v_mfma_f32_16x16x32_bf16 v[100:103],a[216:219],a[128:131],v[100:103]
 s_waitcnt lgkmcnt(10)
 ds_read_b128 a[172:175],v24 offset:6144
 v_mfma_f32_16x16x32_bf16 v[100:103],a[220:223],a[144:147],v[100:103]
 ds_read_b128 a[188:191],v25 offset:6144
 v_mfma_f32_16x16x32_bf16 v[104:107],a[208:211],a[132:135],v[104:107]
 ds_read_b64_tr_b16 a[232:233],v19 offset:32768
 v_mfma_f32_16x16x32_bf16 v[104:107],a[212:215],a[148:151],v[104:107]
 s_add_u32 s38,s31,393216
 ds_read_b64_tr_b16 a[234:235],v19 offset:33792
 buffer_store_dwordx4 v[52:55],v36,s[20:23],s38 offen offset:1024 sc0 sc1
 v_mfma_f32_16x16x32_bf16 v[108:111],a[216:219],a[132:135],v[108:111]
 v_mfma_f32_16x16x32_bf16 v[108:111],a[220:223],a[148:151],v[108:111]
 ds_read_b64_tr_b16 a[236:237],v19 offset:40960
 v_mfma_f32_16x16x32_bf16 v[112:115],a[208:211],a[136:139],v[112:115]
 ds_read_b64_tr_b16 a[238:239],v19 offset:41984
 v_mfma_f32_16x16x32_bf16 v[112:115],a[212:215],a[152:155],v[112:115]
 s_add_u32 s38,s31,393216
 ds_read_b64_tr_b16 a[240:241],v20 offset:32768
 buffer_store_dwordx4 v[56:59],v36,s[20:23],s38 offen offset:2048 sc0 sc1
 v_mfma_f32_16x16x32_bf16 v[116:119],a[216:219],a[136:139],v[116:119]
 ds_read_b64_tr_b16 a[242:243],v20 offset:33792
 v_mfma_f32_16x16x32_bf16 v[116:119],a[220:223],a[152:155],v[116:119]
 v_mfma_f32_16x16x32_bf16 v[120:123],a[208:211],a[140:143],v[120:123]
 ds_read_b64_tr_b16 a[244:245],v20 offset:40960
 v_mfma_f32_16x16x32_bf16 v[120:123],a[212:215],a[156:159],v[120:123]
 s_add_u32 s38,s31,393216
 ds_read_b64_tr_b16 a[246:247],v20 offset:41984
 buffer_store_dwordx4 v[60:63],v36,s[20:23],s38 offen offset:3072 sc0 sc1
 v_mfma_f32_16x16x32_bf16 v[124:127],a[216:219],a[140:143],v[124:127]
 ds_read_b64_tr_b16 a[248:249],v21 offset:32768
 v_mfma_f32_16x16x32_bf16 v[124:127],a[220:223],a[156:159],v[124:127]
 s_waitcnt lgkmcnt(9)
 s_add_u32 m0,s26,32768
 v_mfma_f32_16x16x32_bf16 v[128:131],a[224:227],a[128:131],v[128:131]
 ds_read_b64_tr_b16 a[250:251],v21 offset:33792
 ds_read_b64_tr_b16 a[252:253],v21 offset:40960
 v_mfma_f32_16x16x32_bf16 v[128:131],a[228:231],a[144:147],v[128:131]
 s_waitcnt lgkmcnt(9)
 s_add_u32 s35,s30,896
 buffer_load_dwordx4 v34,s[4:7],s35 offen offset:0 lds
 v_mfma_f32_16x16x32_bf16 v[132:135],a[232:235],a[128:131],v[132:135]
 s_waitcnt lgkmcnt(7)
 ds_read_b64_tr_b16 a[254:255],v21 offset:41984
 v_mfma_f32_16x16x32_bf16 v[132:135],a[236:239],a[144:147],v[132:135]
 v_mfma_f32_16x16x32_bf16 v[136:139],a[224:227],a[132:135],v[136:139]
 v_mfma_f32_16x16x32_bf16 v[136:139],a[228:231],a[148:151],v[136:139]
 s_add_u32 s35,s30,9088
 buffer_load_dwordx4 v35,s[4:7],s35 offen offset:1024 lds
 v_mfma_f32_16x16x32_bf16 v[140:143],a[232:235],a[132:135],v[140:143]
 v_mfma_f32_16x16x32_bf16 v[140:143],a[236:239],a[148:151],v[140:143]
 v_mfma_f32_16x16x32_bf16 v[144:147],a[224:227],a[136:139],v[144:147]
 v_mfma_f32_16x16x32_bf16 v[144:147],a[228:231],a[152:155],v[144:147]
 s_add_u32 s35,s30,17280
 buffer_load_dwordx4 v34,s[4:7],s35 offen offset:2048 lds
 v_mfma_f32_16x16x32_bf16 v[148:151],a[232:235],a[136:139],v[148:151]
 s_waitcnt vmcnt(23)
 s_waitcnt lgkmcnt(0)
 s_barrier
 v_mfma_f32_16x16x32_bf16 v[148:151],a[236:239],a[152:155],v[148:151]
 ds_read_b64_tr_b16 a[192:193],v14 offset:49152
 v_mfma_f32_16x16x32_bf16 v[152:155],a[224:227],a[140:143],v[152:155]
 v_mfma_f32_16x16x32_bf16 v[152:155],a[228:231],a[156:159],v[152:155]
 s_add_u32 s35,s30,25472
 ds_read_b64_tr_b16 a[194:195],v14 offset:50176
 buffer_load_dwordx4 v35,s[4:7],s35 offen offset:3072 lds
 v_mfma_f32_16x16x32_bf16 v[156:159],a[232:235],a[140:143],v[156:159]
 ds_read_b64_tr_b16 a[196:197],v14 offset:57344
 v_mfma_f32_16x16x32_bf16 v[156:159],a[236:239],a[156:159],v[156:159]
 v_mfma_f32_16x16x32_bf16 v[160:163],a[240:243],a[128:131],v[160:163]
 s_add_u32 m0,s26,36864
 ds_read_b64_tr_b16 a[198:199],v14 offset:58368
 v_mfma_f32_16x16x32_bf16 v[160:163],a[244:247],a[144:147],v[160:163]
 s_add_u32 s35,s30,37760
 buffer_load_dwordx4 v34,s[4:7],s35 offen offset:0 lds
 v_mfma_f32_16x16x32_bf16 v[164:167],a[248:251],a[128:131],v[164:167]
 ds_read_b64_tr_b16 a[200:201],v15 offset:49152
 v_mfma_f32_16x16x32_bf16 v[164:167],a[252:255],a[144:147],v[164:167]
 ds_read_b64_tr_b16 a[202:203],v15 offset:50176
 v_mfma_f32_16x16x32_bf16 v[168:171],a[240:243],a[132:135],v[168:171]
 v_mfma_f32_16x16x32_bf16 v[168:171],a[244:247],a[148:151],v[168:171]
 ds_read_b64_tr_b16 a[204:205],v15 offset:57344
 v_mfma_f32_16x16x32_bf16 v[172:175],a[248:251],a[132:135],v[172:175]
 s_add_u32 s35,s30,45952
 ds_read_b64_tr_b16 a[206:207],v15 offset:58368
 buffer_load_dwordx4 v35,s[4:7],s35 offen offset:1024 lds
 v_mfma_f32_16x16x32_bf16 v[172:175],a[252:255],a[148:151],v[172:175]
 v_mfma_f32_16x16x32_bf16 v[176:179],a[240:243],a[136:139],v[176:179]
 ds_read_b64_tr_b16 a[208:209],v16 offset:49152
 v_mfma_f32_16x16x32_bf16 v[176:179],a[244:247],a[152:155],v[176:179]
 v_mfma_f32_16x16x32_bf16 v[180:183],a[248:251],a[136:139],v[180:183]
 s_add_u32 s35,s30,54144
 ds_read_b64_tr_b16 a[210:211],v16 offset:50176
 buffer_load_dwordx4 v34,s[4:7],s35 offen offset:2048 lds
 v_mfma_f32_16x16x32_bf16 v[180:183],a[252:255],a[152:155],v[180:183]
 ds_read_b64_tr_b16 a[212:213],v16 offset:57344
 v_mfma_f32_16x16x32_bf16 v[184:187],a[240:243],a[140:143],v[184:187]
 v_mfma_f32_16x16x32_bf16 v[184:187],a[244:247],a[156:159],v[184:187]
 ds_read_b64_tr_b16 a[214:215],v16 offset:58368
 v_mfma_f32_16x16x32_bf16 v[188:191],a[248:251],a[140:143],v[188:191]
 s_add_u32 s35,s30,62336
 buffer_load_dwordx4 v35,s[4:7],s35 offen offset:3072 lds
 v_mfma_f32_16x16x32_bf16 v[188:191],a[252:255],a[156:159],v[188:191]
 s_waitcnt lgkmcnt(10)
 v_mfma_f32_16x16x32_bf16 v[64:67],a[192:195],a[160:163],v[64:67]
 s_waitcnt lgkmcnt(8)
 ds_read_b64_tr_b16 a[216:217],v17 offset:49152
 v_mfma_f32_16x16x32_bf16 v[64:67],a[196:199],a[176:179],v[64:67]
 s_waitcnt lgkmcnt(7)
 s_add_u32 m0,s25,98304
 ds_read_b64_tr_b16 a[218:219],v17 offset:50176
 v_mfma_f32_16x16x32_bf16 v[68:71],a[200:203],a[160:163],v[68:71]
 s_waitcnt lgkmcnt(6)
 s_add_u32 s34,s29,3670016
 buffer_load_dwordx4 v32,s[8:11],s34 offen offset:0 lds
 v_mfma_f32_16x16x32_bf16 v[68:71],a[204:207],a[176:179],v[68:71]
 ds_read_b64_tr_b16 a[220:221],v17 offset:57344
 v_mfma_f32_16x16x32_bf16 v[72:75],a[192:195],a[164:167],v[72:75]
 ds_read_b64_tr_b16 a[222:223],v17 offset:58368
 v_mfma_f32_16x16x32_bf16 v[72:75],a[196:199],a[180:183],v[72:75]
 ds_read_b64_tr_b16 a[224:225],v18 offset:49152
 v_mfma_f32_16x16x32_bf16 v[76:79],a[200:203],a[164:167],v[76:79]
 ds_read_b64_tr_b16 a[226:227],v18 offset:50176
 v_mfma_f32_16x16x32_bf16 v[76:79],a[204:207],a[180:183],v[76:79]
 s_add_u32 s34,s29,3701760
 buffer_load_dwordx4 v32,s[8:11],s34 offen offset:1024 lds
 v_mfma_f32_16x16x32_bf16 v[80:83],a[192:195],a[168:171],v[80:83]
 ds_read_b64_tr_b16 a[228:229],v18 offset:57344
 v_mfma_f32_16x16x32_bf16 v[80:83],a[196:199],a[184:187],v[80:83]
 ds_read_b64_tr_b16 a[230:231],v18 offset:58368
 v_mfma_f32_16x16x32_bf16 v[84:87],a[200:203],a[168:171],v[84:87]
 s_waitcnt vmcnt(18)
 ds_read_b128 a[128:131],v22 offset:0
 v_mfma_f32_16x16x32_bf16 v[84:87],a[204:207],a[184:187],v[84:87]
 ds_read_b128 a[144:147],v23 offset:0
 v_mfma_f32_16x16x32_bf16 v[88:91],a[192:195],a[172:175],v[88:91]
 s_add_u32 s34,s29,3733504
 buffer_load_dwordx4 v33,s[8:11],s34 offen offset:2048 lds
 v_mfma_f32_16x16x32_bf16 v[88:91],a[196:199],a[188:191],v[88:91]
 ds_read_b128 a[132:135],v22 offset:2048
 v_mfma_f32_16x16x32_bf16 v[92:95],a[200:203],a[172:175],v[92:95]
 ds_read_b128 a[148:151],v23 offset:2048
 v_mfma_f32_16x16x32_bf16 v[92:95],a[204:207],a[188:191],v[92:95]
 s_waitcnt lgkmcnt(14)
 ds_read_b128 a[136:139],v22 offset:4096
 v_mfma_f32_16x16x32_bf16 v[96:99],a[208:211],a[160:163],v[96:99]
 s_waitcnt lgkmcnt(13)
 ds_read_b128 a[152:155],v23 offset:4096
 v_mfma_f32_16x16x32_bf16 v[96:99],a[212:215],a[176:179],v[96:99]
 s_waitcnt lgkmcnt(12)
 s_add_u32 s34,s29,3765248
 buffer_load_dwordx4 v33,s[8:11],s34 offen offset:3072 lds
 v_mfma_f32_16x16x32_bf16 v[100:103],a[216:219],a[160:163],v[100:103]
 s_waitcnt lgkmcnt(10)
 ds_read_b128 a[140:143],v22 offset:6144
 v_mfma_f32_16x16x32_bf16 v[100:103],a[220:223],a[176:179],v[100:103]
 ds_read_b128 a[156:159],v23 offset:6144
 v_mfma_f32_16x16x32_bf16 v[104:107],a[208:211],a[164:167],v[104:107]
 ds_read_b64_tr_b16 a[232:233],v19 offset:49152
 v_mfma_f32_16x16x32_bf16 v[104:107],a[212:215],a[180:183],v[104:107]
 ds_read_b64_tr_b16 a[234:235],v19 offset:50176
 v_mfma_f32_16x16x32_bf16 v[108:111],a[216:219],a[164:167],v[108:111]
 v_mfma_f32_16x16x32_bf16 v[108:111],a[220:223],a[180:183],v[108:111]
 ds_read_b64_tr_b16 a[236:237],v19 offset:57344
 v_mfma_f32_16x16x32_bf16 v[112:115],a[208:211],a[168:171],v[112:115]
 ds_read_b64_tr_b16 a[238:239],v19 offset:58368
 v_mfma_f32_16x16x32_bf16 v[112:115],a[212:215],a[184:187],v[112:115]
 ds_read_b64_tr_b16 a[240:241],v20 offset:49152
 s_waitcnt lgkmcnt(5)
 s_add_u32 m0,s26,131072
 v_mfma_f32_16x16x32_bf16 v[116:119],a[216:219],a[168:171],v[116:119]
 s_add_u32 s35,s30,1024
 ds_read_b64_tr_b16 a[242:243],v20 offset:50176
 buffer_load_dwordx4 v34,s[4:7],s35 offen offset:0 lds
 v_mfma_f32_16x16x32_bf16 v[116:119],a[220:223],a[184:187],v[116:119]
 v_mfma_f32_16x16x32_bf16 v[120:123],a[208:211],a[172:175],v[120:123]
 ds_read_b64_tr_b16 a[244:245],v20 offset:57344
 v_mfma_f32_16x16x32_bf16 v[120:123],a[212:215],a[188:191],v[120:123]
 ds_read_b64_tr_b16 a[246:247],v20 offset:58368
 v_mfma_f32_16x16x32_bf16 v[124:127],a[216:219],a[172:175],v[124:127]
 ds_read_b64_tr_b16 a[248:249],v21 offset:49152
 v_mfma_f32_16x16x32_bf16 v[124:127],a[220:223],a[188:191],v[124:127]
 s_add_u32 s35,s30,9216
 buffer_load_dwordx4 v35,s[4:7],s35 offen offset:1024 lds
 v_mfma_f32_16x16x32_bf16 v[128:131],a[224:227],a[160:163],v[128:131]
 ds_read_b64_tr_b16 a[250:251],v21 offset:50176
 v_mfma_f32_16x16x32_bf16 v[128:131],a[228:231],a[176:179],v[128:131]
 s_waitcnt lgkmcnt(8)
 ds_read_b64_tr_b16 a[252:253],v21 offset:57344
 v_mfma_f32_16x16x32_bf16 v[132:135],a[232:235],a[160:163],v[132:135]
 s_waitcnt lgkmcnt(7)
 ds_read_b64_tr_b16 a[254:255],v21 offset:58368
 v_mfma_f32_16x16x32_bf16 v[132:135],a[236:239],a[176:179],v[132:135]
 v_mfma_f32_16x16x32_bf16 v[136:139],a[224:227],a[164:167],v[136:139]
 s_add_u32 s35,s30,17408
 buffer_load_dwordx4 v34,s[4:7],s35 offen offset:2048 lds
 v_mfma_f32_16x16x32_bf16 v[136:139],a[228:231],a[180:183],v[136:139]
 v_mfma_f32_16x16x32_bf16 v[140:143],a[232:235],a[164:167],v[140:143]
 v_mfma_f32_16x16x32_bf16 v[140:143],a[236:239],a[180:183],v[140:143]
 v_mfma_f32_16x16x32_bf16 v[144:147],a[224:227],a[168:171],v[144:147]
 v_mfma_f32_16x16x32_bf16 v[144:147],a[228:231],a[184:187],v[144:147]
 s_add_u32 s35,s30,25600
 buffer_load_dwordx4 v35,s[4:7],s35 offen offset:3072 lds
 v_mfma_f32_16x16x32_bf16 v[148:151],a[232:235],a[168:171],v[148:151]
 s_waitcnt vmcnt(20)
 s_waitcnt lgkmcnt(0)
 s_barrier
 v_mfma_f32_16x16x32_bf16 v[148:151],a[236:239],a[184:187],v[148:151]
 ds_read_b64_tr_b16 a[192:193],v14 offset:16384
 v_mfma_f32_16x16x32_bf16 v[152:155],a[224:227],a[172:175],v[152:155]
 v_mfma_f32_16x16x32_bf16 v[152:155],a[228:231],a[188:191],v[152:155]
 ds_read_b64_tr_b16 a[194:195],v14 offset:17408
 v_mfma_f32_16x16x32_bf16 v[156:159],a[232:235],a[172:175],v[156:159]
 s_add_u32 m0,s26,135168
 ds_read_b64_tr_b16 a[196:197],v14 offset:24576
 v_mfma_f32_16x16x32_bf16 v[156:159],a[236:239],a[188:191],v[156:159]
 s_add_u32 s35,s30,37888
 buffer_load_dwordx4 v34,s[4:7],s35 offen offset:0 lds
 v_mfma_f32_16x16x32_bf16 v[160:163],a[240:243],a[160:163],v[160:163]
 ds_read_b64_tr_b16 a[198:199],v14 offset:25600
 v_mfma_f32_16x16x32_bf16 v[160:163],a[244:247],a[176:179],v[160:163]
 v_mfma_f32_16x16x32_bf16 v[164:167],a[248:251],a[160:163],v[164:167]
 ds_read_b64_tr_b16 a[200:201],v15 offset:16384
 v_mfma_f32_16x16x32_bf16 v[164:167],a[252:255],a[176:179],v[164:167]
 ds_read_b64_tr_b16 a[202:203],v15 offset:17408
 v_mfma_f32_16x16x32_bf16 v[168:171],a[240:243],a[164:167],v[168:171]
 s_add_u32 s35,s30,46080
 buffer_load_dwordx4 v35,s[4:7],s35 offen offset:1024 lds
 v_mfma_f32_16x16x32_bf16 v[168:171],a[244:247],a[180:183],v[168:171]
 ds_read_b64_tr_b16 a[204:205],v15 offset:24576
 v_mfma_f32_16x16x32_bf16 v[172:175],a[248:251],a[164:167],v[172:175]
 ds_read_b64_tr_b16 a[206:207],v15 offset:25600
 v_mfma_f32_16x16x32_bf16 v[172:175],a[252:255],a[180:183],v[172:175]
 v_mfma_f32_16x16x32_bf16 v[176:179],a[240:243],a[168:171],v[176:179]
 ds_read_b64_tr_b16 a[208:209],v16 offset:16384
 v_mfma_f32_16x16x32_bf16 v[176:179],a[244:247],a[184:187],v[176:179]
 s_add_u32 s35,s30,54272
 buffer_load_dwordx4 v34,s[4:7],s35 offen offset:2048 lds
 v_mfma_f32_16x16x32_bf16 v[180:183],a[248:251],a[168:171],v[180:183]
 ds_read_b64_tr_b16 a[210:211],v16 offset:17408
 v_mfma_f32_16x16x32_bf16 v[180:183],a[252:255],a[184:187],v[180:183]
 ds_read_b64_tr_b16 a[212:213],v16 offset:24576
 v_mfma_f32_16x16x32_bf16 v[184:187],a[240:243],a[172:175],v[184:187]
 v_mfma_f32_16x16x32_bf16 v[184:187],a[244:247],a[188:191],v[184:187]
 ds_read_b64_tr_b16 a[214:215],v16 offset:25600
 v_mfma_f32_16x16x32_bf16 v[188:191],a[248:251],a[172:175],v[188:191]
 s_add_u32 s35,s30,62464
 buffer_load_dwordx4 v35,s[4:7],s35 offen offset:3072 lds
 v_mfma_f32_16x16x32_bf16 v[188:191],a[252:255],a[188:191],v[188:191]
 s_waitcnt lgkmcnt(10)
 v_mfma_f32_16x16x32_bf16 v[64:67],a[192:195],a[128:131],v[64:67]
 s_waitcnt lgkmcnt(8)
 ds_read_b64_tr_b16 a[216:217],v17 offset:16384
 v_mfma_f32_16x16x32_bf16 v[64:67],a[196:199],a[144:147],v[64:67]
 s_waitcnt lgkmcnt(7)
 s_add_u32 m0,s25,114688
 ds_read_b64_tr_b16 a[218:219],v17 offset:17408
 v_mfma_f32_16x16x32_bf16 v[68:71],a[200:203],a[128:131],v[68:71]
 s_waitcnt lgkmcnt(6)
 s_add_u32 s34,s29,4194304
 buffer_load_dwordx4 v32,s[8:11],s34 offen offset:0 lds
 v_mfma_f32_16x16x32_bf16 v[68:71],a[204:207],a[144:147],v[68:71]
 ds_read_b64_tr_b16 a[220:221],v17 offset:24576
 v_mfma_f32_16x16x32_bf16 v[72:75],a[192:195],a[132:135],v[72:75]
 ds_read_b64_tr_b16 a[222:223],v17 offset:25600
 v_mfma_f32_16x16x32_bf16 v[72:75],a[196:199],a[148:151],v[72:75]
 ds_read_b64_tr_b16 a[224:225],v18 offset:16384
 v_mfma_f32_16x16x32_bf16 v[76:79],a[200:203],a[132:135],v[76:79]
 ds_read_b64_tr_b16 a[226:227],v18 offset:17408
 v_mfma_f32_16x16x32_bf16 v[76:79],a[204:207],a[148:151],v[76:79]
 v_mfma_f32_16x16x32_bf16 v[80:83],a[192:195],a[136:139],v[80:83]
 ds_read_b64_tr_b16 a[228:229],v18 offset:24576
 v_mfma_f32_16x16x32_bf16 v[80:83],a[196:199],a[152:155],v[80:83]
 s_add_u32 s34,s29,4226048
 ds_read_b64_tr_b16 a[230:231],v18 offset:25600
 buffer_load_dwordx4 v32,s[8:11],s34 offen offset:1024 lds
 v_mfma_f32_16x16x32_bf16 v[84:87],a[200:203],a[136:139],v[84:87]
 s_waitcnt vmcnt(14)
 ds_read_b128 a[160:163],v24 offset:0
 v_mfma_f32_16x16x32_bf16 v[84:87],a[204:207],a[152:155],v[84:87]
 ds_read_b128 a[176:179],v25 offset:0
 v_mfma_f32_16x16x32_bf16 v[88:91],a[192:195],a[140:143],v[88:91]
 v_mfma_f32_16x16x32_bf16 v[88:91],a[196:199],a[156:159],v[88:91]
 ds_read_b128 a[164:167],v24 offset:2048
 v_mfma_f32_16x16x32_bf16 v[92:95],a[200:203],a[140:143],v[92:95]
 ds_read_b128 a[180:183],v25 offset:2048
 v_mfma_f32_16x16x32_bf16 v[92:95],a[204:207],a[156:159],v[92:95]
 s_waitcnt lgkmcnt(14)
 ds_read_b128 a[168:171],v24 offset:4096
 v_mfma_f32_16x16x32_bf16 v[96:99],a[208:211],a[128:131],v[96:99]
 s_waitcnt lgkmcnt(13)
 ds_read_b128 a[184:187],v25 offset:4096
 v_mfma_f32_16x16x32_bf16 v[96:99],a[212:215],a[144:147],v[96:99]
 s_waitcnt lgkmcnt(12)
 ds_read_b128 a[172:175],v24 offset:6144
 v_mfma_f32_16x16x32_bf16 v[100:103],a[216:219],a[128:131],v[100:103]
 s_waitcnt lgkmcnt(11)
 s_add_u32 s34,s29,4257792
 buffer_load_dwordx4 v33,s[8:11],s34 offen offset:2048 lds
 v_mfma_f32_16x16x32_bf16 v[100:103],a[220:223],a[144:147],v[100:103]
 ds_read_b128 a[188:191],v25 offset:6144
 v_mfma_f32_16x16x32_bf16 v[104:107],a[208:211],a[132:135],v[104:107]
 ds_read_b64_tr_b16 a[232:233],v19 offset:16384
 v_mfma_f32_16x16x32_bf16 v[104:107],a[212:215],a[148:151],v[104:107]
 ds_read_b64_tr_b16 a[234:235],v19 offset:17408
 v_mfma_f32_16x16x32_bf16 v[108:111],a[216:219],a[132:135],v[108:111]
 v_mfma_f32_16x16x32_bf16 v[108:111],a[220:223],a[148:151],v[108:111]
 ds_read_b64_tr_b16 a[236:237],v19 offset:24576
 v_mfma_f32_16x16x32_bf16 v[112:115],a[208:211],a[136:139],v[112:115]
 ds_read_b64_tr_b16 a[238:239],v19 offset:25600
 v_mfma_f32_16x16x32_bf16 v[112:115],a[212:215],a[152:155],v[112:115]
 ds_read_b64_tr_b16 a[240:241],v20 offset:16384
 v_mfma_f32_16x16x32_bf16 v[116:119],a[216:219],a[136:139],v[116:119]
 s_add_u32 s34,s29,4289536
 ds_read_b64_tr_b16 a[242:243],v20 offset:17408
 buffer_load_dwordx4 v33,s[8:11],s34 offen offset:3072 lds
 v_mfma_f32_16x16x32_bf16 v[116:119],a[220:223],a[152:155],v[116:119]
 v_mfma_f32_16x16x32_bf16 v[120:123],a[208:211],a[140:143],v[120:123]
 ds_read_b64_tr_b16 a[244:245],v20 offset:24576
 v_mfma_f32_16x16x32_bf16 v[120:123],a[212:215],a[156:159],v[120:123]
 ds_read_b64_tr_b16 a[246:247],v20 offset:25600
 v_mfma_f32_16x16x32_bf16 v[124:127],a[216:219],a[140:143],v[124:127]
 ds_read_b64_tr_b16 a[248:249],v21 offset:16384
 v_mfma_f32_16x16x32_bf16 v[124:127],a[220:223],a[156:159],v[124:127]
 s_waitcnt lgkmcnt(15)
 ds_read_b64_tr_b16 a[250:251],v21 offset:17408
 v_mfma_f32_16x16x32_bf16 v[128:131],a[224:227],a[128:131],v[128:131]
 s_waitcnt lgkmcnt(15)
 v_mfma_f32_16x16x32_bf16 v[128:131],a[228:231],a[144:147],v[128:131]
 s_waitcnt lgkmcnt(8)
 ds_read_b64_tr_b16 a[252:253],v21 offset:24576
 v_mfma_f32_16x16x32_bf16 v[132:135],a[232:235],a[128:131],v[132:135]
 s_waitcnt lgkmcnt(7)
 ds_read_b64_tr_b16 a[254:255],v21 offset:25600
 v_mfma_f32_16x16x32_bf16 v[132:135],a[236:239],a[144:147],v[132:135]
 v_mfma_f32_16x16x32_bf16 v[136:139],a[224:227],a[132:135],v[136:139]
 v_mfma_f32_16x16x32_bf16 v[136:139],a[228:231],a[148:151],v[136:139]
 v_mfma_f32_16x16x32_bf16 v[140:143],a[232:235],a[132:135],v[140:143]
 v_mfma_f32_16x16x32_bf16 v[140:143],a[236:239],a[148:151],v[140:143]
 v_mfma_f32_16x16x32_bf16 v[144:147],a[224:227],a[136:139],v[144:147]
 v_mfma_f32_16x16x32_bf16 v[144:147],a[228:231],a[152:155],v[144:147]
 v_mfma_f32_16x16x32_bf16 v[148:151],a[232:235],a[136:139],v[148:151]
 s_waitcnt vmcnt(12)
 s_waitcnt lgkmcnt(0)
 s_barrier
 v_mfma_f32_16x16x32_bf16 v[148:151],a[236:239],a[152:155],v[148:151]
 ds_read_b64_tr_b16 a[192:193],v14 offset:32768
 v_mfma_f32_16x16x32_bf16 v[152:155],a[224:227],a[140:143],v[152:155]
 v_mfma_f32_16x16x32_bf16 v[152:155],a[228:231],a[156:159],v[152:155]
 ds_read_b64_tr_b16 a[194:195],v14 offset:33792
 v_mfma_f32_16x16x32_bf16 v[156:159],a[232:235],a[140:143],v[156:159]
 ds_read_b64_tr_b16 a[196:197],v14 offset:40960
 v_mfma_f32_16x16x32_bf16 v[156:159],a[236:239],a[156:159],v[156:159]
 v_mfma_f32_16x16x32_bf16 v[160:163],a[240:243],a[128:131],v[160:163]
 ds_read_b64_tr_b16 a[198:199],v14 offset:41984
 v_mfma_f32_16x16x32_bf16 v[160:163],a[244:247],a[144:147],v[160:163]
 v_mfma_f32_16x16x32_bf16 v[164:167],a[248:251],a[128:131],v[164:167]
 ds_read_b64_tr_b16 a[200:201],v15 offset:32768
 v_mfma_f32_16x16x32_bf16 v[164:167],a[252:255],a[144:147],v[164:167]
 ds_read_b64_tr_b16 a[202:203],v15 offset:33792
 v_mfma_f32_16x16x32_bf16 v[168:171],a[240:243],a[132:135],v[168:171]
 v_mfma_f32_16x16x32_bf16 v[168:171],a[244:247],a[148:151],v[168:171]
 ds_read_b64_tr_b16 a[204:205],v15 offset:40960
 v_mfma_f32_16x16x32_bf16 v[172:175],a[248:251],a[132:135],v[172:175]
 ds_read_b64_tr_b16 a[206:207],v15 offset:41984
 v_mfma_f32_16x16x32_bf16 v[172:175],a[252:255],a[148:151],v[172:175]
 v_mfma_f32_16x16x32_bf16 v[176:179],a[240:243],a[136:139],v[176:179]
 ds_read_b64_tr_b16 a[208:209],v16 offset:32768
 v_mfma_f32_16x16x32_bf16 v[176:179],a[244:247],a[152:155],v[176:179]
 v_mfma_f32_16x16x32_bf16 v[180:183],a[248:251],a[136:139],v[180:183]
 ds_read_b64_tr_b16 a[210:211],v16 offset:33792
 v_mfma_f32_16x16x32_bf16 v[180:183],a[252:255],a[152:155],v[180:183]
 ds_read_b64_tr_b16 a[212:213],v16 offset:40960
 v_mfma_f32_16x16x32_bf16 v[184:187],a[240:243],a[140:143],v[184:187]
 v_mfma_f32_16x16x32_bf16 v[184:187],a[244:247],a[156:159],v[184:187]
 ds_read_b64_tr_b16 a[214:215],v16 offset:41984
 v_mfma_f32_16x16x32_bf16 v[188:191],a[248:251],a[140:143],v[188:191]
 v_mfma_f32_16x16x32_bf16 v[188:191],a[252:255],a[156:159],v[188:191]
 s_waitcnt lgkmcnt(10)
 v_mfma_f32_16x16x32_bf16 v[64:67],a[192:195],a[160:163],v[64:67]
 s_waitcnt lgkmcnt(8)
 ds_read_b64_tr_b16 a[216:217],v17 offset:32768
 v_mfma_f32_16x16x32_bf16 v[64:67],a[196:199],a[176:179],v[64:67]
 s_waitcnt lgkmcnt(7)
 s_add_u32 m0,s25,81920
 ds_read_b64_tr_b16 a[218:219],v17 offset:33792
 v_mfma_f32_16x16x32_bf16 v[68:71],a[200:203],a[160:163],v[68:71]
 s_waitcnt lgkmcnt(6)
 buffer_load_dwordx4 v30,s[16:19],s28 offen offset:0 sc1 nt lds
 v_mfma_f32_16x16x32_bf16 v[68:71],a[204:207],a[176:179],v[68:71]
 ds_read_b64_tr_b16 a[220:221],v17 offset:40960
 v_mfma_f32_16x16x32_bf16 v[72:75],a[192:195],a[164:167],v[72:75]
 ds_read_b64_tr_b16 a[222:223],v17 offset:41984
 v_mfma_f32_16x16x32_bf16 v[72:75],a[196:199],a[180:183],v[72:75]
 ds_read_b64_tr_b16 a[224:225],v18 offset:32768
 v_mfma_f32_16x16x32_bf16 v[76:79],a[200:203],a[164:167],v[76:79]
 ds_read_b64_tr_b16 a[226:227],v18 offset:33792
 v_mfma_f32_16x16x32_bf16 v[76:79],a[204:207],a[180:183],v[76:79]
 v_mfma_f32_16x16x32_bf16 v[80:83],a[192:195],a[168:171],v[80:83]
 ds_read_b64_tr_b16 a[228:229],v18 offset:40960
 v_mfma_f32_16x16x32_bf16 v[80:83],a[196:199],a[184:187],v[80:83]
 ds_read_b64_tr_b16 a[230:231],v18 offset:41984
 v_mfma_f32_16x16x32_bf16 v[84:87],a[200:203],a[168:171],v[84:87]
 s_waitcnt vmcnt(5)
 ds_read_b128 a[128:131],v22 offset:0
 buffer_load_dwordx4 v31,s[16:19],s28 offen offset:1024 sc1 nt lds
 v_mfma_f32_16x16x32_bf16 v[84:87],a[204:207],a[184:187],v[84:87]
 ds_read_b128 a[144:147],v23 offset:0
 v_mfma_f32_16x16x32_bf16 v[88:91],a[192:195],a[172:175],v[88:91]
 v_mfma_f32_16x16x32_bf16 v[88:91],a[196:199],a[188:191],v[88:91]
 ds_read_b128 a[132:135],v22 offset:2048
 v_mfma_f32_16x16x32_bf16 v[92:95],a[200:203],a[172:175],v[92:95]
 ds_read_b128 a[148:151],v23 offset:2048
 v_mfma_f32_16x16x32_bf16 v[92:95],a[204:207],a[188:191],v[92:95]
 s_waitcnt lgkmcnt(14)
 ds_read_b128 a[136:139],v22 offset:4096
 v_mfma_f32_16x16x32_bf16 v[96:99],a[208:211],a[160:163],v[96:99]
 s_waitcnt lgkmcnt(13)
 ds_read_b128 a[152:155],v23 offset:4096
 v_mfma_f32_16x16x32_bf16 v[96:99],a[212:215],a[176:179],v[96:99]
 s_waitcnt lgkmcnt(12)
 buffer_load_dwordx4 v30,s[16:19],s28 offen offset:2048 sc1 nt lds
 v_mfma_f32_16x16x32_bf16 v[100:103],a[216:219],a[160:163],v[100:103]
 s_waitcnt lgkmcnt(10)
 ds_read_b128 a[140:143],v22 offset:6144
 v_mfma_f32_16x16x32_bf16 v[100:103],a[220:223],a[176:179],v[100:103]
 ds_read_b128 a[156:159],v23 offset:6144
 v_mfma_f32_16x16x32_bf16 v[104:107],a[208:211],a[164:167],v[104:107]
 ds_read_b64_tr_b16 a[232:233],v19 offset:32768
 v_mfma_f32_16x16x32_bf16 v[104:107],a[212:215],a[180:183],v[104:107]
 ds_read_b64_tr_b16 a[234:235],v19 offset:33792
 v_mfma_f32_16x16x32_bf16 v[108:111],a[216:219],a[164:167],v[108:111]
 v_mfma_f32_16x16x32_bf16 v[108:111],a[220:223],a[180:183],v[108:111]
 ds_read_b64_tr_b16 a[236:237],v19 offset:40960
 v_mfma_f32_16x16x32_bf16 v[112:115],a[208:211],a[168:171],v[112:115]
 ds_read_b64_tr_b16 a[238:239],v19 offset:41984
 v_mfma_f32_16x16x32_bf16 v[112:115],a[212:215],a[184:187],v[112:115]
 ds_read_b64_tr_b16 a[240:241],v20 offset:32768
 buffer_load_dwordx4 v31,s[16:19],s28 offen offset:3072 sc1 nt lds
 s_add_u32 s28,s28,16384
 v_mfma_f32_16x16x32_bf16 v[116:119],a[216:219],a[168:171],v[116:119]
 ds_read_b64_tr_b16 a[242:243],v20 offset:33792
 v_mfma_f32_16x16x32_bf16 v[116:119],a[220:223],a[184:187],v[116:119]
 v_mfma_f32_16x16x32_bf16 v[120:123],a[208:211],a[172:175],v[120:123]
 ds_read_b64_tr_b16 a[244:245],v20 offset:40960
 v_mfma_f32_16x16x32_bf16 v[120:123],a[212:215],a[188:191],v[120:123]
 ds_read_b64_tr_b16 a[246:247],v20 offset:41984
 v_mfma_f32_16x16x32_bf16 v[124:127],a[216:219],a[172:175],v[124:127]
 ds_read_b64_tr_b16 a[248:249],v21 offset:32768
 v_mfma_f32_16x16x32_bf16 v[124:127],a[220:223],a[188:191],v[124:127]
 s_waitcnt lgkmcnt(15)
 s_add_u32 m0,s25,32768
 ds_read_b64_tr_b16 a[250:251],v21 offset:33792
 v_mfma_f32_16x16x32_bf16 v[128:131],a[224:227],a[160:163],v[128:131]
 s_waitcnt lgkmcnt(15)
 v_mfma_f32_16x16x32_bf16 v[128:131],a[228:231],a[176:179],v[128:131]
 s_waitcnt lgkmcnt(8)
 ds_read_b64_tr_b16 a[252:253],v21 offset:40960
 buffer_load_dwordx4 v26,s[12:15],s27 offen offset:0 sc1 nt lds
 v_mfma_f32_16x16x32_bf16 v[132:135],a[232:235],a[160:163],v[132:135]
 s_waitcnt lgkmcnt(7)
 ds_read_b64_tr_b16 a[254:255],v21 offset:41984
 v_mfma_f32_16x16x32_bf16 v[132:135],a[236:239],a[176:179],v[132:135]
 v_mfma_f32_16x16x32_bf16 v[136:139],a[224:227],a[164:167],v[136:139]
 v_mfma_f32_16x16x32_bf16 v[136:139],a[228:231],a[180:183],v[136:139]
 v_mfma_f32_16x16x32_bf16 v[140:143],a[232:235],a[164:167],v[140:143]
 v_mfma_f32_16x16x32_bf16 v[140:143],a[236:239],a[180:183],v[140:143]
 v_mfma_f32_16x16x32_bf16 v[144:147],a[224:227],a[168:171],v[144:147]
 buffer_load_dwordx4 v27,s[12:15],s27 offen offset:1024 sc1 nt lds
 v_mfma_f32_16x16x32_bf16 v[144:147],a[228:231],a[184:187],v[144:147]
 v_mfma_f32_16x16x32_bf16 v[148:151],a[232:235],a[168:171],v[148:151]
 s_waitcnt vmcnt(6)
 s_waitcnt lgkmcnt(0)
 s_barrier
 v_mfma_f32_16x16x32_bf16 v[148:151],a[236:239],a[184:187],v[148:151]
 ds_read_b64_tr_b16 a[192:193],v14 offset:49152
 v_mfma_f32_16x16x32_bf16 v[152:155],a[224:227],a[172:175],v[152:155]
 v_mfma_f32_16x16x32_bf16 v[152:155],a[228:231],a[188:191],v[152:155]
 ds_read_b64_tr_b16 a[194:195],v14 offset:50176
 v_mfma_f32_16x16x32_bf16 v[156:159],a[232:235],a[172:175],v[156:159]
 ds_read_b64_tr_b16 a[196:197],v14 offset:57344
 v_mfma_f32_16x16x32_bf16 v[156:159],a[236:239],a[188:191],v[156:159]
 v_mfma_f32_16x16x32_bf16 v[160:163],a[240:243],a[160:163],v[160:163]
 ds_read_b64_tr_b16 a[198:199],v14 offset:58368
 buffer_load_dwordx4 v28,s[12:15],s27 offen offset:2048 sc1 nt lds
 v_mfma_f32_16x16x32_bf16 v[160:163],a[244:247],a[176:179],v[160:163]
 v_mfma_f32_16x16x32_bf16 v[164:167],a[248:251],a[160:163],v[164:167]
 ds_read_b64_tr_b16 a[200:201],v15 offset:49152
 v_mfma_f32_16x16x32_bf16 v[164:167],a[252:255],a[176:179],v[164:167]
 ds_read_b64_tr_b16 a[202:203],v15 offset:50176
 v_mfma_f32_16x16x32_bf16 v[168:171],a[240:243],a[164:167],v[168:171]
 v_mfma_f32_16x16x32_bf16 v[168:171],a[244:247],a[180:183],v[168:171]
 ds_read_b64_tr_b16 a[204:205],v15 offset:57344
 v_mfma_f32_16x16x32_bf16 v[172:175],a[248:251],a[164:167],v[172:175]
 ds_read_b64_tr_b16 a[206:207],v15 offset:58368
 v_mfma_f32_16x16x32_bf16 v[172:175],a[252:255],a[180:183],v[172:175]
 buffer_load_dwordx4 v29,s[12:15],s27 offen offset:3072 sc1 nt lds
 s_add_u32 s27,s27,16384
 v_mfma_f32_16x16x32_bf16 v[176:179],a[240:243],a[168:171],v[176:179]
 ds_read_b64_tr_b16 a[208:209],v16 offset:49152
 v_mfma_f32_16x16x32_bf16 v[176:179],a[244:247],a[184:187],v[176:179]
 v_mfma_f32_16x16x32_bf16 v[180:183],a[248:251],a[168:171],v[180:183]
 ds_read_b64_tr_b16 a[210:211],v16 offset:50176
 v_mfma_f32_16x16x32_bf16 v[180:183],a[252:255],a[184:187],v[180:183]
 ds_read_b64_tr_b16 a[212:213],v16 offset:57344
 v_mfma_f32_16x16x32_bf16 v[184:187],a[240:243],a[172:175],v[184:187]
 v_mfma_f32_16x16x32_bf16 v[184:187],a[244:247],a[188:191],v[184:187]
 ds_read_b64_tr_b16 a[214:215],v16 offset:58368
 v_mfma_f32_16x16x32_bf16 v[188:191],a[248:251],a[172:175],v[188:191]
 v_mfma_f32_16x16x32_bf16 v[188:191],a[252:255],a[188:191],v[188:191]
 s_waitcnt lgkmcnt(10)
 v_mfma_f32_16x16x32_bf16 v[64:67],a[192:195],a[128:131],v[64:67]
 s_waitcnt lgkmcnt(8)
 ds_read_b64_tr_b16 a[216:217],v17 offset:49152
 ds_read_b64_tr_b16 a[218:219],v17 offset:50176
 v_mfma_f32_16x16x32_bf16 v[64:67],a[196:199],a[144:147],v[64:67]
 s_waitcnt lgkmcnt(8)
 s_add_u32 m0,s25,98304
 ds_read_b64_tr_b16 a[220:221],v17 offset:57344
 ds_read_b64_tr_b16 a[222:223],v17 offset:58368
 v_mfma_f32_16x16x32_bf16 v[68:71],a[200:203],a[128:131],v[68:71]
 s_waitcnt lgkmcnt(8)
 ds_read_b64_tr_b16 a[224:225],v18 offset:49152
 buffer_load_dwordx4 v30,s[16:19],s28 offen offset:0 sc1 nt lds
 v_mfma_f32_16x16x32_bf16 v[68:71],a[204:207],a[144:147],v[68:71]
 ds_read_b64_tr_b16 a[226:227],v18 offset:50176
 ds_read_b64_tr_b16 a[228:229],v18 offset:57344
 v_mfma_f32_16x16x32_bf16 v[72:75],a[192:195],a[132:135],v[72:75]
 ds_read_b64_tr_b16 a[230:231],v18 offset:58368
 ds_read_b64_tr_b16 a[232:233],v19 offset:49152
 v_mfma_f32_16x16x32_bf16 v[72:75],a[196:199],a[148:151],v[72:75]
 ds_read_b64_tr_b16 a[234:235],v19 offset:50176
 ds_read_b64_tr_b16 a[236:237],v19 offset:57344
 v_mfma_f32_16x16x32_bf16 v[76:79],a[200:203],a[132:135],v[76:79]
 ds_read_b64_tr_b16 a[238:239],v19 offset:58368
 ds_read_b64_tr_b16 a[240:241],v20 offset:49152
 ds_read_b64_tr_b16 a[242:243],v20 offset:50176
 v_mfma_f32_16x16x32_bf16 v[76:79],a[204:207],a[148:151],v[76:79]
 s_waitcnt lgkmcnt(15)
 v_mul_f32 v64,s36,v64
 v_mul_f32 v65,s36,v65
 v_mul_f32 v66,s36,v66
 v_mul_f32 v67,s36,v67
 v_mfma_f32_16x16x32_bf16 v[96:99],a[208:211],a[128:131],v[96:99]
 s_waitcnt lgkmcnt(14)
 v_mul_f32 v68,s36,v68
 v_mul_f32 v69,s36,v69
 v_mul_f32 v70,s36,v70
 v_mul_f32 v71,s36,v71
 v_mfma_f32_16x16x32_bf16 v[96:99],a[212:215],a[144:147],v[96:99]
 s_waitcnt lgkmcnt(12)
 v_cvt_pk_bf16_f32 v64,v64,v65
 v_cvt_pk_bf16_f32 v65,v66,v67
 v_cvt_pk_bf16_f32 v66,v68,v69
 v_cvt_pk_bf16_f32 v67,v70,v71
 v_mfma_f32_16x16x32_bf16 v[100:103],a[216:219],a[128:131],v[100:103]
 s_waitcnt lgkmcnt(10)
 ds_read_b64_tr_b16 a[244:245],v20 offset:57344
 ds_read_b64_tr_b16 a[246:247],v20 offset:58368
 ds_read_b64_tr_b16 a[248:249],v21 offset:49152
 buffer_load_dwordx4 v31,s[16:19],s28 offen offset:1024 sc1 nt lds
 v_mfma_f32_16x16x32_bf16 v[100:103],a[220:223],a[144:147],v[100:103]
 v_mul_f32 v72,s36,v72
 v_mul_f32 v73,s36,v73
 v_mul_f32 v74,s36,v74
 v_mul_f32 v75,s36,v75
 v_mfma_f32_16x16x32_bf16 v[104:107],a[208:211],a[132:135],v[104:107]
 v_mul_f32 v76,s36,v76
 v_mul_f32 v77,s36,v77
 v_mul_f32 v78,s36,v78
 v_mul_f32 v79,s36,v79
 v_mfma_f32_16x16x32_bf16 v[104:107],a[212:215],a[148:151],v[104:107]
 v_permlane32_swap_b32 v64,v66
 v_permlane32_swap_b32 v65,v67
 v_mfma_f32_16x16x32_bf16 v[108:111],a[216:219],a[132:135],v[108:111]
 v_cvt_pk_bf16_f32 v72,v72,v73
 v_cvt_pk_bf16_f32 v73,v74,v75
 v_cvt_pk_bf16_f32 v74,v76,v77
 v_cvt_pk_bf16_f32 v75,v78,v79
 v_mfma_f32_16x16x32_bf16 v[108:111],a[220:223],a[148:151],v[108:111]
 s_waitcnt lgkmcnt(11)
 ds_read_b64_tr_b16 a[250:251],v21 offset:50176
 ds_read_b64_tr_b16 a[252:253],v21 offset:57344
 v_permlane16_swap_b32 v64,v66
 v_mfma_f32_16x16x32_bf16 v[128:131],a[224:227],a[128:131],v[128:131]
 s_waitcnt lgkmcnt(11)
 ds_read_b64_tr_b16 a[254:255],v21 offset:58368
 v_permlane16_swap_b32 v65,v67
 v_mul_f32 v96,s36,v96
 v_mfma_f32_16x16x32_bf16 v[128:131],a[228:231],a[144:147],v[128:131]
 s_waitcnt lgkmcnt(10)
 v_mul_f32 v97,s36,v97
 v_mul_f32 v98,s36,v98
 v_mul_f32 v99,s36,v99
 v_mul_f32 v100,s36,v100
 v_mfma_f32_16x16x32_bf16 v[132:135],a[232:235],a[128:131],v[132:135]
 s_waitcnt lgkmcnt(8)
 buffer_load_dwordx4 v30,s[16:19],s28 offen offset:2048 sc1 nt lds
 v_mul_f32 v101,s36,v101
 v_mul_f32 v102,s36,v102
 v_mul_f32 v103,s36,v103
 v_mfma_f32_16x16x32_bf16 v[132:135],a[236:239],a[144:147],v[132:135]
 v_permlane32_swap_b32 v72,v74
 v_permlane32_swap_b32 v73,v75
 v_mfma_f32_16x16x32_bf16 v[136:139],a[224:227],a[132:135],v[136:139]
 v_cvt_pk_bf16_f32 v96,v96,v97
 v_cvt_pk_bf16_f32 v97,v98,v99
 v_cvt_pk_bf16_f32 v98,v100,v101
 v_cvt_pk_bf16_f32 v99,v102,v103
 v_mfma_f32_16x16x32_bf16 v[136:139],a[228:231],a[148:151],v[136:139]
 v_permlane16_swap_b32 v72,v74
 v_permlane16_swap_b32 v73,v75
 v_mfma_f32_16x16x32_bf16 v[140:143],a[232:235],a[132:135],v[140:143]
 v_mul_f32 v104,s36,v104
 v_mul_f32 v105,s36,v105
 v_mul_f32 v106,s36,v106
 v_mul_f32 v107,s36,v107
 v_mfma_f32_16x16x32_bf16 v[140:143],a[236:239],a[148:151],v[140:143]
 s_waitcnt lgkmcnt(6)
 v_mul_f32 v108,s36,v108
 v_mul_f32 v109,s36,v109
 v_mul_f32 v110,s36,v110
 v_mul_f32 v111,s36,v111
 v_mfma_f32_16x16x32_bf16 v[160:163],a[240:243],a[128:131],v[160:163]
 s_waitcnt lgkmcnt(4)
 v_permlane32_swap_b32 v96,v98
 v_permlane32_swap_b32 v97,v99
 v_mfma_f32_16x16x32_bf16 v[160:163],a[244:247],a[144:147],v[160:163]
 s_waitcnt lgkmcnt(2)
 buffer_load_dwordx4 v31,s[16:19],s28 offen offset:3072 sc1 nt lds
 s_add_u32 s28,s28,16384
 v_cvt_pk_bf16_f32 v104,v104,v105
 v_cvt_pk_bf16_f32 v105,v106,v107
 v_mfma_f32_16x16x32_bf16 v[164:167],a[248:251],a[128:131],v[164:167]
 s_waitcnt vmcnt(63)
 s_waitcnt lgkmcnt(0)
 s_barrier
 v_cvt_pk_bf16_f32 v106,v108,v109
 v_mfma_f32_16x16x32_bf16 v[164:167],a[252:255],a[144:147],v[164:167]
 v_cvt_pk_bf16_f32 v107,v110,v111
 v_permlane16_swap_b32 v96,v98
 v_mfma_f32_16x16x32_bf16 v[168:171],a[240:243],a[132:135],v[168:171]
 v_permlane16_swap_b32 v97,v99
 v_mfma_f32_16x16x32_bf16 v[168:171],a[244:247],a[148:151],v[168:171]
 ds_read_b128 a[160:163],v2 offset:0
 v_mul_f32 v128,s36,v128
 v_mfma_f32_16x16x32_bf16 v[172:175],a[248:251],a[132:135],v[172:175]
 v_mul_f32 v129,s36,v129
 v_mul_f32 v130,s36,v130
 v_mfma_f32_16x16x32_bf16 v[172:175],a[252:255],a[148:151],v[172:175]
 v_mul_f32 v131,s36,v131
 v_mul_f32 v132,s36,v132
 v_mfma_f32_16x16x32_bf16 v[80:83],a[192:195],a[136:139],v[80:83]
 s_add_u32 m0,s25,49152
 ds_read_b128 a[164:167],v3 offset:0
 v_mul_f32 v133,s36,v133
 v_mfma_f32_16x16x32_bf16 v[80:83],a[196:199],a[152:155],v[80:83]
 ds_read_b128 a[168:171],v4 offset:0
 buffer_load_dwordx4 v26,s[12:15],s27 offen offset:0 sc1 nt lds
 v_mfma_f32_16x16x32_bf16 v[84:87],a[200:203],a[136:139],v[84:87]
 v_mul_f32 v134,s36,v134
 v_mul_f32 v135,s36,v135
 v_mfma_f32_16x16x32_bf16 v[84:87],a[204:207],a[152:155],v[84:87]
 v_permlane32_swap_b32 v104,v106
 v_permlane32_swap_b32 v105,v107
 v_mfma_f32_16x16x32_bf16 v[88:91],a[192:195],a[140:143],v[88:91]
 v_cvt_pk_bf16_f32 v128,v128,v129
 v_cvt_pk_bf16_f32 v129,v130,v131
 v_cvt_pk_bf16_f32 v130,v132,v133
 v_cvt_pk_bf16_f32 v131,v134,v135
 v_mfma_f32_16x16x32_bf16 v[88:91],a[196:199],a[156:159],v[88:91]
 v_permlane16_swap_b32 v104,v106
 v_mfma_f32_16x16x32_bf16 v[92:95],a[200:203],a[140:143],v[92:95]
 v_permlane16_swap_b32 v105,v107
 v_mfma_f32_16x16x32_bf16 v[92:95],a[204:207],a[156:159],v[92:95]
 v_mul_f32 v136,s36,v136
 v_mul_f32 v137,s36,v137
 v_mfma_f32_16x16x32_bf16 v[112:115],a[208:211],a[136:139],v[112:115]
 ds_read_b128 a[172:175],v5 offset:0
 v_mul_f32 v138,s36,v138
 v_mfma_f32_16x16x32_bf16 v[112:115],a[212:215],a[152:155],v[112:115]
 ds_read_b128 a[176:179],v2 offset:4096
 buffer_load_dwordx4 v27,s[12:15],s27 offen offset:1024 sc1 nt lds
 v_mfma_f32_16x16x32_bf16 v[116:119],a[216:219],a[136:139],v[116:119]
 v_mul_f32 v139,s36,v139
 v_mul_f32 v140,s36,v140
 v_mfma_f32_16x16x32_bf16 v[116:119],a[220:223],a[152:155],v[116:119]
 v_mul_f32 v141,s36,v141
 v_mul_f32 v142,s36,v142
 v_mul_f32 v143,s36,v143
 v_mfma_f32_16x16x32_bf16 v[120:123],a[208:211],a[140:143],v[120:123]
 v_permlane32_swap_b32 v128,v130
 v_permlane32_swap_b32 v129,v131
 v_mfma_f32_16x16x32_bf16 v[120:123],a[212:215],a[156:159],v[120:123]
 v_cvt_pk_bf16_f32 v136,v136,v137
 v_cvt_pk_bf16_f32 v137,v138,v139
 v_cvt_pk_bf16_f32 v138,v140,v141
 v_mfma_f32_16x16x32_bf16 v[124:127],a[216:219],a[140:143],v[124:127]
 ds_read_b128 a[180:183],v3 offset:4096
 v_cvt_pk_bf16_f32 v139,v142,v143
 v_mfma_f32_16x16x32_bf16 v[124:127],a[220:223],a[156:159],v[124:127]
 v_permlane16_swap_b32 v128,v130
 v_mfma_f32_16x16x32_bf16 v[144:147],a[224:227],a[136:139],v[144:147]
 v_permlane16_swap_b32 v129,v131
 v_mfma_f32_16x16x32_bf16 v[144:147],a[228:231],a[152:155],v[144:147]
 buffer_load_dwordx4 v28,s[12:15],s27 offen offset:2048 sc1 nt lds
 v_mul_f32 v160,s36,v160
 v_mfma_f32_16x16x32_bf16 v[148:151],a[232:235],a[136:139],v[148:151]
 v_mul_f32 v161,s36,v161
 v_mul_f32 v162,s36,v162
 v_mfma_f32_16x16x32_bf16 v[148:151],a[236:239],a[152:155],v[148:151]
 ds_read_b128 a[184:187],v4 offset:4096
 v_mul_f32 v163,s36,v163
 v_mfma_f32_16x16x32_bf16 v[152:155],a[224:227],a[140:143],v[152:155]
 v_mul_f32 v164,s36,v164
 v_mul_f32 v165,s36,v165
 v_mfma_f32_16x16x32_bf16 v[152:155],a[228:231],a[156:159],v[152:155]
 v_mul_f32 v166,s36,v166
 v_mul_f32 v167,s36,v167
 v_mfma_f32_16x16x32_bf16 v[156:159],a[232:235],a[140:143],v[156:159]
 v_permlane32_swap_b32 v136,v138
 v_mfma_f32_16x16x32_bf16 v[156:159],a[236:239],a[156:159],v[156:159]
 v_permlane32_swap_b32 v137,v139
 v_mfma_f32_16x16x32_bf16 v[176:179],a[240:243],a[136:139],v[176:179]
 ds_read_b128 a[188:191],v5 offset:4096
 ds_read_b128 a[224:227],v2 offset:8192
 v_mfma_f32_16x16x32_bf16 v[176:179],a[244:247],a[152:155],v[176:179]
 ds_read_b128 a[228:231],v3 offset:8192
 buffer_load_dwordx4 v29,s[12:15],s27 offen offset:3072 sc1 nt lds
 s_add_u32 s27,s27,16384
 v_mfma_f32_16x16x32_bf16 v[180:183],a[248:251],a[136:139],v[180:183]
 v_cvt_pk_bf16_f32 v160,v160,v161
 v_cvt_pk_bf16_f32 v161,v162,v163
 v_mfma_f32_16x16x32_bf16 v[180:183],a[252:255],a[152:155],v[180:183]
 v_cvt_pk_bf16_f32 v162,v164,v165
 v_cvt_pk_bf16_f32 v163,v166,v167
 v_permlane16_swap_b32 v136,v138
 v_mfma_f32_16x16x32_bf16 v[184:187],a[240:243],a[140:143],v[184:187]
 v_permlane16_swap_b32 v137,v139
 v_mul_f32 v168,s36,v168
 v_mul_f32 v169,s36,v169
 v_mfma_f32_16x16x32_bf16 v[184:187],a[244:247],a[156:159],v[184:187]
 v_mul_f32 v170,s36,v170
 v_mul_f32 v171,s36,v171
 v_mul_f32 v172,s36,v172
 v_mul_f32 v173,s36,v173
 v_mfma_f32_16x16x32_bf16 v[188:191],a[248:251],a[140:143],v[188:191]
 ds_read_b128 a[232:235],v4 offset:8192
 ds_read_b128 a[236:239],v5 offset:8192
 v_mul_f32 v174,s36,v174
 v_mul_f32 v175,s36,v175
 v_permlane32_swap_b32 v160,v162
 v_permlane32_swap_b32 v161,v163
 v_cvt_pk_bf16_f32 v168,v168,v169
 v_cvt_pk_bf16_f32 v169,v170,v171
 v_cvt_pk_bf16_f32 v170,v172,v173
 v_cvt_pk_bf16_f32 v171,v174,v175
 v_permlane16_swap_b32 v160,v162
 v_permlane16_swap_b32 v161,v163
 v_mfma_f32_16x16x32_bf16 v[188:191],a[252:255],a[156:159],v[188:191]
 s_waitcnt lgkmcnt(11)
 v_mul_f32 v80,s36,v80
 v_mul_f32 v81,s36,v81
 v_mul_f32 v82,s36,v82
 v_mul_f32 v83,s36,v83
 v_mfma_f32_16x16x32_bf16 v[68:71],a[160:163],v[64:67],0
 s_waitcnt lgkmcnt(10)
 v_mul_f32 v84,s36,v84
 v_mul_f32 v85,s36,v85
 v_mul_f32 v86,s36,v86
 v_mul_f32 v87,s36,v87
 v_mfma_f32_16x16x32_bf16 v[68:71],a[164:167],v[96:99],v[68:71]
 s_waitcnt lgkmcnt(9)
 ds_read_b128 a[240:243],v2 offset:12288
 ds_read_b128 a[244:247],v3 offset:12288
 v_permlane32_swap_b32 v168,v170
 v_mfma_f32_16x16x32_bf16 v[68:71],a[168:171],v[128:131],v[68:71]
 s_waitcnt lgkmcnt(10)
 ds_read_b128 a[248:251],v4 offset:12288
 v_permlane32_swap_b32 v169,v171
 v_cvt_pk_bf16_f32 v80,v80,v81
 v_mfma_f32_16x16x32_bf16 v[68:71],a[172:175],v[160:163],v[68:71]
 s_waitcnt lgkmcnt(10)
 ds_read_b128 a[252:255],v5 offset:12288
 v_cvt_pk_bf16_f32 v81,v82,v83
 v_cvt_pk_bf16_f32 v82,v84,v85
 v_cvt_pk_bf16_f32 v83,v86,v87
 v_mfma_f32_16x16x32_bf16 v[100:103],a[176:179],v[64:67],0
 s_waitcnt lgkmcnt(10)
 v_permlane16_swap_b32 v168,v170
 v_permlane16_swap_b32 v169,v171
 v_mfma_f32_16x16x32_bf16 v[100:103],a[180:183],v[96:99],v[100:103]
 s_waitcnt lgkmcnt(9)
 v_mul_f32 v88,s36,v88
 v_mul_f32 v89,s36,v89
 v_mul_f32 v90,s36,v90
 v_mul_f32 v91,s36,v91
 v_mfma_f32_16x16x32_bf16 v[100:103],a[184:187],v[128:131],v[100:103]
 s_waitcnt lgkmcnt(8)
 v_mul_f32 v92,s36,v92
 v_mul_f32 v93,s36,v93
 v_mul_f32 v94,s36,v94
 v_mul_f32 v95,s36,v95
 v_mfma_f32_16x16x32_bf16 v[100:103],a[188:191],v[160:163],v[100:103]
 v_permlane32_swap_b32 v80,v82
 v_permlane32_swap_b32 v81,v83
 v_mfma_f32_16x16x32_bf16 v[76:79],a[160:163],v[72:75],0
 v_cvt_pk_bf16_f32 v88,v88,v89
 v_cvt_pk_bf16_f32 v89,v90,v91
 v_cvt_pk_bf16_f32 v90,v92,v93
 v_cvt_pk_bf16_f32 v91,v94,v95
 v_mfma_f32_16x16x32_bf16 v[76:79],a[164:167],v[104:107],v[76:79]
 v_permlane16_swap_b32 v80,v82
 v_permlane16_swap_b32 v81,v83
 v_mfma_f32_16x16x32_bf16 v[76:79],a[168:171],v[136:139],v[76:79]
 v_mul_f32 v112,s36,v112
 v_mul_f32 v113,s36,v113
 v_mul_f32 v114,s36,v114
 v_mul_f32 v115,s36,v115
 v_mfma_f32_16x16x32_bf16 v[76:79],a[172:175],v[168:171],v[76:79]
 s_waitcnt vmcnt(63)
 s_waitcnt lgkmcnt(0)
 s_barrier
 v_mul_f32 v116,s36,v116
 v_mfma_f32_16x16x32_bf16 v[108:111],a[176:179],v[72:75],0
 v_mul_f32 v117,s36,v117
 v_mul_f32 v118,s36,v118
 v_mfma_f32_16x16x32_bf16 v[108:111],a[180:183],v[104:107],v[108:111]
 ds_read_b128 a[192:195],v2 offset:16384
 v_mul_f32 v119,s36,v119
 v_mfma_f32_16x16x32_bf16 v[108:111],a[184:187],v[136:139],v[108:111]
 v_permlane32_swap_b32 v88,v90
 v_permlane32_swap_b32 v89,v91
 v_cvt_pk_bf16_f32 v112,v112,v113
 v_cvt_pk_bf16_f32 v113,v114,v115
 v_cvt_pk_bf16_f32 v114,v116,v117
 v_cvt_pk_bf16_f32 v115,v118,v119
 v_permlane16_swap_b32 v88,v90
 v_permlane16_swap_b32 v89,v91
 v_mul_f32 v120,s36,v120
 v_mul_f32 v121,s36,v121
 v_mul_f32 v122,s36,v122
 v_mul_f32 v123,s36,v123
 v_mul_f32 v124,s36,v124
 v_mul_f32 v125,s36,v125
 v_mul_f32 v126,s36,v126
 v_mul_f32 v127,s36,v127
 v_permlane32_swap_b32 v112,v114
 v_permlane32_swap_b32 v113,v115
 v_cvt_pk_bf16_f32 v120,v120,v121
 v_cvt_pk_bf16_f32 v121,v122,v123
 v_cvt_pk_bf16_f32 v122,v124,v125
 v_cvt_pk_bf16_f32 v123,v126,v127
 v_permlane16_swap_b32 v112,v114
 v_permlane16_swap_b32 v113,v115
 v_mul_f32 v144,s36,v144
 v_mul_f32 v145,s36,v145
 v_mul_f32 v146,s36,v146
 v_mul_f32 v147,s36,v147
 v_mul_f32 v148,s36,v148
 v_mul_f32 v149,s36,v149
 v_mul_f32 v150,s36,v150
 v_mul_f32 v151,s36,v151
 v_permlane32_swap_b32 v120,v122
 v_permlane32_swap_b32 v121,v123
 v_cvt_pk_bf16_f32 v144,v144,v145
 v_cvt_pk_bf16_f32 v145,v146,v147
 v_cvt_pk_bf16_f32 v146,v148,v149
 v_cvt_pk_bf16_f32 v147,v150,v151
 v_permlane16_swap_b32 v120,v122
 v_permlane16_swap_b32 v121,v123
 v_mul_f32 v152,s36,v152
 v_mul_f32 v153,s36,v153
 v_mul_f32 v154,s36,v154
 v_mul_f32 v155,s36,v155
 v_mul_f32 v156,s36,v156
 v_mul_f32 v157,s36,v157
 v_mul_f32 v158,s36,v158
 v_mul_f32 v159,s36,v159
 v_permlane32_swap_b32 v144,v146
 v_permlane32_swap_b32 v145,v147
 v_cvt_pk_bf16_f32 v152,v152,v153
 v_cvt_pk_bf16_f32 v153,v154,v155
 v_cvt_pk_bf16_f32 v154,v156,v157
 v_cvt_pk_bf16_f32 v155,v158,v159
 v_permlane16_swap_b32 v144,v146
 v_permlane16_swap_b32 v145,v147
 v_mul_f32 v176,s36,v176
 v_mul_f32 v177,s36,v177
 v_mul_f32 v178,s36,v178
 v_mul_f32 v179,s36,v179
 v_mul_f32 v180,s36,v180
 v_mul_f32 v181,s36,v181
 v_mul_f32 v182,s36,v182
 v_mul_f32 v183,s36,v183
 v_permlane32_swap_b32 v152,v154
 v_permlane32_swap_b32 v153,v155
 v_cvt_pk_bf16_f32 v176,v176,v177
 v_cvt_pk_bf16_f32 v177,v178,v179
 v_cvt_pk_bf16_f32 v178,v180,v181
 v_cvt_pk_bf16_f32 v179,v182,v183
 v_permlane16_swap_b32 v152,v154
 v_permlane16_swap_b32 v153,v155
 v_mul_f32 v184,s36,v184
 v_mul_f32 v185,s36,v185
 v_mul_f32 v186,s36,v186
 v_mul_f32 v187,s36,v187
 v_mul_f32 v188,s36,v188
 v_mul_f32 v189,s36,v189
 v_mul_f32 v190,s36,v190
 v_mul_f32 v191,s36,v191
 v_permlane32_swap_b32 v176,v178
 v_permlane32_swap_b32 v177,v179
 v_cvt_pk_bf16_f32 v184,v184,v185
 v_cvt_pk_bf16_f32 v185,v186,v187
 v_cvt_pk_bf16_f32 v186,v188,v189
 v_cvt_pk_bf16_f32 v187,v190,v191
 v_permlane16_swap_b32 v176,v178
 v_permlane16_swap_b32 v177,v179
 v_mfma_f32_16x16x32_bf16 v[108:111],a[188:191],v[168:171],v[108:111]
 s_nop 1
 v_permlane32_swap_b32 v184,v186
 v_mfma_f32_16x16x32_bf16 v[84:87],a[160:163],v[80:83],0
 v_permlane32_swap_b32 v185,v187
 s_nop 1
 v_mfma_f32_16x16x32_bf16 v[84:87],a[164:167],v[112:115],v[84:87]
 v_permlane16_swap_b32 v184,v186
 v_mfma_f32_16x16x32_bf16 v[84:87],a[168:171],v[144:147],v[84:87]
 v_permlane16_swap_b32 v185,v187
 s_nop 0
 v_mfma_f32_16x16x32_bf16 v[84:87],a[172:175],v[176:179],v[84:87]
 ds_read_b128 a[196:199],v3 offset:16384
 ds_read_b128 a[200:203],v4 offset:16384
 v_mfma_f32_16x16x32_bf16 v[116:119],a[176:179],v[80:83],0
 v_max3_f32 v40,v68,v69,v70
 v_max3_f32 v41,v76,v77,v78
 v_max3_f32 v44,v71,v100,v101
 v_max3_f32 v45,v79,v108,v109
 v_mfma_f32_16x16x32_bf16 v[116:119],a[180:183],v[112:115],v[116:119]
 v_max3_f32 v40,v40,v102,v103
 v_max3_f32 v41,v41,v110,v111
 v_max_f32 v40,v40,v44
 v_max_f32 v41,v41,v45
 v_mfma_f32_16x16x32_bf16 v[116:119],a[184:187],v[144:147],v[116:119]
 v_mov_b32 v44,v40
 v_mov_b32 v45,v41
 s_nop 0
 v_permlane32_swap_b32 v40,v44
 v_mfma_f32_16x16x32_bf16 v[116:119],a[188:191],v[176:179],v[116:119]
 v_permlane32_swap_b32 v41,v45
 v_max_f32 v40,v40,v44
 v_max_f32 v41,v41,v45
 v_mfma_f32_16x16x32_bf16 v[92:95],a[160:163],v[88:91],0
 v_mov_b32 v44,v40
 v_mov_b32 v45,v41
 s_nop 0
 v_permlane16_swap_b32 v40,v44
 v_mfma_f32_16x16x32_bf16 v[92:95],a[164:167],v[120:123],v[92:95]
 v_permlane16_swap_b32 v41,v45
 v_max_f32 v40,v40,v44
 v_max_f32 v41,v41,v45
 v_mfma_f32_16x16x32_bf16 v[92:95],a[168:171],v[152:155],v[92:95]
 v_sub_f32 v224,0,v40
 v_sub_f32 v225,0,v40
 v_sub_f32 v226,0,v40
 v_mfma_f32_16x16x32_bf16 v[92:95],a[172:175],v[184:187],v[92:95]
 v_sub_f32 v227,0,v40
 v_sub_f32 v228,0,v41
 v_mfma_f32_16x16x32_bf16 v[124:127],a[176:179],v[88:91],0
 v_sub_f32 v229,0,v41
 v_sub_f32 v230,0,v41
 v_mfma_f32_16x16x32_bf16 v[124:127],a[180:183],v[120:123],v[124:127]
 v_sub_f32 v231,0,v41
 v_sub_f32 v68,v68,v40
 v_mfma_f32_16x16x32_bf16 v[124:127],a[184:187],v[152:155],v[124:127]
 v_sub_f32 v69,v69,v40
 v_sub_f32 v70,v70,v40
 v_mfma_f32_16x16x32_bf16 v[124:127],a[188:191],v[184:187],v[124:127]
 v_exp_f32 v68,v68
 v_mfma_f32_16x16x32_bf16 v[132:135],a[224:227],v[64:67],v[224:227]
 ds_read_b128 a[204:207],v5 offset:16384
 v_sub_f32 v71,v71,v40
 v_mfma_f32_16x16x32_bf16 v[132:135],a[228:231],v[96:99],v[132:135]
 v_exp_f32 v69,v69
 v_mfma_f32_16x16x32_bf16 v[132:135],a[232:235],v[128:131],v[132:135]
 ds_read_b128 a[208:211],v2 offset:20480
 v_sub_f32 v100,v100,v40
 v_mfma_f32_16x16x32_bf16 v[132:135],a[236:239],v[160:163],v[132:135]
 v_exp_f32 v70,v70
 v_mfma_f32_16x16x32_bf16 v[164:167],a[240:243],v[64:67],v[224:227]
 v_mov_b32 v48,0x3f803f80
 v_accvgpr_write_b32 a188,v48
 v_accvgpr_write_b32 a189,v48
 v_accvgpr_write_b32 a190,v48
 v_mfma_f32_16x16x32_bf16 v[164:167],a[244:247],v[96:99],v[164:167]
 v_accvgpr_write_b32 a191,v48
 v_max3_f32 v42,v84,v85,v86
 v_max3_f32 v43,v92,v93,v94
 v_max3_f32 v46,v87,v116,v117
 v_mfma_f32_16x16x32_bf16 v[164:167],a[248:251],v[128:131],v[164:167]
 v_max3_f32 v47,v95,v124,v125
 v_max3_f32 v42,v42,v118,v119
 v_max3_f32 v43,v43,v126,v127
 v_mfma_f32_16x16x32_bf16 v[164:167],a[252:255],v[160:163],v[164:167]
 v_max_f32 v42,v42,v46
 v_max_f32 v43,v43,v47
 v_mfma_f32_16x16x32_bf16 v[140:143],a[224:227],v[72:75],v[228:231]
 v_mov_b32 v46,v42
 v_mov_b32 v47,v43
 v_mfma_f32_16x16x32_bf16 v[140:143],a[228:231],v[104:107],v[140:143]
 s_nop 0
 v_permlane32_swap_b32 v42,v46
 v_mfma_f32_16x16x32_bf16 v[140:143],a[232:235],v[136:139],v[140:143]
 v_permlane32_swap_b32 v43,v47
 v_max_f32 v42,v42,v46
 v_mfma_f32_16x16x32_bf16 v[140:143],a[236:239],v[168:171],v[140:143]
 ds_read_b128 a[212:215],v3 offset:20480
 v_max_f32 v43,v43,v47
 v_mfma_f32_16x16x32_bf16 v[172:175],a[240:243],v[72:75],v[228:231]
 v_mov_b32 v46,v42
 v_mov_b32 v47,v43
 v_mfma_f32_16x16x32_bf16 v[172:175],a[244:247],v[104:107],v[172:175]
 s_nop 0
 v_permlane16_swap_b32 v42,v46
 v_permlane16_swap_b32 v43,v47
 v_max_f32 v42,v42,v46
 v_max_f32 v43,v43,v47
 v_sub_f32 v232,0,v42
 v_sub_f32 v233,0,v42
 v_sub_f32 v234,0,v42
 v_sub_f32 v235,0,v42
 v_mfma_f32_16x16x32_bf16 v[172:175],a[248:251],v[136:139],v[172:175]
 v_sub_f32 v236,0,v43
 v_sub_f32 v237,0,v43
 v_sub_f32 v238,0,v43
 v_mfma_f32_16x16x32_bf16 v[172:175],a[252:255],v[168:171],v[172:175]
 v_sub_f32 v239,0,v43
 v_sub_f32 v84,v84,v42
 v_mfma_f32_16x16x32_bf16 v[148:151],a[224:227],v[80:83],v[232:235]
 v_sub_f32 v85,v85,v42
 v_sub_f32 v86,v86,v42
 v_mfma_f32_16x16x32_bf16 v[148:151],a[228:231],v[112:115],v[148:151]
 v_exp_f32 v84,v84
 v_mfma_f32_16x16x32_bf16 v[148:151],a[232:235],v[144:147],v[148:151]
 ds_read_b128 a[216:219],v4 offset:20480
 v_sub_f32 v87,v87,v42
 v_mfma_f32_16x16x32_bf16 v[148:151],a[236:239],v[176:179],v[148:151]
 v_exp_f32 v85,v85
 v_sub_f32 v116,v116,v42
 v_mfma_f32_16x16x32_bf16 v[180:183],a[240:243],v[80:83],v[232:235]
 v_exp_f32 v86,v86
 v_sub_f32 v117,v117,v42
 v_mfma_f32_16x16x32_bf16 v[180:183],a[244:247],v[112:115],v[180:183]
 v_exp_f32 v87,v87
 v_mfma_f32_16x16x32_bf16 v[180:183],a[248:251],v[144:147],v[180:183]
 v_cvt_pk_bf16_f32 v200,v84,v85
 v_sub_f32 v118,v118,v42
 v_mfma_f32_16x16x32_bf16 v[180:183],a[252:255],v[176:179],v[180:183]
 v_exp_f32 v116,v116
 v_sub_f32 v119,v119,v42
 v_mfma_f32_16x16x32_bf16 v[156:159],a[224:227],v[88:91],v[236:239]
 ds_read_b128 a[220:223],v5 offset:20480
 v_exp_f32 v117,v117
 v_mfma_f32_16x16x32_bf16 v[156:159],a[228:231],v[120:123],v[156:159]
 v_cvt_pk_bf16_f32 v201,v86,v87
 v_sub_f32 v92,v92,v43
 v_mfma_f32_16x16x32_bf16 v[156:159],a[232:235],v[152:155],v[156:159]
 v_exp_f32 v118,v118
 v_sub_f32 v93,v93,v43
 v_mfma_f32_16x16x32_bf16 v[156:159],a[236:239],v[184:187],v[156:159]
 v_exp_f32 v119,v119
 v_mfma_f32_16x16x32_bf16 v[188:191],a[240:243],v[88:91],v[236:239]
 v_cvt_pk_bf16_f32 v202,v116,v117
 v_sub_f32 v94,v94,v43
 v_mfma_f32_16x16x32_bf16 v[188:191],a[244:247],v[120:123],v[188:191]
 v_exp_f32 v92,v92
 v_mfma_f32_16x16x32_bf16 v[188:191],a[248:251],v[152:155],v[188:191]
 v_sub_f32 v95,v95,v43
 v_exp_f32 v93,v93
 v_mfma_f32_16x16x32_bf16 v[188:191],a[252:255],v[184:187],v[188:191]
 v_sub_f32 v101,v101,v40
 v_exp_f32 v71,v71
 v_cvt_pk_bf16_f32 v192,v68,v69
 v_sub_f32 v102,v102,v40
 v_exp_f32 v100,v100
 v_sub_f32 v103,v103,v40
 v_exp_f32 v101,v101
 v_cvt_pk_bf16_f32 v193,v70,v71
 v_sub_f32 v76,v76,v41
 v_exp_f32 v102,v102
 v_sub_f32 v77,v77,v41
 v_exp_f32 v103,v103
 v_cvt_pk_bf16_f32 v194,v100,v101
 v_sub_f32 v78,v78,v41
 v_exp_f32 v76,v76
 v_sub_f32 v79,v79,v41
 v_exp_f32 v77,v77
 v_cvt_pk_bf16_f32 v195,v102,v103
 v_sub_f32 v108,v108,v41
 v_exp_f32 v78,v78
 v_sub_f32 v109,v109,v41
 v_exp_f32 v79,v79
 v_cvt_pk_bf16_f32 v196,v76,v77
 v_sub_f32 v110,v110,v41
 v_exp_f32 v108,v108
 v_sub_f32 v111,v111,v41
 v_exp_f32 v109,v109
 v_cvt_pk_bf16_f32 v197,v78,v79
 v_exp_f32 v110,v110
 v_exp_f32 v111,v111
 v_cvt_pk_bf16_f32 v198,v108,v109
 v_cvt_pk_bf16_f32 v199,v110,v111
 v_cvt_pk_bf16_f32 v203,v118,v119
 v_sub_f32 v124,v124,v43
 v_exp_f32 v94,v94
 v_sub_f32 v125,v125,v43
 v_exp_f32 v95,v95
 v_cvt_pk_bf16_f32 v204,v92,v93
 v_sub_f32 v126,v126,v43
 v_exp_f32 v124,v124
 v_sub_f32 v127,v127,v43
 v_exp_f32 v125,v125
 v_cvt_pk_bf16_f32 v205,v94,v95
 v_exp_f32 v126,v126
 v_exp_f32 v127,v127
 v_cvt_pk_bf16_f32 v206,v124,v125
 v_cvt_pk_bf16_f32 v207,v126,v127
 s_add_u32 s31,s31,4096
 s_mov_b32 s33,1
 s_mov_b32 s29,1073741824
 s_mov_b32 s30,1073741824
 s_mov_b32 s66,s58
 s_mov_b32 s94,s93
 s_bfe_u32 s68,s2,0x10003
 s_lshl_b32 s68,s68,13
 s_add_u32 s95,s68,K1_op-K1_pc
 s_add_u32 s95,s95,s26
 s_branch K1_attn
K1_fin:
 s_waitcnt lgkmcnt(7)
 v_mfma_f32_16x16x32_bf16 v[68:71],a[192:195],v[64:67],v[224:227]
 s_waitcnt lgkmcnt(6)
 v_exp_f32 v132,v132
 v_mfma_f32_16x16x32_bf16 v[68:71],a[196:199],v[96:99],v[68:71]
 s_waitcnt lgkmcnt(5)
 v_exp_f32 v133,v133
 v_mfma_f32_16x16x32_bf16 v[68:71],a[200:203],v[128:131],v[68:71]
 s_waitcnt lgkmcnt(4)
 ds_read_b64_tr_b16 a[224:225],v6 offset:16384
 ds_read_b64_tr_b16 a[226:227],v6 offset:20480
 v_mfma_f32_16x16x32_bf16 v[68:71],a[204:207],v[160:163],v[68:71]
 s_mov_b32 m0,162816
 v_exp_f32 v134,v134
 v_mfma_f32_16x16x32_bf16 v[76:79],a[192:195],v[72:75],v[228:231]
 s_add_u32 s35,s93,0
 buffer_load_dwordx4 v252,s[88:91],s35 offen lds
 v_add_u32 v22,0,v0
 v_mfma_f32_16x16x32_bf16 v[76:79],a[196:199],v[104:107],v[76:79]
 v_exp_f32 v135,v135
 v_mfma_f32_16x16x32_bf16 v[76:79],a[200:203],v[136:139],v[76:79]
 ds_read_b64_tr_b16 a[228:229],v6 offset:24576
 v_cvt_pk_bf16_f32 v208,v132,v133
 v_mfma_f32_16x16x32_bf16 v[76:79],a[204:207],v[168:171],v[76:79]
 v_exp_f32 v140,v140
 v_mfma_f32_16x16x32_bf16 v[84:87],a[192:195],v[80:83],v[232:235]
 ds_read_b64_tr_b16 a[230:231],v6 offset:28672
 v_mul_u32_u24 v23,2731,v22
 v_mfma_f32_16x16x32_bf16 v[84:87],a[196:199],v[112:115],v[84:87]
 v_exp_f32 v141,v141
 v_mfma_f32_16x16x32_bf16 v[84:87],a[200:203],v[144:147],v[84:87]
 v_cvt_pk_bf16_f32 v209,v134,v135
 v_lshrrev_b32 v23,16,v23
 v_mfma_f32_16x16x32_bf16 v[84:87],a[204:207],v[176:179],v[84:87]
 v_exp_f32 v142,v142
 v_mfma_f32_16x16x32_bf16 v[92:95],a[192:195],v[88:91],v[236:239]
 s_add_u32 s35,s93,1024
 ds_read_b64_tr_b16 a[232:233],v7 offset:16384
 buffer_load_dwordx4 v252,s[88:91],s35 offen lds
 v_mfma_f32_16x16x32_bf16 v[92:95],a[196:199],v[120:123],v[92:95]
 ds_read_b64_tr_b16 a[234:235],v7 offset:20480
 v_mul_u32_u24 v24,24,v23
 v_mfma_f32_16x16x32_bf16 v[92:95],a[200:203],v[152:155],v[92:95]
 v_exp_f32 v143,v143
 v_mfma_f32_16x16x32_bf16 v[92:95],a[204:207],v[184:187],v[92:95]
 s_waitcnt lgkmcnt(9)
 v_cvt_pk_bf16_f32 v212,v140,v141
 v_sub_u32 v22,v22,v24
 v_mfma_f32_16x16x32_bf16 v[100:103],a[208:211],v[64:67],v[224:227]
 s_waitcnt lgkmcnt(8)
 v_exp_f32 v148,v148
 v_mfma_f32_16x16x32_bf16 v[100:103],a[212:215],v[96:99],v[100:103]
 s_waitcnt lgkmcnt(7)
 v_exp_f32 v149,v149
 v_mfma_f32_16x16x32_bf16 v[100:103],a[216:219],v[128:131],v[100:103]
 s_waitcnt lgkmcnt(6)
 v_cvt_pk_bf16_f32 v213,v142,v143
 v_and_b32 v24,6,v23
 v_mfma_f32_16x16x32_bf16 v[100:103],a[220:223],v[160:163],v[100:103]
 ds_read_b128 a[192:195],v2 offset:40960
 ds_read_b128 a[196:199],v3 offset:40960
 v_mfma_f32_16x16x32_bf16 v[108:111],a[208:211],v[72:75],v[228:231]
 v_exp_f32 v150,v150
 v_mfma_f32_16x16x32_bf16 v[108:111],a[212:215],v[104:107],v[108:111]
 s_add_u32 s35,s93,2048
 buffer_load_dwordx4 v252,s[88:91],s35 offen lds
 v_xor_b32 v22,v22,v24
 v_mfma_f32_16x16x32_bf16 v[108:111],a[216:219],v[136:139],v[108:111]
 v_exp_f32 v151,v151
 v_mfma_f32_16x16x32_bf16 v[108:111],a[220:223],v[168:171],v[108:111]
 ds_read_b128 a[200:203],v4 offset:40960
 v_cvt_pk_bf16_f32 v216,v148,v149
 v_mfma_f32_16x16x32_bf16 v[116:119],a[208:211],v[80:83],v[232:235]
 ds_read_b128 a[204:207],v5 offset:40960
 v_add_u32 v22,s101,v22
 v_mfma_f32_16x16x32_bf16 v[116:119],a[212:215],v[112:115],v[116:119]
 v_exp_f32 v156,v156
 v_mfma_f32_16x16x32_bf16 v[116:119],a[216:219],v[144:147],v[116:119]
 v_exp_f32 v157,v157
 v_mfma_f32_16x16x32_bf16 v[116:119],a[220:223],v[176:179],v[116:119]
 v_cvt_pk_bf16_f32 v217,v150,v151
 v_subrev_u32 v24,24,v22
 v_mfma_f32_16x16x32_bf16 v[124:127],a[208:211],v[88:91],v[236:239]
 v_exp_f32 v158,v158
 v_mfma_f32_16x16x32_bf16 v[124:127],a[212:215],v[120:123],v[124:127]
 s_add_u32 s35,s93,3072
 buffer_load_dwordx4 v252,s[88:91],s35 offen lds
 v_min_u32 v22,v22,v24
 v_mfma_f32_16x16x32_bf16 v[124:127],a[216:219],v[152:155],v[124:127]
 ds_read_b64_tr_b16 a[236:237],v7 offset:24576
 ds_read_b64_tr_b16 a[238:239],v7 offset:28672
 v_mfma_f32_16x16x32_bf16 v[124:127],a[220:223],v[184:187],v[124:127]
 s_waitcnt lgkmcnt(5)
 v_exp_f32 v159,v159
 v_mfma_f32_16x16x32_bf16 v[132:135],a[192:195],v[64:67],v[224:227]
 s_waitcnt lgkmcnt(4)
 v_cvt_pk_bf16_f32 v220,v156,v157
 v_mul_u32_u24 v23,1152,v23
 v_mfma_f32_16x16x32_bf16 v[132:135],a[196:199],v[96:99],v[132:135]
 s_waitcnt lgkmcnt(3)
 v_exp_f32 v164,v164
 v_mfma_f32_16x16x32_bf16 v[132:135],a[200:203],v[128:131],v[132:135]
 s_waitcnt lgkmcnt(2)
 ds_read_b128 a[208:211],v2 offset:45056
 v_lshl_add_u32 v14,v22,4,v23
 v_mfma_f32_16x16x32_bf16 v[132:135],a[204:207],v[160:163],v[132:135]
 v_exp_f32 v165,v165
 v_mfma_f32_16x16x32_bf16 v[140:143],a[192:195],v[72:75],v[228:231]
 ds_read_b128 a[212:215],v3 offset:45056
 v_cvt_pk_bf16_f32 v221,v158,v159
 v_mfma_f32_16x16x32_bf16 v[140:143],a[196:199],v[104:107],v[140:143]
 s_add_u32 s35,s93,4096
 buffer_load_dwordx4 v252,s[88:91],s35 offen lds
 v_add_u32 v22,64,v0
 v_mfma_f32_16x16x32_bf16 v[140:143],a[200:203],v[136:139],v[140:143]
 v_exp_f32 v166,v166
 v_mfma_f32_16x16x32_bf16 v[140:143],a[204:207],v[168:171],v[140:143]
 v_exp_f32 v167,v167
 v_mfma_f32_16x16x32_bf16 v[148:151],a[192:195],v[80:83],v[232:235]
 ds_read_b128 a[216:219],v4 offset:45056
 ds_read_b128 a[220:223],v5 offset:45056
 v_mfma_f32_16x16x32_bf16 v[148:151],a[196:199],v[112:115],v[148:151]
 v_cvt_pk_bf16_f32 v210,v164,v165
 v_mul_u32_u24 v23,2731,v22
 v_mfma_f32_16x16x32_bf16 v[148:151],a[200:203],v[144:147],v[148:151]
 v_exp_f32 v172,v172
 v_mfma_f32_16x16x32_bf16 v[148:151],a[204:207],v[176:179],v[148:151]
 v_exp_f32 v173,v173
 v_mfma_f32_16x16x32_bf16 v[156:159],a[192:195],v[88:91],v[236:239]
 v_cvt_pk_bf16_f32 v211,v166,v167
 v_lshrrev_b32 v23,16,v23
 v_mfma_f32_16x16x32_bf16 v[156:159],a[196:199],v[120:123],v[156:159]
 s_add_u32 s35,s93,5120
 ds_read_b64_tr_b16 a[240:241],v8 offset:16384
 buffer_load_dwordx4 v252,s[88:91],s35 offen lds
 v_mfma_f32_16x16x32_bf16 v[156:159],a[200:203],v[152:155],v[156:159]
 v_exp_f32 v174,v174
 v_mfma_f32_16x16x32_bf16 v[156:159],a[204:207],v[184:187],v[156:159]
 s_waitcnt lgkmcnt(4)
 v_exp_f32 v175,v175
 v_mfma_f32_16x16x32_bf16 v[164:167],a[208:211],v[64:67],v[224:227]
 s_waitcnt lgkmcnt(3)
 ds_read_b64_tr_b16 a[242:243],v8 offset:20480
 v_cvt_pk_bf16_f32 v214,v172,v173
 v_mfma_f32_16x16x32_bf16 v[164:167],a[212:215],v[96:99],v[164:167]
 s_waitcnt lgkmcnt(3)
 v_exp_f32 v180,v180
 v_mfma_f32_16x16x32_bf16 v[164:167],a[216:219],v[128:131],v[164:167]
 s_waitcnt lgkmcnt(2)
 v_exp_f32 v181,v181
 v_mfma_f32_16x16x32_bf16 v[164:167],a[220:223],v[160:163],v[164:167]
 ds_read_b64_tr_b16 a[244:245],v8 offset:24576
 v_cvt_pk_bf16_f32 v215,v174,v175
 v_mfma_f32_16x16x32_bf16 v[172:175],a[208:211],v[72:75],v[228:231]
 v_exp_f32 v182,v182
 v_mfma_f32_16x16x32_bf16 v[172:175],a[212:215],v[104:107],v[172:175]
 v_exp_f32 v183,v183
 v_mfma_f32_16x16x32_bf16 v[172:175],a[216:219],v[136:139],v[172:175]
 s_add_u32 s35,s93,6144
 buffer_load_dwordx4 v252,s[88:91],s35 offen lds
 v_cvt_pk_bf16_f32 v218,v180,v181
 v_mfma_f32_16x16x32_bf16 v[172:175],a[220:223],v[168:171],v[172:175]
 v_exp_f32 v188,v188
 v_exp_f32 v189,v189
 v_cvt_pk_bf16_f32 v219,v182,v183
 v_mfma_f32_16x16x32_bf16 v[180:183],a[208:211],v[80:83],v[232:235]
 v_mul_u32_u24 v24,24,v23
 v_sub_u32 v22,v22,v24
 v_mfma_f32_16x16x32_bf16 v[180:183],a[212:215],v[112:115],v[180:183]
 v_exp_f32 v190,v190
 v_mfma_f32_16x16x32_bf16 v[180:183],a[216:219],v[144:147],v[180:183]
 v_exp_f32 v191,v191
 v_mfma_f32_16x16x32_bf16 v[180:183],a[220:223],v[176:179],v[180:183]
 v_cvt_pk_bf16_f32 v222,v188,v189
 v_cvt_pk_bf16_f32 v223,v190,v191
 v_mfma_f32_16x16x32_bf16 v[188:191],a[208:211],v[88:91],v[236:239]
 v_and_b32 v24,6,v23
 v_xor_b32 v22,v22,v24
 v_mfma_f32_16x16x32_bf16 v[188:191],a[212:215],v[120:123],v[188:191]
 ds_read_b64_tr_b16 a[246:247],v8 offset:28672
 ds_read_b64_tr_b16 a[248:249],v9 offset:16384
 v_mfma_f32_16x16x32_bf16 v[188:191],a[216:219],v[152:155],v[188:191]
 s_add_u32 s35,s93,7168
 ds_read_b64_tr_b16 a[250:251],v9 offset:20480
 buffer_load_dwordx4 v252,s[88:91],s35 offen lds
 v_mfma_f32_16x16x32_bf16 v[188:191],a[220:223],v[184:187],v[188:191]
 v_add_u32 v22,s101,v22
 v_subrev_u32 v24,24,v22
 v_mfma_f32_16x16x32_bf16 a[0:3],a[224:227],v[48:51],a[0:3]
 v_exp_f32 v68,v68
 v_mfma_f32_16x16x32_bf16 a[0:3],a[228:231],v[208:211],a[0:3]
 v_min_u32 v22,v22,v24
 v_mul_u32_u24 v23,1152,v23
 v_mfma_f32_16x16x32_bf16 a[4:7],a[224:227],v[52:55],a[4:7]
 v_exp_f32 v69,v69
 v_mfma_f32_16x16x32_bf16 a[4:7],a[228:231],v[212:215],a[4:7]
 v_exp_f32 v70,v70
 v_mfma_f32_16x16x32_bf16 a[8:11],a[224:227],v[60:63],a[8:11]
 ds_read_b64_tr_b16 a[252:253],v9 offset:24576
 v_lshl_add_u32 v15,v22,4,v23
 v_mfma_f32_16x16x32_bf16 a[8:11],a[228:231],v[216:219],a[8:11]
 v_exp_f32 v71,v71
 v_mfma_f32_16x16x32_bf16 a[12:15],a[224:227],v[26:29],a[12:15]
 s_add_u32 s35,s93,8192
 ds_read_b64_tr_b16 a[254:255],v9 offset:28672
 buffer_load_dwordx4 v252,s[88:91],s35 offen lds
 v_mfma_f32_16x16x32_bf16 a[12:15],a[228:231],v[220:223],a[12:15]
 v_cvt_pk_bf16_f32 v192,v68,v69
 v_add_u32 v22,128,v0
 v_mfma_f32_16x16x32_bf16 a[16:19],a[232:235],v[48:51],a[16:19]
 v_exp_f32 v100,v100
 v_mfma_f32_16x16x32_bf16 a[16:19],a[236:239],v[208:211],a[16:19]
 ds_read_b64_tr_b16 a[224:225],v10 offset:16384
 ds_read_b64_tr_b16 a[226:227],v10 offset:20480
 v_mfma_f32_16x16x32_bf16 a[20:23],a[232:235],v[52:55],a[20:23]
 ds_read_b64_tr_b16 a[228:229],v10 offset:24576
 v_mul_u32_u24 v23,2731,v22
 v_mfma_f32_16x16x32_bf16 a[20:23],a[236:239],v[212:215],a[20:23]
 v_exp_f32 v101,v101
 v_mfma_f32_16x16x32_bf16 a[24:27],a[232:235],v[60:63],a[24:27]
 ds_read_b64_tr_b16 a[230:231],v10 offset:28672
 v_cvt_pk_bf16_f32 v193,v70,v71
 v_mfma_f32_16x16x32_bf16 a[24:27],a[236:239],v[216:219],a[24:27]
 v_exp_f32 v102,v102
 v_mfma_f32_16x16x32_bf16 a[28:31],a[232:235],v[26:29],a[28:31]
 v_exp_f32 v103,v103
 v_mfma_f32_16x16x32_bf16 a[28:31],a[236:239],v[220:223],a[28:31]
 s_waitcnt lgkmcnt(10)
 v_lshrrev_b32 v23,16,v23
 v_mul_u32_u24 v24,24,v23
 v_mfma_f32_16x16x32_bf16 a[32:35],a[240:243],v[48:51],a[32:35]
 s_waitcnt lgkmcnt(8)
 ds_read_b64_tr_b16 a[232:233],v11 offset:16384
 v_cvt_pk_bf16_f32 v194,v100,v101
 v_mfma_f32_16x16x32_bf16 a[32:35],a[244:247],v[208:211],a[32:35]
 s_add_u32 s35,s93,9216
 ds_read_b64_tr_b16 a[234:235],v11 offset:20480
 buffer_load_dwordx4 v252,s[88:91],s35 offen lds
 v_mfma_f32_16x16x32_bf16 a[36:39],a[240:243],v[52:55],a[36:39]
 ds_read_b64_tr_b16 a[236:237],v11 offset:24576
 v_sub_u32 v22,v22,v24
 v_mfma_f32_16x16x32_bf16 a[36:39],a[244:247],v[212:215],a[36:39]
 v_exp_f32 v76,v76
 v_mfma_f32_16x16x32_bf16 a[40:43],a[240:243],v[60:63],a[40:43]
 v_exp_f32 v77,v77
 v_mfma_f32_16x16x32_bf16 a[40:43],a[244:247],v[216:219],a[40:43]
 v_cvt_pk_bf16_f32 v195,v102,v103
 v_and_b32 v24,6,v23
 v_mfma_f32_16x16x32_bf16 a[44:47],a[240:243],v[26:29],a[44:47]
 v_exp_f32 v78,v78
 v_mfma_f32_16x16x32_bf16 a[44:47],a[244:247],v[220:223],a[44:47]
 s_waitcnt lgkmcnt(9)
 ds_read_b64_tr_b16 a[238:239],v11 offset:28672
 ds_read_b64_tr_b16 a[240:241],v12 offset:16384
 v_mfma_f32_16x16x32_bf16 a[48:51],a[248:251],v[48:51],a[48:51]
 s_waitcnt lgkmcnt(9)
 v_exp_f32 v79,v79
 v_mfma_f32_16x16x32_bf16 a[48:51],a[252:255],v[208:211],a[48:51]
 s_add_u32 s35,s93,10240
 buffer_load_dwordx4 v252,s[88:91],s35 offen lds
 v_xor_b32 v22,v22,v24
 v_mfma_f32_16x16x32_bf16 a[52:55],a[248:251],v[52:55],a[52:55]
 ds_read_b64_tr_b16 a[242:243],v12 offset:20480
 v_add_u32 v22,s101,v22
 v_mfma_f32_16x16x32_bf16 a[52:55],a[252:255],v[212:215],a[52:55]
 ds_read_b64_tr_b16 a[244:245],v12 offset:24576
 v_cvt_pk_bf16_f32 v196,v76,v77
 v_mfma_f32_16x16x32_bf16 a[56:59],a[248:251],v[60:63],a[56:59]
 v_exp_f32 v108,v108
 v_mfma_f32_16x16x32_bf16 a[56:59],a[252:255],v[216:219],a[56:59]
 ds_read_b64_tr_b16 a[246:247],v12 offset:28672
 v_subrev_u32 v24,24,v22
 v_mfma_f32_16x16x32_bf16 a[60:63],a[248:251],v[26:29],a[60:63]
 v_exp_f32 v109,v109
 v_mfma_f32_16x16x32_bf16 a[60:63],a[252:255],v[220:223],a[60:63]
 s_waitcnt lgkmcnt(10)
 ds_read_b64_tr_b16 a[248:249],v13 offset:16384
 v_cvt_pk_bf16_f32 v197,v78,v79
 v_mfma_f32_16x16x32_bf16 a[64:67],a[224:227],v[48:51],a[64:67]
 s_waitcnt lgkmcnt(9)
 v_exp_f32 v110,v110
 v_mfma_f32_16x16x32_bf16 a[64:67],a[228:231],v[208:211],a[64:67]
 s_add_u32 s35,s93,11264
 buffer_load_dwordx4 v252,s[88:91],s35 offen lds
 v_min_u32 v22,v22,v24
 v_mfma_f32_16x16x32_bf16 a[68:71],a[224:227],v[52:55],a[68:71]
 ds_read_b64_tr_b16 a[250:251],v13 offset:20480
 ds_read_b64_tr_b16 a[252:253],v13 offset:24576
 v_mfma_f32_16x16x32_bf16 a[68:71],a[228:231],v[212:215],a[68:71]
 v_exp_f32 v111,v111
 v_mfma_f32_16x16x32_bf16 a[72:75],a[224:227],v[60:63],a[72:75]
 v_cvt_pk_bf16_f32 v198,v108,v109
 v_mul_u32_u24 v23,1152,v23
 v_mfma_f32_16x16x32_bf16 a[72:75],a[228:231],v[216:219],a[72:75]
 v_exp_f32 v84,v84
 v_mfma_f32_16x16x32_bf16 a[76:79],a[224:227],v[26:29],a[76:79]
 v_exp_f32 v85,v85
 v_mfma_f32_16x16x32_bf16 a[76:79],a[228:231],v[220:223],a[76:79]
 s_waitcnt lgkmcnt(9)
 ds_read_b64_tr_b16 a[254:255],v13 offset:28672
 v_cvt_pk_bf16_f32 v199,v110,v111
 v_mfma_f32_16x16x32_bf16 a[80:83],a[232:235],v[48:51],a[80:83]
 s_waitcnt lgkmcnt(8)
 v_exp_f32 v86,v86
 v_mfma_f32_16x16x32_bf16 a[80:83],a[236:239],v[208:211],a[80:83]
 s_add_u32 s35,s93,12288
 buffer_load_dwordx4 v252,s[88:91],s35 offen lds
 v_lshl_add_u32 v16,v22,4,v23
 v_mfma_f32_16x16x32_bf16 a[84:87],a[232:235],v[52:55],a[84:87]
 v_exp_f32 v87,v87
 v_mfma_f32_16x16x32_bf16 a[84:87],a[236:239],v[212:215],a[84:87]
 v_cvt_pk_bf16_f32 v200,v84,v85
 v_mfma_f32_16x16x32_bf16 a[88:91],a[232:235],v[60:63],a[88:91]
 v_exp_f32 v116,v116
 v_mfma_f32_16x16x32_bf16 a[88:91],a[236:239],v[216:219],a[88:91]
 s_waitcnt vmcnt(16)
 s_waitcnt lgkmcnt(0)
 s_barrier
 ds_read_b128 a[192:195],v2 offset:49152
 v_mfma_f32_16x16x32_bf16 a[92:95],a[232:235],v[26:29],a[92:95]
 s_add_u32 m0,s92,0
 s_add_u32 s34,s56,0
 buffer_load_dwordx4 v14,s[44:47],s34 offen lds
 v_mfma_f32_16x16x32_bf16 a[92:95],a[236:239],v[220:223],a[92:95]
 v_exp_f32 v117,v117
 v_mfma_f32_16x16x32_bf16 a[96:99],a[240:243],v[48:51],a[96:99]
 ds_read_b128 a[196:199],v3 offset:49152
 v_cvt_pk_bf16_f32 v201,v86,v87
 v_mfma_f32_16x16x32_bf16 a[96:99],a[244:247],v[208:211],a[96:99]
 v_exp_f32 v118,v118
 v_mfma_f32_16x16x32_bf16 a[100:103],a[240:243],v[52:55],a[100:103]
 v_exp_f32 v119,v119
 v_mfma_f32_16x16x32_bf16 a[100:103],a[244:247],v[212:215],a[100:103]
 ds_read_b128 a[200:203],v4 offset:49152
 v_cvt_pk_bf16_f32 v202,v116,v117
 v_mfma_f32_16x16x32_bf16 a[104:107],a[240:243],v[60:63],a[104:107]
 v_exp_f32 v92,v92
 v_mfma_f32_16x16x32_bf16 a[104:107],a[244:247],v[216:219],a[104:107]
 v_exp_f32 v93,v93
 v_mfma_f32_16x16x32_bf16 a[108:111],a[240:243],v[26:29],a[108:111]
 s_add_u32 m0,s92,1024
 s_add_u32 s34,s56,0
 buffer_load_dwordx4 v15,s[44:47],s34 offen lds
 v_mfma_f32_16x16x32_bf16 a[108:111],a[244:247],v[220:223],a[108:111]
 ds_read_b128 a[204:207],v5 offset:49152
 v_cvt_pk_bf16_f32 v203,v118,v119
 v_mfma_f32_16x16x32_bf16 a[112:115],a[248:251],v[48:51],a[112:115]
 v_exp_f32 v94,v94
 v_mfma_f32_16x16x32_bf16 a[112:115],a[252:255],v[208:211],a[112:115]
 v_mfma_f32_16x16x32_bf16 a[116:119],a[248:251],v[52:55],a[116:119]
 v_exp_f32 v95,v95
 v_mfma_f32_16x16x32_bf16 a[116:119],a[252:255],v[212:215],a[116:119]
 ds_read_b128 a[208:211],v2 offset:53248
 v_mfma_f32_16x16x32_bf16 a[120:123],a[248:251],v[60:63],a[120:123]
 ds_read_b128 a[212:215],v3 offset:53248
 v_cvt_pk_bf16_f32 v204,v92,v93
 v_mfma_f32_16x16x32_bf16 a[120:123],a[252:255],v[216:219],a[120:123]
 v_exp_f32 v124,v124
 v_mfma_f32_16x16x32_bf16 a[124:127],a[248:251],v[26:29],a[124:127]
 s_add_u32 m0,s92,2048
 s_add_u32 s34,s56,0
 buffer_load_dwordx4 v16,s[44:47],s34 offen lds
 v_mfma_f32_16x16x32_bf16 a[124:127],a[252:255],v[220:223],a[124:127]
 v_exp_f32 v125,v125
 v_mfma_f32_16x16x32_bf16 v[248:251],a[188:191],v[48:51],v[248:251]
 v_mfma_f32_16x16x32_bf16 v[248:251],a[188:191],v[208:211],v[248:251]
 ds_read_b128 a[216:219],v4 offset:53248
 v_cvt_pk_bf16_f32 v205,v94,v95
 v_mfma_f32_16x16x32_bf16 v[240:243],a[188:191],v[52:55],v[240:243]
 v_exp_f32 v126,v126
 v_mfma_f32_16x16x32_bf16 v[240:243],a[188:191],v[212:215],v[240:243]
 ds_read_b128 a[220:223],v5 offset:53248
 v_mfma_f32_16x16x32_bf16 v[244:247],a[188:191],v[60:63],v[244:247]
 v_exp_f32 v127,v127
 v_mfma_f32_16x16x32_bf16 v[244:247],a[188:191],v[216:219],v[244:247]
 s_add_u32 m0,s92,3072
 s_add_u32 s34,s56,9216
 buffer_load_dwordx4 v14,s[44:47],s34 offen lds
 v_mfma_f32_16x16x32_bf16 v[56:59],a[188:191],v[26:29],v[56:59]
 v_cvt_pk_bf16_f32 v206,v124,v125
 v_mfma_f32_16x16x32_bf16 v[56:59],a[188:191],v[220:223],v[56:59]
 s_waitcnt lgkmcnt(7)
 v_cvt_pk_bf16_f32 v207,v126,v127
 v_mfma_f32_16x16x32_bf16 v[68:71],a[192:195],v[64:67],v[224:227]
 s_waitcnt lgkmcnt(6)
 v_exp_f32 v132,v132
 v_mfma_f32_16x16x32_bf16 v[68:71],a[196:199],v[96:99],v[68:71]
 s_waitcnt lgkmcnt(5)
 ds_read_b64_tr_b16 a[224:225],v6 offset:32768
 ds_read_b64_tr_b16 a[226:227],v6 offset:36864
 v_mfma_f32_16x16x32_bf16 v[68:71],a[200:203],v[128:131],v[68:71]
 s_waitcnt lgkmcnt(6)
 v_exp_f32 v133,v133
 v_mfma_f32_16x16x32_bf16 v[68:71],a[204:207],v[160:163],v[68:71]
 s_add_u32 m0,s92,4096
 s_add_u32 s34,s56,9216
 buffer_load_dwordx4 v15,s[44:47],s34 offen lds
 v_mfma_f32_16x16x32_bf16 v[76:79],a[192:195],v[72:75],v[228:231]
 v_exp_f32 v134,v134
 v_mfma_f32_16x16x32_bf16 v[76:79],a[196:199],v[104:107],v[76:79]
 v_exp_f32 v135,v135
 v_mfma_f32_16x16x32_bf16 v[76:79],a[200:203],v[136:139],v[76:79]
 ds_read_b64_tr_b16 a[228:229],v7 offset:32768
 ds_read_b64_tr_b16 a[230:231],v7 offset:36864
 v_mfma_f32_16x16x32_bf16 v[76:79],a[204:207],v[168:171],v[76:79]
 ds_read_b64_tr_b16 a[232:233],v8 offset:32768
 v_cvt_pk_bf16_f32 v208,v132,v133
 v_mfma_f32_16x16x32_bf16 v[84:87],a[192:195],v[80:83],v[232:235]
 v_exp_f32 v164,v164
 v_mfma_f32_16x16x32_bf16 v[84:87],a[196:199],v[112:115],v[84:87]
 v_exp_f32 v165,v165
 v_mfma_f32_16x16x32_bf16 v[84:87],a[200:203],v[144:147],v[84:87]
 ds_read_b64_tr_b16 a[234:235],v8 offset:36864
 v_cvt_pk_bf16_f32 v209,v134,v135
 v_mfma_f32_16x16x32_bf16 v[84:87],a[204:207],v[176:179],v[84:87]
 s_add_u32 m0,s92,5120
 s_add_u32 s34,s56,9216
 buffer_load_dwordx4 v16,s[44:47],s34 offen lds
 v_mfma_f32_16x16x32_bf16 v[92:95],a[192:195],v[88:91],v[236:239]
 v_exp_f32 v166,v166
 v_mfma_f32_16x16x32_bf16 v[92:95],a[196:199],v[120:123],v[92:95]
 v_exp_f32 v167,v167
 v_mfma_f32_16x16x32_bf16 v[92:95],a[200:203],v[152:155],v[92:95]
 ds_read_b64_tr_b16 a[236:237],v9 offset:32768
 ds_read_b64_tr_b16 a[238:239],v9 offset:36864
 v_mfma_f32_16x16x32_bf16 v[92:95],a[204:207],v[184:187],v[92:95]
 s_waitcnt lgkmcnt(11)
 ds_read_b64_tr_b16 a[240:241],v10 offset:32768
 v_cvt_pk_bf16_f32 v210,v164,v165
 v_mfma_f32_16x16x32_bf16 v[100:103],a[208:211],v[64:67],v[224:227]
 s_waitcnt lgkmcnt(11)
 v_exp_f32 v140,v140
 v_mfma_f32_16x16x32_bf16 v[100:103],a[212:215],v[96:99],v[100:103]
 s_waitcnt lgkmcnt(10)
 v_exp_f32 v141,v141
 v_mfma_f32_16x16x32_bf16 v[100:103],a[216:219],v[128:131],v[100:103]
 s_waitcnt lgkmcnt(9)
 ds_read_b64_tr_b16 a[242:243],v10 offset:36864
 v_cvt_pk_bf16_f32 v211,v166,v167
 v_mfma_f32_16x16x32_bf16 v[100:103],a[220:223],v[160:163],v[100:103]
 s_add_u32 m0,s92,6144
 s_add_u32 s34,s56,18432
 buffer_load_dwordx4 v14,s[44:47],s34 offen lds
 v_mfma_f32_16x16x32_bf16 v[108:111],a[208:211],v[72:75],v[228:231]
 v_exp_f32 v142,v142
 v_mfma_f32_16x16x32_bf16 v[108:111],a[212:215],v[104:107],v[108:111]
 ds_read_b64_tr_b16 a[244:245],v11 offset:32768
 ds_read_b64_tr_b16 a[246:247],v11 offset:36864
 v_mfma_f32_16x16x32_bf16 v[108:111],a[216:219],v[136:139],v[108:111]
 v_exp_f32 v143,v143
 v_mfma_f32_16x16x32_bf16 v[108:111],a[220:223],v[168:171],v[108:111]
 ds_read_b64_tr_b16 a[248:249],v12 offset:32768
 v_cvt_pk_bf16_f32 v212,v140,v141
 v_mfma_f32_16x16x32_bf16 v[116:119],a[208:211],v[80:83],v[232:235]
 v_exp_f32 v172,v172
 v_mfma_f32_16x16x32_bf16 v[116:119],a[212:215],v[112:115],v[116:119]
 v_exp_f32 v173,v173
 v_mfma_f32_16x16x32_bf16 v[116:119],a[216:219],v[144:147],v[116:119]
 ds_read_b64_tr_b16 a[250:251],v12 offset:36864
 v_cvt_pk_bf16_f32 v213,v142,v143
 v_mfma_f32_16x16x32_bf16 v[116:119],a[220:223],v[176:179],v[116:119]
 s_add_u32 m0,s92,7168
 s_add_u32 s34,s56,18432
 buffer_load_dwordx4 v15,s[44:47],s34 offen lds
 v_mfma_f32_16x16x32_bf16 v[124:127],a[208:211],v[88:91],v[236:239]
 v_exp_f32 v174,v174
 v_mfma_f32_16x16x32_bf16 v[124:127],a[212:215],v[120:123],v[124:127]
 ds_read_b64_tr_b16 a[252:253],v13 offset:32768
 ds_read_b64_tr_b16 a[254:255],v13 offset:36864
 v_mfma_f32_16x16x32_bf16 v[124:127],a[216:219],v[152:155],v[124:127]
 v_exp_f32 v175,v175
 v_mfma_f32_16x16x32_bf16 v[124:127],a[220:223],v[184:187],v[124:127]
 s_waitcnt lgkmcnt(14)
 v_cvt_pk_bf16_f32 v214,v172,v173
 v_mfma_f32_16x16x32_bf16 a[0:3],a[224:227],v[192:195],a[0:3]
 v_exp_f32 v148,v148
 v_mfma_f32_16x16x32_bf16 a[4:7],a[224:227],v[196:199],a[4:7]
 v_exp_f32 v149,v149
 v_mfma_f32_16x16x32_bf16 a[8:11],a[224:227],v[200:203],a[8:11]
 s_add_u32 m0,s92,8192
 s_add_u32 s34,s56,18432
 buffer_load_dwordx4 v16,s[44:47],s34 offen lds
 v_mfma_f32_16x16x32_bf16 a[12:15],a[224:227],v[204:207],a[12:15]
 s_waitcnt lgkmcnt(12)
 ds_read_b128 a[192:195],v2 offset:57344
 v_cvt_pk_bf16_f32 v215,v174,v175
 v_mfma_f32_16x16x32_bf16 a[16:19],a[228:231],v[192:195],a[16:19]
 v_exp_f32 v150,v150
 v_mfma_f32_16x16x32_bf16 a[20:23],a[228:231],v[196:199],a[20:23]
 v_exp_f32 v151,v151
 v_mfma_f32_16x16x32_bf16 a[24:27],a[228:231],v[200:203],a[24:27]
 ds_read_b128 a[196:199],v3 offset:57344
 v_cvt_pk_bf16_f32 v216,v148,v149
 v_mfma_f32_16x16x32_bf16 a[28:31],a[228:231],v[204:207],a[28:31]
 s_waitcnt lgkmcnt(12)
 v_exp_f32 v180,v180
 v_mfma_f32_16x16x32_bf16 a[32:35],a[232:235],v[192:195],a[32:35]
 v_exp_f32 v181,v181
 v_mfma_f32_16x16x32_bf16 a[36:39],a[232:235],v[196:199],a[36:39]
 ds_read_b128 a[200:203],v4 offset:57344
 v_cvt_pk_bf16_f32 v217,v150,v151
 v_mfma_f32_16x16x32_bf16 a[40:43],a[232:235],v[200:203],a[40:43]
 s_add_u32 m0,s92,9216
 s_add_u32 s34,s56,27648
 buffer_load_dwordx4 v14,s[44:47],s34 offen lds
 v_mfma_f32_16x16x32_bf16 a[44:47],a[232:235],v[204:207],a[44:47]
 s_waitcnt lgkmcnt(11)
 v_exp_f32 v182,v182
 v_mfma_f32_16x16x32_bf16 a[48:51],a[236:239],v[192:195],a[48:51]
 ds_read_b128 a[204:207],v5 offset:57344
 v_mfma_f32_16x16x32_bf16 a[52:55],a[236:239],v[196:199],a[52:55]
 v_exp_f32 v183,v183
 v_mfma_f32_16x16x32_bf16 a[56:59],a[236:239],v[200:203],a[56:59]
 v_cvt_pk_bf16_f32 v218,v180,v181
 v_mfma_f32_16x16x32_bf16 a[60:63],a[236:239],v[204:207],a[60:63]
 s_waitcnt lgkmcnt(10)
 v_exp_f32 v156,v156
 v_mfma_f32_16x16x32_bf16 a[64:67],a[240:243],v[192:195],a[64:67]
 ds_read_b128 a[208:211],v2 offset:61440
 v_mfma_f32_16x16x32_bf16 a[68:71],a[240:243],v[196:199],a[68:71]
 v_exp_f32 v157,v157
 v_mfma_f32_16x16x32_bf16 a[72:75],a[240:243],v[200:203],a[72:75]
 s_add_u32 m0,s92,10240
 s_add_u32 s34,s56,27648
 buffer_load_dwordx4 v15,s[44:47],s34 offen lds
 v_mfma_f32_16x16x32_bf16 a[76:79],a[240:243],v[204:207],a[76:79]
 s_waitcnt lgkmcnt(9)
 ds_read_b128 a[212:215],v3 offset:61440
 v_cvt_pk_bf16_f32 v219,v182,v183
 v_mfma_f32_16x16x32_bf16 a[80:83],a[244:247],v[192:195],a[80:83]
 v_exp_f32 v158,v158
 v_mfma_f32_16x16x32_bf16 a[84:87],a[244:247],v[196:199],a[84:87]
 v_exp_f32 v159,v159
 v_mfma_f32_16x16x32_bf16 a[88:91],a[244:247],v[200:203],a[88:91]
 ds_read_b128 a[216:219],v4 offset:61440
 v_cvt_pk_bf16_f32 v220,v156,v157
 v_mfma_f32_16x16x32_bf16 a[92:95],a[244:247],v[204:207],a[92:95]
 s_waitcnt lgkmcnt(9)
 v_exp_f32 v188,v188
 v_mfma_f32_16x16x32_bf16 a[96:99],a[248:251],v[192:195],a[96:99]
 v_exp_f32 v189,v189
 v_mfma_f32_16x16x32_bf16 a[100:103],a[248:251],v[196:199],a[100:103]
 ds_read_b128 a[220:223],v5 offset:61440
 v_cvt_pk_bf16_f32 v221,v158,v159
 v_mfma_f32_16x16x32_bf16 a[104:107],a[248:251],v[200:203],a[104:107]
 s_add_u32 m0,s92,11264
 s_add_u32 s34,s56,27648
 buffer_load_dwordx4 v16,s[44:47],s34 offen lds
 v_mfma_f32_16x16x32_bf16 a[108:111],a[248:251],v[204:207],a[108:111]
 s_waitcnt lgkmcnt(8)
 v_exp_f32 v190,v190
 v_mfma_f32_16x16x32_bf16 a[112:115],a[252:255],v[192:195],a[112:115]
 v_exp_f32 v191,v191
 v_mfma_f32_16x16x32_bf16 a[116:119],a[252:255],v[196:199],a[116:119]
 ds_read_b64_tr_b16 a[224:225],v6 offset:40960
 v_mfma_f32_16x16x32_bf16 a[120:123],a[252:255],v[200:203],a[120:123]
 v_cvt_pk_bf16_f32 v222,v188,v189
 v_mfma_f32_16x16x32_bf16 a[124:127],a[252:255],v[204:207],a[124:127]
 v_mfma_f32_16x16x32_bf16 v[248:251],a[188:191],v[192:195],v[248:251]
 v_mfma_f32_16x16x32_bf16 v[240:243],a[188:191],v[196:199],v[240:243]
 v_mfma_f32_16x16x32_bf16 v[244:247],a[188:191],v[200:203],v[244:247]
 v_mfma_f32_16x16x32_bf16 v[56:59],a[188:191],v[204:207],v[56:59]
 s_waitcnt lgkmcnt(8)
 ds_read_b64_tr_b16 a[226:227],v6 offset:45056
 v_cvt_pk_bf16_f32 v223,v190,v191
 v_mfma_f32_16x16x32_bf16 v[132:135],a[192:195],v[64:67],v[224:227]
 s_waitcnt lgkmcnt(8)
 v_exp_f32 v68,v68
 v_mfma_f32_16x16x32_bf16 v[132:135],a[196:199],v[96:99],v[132:135]
 s_waitcnt lgkmcnt(7)
 s_mov_b32 m0,162816
 ds_read_b64_tr_b16 a[228:229],v7 offset:40960
 v_mfma_f32_16x16x32_bf16 v[132:135],a[200:203],v[128:131],v[132:135]
 s_waitcnt lgkmcnt(7)
 v_exp_f32 v69,v69
 v_mfma_f32_16x16x32_bf16 v[132:135],a[204:207],v[160:163],v[132:135]
 s_add_u32 s35,s93,13312
 ds_read_b64_tr_b16 a[230:231],v7 offset:45056
 buffer_load_dwordx4 v252,s[88:91],s35 offen lds
 v_mfma_f32_16x16x32_bf16 v[140:143],a[192:195],v[72:75],v[228:231]
 v_exp_f32 v70,v70
 v_mfma_f32_16x16x32_bf16 v[140:143],a[196:199],v[104:107],v[140:143]
 v_exp_f32 v71,v71
 v_mfma_f32_16x16x32_bf16 v[140:143],a[200:203],v[136:139],v[140:143]
 ds_read_b64_tr_b16 a[232:233],v8 offset:40960
 v_cvt_pk_bf16_f32 v192,v68,v69
 v_mfma_f32_16x16x32_bf16 v[140:143],a[204:207],v[168:171],v[140:143]
 v_exp_f32 v100,v100
 v_mfma_f32_16x16x32_bf16 v[148:151],a[192:195],v[80:83],v[232:235]
 s_add_u32 s35,s93,14336
 ds_read_b64_tr_b16 a[234:235],v8 offset:45056
 buffer_load_dwordx4 v252,s[88:91],s35 offen lds
 v_mfma_f32_16x16x32_bf16 v[148:151],a[196:199],v[112:115],v[148:151]
 v_exp_f32 v101,v101
 v_mfma_f32_16x16x32_bf16 v[148:151],a[200:203],v[144:147],v[148:151]
 ds_read_b64_tr_b16 a[236:237],v9 offset:40960
 v_cvt_pk_bf16_f32 v193,v70,v71
 v_mfma_f32_16x16x32_bf16 v[148:151],a[204:207],v[176:179],v[148:151]
 v_exp_f32 v102,v102
 v_mfma_f32_16x16x32_bf16 v[156:159],a[192:195],v[88:91],v[236:239]
 ds_read_b64_tr_b16 a[238:239],v9 offset:45056
 v_mfma_f32_16x16x32_bf16 v[156:159],a[196:199],v[120:123],v[156:159]
 v_exp_f32 v103,v103
 v_mfma_f32_16x16x32_bf16 v[156:159],a[200:203],v[152:155],v[156:159]
 ds_read_b64_tr_b16 a[240:241],v10 offset:40960
 v_cvt_pk_bf16_f32 v194,v100,v101
 v_mfma_f32_16x16x32_bf16 v[156:159],a[204:207],v[184:187],v[156:159]
 s_waitcnt lgkmcnt(12)
 v_exp_f32 v76,v76
 v_mfma_f32_16x16x32_bf16 v[164:167],a[208:211],v[64:67],v[224:227]
 s_waitcnt lgkmcnt(11)
 ds_read_b64_tr_b16 a[242:243],v10 offset:45056
 v_mfma_f32_16x16x32_bf16 v[164:167],a[212:215],v[96:99],v[164:167]
 s_waitcnt lgkmcnt(11)
 v_exp_f32 v77,v77
 v_mfma_f32_16x16x32_bf16 v[164:167],a[216:219],v[128:131],v[164:167]
 s_waitcnt lgkmcnt(10)
 ds_read_b64_tr_b16 a[244:245],v11 offset:40960
 v_cvt_pk_bf16_f32 v195,v102,v103
 v_mfma_f32_16x16x32_bf16 v[164:167],a[220:223],v[160:163],v[164:167]
 s_add_u32 s35,s93,15360
 ds_read_b64_tr_b16 a[246:247],v11 offset:45056
 buffer_load_dwordx4 v252,s[88:91],s35 offen lds
 v_mfma_f32_16x16x32_bf16 v[172:175],a[208:211],v[72:75],v[228:231]
 v_exp_f32 v78,v78
 v_mfma_f32_16x16x32_bf16 v[172:175],a[212:215],v[104:107],v[172:175]
 v_exp_f32 v79,v79
 v_mfma_f32_16x16x32_bf16 v[172:175],a[216:219],v[136:139],v[172:175]
 ds_read_b64_tr_b16 a[248:249],v12 offset:40960
 v_cvt_pk_bf16_f32 v196,v76,v77
 v_mfma_f32_16x16x32_bf16 v[172:175],a[220:223],v[168:171],v[172:175]
 v_exp_f32 v108,v108
 v_mfma_f32_16x16x32_bf16 v[180:183],a[208:211],v[80:83],v[232:235]
 v_exp_f32 v109,v109
 v_mfma_f32_16x16x32_bf16 v[180:183],a[212:215],v[112:115],v[180:183]
 s_add_u32 s35,s93,16384
 ds_read_b64_tr_b16 a[250:251],v12 offset:45056
 buffer_load_dwordx4 v252,s[88:91],s35 offen lds
 v_mfma_f32_16x16x32_bf16 v[180:183],a[216:219],v[144:147],v[180:183]
 ds_read_b64_tr_b16 a[252:253],v13 offset:40960
 v_cvt_pk_bf16_f32 v197,v78,v79
 v_mfma_f32_16x16x32_bf16 v[180:183],a[220:223],v[176:179],v[180:183]
 v_exp_f32 v110,v110
 v_mfma_f32_16x16x32_bf16 v[188:191],a[208:211],v[88:91],v[236:239]
 v_exp_f32 v111,v111
 v_mfma_f32_16x16x32_bf16 v[188:191],a[212:215],v[120:123],v[188:191]
 ds_read_b64_tr_b16 a[254:255],v13 offset:45056
 v_cvt_pk_bf16_f32 v198,v108,v109
 v_mfma_f32_16x16x32_bf16 v[188:191],a[216:219],v[152:155],v[188:191]
 v_exp_f32 v84,v84
 v_mfma_f32_16x16x32_bf16 v[188:191],a[220:223],v[184:187],v[188:191]
 s_waitcnt lgkmcnt(14)
 v_exp_f32 v85,v85
 v_mfma_f32_16x16x32_bf16 a[0:3],a[224:227],v[208:211],a[0:3]
 s_add_u32 s35,s93,17408
 buffer_load_dwordx4 v252,s[88:91],s35 offen lds
 v_cvt_pk_bf16_f32 v199,v110,v111
 v_mfma_f32_16x16x32_bf16 a[4:7],a[224:227],v[212:215],a[4:7]
 v_exp_f32 v86,v86
 v_mfma_f32_16x16x32_bf16 a[8:11],a[224:227],v[216:219],a[8:11]
 v_exp_f32 v87,v87
 v_mfma_f32_16x16x32_bf16 a[12:15],a[224:227],v[220:223],a[12:15]
 s_waitcnt lgkmcnt(12)
 v_cvt_pk_bf16_f32 v200,v84,v85
 v_mfma_f32_16x16x32_bf16 a[16:19],a[228:231],v[208:211],a[16:19]
 v_exp_f32 v116,v116
 v_mfma_f32_16x16x32_bf16 a[20:23],a[228:231],v[212:215],a[20:23]
 s_waitcnt vmcnt(49)
 s_waitcnt lgkmcnt(0)
 s_barrier
 ds_read_b64_tr_b16 a[192:193],v6 offset:49152
 v_mfma_f32_16x16x32_bf16 a[24:27],a[228:231],v[216:219],a[24:27]
 s_add_u32 m0,s92,49152
 s_add_u32 s34,s56,589824
 buffer_load_dwordx4 v14,s[44:47],s34 offen lds
 v_mfma_f32_16x16x32_bf16 a[28:31],a[228:231],v[220:223],a[28:31]
 ds_read_b64_tr_b16 a[194:195],v6 offset:53248
 ds_read_b64_tr_b16 a[196:197],v7 offset:49152
 v_mfma_f32_16x16x32_bf16 a[32:35],a[232:235],v[208:211],a[32:35]
 v_exp_f32 v117,v117
 v_mfma_f32_16x16x32_bf16 a[36:39],a[232:235],v[212:215],a[36:39]
 ds_read_b64_tr_b16 a[198:199],v7 offset:53248
 v_cvt_pk_bf16_f32 v201,v86,v87
 v_mfma_f32_16x16x32_bf16 a[40:43],a[232:235],v[216:219],a[40:43]
 s_add_u32 m0,s92,50176
 s_add_u32 s34,s56,589824
 buffer_load_dwordx4 v15,s[44:47],s34 offen lds
 v_mfma_f32_16x16x32_bf16 a[44:47],a[232:235],v[220:223],a[44:47]
 v_exp_f32 v118,v118
 v_mfma_f32_16x16x32_bf16 a[48:51],a[236:239],v[208:211],a[48:51]
 ds_read_b64_tr_b16 a[200:201],v8 offset:49152
 ds_read_b64_tr_b16 a[202:203],v8 offset:53248
 v_mfma_f32_16x16x32_bf16 a[52:55],a[236:239],v[212:215],a[52:55]
 v_exp_f32 v119,v119
 v_mfma_f32_16x16x32_bf16 a[56:59],a[236:239],v[216:219],a[56:59]
 ds_read_b64_tr_b16 a[204:205],v9 offset:49152
 v_cvt_pk_bf16_f32 v202,v116,v117
 v_mfma_f32_16x16x32_bf16 a[60:63],a[236:239],v[220:223],a[60:63]
 v_exp_f32 v92,v92
 v_mfma_f32_16x16x32_bf16 a[64:67],a[240:243],v[208:211],a[64:67]
 s_add_u32 m0,s92,51200
 s_add_u32 s34,s56,589824
 buffer_load_dwordx4 v16,s[44:47],s34 offen lds
 v_mfma_f32_16x16x32_bf16 a[68:71],a[240:243],v[212:215],a[68:71]
 ds_read_b64_tr_b16 a[206:207],v9 offset:53248
 ds_read_b64_tr_b16 a[208:209],v10 offset:49152
 v_mfma_f32_16x16x32_bf16 a[72:75],a[240:243],v[216:219],a[72:75]
 v_exp_f32 v93,v93
 v_mfma_f32_16x16x32_bf16 a[76:79],a[240:243],v[220:223],a[76:79]
 ds_read_b64_tr_b16 a[210:211],v10 offset:53248
 v_cvt_pk_bf16_f32 v203,v118,v119
 v_mfma_f32_16x16x32_bf16 a[80:83],a[244:247],v[208:211],a[80:83]
 s_add_u32 m0,s92,52224
 s_add_u32 s34,s56,599040
 buffer_load_dwordx4 v14,s[44:47],s34 offen lds
 v_mfma_f32_16x16x32_bf16 a[84:87],a[244:247],v[212:215],a[84:87]
 ds_read_b64_tr_b16 a[212:213],v11 offset:49152
 ds_read_b64_tr_b16 a[214:215],v11 offset:53248
 v_mfma_f32_16x16x32_bf16 a[88:91],a[244:247],v[216:219],a[88:91]
 v_exp_f32 v94,v94
 v_mfma_f32_16x16x32_bf16 a[92:95],a[244:247],v[220:223],a[92:95]
 v_exp_f32 v95,v95
 v_mfma_f32_16x16x32_bf16 a[96:99],a[248:251],v[208:211],a[96:99]
 ds_read_b64_tr_b16 a[216:217],v12 offset:49152
 buffer_load_dword v63,v252,s[40:43],0 offen sc1
 v_mfma_f32_16x16x32_bf16 a[100:103],a[248:251],v[212:215],a[100:103]
 ds_read_b64_tr_b16 a[218:219],v12 offset:53248
 v_cvt_pk_bf16_f32 v204,v92,v93
 v_mfma_f32_16x16x32_bf16 a[104:107],a[248:251],v[216:219],a[104:107]
 v_exp_f32 v124,v124
 v_mfma_f32_16x16x32_bf16 a[108:111],a[248:251],v[220:223],a[108:111]
 ds_read_b64_tr_b16 a[220:221],v13 offset:49152
 ds_read_b64_tr_b16 a[222:223],v13 offset:53248
 v_mfma_f32_16x16x32_bf16 a[112:115],a[252:255],v[208:211],a[112:115]
 v_exp_f32 v125,v125
 v_mfma_f32_16x16x32_bf16 a[116:119],a[252:255],v[212:215],a[116:119]
 v_cvt_pk_bf16_f32 v205,v94,v95
 v_mfma_f32_16x16x32_bf16 a[120:123],a[252:255],v[216:219],a[120:123]
 v_exp_f32 v126,v126
 v_mfma_f32_16x16x32_bf16 a[124:127],a[252:255],v[220:223],a[124:127]
 v_exp_f32 v127,v127
 v_mfma_f32_16x16x32_bf16 v[248:251],a[188:191],v[208:211],v[248:251]
 v_cvt_pk_bf16_f32 v206,v124,v125
 v_mfma_f32_16x16x32_bf16 v[240:243],a[188:191],v[212:215],v[240:243]
 v_mfma_f32_16x16x32_bf16 v[244:247],a[188:191],v[216:219],v[244:247]
 v_mfma_f32_16x16x32_bf16 v[56:59],a[188:191],v[220:223],v[56:59]
 s_waitcnt lgkmcnt(14)
 v_cvt_pk_bf16_f32 v207,v126,v127
 v_mfma_f32_16x16x32_bf16 a[0:3],a[192:195],v[192:195],a[0:3]
 v_exp_f32 v132,v132
 v_mfma_f32_16x16x32_bf16 a[4:7],a[192:195],v[196:199],a[4:7]
 ds_read_b64_tr_b16 a[224:225],v6 offset:57344
 ds_read_b64_tr_b16 a[226:227],v6 offset:61440
 v_mfma_f32_16x16x32_bf16 a[8:11],a[192:195],v[200:203],a[8:11]
 v_exp_f32 v133,v133
 v_mfma_f32_16x16x32_bf16 a[12:15],a[192:195],v[204:207],a[12:15]
 s_waitcnt lgkmcnt(14)
 v_exp_f32 v134,v134
 v_mfma_f32_16x16x32_bf16 a[16:19],a[196:199],v[192:195],a[16:19]
 ds_read_b64_tr_b16 a[228:229],v7 offset:57344
 ds_read_b64_tr_b16 a[230:231],v7 offset:61440
 v_mfma_f32_16x16x32_bf16 a[20:23],a[196:199],v[196:199],a[20:23]
 v_exp_f32 v135,v135
 v_mfma_f32_16x16x32_bf16 a[24:27],a[196:199],v[200:203],a[24:27]
 ds_read_b64_tr_b16 a[232:233],v8 offset:57344
 v_cvt_pk_bf16_f32 v208,v132,v133
 v_mfma_f32_16x16x32_bf16 a[28:31],a[196:199],v[204:207],a[28:31]
 s_waitcnt lgkmcnt(15)
 ds_read_b64_tr_b16 a[234:235],v8 offset:61440
 ds_read_b64_tr_b16 a[236:237],v9 offset:57344
 v_mfma_f32_16x16x32_bf16 a[32:35],a[200:203],v[192:195],a[32:35]
 v_exp_f32 v164,v164
 v_mfma_f32_16x16x32_bf16 a[36:39],a[200:203],v[196:199],a[36:39]
 v_exp_f32 v165,v165
 v_mfma_f32_16x16x32_bf16 a[40:43],a[200:203],v[200:203],a[40:43]
 ds_read_b64_tr_b16 a[238:239],v9 offset:61440
 v_cvt_pk_bf16_f32 v209,v134,v135
 v_mfma_f32_16x16x32_bf16 a[44:47],a[200:203],v[204:207],a[44:47]
 s_waitcnt lgkmcnt(15)
 ds_read_b64_tr_b16 a[240:241],v10 offset:57344
 ds_read_b64_tr_b16 a[242:243],v10 offset:61440
 v_mfma_f32_16x16x32_bf16 a[48:51],a[204:207],v[192:195],a[48:51]
 v_exp_f32 v166,v166
 v_mfma_f32_16x16x32_bf16 a[52:55],a[204:207],v[196:199],a[52:55]
 ds_read_b64_tr_b16 a[244:245],v11 offset:57344
 ds_read_b64_tr_b16 a[246:247],v11 offset:61440
 v_mfma_f32_16x16x32_bf16 a[56:59],a[204:207],v[200:203],a[56:59]
 v_exp_f32 v167,v167
 v_mfma_f32_16x16x32_bf16 a[60:63],a[204:207],v[204:207],a[60:63]
 s_waitcnt lgkmcnt(15)
 ds_read_b64_tr_b16 a[248:249],v12 offset:57344
 v_cvt_pk_bf16_f32 v210,v164,v165
 v_mfma_f32_16x16x32_bf16 a[64:67],a[208:211],v[192:195],a[64:67]
 s_add_u32 m0,s92,53248
 s_add_u32 s34,s56,599040
 buffer_load_dwordx4 v15,s[44:47],s34 offen lds
 v_mfma_f32_16x16x32_bf16 a[68:71],a[208:211],v[196:199],a[68:71]
 ds_read_b64_tr_b16 a[250:251],v12 offset:61440
 ds_read_b64_tr_b16 a[252:253],v13 offset:57344
 v_mfma_f32_16x16x32_bf16 a[72:75],a[208:211],v[200:203],a[72:75]
 s_add_u32 m0,s92,54272
 s_add_u32 s34,s56,599040
 buffer_load_dwordx4 v16,s[44:47],s34 offen lds
 v_mfma_f32_16x16x32_bf16 a[76:79],a[208:211],v[204:207],a[76:79]
 s_waitcnt lgkmcnt(15)
 s_add_u32 m0,s92,55296
 s_add_u32 s34,s56,608256
 buffer_load_dwordx4 v14,s[44:47],s34 offen lds
 v_mfma_f32_16x16x32_bf16 a[80:83],a[212:215],v[192:195],a[80:83]
 s_add_u32 m0,s92,56320
 s_add_u32 s34,s56,608256
 ds_read_b64_tr_b16 a[254:255],v13 offset:61440
 buffer_load_dwordx4 v15,s[44:47],s34 offen lds
 v_mfma_f32_16x16x32_bf16 a[84:87],a[212:215],v[196:199],a[84:87]
 s_add_u32 m0,s92,57344
 s_add_u32 s34,s56,608256
 buffer_load_dwordx4 v16,s[44:47],s34 offen lds
 v_mfma_f32_16x16x32_bf16 a[88:91],a[212:215],v[200:203],a[88:91]
 s_add_u32 m0,s92,58368
 s_add_u32 s34,s56,617472
 buffer_load_dwordx4 v14,s[44:47],s34 offen lds
 v_mfma_f32_16x16x32_bf16 a[92:95],a[212:215],v[204:207],a[92:95]
 s_waitcnt lgkmcnt(15)
 s_add_u32 m0,s92,59392
 s_add_u32 s34,s56,617472
 buffer_load_dwordx4 v15,s[44:47],s34 offen lds
 v_mfma_f32_16x16x32_bf16 a[96:99],a[216:219],v[192:195],a[96:99]
 v_exp_f32 v140,v140
 v_mfma_f32_16x16x32_bf16 a[100:103],a[216:219],v[196:199],a[100:103]
 s_add_u32 m0,s92,60416
 s_add_u32 s34,s56,617472
 buffer_load_dwordx4 v16,s[44:47],s34 offen lds
 v_mfma_f32_16x16x32_bf16 a[104:107],a[216:219],v[200:203],a[104:107]
 s_waitcnt lgkmcnt(0)
 s_barrier
 v_exp_f32 v141,v141
 v_cvt_pk_bf16_f32 v211,v166,v167
 v_mfma_f32_16x16x32_bf16 a[108:111],a[216:219],v[204:207],a[108:111]
 v_exp_f32 v142,v142
 v_mfma_f32_16x16x32_bf16 a[112:115],a[220:223],v[192:195],a[112:115]
 v_exp_f32 v143,v143
 v_cvt_pk_bf16_f32 v212,v140,v141
 v_mfma_f32_16x16x32_bf16 a[116:119],a[220:223],v[196:199],a[116:119]
 v_exp_f32 v172,v172
 v_mfma_f32_16x16x32_bf16 a[120:123],a[220:223],v[200:203],a[120:123]
 v_exp_f32 v173,v173
 v_cvt_pk_bf16_f32 v213,v142,v143
 v_mfma_f32_16x16x32_bf16 a[124:127],a[220:223],v[204:207],a[124:127]
 v_exp_f32 v174,v174
 v_mfma_f32_16x16x32_bf16 v[248:251],a[188:191],v[192:195],v[248:251]
 v_exp_f32 v175,v175
 v_cvt_pk_bf16_f32 v214,v172,v173
 v_mfma_f32_16x16x32_bf16 v[240:243],a[188:191],v[196:199],v[240:243]
 v_exp_f32 v148,v148
 v_mfma_f32_16x16x32_bf16 v[244:247],a[188:191],v[200:203],v[244:247]
 v_exp_f32 v149,v149
 v_cvt_pk_bf16_f32 v215,v174,v175
 v_mfma_f32_16x16x32_bf16 v[56:59],a[188:191],v[204:207],v[56:59]
 v_exp_f32 v150,v150
 v_mfma_f32_16x16x32_bf16 a[0:3],a[224:227],v[208:211],a[0:3]
 v_exp_f32 v151,v151
 v_cvt_pk_bf16_f32 v216,v148,v149
 v_mfma_f32_16x16x32_bf16 a[16:19],a[228:231],v[208:211],a[16:19]
 v_exp_f32 v180,v180
 v_mfma_f32_16x16x32_bf16 a[32:35],a[232:235],v[208:211],a[32:35]
 v_exp_f32 v181,v181
 v_cvt_pk_bf16_f32 v217,v150,v151
 v_mfma_f32_16x16x32_bf16 a[48:51],a[236:239],v[208:211],a[48:51]
 v_exp_f32 v182,v182
 v_mfma_f32_16x16x32_bf16 a[64:67],a[240:243],v[208:211],a[64:67]
 v_exp_f32 v183,v183
 v_cvt_pk_bf16_f32 v218,v180,v181
 v_mfma_f32_16x16x32_bf16 a[80:83],a[244:247],v[208:211],a[80:83]
 s_add_u32 m0,s92,98304
 s_add_u32 s34,s56,1179648
 buffer_load_dwordx4 v14,s[44:47],s34 offen lds
 v_mfma_f32_16x16x32_bf16 a[96:99],a[248:251],v[208:211],a[96:99]
 v_exp_f32 v156,v156
 v_mfma_f32_16x16x32_bf16 a[112:115],a[252:255],v[208:211],a[112:115]
 v_exp_f32 v157,v157
 v_cvt_pk_bf16_f32 v219,v182,v183
 v_mfma_f32_16x16x32_bf16 a[4:7],a[224:227],v[212:215],a[4:7]
 v_exp_f32 v158,v158
 v_mfma_f32_16x16x32_bf16 a[20:23],a[228:231],v[212:215],a[20:23]
 v_exp_f32 v159,v159
 v_mfma_f32_16x16x32_bf16 a[36:39],a[232:235],v[212:215],a[36:39]
 s_add_u32 m0,s92,99328
 s_add_u32 s34,s56,1179648
 buffer_load_dwordx4 v15,s[44:47],s34 offen lds
 v_mfma_f32_16x16x32_bf16 a[52:55],a[236:239],v[212:215],a[52:55]
 v_cvt_pk_bf16_f32 v220,v156,v157
 v_mfma_f32_16x16x32_bf16 a[68:71],a[240:243],v[212:215],a[68:71]
 v_exp_f32 v188,v188
 v_mfma_f32_16x16x32_bf16 a[84:87],a[244:247],v[212:215],a[84:87]
 v_exp_f32 v189,v189
 v_mfma_f32_16x16x32_bf16 a[100:103],a[248:251],v[212:215],a[100:103]
 v_cvt_pk_bf16_f32 v221,v158,v159
 v_mfma_f32_16x16x32_bf16 a[116:119],a[252:255],v[212:215],a[116:119]
 v_exp_f32 v190,v190
 v_mfma_f32_16x16x32_bf16 a[8:11],a[224:227],v[216:219],a[8:11]
 v_exp_f32 v191,v191
 v_mfma_f32_16x16x32_bf16 a[24:27],a[228:231],v[216:219],a[24:27]
 v_cvt_pk_bf16_f32 v222,v188,v189
 v_cvt_pk_bf16_f32 v223,v190,v191
 v_mfma_f32_16x16x32_bf16 a[40:43],a[232:235],v[216:219],a[40:43]
 s_add_u32 m0,s92,100352
 s_add_u32 s34,s56,1179648
 buffer_load_dwordx4 v16,s[44:47],s34 offen lds
 v_mfma_f32_16x16x32_bf16 a[56:59],a[236:239],v[216:219],a[56:59]
 s_add_u32 m0,s92,101376
 s_add_u32 s34,s56,1188864
 buffer_load_dwordx4 v14,s[44:47],s34 offen lds
 v_mfma_f32_16x16x32_bf16 a[72:75],a[240:243],v[216:219],a[72:75]
 s_add_u32 m0,s92,102400
 s_add_u32 s34,s56,1188864
 buffer_load_dwordx4 v15,s[44:47],s34 offen lds
 v_mfma_f32_16x16x32_bf16 a[88:91],a[244:247],v[216:219],a[88:91]
 s_add_u32 m0,s92,103424
 s_add_u32 s34,s56,1188864
 buffer_load_dwordx4 v16,s[44:47],s34 offen lds
 v_mfma_f32_16x16x32_bf16 a[104:107],a[248:251],v[216:219],a[104:107]
 s_add_u32 m0,s92,104448
 s_add_u32 s34,s56,1198080
 buffer_load_dwordx4 v14,s[44:47],s34 offen lds
 v_mfma_f32_16x16x32_bf16 a[120:123],a[252:255],v[216:219],a[120:123]
 v_bfe_u32 v22,v0,2,4
 v_and_b32 v23,6,v22
 v_mfma_f32_16x16x32_bf16 v[248:251],a[188:191],v[208:211],v[248:251]
 v_bfe_u32 v24,v0,1,1
 v_xor_b32 v23,v23,v24
 v_mfma_f32_16x16x32_bf16 v[240:243],a[188:191],v[212:215],v[240:243]
 v_mul_u32_u24 v22,384,v22
 v_and_b32 v24,1,v0
 v_mfma_f32_16x16x32_bf16 v[244:247],a[188:191],v[216:219],v[244:247]
 v_lshl_add_u32 v22,v24,3,v22
 v_add_u32 v22,s92,v22
 v_mfma_f32_16x16x32_bf16 v[56:59],a[188:191],v[220:223],v[56:59]
 v_lshl_add_u32 v18,v23,4,v22
 v_xor_b32 v19,32,v18
 v_mfma_f32_16x16x32_bf16 a[12:15],a[224:227],v[220:223],a[12:15]
 v_xor_b32 v20,64,v18
 v_xor_b32 v21,96,v18
 v_mfma_f32_16x16x32_bf16 a[28:31],a[228:231],v[220:223],a[28:31]
 s_add_u32 m0,s92,105472
 s_add_u32 s34,s56,1198080
 buffer_load_dwordx4 v15,s[44:47],s34 offen lds
 v_mfma_f32_16x16x32_bf16 a[44:47],a[232:235],v[220:223],a[44:47]
 s_add_u32 m0,s92,106496
 s_add_u32 s34,s56,1198080
 buffer_load_dwordx4 v16,s[44:47],s34 offen lds
 v_mfma_f32_16x16x32_bf16 a[60:63],a[236:239],v[220:223],a[60:63]
 s_add_u32 m0,s92,107520
 s_add_u32 s34,s56,1207296
 buffer_load_dwordx4 v14,s[44:47],s34 offen lds
 v_mfma_f32_16x16x32_bf16 a[76:79],a[240:243],v[220:223],a[76:79]
 s_add_u32 m0,s92,108544
 s_add_u32 s34,s56,1207296
 buffer_load_dwordx4 v15,s[44:47],s34 offen lds
 v_mfma_f32_16x16x32_bf16 a[92:95],a[244:247],v[220:223],a[92:95]
 s_add_u32 m0,s92,109568
 s_add_u32 s34,s56,1207296
 buffer_load_dwordx4 v16,s[44:47],s34 offen lds
 v_mfma_f32_16x16x32_bf16 a[108:111],a[248:251],v[220:223],a[108:111]
 s_nop 0
 s_nop 0
 v_mfma_f32_16x16x32_bf16 a[124:127],a[252:255],v[220:223],a[124:127]
 s_mov_b32 s68,0x4e800000
 v_mov_b32 v249,v240
 v_mov_b32 v250,v244
 v_mov_b32 v251,v56
 v_add_f32 v41,v248,v249
 v_add_f32 v41,v41,v250
 v_add_f32 v41,v41,v251
 v_cmp_ngt_f32 vcc,s68,v41
 s_nop 0
 s_cbranch_vccnz K1_slow
K1_backL:
 v_rcp_f32 v248,v248
 v_rcp_f32 v249,v249
 v_rcp_f32 v250,v250
 v_rcp_f32 v251,v251
 s_branch K1_op
K1_slow:
 s_waitcnt vmcnt(0)
 s_lshl_b32 s70,s33,18
 v_and_b32 v48,15,v0
 v_lshrrev_b32 v49,4,v0
 v_lshlrev_b32 v50,8,v48
 v_lshlrev_b32 v51,1,v48
 v_lshl_add_u32 v48,v49,4,v50
 v_lshl_add_u32 v49,v49,10,v51
 s_mov_b32 s71,0
 v_mov_b32 v40,0xff800000
 v_mov_b32 v41,0xff800000
 v_mov_b32 v42,0xff800000
 v_mov_b32 v43,0xff800000
K1_s1:
 s_add_u32 s64,s70,s71
 s_add_u32 s65,s64,4096
 buffer_load_dwordx4 v[132:135],v48,s[12:15],s64 offen offset:0
 buffer_load_dwordx4 v[140:143],v48,s[12:15],s64 offen offset:64
 buffer_load_dwordx4 v[148:151],v48,s[12:15],s64 offen offset:128
 buffer_load_dwordx4 v[156:159],v48,s[12:15],s64 offen offset:192
 buffer_load_dwordx4 v[164:167],v48,s[12:15],s65 offen offset:0
 buffer_load_dwordx4 v[172:175],v48,s[12:15],s65 offen offset:64
 buffer_load_dwordx4 v[180:183],v48,s[12:15],s65 offen offset:128
 buffer_load_dwordx4 v[188:191],v48,s[12:15],s65 offen offset:192
 s_waitcnt vmcnt(0)
 v_mfma_f32_16x16x32_bf16 v[68:71],v[132:135],v[64:67],0
 v_mfma_f32_16x16x32_bf16 v[68:71],v[140:143],v[96:99],v[68:71]
 v_mfma_f32_16x16x32_bf16 v[68:71],v[148:151],v[128:131],v[68:71]
 v_mfma_f32_16x16x32_bf16 v[68:71],v[156:159],v[160:163],v[68:71]
 v_mfma_f32_16x16x32_bf16 v[76:79],v[132:135],v[72:75],0
 v_mfma_f32_16x16x32_bf16 v[76:79],v[140:143],v[104:107],v[76:79]
 v_mfma_f32_16x16x32_bf16 v[76:79],v[148:151],v[136:139],v[76:79]
 v_mfma_f32_16x16x32_bf16 v[76:79],v[156:159],v[168:171],v[76:79]
 v_mfma_f32_16x16x32_bf16 v[84:87],v[132:135],v[80:83],0
 v_mfma_f32_16x16x32_bf16 v[84:87],v[140:143],v[112:115],v[84:87]
 v_mfma_f32_16x16x32_bf16 v[84:87],v[148:151],v[144:147],v[84:87]
 v_mfma_f32_16x16x32_bf16 v[84:87],v[156:159],v[176:179],v[84:87]
 v_mfma_f32_16x16x32_bf16 v[92:95],v[132:135],v[88:91],0
 v_mfma_f32_16x16x32_bf16 v[92:95],v[140:143],v[120:123],v[92:95]
 v_mfma_f32_16x16x32_bf16 v[92:95],v[148:151],v[152:155],v[92:95]
 v_mfma_f32_16x16x32_bf16 v[92:95],v[156:159],v[184:187],v[92:95]
 v_mfma_f32_16x16x32_bf16 v[100:103],v[164:167],v[64:67],0
 v_mfma_f32_16x16x32_bf16 v[100:103],v[172:175],v[96:99],v[100:103]
 v_mfma_f32_16x16x32_bf16 v[100:103],v[180:183],v[128:131],v[100:103]
 v_mfma_f32_16x16x32_bf16 v[100:103],v[188:191],v[160:163],v[100:103]
 v_mfma_f32_16x16x32_bf16 v[108:111],v[164:167],v[72:75],0
 v_mfma_f32_16x16x32_bf16 v[108:111],v[172:175],v[104:107],v[108:111]
 v_mfma_f32_16x16x32_bf16 v[108:111],v[180:183],v[136:139],v[108:111]
 v_mfma_f32_16x16x32_bf16 v[108:111],v[188:191],v[168:171],v[108:111]
 v_mfma_f32_16x16x32_bf16 v[116:119],v[164:167],v[80:83],0
 v_mfma_f32_16x16x32_bf16 v[116:119],v[172:175],v[112:115],v[116:119]
 v_mfma_f32_16x16x32_bf16 v[116:119],v[180:183],v[144:147],v[116:119]
 v_mfma_f32_16x16x32_bf16 v[116:119],v[188:191],v[176:179],v[116:119]
 v_mfma_f32_16x16x32_bf16 v[124:127],v[164:167],v[88:91],0
 v_mfma_f32_16x16x32_bf16 v[124:127],v[172:175],v[120:123],v[124:127]
 v_mfma_f32_16x16x32_bf16 v[124:127],v[180:183],v[152:155],v[124:127]
 v_mfma_f32_16x16x32_bf16 v[124:127],v[188:191],v[184:187],v[124:127]
 s_nop 7
 v_max3_f32 v40,v40,v68,v69
 v_max3_f32 v40,v40,v70,v71
 v_max3_f32 v40,v40,v100,v101
 v_max3_f32 v40,v40,v102,v103
 v_max3_f32 v41,v41,v76,v77
 v_max3_f32 v41,v41,v78,v79
 v_max3_f32 v41,v41,v108,v109
 v_max3_f32 v41,v41,v110,v111
 v_max3_f32 v42,v42,v84,v85
 v_max3_f32 v42,v42,v86,v87
 v_max3_f32 v42,v42,v116,v117
 v_max3_f32 v42,v42,v118,v119
 v_max3_f32 v43,v43,v92,v93
 v_max3_f32 v43,v43,v94,v95
 v_max3_f32 v43,v43,v124,v125
 v_max3_f32 v43,v43,v126,v127
 s_add_u32 s71,s71,8192
 s_cmp_lt_u32 s71,262144
 s_cbranch_scc1 K1_s1
 v_mov_b32 v44,v40
 s_nop 1
 v_permlane32_swap_b32 v40,v44
 s_nop 0
 v_max_f32 v40,v40,v44
 v_mov_b32 v44,v40
 s_nop 1
 v_permlane16_swap_b32 v40,v44
 s_nop 0
 v_max_f32 v40,v40,v44
 v_mov_b32 v45,v41
 s_nop 1
 v_permlane32_swap_b32 v41,v45
 s_nop 0
 v_max_f32 v41,v41,v45
 v_mov_b32 v45,v41
 s_nop 1
 v_permlane16_swap_b32 v41,v45
 s_nop 0
 v_max_f32 v41,v41,v45
 v_mov_b32 v46,v42
 s_nop 1
 v_permlane32_swap_b32 v42,v46
 s_nop 0
 v_max_f32 v42,v42,v46
 v_mov_b32 v46,v42
 s_nop 1
 v_permlane16_swap_b32 v42,v46
 s_nop 0
 v_max_f32 v42,v42,v46
 v_mov_b32 v47,v43
 s_nop 1
 v_permlane32_swap_b32 v43,v47
 s_nop 0
 v_max_f32 v43,v43,v47
 v_mov_b32 v47,v43
 s_nop 1
 v_permlane16_swap_b32 v43,v47
 s_nop 0
 v_max_f32 v43,v43,v47
 v_sub_f32 v224,0,v40
 v_sub_f32 v225,0,v40
 v_sub_f32 v226,0,v40
 v_sub_f32 v227,0,v40
 v_mov_b32 v248,0
 v_sub_f32 v228,0,v41
 v_sub_f32 v229,0,v41
 v_sub_f32 v230,0,v41
 v_sub_f32 v231,0,v41
 v_mov_b32 v249,0
 v_sub_f32 v232,0,v42
 v_sub_f32 v233,0,v42
 v_sub_f32 v234,0,v42
 v_sub_f32 v235,0,v42
 v_mov_b32 v250,0
 v_sub_f32 v236,0,v43
 v_sub_f32 v237,0,v43
 v_sub_f32 v238,0,v43
 v_sub_f32 v239,0,v43
 v_mov_b32 v251,0
 v_accvgpr_write_b32 a0,0
 v_accvgpr_write_b32 a1,0
 v_accvgpr_write_b32 a2,0
 v_accvgpr_write_b32 a3,0
 v_accvgpr_write_b32 a4,0
 v_accvgpr_write_b32 a5,0
 v_accvgpr_write_b32 a6,0
 v_accvgpr_write_b32 a7,0
 v_accvgpr_write_b32 a8,0
 v_accvgpr_write_b32 a9,0
 v_accvgpr_write_b32 a10,0
 v_accvgpr_write_b32 a11,0
 v_accvgpr_write_b32 a12,0
 v_accvgpr_write_b32 a13,0
 v_accvgpr_write_b32 a14,0
 v_accvgpr_write_b32 a15,0
 v_accvgpr_write_b32 a16,0
 v_accvgpr_write_b32 a17,0
 v_accvgpr_write_b32 a18,0
 v_accvgpr_write_b32 a19,0
 v_accvgpr_write_b32 a20,0
 v_accvgpr_write_b32 a21,0
 v_accvgpr_write_b32 a22,0
 v_accvgpr_write_b32 a23,0
 v_accvgpr_write_b32 a24,0
 v_accvgpr_write_b32 a25,0
 v_accvgpr_write_b32 a26,0
 v_accvgpr_write_b32 a27,0
 v_accvgpr_write_b32 a28,0
 v_accvgpr_write_b32 a29,0
 v_accvgpr_write_b32 a30,0
 v_accvgpr_write_b32 a31,0
 v_accvgpr_write_b32 a32,0
 v_accvgpr_write_b32 a33,0
 v_accvgpr_write_b32 a34,0
 v_accvgpr_write_b32 a35,0
 v_accvgpr_write_b32 a36,0
 v_accvgpr_write_b32 a37,0
 v_accvgpr_write_b32 a38,0
 v_accvgpr_write_b32 a39,0
 v_accvgpr_write_b32 a40,0
 v_accvgpr_write_b32 a41,0
 v_accvgpr_write_b32 a42,0
 v_accvgpr_write_b32 a43,0
 v_accvgpr_write_b32 a44,0
 v_accvgpr_write_b32 a45,0
 v_accvgpr_write_b32 a46,0
 v_accvgpr_write_b32 a47,0
 v_accvgpr_write_b32 a48,0
 v_accvgpr_write_b32 a49,0
 v_accvgpr_write_b32 a50,0
 v_accvgpr_write_b32 a51,0
 v_accvgpr_write_b32 a52,0
 v_accvgpr_write_b32 a53,0
 v_accvgpr_write_b32 a54,0
 v_accvgpr_write_b32 a55,0
 v_accvgpr_write_b32 a56,0
 v_accvgpr_write_b32 a57,0
 v_accvgpr_write_b32 a58,0
 v_accvgpr_write_b32 a59,0
 v_accvgpr_write_b32 a60,0
 v_accvgpr_write_b32 a61,0
 v_accvgpr_write_b32 a62,0
 v_accvgpr_write_b32 a63,0
 v_accvgpr_write_b32 a64,0
 v_accvgpr_write_b32 a65,0
 v_accvgpr_write_b32 a66,0
 v_accvgpr_write_b32 a67,0
 v_accvgpr_write_b32 a68,0
 v_accvgpr_write_b32 a69,0
 v_accvgpr_write_b32 a70,0
 v_accvgpr_write_b32 a71,0
 v_accvgpr_write_b32 a72,0
 v_accvgpr_write_b32 a73,0
 v_accvgpr_write_b32 a74,0
 v_accvgpr_write_b32 a75,0
 v_accvgpr_write_b32 a76,0
 v_accvgpr_write_b32 a77,0
 v_accvgpr_write_b32 a78,0
 v_accvgpr_write_b32 a79,0
 v_accvgpr_write_b32 a80,0
 v_accvgpr_write_b32 a81,0
 v_accvgpr_write_b32 a82,0
 v_accvgpr_write_b32 a83,0
 v_accvgpr_write_b32 a84,0
 v_accvgpr_write_b32 a85,0
 v_accvgpr_write_b32 a86,0
 v_accvgpr_write_b32 a87,0
 v_accvgpr_write_b32 a88,0
 v_accvgpr_write_b32 a89,0
 v_accvgpr_write_b32 a90,0
 v_accvgpr_write_b32 a91,0
 v_accvgpr_write_b32 a92,0
 v_accvgpr_write_b32 a93,0
 v_accvgpr_write_b32 a94,0
 v_accvgpr_write_b32 a95,0
 v_accvgpr_write_b32 a96,0
 v_accvgpr_write_b32 a97,0
 v_accvgpr_write_b32 a98,0
 v_accvgpr_write_b32 a99,0
 v_accvgpr_write_b32 a100,0
 v_accvgpr_write_b32 a101,0
 v_accvgpr_write_b32 a102,0
 v_accvgpr_write_b32 a103,0
 v_accvgpr_write_b32 a104,0
 v_accvgpr_write_b32 a105,0
 v_accvgpr_write_b32 a106,0
 v_accvgpr_write_b32 a107,0
 v_accvgpr_write_b32 a108,0
 v_accvgpr_write_b32 a109,0
 v_accvgpr_write_b32 a110,0
 v_accvgpr_write_b32 a111,0
 v_accvgpr_write_b32 a112,0
 v_accvgpr_write_b32 a113,0
 v_accvgpr_write_b32 a114,0
 v_accvgpr_write_b32 a115,0
 v_accvgpr_write_b32 a116,0
 v_accvgpr_write_b32 a117,0
 v_accvgpr_write_b32 a118,0
 v_accvgpr_write_b32 a119,0
 v_accvgpr_write_b32 a120,0
 v_accvgpr_write_b32 a121,0
 v_accvgpr_write_b32 a122,0
 v_accvgpr_write_b32 a123,0
 v_accvgpr_write_b32 a124,0
 v_accvgpr_write_b32 a125,0
 v_accvgpr_write_b32 a126,0
 v_accvgpr_write_b32 a127,0
 s_mov_b32 s71,0
K1_s2:
 s_add_u32 s64,s70,s71
 s_add_u32 s65,s64,4096
 buffer_load_dwordx4 v[132:135],v48,s[12:15],s64 offen offset:0
 buffer_load_dwordx4 v[140:143],v48,s[12:15],s64 offen offset:64
 buffer_load_dwordx4 v[148:151],v48,s[12:15],s64 offen offset:128
 buffer_load_dwordx4 v[156:159],v48,s[12:15],s64 offen offset:192
 buffer_load_dwordx4 v[164:167],v48,s[12:15],s65 offen offset:0
 buffer_load_dwordx4 v[172:175],v48,s[12:15],s65 offen offset:64
 buffer_load_dwordx4 v[180:183],v48,s[12:15],s65 offen offset:128
 buffer_load_dwordx4 v[188:191],v48,s[12:15],s65 offen offset:192
 s_waitcnt vmcnt(0)
 v_mfma_f32_16x16x32_bf16 v[68:71],v[132:135],v[64:67],v[224:227]
 v_mfma_f32_16x16x32_bf16 v[68:71],v[140:143],v[96:99],v[68:71]
 v_mfma_f32_16x16x32_bf16 v[68:71],v[148:151],v[128:131],v[68:71]
 v_mfma_f32_16x16x32_bf16 v[68:71],v[156:159],v[160:163],v[68:71]
 v_mfma_f32_16x16x32_bf16 v[76:79],v[132:135],v[72:75],v[228:231]
 v_mfma_f32_16x16x32_bf16 v[76:79],v[140:143],v[104:107],v[76:79]
 v_mfma_f32_16x16x32_bf16 v[76:79],v[148:151],v[136:139],v[76:79]
 v_mfma_f32_16x16x32_bf16 v[76:79],v[156:159],v[168:171],v[76:79]
 v_mfma_f32_16x16x32_bf16 v[84:87],v[132:135],v[80:83],v[232:235]
 v_mfma_f32_16x16x32_bf16 v[84:87],v[140:143],v[112:115],v[84:87]
 v_mfma_f32_16x16x32_bf16 v[84:87],v[148:151],v[144:147],v[84:87]
 v_mfma_f32_16x16x32_bf16 v[84:87],v[156:159],v[176:179],v[84:87]
 v_mfma_f32_16x16x32_bf16 v[92:95],v[132:135],v[88:91],v[236:239]
 v_mfma_f32_16x16x32_bf16 v[92:95],v[140:143],v[120:123],v[92:95]
 v_mfma_f32_16x16x32_bf16 v[92:95],v[148:151],v[152:155],v[92:95]
 v_mfma_f32_16x16x32_bf16 v[92:95],v[156:159],v[184:187],v[92:95]
 v_mfma_f32_16x16x32_bf16 v[100:103],v[164:167],v[64:67],v[224:227]
 v_mfma_f32_16x16x32_bf16 v[100:103],v[172:175],v[96:99],v[100:103]
 v_mfma_f32_16x16x32_bf16 v[100:103],v[180:183],v[128:131],v[100:103]
 v_mfma_f32_16x16x32_bf16 v[100:103],v[188:191],v[160:163],v[100:103]
 v_mfma_f32_16x16x32_bf16 v[108:111],v[164:167],v[72:75],v[228:231]
 v_mfma_f32_16x16x32_bf16 v[108:111],v[172:175],v[104:107],v[108:111]
 v_mfma_f32_16x16x32_bf16 v[108:111],v[180:183],v[136:139],v[108:111]
 v_mfma_f32_16x16x32_bf16 v[108:111],v[188:191],v[168:171],v[108:111]
 v_mfma_f32_16x16x32_bf16 v[116:119],v[164:167],v[80:83],v[232:235]
 v_mfma_f32_16x16x32_bf16 v[116:119],v[172:175],v[112:115],v[116:119]
 v_mfma_f32_16x16x32_bf16 v[116:119],v[180:183],v[144:147],v[116:119]
 v_mfma_f32_16x16x32_bf16 v[116:119],v[188:191],v[176:179],v[116:119]
 v_mfma_f32_16x16x32_bf16 v[124:127],v[164:167],v[88:91],v[236:239]
 v_mfma_f32_16x16x32_bf16 v[124:127],v[172:175],v[120:123],v[124:127]
 v_mfma_f32_16x16x32_bf16 v[124:127],v[180:183],v[152:155],v[124:127]
 v_mfma_f32_16x16x32_bf16 v[124:127],v[188:191],v[184:187],v[124:127]
 s_nop 7
 v_exp_f32 v68,v68
 v_exp_f32 v69,v69
 v_exp_f32 v70,v70
 v_exp_f32 v71,v71
 s_nop 0
 v_add_f32 v248,v248,v68
 v_add_f32 v248,v248,v69
 v_add_f32 v248,v248,v70
 v_add_f32 v248,v248,v71
 v_cvt_pk_bf16_f32 v192,v68,v69
 v_cvt_pk_bf16_f32 v193,v70,v71
 v_exp_f32 v100,v100
 v_exp_f32 v101,v101
 v_exp_f32 v102,v102
 v_exp_f32 v103,v103
 s_nop 0
 v_add_f32 v248,v248,v100
 v_add_f32 v248,v248,v101
 v_add_f32 v248,v248,v102
 v_add_f32 v248,v248,v103
 v_cvt_pk_bf16_f32 v194,v100,v101
 v_cvt_pk_bf16_f32 v195,v102,v103
 v_exp_f32 v76,v76
 v_exp_f32 v77,v77
 v_exp_f32 v78,v78
 v_exp_f32 v79,v79
 s_nop 0
 v_add_f32 v249,v249,v76
 v_add_f32 v249,v249,v77
 v_add_f32 v249,v249,v78
 v_add_f32 v249,v249,v79
 v_cvt_pk_bf16_f32 v196,v76,v77
 v_cvt_pk_bf16_f32 v197,v78,v79
 v_exp_f32 v108,v108
 v_exp_f32 v109,v109
 v_exp_f32 v110,v110
 v_exp_f32 v111,v111
 s_nop 0
 v_add_f32 v249,v249,v108
 v_add_f32 v249,v249,v109
 v_add_f32 v249,v249,v110
 v_add_f32 v249,v249,v111
 v_cvt_pk_bf16_f32 v198,v108,v109
 v_cvt_pk_bf16_f32 v199,v110,v111
 v_exp_f32 v84,v84
 v_exp_f32 v85,v85
 v_exp_f32 v86,v86
 v_exp_f32 v87,v87
 s_nop 0
 v_add_f32 v250,v250,v84
 v_add_f32 v250,v250,v85
 v_add_f32 v250,v250,v86
 v_add_f32 v250,v250,v87
 v_cvt_pk_bf16_f32 v200,v84,v85
 v_cvt_pk_bf16_f32 v201,v86,v87
 v_exp_f32 v116,v116
 v_exp_f32 v117,v117
 v_exp_f32 v118,v118
 v_exp_f32 v119,v119
 s_nop 0
 v_add_f32 v250,v250,v116
 v_add_f32 v250,v250,v117
 v_add_f32 v250,v250,v118
 v_add_f32 v250,v250,v119
 v_cvt_pk_bf16_f32 v202,v116,v117
 v_cvt_pk_bf16_f32 v203,v118,v119
 v_exp_f32 v92,v92
 v_exp_f32 v93,v93
 v_exp_f32 v94,v94
 v_exp_f32 v95,v95
 s_nop 0
 v_add_f32 v251,v251,v92
 v_add_f32 v251,v251,v93
 v_add_f32 v251,v251,v94
 v_add_f32 v251,v251,v95
 v_cvt_pk_bf16_f32 v204,v92,v93
 v_cvt_pk_bf16_f32 v205,v94,v95
 v_exp_f32 v124,v124
 v_exp_f32 v125,v125
 v_exp_f32 v126,v126
 v_exp_f32 v127,v127
 s_nop 0
 v_add_f32 v251,v251,v124
 v_add_f32 v251,v251,v125
 v_add_f32 v251,v251,v126
 v_add_f32 v251,v251,v127
 v_cvt_pk_bf16_f32 v206,v124,v125
 v_cvt_pk_bf16_f32 v207,v126,v127
 buffer_load_ushort v208,v49,s[16:19],s64 offen offset:0
 buffer_load_ushort v209,v49,s[16:19],s64 offen offset:256
 buffer_load_ushort v210,v49,s[16:19],s64 offen offset:512
 buffer_load_ushort v211,v49,s[16:19],s64 offen offset:768
 buffer_load_ushort v212,v49,s[16:19],s65 offen offset:0
 buffer_load_ushort v213,v49,s[16:19],s65 offen offset:256
 buffer_load_ushort v214,v49,s[16:19],s65 offen offset:512
 buffer_load_ushort v215,v49,s[16:19],s65 offen offset:768
 s_waitcnt vmcnt(0)
 v_lshl_or_b32 v216,v209,16,v208
 v_lshl_or_b32 v217,v211,16,v210
 v_lshl_or_b32 v218,v213,16,v212
 v_lshl_or_b32 v219,v215,16,v214
 s_nop 1
 v_mfma_f32_16x16x32_bf16 a[0:3],v[216:219],v[192:195],a[0:3]
 v_mfma_f32_16x16x32_bf16 a[4:7],v[216:219],v[196:199],a[4:7]
 v_mfma_f32_16x16x32_bf16 a[8:11],v[216:219],v[200:203],a[8:11]
 v_mfma_f32_16x16x32_bf16 a[12:15],v[216:219],v[204:207],a[12:15]
 buffer_load_ushort v208,v49,s[16:19],s64 offen offset:32
 buffer_load_ushort v209,v49,s[16:19],s64 offen offset:288
 buffer_load_ushort v210,v49,s[16:19],s64 offen offset:544
 buffer_load_ushort v211,v49,s[16:19],s64 offen offset:800
 buffer_load_ushort v212,v49,s[16:19],s65 offen offset:32
 buffer_load_ushort v213,v49,s[16:19],s65 offen offset:288
 buffer_load_ushort v214,v49,s[16:19],s65 offen offset:544
 buffer_load_ushort v215,v49,s[16:19],s65 offen offset:800
 s_waitcnt vmcnt(0)
 v_lshl_or_b32 v216,v209,16,v208
 v_lshl_or_b32 v217,v211,16,v210
 v_lshl_or_b32 v218,v213,16,v212
 v_lshl_or_b32 v219,v215,16,v214
 s_nop 1
 v_mfma_f32_16x16x32_bf16 a[16:19],v[216:219],v[192:195],a[16:19]
 v_mfma_f32_16x16x32_bf16 a[20:23],v[216:219],v[196:199],a[20:23]
 v_mfma_f32_16x16x32_bf16 a[24:27],v[216:219],v[200:203],a[24:27]
 v_mfma_f32_16x16x32_bf16 a[28:31],v[216:219],v[204:207],a[28:31]
 buffer_load_ushort v208,v49,s[16:19],s64 offen offset:64
 buffer_load_ushort v209,v49,s[16:19],s64 offen offset:320
 buffer_load_ushort v210,v49,s[16:19],s64 offen offset:576
 buffer_load_ushort v211,v49,s[16:19],s64 offen offset:832
 buffer_load_ushort v212,v49,s[16:19],s65 offen offset:64
 buffer_load_ushort v213,v49,s[16:19],s65 offen offset:320
 buffer_load_ushort v214,v49,s[16:19],s65 offen offset:576
 buffer_load_ushort v215,v49,s[16:19],s65 offen offset:832
 s_waitcnt vmcnt(0)
 v_lshl_or_b32 v216,v209,16,v208
 v_lshl_or_b32 v217,v211,16,v210
 v_lshl_or_b32 v218,v213,16,v212
 v_lshl_or_b32 v219,v215,16,v214
 s_nop 1
 v_mfma_f32_16x16x32_bf16 a[32:35],v[216:219],v[192:195],a[32:35]
 v_mfma_f32_16x16x32_bf16 a[36:39],v[216:219],v[196:199],a[36:39]
 v_mfma_f32_16x16x32_bf16 a[40:43],v[216:219],v[200:203],a[40:43]
 v_mfma_f32_16x16x32_bf16 a[44:47],v[216:219],v[204:207],a[44:47]
 buffer_load_ushort v208,v49,s[16:19],s64 offen offset:96
 buffer_load_ushort v209,v49,s[16:19],s64 offen offset:352
 buffer_load_ushort v210,v49,s[16:19],s64 offen offset:608
 buffer_load_ushort v211,v49,s[16:19],s64 offen offset:864
 buffer_load_ushort v212,v49,s[16:19],s65 offen offset:96
 buffer_load_ushort v213,v49,s[16:19],s65 offen offset:352
 buffer_load_ushort v214,v49,s[16:19],s65 offen offset:608
 buffer_load_ushort v215,v49,s[16:19],s65 offen offset:864
 s_waitcnt vmcnt(0)
 v_lshl_or_b32 v216,v209,16,v208
 v_lshl_or_b32 v217,v211,16,v210
 v_lshl_or_b32 v218,v213,16,v212
 v_lshl_or_b32 v219,v215,16,v214
 s_nop 1
 v_mfma_f32_16x16x32_bf16 a[48:51],v[216:219],v[192:195],a[48:51]
 v_mfma_f32_16x16x32_bf16 a[52:55],v[216:219],v[196:199],a[52:55]
 v_mfma_f32_16x16x32_bf16 a[56:59],v[216:219],v[200:203],a[56:59]
 v_mfma_f32_16x16x32_bf16 a[60:63],v[216:219],v[204:207],a[60:63]
 buffer_load_ushort v208,v49,s[16:19],s64 offen offset:128
 buffer_load_ushort v209,v49,s[16:19],s64 offen offset:384
 buffer_load_ushort v210,v49,s[16:19],s64 offen offset:640
 buffer_load_ushort v211,v49,s[16:19],s64 offen offset:896
 buffer_load_ushort v212,v49,s[16:19],s65 offen offset:128
 buffer_load_ushort v213,v49,s[16:19],s65 offen offset:384
 buffer_load_ushort v214,v49,s[16:19],s65 offen offset:640
 buffer_load_ushort v215,v49,s[16:19],s65 offen offset:896
 s_waitcnt vmcnt(0)
 v_lshl_or_b32 v216,v209,16,v208
 v_lshl_or_b32 v217,v211,16,v210
 v_lshl_or_b32 v218,v213,16,v212
 v_lshl_or_b32 v219,v215,16,v214
 s_nop 1
 v_mfma_f32_16x16x32_bf16 a[64:67],v[216:219],v[192:195],a[64:67]
 v_mfma_f32_16x16x32_bf16 a[68:71],v[216:219],v[196:199],a[68:71]
 v_mfma_f32_16x16x32_bf16 a[72:75],v[216:219],v[200:203],a[72:75]
 v_mfma_f32_16x16x32_bf16 a[76:79],v[216:219],v[204:207],a[76:79]
 buffer_load_ushort v208,v49,s[16:19],s64 offen offset:160
 buffer_load_ushort v209,v49,s[16:19],s64 offen offset:416
 buffer_load_ushort v210,v49,s[16:19],s64 offen offset:672
 buffer_load_ushort v211,v49,s[16:19],s64 offen offset:928
 buffer_load_ushort v212,v49,s[16:19],s65 offen offset:160
 buffer_load_ushort v213,v49,s[16:19],s65 offen offset:416
 buffer_load_ushort v214,v49,s[16:19],s65 offen offset:672
 buffer_load_ushort v215,v49,s[16:19],s65 offen offset:928
 s_waitcnt vmcnt(0)
 v_lshl_or_b32 v216,v209,16,v208
 v_lshl_or_b32 v217,v211,16,v210
 v_lshl_or_b32 v218,v213,16,v212
 v_lshl_or_b32 v219,v215,16,v214
 s_nop 1
 v_mfma_f32_16x16x32_bf16 a[80:83],v[216:219],v[192:195],a[80:83]
 v_mfma_f32_16x16x32_bf16 a[84:87],v[216:219],v[196:199],a[84:87]
 v_mfma_f32_16x16x32_bf16 a[88:91],v[216:219],v[200:203],a[88:91]
 v_mfma_f32_16x16x32_bf16 a[92:95],v[216:219],v[204:207],a[92:95]
 buffer_load_ushort v208,v49,s[16:19],s64 offen offset:192
 buffer_load_ushort v209,v49,s[16:19],s64 offen offset:448
 buffer_load_ushort v210,v49,s[16:19],s64 offen offset:704
 buffer_load_ushort v211,v49,s[16:19],s64 offen offset:960
 buffer_load_ushort v212,v49,s[16:19],s65 offen offset:192
 buffer_load_ushort v213,v49,s[16:19],s65 offen offset:448
 buffer_load_ushort v214,v49,s[16:19],s65 offen offset:704
 buffer_load_ushort v215,v49,s[16:19],s65 offen offset:960
 s_waitcnt vmcnt(0)
 v_lshl_or_b32 v216,v209,16,v208
 v_lshl_or_b32 v217,v211,16,v210
 v_lshl_or_b32 v218,v213,16,v212
 v_lshl_or_b32 v219,v215,16,v214
 s_nop 1
 v_mfma_f32_16x16x32_bf16 a[96:99],v[216:219],v[192:195],a[96:99]
 v_mfma_f32_16x16x32_bf16 a[100:103],v[216:219],v[196:199],a[100:103]
 v_mfma_f32_16x16x32_bf16 a[104:107],v[216:219],v[200:203],a[104:107]
 v_mfma_f32_16x16x32_bf16 a[108:111],v[216:219],v[204:207],a[108:111]
 buffer_load_ushort v208,v49,s[16:19],s64 offen offset:224
 buffer_load_ushort v209,v49,s[16:19],s64 offen offset:480
 buffer_load_ushort v210,v49,s[16:19],s64 offen offset:736
 buffer_load_ushort v211,v49,s[16:19],s64 offen offset:992
 buffer_load_ushort v212,v49,s[16:19],s65 offen offset:224
 buffer_load_ushort v213,v49,s[16:19],s65 offen offset:480
 buffer_load_ushort v214,v49,s[16:19],s65 offen offset:736
 buffer_load_ushort v215,v49,s[16:19],s65 offen offset:992
 s_waitcnt vmcnt(0)
 v_lshl_or_b32 v216,v209,16,v208
 v_lshl_or_b32 v217,v211,16,v210
 v_lshl_or_b32 v218,v213,16,v212
 v_lshl_or_b32 v219,v215,16,v214
 s_nop 1
 v_mfma_f32_16x16x32_bf16 a[112:115],v[216:219],v[192:195],a[112:115]
 v_mfma_f32_16x16x32_bf16 a[116:119],v[216:219],v[196:199],a[116:119]
 v_mfma_f32_16x16x32_bf16 a[120:123],v[216:219],v[200:203],a[120:123]
 v_mfma_f32_16x16x32_bf16 a[124:127],v[216:219],v[204:207],a[124:127]
 s_nop 7
 s_add_u32 s71,s71,8192
 s_cmp_lt_u32 s71,262144
 s_cbranch_scc1 K1_s2
 v_mov_b32 v44,v248
 s_nop 1
 v_permlane32_swap_b32 v248,v44
 s_nop 0
 v_add_f32 v248,v248,v44
 v_mov_b32 v44,v248
 s_nop 1
 v_permlane16_swap_b32 v248,v44
 s_nop 0
 v_add_f32 v248,v248,v44
 v_mov_b32 v45,v249
 s_nop 1
 v_permlane32_swap_b32 v249,v45
 s_nop 0
 v_add_f32 v249,v249,v45
 v_mov_b32 v45,v249
 s_nop 1
 v_permlane16_swap_b32 v249,v45
 s_nop 0
 v_add_f32 v249,v249,v45
 v_mov_b32 v46,v250
 s_nop 1
 v_permlane32_swap_b32 v250,v46
 s_nop 0
 v_add_f32 v250,v250,v46
 v_mov_b32 v46,v250
 s_nop 1
 v_permlane16_swap_b32 v250,v46
 s_nop 0
 v_add_f32 v250,v250,v46
 v_mov_b32 v47,v251
 s_nop 1
 v_permlane32_swap_b32 v251,v47
 s_nop 0
 v_add_f32 v251,v251,v47
 v_mov_b32 v47,v251
 s_nop 1
 v_permlane16_swap_b32 v251,v47
 s_nop 0
 v_add_f32 v251,v251,v47
 s_cmp_lg_u32 s33,0
 s_cbranch_scc1 K1_backL
 s_branch K1_back
 .p2align 6
K1_w3:
 v_subrev_u32 v26,12288,v26
 v_subrev_u32 v27,12288,v27
 v_subrev_u32 v28,12288,v28
 v_subrev_u32 v29,12288,v29
 v_subrev_u32 v30,12288,v30
 v_subrev_u32 v31,12288,v31
 s_waitcnt vmcnt(13)
 s_waitcnt lgkmcnt(0)
 s_barrier
 ds_read_b128 a[128:131],v22 offset:0
 ds_read_b128 a[144:147],v23 offset:0
 ds_read_b128 a[132:135],v22 offset:2048
 ds_read_b128 a[148:151],v23 offset:2048
 ds_read_b128 a[136:139],v22 offset:4096
 ds_read_b128 a[152:155],v23 offset:4096
 ds_read_b64_tr_b16 a[192:193],v14 offset:16384
 ds_read_b64_tr_b16 a[194:195],v14 offset:17408
 ds_read_b64_tr_b16 a[196:197],v14 offset:24576
 ds_read_b64_tr_b16 a[198:199],v14 offset:25600
 ds_read_b64_tr_b16 a[200:201],v15 offset:16384
 ds_read_b64_tr_b16 a[202:203],v15 offset:17408
 ds_read_b64_tr_b16 a[204:205],v15 offset:24576
 ds_read_b64_tr_b16 a[206:207],v15 offset:25600
 ds_read_b64_tr_b16 a[208:209],v16 offset:16384
 ds_read_b64_tr_b16 a[210:211],v16 offset:17408
 ds_read_b64_tr_b16 a[212:213],v16 offset:24576
 ds_read_b64_tr_b16 a[214:215],v16 offset:25600
 s_waitcnt lgkmcnt(12)
 s_add_u32 m0,s26,131072
 s_nop 0
 s_add_u32 s35,s30,256
 buffer_load_dwordx4 v34,s[4:7],s35 offen offset:0 lds
 s_add_u32 s35,s30,8448
 buffer_load_dwordx4 v35,s[4:7],s35 offen offset:1024 lds
 s_add_u32 s35,s30,16640
 buffer_load_dwordx4 v34,s[4:7],s35 offen offset:2048 lds
 s_add_u32 s35,s30,24832
 buffer_load_dwordx4 v35,s[4:7],s35 offen offset:3072 lds
 s_add_u32 m0,s26,135168
 s_nop 0
 s_add_u32 s35,s30,37120
 buffer_load_dwordx4 v34,s[4:7],s35 offen offset:0 lds
 s_add_u32 s35,s30,45312
 buffer_load_dwordx4 v35,s[4:7],s35 offen offset:1024 lds
 s_waitcnt lgkmcnt(10)
 v_mfma_f32_16x16x32_bf16 v[64:67],a[192:195],a[128:131],0
 s_waitcnt lgkmcnt(8)
 ds_read_b64_tr_b16 a[216:217],v17 offset:16384
 v_mfma_f32_16x16x32_bf16 v[64:67],a[196:199],a[144:147],v[64:67]
 s_waitcnt lgkmcnt(7)
 s_add_u32 m0,s25,114688
 ds_read_b64_tr_b16 a[218:219],v17 offset:17408
 v_mfma_f32_16x16x32_bf16 v[68:71],a[200:203],a[128:131],0
 s_waitcnt lgkmcnt(6)
 s_add_u32 s34,s29,1048576
 buffer_load_dwordx4 v32,s[8:11],s34 offen offset:0 lds
 v_mfma_f32_16x16x32_bf16 v[68:71],a[204:207],a[144:147],v[68:71]
 ds_read_b64_tr_b16 a[220:221],v17 offset:24576
 ds_read_b64_tr_b16 a[222:223],v17 offset:25600
 v_mfma_f32_16x16x32_bf16 v[72:75],a[192:195],a[132:135],0
 ds_read_b64_tr_b16 a[224:225],v18 offset:16384
 v_mfma_f32_16x16x32_bf16 v[72:75],a[196:199],a[148:151],v[72:75]
 ds_read_b64_tr_b16 a[226:227],v18 offset:17408
 ds_read_b64_tr_b16 a[228:229],v18 offset:24576
 v_mfma_f32_16x16x32_bf16 v[76:79],a[200:203],a[132:135],0
 s_add_u32 s34,s29,1080320
 ds_read_b64_tr_b16 a[230:231],v18 offset:25600
 buffer_load_dwordx4 v32,s[8:11],s34 offen offset:1024 lds
 v_mfma_f32_16x16x32_bf16 v[76:79],a[204:207],a[148:151],v[76:79]
 s_waitcnt vmcnt(13)
 ds_read_b128 a[160:163],v24 offset:0
 v_mfma_f32_16x16x32_bf16 v[80:83],a[192:195],a[136:139],0
 ds_read_b128 a[176:179],v25 offset:0
 v_mfma_f32_16x16x32_bf16 v[80:83],a[196:199],a[152:155],v[80:83]
 ds_read_b128 a[164:167],v24 offset:2048
 v_mfma_f32_16x16x32_bf16 v[84:87],a[200:203],a[136:139],0
 s_add_u32 s34,s29,1112064
 ds_read_b128 a[180:183],v25 offset:2048
 buffer_load_dwordx4 v33,s[8:11],s34 offen offset:2048 lds
 v_mfma_f32_16x16x32_bf16 v[84:87],a[204:207],a[152:155],v[84:87]
 s_waitcnt lgkmcnt(14)
 ds_read_b128 a[168:171],v24 offset:4096
 v_mfma_f32_16x16x32_bf16 v[96:99],a[208:211],a[128:131],0
 s_waitcnt lgkmcnt(13)
 ds_read_b128 a[184:187],v25 offset:4096
 ds_read_b64_tr_b16 a[232:233],v19 offset:16384
 v_mfma_f32_16x16x32_bf16 v[96:99],a[212:215],a[144:147],v[96:99]
 s_waitcnt lgkmcnt(13)
 s_add_u32 s34,s29,1143808
 buffer_load_dwordx4 v33,s[8:11],s34 offen offset:3072 lds
 v_mfma_f32_16x16x32_bf16 v[100:103],a[216:219],a[128:131],0
 s_waitcnt lgkmcnt(11)
 ds_read_b64_tr_b16 a[234:235],v19 offset:17408
 v_mfma_f32_16x16x32_bf16 v[100:103],a[220:223],a[144:147],v[100:103]
 ds_read_b64_tr_b16 a[236:237],v19 offset:24576
 ds_read_b64_tr_b16 a[238:239],v19 offset:25600
 v_mfma_f32_16x16x32_bf16 v[104:107],a[208:211],a[132:135],0
 s_mov_b32 m0,162816
 ds_read_b64_tr_b16 a[240:241],v20 offset:16384
 v_mfma_f32_16x16x32_bf16 v[104:107],a[212:215],a[148:151],v[104:107]
 s_mov_b32 s35,384
 buffer_load_dwordx4 v37,s[4:7],s35 offen lds
 v_mfma_f32_16x16x32_bf16 v[108:111],a[216:219],a[132:135],0
 ds_read_b64_tr_b16 a[242:243],v20 offset:17408
 ds_read_b64_tr_b16 a[244:245],v20 offset:24576
 v_mfma_f32_16x16x32_bf16 v[108:111],a[220:223],a[148:151],v[108:111]
 ds_read_b64_tr_b16 a[246:247],v20 offset:25600
 v_mfma_f32_16x16x32_bf16 v[112:115],a[208:211],a[136:139],0
 ds_read_b64_tr_b16 a[248:249],v21 offset:16384
 v_mfma_f32_16x16x32_bf16 v[112:115],a[212:215],a[152:155],v[112:115]
 s_mov_b32 s35,1572864
 ds_read_b64_tr_b16 a[250:251],v21 offset:17408
 buffer_load_dwordx4 v38,s[8:11],s35 offen lds
 v_mfma_f32_16x16x32_bf16 v[116:119],a[216:219],a[136:139],0
 ds_read_b64_tr_b16 a[252:253],v21 offset:24576
 v_mfma_f32_16x16x32_bf16 v[116:119],a[220:223],a[152:155],v[116:119]
 s_waitcnt lgkmcnt(15)
 ds_read_b64_tr_b16 a[254:255],v21 offset:25600
 v_mfma_f32_16x16x32_bf16 v[128:131],a[224:227],a[128:131],0
 s_waitcnt lgkmcnt(12)
 s_add_u32 m0,s26,32768
 v_mfma_f32_16x16x32_bf16 v[128:131],a[228:231],a[144:147],v[128:131]
 s_waitcnt lgkmcnt(10)
 s_add_u32 s35,s30,384
 buffer_load_dwordx4 v34,s[4:7],s35 offen offset:0 lds
 v_mfma_f32_16x16x32_bf16 v[132:135],a[232:235],a[128:131],0
 s_waitcnt lgkmcnt(8)
 v_mfma_f32_16x16x32_bf16 v[132:135],a[236:239],a[144:147],v[132:135]
 v_mfma_f32_16x16x32_bf16 v[136:139],a[224:227],a[132:135],0
 v_mfma_f32_16x16x32_bf16 v[136:139],a[228:231],a[148:151],v[136:139]
 s_add_u32 s35,s30,8576
 buffer_load_dwordx4 v35,s[4:7],s35 offen offset:1024 lds
 v_mfma_f32_16x16x32_bf16 v[140:143],a[232:235],a[132:135],0
 v_mfma_f32_16x16x32_bf16 v[140:143],a[236:239],a[148:151],v[140:143]
 s_waitcnt vmcnt(15)
 s_waitcnt lgkmcnt(0)
 s_barrier
 v_mfma_f32_16x16x32_bf16 v[144:147],a[224:227],a[136:139],0
 ds_read_b64_tr_b16 a[192:193],v14 offset:32768
 v_mfma_f32_16x16x32_bf16 v[144:147],a[228:231],a[152:155],v[144:147]
 s_add_u32 s35,s30,16768
 buffer_load_dwordx4 v34,s[4:7],s35 offen offset:2048 lds
 v_mfma_f32_16x16x32_bf16 v[148:151],a[232:235],a[136:139],0
 ds_read_b64_tr_b16 a[194:195],v14 offset:33792
 ds_read_b64_tr_b16 a[196:197],v14 offset:40960
 v_mfma_f32_16x16x32_bf16 v[148:151],a[236:239],a[152:155],v[148:151]
 v_mfma_f32_16x16x32_bf16 v[160:163],a[240:243],a[128:131],0
 ds_read_b64_tr_b16 a[198:199],v14 offset:41984
 ds_read_b64_tr_b16 a[200:201],v15 offset:32768
 v_mfma_f32_16x16x32_bf16 v[160:163],a[244:247],a[144:147],v[160:163]
 s_add_u32 s35,s30,24960
 buffer_load_dwordx4 v35,s[4:7],s35 offen offset:3072 lds
 v_mfma_f32_16x16x32_bf16 v[164:167],a[248:251],a[128:131],0
 ds_read_b64_tr_b16 a[202:203],v15 offset:33792
 v_mfma_f32_16x16x32_bf16 v[164:167],a[252:255],a[144:147],v[164:167]
 ds_read_b64_tr_b16 a[204:205],v15 offset:40960
 v_mfma_f32_16x16x32_bf16 v[168:171],a[240:243],a[132:135],0
 ds_read_b64_tr_b16 a[206:207],v15 offset:41984
 v_mfma_f32_16x16x32_bf16 v[168:171],a[244:247],a[148:151],v[168:171]
 s_add_u32 m0,s26,36864
 ds_read_b64_tr_b16 a[208:209],v16 offset:32768
 v_mfma_f32_16x16x32_bf16 v[172:175],a[248:251],a[132:135],0
 s_add_u32 s35,s30,37248
 buffer_load_dwordx4 v34,s[4:7],s35 offen offset:0 lds
 v_mfma_f32_16x16x32_bf16 v[172:175],a[252:255],a[148:151],v[172:175]
 ds_read_b64_tr_b16 a[210:211],v16 offset:33792
 v_mfma_f32_16x16x32_bf16 v[176:179],a[240:243],a[136:139],0
 ds_read_b64_tr_b16 a[212:213],v16 offset:40960
 v_mfma_f32_16x16x32_bf16 v[176:179],a[244:247],a[152:155],v[176:179]
 ds_read_b64_tr_b16 a[214:215],v16 offset:41984
 v_mfma_f32_16x16x32_bf16 v[180:183],a[248:251],a[136:139],0
 s_add_u32 s35,s30,45440
 buffer_load_dwordx4 v35,s[4:7],s35 offen offset:1024 lds
 v_mfma_f32_16x16x32_bf16 v[180:183],a[252:255],a[152:155],v[180:183]
 s_waitcnt lgkmcnt(10)
 v_mfma_f32_16x16x32_bf16 v[64:67],a[192:195],a[160:163],v[64:67]
 s_waitcnt lgkmcnt(8)
 ds_read_b64_tr_b16 a[216:217],v17 offset:32768
 ds_read_b64_tr_b16 a[218:219],v17 offset:33792
 v_mfma_f32_16x16x32_bf16 v[64:67],a[196:199],a[176:179],v[64:67]
 s_waitcnt lgkmcnt(8)
 s_add_u32 m0,s25,81920
 ds_read_b64_tr_b16 a[220:221],v17 offset:40960
 v_mfma_f32_16x16x32_bf16 v[68:71],a[200:203],a[160:163],v[68:71]
 s_waitcnt lgkmcnt(7)
 s_add_u32 s34,s29,1572864
 buffer_load_dwordx4 v32,s[8:11],s34 offen offset:0 lds
 v_mfma_f32_16x16x32_bf16 v[68:71],a[204:207],a[176:179],v[68:71]
 ds_read_b64_tr_b16 a[222:223],v17 offset:41984
 ds_read_b64_tr_b16 a[224:225],v18 offset:32768
 v_mfma_f32_16x16x32_bf16 v[72:75],a[192:195],a[164:167],v[72:75]
 s_add_u32 s34,s29,1604608
 buffer_load_dwordx4 v32,s[8:11],s34 offen offset:1024 lds
 v_mfma_f32_16x16x32_bf16 v[72:75],a[196:199],a[180:183],v[72:75]
 ds_read_b64_tr_b16 a[226:227],v18 offset:33792
 ds_read_b64_tr_b16 a[228:229],v18 offset:40960
 v_mfma_f32_16x16x32_bf16 v[76:79],a[200:203],a[164:167],v[76:79]
 s_add_u32 s34,s29,1636352
 ds_read_b64_tr_b16 a[230:231],v18 offset:41984
 buffer_load_dwordx4 v33,s[8:11],s34 offen offset:2048 lds
 v_mfma_f32_16x16x32_bf16 v[76:79],a[204:207],a[180:183],v[76:79]
 s_waitcnt vmcnt(15)
 ds_read_b128 a[128:131],v22 offset:0
 v_mfma_f32_16x16x32_bf16 v[80:83],a[192:195],a[168:171],v[80:83]
 s_add_u32 s34,s29,1668096
 buffer_load_dwordx4 v33,s[8:11],s34 offen offset:3072 lds
 v_mfma_f32_16x16x32_bf16 v[80:83],a[196:199],a[184:187],v[80:83]
 s_mov_b32 m0,162816
 ds_read_b128 a[144:147],v23 offset:0
 ds_read_b128 a[132:135],v22 offset:2048
 v_mfma_f32_16x16x32_bf16 v[84:87],a[200:203],a[168:171],v[84:87]
 s_mov_b32 s35,512
 ds_read_b128 a[148:151],v23 offset:2048
 buffer_load_dwordx4 v37,s[4:7],s35 offen lds
 v_mfma_f32_16x16x32_bf16 v[84:87],a[204:207],a[184:187],v[84:87]
 s_waitcnt lgkmcnt(14)
 ds_read_b128 a[136:139],v22 offset:4096
 ds_read_b128 a[152:155],v23 offset:4096
 v_mfma_f32_16x16x32_bf16 v[96:99],a[208:211],a[160:163],v[96:99]
 s_waitcnt lgkmcnt(14)
 s_mov_b32 s35,2097152
 buffer_load_dwordx4 v38,s[8:11],s35 offen lds
 v_mfma_f32_16x16x32_bf16 v[96:99],a[212:215],a[176:179],v[96:99]
 s_waitcnt lgkmcnt(12)
 ds_read_b64_tr_b16 a[232:233],v19 offset:32768
 ds_read_b64_tr_b16 a[234:235],v19 offset:33792
 v_mfma_f32_16x16x32_bf16 v[100:103],a[216:219],a[160:163],v[100:103]
 s_waitcnt lgkmcnt(12)
 s_mov_b32 s35,640
 buffer_load_dwordx4 v37,s[4:7],s35 offen lds
 v_mfma_f32_16x16x32_bf16 v[100:103],a[220:223],a[176:179],v[100:103]
 s_mov_b32 s35,2621440
 ds_read_b64_tr_b16 a[236:237],v19 offset:40960
 buffer_load_dwordx4 v38,s[8:11],s35 offen lds
 v_mfma_f32_16x16x32_bf16 v[104:107],a[208:211],a[164:167],v[104:107]
 ds_read_b64_tr_b16 a[238:239],v19 offset:41984
 ds_read_b64_tr_b16 a[240:241],v20 offset:32768
 v_mfma_f32_16x16x32_bf16 v[104:107],a[212:215],a[180:183],v[104:107]
 s_add_u32 s34,s27,0
 s_mov_b32 m0,0
 v_mfma_f32_16x16x32_bf16 v[108:111],a[216:219],a[164:167],v[108:111]
 ds_read_b64_tr_b16 a[242:243],v20 offset:33792
 buffer_load_dwordx4 v26,s[12:15],s34 offen offset:0 sc1 nt lds
 v_mfma_f32_16x16x32_bf16 v[108:111],a[220:223],a[180:183],v[108:111]
 ds_read_b64_tr_b16 a[244:245],v20 offset:40960
 ds_read_b64_tr_b16 a[246:247],v20 offset:41984
 v_mfma_f32_16x16x32_bf16 v[112:115],a[208:211],a[168:171],v[112:115]
 ds_read_b64_tr_b16 a[248:249],v21 offset:32768
 buffer_load_dwordx4 v27,s[12:15],s34 offen offset:1024 sc1 nt lds
 v_mfma_f32_16x16x32_bf16 v[112:115],a[212:215],a[184:187],v[112:115]
 ds_read_b64_tr_b16 a[250:251],v21 offset:33792
 v_mfma_f32_16x16x32_bf16 v[116:119],a[216:219],a[168:171],v[116:119]
 ds_read_b64_tr_b16 a[252:253],v21 offset:40960
 buffer_load_dwordx4 v28,s[12:15],s34 offen offset:2048 sc1 nt lds
 v_mfma_f32_16x16x32_bf16 v[116:119],a[220:223],a[184:187],v[116:119]
 s_waitcnt lgkmcnt(15)
 ds_read_b64_tr_b16 a[254:255],v21 offset:41984
 v_mfma_f32_16x16x32_bf16 v[128:131],a[224:227],a[160:163],v[128:131]
 s_waitcnt lgkmcnt(15)
 v_mfma_f32_16x16x32_bf16 v[128:131],a[228:231],a[176:179],v[128:131]
 s_waitcnt lgkmcnt(10)
 buffer_load_dwordx4 v29,s[12:15],s34 offen offset:3072 sc1 nt lds
 v_mfma_f32_16x16x32_bf16 v[132:135],a[232:235],a[160:163],v[132:135]
 s_waitcnt lgkmcnt(8)
 s_add_u32 s34,s27,4096
 s_mov_b32 m0,4096
 v_mfma_f32_16x16x32_bf16 v[132:135],a[236:239],a[176:179],v[132:135]
 buffer_load_dwordx4 v26,s[12:15],s34 offen offset:0 sc1 nt lds
 v_mfma_f32_16x16x32_bf16 v[136:139],a[224:227],a[164:167],v[136:139]
 v_mfma_f32_16x16x32_bf16 v[136:139],a[228:231],a[180:183],v[136:139]
 buffer_load_dwordx4 v27,s[12:15],s34 offen offset:1024 sc1 nt lds
 v_mfma_f32_16x16x32_bf16 v[140:143],a[232:235],a[164:167],v[140:143]
 v_mfma_f32_16x16x32_bf16 v[140:143],a[236:239],a[180:183],v[140:143]
 s_waitcnt vmcnt(22)
 s_waitcnt lgkmcnt(0)
 s_barrier
 buffer_load_dwordx4 v28,s[12:15],s34 offen offset:2048 sc1 nt lds
 v_mfma_f32_16x16x32_bf16 v[144:147],a[224:227],a[168:171],v[144:147]
 ds_read_b64_tr_b16 a[192:193],v14 offset:49152
 buffer_load_dwordx4 v29,s[12:15],s34 offen offset:3072 sc1 nt lds
 v_mfma_f32_16x16x32_bf16 v[144:147],a[228:231],a[184:187],v[144:147]
 ds_read_b64_tr_b16 a[194:195],v14 offset:50176
 ds_read_b64_tr_b16 a[196:197],v14 offset:57344
 v_mfma_f32_16x16x32_bf16 v[148:151],a[232:235],a[168:171],v[148:151]
 s_waitcnt lgkmcnt(15)
 s_add_u32 m0,s26,131072
 v_mfma_f32_16x16x32_bf16 v[148:151],a[236:239],a[184:187],v[148:151]
 s_add_u32 s35,s30,512
 buffer_load_dwordx4 v34,s[4:7],s35 offen offset:0 lds
 v_mfma_f32_16x16x32_bf16 v[160:163],a[240:243],a[160:163],v[160:163]
 ds_read_b64_tr_b16 a[198:199],v14 offset:58368
 ds_read_b64_tr_b16 a[200:201],v15 offset:49152
 v_mfma_f32_16x16x32_bf16 v[160:163],a[244:247],a[176:179],v[160:163]
 s_add_u32 s35,s30,8704
 buffer_load_dwordx4 v35,s[4:7],s35 offen offset:1024 lds
 v_mfma_f32_16x16x32_bf16 v[164:167],a[248:251],a[160:163],v[164:167]
 ds_read_b64_tr_b16 a[202:203],v15 offset:50176
 v_mfma_f32_16x16x32_bf16 v[164:167],a[252:255],a[176:179],v[164:167]
 s_add_u32 s35,s30,16896
 buffer_load_dwordx4 v34,s[4:7],s35 offen offset:2048 lds
 v_mfma_f32_16x16x32_bf16 v[168:171],a[240:243],a[164:167],v[168:171]
 ds_read_b64_tr_b16 a[204:205],v15 offset:57344
 ds_read_b64_tr_b16 a[206:207],v15 offset:58368
 v_mfma_f32_16x16x32_bf16 v[168:171],a[244:247],a[180:183],v[168:171]
 s_add_u32 s35,s30,25088
 ds_read_b64_tr_b16 a[208:209],v16 offset:49152
 buffer_load_dwordx4 v35,s[4:7],s35 offen offset:3072 lds
 v_mfma_f32_16x16x32_bf16 v[172:175],a[248:251],a[164:167],v[172:175]
 v_mfma_f32_16x16x32_bf16 v[172:175],a[252:255],a[180:183],v[172:175]
 s_add_u32 m0,s26,135168
 ds_read_b64_tr_b16 a[210:211],v16 offset:50176
 v_mfma_f32_16x16x32_bf16 v[176:179],a[240:243],a[168:171],v[176:179]
 s_add_u32 s35,s30,37376
 ds_read_b64_tr_b16 a[212:213],v16 offset:57344
 buffer_load_dwordx4 v34,s[4:7],s35 offen offset:0 lds
 v_mfma_f32_16x16x32_bf16 v[176:179],a[244:247],a[184:187],v[176:179]
 ds_read_b64_tr_b16 a[214:215],v16 offset:58368
 v_mfma_f32_16x16x32_bf16 v[180:183],a[248:251],a[168:171],v[180:183]
 s_add_u32 s35,s30,45568
 buffer_load_dwordx4 v35,s[4:7],s35 offen offset:1024 lds
 v_mfma_f32_16x16x32_bf16 v[180:183],a[252:255],a[184:187],v[180:183]
 s_waitcnt lgkmcnt(10)
 v_mfma_f32_16x16x32_bf16 v[64:67],a[192:195],a[128:131],v[64:67]
 s_waitcnt lgkmcnt(8)
 ds_read_b64_tr_b16 a[216:217],v17 offset:49152
 ds_read_b64_tr_b16 a[218:219],v17 offset:50176
 v_mfma_f32_16x16x32_bf16 v[64:67],a[196:199],a[144:147],v[64:67]
 s_waitcnt lgkmcnt(8)
 s_add_u32 m0,s25,98304
 ds_read_b64_tr_b16 a[220:221],v17 offset:57344
 v_mfma_f32_16x16x32_bf16 v[68:71],a[200:203],a[128:131],v[68:71]
 s_waitcnt lgkmcnt(7)
 s_add_u32 s34,s29,2097152
 buffer_load_dwordx4 v32,s[8:11],s34 offen offset:0 lds
 v_mfma_f32_16x16x32_bf16 v[68:71],a[204:207],a[144:147],v[68:71]
 ds_read_b64_tr_b16 a[222:223],v17 offset:58368
 ds_read_b64_tr_b16 a[224:225],v18 offset:49152
 v_mfma_f32_16x16x32_bf16 v[72:75],a[192:195],a[132:135],v[72:75]
 s_add_u32 s34,s29,2128896
 buffer_load_dwordx4 v32,s[8:11],s34 offen offset:1024 lds
 v_mfma_f32_16x16x32_bf16 v[72:75],a[196:199],a[148:151],v[72:75]
 ds_read_b64_tr_b16 a[226:227],v18 offset:50176
 ds_read_b64_tr_b16 a[228:229],v18 offset:57344
 v_mfma_f32_16x16x32_bf16 v[76:79],a[200:203],a[132:135],v[76:79]
 s_add_u32 s34,s29,2160640
 ds_read_b64_tr_b16 a[230:231],v18 offset:58368
 buffer_load_dwordx4 v33,s[8:11],s34 offen offset:2048 lds
 v_mfma_f32_16x16x32_bf16 v[76:79],a[204:207],a[148:151],v[76:79]
 s_waitcnt vmcnt(25)
 ds_read_b128 a[160:163],v24 offset:0
 v_mfma_f32_16x16x32_bf16 v[80:83],a[192:195],a[136:139],v[80:83]
 s_add_u32 s34,s29,2192384
 buffer_load_dwordx4 v33,s[8:11],s34 offen offset:3072 lds
 v_mfma_f32_16x16x32_bf16 v[80:83],a[196:199],a[152:155],v[80:83]
 s_mov_b32 m0,162816
 ds_read_b128 a[176:179],v25 offset:0
 ds_read_b128 a[164:167],v24 offset:2048
 v_mfma_f32_16x16x32_bf16 v[84:87],a[200:203],a[136:139],v[84:87]
 s_mov_b32 s35,768
 ds_read_b128 a[180:183],v25 offset:2048
 buffer_load_dwordx4 v37,s[4:7],s35 offen lds
 v_mfma_f32_16x16x32_bf16 v[84:87],a[204:207],a[152:155],v[84:87]
 s_waitcnt lgkmcnt(14)
 ds_read_b128 a[168:171],v24 offset:4096
 v_mfma_f32_16x16x32_bf16 v[96:99],a[208:211],a[128:131],v[96:99]
 s_waitcnt lgkmcnt(13)
 ds_read_b128 a[184:187],v25 offset:4096
 ds_read_b64_tr_b16 a[232:233],v19 offset:49152
 v_mfma_f32_16x16x32_bf16 v[96:99],a[212:215],a[144:147],v[96:99]
 s_waitcnt lgkmcnt(13)
 s_mov_b32 s35,3145728
 buffer_load_dwordx4 v38,s[8:11],s35 offen lds
 v_mfma_f32_16x16x32_bf16 v[100:103],a[216:219],a[128:131],v[100:103]
 s_waitcnt lgkmcnt(11)
 ds_read_b64_tr_b16 a[234:235],v19 offset:50176
 ds_read_b64_tr_b16 a[236:237],v19 offset:57344
 v_mfma_f32_16x16x32_bf16 v[100:103],a[220:223],a[144:147],v[100:103]
 ds_read_b64_tr_b16 a[238:239],v19 offset:58368
 buffer_store_dword v240,v253,s[80:83],s87 offen sc0 sc1
 v_mfma_f32_16x16x32_bf16 v[104:107],a[208:211],a[132:135],v[104:107]
 s_add_u32 s34,s27,8192
 s_mov_b32 m0,8192
 v_mfma_f32_16x16x32_bf16 v[104:107],a[212:215],a[148:151],v[104:107]
 ds_read_b64_tr_b16 a[240:241],v20 offset:49152
 buffer_load_dwordx4 v26,s[12:15],s34 offen offset:0 sc1 nt lds
 v_mfma_f32_16x16x32_bf16 v[108:111],a[216:219],a[132:135],v[108:111]
 ds_read_b64_tr_b16 a[242:243],v20 offset:50176
 ds_read_b64_tr_b16 a[244:245],v20 offset:57344
 v_mfma_f32_16x16x32_bf16 v[108:111],a[220:223],a[148:151],v[108:111]
 ds_read_b64_tr_b16 a[246:247],v20 offset:58368
 buffer_load_dwordx4 v27,s[12:15],s34 offen offset:1024 sc1 nt lds
 v_mfma_f32_16x16x32_bf16 v[112:115],a[208:211],a[136:139],v[112:115]
 ds_read_b64_tr_b16 a[248:249],v21 offset:49152
 v_mfma_f32_16x16x32_bf16 v[112:115],a[212:215],a[152:155],v[112:115]
 ds_read_b64_tr_b16 a[250:251],v21 offset:50176
 buffer_load_dwordx4 v28,s[12:15],s34 offen offset:2048 sc1 nt lds
 v_mfma_f32_16x16x32_bf16 v[116:119],a[216:219],a[136:139],v[116:119]
 ds_read_b64_tr_b16 a[252:253],v21 offset:57344
 v_mfma_f32_16x16x32_bf16 v[116:119],a[220:223],a[152:155],v[116:119]
 s_waitcnt lgkmcnt(15)
 ds_read_b64_tr_b16 a[254:255],v21 offset:58368
 buffer_load_dwordx4 v29,s[12:15],s34 offen offset:3072 sc1 nt lds
 v_mfma_f32_16x16x32_bf16 v[128:131],a[224:227],a[128:131],v[128:131]
 s_waitcnt lgkmcnt(15)
 v_mfma_f32_16x16x32_bf16 v[128:131],a[228:231],a[144:147],v[128:131]
 s_waitcnt lgkmcnt(10)
 s_add_u32 s34,s27,12288
 s_mov_b32 m0,12288
 v_mfma_f32_16x16x32_bf16 v[132:135],a[232:235],a[128:131],v[132:135]
 s_waitcnt lgkmcnt(8)
 buffer_load_dwordx4 v26,s[12:15],s34 offen offset:0 sc1 nt lds
 v_mfma_f32_16x16x32_bf16 v[132:135],a[236:239],a[144:147],v[132:135]
 v_mfma_f32_16x16x32_bf16 v[136:139],a[224:227],a[132:135],v[136:139]
 buffer_load_dwordx4 v27,s[12:15],s34 offen offset:1024 sc1 nt lds
 v_mfma_f32_16x16x32_bf16 v[136:139],a[228:231],a[148:151],v[136:139]
 v_mfma_f32_16x16x32_bf16 v[140:143],a[232:235],a[132:135],v[140:143]
 buffer_load_dwordx4 v28,s[12:15],s34 offen offset:2048 sc1 nt lds
 v_mfma_f32_16x16x32_bf16 v[140:143],a[236:239],a[148:151],v[140:143]
 s_waitcnt vmcnt(32)
 s_waitcnt lgkmcnt(0)
 s_barrier
 ds_read_b64_tr_b16 a[192:193],v14 offset:16384
 v_mfma_f32_16x16x32_bf16 v[144:147],a[224:227],a[136:139],v[144:147]
 s_add_u32 s27,s27,16384
 buffer_load_dwordx4 v29,s[12:15],s34 offen offset:3072 sc1 nt lds
 v_mfma_f32_16x16x32_bf16 v[144:147],a[228:231],a[152:155],v[144:147]
 s_waitcnt lgkmcnt(15)
 s_add_u32 m0,s26,32768
 v_mfma_f32_16x16x32_bf16 v[148:151],a[232:235],a[136:139],v[148:151]
 ds_read_b64_tr_b16 a[194:195],v14 offset:17408
 ds_read_b64_tr_b16 a[196:197],v14 offset:24576
 v_mfma_f32_16x16x32_bf16 v[148:151],a[236:239],a[152:155],v[148:151]
 s_add_u32 s35,s30,640
 buffer_load_dwordx4 v34,s[4:7],s35 offen offset:0 lds
 v_mfma_f32_16x16x32_bf16 v[160:163],a[240:243],a[128:131],v[160:163]
 ds_read_b64_tr_b16 a[198:199],v14 offset:25600
 ds_read_b64_tr_b16 a[200:201],v15 offset:16384
 v_mfma_f32_16x16x32_bf16 v[160:163],a[244:247],a[144:147],v[160:163]
 s_add_u32 s35,s30,8832
 buffer_load_dwordx4 v35,s[4:7],s35 offen offset:1024 lds
 v_mfma_f32_16x16x32_bf16 v[164:167],a[248:251],a[128:131],v[164:167]
 ds_read_b64_tr_b16 a[202:203],v15 offset:17408
 v_mfma_f32_16x16x32_bf16 v[164:167],a[252:255],a[144:147],v[164:167]
 s_add_u32 s35,s30,17024
 buffer_load_dwordx4 v34,s[4:7],s35 offen offset:2048 lds
 v_mfma_f32_16x16x32_bf16 v[168:171],a[240:243],a[132:135],v[168:171]
 ds_read_b64_tr_b16 a[204:205],v15 offset:24576
 ds_read_b64_tr_b16 a[206:207],v15 offset:25600
 v_mfma_f32_16x16x32_bf16 v[168:171],a[244:247],a[148:151],v[168:171]
 s_add_u32 s35,s30,25216
 ds_read_b64_tr_b16 a[208:209],v16 offset:16384
 buffer_load_dwordx4 v35,s[4:7],s35 offen offset:3072 lds
 v_mfma_f32_16x16x32_bf16 v[172:175],a[248:251],a[132:135],v[172:175]
 v_mfma_f32_16x16x32_bf16 v[172:175],a[252:255],a[148:151],v[172:175]
 s_add_u32 m0,s26,36864
 ds_read_b64_tr_b16 a[210:211],v16 offset:17408
 v_mfma_f32_16x16x32_bf16 v[176:179],a[240:243],a[136:139],v[176:179]
 s_add_u32 s35,s30,37504
 ds_read_b64_tr_b16 a[212:213],v16 offset:24576
 buffer_load_dwordx4 v34,s[4:7],s35 offen offset:0 lds
 v_mfma_f32_16x16x32_bf16 v[176:179],a[244:247],a[152:155],v[176:179]
 ds_read_b64_tr_b16 a[214:215],v16 offset:25600
 v_mfma_f32_16x16x32_bf16 v[180:183],a[248:251],a[136:139],v[180:183]
 s_add_u32 s35,s30,45696
 buffer_load_dwordx4 v35,s[4:7],s35 offen offset:1024 lds
 v_mfma_f32_16x16x32_bf16 v[180:183],a[252:255],a[152:155],v[180:183]
 s_waitcnt lgkmcnt(10)
 v_mfma_f32_16x16x32_bf16 v[64:67],a[192:195],a[160:163],v[64:67]
 s_waitcnt lgkmcnt(8)
 ds_read_b64_tr_b16 a[216:217],v17 offset:16384
 v_mfma_f32_16x16x32_bf16 v[64:67],a[196:199],a[176:179],v[64:67]
 s_waitcnt lgkmcnt(7)
 s_add_u32 m0,s25,114688
 ds_read_b64_tr_b16 a[218:219],v17 offset:17408
 v_mfma_f32_16x16x32_bf16 v[68:71],a[200:203],a[160:163],v[68:71]
 s_waitcnt lgkmcnt(6)
 s_add_u32 s34,s29,2621440
 buffer_load_dwordx4 v32,s[8:11],s34 offen offset:0 lds
 v_mfma_f32_16x16x32_bf16 v[68:71],a[204:207],a[176:179],v[68:71]
 ds_read_b64_tr_b16 a[220:221],v17 offset:24576
 ds_read_b64_tr_b16 a[222:223],v17 offset:25600
 v_mfma_f32_16x16x32_bf16 v[72:75],a[192:195],a[164:167],v[72:75]
 ds_read_b64_tr_b16 a[224:225],v18 offset:16384
 ds_read_b64_tr_b16 a[226:227],v18 offset:17408
 v_mfma_f32_16x16x32_bf16 v[72:75],a[196:199],a[180:183],v[72:75]
 s_add_u32 s34,s29,2653184
 ds_read_b64_tr_b16 a[228:229],v18 offset:24576
 buffer_load_dwordx4 v32,s[8:11],s34 offen offset:1024 lds
 v_mfma_f32_16x16x32_bf16 v[76:79],a[200:203],a[164:167],v[76:79]
 s_add_u32 s34,s29,2684928
 ds_read_b64_tr_b16 a[230:231],v18 offset:25600
 buffer_load_dwordx4 v33,s[8:11],s34 offen offset:2048 lds
 v_mfma_f32_16x16x32_bf16 v[76:79],a[204:207],a[180:183],v[76:79]
 s_waitcnt vmcnt(24)
 ds_read_b128 a[128:131],v22 offset:0
 v_mfma_f32_16x16x32_bf16 v[80:83],a[192:195],a[168:171],v[80:83]
 ds_read_b128 a[144:147],v23 offset:0
 v_mfma_f32_16x16x32_bf16 v[80:83],a[196:199],a[184:187],v[80:83]
 s_add_u32 s34,s29,2716672
 ds_read_b128 a[132:135],v22 offset:2048
 buffer_load_dwordx4 v33,s[8:11],s34 offen offset:3072 lds
 v_mfma_f32_16x16x32_bf16 v[84:87],a[200:203],a[168:171],v[84:87]
 s_mov_b32 m0,162816
 ds_read_b128 a[148:151],v23 offset:2048
 ds_read_b128 a[136:139],v22 offset:4096
 v_mfma_f32_16x16x32_bf16 v[84:87],a[204:207],a[184:187],v[84:87]
 s_waitcnt lgkmcnt(15)
 s_mov_b32 s35,896
 buffer_load_dwordx4 v37,s[4:7],s35 offen lds
 v_mfma_f32_16x16x32_bf16 v[96:99],a[208:211],a[160:163],v[96:99]
 s_waitcnt lgkmcnt(13)
 ds_read_b128 a[152:155],v23 offset:4096
 ds_read_b64_tr_b16 a[232:233],v19 offset:16384
 v_mfma_f32_16x16x32_bf16 v[96:99],a[212:215],a[176:179],v[96:99]
 s_waitcnt lgkmcnt(13)
 s_mov_b32 s35,3670016
 buffer_load_dwordx4 v38,s[8:11],s35 offen lds
 v_mfma_f32_16x16x32_bf16 v[100:103],a[216:219],a[160:163],v[100:103]
 s_waitcnt lgkmcnt(11)
 ds_read_b64_tr_b16 a[234:235],v19 offset:17408
 v_mfma_f32_16x16x32_bf16 v[100:103],a[220:223],a[176:179],v[100:103]
 s_add_u32 s34,s27,0
 s_mov_b32 m0,16384
 ds_read_b64_tr_b16 a[236:237],v19 offset:24576
 v_mfma_f32_16x16x32_bf16 v[104:107],a[208:211],a[164:167],v[104:107]
 ds_read_b64_tr_b16 a[238:239],v19 offset:25600
 buffer_load_dwordx4 v26,s[12:15],s34 offen offset:0 sc1 nt lds
 v_mfma_f32_16x16x32_bf16 v[104:107],a[212:215],a[180:183],v[104:107]
 ds_read_b64_tr_b16 a[240:241],v20 offset:16384
 ds_read_b64_tr_b16 a[242:243],v20 offset:17408
 v_mfma_f32_16x16x32_bf16 v[108:111],a[216:219],a[164:167],v[108:111]
 ds_read_b64_tr_b16 a[244:245],v20 offset:24576
 buffer_load_dwordx4 v27,s[12:15],s34 offen offset:1024 sc1 nt lds
 v_mfma_f32_16x16x32_bf16 v[108:111],a[220:223],a[180:183],v[108:111]
 ds_read_b64_tr_b16 a[246:247],v20 offset:25600
 v_mfma_f32_16x16x32_bf16 v[112:115],a[208:211],a[168:171],v[112:115]
 ds_read_b64_tr_b16 a[248:249],v21 offset:16384
 buffer_load_dwordx4 v28,s[12:15],s34 offen offset:2048 sc1 nt lds
 v_mfma_f32_16x16x32_bf16 v[112:115],a[212:215],a[184:187],v[112:115]
 ds_read_b64_tr_b16 a[250:251],v21 offset:17408
 v_mfma_f32_16x16x32_bf16 v[116:119],a[216:219],a[168:171],v[116:119]
 ds_read_b64_tr_b16 a[252:253],v21 offset:24576
 buffer_load_dwordx4 v29,s[12:15],s34 offen offset:3072 sc1 nt lds
 v_mfma_f32_16x16x32_bf16 v[116:119],a[220:223],a[184:187],v[116:119]
 s_waitcnt lgkmcnt(15)
 ds_read_b64_tr_b16 a[254:255],v21 offset:25600
 v_mfma_f32_16x16x32_bf16 v[128:131],a[224:227],a[160:163],v[128:131]
 s_waitcnt lgkmcnt(15)
 s_add_u32 s34,s27,4096
 s_mov_b32 m0,20480
 v_mfma_f32_16x16x32_bf16 v[128:131],a[228:231],a[176:179],v[128:131]
 s_waitcnt lgkmcnt(10)
 buffer_load_dwordx4 v26,s[12:15],s34 offen offset:0 sc1 nt lds
 v_mfma_f32_16x16x32_bf16 v[132:135],a[232:235],a[160:163],v[132:135]
 s_waitcnt lgkmcnt(8)
 v_mfma_f32_16x16x32_bf16 v[132:135],a[236:239],a[176:179],v[132:135]
 buffer_load_dwordx4 v27,s[12:15],s34 offen offset:1024 sc1 nt lds
 v_mfma_f32_16x16x32_bf16 v[136:139],a[224:227],a[164:167],v[136:139]
 v_mfma_f32_16x16x32_bf16 v[136:139],a[228:231],a[180:183],v[136:139]
 buffer_load_dwordx4 v28,s[12:15],s34 offen offset:2048 sc1 nt lds
 v_mfma_f32_16x16x32_bf16 v[140:143],a[232:235],a[164:167],v[140:143]
 v_mfma_f32_16x16x32_bf16 v[140:143],a[236:239],a[180:183],v[140:143]
 s_waitcnt vmcnt(30)
 s_waitcnt lgkmcnt(0)
 s_barrier
 buffer_load_dwordx4 v29,s[12:15],s34 offen offset:3072 sc1 nt lds
 v_mfma_f32_16x16x32_bf16 v[144:147],a[224:227],a[168:171],v[144:147]
 s_waitcnt lgkmcnt(15)
 s_add_u32 m0,s26,131072
 v_mfma_f32_16x16x32_bf16 v[144:147],a[228:231],a[184:187],v[144:147]
 ds_read_b64_tr_b16 a[192:193],v14 offset:32768
 ds_read_b64_tr_b16 a[194:195],v14 offset:33792
 v_mfma_f32_16x16x32_bf16 v[148:151],a[232:235],a[168:171],v[148:151]
 s_add_u32 s35,s30,768
 buffer_load_dwordx4 v34,s[4:7],s35 offen offset:0 lds
 v_mfma_f32_16x16x32_bf16 v[148:151],a[236:239],a[184:187],v[148:151]
 ds_read_b64_tr_b16 a[196:197],v14 offset:40960
 ds_read_b64_tr_b16 a[198:199],v14 offset:41984
 v_mfma_f32_16x16x32_bf16 v[160:163],a[240:243],a[160:163],v[160:163]
 s_add_u32 s35,s30,8960
 buffer_load_dwordx4 v35,s[4:7],s35 offen offset:1024 lds
 v_mfma_f32_16x16x32_bf16 v[160:163],a[244:247],a[176:179],v[160:163]
 ds_read_b64_tr_b16 a[200:201],v15 offset:32768
 v_mfma_f32_16x16x32_bf16 v[164:167],a[248:251],a[160:163],v[164:167]
 ds_read_b64_tr_b16 a[202:203],v15 offset:33792
 v_mfma_f32_16x16x32_bf16 v[164:167],a[252:255],a[176:179],v[164:167]
 s_add_u32 s35,s30,17152
 buffer_load_dwordx4 v34,s[4:7],s35 offen offset:2048 lds
 v_mfma_f32_16x16x32_bf16 v[168:171],a[240:243],a[164:167],v[168:171]
 ds_read_b64_tr_b16 a[204:205],v15 offset:40960
 ds_read_b64_tr_b16 a[206:207],v15 offset:41984
 v_mfma_f32_16x16x32_bf16 v[168:171],a[244:247],a[180:183],v[168:171]
 s_add_u32 s35,s30,25344
 ds_read_b64_tr_b16 a[208:209],v16 offset:32768
 buffer_load_dwordx4 v35,s[4:7],s35 offen offset:3072 lds
 v_mfma_f32_16x16x32_bf16 v[172:175],a[248:251],a[164:167],v[172:175]
 v_mfma_f32_16x16x32_bf16 v[172:175],a[252:255],a[180:183],v[172:175]
 s_add_u32 m0,s26,135168
 ds_read_b64_tr_b16 a[210:211],v16 offset:33792
 v_mfma_f32_16x16x32_bf16 v[176:179],a[240:243],a[168:171],v[176:179]
 s_add_u32 s35,s30,37632
 ds_read_b64_tr_b16 a[212:213],v16 offset:40960
 buffer_load_dwordx4 v34,s[4:7],s35 offen offset:0 lds
 v_mfma_f32_16x16x32_bf16 v[176:179],a[244:247],a[184:187],v[176:179]
 ds_read_b64_tr_b16 a[214:215],v16 offset:41984
 v_mfma_f32_16x16x32_bf16 v[180:183],a[248:251],a[168:171],v[180:183]
 s_add_u32 s35,s30,45824
 buffer_load_dwordx4 v35,s[4:7],s35 offen offset:1024 lds
 v_mfma_f32_16x16x32_bf16 v[180:183],a[252:255],a[184:187],v[180:183]
 s_waitcnt lgkmcnt(10)
 v_mfma_f32_16x16x32_bf16 v[64:67],a[192:195],a[128:131],v[64:67]
 s_waitcnt lgkmcnt(8)
 ds_read_b64_tr_b16 a[216:217],v17 offset:32768
 v_mfma_f32_16x16x32_bf16 v[64:67],a[196:199],a[144:147],v[64:67]
 s_waitcnt lgkmcnt(7)
 s_add_u32 m0,s25,81920
 ds_read_b64_tr_b16 a[218:219],v17 offset:33792
 v_mfma_f32_16x16x32_bf16 v[68:71],a[200:203],a[128:131],v[68:71]
 s_waitcnt lgkmcnt(6)
 s_add_u32 s34,s29,3145728
 buffer_load_dwordx4 v32,s[8:11],s34 offen offset:0 lds
 v_mfma_f32_16x16x32_bf16 v[68:71],a[204:207],a[144:147],v[68:71]
 ds_read_b64_tr_b16 a[220:221],v17 offset:40960
 ds_read_b64_tr_b16 a[222:223],v17 offset:41984
 v_mfma_f32_16x16x32_bf16 v[72:75],a[192:195],a[132:135],v[72:75]
 ds_read_b64_tr_b16 a[224:225],v18 offset:32768
 ds_read_b64_tr_b16 a[226:227],v18 offset:33792
 v_mfma_f32_16x16x32_bf16 v[72:75],a[196:199],a[148:151],v[72:75]
 s_add_u32 s34,s29,3177472
 ds_read_b64_tr_b16 a[228:229],v18 offset:40960
 buffer_load_dwordx4 v32,s[8:11],s34 offen offset:1024 lds
 v_mfma_f32_16x16x32_bf16 v[76:79],a[200:203],a[132:135],v[76:79]
 s_add_u32 s34,s29,3209216
 ds_read_b64_tr_b16 a[230:231],v18 offset:41984
 buffer_load_dwordx4 v33,s[8:11],s34 offen offset:2048 lds
 v_mfma_f32_16x16x32_bf16 v[76:79],a[204:207],a[148:151],v[76:79]
 s_waitcnt vmcnt(23)
 ds_read_b128 a[160:163],v24 offset:0
 v_mfma_f32_16x16x32_bf16 v[80:83],a[192:195],a[136:139],v[80:83]
 ds_read_b128 a[176:179],v25 offset:0
 v_mfma_f32_16x16x32_bf16 v[80:83],a[196:199],a[152:155],v[80:83]
 s_add_u32 s34,s29,3240960
 ds_read_b128 a[164:167],v24 offset:2048
 buffer_load_dwordx4 v33,s[8:11],s34 offen offset:3072 lds
 v_mfma_f32_16x16x32_bf16 v[84:87],a[200:203],a[136:139],v[84:87]
 s_mov_b32 m0,162816
 ds_read_b128 a[180:183],v25 offset:2048
 ds_read_b128 a[168:171],v24 offset:4096
 v_mfma_f32_16x16x32_bf16 v[84:87],a[204:207],a[152:155],v[84:87]
 s_waitcnt lgkmcnt(15)
 s_mov_b32 s35,1024
 buffer_load_dwordx4 v37,s[4:7],s35 offen lds
 v_mfma_f32_16x16x32_bf16 v[96:99],a[208:211],a[128:131],v[96:99]
 s_waitcnt lgkmcnt(13)
 ds_read_b128 a[184:187],v25 offset:4096
 ds_read_b64_tr_b16 a[232:233],v19 offset:32768
 v_mfma_f32_16x16x32_bf16 v[96:99],a[212:215],a[144:147],v[96:99]
 s_waitcnt lgkmcnt(13)
 s_mov_b32 s35,4194304
 buffer_load_dwordx4 v38,s[8:11],s35 offen lds
 v_mfma_f32_16x16x32_bf16 v[100:103],a[216:219],a[128:131],v[100:103]
 s_waitcnt lgkmcnt(11)
 ds_read_b64_tr_b16 a[234:235],v19 offset:33792
 v_mfma_f32_16x16x32_bf16 v[100:103],a[220:223],a[144:147],v[100:103]
 s_add_u32 s34,s27,8192
 s_mov_b32 m0,24576
 ds_read_b64_tr_b16 a[236:237],v19 offset:40960
 v_mfma_f32_16x16x32_bf16 v[104:107],a[208:211],a[132:135],v[104:107]
 ds_read_b64_tr_b16 a[238:239],v19 offset:41984
 buffer_load_dwordx4 v26,s[12:15],s34 offen offset:0 sc1 nt lds
 v_mfma_f32_16x16x32_bf16 v[104:107],a[212:215],a[148:151],v[104:107]
 ds_read_b64_tr_b16 a[240:241],v20 offset:32768
 ds_read_b64_tr_b16 a[242:243],v20 offset:33792
 v_mfma_f32_16x16x32_bf16 v[108:111],a[216:219],a[132:135],v[108:111]
 ds_read_b64_tr_b16 a[244:245],v20 offset:40960
 buffer_load_dwordx4 v27,s[12:15],s34 offen offset:1024 sc1 nt lds
 v_mfma_f32_16x16x32_bf16 v[108:111],a[220:223],a[148:151],v[108:111]
 ds_read_b64_tr_b16 a[246:247],v20 offset:41984
 v_mfma_f32_16x16x32_bf16 v[112:115],a[208:211],a[136:139],v[112:115]
 ds_read_b64_tr_b16 a[248:249],v21 offset:32768
 buffer_load_dwordx4 v28,s[12:15],s34 offen offset:2048 sc1 nt lds
 v_mfma_f32_16x16x32_bf16 v[112:115],a[212:215],a[152:155],v[112:115]
 ds_read_b64_tr_b16 a[250:251],v21 offset:33792
 v_mfma_f32_16x16x32_bf16 v[116:119],a[216:219],a[136:139],v[116:119]
 ds_read_b64_tr_b16 a[252:253],v21 offset:40960
 buffer_load_dwordx4 v29,s[12:15],s34 offen offset:3072 sc1 nt lds
 v_mfma_f32_16x16x32_bf16 v[116:119],a[220:223],a[152:155],v[116:119]
 s_waitcnt lgkmcnt(15)
 ds_read_b64_tr_b16 a[254:255],v21 offset:41984
 v_mfma_f32_16x16x32_bf16 v[128:131],a[224:227],a[128:131],v[128:131]
 s_waitcnt lgkmcnt(15)
 s_add_u32 s34,s27,12288
 s_mov_b32 m0,28672
 v_mfma_f32_16x16x32_bf16 v[128:131],a[228:231],a[144:147],v[128:131]
 s_waitcnt lgkmcnt(10)
 buffer_load_dwordx4 v26,s[12:15],s34 offen offset:0 sc1 nt lds
 v_mfma_f32_16x16x32_bf16 v[132:135],a[232:235],a[128:131],v[132:135]
 s_waitcnt lgkmcnt(8)
 v_mfma_f32_16x16x32_bf16 v[132:135],a[236:239],a[144:147],v[132:135]
 buffer_load_dwordx4 v27,s[12:15],s34 offen offset:1024 sc1 nt lds
 v_mfma_f32_16x16x32_bf16 v[136:139],a[224:227],a[132:135],v[136:139]
 v_mfma_f32_16x16x32_bf16 v[136:139],a[228:231],a[148:151],v[136:139]
 buffer_load_dwordx4 v28,s[12:15],s34 offen offset:2048 sc1 nt lds
 v_mfma_f32_16x16x32_bf16 v[140:143],a[232:235],a[132:135],v[140:143]
 s_add_u32 s27,s27,16384
 buffer_load_dwordx4 v29,s[12:15],s34 offen offset:3072 sc1 nt lds
 v_mfma_f32_16x16x32_bf16 v[140:143],a[236:239],a[148:151],v[140:143]
 s_waitcnt vmcnt(30)
 s_waitcnt lgkmcnt(0)
 s_barrier
 v_mfma_f32_16x16x32_bf16 v[144:147],a[224:227],a[136:139],v[144:147]
 s_waitcnt lgkmcnt(15)
 s_add_u32 m0,s26,32768
 v_mfma_f32_16x16x32_bf16 v[144:147],a[228:231],a[152:155],v[144:147]
 ds_read_b64_tr_b16 a[192:193],v14 offset:49152
 ds_read_b64_tr_b16 a[194:195],v14 offset:50176
 v_mfma_f32_16x16x32_bf16 v[148:151],a[232:235],a[136:139],v[148:151]
 s_add_u32 s35,s30,896
 buffer_load_dwordx4 v34,s[4:7],s35 offen offset:0 lds
 v_mfma_f32_16x16x32_bf16 v[148:151],a[236:239],a[152:155],v[148:151]
 ds_read_b64_tr_b16 a[196:197],v14 offset:57344
 ds_read_b64_tr_b16 a[198:199],v14 offset:58368
 v_mfma_f32_16x16x32_bf16 v[160:163],a[240:243],a[128:131],v[160:163]
 s_add_u32 s35,s30,9088
 buffer_load_dwordx4 v35,s[4:7],s35 offen offset:1024 lds
 v_mfma_f32_16x16x32_bf16 v[160:163],a[244:247],a[144:147],v[160:163]
 ds_read_b64_tr_b16 a[200:201],v15 offset:49152
 v_mfma_f32_16x16x32_bf16 v[164:167],a[248:251],a[128:131],v[164:167]
 ds_read_b64_tr_b16 a[202:203],v15 offset:50176
 v_mfma_f32_16x16x32_bf16 v[164:167],a[252:255],a[144:147],v[164:167]
 s_add_u32 s35,s30,17280
 buffer_load_dwordx4 v34,s[4:7],s35 offen offset:2048 lds
 v_mfma_f32_16x16x32_bf16 v[168:171],a[240:243],a[132:135],v[168:171]
 ds_read_b64_tr_b16 a[204:205],v15 offset:57344
 ds_read_b64_tr_b16 a[206:207],v15 offset:58368
 v_mfma_f32_16x16x32_bf16 v[168:171],a[244:247],a[148:151],v[168:171]
 s_add_u32 s35,s30,25472
 ds_read_b64_tr_b16 a[208:209],v16 offset:49152
 buffer_load_dwordx4 v35,s[4:7],s35 offen offset:3072 lds
 v_mfma_f32_16x16x32_bf16 v[172:175],a[248:251],a[132:135],v[172:175]
 v_mfma_f32_16x16x32_bf16 v[172:175],a[252:255],a[148:151],v[172:175]
 s_add_u32 m0,s26,36864
 ds_read_b64_tr_b16 a[210:211],v16 offset:50176
 v_mfma_f32_16x16x32_bf16 v[176:179],a[240:243],a[136:139],v[176:179]
 s_add_u32 s35,s30,37760
 ds_read_b64_tr_b16 a[212:213],v16 offset:57344
 buffer_load_dwordx4 v34,s[4:7],s35 offen offset:0 lds
 v_mfma_f32_16x16x32_bf16 v[176:179],a[244:247],a[152:155],v[176:179]
 ds_read_b64_tr_b16 a[214:215],v16 offset:58368
 v_mfma_f32_16x16x32_bf16 v[180:183],a[248:251],a[136:139],v[180:183]
 s_add_u32 s35,s30,45952
 buffer_load_dwordx4 v35,s[4:7],s35 offen offset:1024 lds
 v_mfma_f32_16x16x32_bf16 v[180:183],a[252:255],a[152:155],v[180:183]
 s_waitcnt lgkmcnt(10)
 v_mfma_f32_16x16x32_bf16 v[64:67],a[192:195],a[160:163],v[64:67]
 s_waitcnt lgkmcnt(8)
 ds_read_b64_tr_b16 a[216:217],v17 offset:49152
 v_mfma_f32_16x16x32_bf16 v[64:67],a[196:199],a[176:179],v[64:67]
 s_waitcnt lgkmcnt(7)
 s_add_u32 m0,s25,98304
 ds_read_b64_tr_b16 a[218:219],v17 offset:50176
 v_mfma_f32_16x16x32_bf16 v[68:71],a[200:203],a[160:163],v[68:71]
 s_waitcnt lgkmcnt(6)
 s_add_u32 s34,s29,3670016
 buffer_load_dwordx4 v32,s[8:11],s34 offen offset:0 lds
 v_mfma_f32_16x16x32_bf16 v[68:71],a[204:207],a[176:179],v[68:71]
 ds_read_b64_tr_b16 a[220:221],v17 offset:57344
 ds_read_b64_tr_b16 a[222:223],v17 offset:58368
 v_mfma_f32_16x16x32_bf16 v[72:75],a[192:195],a[164:167],v[72:75]
 ds_read_b64_tr_b16 a[224:225],v18 offset:49152
 ds_read_b64_tr_b16 a[226:227],v18 offset:50176
 v_mfma_f32_16x16x32_bf16 v[72:75],a[196:199],a[180:183],v[72:75]
 s_add_u32 s34,s29,3701760
 ds_read_b64_tr_b16 a[228:229],v18 offset:57344
 buffer_load_dwordx4 v32,s[8:11],s34 offen offset:1024 lds
 v_mfma_f32_16x16x32_bf16 v[76:79],a[200:203],a[164:167],v[76:79]
 ds_read_b64_tr_b16 a[230:231],v18 offset:58368
 s_waitcnt vmcnt(22)
 ds_read_b128 a[128:131],v22 offset:0
 v_mfma_f32_16x16x32_bf16 v[76:79],a[204:207],a[180:183],v[76:79]
 s_add_u32 s34,s29,3733504
 buffer_load_dwordx4 v33,s[8:11],s34 offen offset:2048 lds
 v_mfma_f32_16x16x32_bf16 v[80:83],a[192:195],a[168:171],v[80:83]
 ds_read_b128 a[144:147],v23 offset:0
 v_mfma_f32_16x16x32_bf16 v[80:83],a[196:199],a[184:187],v[80:83]
 s_add_u32 s34,s29,3765248
 ds_read_b128 a[132:135],v22 offset:2048
 buffer_load_dwordx4 v33,s[8:11],s34 offen offset:3072 lds
 v_mfma_f32_16x16x32_bf16 v[84:87],a[200:203],a[168:171],v[84:87]
 s_add_u32 s34,s28,0
 s_mov_b32 m0,65536
 ds_read_b128 a[148:151],v23 offset:2048
 v_mfma_f32_16x16x32_bf16 v[84:87],a[204:207],a[184:187],v[84:87]
 s_waitcnt lgkmcnt(14)
 ds_read_b128 a[136:139],v22 offset:4096
 v_mfma_f32_16x16x32_bf16 v[96:99],a[208:211],a[160:163],v[96:99]
 s_waitcnt lgkmcnt(13)
 ds_read_b128 a[152:155],v23 offset:4096
 buffer_load_dwordx4 v30,s[16:19],s34 offen offset:0 sc1 nt lds
 v_mfma_f32_16x16x32_bf16 v[96:99],a[212:215],a[176:179],v[96:99]
 s_waitcnt lgkmcnt(12)
 ds_read_b64_tr_b16 a[232:233],v19 offset:49152
 v_mfma_f32_16x16x32_bf16 v[100:103],a[216:219],a[160:163],v[100:103]
 s_waitcnt lgkmcnt(11)
 ds_read_b64_tr_b16 a[234:235],v19 offset:50176
 v_mfma_f32_16x16x32_bf16 v[100:103],a[220:223],a[176:179],v[100:103]
 ds_read_b64_tr_b16 a[236:237],v19 offset:57344
 buffer_load_dwordx4 v31,s[16:19],s34 offen offset:1024 sc1 nt lds
 v_mfma_f32_16x16x32_bf16 v[104:107],a[208:211],a[164:167],v[104:107]
 ds_read_b64_tr_b16 a[238:239],v19 offset:58368
 v_mfma_f32_16x16x32_bf16 v[104:107],a[212:215],a[180:183],v[104:107]
 ds_read_b64_tr_b16 a[240:241],v20 offset:49152
 buffer_load_dwordx4 v30,s[16:19],s34 offen offset:2048 sc1 nt lds
 v_mfma_f32_16x16x32_bf16 v[108:111],a[216:219],a[164:167],v[108:111]
 ds_read_b64_tr_b16 a[242:243],v20 offset:50176
 ds_read_b64_tr_b16 a[244:245],v20 offset:57344
 v_mfma_f32_16x16x32_bf16 v[108:111],a[220:223],a[180:183],v[108:111]
 ds_read_b64_tr_b16 a[246:247],v20 offset:58368
 buffer_load_dwordx4 v31,s[16:19],s34 offen offset:3072 sc1 nt lds
 v_mfma_f32_16x16x32_bf16 v[112:115],a[208:211],a[168:171],v[112:115]
 ds_read_b64_tr_b16 a[248:249],v21 offset:49152
 v_mfma_f32_16x16x32_bf16 v[112:115],a[212:215],a[184:187],v[112:115]
 s_add_u32 s34,s28,4096
 s_mov_b32 m0,69632
 ds_read_b64_tr_b16 a[250:251],v21 offset:50176
 v_mfma_f32_16x16x32_bf16 v[116:119],a[216:219],a[168:171],v[116:119]
 ds_read_b64_tr_b16 a[252:253],v21 offset:57344
 buffer_load_dwordx4 v30,s[16:19],s34 offen offset:0 sc1 nt lds
 v_mfma_f32_16x16x32_bf16 v[116:119],a[220:223],a[184:187],v[116:119]
 s_waitcnt lgkmcnt(15)
 ds_read_b64_tr_b16 a[254:255],v21 offset:58368
 v_mfma_f32_16x16x32_bf16 v[128:131],a[224:227],a[160:163],v[128:131]
 s_waitcnt lgkmcnt(15)
 v_mfma_f32_16x16x32_bf16 v[128:131],a[228:231],a[176:179],v[128:131]
 s_waitcnt lgkmcnt(10)
 buffer_load_dwordx4 v31,s[16:19],s34 offen offset:1024 sc1 nt lds
 v_mfma_f32_16x16x32_bf16 v[132:135],a[232:235],a[160:163],v[132:135]
 s_waitcnt lgkmcnt(8)
 v_mfma_f32_16x16x32_bf16 v[132:135],a[236:239],a[176:179],v[132:135]
 buffer_load_dwordx4 v30,s[16:19],s34 offen offset:2048 sc1 nt lds
 v_mfma_f32_16x16x32_bf16 v[136:139],a[224:227],a[164:167],v[136:139]
 v_mfma_f32_16x16x32_bf16 v[136:139],a[228:231],a[180:183],v[136:139]
 v_mfma_f32_16x16x32_bf16 v[140:143],a[232:235],a[164:167],v[140:143]
 buffer_load_dwordx4 v31,s[16:19],s34 offen offset:3072 sc1 nt lds
 s_waitcnt lgkmcnt(15)
 s_add_u32 m0,s26,131072
 v_mfma_f32_16x16x32_bf16 v[140:143],a[236:239],a[180:183],v[140:143]
 s_waitcnt vmcnt(28)
 s_waitcnt lgkmcnt(0)
 s_barrier
 v_mfma_f32_16x16x32_bf16 v[144:147],a[224:227],a[168:171],v[144:147]
 s_add_u32 s35,s30,1024
 buffer_load_dwordx4 v34,s[4:7],s35 offen offset:0 lds
 v_mfma_f32_16x16x32_bf16 v[144:147],a[228:231],a[184:187],v[144:147]
 ds_read_b64_tr_b16 a[192:193],v14 offset:16384
 ds_read_b64_tr_b16 a[194:195],v14 offset:17408
 v_mfma_f32_16x16x32_bf16 v[148:151],a[232:235],a[168:171],v[148:151]
 ds_read_b64_tr_b16 a[196:197],v14 offset:24576
 v_mfma_f32_16x16x32_bf16 v[148:151],a[236:239],a[184:187],v[148:151]
 s_add_u32 s35,s30,9216
 buffer_load_dwordx4 v35,s[4:7],s35 offen offset:1024 lds
 v_mfma_f32_16x16x32_bf16 v[160:163],a[240:243],a[160:163],v[160:163]
 ds_read_b64_tr_b16 a[198:199],v14 offset:25600
 ds_read_b64_tr_b16 a[200:201],v15 offset:16384
 v_mfma_f32_16x16x32_bf16 v[160:163],a[244:247],a[176:179],v[160:163]
 s_add_u32 s35,s30,17408
 buffer_load_dwordx4 v34,s[4:7],s35 offen offset:2048 lds
 v_mfma_f32_16x16x32_bf16 v[164:167],a[248:251],a[160:163],v[164:167]
 ds_read_b64_tr_b16 a[202:203],v15 offset:17408
 v_mfma_f32_16x16x32_bf16 v[164:167],a[252:255],a[176:179],v[164:167]
 ds_read_b64_tr_b16 a[204:205],v15 offset:24576
 v_mfma_f32_16x16x32_bf16 v[168:171],a[240:243],a[164:167],v[168:171]
 ds_read_b64_tr_b16 a[206:207],v15 offset:25600
 v_mfma_f32_16x16x32_bf16 v[168:171],a[244:247],a[180:183],v[168:171]
 s_add_u32 s35,s30,25600
 ds_read_b64_tr_b16 a[208:209],v16 offset:16384
 buffer_load_dwordx4 v35,s[4:7],s35 offen offset:3072 lds
 v_mfma_f32_16x16x32_bf16 v[172:175],a[248:251],a[164:167],v[172:175]
 s_add_u32 m0,s26,135168
 v_mfma_f32_16x16x32_bf16 v[172:175],a[252:255],a[180:183],v[172:175]
 s_add_u32 s35,s30,37888
 ds_read_b64_tr_b16 a[210:211],v16 offset:17408
 buffer_load_dwordx4 v34,s[4:7],s35 offen offset:0 lds
 v_mfma_f32_16x16x32_bf16 v[176:179],a[240:243],a[168:171],v[176:179]
 ds_read_b64_tr_b16 a[212:213],v16 offset:24576
 v_mfma_f32_16x16x32_bf16 v[176:179],a[244:247],a[184:187],v[176:179]
 ds_read_b64_tr_b16 a[214:215],v16 offset:25600
 v_mfma_f32_16x16x32_bf16 v[180:183],a[248:251],a[168:171],v[180:183]
 s_add_u32 s35,s30,46080
 buffer_load_dwordx4 v35,s[4:7],s35 offen offset:1024 lds
 v_mfma_f32_16x16x32_bf16 v[180:183],a[252:255],a[184:187],v[180:183]
 s_waitcnt lgkmcnt(10)
 v_mfma_f32_16x16x32_bf16 v[64:67],a[192:195],a[128:131],v[64:67]
 s_waitcnt lgkmcnt(8)
 ds_read_b64_tr_b16 a[216:217],v17 offset:16384
 v_mfma_f32_16x16x32_bf16 v[64:67],a[196:199],a[144:147],v[64:67]
 s_waitcnt lgkmcnt(7)
 s_add_u32 m0,s25,114688
 ds_read_b64_tr_b16 a[218:219],v17 offset:17408
 v_mfma_f32_16x16x32_bf16 v[68:71],a[200:203],a[128:131],v[68:71]
 s_waitcnt lgkmcnt(6)
 s_add_u32 s34,s29,4194304
 buffer_load_dwordx4 v32,s[8:11],s34 offen offset:0 lds
 v_mfma_f32_16x16x32_bf16 v[68:71],a[204:207],a[144:147],v[68:71]
 ds_read_b64_tr_b16 a[220:221],v17 offset:24576
 ds_read_b64_tr_b16 a[222:223],v17 offset:25600
 v_mfma_f32_16x16x32_bf16 v[72:75],a[192:195],a[132:135],v[72:75]
 ds_read_b64_tr_b16 a[224:225],v18 offset:16384
 v_mfma_f32_16x16x32_bf16 v[72:75],a[196:199],a[148:151],v[72:75]
 ds_read_b64_tr_b16 a[226:227],v18 offset:17408
 ds_read_b64_tr_b16 a[228:229],v18 offset:24576
 v_mfma_f32_16x16x32_bf16 v[76:79],a[200:203],a[132:135],v[76:79]
 s_add_u32 s34,s29,4226048
 ds_read_b64_tr_b16 a[230:231],v18 offset:25600
 buffer_load_dwordx4 v32,s[8:11],s34 offen offset:1024 lds
 v_mfma_f32_16x16x32_bf16 v[76:79],a[204:207],a[148:151],v[76:79]
 s_waitcnt vmcnt(20)
 ds_read_b128 a[160:163],v24 offset:0
 v_mfma_f32_16x16x32_bf16 v[80:83],a[192:195],a[136:139],v[80:83]
 ds_read_b128 a[176:179],v25 offset:0
 v_mfma_f32_16x16x32_bf16 v[80:83],a[196:199],a[152:155],v[80:83]
 ds_read_b128 a[164:167],v24 offset:2048
 v_mfma_f32_16x16x32_bf16 v[84:87],a[200:203],a[136:139],v[84:87]
 s_add_u32 s34,s29,4257792
 ds_read_b128 a[180:183],v25 offset:2048
 buffer_load_dwordx4 v33,s[8:11],s34 offen offset:2048 lds
 v_mfma_f32_16x16x32_bf16 v[84:87],a[204:207],a[152:155],v[84:87]
 s_waitcnt lgkmcnt(14)
 ds_read_b128 a[168:171],v24 offset:4096
 v_mfma_f32_16x16x32_bf16 v[96:99],a[208:211],a[128:131],v[96:99]
 s_waitcnt lgkmcnt(13)
 ds_read_b128 a[184:187],v25 offset:4096
 ds_read_b64_tr_b16 a[232:233],v19 offset:16384
 v_mfma_f32_16x16x32_bf16 v[96:99],a[212:215],a[144:147],v[96:99]
 s_waitcnt lgkmcnt(13)
 s_add_u32 s34,s29,4289536
 buffer_load_dwordx4 v33,s[8:11],s34 offen offset:3072 lds
 v_mfma_f32_16x16x32_bf16 v[100:103],a[216:219],a[128:131],v[100:103]
 s_waitcnt lgkmcnt(11)
 ds_read_b64_tr_b16 a[234:235],v19 offset:17408
 v_mfma_f32_16x16x32_bf16 v[100:103],a[220:223],a[144:147],v[100:103]
 ds_read_b64_tr_b16 a[236:237],v19 offset:24576
 ds_read_b64_tr_b16 a[238:239],v19 offset:25600
 v_mfma_f32_16x16x32_bf16 v[104:107],a[208:211],a[132:135],v[104:107]
 s_add_u32 s34,s28,8192
 s_mov_b32 m0,73728
 v_mfma_f32_16x16x32_bf16 v[104:107],a[212:215],a[148:151],v[104:107]
 ds_read_b64_tr_b16 a[240:241],v20 offset:16384
 buffer_load_dwordx4 v30,s[16:19],s34 offen offset:0 sc1 nt lds
 v_mfma_f32_16x16x32_bf16 v[108:111],a[216:219],a[132:135],v[108:111]
 ds_read_b64_tr_b16 a[242:243],v20 offset:17408
 ds_read_b64_tr_b16 a[244:245],v20 offset:24576
 v_mfma_f32_16x16x32_bf16 v[108:111],a[220:223],a[148:151],v[108:111]
 ds_read_b64_tr_b16 a[246:247],v20 offset:25600
 v_mfma_f32_16x16x32_bf16 v[112:115],a[208:211],a[136:139],v[112:115]
 ds_read_b64_tr_b16 a[248:249],v21 offset:16384
 v_mfma_f32_16x16x32_bf16 v[112:115],a[212:215],a[152:155],v[112:115]
 ds_read_b64_tr_b16 a[250:251],v21 offset:17408
 buffer_load_dwordx4 v31,s[16:19],s34 offen offset:1024 sc1 nt lds
 v_mfma_f32_16x16x32_bf16 v[116:119],a[216:219],a[136:139],v[116:119]
 ds_read_b64_tr_b16 a[252:253],v21 offset:24576
 v_mfma_f32_16x16x32_bf16 v[116:119],a[220:223],a[152:155],v[116:119]
 s_waitcnt lgkmcnt(15)
 ds_read_b64_tr_b16 a[254:255],v21 offset:25600
 v_mfma_f32_16x16x32_bf16 v[128:131],a[224:227],a[128:131],v[128:131]
 s_waitcnt lgkmcnt(15)
 v_mfma_f32_16x16x32_bf16 v[128:131],a[228:231],a[144:147],v[128:131]
 s_waitcnt lgkmcnt(10)
 buffer_load_dwordx4 v30,s[16:19],s34 offen offset:2048 sc1 nt lds
 v_mfma_f32_16x16x32_bf16 v[132:135],a[232:235],a[128:131],v[132:135]
 s_waitcnt lgkmcnt(8)
 v_mfma_f32_16x16x32_bf16 v[132:135],a[236:239],a[144:147],v[132:135]
 v_mfma_f32_16x16x32_bf16 v[136:139],a[224:227],a[132:135],v[136:139]
 buffer_load_dwordx4 v31,s[16:19],s34 offen offset:3072 sc1 nt lds
 v_mfma_f32_16x16x32_bf16 v[136:139],a[228:231],a[148:151],v[136:139]
 v_mfma_f32_16x16x32_bf16 v[140:143],a[232:235],a[132:135],v[140:143]
 s_add_u32 s34,s28,12288
 s_mov_b32 m0,77824
 v_mfma_f32_16x16x32_bf16 v[140:143],a[236:239],a[148:151],v[140:143]
 s_waitcnt vmcnt(22)
 s_waitcnt lgkmcnt(0)
 s_barrier
 v_mfma_f32_16x16x32_bf16 v[144:147],a[224:227],a[136:139],v[144:147]
 ds_read_b64_tr_b16 a[192:193],v14 offset:32768
 buffer_load_dwordx4 v30,s[16:19],s34 offen offset:0 sc1 nt lds
 v_mfma_f32_16x16x32_bf16 v[144:147],a[228:231],a[152:155],v[144:147]
 ds_read_b64_tr_b16 a[194:195],v14 offset:33792
 v_mfma_f32_16x16x32_bf16 v[148:151],a[232:235],a[136:139],v[148:151]
 ds_read_b64_tr_b16 a[196:197],v14 offset:40960
 v_mfma_f32_16x16x32_bf16 v[148:151],a[236:239],a[152:155],v[148:151]
 v_mfma_f32_16x16x32_bf16 v[160:163],a[240:243],a[128:131],v[160:163]
 ds_read_b64_tr_b16 a[198:199],v14 offset:41984
 buffer_load_dwordx4 v31,s[16:19],s34 offen offset:1024 sc1 nt lds
 v_mfma_f32_16x16x32_bf16 v[160:163],a[244:247],a[144:147],v[160:163]
 ds_read_b64_tr_b16 a[200:201],v15 offset:32768
 v_mfma_f32_16x16x32_bf16 v[164:167],a[248:251],a[128:131],v[164:167]
 ds_read_b64_tr_b16 a[202:203],v15 offset:33792
 v_mfma_f32_16x16x32_bf16 v[164:167],a[252:255],a[144:147],v[164:167]
 ds_read_b64_tr_b16 a[204:205],v15 offset:40960
 v_mfma_f32_16x16x32_bf16 v[168:171],a[240:243],a[132:135],v[168:171]
 ds_read_b64_tr_b16 a[206:207],v15 offset:41984
 buffer_load_dwordx4 v30,s[16:19],s34 offen offset:2048 sc1 nt lds
 v_mfma_f32_16x16x32_bf16 v[168:171],a[244:247],a[148:151],v[168:171]
 ds_read_b64_tr_b16 a[208:209],v16 offset:32768
 v_mfma_f32_16x16x32_bf16 v[172:175],a[248:251],a[132:135],v[172:175]
 v_mfma_f32_16x16x32_bf16 v[172:175],a[252:255],a[148:151],v[172:175]
 s_add_u32 s28,s28,16384
 ds_read_b64_tr_b16 a[210:211],v16 offset:33792
 buffer_load_dwordx4 v31,s[16:19],s34 offen offset:3072 sc1 nt lds
 v_mfma_f32_16x16x32_bf16 v[176:179],a[240:243],a[136:139],v[176:179]
 ds_read_b64_tr_b16 a[212:213],v16 offset:40960
 v_mfma_f32_16x16x32_bf16 v[176:179],a[244:247],a[152:155],v[176:179]
 ds_read_b64_tr_b16 a[214:215],v16 offset:41984
 v_mfma_f32_16x16x32_bf16 v[180:183],a[248:251],a[136:139],v[180:183]
 v_mfma_f32_16x16x32_bf16 v[180:183],a[252:255],a[152:155],v[180:183]
 s_waitcnt lgkmcnt(10)
 v_mfma_f32_16x16x32_bf16 v[64:67],a[192:195],a[160:163],v[64:67]
 s_waitcnt lgkmcnt(8)
 ds_read_b64_tr_b16 a[216:217],v17 offset:32768
 ds_read_b64_tr_b16 a[218:219],v17 offset:33792
 v_mfma_f32_16x16x32_bf16 v[64:67],a[196:199],a[176:179],v[64:67]
 s_waitcnt lgkmcnt(8)
 s_add_u32 s34,s28,12288
 s_add_u32 m0,s25,81920
 v_mfma_f32_16x16x32_bf16 v[68:71],a[200:203],a[160:163],v[68:71]
 s_waitcnt lgkmcnt(6)
 ds_read_b64_tr_b16 a[220:221],v17 offset:40960
 buffer_load_dwordx4 v30,s[16:19],s34 offen offset:0 sc1 nt lds
 v_mfma_f32_16x16x32_bf16 v[68:71],a[204:207],a[176:179],v[68:71]
 ds_read_b64_tr_b16 a[222:223],v17 offset:41984
 v_mfma_f32_16x16x32_bf16 v[72:75],a[192:195],a[164:167],v[72:75]
 ds_read_b64_tr_b16 a[224:225],v18 offset:32768
 v_mfma_f32_16x16x32_bf16 v[72:75],a[196:199],a[180:183],v[72:75]
 ds_read_b64_tr_b16 a[226:227],v18 offset:33792
 v_mfma_f32_16x16x32_bf16 v[76:79],a[200:203],a[164:167],v[76:79]
 ds_read_b64_tr_b16 a[228:229],v18 offset:40960
 ds_read_b64_tr_b16 a[230:231],v18 offset:41984
 v_mfma_f32_16x16x32_bf16 v[76:79],a[204:207],a[180:183],v[76:79]
 s_waitcnt vmcnt(13)
 ds_read_b128 a[128:131],v22 offset:0
 v_mfma_f32_16x16x32_bf16 v[80:83],a[192:195],a[168:171],v[80:83]
 ds_read_b128 a[144:147],v23 offset:0
 buffer_load_dwordx4 v31,s[16:19],s34 offen offset:1024 sc1 nt lds
 v_mfma_f32_16x16x32_bf16 v[80:83],a[196:199],a[184:187],v[80:83]
 ds_read_b128 a[132:135],v22 offset:2048
 v_mfma_f32_16x16x32_bf16 v[84:87],a[200:203],a[168:171],v[84:87]
 ds_read_b128 a[148:151],v23 offset:2048
 v_mfma_f32_16x16x32_bf16 v[84:87],a[204:207],a[184:187],v[84:87]
 s_waitcnt lgkmcnt(14)
 ds_read_b128 a[136:139],v22 offset:4096
 v_mfma_f32_16x16x32_bf16 v[96:99],a[208:211],a[160:163],v[96:99]
 s_waitcnt lgkmcnt(13)
 ds_read_b128 a[152:155],v23 offset:4096
 v_mfma_f32_16x16x32_bf16 v[96:99],a[212:215],a[176:179],v[96:99]
 s_waitcnt lgkmcnt(12)
 ds_read_b64_tr_b16 a[232:233],v19 offset:32768
 buffer_load_dwordx4 v30,s[16:19],s34 offen offset:2048 sc1 nt lds
 v_mfma_f32_16x16x32_bf16 v[100:103],a[216:219],a[160:163],v[100:103]
 s_waitcnt lgkmcnt(11)
 ds_read_b64_tr_b16 a[234:235],v19 offset:33792
 v_mfma_f32_16x16x32_bf16 v[100:103],a[220:223],a[176:179],v[100:103]
 ds_read_b64_tr_b16 a[236:237],v19 offset:40960
 v_mfma_f32_16x16x32_bf16 v[104:107],a[208:211],a[164:167],v[104:107]
 ds_read_b64_tr_b16 a[238:239],v19 offset:41984
 v_mfma_f32_16x16x32_bf16 v[104:107],a[212:215],a[180:183],v[104:107]
 ds_read_b64_tr_b16 a[240:241],v20 offset:32768
 ds_read_b64_tr_b16 a[242:243],v20 offset:33792
 v_mfma_f32_16x16x32_bf16 v[108:111],a[216:219],a[164:167],v[108:111]
 ds_read_b64_tr_b16 a[244:245],v20 offset:40960
 v_mfma_f32_16x16x32_bf16 v[108:111],a[220:223],a[180:183],v[108:111]
 s_add_u32 s28,s28,16384
 buffer_load_dwordx4 v31,s[16:19],s34 offen offset:3072 sc1 nt lds
 v_mfma_f32_16x16x32_bf16 v[112:115],a[208:211],a[168:171],v[112:115]
 ds_read_b64_tr_b16 a[246:247],v20 offset:41984
 ds_read_b64_tr_b16 a[248:249],v21 offset:32768
 v_mfma_f32_16x16x32_bf16 v[112:115],a[212:215],a[184:187],v[112:115]
 ds_read_b64_tr_b16 a[250:251],v21 offset:33792
 v_mfma_f32_16x16x32_bf16 v[116:119],a[216:219],a[168:171],v[116:119]
 ds_read_b64_tr_b16 a[252:253],v21 offset:40960
 v_mfma_f32_16x16x32_bf16 v[116:119],a[220:223],a[184:187],v[116:119]
 s_waitcnt lgkmcnt(15)
 ds_read_b64_tr_b16 a[254:255],v21 offset:41984
 v_mfma_f32_16x16x32_bf16 v[128:131],a[224:227],a[160:163],v[128:131]
 s_waitcnt lgkmcnt(15)
 s_add_u32 s34,s27,12288
 s_add_u32 m0,s25,32768
 v_mfma_f32_16x16x32_bf16 v[128:131],a[228:231],a[176:179],v[128:131]
 s_waitcnt lgkmcnt(10)
 buffer_load_dwordx4 v26,s[12:15],s34 offen offset:0 sc1 nt lds
 v_mfma_f32_16x16x32_bf16 v[132:135],a[232:235],a[160:163],v[132:135]
 s_waitcnt lgkmcnt(8)
 v_mfma_f32_16x16x32_bf16 v[132:135],a[236:239],a[176:179],v[132:135]
 v_mfma_f32_16x16x32_bf16 v[136:139],a[224:227],a[164:167],v[136:139]
 v_mfma_f32_16x16x32_bf16 v[136:139],a[228:231],a[180:183],v[136:139]
 v_mfma_f32_16x16x32_bf16 v[140:143],a[232:235],a[164:167],v[140:143]
 buffer_load_dwordx4 v27,s[12:15],s34 offen offset:1024 sc1 nt lds
 v_mfma_f32_16x16x32_bf16 v[140:143],a[236:239],a[180:183],v[140:143]
 s_waitcnt vmcnt(14)
 s_waitcnt lgkmcnt(0)
 s_barrier
 v_mfma_f32_16x16x32_bf16 v[144:147],a[224:227],a[168:171],v[144:147]
 ds_read_b64_tr_b16 a[192:193],v14 offset:49152
 v_mfma_f32_16x16x32_bf16 v[144:147],a[228:231],a[184:187],v[144:147]
 ds_read_b64_tr_b16 a[194:195],v14 offset:50176
 v_mfma_f32_16x16x32_bf16 v[148:151],a[232:235],a[168:171],v[148:151]
 ds_read_b64_tr_b16 a[196:197],v14 offset:57344
 v_mfma_f32_16x16x32_bf16 v[148:151],a[236:239],a[184:187],v[148:151]
 v_mfma_f32_16x16x32_bf16 v[160:163],a[240:243],a[160:163],v[160:163]
 ds_read_b64_tr_b16 a[198:199],v14 offset:58368
 buffer_load_dwordx4 v28,s[12:15],s34 offen offset:2048 sc1 nt lds
 v_mfma_f32_16x16x32_bf16 v[160:163],a[244:247],a[176:179],v[160:163]
 ds_read_b64_tr_b16 a[200:201],v15 offset:49152
 v_mfma_f32_16x16x32_bf16 v[164:167],a[248:251],a[160:163],v[164:167]
 ds_read_b64_tr_b16 a[202:203],v15 offset:50176
 v_mfma_f32_16x16x32_bf16 v[164:167],a[252:255],a[176:179],v[164:167]
 ds_read_b64_tr_b16 a[204:205],v15 offset:57344
 v_mfma_f32_16x16x32_bf16 v[168:171],a[240:243],a[164:167],v[168:171]
 ds_read_b64_tr_b16 a[206:207],v15 offset:58368
 v_mfma_f32_16x16x32_bf16 v[168:171],a[244:247],a[180:183],v[168:171]
 s_add_u32 s27,s27,16384
 ds_read_b64_tr_b16 a[208:209],v16 offset:49152
 buffer_load_dwordx4 v29,s[12:15],s34 offen offset:3072 sc1 nt lds
 v_mfma_f32_16x16x32_bf16 v[172:175],a[248:251],a[164:167],v[172:175]
 v_mfma_f32_16x16x32_bf16 v[172:175],a[252:255],a[180:183],v[172:175]
 ds_read_b64_tr_b16 a[210:211],v16 offset:50176
 v_mfma_f32_16x16x32_bf16 v[176:179],a[240:243],a[168:171],v[176:179]
 ds_read_b64_tr_b16 a[212:213],v16 offset:57344
 v_mfma_f32_16x16x32_bf16 v[176:179],a[244:247],a[184:187],v[176:179]
 ds_read_b64_tr_b16 a[214:215],v16 offset:58368
 v_mfma_f32_16x16x32_bf16 v[180:183],a[248:251],a[168:171],v[180:183]
 v_mfma_f32_16x16x32_bf16 v[180:183],a[252:255],a[184:187],v[180:183]
 s_waitcnt lgkmcnt(10)
 s_lshl_b32 s31,s37,12
 s_bitcmp1_b32 s2,3
 s_mov_b32 s95,K1_tail-K1_pc+2048
 s_cselect_b32 s95,K1_tailc-K1_pc+2048,s95
 s_add_u32 s95,s95,s26
 s_mov_b32 s29,256
 v_mfma_f32_16x16x32_bf16 v[64:67],a[192:195],a[128:131],v[64:67]
 s_waitcnt lgkmcnt(8)
 ds_read_b64_tr_b16 a[216:217],v17 offset:49152
 ds_read_b64_tr_b16 a[218:219],v17 offset:50176
 v_mfma_f32_16x16x32_bf16 v[64:67],a[196:199],a[144:147],v[64:67]
 s_waitcnt lgkmcnt(8)
 s_add_u32 s34,s28,12288
 s_add_u32 m0,s25,98304
 ds_read_b64_tr_b16 a[220:221],v17 offset:57344
 v_mfma_f32_16x16x32_bf16 v[68:71],a[200:203],a[128:131],v[68:71]
 s_waitcnt lgkmcnt(7)
 ds_read_b64_tr_b16 a[222:223],v17 offset:58368
 buffer_load_dwordx4 v30,s[16:19],s34 offen offset:0 sc1 nt lds
 v_mfma_f32_16x16x32_bf16 v[68:71],a[204:207],a[144:147],v[68:71]
 ds_read_b64_tr_b16 a[224:225],v18 offset:49152
 ds_read_b64_tr_b16 a[226:227],v18 offset:50176
 v_mfma_f32_16x16x32_bf16 v[72:75],a[192:195],a[132:135],v[72:75]
 ds_read_b64_tr_b16 a[228:229],v18 offset:57344
 ds_read_b64_tr_b16 a[230:231],v18 offset:58368
 v_mfma_f32_16x16x32_bf16 v[72:75],a[196:199],a[148:151],v[72:75]
 ds_read_b64_tr_b16 a[232:233],v19 offset:49152
 ds_read_b64_tr_b16 a[234:235],v19 offset:50176
 v_mfma_f32_16x16x32_bf16 v[76:79],a[200:203],a[132:135],v[76:79]
 ds_read_b64_tr_b16 a[236:237],v19 offset:57344
 buffer_load_dwordx4 v31,s[16:19],s34 offen offset:1024 sc1 nt lds
 v_mfma_f32_16x16x32_bf16 v[76:79],a[204:207],a[148:151],v[76:79]
 s_waitcnt lgkmcnt(13)
 v_mul_f32 v64,s36,v64
 v_mul_f32 v65,s36,v65
 v_mul_f32 v66,s36,v66
 v_mul_f32 v67,s36,v67
 v_mfma_f32_16x16x32_bf16 v[96:99],a[208:211],a[128:131],v[96:99]
 s_waitcnt lgkmcnt(11)
 v_mul_f32 v68,s36,v68
 v_mul_f32 v69,s36,v69
 v_mul_f32 v70,s36,v70
 v_mul_f32 v71,s36,v71
 v_mfma_f32_16x16x32_bf16 v[96:99],a[212:215],a[144:147],v[96:99]
 s_waitcnt lgkmcnt(9)
 v_cvt_pk_bf16_f32 v64,v64,v65
 v_cvt_pk_bf16_f32 v65,v66,v67
 v_cvt_pk_bf16_f32 v66,v68,v69
 v_cvt_pk_bf16_f32 v67,v70,v71
 v_mfma_f32_16x16x32_bf16 v[100:103],a[216:219],a[128:131],v[100:103]
 s_waitcnt lgkmcnt(7)
 ds_read_b64_tr_b16 a[238:239],v19 offset:58368
 ds_read_b64_tr_b16 a[240:241],v20 offset:49152
 ds_read_b64_tr_b16 a[242:243],v20 offset:50176
 ds_read_b64_tr_b16 a[244:245],v20 offset:57344
 v_mfma_f32_16x16x32_bf16 v[100:103],a[220:223],a[144:147],v[100:103]
 v_mul_f32 v72,s36,v72
 v_mul_f32 v73,s36,v73
 v_mul_f32 v74,s36,v74
 v_mul_f32 v75,s36,v75
 v_mfma_f32_16x16x32_bf16 v[104:107],a[208:211],a[132:135],v[104:107]
 v_mul_f32 v76,s36,v76
 v_mul_f32 v77,s36,v77
 v_mul_f32 v78,s36,v78
 v_mul_f32 v79,s36,v79
 v_mfma_f32_16x16x32_bf16 v[104:107],a[212:215],a[148:151],v[104:107]
 ds_read_b64_tr_b16 a[246:247],v20 offset:58368
 buffer_load_dwordx4 v30,s[16:19],s34 offen offset:2048 sc1 nt lds
 v_permlane32_swap_b32 v64,v66
 v_mfma_f32_16x16x32_bf16 v[108:111],a[216:219],a[132:135],v[108:111]
 v_permlane32_swap_b32 v65,v67
 v_cvt_pk_bf16_f32 v72,v72,v73
 v_cvt_pk_bf16_f32 v73,v74,v75
 v_mfma_f32_16x16x32_bf16 v[108:111],a[220:223],a[148:151],v[108:111]
 s_waitcnt lgkmcnt(10)
 ds_read_b64_tr_b16 a[248:249],v21 offset:49152
 ds_read_b64_tr_b16 a[250:251],v21 offset:50176
 v_cvt_pk_bf16_f32 v74,v76,v77
 v_cvt_pk_bf16_f32 v75,v78,v79
 v_mfma_f32_16x16x32_bf16 v[128:131],a[224:227],a[128:131],v[128:131]
 s_waitcnt lgkmcnt(10)
 ds_read_b64_tr_b16 a[252:253],v21 offset:57344
 ds_read_b64_tr_b16 a[254:255],v21 offset:58368
 v_permlane16_swap_b32 v64,v66
 v_mfma_f32_16x16x32_bf16 v[128:131],a[228:231],a[144:147],v[128:131]
 s_waitcnt lgkmcnt(10)
 v_permlane16_swap_b32 v65,v67
 v_mul_f32 v96,s36,v96
 v_mul_f32 v97,s36,v97
 v_mfma_f32_16x16x32_bf16 v[132:135],a[232:235],a[128:131],v[132:135]
 s_waitcnt lgkmcnt(8)
 v_mul_f32 v98,s36,v98
 v_mul_f32 v99,s36,v99
 v_mul_f32 v100,s36,v100
 v_mul_f32 v101,s36,v101
 v_mfma_f32_16x16x32_bf16 v[132:135],a[236:239],a[144:147],v[132:135]
 v_mul_f32 v102,s36,v102
 v_mul_f32 v103,s36,v103
 v_permlane32_swap_b32 v72,v74
 v_mfma_f32_16x16x32_bf16 v[136:139],a[224:227],a[132:135],v[136:139]
 v_permlane32_swap_b32 v73,v75
 v_cvt_pk_bf16_f32 v96,v96,v97
 v_cvt_pk_bf16_f32 v97,v98,v99
 v_mfma_f32_16x16x32_bf16 v[136:139],a[228:231],a[148:151],v[136:139]
 s_add_u32 s28,s28,16384
 buffer_load_dwordx4 v31,s[16:19],s34 offen offset:3072 sc1 nt lds
 v_cvt_pk_bf16_f32 v98,v100,v101
 v_cvt_pk_bf16_f32 v99,v102,v103
 v_mfma_f32_16x16x32_bf16 v[140:143],a[232:235],a[132:135],v[140:143]
 v_permlane16_swap_b32 v72,v74
 v_permlane16_swap_b32 v73,v75
 v_mfma_f32_16x16x32_bf16 v[140:143],a[236:239],a[148:151],v[140:143]
 s_waitcnt lgkmcnt(6)
 v_mul_f32 v104,s36,v104
 v_mul_f32 v105,s36,v105
 v_mfma_f32_16x16x32_bf16 v[160:163],a[240:243],a[128:131],v[160:163]
 s_waitcnt lgkmcnt(4)
 v_mul_f32 v106,s36,v106
 v_mul_f32 v107,s36,v107
 v_mfma_f32_16x16x32_bf16 v[160:163],a[244:247],a[144:147],v[160:163]
 s_waitcnt lgkmcnt(2)
 s_add_u32 s34,s27,12288
 s_add_u32 m0,s25,49152
 v_mul_f32 v108,s36,v108
 v_mfma_f32_16x16x32_bf16 v[164:167],a[248:251],a[128:131],v[164:167]
 s_waitcnt vmcnt(63)
 s_waitcnt lgkmcnt(0)
 s_barrier
 buffer_load_dwordx4 v26,s[12:15],s34 offen offset:0 sc1 nt lds
 v_mfma_f32_16x16x32_bf16 v[164:167],a[252:255],a[144:147],v[164:167]
 v_mul_f32 v109,s36,v109
 v_mul_f32 v110,s36,v110
 v_mfma_f32_16x16x32_bf16 v[168:171],a[240:243],a[132:135],v[168:171]
 ds_read_b128 a[160:163],v2 offset:0
 ds_read_b128 a[164:167],v3 offset:0
 v_mfma_f32_16x16x32_bf16 v[168:171],a[244:247],a[148:151],v[168:171]
 ds_read_b128 a[168:171],v4 offset:0
 buffer_load_dwordx4 v27,s[12:15],s34 offen offset:1024 sc1 nt lds
 v_mfma_f32_16x16x32_bf16 v[172:175],a[248:251],a[132:135],v[172:175]
 ds_read_b128 a[172:175],v5 offset:0
 ds_read_b128 a[176:179],v2 offset:4096
 v_mfma_f32_16x16x32_bf16 v[172:175],a[252:255],a[148:151],v[172:175]
 v_mul_f32 v111,s36,v111
 v_permlane32_swap_b32 v96,v98
 v_mfma_f32_16x16x32_bf16 v[80:83],a[192:195],a[136:139],v[80:83]
 v_permlane32_swap_b32 v97,v99
 v_cvt_pk_bf16_f32 v104,v104,v105
 v_cvt_pk_bf16_f32 v105,v106,v107
 v_mfma_f32_16x16x32_bf16 v[80:83],a[196:199],a[152:155],v[80:83]
 v_cvt_pk_bf16_f32 v106,v108,v109
 v_cvt_pk_bf16_f32 v107,v110,v111
 v_mfma_f32_16x16x32_bf16 v[84:87],a[200:203],a[136:139],v[84:87]
 v_permlane16_swap_b32 v96,v98
 v_mfma_f32_16x16x32_bf16 v[84:87],a[204:207],a[152:155],v[84:87]
 ds_read_b128 a[180:183],v3 offset:4096
 buffer_load_dwordx4 v28,s[12:15],s34 offen offset:2048 sc1 nt lds
 v_mfma_f32_16x16x32_bf16 v[112:115],a[208:211],a[136:139],v[112:115]
 v_permlane16_swap_b32 v97,v99
 v_mul_f32 v128,s36,v128
 v_mfma_f32_16x16x32_bf16 v[112:115],a[212:215],a[152:155],v[112:115]
 ds_read_b128 a[184:187],v4 offset:4096
 v_mul_f32 v129,s36,v129
 v_mul_f32 v130,s36,v130
 v_mfma_f32_16x16x32_bf16 v[116:119],a[216:219],a[136:139],v[116:119]
 ds_read_b128 a[188:191],v5 offset:4096
 v_mul_f32 v131,s36,v131
 v_mul_f32 v132,s36,v132
 v_mul_f32 v133,s36,v133
 v_mfma_f32_16x16x32_bf16 v[116:119],a[220:223],a[152:155],v[116:119]
 v_mul_f32 v134,s36,v134
 v_mul_f32 v135,s36,v135
 v_permlane32_swap_b32 v104,v106
 v_mfma_f32_16x16x32_bf16 v[144:147],a[224:227],a[136:139],v[144:147]
 v_permlane32_swap_b32 v105,v107
 v_cvt_pk_bf16_f32 v128,v128,v129
 v_cvt_pk_bf16_f32 v129,v130,v131
 v_mfma_f32_16x16x32_bf16 v[144:147],a[228:231],a[152:155],v[144:147]
 v_cvt_pk_bf16_f32 v130,v132,v133
 v_cvt_pk_bf16_f32 v131,v134,v135
 v_permlane16_swap_b32 v104,v106
 v_mfma_f32_16x16x32_bf16 v[148:151],a[232:235],a[136:139],v[148:151]
 s_add_u32 s27,s27,16384
 buffer_load_dwordx4 v29,s[12:15],s34 offen offset:3072 sc1 nt lds
 v_permlane16_swap_b32 v105,v107
 v_mfma_f32_16x16x32_bf16 v[148:151],a[236:239],a[152:155],v[148:151]
 v_mul_f32 v136,s36,v136
 v_mul_f32 v137,s36,v137
 v_mfma_f32_16x16x32_bf16 v[176:179],a[240:243],a[136:139],v[176:179]
 ds_read_b128 a[224:227],v2 offset:8192
 v_mul_f32 v138,s36,v138
 v_mfma_f32_16x16x32_bf16 v[176:179],a[244:247],a[152:155],v[176:179]
 ds_read_b128 a[228:231],v3 offset:8192
 v_mul_f32 v139,s36,v139
 v_mfma_f32_16x16x32_bf16 v[180:183],a[248:251],a[136:139],v[180:183]
 ds_read_b128 a[232:235],v4 offset:8192
 ds_read_b128 a[236:239],v5 offset:8192
 v_mul_f32 v140,s36,v140
 v_mul_f32 v141,s36,v141
 v_mul_f32 v142,s36,v142
 v_mul_f32 v143,s36,v143
 v_permlane32_swap_b32 v128,v130
 v_permlane32_swap_b32 v129,v131
 v_cvt_pk_bf16_f32 v136,v136,v137
 v_cvt_pk_bf16_f32 v137,v138,v139
 v_cvt_pk_bf16_f32 v138,v140,v141
 v_cvt_pk_bf16_f32 v139,v142,v143
 v_permlane16_swap_b32 v128,v130
 v_permlane16_swap_b32 v129,v131
 v_mul_f32 v160,s36,v160
 v_mul_f32 v161,s36,v161
 v_mul_f32 v162,s36,v162
 v_mul_f32 v163,s36,v163
 v_mul_f32 v164,s36,v164
 v_mul_f32 v165,s36,v165
 v_mul_f32 v166,s36,v166
 v_mul_f32 v167,s36,v167
 v_permlane32_swap_b32 v136,v138
 v_permlane32_swap_b32 v137,v139
 v_cvt_pk_bf16_f32 v160,v160,v161
 v_cvt_pk_bf16_f32 v161,v162,v163
 v_cvt_pk_bf16_f32 v162,v164,v165
 v_cvt_pk_bf16_f32 v163,v166,v167
 v_permlane16_swap_b32 v136,v138
 v_permlane16_swap_b32 v137,v139
 v_mul_f32 v168,s36,v168
 v_mul_f32 v169,s36,v169
 v_mul_f32 v170,s36,v170
 v_mul_f32 v171,s36,v171
 v_mul_f32 v172,s36,v172
 v_mul_f32 v173,s36,v173
 v_mul_f32 v174,s36,v174
 v_mul_f32 v175,s36,v175
 v_permlane32_swap_b32 v160,v162
 v_permlane32_swap_b32 v161,v163
 v_cvt_pk_bf16_f32 v168,v168,v169
 v_cvt_pk_bf16_f32 v169,v170,v171
 v_cvt_pk_bf16_f32 v170,v172,v173
 v_cvt_pk_bf16_f32 v171,v174,v175
 v_permlane16_swap_b32 v160,v162
 v_permlane16_swap_b32 v161,v163
 v_mfma_f32_16x16x32_bf16 v[180:183],a[252:255],a[152:155],v[180:183]
 s_waitcnt lgkmcnt(11)
 v_mul_f32 v80,s36,v80
 v_mul_f32 v81,s36,v81
 v_mul_f32 v82,s36,v82
 v_mul_f32 v83,s36,v83
 v_mfma_f32_16x16x32_bf16 v[68:71],a[160:163],v[64:67],0
 s_waitcnt lgkmcnt(10)
 v_mul_f32 v84,s36,v84
 v_mul_f32 v85,s36,v85
 v_mul_f32 v86,s36,v86
 v_mul_f32 v87,s36,v87
 v_mfma_f32_16x16x32_bf16 v[68:71],a[164:167],v[96:99],v[68:71]
 s_waitcnt lgkmcnt(9)
 ds_read_b128 a[240:243],v2 offset:12288
 ds_read_b128 a[244:247],v3 offset:12288
 v_permlane32_swap_b32 v168,v170
 v_mfma_f32_16x16x32_bf16 v[68:71],a[168:171],v[128:131],v[68:71]
 s_waitcnt lgkmcnt(10)
 ds_read_b128 a[248:251],v4 offset:12288
 v_permlane32_swap_b32 v169,v171
 v_cvt_pk_bf16_f32 v80,v80,v81
 v_mfma_f32_16x16x32_bf16 v[68:71],a[172:175],v[160:163],v[68:71]
 s_waitcnt lgkmcnt(10)
 ds_read_b128 a[252:255],v5 offset:12288
 v_cvt_pk_bf16_f32 v81,v82,v83
 v_cvt_pk_bf16_f32 v82,v84,v85
 v_cvt_pk_bf16_f32 v83,v86,v87
 v_mfma_f32_16x16x32_bf16 v[100:103],a[176:179],v[64:67],0
 s_waitcnt lgkmcnt(10)
 v_permlane16_swap_b32 v168,v170
 v_permlane16_swap_b32 v169,v171
 v_mfma_f32_16x16x32_bf16 v[100:103],a[180:183],v[96:99],v[100:103]
 s_waitcnt lgkmcnt(9)
 v_mul_f32 v112,s36,v112
 v_mul_f32 v113,s36,v113
 v_mul_f32 v114,s36,v114
 v_mul_f32 v115,s36,v115
 v_mfma_f32_16x16x32_bf16 v[100:103],a[184:187],v[128:131],v[100:103]
 s_waitcnt lgkmcnt(8)
 v_mul_f32 v116,s36,v116
 v_mul_f32 v117,s36,v117
 v_mul_f32 v118,s36,v118
 v_mul_f32 v119,s36,v119
 v_mfma_f32_16x16x32_bf16 v[100:103],a[188:191],v[160:163],v[100:103]
 v_permlane32_swap_b32 v80,v82
 v_permlane32_swap_b32 v81,v83
 v_mfma_f32_16x16x32_bf16 v[76:79],a[160:163],v[72:75],0
 v_cvt_pk_bf16_f32 v112,v112,v113
 v_cvt_pk_bf16_f32 v113,v114,v115
 v_cvt_pk_bf16_f32 v114,v116,v117
 v_cvt_pk_bf16_f32 v115,v118,v119
 v_mfma_f32_16x16x32_bf16 v[76:79],a[164:167],v[104:107],v[76:79]
 v_permlane16_swap_b32 v80,v82
 v_permlane16_swap_b32 v81,v83
 v_mfma_f32_16x16x32_bf16 v[76:79],a[168:171],v[136:139],v[76:79]
 v_mul_f32 v144,s36,v144
 v_mul_f32 v145,s36,v145
 v_mul_f32 v146,s36,v146
 v_mfma_f32_16x16x32_bf16 v[76:79],a[172:175],v[168:171],v[76:79]
 s_waitcnt vmcnt(16)
 s_waitcnt lgkmcnt(0)
 s_barrier
 v_mul_f32 v147,s36,v147
 v_mfma_f32_16x16x32_bf16 v[108:111],a[176:179],v[72:75],0
 v_mul_f32 v148,s36,v148
 v_mul_f32 v149,s36,v149
 v_mfma_f32_16x16x32_bf16 v[108:111],a[180:183],v[104:107],v[108:111]
 v_mul_f32 v150,s36,v150
 v_mul_f32 v151,s36,v151
 v_mfma_f32_16x16x32_bf16 v[108:111],a[184:187],v[136:139],v[108:111]
 v_permlane32_swap_b32 v112,v114
 v_permlane32_swap_b32 v113,v115
 v_cvt_pk_bf16_f32 v144,v144,v145
 v_cvt_pk_bf16_f32 v145,v146,v147
 v_cvt_pk_bf16_f32 v146,v148,v149
 v_cvt_pk_bf16_f32 v147,v150,v151
 v_permlane16_swap_b32 v112,v114
 v_permlane16_swap_b32 v113,v115
 v_mul_f32 v176,s36,v176
 v_mul_f32 v177,s36,v177
 v_mul_f32 v178,s36,v178
 v_mul_f32 v179,s36,v179
 v_mul_f32 v180,s36,v180
 v_mul_f32 v181,s36,v181
 v_mul_f32 v182,s36,v182
 v_mul_f32 v183,s36,v183
 v_permlane32_swap_b32 v144,v146
 v_permlane32_swap_b32 v145,v147
 v_cvt_pk_bf16_f32 v176,v176,v177
 v_cvt_pk_bf16_f32 v177,v178,v179
 v_cvt_pk_bf16_f32 v178,v180,v181
 v_cvt_pk_bf16_f32 v179,v182,v183
 v_permlane16_swap_b32 v144,v146
 v_permlane16_swap_b32 v145,v147
 s_nop 1
 v_permlane32_swap_b32 v176,v178
 v_permlane32_swap_b32 v177,v179
 s_nop 1
 v_permlane16_swap_b32 v176,v178
 v_permlane16_swap_b32 v177,v179
 s_nop 0
 v_mfma_f32_16x16x32_bf16 v[108:111],a[188:191],v[168:171],v[108:111]
 s_add_u32 s34,s27,0
 s_mov_b32 m0,0
 ds_read_b128 a[192:195],v2 offset:16384
 v_mfma_f32_16x16x32_bf16 v[84:87],a[160:163],v[80:83],0
 ds_read_b128 a[196:199],v3 offset:16384
 buffer_load_dwordx4 v26,s[12:15],s34 offen offset:0 sc1 nt lds
 v_mfma_f32_16x16x32_bf16 v[84:87],a[164:167],v[112:115],v[84:87]
 ds_read_b128 a[200:203],v4 offset:16384
 ds_read_b128 a[204:207],v5 offset:16384
 v_mfma_f32_16x16x32_bf16 v[84:87],a[168:171],v[144:147],v[84:87]
 ds_read_b128 a[208:211],v2 offset:20480
 ds_read_b128 a[212:215],v3 offset:20480
 v_mfma_f32_16x16x32_bf16 v[84:87],a[172:175],v[176:179],v[84:87]
 ds_read_b128 a[216:219],v4 offset:20480
 ds_read_b128 a[220:223],v5 offset:20480
 v_mfma_f32_16x16x32_bf16 v[116:119],a[176:179],v[80:83],0
 v_max3_f32 v40,v68,v69,v70
 v_max3_f32 v41,v76,v77,v78
 v_max3_f32 v44,v71,v100,v101
 v_max3_f32 v45,v79,v108,v109
 v_mfma_f32_16x16x32_bf16 v[116:119],a[180:183],v[112:115],v[116:119]
 v_max3_f32 v40,v40,v102,v103
 v_max3_f32 v41,v41,v110,v111
 v_max_f32 v40,v40,v44
 v_max_f32 v41,v41,v45
 v_mov_b32 v44,v40
 v_mov_b32 v45,v41
 s_nop 0
 v_permlane32_swap_b32 v40,v44
 v_permlane32_swap_b32 v41,v45
 v_max_f32 v40,v40,v44
 v_max_f32 v41,v41,v45
 v_mov_b32 v44,v40
 v_mov_b32 v45,v41
 s_nop 0
 v_permlane16_swap_b32 v40,v44
 v_permlane16_swap_b32 v41,v45
 v_max_f32 v40,v40,v44
 v_max_f32 v41,v41,v45
 v_sub_f32 v224,0,v40
 v_sub_f32 v225,0,v40
 v_sub_f32 v226,0,v40
 v_sub_f32 v227,0,v40
 v_mfma_f32_16x16x32_bf16 v[116:119],a[184:187],v[144:147],v[116:119]
 v_sub_f32 v228,0,v41
 v_sub_f32 v229,0,v41
 v_sub_f32 v230,0,v41
 v_sub_f32 v231,0,v41
 v_mfma_f32_16x16x32_bf16 v[116:119],a[188:191],v[176:179],v[116:119]
 v_sub_f32 v68,v68,v40
 v_sub_f32 v69,v69,v40
 v_sub_f32 v70,v70,v40
 v_mfma_f32_16x16x32_bf16 v[132:135],a[224:227],v[64:67],v[224:227]
 buffer_load_dwordx4 v27,s[12:15],s34 offen offset:1024 sc1 nt lds
 v_exp_f32 v68,v68
 v_sub_f32 v71,v71,v40
 v_mfma_f32_16x16x32_bf16 v[132:135],a[228:231],v[96:99],v[132:135]
 v_exp_f32 v69,v69
 v_sub_f32 v100,v100,v40
 v_mfma_f32_16x16x32_bf16 v[132:135],a[232:235],v[128:131],v[132:135]
 v_exp_f32 v70,v70
 v_sub_f32 v101,v101,v40
 v_mfma_f32_16x16x32_bf16 v[132:135],a[236:239],v[160:163],v[132:135]
 v_exp_f32 v71,v71
 v_mfma_f32_16x16x32_bf16 v[164:167],a[240:243],v[64:67],v[224:227]
 v_mov_b32 v48,0x3f803f80
 v_accvgpr_write_b32 a188,v48
 v_accvgpr_write_b32 a189,v48
 v_accvgpr_write_b32 a190,v48
 v_mfma_f32_16x16x32_bf16 v[164:167],a[244:247],v[96:99],v[164:167]
 v_accvgpr_write_b32 a191,v48
 v_max3_f32 v42,v84,v85,v86
 v_max3_f32 v46,v87,v116,v117
 v_max3_f32 v42,v42,v118,v119
 v_mfma_f32_16x16x32_bf16 v[164:167],a[248:251],v[128:131],v[164:167]
 v_max_f32 v42,v42,v46
 v_mov_b32 v46,v42
 s_nop 1
 v_permlane32_swap_b32 v42,v46
 v_mfma_f32_16x16x32_bf16 v[164:167],a[252:255],v[160:163],v[164:167]
 v_max_f32 v42,v42,v46
 v_mov_b32 v46,v42
 s_nop 1
 v_mfma_f32_16x16x32_bf16 v[140:143],a[224:227],v[72:75],v[228:231]
 v_permlane16_swap_b32 v42,v46
 v_mfma_f32_16x16x32_bf16 v[140:143],a[228:231],v[104:107],v[140:143]
 buffer_load_dwordx4 v28,s[12:15],s34 offen offset:2048 sc1 nt lds
 v_max_f32 v42,v42,v46
 v_sub_f32 v232,0,v42
 v_mfma_f32_16x16x32_bf16 v[140:143],a[232:235],v[136:139],v[140:143]
 v_sub_f32 v233,0,v42
 v_sub_f32 v234,0,v42
 v_sub_f32 v235,0,v42
 v_sub_f32 v84,v84,v42
 v_mfma_f32_16x16x32_bf16 v[140:143],a[236:239],v[168:171],v[140:143]
 v_sub_f32 v85,v85,v42
 v_sub_f32 v86,v86,v42
 v_exp_f32 v84,v84
 v_mfma_f32_16x16x32_bf16 v[172:175],a[240:243],v[72:75],v[228:231]
 v_sub_f32 v87,v87,v42
 v_exp_f32 v85,v85
 v_mfma_f32_16x16x32_bf16 v[172:175],a[244:247],v[104:107],v[172:175]
 v_sub_f32 v116,v116,v42
 v_exp_f32 v86,v86
 v_sub_f32 v117,v117,v42
 v_mfma_f32_16x16x32_bf16 v[172:175],a[248:251],v[136:139],v[172:175]
 v_exp_f32 v87,v87
 v_cvt_pk_bf16_f32 v200,v84,v85
 v_sub_f32 v118,v118,v42
 v_mfma_f32_16x16x32_bf16 v[172:175],a[252:255],v[168:171],v[172:175]
 v_exp_f32 v116,v116
 v_sub_f32 v119,v119,v42
 v_mfma_f32_16x16x32_bf16 v[148:151],a[224:227],v[80:83],v[232:235]
 v_exp_f32 v117,v117
 v_cvt_pk_bf16_f32 v201,v86,v87
 v_mfma_f32_16x16x32_bf16 v[148:151],a[228:231],v[112:115],v[148:151]
 v_exp_f32 v118,v118
 v_exp_f32 v119,v119
 v_mfma_f32_16x16x32_bf16 v[148:151],a[232:235],v[144:147],v[148:151]
 buffer_load_dwordx4 v29,s[12:15],s34 offen offset:3072 sc1 nt lds
 v_cvt_pk_bf16_f32 v202,v116,v117
 v_cvt_pk_bf16_f32 v203,v118,v119
 v_mfma_f32_16x16x32_bf16 v[148:151],a[236:239],v[176:179],v[148:151]
 v_cvt_pk_bf16_f32 v192,v68,v69
 v_sub_f32 v102,v102,v40
 v_mfma_f32_16x16x32_bf16 v[180:183],a[240:243],v[80:83],v[232:235]
 v_exp_f32 v100,v100
 v_sub_f32 v103,v103,v40
 v_mfma_f32_16x16x32_bf16 v[180:183],a[244:247],v[112:115],v[180:183]
 v_exp_f32 v101,v101
 v_mfma_f32_16x16x32_bf16 v[180:183],a[248:251],v[144:147],v[180:183]
 v_cvt_pk_bf16_f32 v193,v70,v71
 v_sub_f32 v76,v76,v41
 v_mfma_f32_16x16x32_bf16 v[180:183],a[252:255],v[176:179],v[180:183]
 v_exp_f32 v102,v102
 v_sub_f32 v77,v77,v41
 v_exp_f32 v103,v103
 v_cvt_pk_bf16_f32 v194,v100,v101
 v_sub_f32 v78,v78,v41
 v_exp_f32 v76,v76
 v_sub_f32 v79,v79,v41
 v_exp_f32 v77,v77
 v_cvt_pk_bf16_f32 v195,v102,v103
 v_sub_f32 v108,v108,v41
 v_exp_f32 v78,v78
 v_sub_f32 v109,v109,v41
 v_exp_f32 v79,v79
 v_cvt_pk_bf16_f32 v196,v76,v77
 v_sub_f32 v110,v110,v41
 v_exp_f32 v108,v108
 v_sub_f32 v111,v111,v41
 v_exp_f32 v109,v109
 v_cvt_pk_bf16_f32 v197,v78,v79
 v_exp_f32 v110,v110
 v_exp_f32 v111,v111
 v_cvt_pk_bf16_f32 v198,v108,v109
 v_cvt_pk_bf16_f32 v199,v110,v111
K1_attnc:
 s_waitcnt lgkmcnt(7)
 v_mfma_f32_16x16x32_bf16 v[68:71],a[192:195],v[64:67],v[224:227]
 s_waitcnt lgkmcnt(6)
 ds_read_b64_tr_b16 a[224:225],v6 offset:0
 v_exp_f32 v132,v132
 v_mfma_f32_16x16x32_bf16 v[68:71],a[196:199],v[96:99],v[68:71]
 s_waitcnt lgkmcnt(6)
 v_exp_f32 v133,v133
 v_mfma_f32_16x16x32_bf16 v[68:71],a[200:203],v[128:131],v[68:71]
 s_waitcnt lgkmcnt(5)
 ds_read_b64_tr_b16 a[226:227],v6 offset:4096
 v_exp_f32 v134,v134
 v_mfma_f32_16x16x32_bf16 v[68:71],a[204:207],v[160:163],v[68:71]
 s_add_u32 s34,s27,4096
 s_mov_b32 m0,4096
 ds_read_b64_tr_b16 a[228:229],v6 offset:8192
 v_mfma_f32_16x16x32_bf16 v[76:79],a[192:195],v[72:75],v[228:231]
 buffer_load_dwordx4 v26,s[12:15],s34 offen offset:0 sc1 nt lds
 v_exp_f32 v135,v135
 v_mfma_f32_16x16x32_bf16 v[76:79],a[196:199],v[104:107],v[76:79]
 ds_read_b64_tr_b16 a[230:231],v6 offset:12288
 v_cvt_pk_bf16_f32 v208,v132,v133
 v_mfma_f32_16x16x32_bf16 v[76:79],a[200:203],v[136:139],v[76:79]
 v_exp_f32 v140,v140
 v_mfma_f32_16x16x32_bf16 v[76:79],a[204:207],v[168:171],v[76:79]
 ds_read_b64_tr_b16 a[232:233],v7 offset:0
 buffer_load_dwordx4 v27,s[12:15],s34 offen offset:1024 sc1 nt lds
 v_mfma_f32_16x16x32_bf16 v[84:87],a[192:195],v[80:83],v[232:235]
 v_exp_f32 v141,v141
 v_mfma_f32_16x16x32_bf16 v[84:87],a[196:199],v[112:115],v[84:87]
 buffer_load_dwordx4 v28,s[12:15],s34 offen offset:2048 sc1 nt lds
 v_cvt_pk_bf16_f32 v209,v134,v135
 v_mfma_f32_16x16x32_bf16 v[84:87],a[200:203],v[144:147],v[84:87]
 v_exp_f32 v142,v142
 v_mfma_f32_16x16x32_bf16 v[84:87],a[204:207],v[176:179],v[84:87]
 s_waitcnt lgkmcnt(8)
 ds_read_b64_tr_b16 a[234:235],v7 offset:4096
 buffer_load_dwordx4 v29,s[12:15],s34 offen offset:3072 sc1 nt lds
 v_mfma_f32_16x16x32_bf16 v[100:103],a[208:211],v[64:67],v[224:227]
 s_waitcnt lgkmcnt(8)
 v_exp_f32 v143,v143
 v_mfma_f32_16x16x32_bf16 v[100:103],a[212:215],v[96:99],v[100:103]
 s_waitcnt lgkmcnt(7)
 ds_read_b128 a[192:195],v2 offset:24576
 v_cvt_pk_bf16_f32 v212,v140,v141
 v_mfma_f32_16x16x32_bf16 v[100:103],a[216:219],v[128:131],v[100:103]
 s_waitcnt lgkmcnt(7)
 v_exp_f32 v148,v148
 v_mfma_f32_16x16x32_bf16 v[100:103],a[220:223],v[160:163],v[100:103]
 s_add_u32 s34,s27,8192
 s_mov_b32 m0,8192
 ds_read_b128 a[196:199],v3 offset:24576
 ds_read_b128 a[200:203],v4 offset:24576
 v_mfma_f32_16x16x32_bf16 v[108:111],a[208:211],v[72:75],v[228:231]
 ds_read_b128 a[204:207],v5 offset:24576
 buffer_load_dwordx4 v26,s[12:15],s34 offen offset:0 sc1 nt lds
 v_mfma_f32_16x16x32_bf16 v[108:111],a[212:215],v[104:107],v[108:111]
 v_exp_f32 v149,v149
 v_mfma_f32_16x16x32_bf16 v[108:111],a[216:219],v[136:139],v[108:111]
 buffer_load_dwordx4 v27,s[12:15],s34 offen offset:1024 sc1 nt lds
 v_cvt_pk_bf16_f32 v213,v142,v143
 v_mfma_f32_16x16x32_bf16 v[108:111],a[220:223],v[168:171],v[108:111]
 v_exp_f32 v150,v150
 v_mfma_f32_16x16x32_bf16 v[116:119],a[208:211],v[80:83],v[232:235]
 ds_read_b64_tr_b16 a[236:237],v7 offset:8192
 buffer_load_dwordx4 v28,s[12:15],s34 offen offset:2048 sc1 nt lds
 v_mfma_f32_16x16x32_bf16 v[116:119],a[212:215],v[112:115],v[116:119]
 v_exp_f32 v151,v151
 v_mfma_f32_16x16x32_bf16 v[116:119],a[216:219],v[144:147],v[116:119]
 ds_read_b64_tr_b16 a[238:239],v7 offset:12288
 v_cvt_pk_bf16_f32 v216,v148,v149
 v_mfma_f32_16x16x32_bf16 v[116:119],a[220:223],v[176:179],v[116:119]
 s_waitcnt lgkmcnt(5)
 v_exp_f32 v164,v164
 v_mfma_f32_16x16x32_bf16 v[132:135],a[192:195],v[64:67],v[224:227]
 s_waitcnt lgkmcnt(4)
 ds_read_b128 a[208:211],v2 offset:28672
 buffer_load_dwordx4 v29,s[12:15],s34 offen offset:3072 sc1 nt lds
 v_mfma_f32_16x16x32_bf16 v[132:135],a[196:199],v[96:99],v[132:135]
 s_waitcnt lgkmcnt(4)
 s_add_u32 s34,s27,12288
 s_mov_b32 m0,12288
 v_mfma_f32_16x16x32_bf16 v[132:135],a[200:203],v[128:131],v[132:135]
 s_waitcnt lgkmcnt(3)
 v_exp_f32 v165,v165
 v_cvt_pk_bf16_f32 v217,v150,v151
 v_mfma_f32_16x16x32_bf16 v[132:135],a[204:207],v[160:163],v[132:135]
 ds_read_b128 a[212:215],v3 offset:28672
 buffer_load_dwordx4 v26,s[12:15],s34 offen offset:0 sc1 nt lds
 v_mfma_f32_16x16x32_bf16 v[140:143],a[192:195],v[72:75],v[228:231]
 ds_read_b128 a[216:219],v4 offset:28672
 ds_read_b128 a[220:223],v5 offset:28672
 v_mfma_f32_16x16x32_bf16 v[140:143],a[196:199],v[104:107],v[140:143]
 v_exp_f32 v166,v166
 v_mfma_f32_16x16x32_bf16 v[140:143],a[200:203],v[136:139],v[140:143]
 buffer_load_dwordx4 v27,s[12:15],s34 offen offset:1024 sc1 nt lds
 v_exp_f32 v167,v167
 v_cvt_pk_bf16_f32 v210,v164,v165
 v_mfma_f32_16x16x32_bf16 v[140:143],a[204:207],v[168:171],v[140:143]
 v_exp_f32 v172,v172
 v_mfma_f32_16x16x32_bf16 v[148:151],a[192:195],v[80:83],v[232:235]
 v_exp_f32 v173,v173
 v_mfma_f32_16x16x32_bf16 v[148:151],a[196:199],v[112:115],v[148:151]
 s_add_u32 s27,s27,16384
 buffer_load_dwordx4 v28,s[12:15],s34 offen offset:2048 sc1 nt lds
 buffer_load_dwordx4 v29,s[12:15],s34 offen offset:3072 sc1 nt lds
 v_mfma_f32_16x16x32_bf16 v[148:151],a[200:203],v[144:147],v[148:151]
 s_add_u32 s34,s28,0
 s_mov_b32 m0,114688
 v_cvt_pk_bf16_f32 v211,v166,v167
 v_mfma_f32_16x16x32_bf16 v[148:151],a[204:207],v[176:179],v[148:151]
 s_waitcnt lgkmcnt(3)
 v_exp_f32 v174,v174
 v_mfma_f32_16x16x32_bf16 v[164:167],a[208:211],v[64:67],v[224:227]
 s_waitcnt lgkmcnt(2)
 v_exp_f32 v175,v175
 v_mfma_f32_16x16x32_bf16 v[164:167],a[212:215],v[96:99],v[164:167]
 s_waitcnt lgkmcnt(1)
 buffer_load_dwordx4 v30,s[16:19],s34 offen offset:0 sc1 nt lds
 v_cvt_pk_bf16_f32 v214,v172,v173
 v_mfma_f32_16x16x32_bf16 v[164:167],a[216:219],v[128:131],v[164:167]
 s_waitcnt lgkmcnt(0)
 v_exp_f32 v180,v180
 v_mfma_f32_16x16x32_bf16 v[164:167],a[220:223],v[160:163],v[164:167]
 v_exp_f32 v181,v181
 v_cvt_pk_bf16_f32 v215,v174,v175
 v_mfma_f32_16x16x32_bf16 v[172:175],a[208:211],v[72:75],v[228:231]
 ds_read_b64_tr_b16 a[240:241],v8 offset:0
 buffer_load_dwordx4 v31,s[16:19],s34 offen offset:1024 sc1 nt lds
 v_mfma_f32_16x16x32_bf16 v[172:175],a[212:215],v[104:107],v[172:175]
 v_exp_f32 v182,v182
 v_mfma_f32_16x16x32_bf16 v[172:175],a[216:219],v[136:139],v[172:175]
 v_exp_f32 v183,v183
 v_mfma_f32_16x16x32_bf16 v[172:175],a[220:223],v[168:171],v[172:175]
 v_cvt_pk_bf16_f32 v218,v180,v181
 v_cvt_pk_bf16_f32 v219,v182,v183
 v_mfma_f32_16x16x32_bf16 v[180:183],a[208:211],v[80:83],v[232:235]
 ds_read_b64_tr_b16 a[242:243],v8 offset:4096
 buffer_load_dwordx4 v30,s[16:19],s34 offen offset:2048 sc1 nt lds
 v_mfma_f32_16x16x32_bf16 v[180:183],a[212:215],v[112:115],v[180:183]
 ds_read_b64_tr_b16 a[244:245],v8 offset:8192
 ds_read_b64_tr_b16 a[246:247],v8 offset:12288
 v_mfma_f32_16x16x32_bf16 v[180:183],a[216:219],v[144:147],v[180:183]
 buffer_load_dwordx4 v31,s[16:19],s34 offen offset:3072 sc1 nt lds
 s_add_u32 s34,s28,4096
 s_mov_b32 m0,118784
 v_mfma_f32_16x16x32_bf16 v[180:183],a[220:223],v[176:179],v[180:183]
 ds_read_b64_tr_b16 a[248:249],v9 offset:0
 ds_read_b64_tr_b16 a[250:251],v9 offset:4096
 v_mfma_f32_16x16x32_bf16 a[0:3],a[224:227],v[192:195],0
 ds_read_b64_tr_b16 a[252:253],v9 offset:8192
 buffer_load_dwordx4 v30,s[16:19],s34 offen offset:0 sc1 nt lds
 v_mfma_f32_16x16x32_bf16 a[0:3],a[228:231],v[208:211],a[0:3]
 v_exp_f32 v68,v68
 v_mfma_f32_16x16x32_bf16 a[4:7],a[224:227],v[196:199],0
 v_exp_f32 v69,v69
 v_mfma_f32_16x16x32_bf16 a[4:7],a[228:231],v[212:215],a[4:7]
 ds_read_b64_tr_b16 a[254:255],v9 offset:12288
 buffer_load_dwordx4 v31,s[16:19],s34 offen offset:1024 sc1 nt lds
 v_mfma_f32_16x16x32_bf16 a[8:11],a[224:227],v[200:203],0
 v_exp_f32 v70,v70
 v_mfma_f32_16x16x32_bf16 a[8:11],a[228:231],v[216:219],a[8:11]
 v_exp_f32 v71,v71
 v_mfma_f32_16x16x32_bf16 a[16:19],a[232:235],v[192:195],0
 ds_read_b64_tr_b16 a[224:225],v10 offset:0
 buffer_load_dwordx4 v30,s[16:19],s34 offen offset:2048 sc1 nt lds
 v_mfma_f32_16x16x32_bf16 a[16:19],a[236:239],v[208:211],a[16:19]
 ds_read_b64_tr_b16 a[226:227],v10 offset:4096
 v_cvt_pk_bf16_f32 v204,v68,v69
 v_mfma_f32_16x16x32_bf16 a[20:23],a[232:235],v[196:199],0
 v_exp_f32 v100,v100
 v_mfma_f32_16x16x32_bf16 a[20:23],a[236:239],v[212:215],a[20:23]
 ds_read_b64_tr_b16 a[228:229],v10 offset:8192
 buffer_load_dwordx4 v31,s[16:19],s34 offen offset:3072 sc1 nt lds
 v_mfma_f32_16x16x32_bf16 a[24:27],a[232:235],v[200:203],0
 s_add_u32 s34,s28,8192
 s_mov_b32 m0,122880
 ds_read_b64_tr_b16 a[230:231],v10 offset:12288
 v_mfma_f32_16x16x32_bf16 a[24:27],a[236:239],v[216:219],a[24:27]
 s_waitcnt lgkmcnt(10)
 ds_read_b64_tr_b16 a[232:233],v11 offset:0
 buffer_load_dwordx4 v30,s[16:19],s34 offen offset:0 sc1 nt lds
 v_mfma_f32_16x16x32_bf16 a[32:35],a[240:243],v[192:195],0
 s_waitcnt lgkmcnt(9)
 v_exp_f32 v101,v101
 v_mfma_f32_16x16x32_bf16 a[32:35],a[244:247],v[208:211],a[32:35]
 ds_read_b64_tr_b16 a[234:235],v11 offset:4096
 v_cvt_pk_bf16_f32 v205,v70,v71
 v_mfma_f32_16x16x32_bf16 a[36:39],a[240:243],v[196:199],0
 ds_read_b64_tr_b16 a[236:237],v11 offset:8192
 buffer_load_dwordx4 v31,s[16:19],s34 offen offset:1024 sc1 nt lds
 v_mfma_f32_16x16x32_bf16 a[36:39],a[244:247],v[212:215],a[36:39]
 v_exp_f32 v102,v102
 v_mfma_f32_16x16x32_bf16 a[40:43],a[240:243],v[200:203],0
 v_exp_f32 v103,v103
 v_mfma_f32_16x16x32_bf16 a[40:43],a[244:247],v[216:219],a[40:43]
 s_waitcnt lgkmcnt(9)
 buffer_load_dwordx4 v30,s[16:19],s34 offen offset:2048 sc1 nt lds
 v_cvt_pk_bf16_f32 v206,v100,v101
 v_mfma_f32_16x16x32_bf16 a[48:51],a[248:251],v[192:195],0
 s_waitcnt lgkmcnt(7)
 ds_read_b64_tr_b16 a[238:239],v11 offset:12288
 ds_read_b64_tr_b16 a[240:241],v12 offset:0
 v_mfma_f32_16x16x32_bf16 a[48:51],a[252:255],v[208:211],a[48:51]
 v_exp_f32 v76,v76
 v_mfma_f32_16x16x32_bf16 a[52:55],a[248:251],v[196:199],0
 ds_read_b64_tr_b16 a[242:243],v12 offset:4096
 buffer_load_dwordx4 v31,s[16:19],s34 offen offset:3072 sc1 nt lds
 v_mfma_f32_16x16x32_bf16 a[52:55],a[252:255],v[212:215],a[52:55]
 v_exp_f32 v77,v77
 v_mfma_f32_16x16x32_bf16 a[56:59],a[248:251],v[200:203],0
 s_add_u32 s34,s28,12288
 s_mov_b32 m0,126976
 v_cvt_pk_bf16_f32 v207,v102,v103
 v_mfma_f32_16x16x32_bf16 a[56:59],a[252:255],v[216:219],a[56:59]
 s_waitcnt lgkmcnt(8)
 ds_read_b64_tr_b16 a[244:245],v12 offset:8192
 buffer_load_dwordx4 v30,s[16:19],s34 offen offset:0 sc1 nt lds
 v_mfma_f32_16x16x32_bf16 a[64:67],a[224:227],v[192:195],0
 s_waitcnt lgkmcnt(7)
 ds_read_b64_tr_b16 a[246:247],v12 offset:12288
 ds_read_b64_tr_b16 a[248:249],v13 offset:0
 v_mfma_f32_16x16x32_bf16 a[64:67],a[228:231],v[208:211],a[64:67]
 ds_read_b64_tr_b16 a[250:251],v13 offset:4096
 buffer_load_dwordx4 v31,s[16:19],s34 offen offset:1024 sc1 nt lds
 v_mfma_f32_16x16x32_bf16 a[68:71],a[224:227],v[196:199],0
 v_exp_f32 v78,v78
 v_mfma_f32_16x16x32_bf16 a[68:71],a[228:231],v[212:215],a[68:71]
 v_exp_f32 v79,v79
 v_mfma_f32_16x16x32_bf16 a[72:75],a[224:227],v[200:203],0
 ds_read_b64_tr_b16 a[252:253],v13 offset:8192
 v_cvt_pk_bf16_f32 v220,v76,v77
 v_mfma_f32_16x16x32_bf16 a[72:75],a[228:231],v[216:219],a[72:75]
 s_waitcnt lgkmcnt(9)
 ds_read_b64_tr_b16 a[254:255],v13 offset:12288
 buffer_load_dwordx4 v30,s[16:19],s34 offen offset:2048 sc1 nt lds
 v_mfma_f32_16x16x32_bf16 a[80:83],a[232:235],v[192:195],0
 s_waitcnt lgkmcnt(8)
 v_exp_f32 v108,v108
 v_mfma_f32_16x16x32_bf16 a[80:83],a[236:239],v[208:211],a[80:83]
 v_exp_f32 v109,v109
 v_mfma_f32_16x16x32_bf16 a[84:87],a[232:235],v[196:199],0
 s_add_u32 s28,s28,16384
 buffer_load_dwordx4 v31,s[16:19],s34 offen offset:3072 sc1 nt lds
 v_cvt_pk_bf16_f32 v221,v78,v79
 v_mfma_f32_16x16x32_bf16 a[84:87],a[236:239],v[212:215],a[84:87]
 v_exp_f32 v110,v110
 v_mfma_f32_16x16x32_bf16 a[88:91],a[232:235],v[200:203],0
 v_exp_f32 v111,v111
 v_mfma_f32_16x16x32_bf16 a[88:91],a[236:239],v[216:219],a[88:91]
 s_waitcnt vmcnt(40)
 s_waitcnt lgkmcnt(0)
 s_barrier
 v_mfma_f32_16x16x32_bf16 a[96:99],a[240:243],v[192:195],0
 ds_read_b128 a[192:195],v2 offset:32768
 v_cvt_pk_bf16_f32 v222,v108,v109
 v_mfma_f32_16x16x32_bf16 a[96:99],a[244:247],v[208:211],a[96:99]
 s_add_u32 s34,s27,0
 s_mov_b32 m0,16384
 ds_read_b128 a[196:199],v3 offset:32768
 v_mfma_f32_16x16x32_bf16 a[100:103],a[240:243],v[196:199],0
 ds_read_b128 a[200:203],v4 offset:32768
 buffer_load_dwordx4 v26,s[12:15],s34 offen offset:0 sc1 nt lds
 v_mfma_f32_16x16x32_bf16 a[100:103],a[244:247],v[212:215],a[100:103]
 v_exp_f32 v84,v84
 v_mfma_f32_16x16x32_bf16 a[104:107],a[240:243],v[200:203],0
 v_exp_f32 v85,v85
 v_mfma_f32_16x16x32_bf16 a[104:107],a[244:247],v[216:219],a[104:107]
 buffer_load_dwordx4 v27,s[12:15],s34 offen offset:1024 sc1 nt lds
 v_cvt_pk_bf16_f32 v223,v110,v111
 v_mfma_f32_16x16x32_bf16 a[112:115],a[248:251],v[192:195],0
 v_exp_f32 v86,v86
 v_mfma_f32_16x16x32_bf16 a[112:115],a[252:255],v[208:211],a[112:115]
 v_exp_f32 v87,v87
 v_mfma_f32_16x16x32_bf16 a[116:119],a[248:251],v[196:199],0
 ds_read_b128 a[204:207],v5 offset:32768
 v_cvt_pk_bf16_f32 v236,v84,v85
 v_mfma_f32_16x16x32_bf16 a[116:119],a[252:255],v[212:215],a[116:119]
 v_exp_f32 v116,v116
 v_mfma_f32_16x16x32_bf16 a[120:123],a[248:251],v[200:203],0
 ds_read_b128 a[208:211],v2 offset:36864
 ds_read_b128 a[212:215],v3 offset:36864
 v_mfma_f32_16x16x32_bf16 a[120:123],a[252:255],v[216:219],a[120:123]
 v_exp_f32 v117,v117
 v_mfma_f32_16x16x32_bf16 v[248:251],a[188:191],v[192:195],0
 buffer_load_dwordx4 v28,s[12:15],s34 offen offset:2048 sc1 nt lds
 v_cvt_pk_bf16_f32 v237,v86,v87
 v_mfma_f32_16x16x32_bf16 v[248:251],a[188:191],v[208:211],v[248:251]
 v_exp_f32 v118,v118
 v_mfma_f32_16x16x32_bf16 v[240:243],a[188:191],v[196:199],0
 ds_read_b128 a[216:219],v4 offset:36864
 ds_read_b128 a[220:223],v5 offset:36864
 v_mfma_f32_16x16x32_bf16 v[240:243],a[188:191],v[212:215],v[240:243]
 v_exp_f32 v119,v119
 v_mfma_f32_16x16x32_bf16 v[244:247],a[188:191],v[200:203],0
 buffer_load_dwordx4 v29,s[12:15],s34 offen offset:3072 sc1 nt lds
 v_cvt_pk_bf16_f32 v238,v116,v117
 v_mfma_f32_16x16x32_bf16 v[244:247],a[188:191],v[216:219],v[244:247]
 v_cvt_pk_bf16_f32 v239,v118,v119
 s_mov_b32 s32,3
 s_mov_b32 s98,1073741824
 .p2align 3
K1_loopc:
 s_waitcnt lgkmcnt(7)
 v_mfma_f32_16x16x32_bf16 v[68:71],a[192:195],v[64:67],v[224:227]
 s_waitcnt lgkmcnt(6)
 ds_read_b64_tr_b16 a[224:225],v6 offset:16384
 v_exp_f32 v132,v132
 v_mfma_f32_16x16x32_bf16 v[68:71],a[196:199],v[96:99],v[68:71]
 s_waitcnt lgkmcnt(6)
 v_exp_f32 v133,v133
 v_mfma_f32_16x16x32_bf16 v[68:71],a[200:203],v[128:131],v[68:71]
 s_waitcnt lgkmcnt(5)
 ds_read_b64_tr_b16 a[226:227],v6 offset:20480
 v_exp_f32 v134,v134
 v_mfma_f32_16x16x32_bf16 v[68:71],a[204:207],v[160:163],v[68:71]
 s_add_u32 s34,s27,4096
 s_mov_b32 m0,20480
 ds_read_b64_tr_b16 a[228:229],v6 offset:24576
 v_mfma_f32_16x16x32_bf16 v[76:79],a[192:195],v[72:75],v[228:231]
 buffer_load_dwordx4 v26,s[12:15],s34 offen offset:0 sc1 nt lds
 v_exp_f32 v135,v135
 v_mfma_f32_16x16x32_bf16 v[76:79],a[196:199],v[104:107],v[76:79]
 ds_read_b64_tr_b16 a[230:231],v6 offset:28672
 v_cvt_pk_bf16_f32 v208,v132,v133
 v_mfma_f32_16x16x32_bf16 v[76:79],a[200:203],v[136:139],v[76:79]
 v_exp_f32 v140,v140
 v_mfma_f32_16x16x32_bf16 v[76:79],a[204:207],v[168:171],v[76:79]
 ds_read_b64_tr_b16 a[232:233],v7 offset:16384
 buffer_load_dwordx4 v27,s[12:15],s34 offen offset:1024 sc1 nt lds
 v_mfma_f32_16x16x32_bf16 v[84:87],a[192:195],v[80:83],v[232:235]
 v_exp_f32 v141,v141
 v_mfma_f32_16x16x32_bf16 v[84:87],a[196:199],v[112:115],v[84:87]
 buffer_load_dwordx4 v28,s[12:15],s34 offen offset:2048 sc1 nt lds
 v_cvt_pk_bf16_f32 v209,v134,v135
 v_mfma_f32_16x16x32_bf16 v[84:87],a[200:203],v[144:147],v[84:87]
 v_exp_f32 v142,v142
 v_mfma_f32_16x16x32_bf16 v[84:87],a[204:207],v[176:179],v[84:87]
 s_waitcnt lgkmcnt(8)
 ds_read_b64_tr_b16 a[234:235],v7 offset:20480
 buffer_load_dwordx4 v29,s[12:15],s34 offen offset:3072 sc1 nt lds
 v_mfma_f32_16x16x32_bf16 v[100:103],a[208:211],v[64:67],v[224:227]
 s_waitcnt lgkmcnt(8)
 v_exp_f32 v143,v143
 v_mfma_f32_16x16x32_bf16 v[100:103],a[212:215],v[96:99],v[100:103]
 s_waitcnt lgkmcnt(7)
 ds_read_b128 a[192:195],v2 offset:40960
 v_cvt_pk_bf16_f32 v212,v140,v141
 v_mfma_f32_16x16x32_bf16 v[100:103],a[216:219],v[128:131],v[100:103]
 s_waitcnt lgkmcnt(7)
 v_exp_f32 v148,v148
 v_mfma_f32_16x16x32_bf16 v[100:103],a[220:223],v[160:163],v[100:103]
 s_add_u32 s34,s27,8192
 s_mov_b32 m0,24576
 ds_read_b128 a[196:199],v3 offset:40960
 ds_read_b128 a[200:203],v4 offset:40960
 v_mfma_f32_16x16x32_bf16 v[108:111],a[208:211],v[72:75],v[228:231]
 ds_read_b128 a[204:207],v5 offset:40960
 buffer_load_dwordx4 v26,s[12:15],s34 offen offset:0 sc1 nt lds
 v_mfma_f32_16x16x32_bf16 v[108:111],a[212:215],v[104:107],v[108:111]
 v_exp_f32 v149,v149
 v_mfma_f32_16x16x32_bf16 v[108:111],a[216:219],v[136:139],v[108:111]
 buffer_load_dwordx4 v27,s[12:15],s34 offen offset:1024 sc1 nt lds
 v_cvt_pk_bf16_f32 v213,v142,v143
 v_mfma_f32_16x16x32_bf16 v[108:111],a[220:223],v[168:171],v[108:111]
 v_exp_f32 v150,v150
 v_mfma_f32_16x16x32_bf16 v[116:119],a[208:211],v[80:83],v[232:235]
 ds_read_b64_tr_b16 a[236:237],v7 offset:24576
 buffer_load_dwordx4 v28,s[12:15],s34 offen offset:2048 sc1 nt lds
 v_mfma_f32_16x16x32_bf16 v[116:119],a[212:215],v[112:115],v[116:119]
 v_exp_f32 v151,v151
 v_mfma_f32_16x16x32_bf16 v[116:119],a[216:219],v[144:147],v[116:119]
 ds_read_b64_tr_b16 a[238:239],v7 offset:28672
 v_cvt_pk_bf16_f32 v216,v148,v149
 v_mfma_f32_16x16x32_bf16 v[116:119],a[220:223],v[176:179],v[116:119]
 s_waitcnt lgkmcnt(5)
 v_exp_f32 v164,v164
 v_mfma_f32_16x16x32_bf16 v[132:135],a[192:195],v[64:67],v[224:227]
 s_waitcnt lgkmcnt(4)
 ds_read_b128 a[208:211],v2 offset:45056
 buffer_load_dwordx4 v29,s[12:15],s34 offen offset:3072 sc1 nt lds
 v_mfma_f32_16x16x32_bf16 v[132:135],a[196:199],v[96:99],v[132:135]
 s_waitcnt lgkmcnt(4)
 s_add_u32 s34,s27,12288
 s_mov_b32 m0,28672
 v_mfma_f32_16x16x32_bf16 v[132:135],a[200:203],v[128:131],v[132:135]
 s_waitcnt lgkmcnt(3)
 v_exp_f32 v165,v165
 v_cvt_pk_bf16_f32 v217,v150,v151
 v_mfma_f32_16x16x32_bf16 v[132:135],a[204:207],v[160:163],v[132:135]
 ds_read_b128 a[212:215],v3 offset:45056
 buffer_load_dwordx4 v26,s[12:15],s34 offen offset:0 sc1 nt lds
 v_mfma_f32_16x16x32_bf16 v[140:143],a[192:195],v[72:75],v[228:231]
 ds_read_b128 a[216:219],v4 offset:45056
 ds_read_b128 a[220:223],v5 offset:45056
 v_mfma_f32_16x16x32_bf16 v[140:143],a[196:199],v[104:107],v[140:143]
 v_exp_f32 v166,v166
 v_mfma_f32_16x16x32_bf16 v[140:143],a[200:203],v[136:139],v[140:143]
 buffer_load_dwordx4 v27,s[12:15],s34 offen offset:1024 sc1 nt lds
 v_exp_f32 v167,v167
 v_cvt_pk_bf16_f32 v210,v164,v165
 v_mfma_f32_16x16x32_bf16 v[140:143],a[204:207],v[168:171],v[140:143]
 v_exp_f32 v172,v172
 v_mfma_f32_16x16x32_bf16 v[148:151],a[192:195],v[80:83],v[232:235]
 v_exp_f32 v173,v173
 v_mfma_f32_16x16x32_bf16 v[148:151],a[196:199],v[112:115],v[148:151]
 s_add_u32 s27,s27,16384
 buffer_load_dwordx4 v28,s[12:15],s34 offen offset:2048 sc1 nt lds
 buffer_load_dwordx4 v29,s[12:15],s34 offen offset:3072 sc1 nt lds
 v_mfma_f32_16x16x32_bf16 v[148:151],a[200:203],v[144:147],v[148:151]
 s_add_u32 s34,s28,0
 s_mov_b32 m0,65536
 v_cvt_pk_bf16_f32 v211,v166,v167
 v_mfma_f32_16x16x32_bf16 v[148:151],a[204:207],v[176:179],v[148:151]
 s_waitcnt lgkmcnt(3)
 v_exp_f32 v174,v174
 v_mfma_f32_16x16x32_bf16 v[164:167],a[208:211],v[64:67],v[224:227]
 s_waitcnt lgkmcnt(2)
 v_exp_f32 v175,v175
 v_mfma_f32_16x16x32_bf16 v[164:167],a[212:215],v[96:99],v[164:167]
 s_waitcnt lgkmcnt(1)
 buffer_load_dwordx4 v30,s[16:19],s34 offen offset:0 sc1 nt lds
 v_cvt_pk_bf16_f32 v214,v172,v173
 v_mfma_f32_16x16x32_bf16 v[164:167],a[216:219],v[128:131],v[164:167]
 s_waitcnt lgkmcnt(0)
 v_exp_f32 v180,v180
 v_mfma_f32_16x16x32_bf16 v[164:167],a[220:223],v[160:163],v[164:167]
 v_exp_f32 v181,v181
 v_cvt_pk_bf16_f32 v215,v174,v175
 v_mfma_f32_16x16x32_bf16 v[172:175],a[208:211],v[72:75],v[228:231]
 ds_read_b64_tr_b16 a[240:241],v8 offset:16384
 buffer_load_dwordx4 v31,s[16:19],s34 offen offset:1024 sc1 nt lds
 v_mfma_f32_16x16x32_bf16 v[172:175],a[212:215],v[104:107],v[172:175]
 v_exp_f32 v182,v182
 v_mfma_f32_16x16x32_bf16 v[172:175],a[216:219],v[136:139],v[172:175]
 v_exp_f32 v183,v183
 v_mfma_f32_16x16x32_bf16 v[172:175],a[220:223],v[168:171],v[172:175]
 v_cvt_pk_bf16_f32 v218,v180,v181
 v_cvt_pk_bf16_f32 v219,v182,v183
 v_mfma_f32_16x16x32_bf16 v[180:183],a[208:211],v[80:83],v[232:235]
 ds_read_b64_tr_b16 a[242:243],v8 offset:20480
 buffer_load_dwordx4 v30,s[16:19],s34 offen offset:2048 sc1 nt lds
 v_mfma_f32_16x16x32_bf16 v[180:183],a[212:215],v[112:115],v[180:183]
 ds_read_b64_tr_b16 a[244:245],v8 offset:24576
 ds_read_b64_tr_b16 a[246:247],v8 offset:28672
 v_mfma_f32_16x16x32_bf16 v[180:183],a[216:219],v[144:147],v[180:183]
 buffer_load_dwordx4 v31,s[16:19],s34 offen offset:3072 sc1 nt lds
 s_add_u32 s34,s28,4096
 s_mov_b32 m0,69632
 v_mfma_f32_16x16x32_bf16 v[180:183],a[220:223],v[176:179],v[180:183]
 ds_read_b64_tr_b16 a[248:249],v9 offset:16384
 ds_read_b64_tr_b16 a[250:251],v9 offset:20480
 v_mfma_f32_16x16x32_bf16 a[0:3],a[224:227],v[204:207],a[0:3]
 ds_read_b64_tr_b16 a[252:253],v9 offset:24576
 buffer_load_dwordx4 v30,s[16:19],s34 offen offset:0 sc1 nt lds
 v_mfma_f32_16x16x32_bf16 a[0:3],a[228:231],v[208:211],a[0:3]
 v_exp_f32 v68,v68
 v_mfma_f32_16x16x32_bf16 a[4:7],a[224:227],v[220:223],a[4:7]
 v_exp_f32 v69,v69
 v_mfma_f32_16x16x32_bf16 a[4:7],a[228:231],v[212:215],a[4:7]
 ds_read_b64_tr_b16 a[254:255],v9 offset:28672
 buffer_load_dwordx4 v31,s[16:19],s34 offen offset:1024 sc1 nt lds
 v_mfma_f32_16x16x32_bf16 a[8:11],a[224:227],v[236:239],a[8:11]
 v_exp_f32 v70,v70
 v_mfma_f32_16x16x32_bf16 a[8:11],a[228:231],v[216:219],a[8:11]
 v_exp_f32 v71,v71
 v_mfma_f32_16x16x32_bf16 a[16:19],a[232:235],v[204:207],a[16:19]
 ds_read_b64_tr_b16 a[224:225],v10 offset:16384
 buffer_load_dwordx4 v30,s[16:19],s34 offen offset:2048 sc1 nt lds
 v_mfma_f32_16x16x32_bf16 a[16:19],a[236:239],v[208:211],a[16:19]
 ds_read_b64_tr_b16 a[226:227],v10 offset:20480
 v_cvt_pk_bf16_f32 v192,v68,v69
 v_mfma_f32_16x16x32_bf16 a[20:23],a[232:235],v[220:223],a[20:23]
 v_exp_f32 v100,v100
 v_mfma_f32_16x16x32_bf16 a[20:23],a[236:239],v[212:215],a[20:23]
 ds_read_b64_tr_b16 a[228:229],v10 offset:24576
 buffer_load_dwordx4 v31,s[16:19],s34 offen offset:3072 sc1 nt lds
 v_mfma_f32_16x16x32_bf16 a[24:27],a[232:235],v[236:239],a[24:27]
 s_add_u32 s34,s28,8192
 s_mov_b32 m0,73728
 ds_read_b64_tr_b16 a[230:231],v10 offset:28672
 v_mfma_f32_16x16x32_bf16 a[24:27],a[236:239],v[216:219],a[24:27]
 s_waitcnt lgkmcnt(10)
 ds_read_b64_tr_b16 a[232:233],v11 offset:16384
 buffer_load_dwordx4 v30,s[16:19],s34 offen offset:0 sc1 nt lds
 v_mfma_f32_16x16x32_bf16 a[32:35],a[240:243],v[204:207],a[32:35]
 s_waitcnt lgkmcnt(9)
 v_exp_f32 v101,v101
 v_mfma_f32_16x16x32_bf16 a[32:35],a[244:247],v[208:211],a[32:35]
 ds_read_b64_tr_b16 a[234:235],v11 offset:20480
 v_cvt_pk_bf16_f32 v193,v70,v71
 v_mfma_f32_16x16x32_bf16 a[36:39],a[240:243],v[220:223],a[36:39]
 ds_read_b64_tr_b16 a[236:237],v11 offset:24576
 buffer_load_dwordx4 v31,s[16:19],s34 offen offset:1024 sc1 nt lds
 v_mfma_f32_16x16x32_bf16 a[36:39],a[244:247],v[212:215],a[36:39]
 v_exp_f32 v102,v102
 v_mfma_f32_16x16x32_bf16 a[40:43],a[240:243],v[236:239],a[40:43]
 v_exp_f32 v103,v103
 v_mfma_f32_16x16x32_bf16 a[40:43],a[244:247],v[216:219],a[40:43]
 s_waitcnt lgkmcnt(9)
 buffer_load_dwordx4 v30,s[16:19],s34 offen offset:2048 sc1 nt lds
 v_cvt_pk_bf16_f32 v194,v100,v101
 v_mfma_f32_16x16x32_bf16 a[48:51],a[248:251],v[204:207],a[48:51]
 s_waitcnt lgkmcnt(7)
 ds_read_b64_tr_b16 a[238:239],v11 offset:28672
 ds_read_b64_tr_b16 a[240:241],v12 offset:16384
 v_mfma_f32_16x16x32_bf16 a[48:51],a[252:255],v[208:211],a[48:51]
 v_exp_f32 v76,v76
 v_mfma_f32_16x16x32_bf16 a[52:55],a[248:251],v[220:223],a[52:55]
 ds_read_b64_tr_b16 a[242:243],v12 offset:20480
 buffer_load_dwordx4 v31,s[16:19],s34 offen offset:3072 sc1 nt lds
 v_mfma_f32_16x16x32_bf16 a[52:55],a[252:255],v[212:215],a[52:55]
 v_exp_f32 v77,v77
 v_mfma_f32_16x16x32_bf16 a[56:59],a[248:251],v[236:239],a[56:59]
 s_add_u32 s34,s28,12288
 s_mov_b32 m0,77824
 v_cvt_pk_bf16_f32 v195,v102,v103
 v_mfma_f32_16x16x32_bf16 a[56:59],a[252:255],v[216:219],a[56:59]
 s_waitcnt lgkmcnt(8)
 ds_read_b64_tr_b16 a[244:245],v12 offset:24576
 buffer_load_dwordx4 v30,s[16:19],s34 offen offset:0 sc1 nt lds
 v_mfma_f32_16x16x32_bf16 a[64:67],a[224:227],v[204:207],a[64:67]
 s_waitcnt lgkmcnt(7)
 ds_read_b64_tr_b16 a[246:247],v12 offset:28672
 ds_read_b64_tr_b16 a[248:249],v13 offset:16384
 v_mfma_f32_16x16x32_bf16 a[64:67],a[228:231],v[208:211],a[64:67]
 ds_read_b64_tr_b16 a[250:251],v13 offset:20480
 buffer_load_dwordx4 v31,s[16:19],s34 offen offset:1024 sc1 nt lds
 v_mfma_f32_16x16x32_bf16 a[68:71],a[224:227],v[220:223],a[68:71]
 v_exp_f32 v78,v78
 v_mfma_f32_16x16x32_bf16 a[68:71],a[228:231],v[212:215],a[68:71]
 v_exp_f32 v79,v79
 v_mfma_f32_16x16x32_bf16 a[72:75],a[224:227],v[236:239],a[72:75]
 ds_read_b64_tr_b16 a[252:253],v13 offset:24576
 v_cvt_pk_bf16_f32 v196,v76,v77
 v_mfma_f32_16x16x32_bf16 a[72:75],a[228:231],v[216:219],a[72:75]
 s_waitcnt lgkmcnt(9)
 ds_read_b64_tr_b16 a[254:255],v13 offset:28672
 buffer_load_dwordx4 v30,s[16:19],s34 offen offset:2048 sc1 nt lds
 v_mfma_f32_16x16x32_bf16 a[80:83],a[232:235],v[204:207],a[80:83]
 s_waitcnt lgkmcnt(8)
 v_exp_f32 v108,v108
 v_mfma_f32_16x16x32_bf16 a[80:83],a[236:239],v[208:211],a[80:83]
 v_exp_f32 v109,v109
 v_mfma_f32_16x16x32_bf16 a[84:87],a[232:235],v[220:223],a[84:87]
 s_add_u32 s28,s28,16384
 buffer_load_dwordx4 v31,s[16:19],s34 offen offset:3072 sc1 nt lds
 v_cvt_pk_bf16_f32 v197,v78,v79
 v_mfma_f32_16x16x32_bf16 a[84:87],a[236:239],v[212:215],a[84:87]
 v_exp_f32 v110,v110
 v_mfma_f32_16x16x32_bf16 a[88:91],a[232:235],v[236:239],a[88:91]
 v_exp_f32 v111,v111
 v_mfma_f32_16x16x32_bf16 a[88:91],a[236:239],v[216:219],a[88:91]
 s_waitcnt vmcnt(63)
 s_waitcnt lgkmcnt(0)
 s_barrier
 v_mfma_f32_16x16x32_bf16 a[96:99],a[240:243],v[204:207],a[96:99]
 ds_read_b128 a[192:195],v2 offset:49152
 v_cvt_pk_bf16_f32 v198,v108,v109
 v_mfma_f32_16x16x32_bf16 a[96:99],a[244:247],v[208:211],a[96:99]
 s_add_u32 s34,s27,0
 s_mov_b32 m0,32768
 ds_read_b128 a[196:199],v3 offset:49152
 v_mfma_f32_16x16x32_bf16 a[100:103],a[240:243],v[220:223],a[100:103]
 ds_read_b128 a[200:203],v4 offset:49152
 buffer_load_dwordx4 v26,s[12:15],s34 offen offset:0 sc1 nt lds
 v_mfma_f32_16x16x32_bf16 a[100:103],a[244:247],v[212:215],a[100:103]
 v_exp_f32 v84,v84
 v_mfma_f32_16x16x32_bf16 a[104:107],a[240:243],v[236:239],a[104:107]
 v_exp_f32 v85,v85
 v_mfma_f32_16x16x32_bf16 a[104:107],a[244:247],v[216:219],a[104:107]
 buffer_load_dwordx4 v27,s[12:15],s34 offen offset:1024 sc1 nt lds
 v_cvt_pk_bf16_f32 v199,v110,v111
 v_mfma_f32_16x16x32_bf16 a[112:115],a[248:251],v[204:207],a[112:115]
 v_exp_f32 v86,v86
 v_mfma_f32_16x16x32_bf16 a[112:115],a[252:255],v[208:211],a[112:115]
 v_exp_f32 v87,v87
 v_mfma_f32_16x16x32_bf16 a[116:119],a[248:251],v[220:223],a[116:119]
 ds_read_b128 a[204:207],v5 offset:49152
 v_cvt_pk_bf16_f32 v200,v84,v85
 v_mfma_f32_16x16x32_bf16 a[116:119],a[252:255],v[212:215],a[116:119]
 v_exp_f32 v116,v116
 v_mfma_f32_16x16x32_bf16 a[120:123],a[248:251],v[236:239],a[120:123]
 ds_read_b128 a[208:211],v2 offset:53248
 ds_read_b128 a[212:215],v3 offset:53248
 v_mfma_f32_16x16x32_bf16 a[120:123],a[252:255],v[216:219],a[120:123]
 v_exp_f32 v117,v117
 v_mfma_f32_16x16x32_bf16 v[248:251],a[188:191],v[204:207],v[248:251]
 buffer_load_dwordx4 v28,s[12:15],s34 offen offset:2048 sc1 nt lds
 v_cvt_pk_bf16_f32 v201,v86,v87
 v_mfma_f32_16x16x32_bf16 v[248:251],a[188:191],v[208:211],v[248:251]
 v_exp_f32 v118,v118
 v_mfma_f32_16x16x32_bf16 v[240:243],a[188:191],v[220:223],v[240:243]
 ds_read_b128 a[216:219],v4 offset:53248
 ds_read_b128 a[220:223],v5 offset:53248
 v_mfma_f32_16x16x32_bf16 v[240:243],a[188:191],v[212:215],v[240:243]
 v_exp_f32 v119,v119
 v_mfma_f32_16x16x32_bf16 v[244:247],a[188:191],v[236:239],v[244:247]
 buffer_load_dwordx4 v29,s[12:15],s34 offen offset:3072 sc1 nt lds
 v_cvt_pk_bf16_f32 v202,v116,v117
 v_mfma_f32_16x16x32_bf16 v[244:247],a[188:191],v[216:219],v[244:247]
 s_waitcnt lgkmcnt(7)
 v_cvt_pk_bf16_f32 v203,v118,v119
 v_mfma_f32_16x16x32_bf16 v[68:71],a[192:195],v[64:67],v[224:227]
 s_waitcnt lgkmcnt(6)
 ds_read_b64_tr_b16 a[224:225],v6 offset:32768
 v_exp_f32 v132,v132
 v_mfma_f32_16x16x32_bf16 v[68:71],a[196:199],v[96:99],v[68:71]
 s_waitcnt lgkmcnt(6)
 v_exp_f32 v133,v133
 v_mfma_f32_16x16x32_bf16 v[68:71],a[200:203],v[128:131],v[68:71]
 s_waitcnt lgkmcnt(5)
 ds_read_b64_tr_b16 a[226:227],v6 offset:36864
 v_exp_f32 v134,v134
 v_mfma_f32_16x16x32_bf16 v[68:71],a[204:207],v[160:163],v[68:71]
 s_add_u32 s34,s27,4096
 s_mov_b32 m0,36864
 ds_read_b64_tr_b16 a[228:229],v6 offset:40960
 v_mfma_f32_16x16x32_bf16 v[76:79],a[192:195],v[72:75],v[228:231]
 buffer_load_dwordx4 v26,s[12:15],s34 offen offset:0 sc1 nt lds
 v_exp_f32 v135,v135
 v_mfma_f32_16x16x32_bf16 v[76:79],a[196:199],v[104:107],v[76:79]
 ds_read_b64_tr_b16 a[230:231],v6 offset:45056
 v_cvt_pk_bf16_f32 v208,v132,v133
 v_mfma_f32_16x16x32_bf16 v[76:79],a[200:203],v[136:139],v[76:79]
 v_exp_f32 v140,v140
 v_mfma_f32_16x16x32_bf16 v[76:79],a[204:207],v[168:171],v[76:79]
 ds_read_b64_tr_b16 a[232:233],v7 offset:32768
 buffer_load_dwordx4 v27,s[12:15],s34 offen offset:1024 sc1 nt lds
 v_mfma_f32_16x16x32_bf16 v[84:87],a[192:195],v[80:83],v[232:235]
 v_exp_f32 v141,v141
 v_mfma_f32_16x16x32_bf16 v[84:87],a[196:199],v[112:115],v[84:87]
 buffer_load_dwordx4 v28,s[12:15],s34 offen offset:2048 sc1 nt lds
 v_cvt_pk_bf16_f32 v209,v134,v135
 v_mfma_f32_16x16x32_bf16 v[84:87],a[200:203],v[144:147],v[84:87]
 v_exp_f32 v142,v142
 v_mfma_f32_16x16x32_bf16 v[84:87],a[204:207],v[176:179],v[84:87]
 s_waitcnt lgkmcnt(8)
 ds_read_b64_tr_b16 a[234:235],v7 offset:36864
 buffer_load_dwordx4 v29,s[12:15],s34 offen offset:3072 sc1 nt lds
 v_mfma_f32_16x16x32_bf16 v[100:103],a[208:211],v[64:67],v[224:227]
 s_waitcnt lgkmcnt(8)
 v_exp_f32 v143,v143
 v_mfma_f32_16x16x32_bf16 v[100:103],a[212:215],v[96:99],v[100:103]
 s_waitcnt lgkmcnt(7)
 ds_read_b128 a[192:195],v2 offset:57344
 v_cvt_pk_bf16_f32 v212,v140,v141
 v_mfma_f32_16x16x32_bf16 v[100:103],a[216:219],v[128:131],v[100:103]
 s_waitcnt lgkmcnt(7)
 v_exp_f32 v148,v148
 v_mfma_f32_16x16x32_bf16 v[100:103],a[220:223],v[160:163],v[100:103]
 s_add_u32 s34,s27,8192
 s_mov_b32 m0,40960
 ds_read_b128 a[196:199],v3 offset:57344
 ds_read_b128 a[200:203],v4 offset:57344
 v_mfma_f32_16x16x32_bf16 v[108:111],a[208:211],v[72:75],v[228:231]
 ds_read_b128 a[204:207],v5 offset:57344
 buffer_load_dwordx4 v26,s[12:15],s34 offen offset:0 sc1 nt lds
 v_mfma_f32_16x16x32_bf16 v[108:111],a[212:215],v[104:107],v[108:111]
 v_exp_f32 v149,v149
 v_cvt_pk_bf16_f32 v213,v142,v143
 v_mfma_f32_16x16x32_bf16 v[108:111],a[216:219],v[136:139],v[108:111]
 v_exp_f32 v150,v150
 v_mfma_f32_16x16x32_bf16 v[108:111],a[220:223],v[168:171],v[108:111]
 ds_read_b64_tr_b16 a[236:237],v7 offset:40960
 buffer_load_dwordx4 v27,s[12:15],s34 offen offset:1024 sc1 nt lds
 v_mfma_f32_16x16x32_bf16 v[116:119],a[208:211],v[80:83],v[232:235]
 v_exp_f32 v151,v151
 v_mfma_f32_16x16x32_bf16 v[116:119],a[212:215],v[112:115],v[116:119]
 buffer_load_dwordx4 v28,s[12:15],s34 offen offset:2048 sc1 nt lds
 v_cvt_pk_bf16_f32 v216,v148,v149
 v_mfma_f32_16x16x32_bf16 v[116:119],a[216:219],v[144:147],v[116:119]
 v_exp_f32 v164,v164
 v_mfma_f32_16x16x32_bf16 v[116:119],a[220:223],v[176:179],v[116:119]
 s_waitcnt lgkmcnt(4)
 ds_read_b64_tr_b16 a[238:239],v7 offset:45056
 buffer_load_dwordx4 v29,s[12:15],s34 offen offset:3072 sc1 nt lds
 v_mfma_f32_16x16x32_bf16 v[132:135],a[192:195],v[64:67],v[224:227]
 s_waitcnt lgkmcnt(4)
 v_exp_f32 v165,v165
 v_mfma_f32_16x16x32_bf16 v[132:135],a[196:199],v[96:99],v[132:135]
 s_waitcnt lgkmcnt(3)
 ds_read_b128 a[208:211],v2 offset:61440
 v_cvt_pk_bf16_f32 v217,v150,v151
 v_mfma_f32_16x16x32_bf16 v[132:135],a[200:203],v[128:131],v[132:135]
 s_waitcnt lgkmcnt(3)
 s_add_u32 s34,s27,12288
 s_mov_b32 m0,45056
 ds_read_b128 a[212:215],v3 offset:61440
 v_mfma_f32_16x16x32_bf16 v[132:135],a[204:207],v[160:163],v[132:135]
 ds_read_b128 a[216:219],v4 offset:61440
 buffer_load_dwordx4 v26,s[12:15],s34 offen offset:0 sc1 nt lds
 v_mfma_f32_16x16x32_bf16 v[140:143],a[192:195],v[72:75],v[228:231]
 ds_read_b128 a[220:223],v5 offset:61440
 buffer_load_dwordx4 v27,s[12:15],s34 offen offset:1024 sc1 nt lds
 v_mfma_f32_16x16x32_bf16 v[140:143],a[196:199],v[104:107],v[140:143]
 v_exp_f32 v166,v166
 v_mfma_f32_16x16x32_bf16 v[140:143],a[200:203],v[136:139],v[140:143]
 v_exp_f32 v167,v167
 v_cvt_pk_bf16_f32 v210,v164,v165
 v_mfma_f32_16x16x32_bf16 v[140:143],a[204:207],v[168:171],v[140:143]
 v_exp_f32 v172,v172
 v_mfma_f32_16x16x32_bf16 v[148:151],a[192:195],v[80:83],v[232:235]
 v_exp_f32 v173,v173
 v_mfma_f32_16x16x32_bf16 v[148:151],a[196:199],v[112:115],v[148:151]
 s_add_u32 s27,s27,16384
 buffer_load_dwordx4 v28,s[12:15],s34 offen offset:2048 sc1 nt lds
 buffer_load_dwordx4 v29,s[12:15],s34 offen offset:3072 sc1 nt lds
 v_mfma_f32_16x16x32_bf16 v[148:151],a[200:203],v[144:147],v[148:151]
 s_add_u32 s34,s28,0
 s_mov_b32 m0,81920
 v_cvt_pk_bf16_f32 v211,v166,v167
 v_mfma_f32_16x16x32_bf16 v[148:151],a[204:207],v[176:179],v[148:151]
 s_waitcnt lgkmcnt(3)
 v_exp_f32 v174,v174
 v_mfma_f32_16x16x32_bf16 v[164:167],a[208:211],v[64:67],v[224:227]
 s_waitcnt lgkmcnt(2)
 v_exp_f32 v175,v175
 v_mfma_f32_16x16x32_bf16 v[164:167],a[212:215],v[96:99],v[164:167]
 s_waitcnt lgkmcnt(1)
 buffer_load_dwordx4 v30,s[16:19],s34 offen offset:0 sc1 nt lds
 v_cvt_pk_bf16_f32 v214,v172,v173
 v_mfma_f32_16x16x32_bf16 v[164:167],a[216:219],v[128:131],v[164:167]
 s_waitcnt lgkmcnt(0)
 v_exp_f32 v180,v180
 v_mfma_f32_16x16x32_bf16 v[164:167],a[220:223],v[160:163],v[164:167]
 v_exp_f32 v181,v181
 v_cvt_pk_bf16_f32 v215,v174,v175
 v_mfma_f32_16x16x32_bf16 v[172:175],a[208:211],v[72:75],v[228:231]
 ds_read_b64_tr_b16 a[240:241],v8 offset:32768
 buffer_load_dwordx4 v31,s[16:19],s34 offen offset:1024 sc1 nt lds
 v_mfma_f32_16x16x32_bf16 v[172:175],a[212:215],v[104:107],v[172:175]
 v_exp_f32 v182,v182
 v_mfma_f32_16x16x32_bf16 v[172:175],a[216:219],v[136:139],v[172:175]
 v_exp_f32 v183,v183
 v_mfma_f32_16x16x32_bf16 v[172:175],a[220:223],v[168:171],v[172:175]
 v_cvt_pk_bf16_f32 v218,v180,v181
 v_cvt_pk_bf16_f32 v219,v182,v183
 v_mfma_f32_16x16x32_bf16 v[180:183],a[208:211],v[80:83],v[232:235]
 ds_read_b64_tr_b16 a[242:243],v8 offset:36864
 buffer_load_dwordx4 v30,s[16:19],s34 offen offset:2048 sc1 nt lds
 v_mfma_f32_16x16x32_bf16 v[180:183],a[212:215],v[112:115],v[180:183]
 ds_read_b64_tr_b16 a[244:245],v8 offset:40960
 ds_read_b64_tr_b16 a[246:247],v8 offset:45056
 v_mfma_f32_16x16x32_bf16 v[180:183],a[216:219],v[144:147],v[180:183]
 buffer_load_dwordx4 v31,s[16:19],s34 offen offset:3072 sc1 nt lds
 s_add_u32 s34,s28,4096
 s_mov_b32 m0,86016
 v_mfma_f32_16x16x32_bf16 v[180:183],a[220:223],v[176:179],v[180:183]
 ds_read_b64_tr_b16 a[248:249],v9 offset:32768
 ds_read_b64_tr_b16 a[250:251],v9 offset:36864
 v_mfma_f32_16x16x32_bf16 a[0:3],a[224:227],v[192:195],a[0:3]
 ds_read_b64_tr_b16 a[252:253],v9 offset:40960
 buffer_load_dwordx4 v30,s[16:19],s34 offen offset:0 sc1 nt lds
 v_mfma_f32_16x16x32_bf16 a[0:3],a[228:231],v[208:211],a[0:3]
 v_exp_f32 v68,v68
 v_mfma_f32_16x16x32_bf16 a[4:7],a[224:227],v[196:199],a[4:7]
 v_exp_f32 v69,v69
 v_mfma_f32_16x16x32_bf16 a[4:7],a[228:231],v[212:215],a[4:7]
 ds_read_b64_tr_b16 a[254:255],v9 offset:45056
 buffer_load_dwordx4 v31,s[16:19],s34 offen offset:1024 sc1 nt lds
 v_mfma_f32_16x16x32_bf16 a[8:11],a[224:227],v[200:203],a[8:11]
 v_exp_f32 v70,v70
 v_mfma_f32_16x16x32_bf16 a[8:11],a[228:231],v[216:219],a[8:11]
 v_exp_f32 v71,v71
 v_mfma_f32_16x16x32_bf16 a[16:19],a[232:235],v[192:195],a[16:19]
 ds_read_b64_tr_b16 a[224:225],v10 offset:32768
 buffer_load_dwordx4 v30,s[16:19],s34 offen offset:2048 sc1 nt lds
 v_mfma_f32_16x16x32_bf16 a[16:19],a[236:239],v[208:211],a[16:19]
 ds_read_b64_tr_b16 a[226:227],v10 offset:36864
 v_cvt_pk_bf16_f32 v204,v68,v69
 v_mfma_f32_16x16x32_bf16 a[20:23],a[232:235],v[196:199],a[20:23]
 v_exp_f32 v100,v100
 v_mfma_f32_16x16x32_bf16 a[20:23],a[236:239],v[212:215],a[20:23]
 ds_read_b64_tr_b16 a[228:229],v10 offset:40960
 buffer_load_dwordx4 v31,s[16:19],s34 offen offset:3072 sc1 nt lds
 v_mfma_f32_16x16x32_bf16 a[24:27],a[232:235],v[200:203],a[24:27]
 s_add_u32 s34,s28,8192
 s_mov_b32 m0,90112
 ds_read_b64_tr_b16 a[230:231],v10 offset:45056
 v_mfma_f32_16x16x32_bf16 a[24:27],a[236:239],v[216:219],a[24:27]
 s_waitcnt lgkmcnt(10)
 ds_read_b64_tr_b16 a[232:233],v11 offset:32768
 buffer_load_dwordx4 v30,s[16:19],s34 offen offset:0 sc1 nt lds
 v_mfma_f32_16x16x32_bf16 a[32:35],a[240:243],v[192:195],a[32:35]
 s_waitcnt lgkmcnt(9)
 v_exp_f32 v101,v101
 v_mfma_f32_16x16x32_bf16 a[32:35],a[244:247],v[208:211],a[32:35]
 ds_read_b64_tr_b16 a[234:235],v11 offset:36864
 v_cvt_pk_bf16_f32 v205,v70,v71
 v_mfma_f32_16x16x32_bf16 a[36:39],a[240:243],v[196:199],a[36:39]
 ds_read_b64_tr_b16 a[236:237],v11 offset:40960
 buffer_load_dwordx4 v31,s[16:19],s34 offen offset:1024 sc1 nt lds
 v_mfma_f32_16x16x32_bf16 a[36:39],a[244:247],v[212:215],a[36:39]
 v_exp_f32 v102,v102
 v_mfma_f32_16x16x32_bf16 a[40:43],a[240:243],v[200:203],a[40:43]
 v_exp_f32 v103,v103
 v_mfma_f32_16x16x32_bf16 a[40:43],a[244:247],v[216:219],a[40:43]
 s_waitcnt lgkmcnt(9)
 buffer_load_dwordx4 v30,s[16:19],s34 offen offset:2048 sc1 nt lds
 v_cvt_pk_bf16_f32 v206,v100,v101
 v_mfma_f32_16x16x32_bf16 a[48:51],a[248:251],v[192:195],a[48:51]
 s_waitcnt lgkmcnt(7)
 ds_read_b64_tr_b16 a[238:239],v11 offset:45056
 ds_read_b64_tr_b16 a[240:241],v12 offset:32768
 v_mfma_f32_16x16x32_bf16 a[48:51],a[252:255],v[208:211],a[48:51]
 v_exp_f32 v76,v76
 v_mfma_f32_16x16x32_bf16 a[52:55],a[248:251],v[196:199],a[52:55]
 ds_read_b64_tr_b16 a[242:243],v12 offset:36864
 buffer_load_dwordx4 v31,s[16:19],s34 offen offset:3072 sc1 nt lds
 v_mfma_f32_16x16x32_bf16 a[52:55],a[252:255],v[212:215],a[52:55]
 v_exp_f32 v77,v77
 v_mfma_f32_16x16x32_bf16 a[56:59],a[248:251],v[200:203],a[56:59]
 s_add_u32 s34,s28,12288
 s_mov_b32 m0,94208
 v_cvt_pk_bf16_f32 v207,v102,v103
 v_mfma_f32_16x16x32_bf16 a[56:59],a[252:255],v[216:219],a[56:59]
 s_waitcnt lgkmcnt(8)
 ds_read_b64_tr_b16 a[244:245],v12 offset:40960
 buffer_load_dwordx4 v30,s[16:19],s34 offen offset:0 sc1 nt lds
 v_mfma_f32_16x16x32_bf16 a[64:67],a[224:227],v[192:195],a[64:67]
 s_waitcnt lgkmcnt(7)
 ds_read_b64_tr_b16 a[246:247],v12 offset:45056
 ds_read_b64_tr_b16 a[248:249],v13 offset:32768
 v_mfma_f32_16x16x32_bf16 a[64:67],a[228:231],v[208:211],a[64:67]
 ds_read_b64_tr_b16 a[250:251],v13 offset:36864
 buffer_load_dwordx4 v31,s[16:19],s34 offen offset:1024 sc1 nt lds
 v_mfma_f32_16x16x32_bf16 a[68:71],a[224:227],v[196:199],a[68:71]
 v_exp_f32 v78,v78
 v_mfma_f32_16x16x32_bf16 a[68:71],a[228:231],v[212:215],a[68:71]
 v_exp_f32 v79,v79
 v_mfma_f32_16x16x32_bf16 a[72:75],a[224:227],v[200:203],a[72:75]
 ds_read_b64_tr_b16 a[252:253],v13 offset:40960
 v_cvt_pk_bf16_f32 v220,v76,v77
 v_mfma_f32_16x16x32_bf16 a[72:75],a[228:231],v[216:219],a[72:75]
 s_waitcnt lgkmcnt(9)
 ds_read_b64_tr_b16 a[254:255],v13 offset:45056
 buffer_load_dwordx4 v30,s[16:19],s34 offen offset:2048 sc1 nt lds
 v_mfma_f32_16x16x32_bf16 a[80:83],a[232:235],v[192:195],a[80:83]
 s_waitcnt lgkmcnt(8)
 v_exp_f32 v108,v108
 v_mfma_f32_16x16x32_bf16 a[80:83],a[236:239],v[208:211],a[80:83]
 v_exp_f32 v109,v109
 v_mfma_f32_16x16x32_bf16 a[84:87],a[232:235],v[196:199],a[84:87]
 s_add_u32 s28,s28,16384
 buffer_load_dwordx4 v31,s[16:19],s34 offen offset:3072 sc1 nt lds
 v_cvt_pk_bf16_f32 v221,v78,v79
 v_mfma_f32_16x16x32_bf16 a[84:87],a[236:239],v[212:215],a[84:87]
 v_exp_f32 v110,v110
 v_mfma_f32_16x16x32_bf16 a[88:91],a[232:235],v[200:203],a[88:91]
 v_exp_f32 v111,v111
 v_mfma_f32_16x16x32_bf16 a[88:91],a[236:239],v[216:219],a[88:91]
 s_waitcnt vmcnt(63)
 s_waitcnt lgkmcnt(0)
 s_barrier
 v_mfma_f32_16x16x32_bf16 a[96:99],a[240:243],v[192:195],a[96:99]
 ds_read_b128 a[192:195],v2 offset:0
 v_cvt_pk_bf16_f32 v222,v108,v109
 v_mfma_f32_16x16x32_bf16 a[96:99],a[244:247],v[208:211],a[96:99]
 s_add_u32 s34,s27,0
 s_mov_b32 m0,49152
 ds_read_b128 a[196:199],v3 offset:0
 v_mfma_f32_16x16x32_bf16 a[100:103],a[240:243],v[196:199],a[100:103]
 ds_read_b128 a[200:203],v4 offset:0
 buffer_load_dwordx4 v26,s[12:15],s34 offen offset:0 sc1 nt lds
 v_mfma_f32_16x16x32_bf16 a[100:103],a[244:247],v[212:215],a[100:103]
 v_exp_f32 v84,v84
 v_mfma_f32_16x16x32_bf16 a[104:107],a[240:243],v[200:203],a[104:107]
 v_exp_f32 v85,v85
 v_mfma_f32_16x16x32_bf16 a[104:107],a[244:247],v[216:219],a[104:107]
 buffer_load_dwordx4 v27,s[12:15],s34 offen offset:1024 sc1 nt lds
 v_cvt_pk_bf16_f32 v223,v110,v111
 v_mfma_f32_16x16x32_bf16 a[112:115],a[248:251],v[192:195],a[112:115]
 v_exp_f32 v86,v86
 v_mfma_f32_16x16x32_bf16 a[112:115],a[252:255],v[208:211],a[112:115]
 v_exp_f32 v87,v87
 v_mfma_f32_16x16x32_bf16 a[116:119],a[248:251],v[196:199],a[116:119]
 buffer_load_dwordx4 v28,s[12:15],s34 offen offset:2048 sc1 nt lds
 v_cvt_pk_bf16_f32 v236,v84,v85
 v_mfma_f32_16x16x32_bf16 a[116:119],a[252:255],v[212:215],a[116:119]
 ds_read_b128 a[204:207],v5 offset:0
 ds_read_b128 a[208:211],v2 offset:4096
 v_mfma_f32_16x16x32_bf16 a[120:123],a[248:251],v[200:203],a[120:123]
 v_exp_f32 v116,v116
 v_mfma_f32_16x16x32_bf16 a[120:123],a[252:255],v[216:219],a[120:123]
 v_exp_f32 v117,v117
 v_mfma_f32_16x16x32_bf16 v[248:251],a[188:191],v[192:195],v[248:251]
 buffer_load_dwordx4 v29,s[12:15],s34 offen offset:3072 sc1 nt lds
 v_cvt_pk_bf16_f32 v237,v86,v87
 v_mfma_f32_16x16x32_bf16 v[248:251],a[188:191],v[208:211],v[248:251]
 ds_read_b128 a[212:215],v3 offset:4096
 ds_read_b128 a[216:219],v4 offset:4096
 v_mfma_f32_16x16x32_bf16 v[240:243],a[188:191],v[196:199],v[240:243]
 v_exp_f32 v118,v118
 v_mfma_f32_16x16x32_bf16 v[240:243],a[188:191],v[212:215],v[240:243]
 ds_read_b128 a[220:223],v5 offset:4096
 buffer_atomic_add v1,v253,s[40:43],s98 offen sc1
 v_mfma_f32_16x16x32_bf16 v[244:247],a[188:191],v[200:203],v[244:247]
 v_exp_f32 v119,v119
 v_mfma_f32_16x16x32_bf16 v[244:247],a[188:191],v[216:219],v[244:247]
 s_waitcnt lgkmcnt(7)
 v_cvt_pk_bf16_f32 v238,v116,v117
 v_cvt_pk_bf16_f32 v239,v118,v119
 v_mfma_f32_16x16x32_bf16 v[68:71],a[192:195],v[64:67],v[224:227]
 s_waitcnt lgkmcnt(6)
 ds_read_b64_tr_b16 a[224:225],v6 offset:49152
 v_exp_f32 v132,v132
 v_mfma_f32_16x16x32_bf16 v[68:71],a[196:199],v[96:99],v[68:71]
 s_waitcnt lgkmcnt(6)
 v_exp_f32 v133,v133
 v_mfma_f32_16x16x32_bf16 v[68:71],a[200:203],v[128:131],v[68:71]
 s_waitcnt lgkmcnt(5)
 ds_read_b64_tr_b16 a[226:227],v6 offset:53248
 v_exp_f32 v134,v134
 v_mfma_f32_16x16x32_bf16 v[68:71],a[204:207],v[160:163],v[68:71]
 s_add_u32 s34,s27,4096
 s_mov_b32 m0,53248
 ds_read_b64_tr_b16 a[228:229],v6 offset:57344
 v_mfma_f32_16x16x32_bf16 v[76:79],a[192:195],v[72:75],v[228:231]
 buffer_load_dwordx4 v26,s[12:15],s34 offen offset:0 sc1 nt lds
 v_exp_f32 v135,v135
 v_mfma_f32_16x16x32_bf16 v[76:79],a[196:199],v[104:107],v[76:79]
 ds_read_b64_tr_b16 a[230:231],v6 offset:61440
 v_cvt_pk_bf16_f32 v208,v132,v133
 v_mfma_f32_16x16x32_bf16 v[76:79],a[200:203],v[136:139],v[76:79]
 v_exp_f32 v140,v140
 v_mfma_f32_16x16x32_bf16 v[76:79],a[204:207],v[168:171],v[76:79]
 ds_read_b64_tr_b16 a[232:233],v7 offset:49152
 buffer_load_dwordx4 v27,s[12:15],s34 offen offset:1024 sc1 nt lds
 v_mfma_f32_16x16x32_bf16 v[84:87],a[192:195],v[80:83],v[232:235]
 v_exp_f32 v141,v141
 v_mfma_f32_16x16x32_bf16 v[84:87],a[196:199],v[112:115],v[84:87]
 buffer_load_dwordx4 v28,s[12:15],s34 offen offset:2048 sc1 nt lds
 v_cvt_pk_bf16_f32 v209,v134,v135
 v_mfma_f32_16x16x32_bf16 v[84:87],a[200:203],v[144:147],v[84:87]
 v_exp_f32 v142,v142
 v_mfma_f32_16x16x32_bf16 v[84:87],a[204:207],v[176:179],v[84:87]
 s_waitcnt lgkmcnt(8)
 ds_read_b64_tr_b16 a[234:235],v7 offset:53248
 buffer_load_dwordx4 v29,s[12:15],s34 offen offset:3072 sc1 nt lds
 v_mfma_f32_16x16x32_bf16 v[100:103],a[208:211],v[64:67],v[224:227]
 s_waitcnt lgkmcnt(8)
 v_exp_f32 v143,v143
 v_mfma_f32_16x16x32_bf16 v[100:103],a[212:215],v[96:99],v[100:103]
 s_waitcnt lgkmcnt(7)
 ds_read_b128 a[192:195],v2 offset:8192
 v_cvt_pk_bf16_f32 v212,v140,v141
 v_mfma_f32_16x16x32_bf16 v[100:103],a[216:219],v[128:131],v[100:103]
 s_waitcnt lgkmcnt(7)
 v_exp_f32 v148,v148
 v_mfma_f32_16x16x32_bf16 v[100:103],a[220:223],v[160:163],v[100:103]
 s_add_u32 s34,s27,8192
 s_mov_b32 m0,57344
 ds_read_b128 a[196:199],v3 offset:8192
 ds_read_b128 a[200:203],v4 offset:8192
 v_mfma_f32_16x16x32_bf16 v[108:111],a[208:211],v[72:75],v[228:231]
 ds_read_b128 a[204:207],v5 offset:8192
 buffer_load_dwordx4 v26,s[12:15],s34 offen offset:0 sc1 nt lds
 v_mfma_f32_16x16x32_bf16 v[108:111],a[212:215],v[104:107],v[108:111]
 v_exp_f32 v149,v149
 v_mfma_f32_16x16x32_bf16 v[108:111],a[216:219],v[136:139],v[108:111]
 buffer_load_dwordx4 v27,s[12:15],s34 offen offset:1024 sc1 nt lds
 v_cvt_pk_bf16_f32 v213,v142,v143
 v_mfma_f32_16x16x32_bf16 v[108:111],a[220:223],v[168:171],v[108:111]
 v_exp_f32 v150,v150
 v_mfma_f32_16x16x32_bf16 v[116:119],a[208:211],v[80:83],v[232:235]
 ds_read_b64_tr_b16 a[236:237],v7 offset:57344
 buffer_load_dwordx4 v28,s[12:15],s34 offen offset:2048 sc1 nt lds
 v_mfma_f32_16x16x32_bf16 v[116:119],a[212:215],v[112:115],v[116:119]
 v_exp_f32 v151,v151
 v_mfma_f32_16x16x32_bf16 v[116:119],a[216:219],v[144:147],v[116:119]
 ds_read_b64_tr_b16 a[238:239],v7 offset:61440
 v_cvt_pk_bf16_f32 v216,v148,v149
 v_mfma_f32_16x16x32_bf16 v[116:119],a[220:223],v[176:179],v[116:119]
 s_waitcnt lgkmcnt(5)
 v_exp_f32 v164,v164
 v_mfma_f32_16x16x32_bf16 v[132:135],a[192:195],v[64:67],v[224:227]
 s_waitcnt lgkmcnt(4)
 ds_read_b128 a[208:211],v2 offset:12288
 buffer_load_dwordx4 v29,s[12:15],s34 offen offset:3072 sc1 nt lds
 v_mfma_f32_16x16x32_bf16 v[132:135],a[196:199],v[96:99],v[132:135]
 s_waitcnt lgkmcnt(4)
 s_add_u32 s34,s27,12288
 s_mov_b32 m0,61440
 v_mfma_f32_16x16x32_bf16 v[132:135],a[200:203],v[128:131],v[132:135]
 s_waitcnt lgkmcnt(3)
 v_exp_f32 v165,v165
 v_cvt_pk_bf16_f32 v217,v150,v151
 v_mfma_f32_16x16x32_bf16 v[132:135],a[204:207],v[160:163],v[132:135]
 ds_read_b128 a[212:215],v3 offset:12288
 buffer_load_dwordx4 v26,s[12:15],s34 offen offset:0 sc1 nt lds
 v_mfma_f32_16x16x32_bf16 v[140:143],a[192:195],v[72:75],v[228:231]
 ds_read_b128 a[216:219],v4 offset:12288
 ds_read_b128 a[220:223],v5 offset:12288
 v_mfma_f32_16x16x32_bf16 v[140:143],a[196:199],v[104:107],v[140:143]
 v_exp_f32 v166,v166
 v_mfma_f32_16x16x32_bf16 v[140:143],a[200:203],v[136:139],v[140:143]
 buffer_load_dwordx4 v27,s[12:15],s34 offen offset:1024 sc1 nt lds
 v_exp_f32 v167,v167
 v_cvt_pk_bf16_f32 v210,v164,v165
 v_mfma_f32_16x16x32_bf16 v[140:143],a[204:207],v[168:171],v[140:143]
 v_exp_f32 v172,v172
 v_mfma_f32_16x16x32_bf16 v[148:151],a[192:195],v[80:83],v[232:235]
 v_exp_f32 v173,v173
 v_mfma_f32_16x16x32_bf16 v[148:151],a[196:199],v[112:115],v[148:151]
 s_add_u32 s27,s27,16384
 buffer_load_dwordx4 v28,s[12:15],s34 offen offset:2048 sc1 nt lds
 buffer_load_dwordx4 v29,s[12:15],s34 offen offset:3072 sc1 nt lds
 v_mfma_f32_16x16x32_bf16 v[148:151],a[200:203],v[144:147],v[148:151]
 s_add_u32 s34,s28,0
 s_mov_b32 m0,98304
 v_cvt_pk_bf16_f32 v211,v166,v167
 v_mfma_f32_16x16x32_bf16 v[148:151],a[204:207],v[176:179],v[148:151]
 s_waitcnt lgkmcnt(3)
 v_exp_f32 v174,v174
 v_mfma_f32_16x16x32_bf16 v[164:167],a[208:211],v[64:67],v[224:227]
 s_waitcnt lgkmcnt(2)
 v_exp_f32 v175,v175
 v_mfma_f32_16x16x32_bf16 v[164:167],a[212:215],v[96:99],v[164:167]
 s_waitcnt lgkmcnt(1)
 buffer_load_dwordx4 v30,s[16:19],s34 offen offset:0 sc1 nt lds
 v_cvt_pk_bf16_f32 v214,v172,v173
 v_mfma_f32_16x16x32_bf16 v[164:167],a[216:219],v[128:131],v[164:167]
 s_waitcnt lgkmcnt(0)
 v_exp_f32 v180,v180
 v_mfma_f32_16x16x32_bf16 v[164:167],a[220:223],v[160:163],v[164:167]
 v_exp_f32 v181,v181
 v_cvt_pk_bf16_f32 v215,v174,v175
 v_mfma_f32_16x16x32_bf16 v[172:175],a[208:211],v[72:75],v[228:231]
 ds_read_b64_tr_b16 a[240:241],v8 offset:49152
 buffer_load_dwordx4 v31,s[16:19],s34 offen offset:1024 sc1 nt lds
 v_mfma_f32_16x16x32_bf16 v[172:175],a[212:215],v[104:107],v[172:175]
 v_exp_f32 v182,v182
 v_mfma_f32_16x16x32_bf16 v[172:175],a[216:219],v[136:139],v[172:175]
 v_exp_f32 v183,v183
 v_mfma_f32_16x16x32_bf16 v[172:175],a[220:223],v[168:171],v[172:175]
 v_cvt_pk_bf16_f32 v218,v180,v181
 v_cvt_pk_bf16_f32 v219,v182,v183
 v_mfma_f32_16x16x32_bf16 v[180:183],a[208:211],v[80:83],v[232:235]
 ds_read_b64_tr_b16 a[242:243],v8 offset:53248
 buffer_load_dwordx4 v30,s[16:19],s34 offen offset:2048 sc1 nt lds
 v_mfma_f32_16x16x32_bf16 v[180:183],a[212:215],v[112:115],v[180:183]
 ds_read_b64_tr_b16 a[244:245],v8 offset:57344
 ds_read_b64_tr_b16 a[246:247],v8 offset:61440
 v_mfma_f32_16x16x32_bf16 v[180:183],a[216:219],v[144:147],v[180:183]
 buffer_load_dwordx4 v31,s[16:19],s34 offen offset:3072 sc1 nt lds
 s_add_u32 s34,s28,4096
 s_mov_b32 m0,102400
 v_mfma_f32_16x16x32_bf16 v[180:183],a[220:223],v[176:179],v[180:183]
 ds_read_b64_tr_b16 a[248:249],v9 offset:49152
 ds_read_b64_tr_b16 a[250:251],v9 offset:53248
 v_mfma_f32_16x16x32_bf16 a[0:3],a[224:227],v[204:207],a[0:3]
 ds_read_b64_tr_b16 a[252:253],v9 offset:57344
 buffer_load_dwordx4 v30,s[16:19],s34 offen offset:0 sc1 nt lds
 v_mfma_f32_16x16x32_bf16 a[0:3],a[228:231],v[208:211],a[0:3]
 v_exp_f32 v68,v68
 v_mfma_f32_16x16x32_bf16 a[4:7],a[224:227],v[220:223],a[4:7]
 v_exp_f32 v69,v69
 v_mfma_f32_16x16x32_bf16 a[4:7],a[228:231],v[212:215],a[4:7]
 ds_read_b64_tr_b16 a[254:255],v9 offset:61440
 buffer_load_dwordx4 v31,s[16:19],s34 offen offset:1024 sc1 nt lds
 v_mfma_f32_16x16x32_bf16 a[8:11],a[224:227],v[236:239],a[8:11]
 v_exp_f32 v70,v70
 v_mfma_f32_16x16x32_bf16 a[8:11],a[228:231],v[216:219],a[8:11]
 v_exp_f32 v71,v71
 v_mfma_f32_16x16x32_bf16 a[16:19],a[232:235],v[204:207],a[16:19]
 ds_read_b64_tr_b16 a[224:225],v10 offset:49152
 buffer_load_dwordx4 v30,s[16:19],s34 offen offset:2048 sc1 nt lds
 v_mfma_f32_16x16x32_bf16 a[16:19],a[236:239],v[208:211],a[16:19]
 ds_read_b64_tr_b16 a[226:227],v10 offset:53248
 v_cvt_pk_bf16_f32 v192,v68,v69
 v_mfma_f32_16x16x32_bf16 a[20:23],a[232:235],v[220:223],a[20:23]
 v_exp_f32 v100,v100
 v_mfma_f32_16x16x32_bf16 a[20:23],a[236:239],v[212:215],a[20:23]
 ds_read_b64_tr_b16 a[228:229],v10 offset:57344
 buffer_load_dwordx4 v31,s[16:19],s34 offen offset:3072 sc1 nt lds
 v_mfma_f32_16x16x32_bf16 a[24:27],a[232:235],v[236:239],a[24:27]
 s_add_u32 s34,s28,8192
 s_mov_b32 m0,106496
 ds_read_b64_tr_b16 a[230:231],v10 offset:61440
 v_mfma_f32_16x16x32_bf16 a[24:27],a[236:239],v[216:219],a[24:27]
 s_waitcnt lgkmcnt(10)
 ds_read_b64_tr_b16 a[232:233],v11 offset:49152
 buffer_load_dwordx4 v30,s[16:19],s34 offen offset:0 sc1 nt lds
 v_mfma_f32_16x16x32_bf16 a[32:35],a[240:243],v[204:207],a[32:35]
 s_waitcnt lgkmcnt(9)
 v_exp_f32 v101,v101
 v_mfma_f32_16x16x32_bf16 a[32:35],a[244:247],v[208:211],a[32:35]
 ds_read_b64_tr_b16 a[234:235],v11 offset:53248
 v_cvt_pk_bf16_f32 v193,v70,v71
 v_mfma_f32_16x16x32_bf16 a[36:39],a[240:243],v[220:223],a[36:39]
 ds_read_b64_tr_b16 a[236:237],v11 offset:57344
 buffer_load_dwordx4 v31,s[16:19],s34 offen offset:1024 sc1 nt lds
 v_mfma_f32_16x16x32_bf16 a[36:39],a[244:247],v[212:215],a[36:39]
 v_exp_f32 v102,v102
 v_mfma_f32_16x16x32_bf16 a[40:43],a[240:243],v[236:239],a[40:43]
 v_exp_f32 v103,v103
 v_mfma_f32_16x16x32_bf16 a[40:43],a[244:247],v[216:219],a[40:43]
 s_waitcnt lgkmcnt(9)
 buffer_load_dwordx4 v30,s[16:19],s34 offen offset:2048 sc1 nt lds
 v_cvt_pk_bf16_f32 v194,v100,v101
 v_mfma_f32_16x16x32_bf16 a[48:51],a[248:251],v[204:207],a[48:51]
 s_waitcnt lgkmcnt(7)
 ds_read_b64_tr_b16 a[238:239],v11 offset:61440
 ds_read_b64_tr_b16 a[240:241],v12 offset:49152
 v_mfma_f32_16x16x32_bf16 a[48:51],a[252:255],v[208:211],a[48:51]
 v_exp_f32 v76,v76
 v_mfma_f32_16x16x32_bf16 a[52:55],a[248:251],v[220:223],a[52:55]
 ds_read_b64_tr_b16 a[242:243],v12 offset:53248
 buffer_load_dwordx4 v31,s[16:19],s34 offen offset:3072 sc1 nt lds
 v_mfma_f32_16x16x32_bf16 a[52:55],a[252:255],v[212:215],a[52:55]
 v_exp_f32 v77,v77
 v_mfma_f32_16x16x32_bf16 a[56:59],a[248:251],v[236:239],a[56:59]
 s_add_u32 s34,s28,12288
 s_mov_b32 m0,110592
 v_cvt_pk_bf16_f32 v195,v102,v103
 v_mfma_f32_16x16x32_bf16 a[56:59],a[252:255],v[216:219],a[56:59]
 s_waitcnt lgkmcnt(8)
 ds_read_b64_tr_b16 a[244:245],v12 offset:57344
 buffer_load_dwordx4 v30,s[16:19],s34 offen offset:0 sc1 nt lds
 v_mfma_f32_16x16x32_bf16 a[64:67],a[224:227],v[204:207],a[64:67]
 s_waitcnt lgkmcnt(7)
 ds_read_b64_tr_b16 a[246:247],v12 offset:61440
 ds_read_b64_tr_b16 a[248:249],v13 offset:49152
 v_mfma_f32_16x16x32_bf16 a[64:67],a[228:231],v[208:211],a[64:67]
 ds_read_b64_tr_b16 a[250:251],v13 offset:53248
 buffer_load_dwordx4 v31,s[16:19],s34 offen offset:1024 sc1 nt lds
 v_mfma_f32_16x16x32_bf16 a[68:71],a[224:227],v[220:223],a[68:71]
 v_exp_f32 v78,v78
 v_mfma_f32_16x16x32_bf16 a[68:71],a[228:231],v[212:215],a[68:71]
 v_exp_f32 v79,v79
 v_mfma_f32_16x16x32_bf16 a[72:75],a[224:227],v[236:239],a[72:75]
 ds_read_b64_tr_b16 a[252:253],v13 offset:57344
 v_cvt_pk_bf16_f32 v196,v76,v77
 v_mfma_f32_16x16x32_bf16 a[72:75],a[228:231],v[216:219],a[72:75]
 s_waitcnt lgkmcnt(9)
 ds_read_b64_tr_b16 a[254:255],v13 offset:61440
 buffer_load_dwordx4 v30,s[16:19],s34 offen offset:2048 sc1 nt lds
 v_mfma_f32_16x16x32_bf16 a[80:83],a[232:235],v[204:207],a[80:83]
 s_waitcnt lgkmcnt(8)
 v_exp_f32 v108,v108
 v_mfma_f32_16x16x32_bf16 a[80:83],a[236:239],v[208:211],a[80:83]
 v_exp_f32 v109,v109
 v_mfma_f32_16x16x32_bf16 a[84:87],a[232:235],v[220:223],a[84:87]
 s_add_u32 s28,s28,16384
 buffer_load_dwordx4 v31,s[16:19],s34 offen offset:3072 sc1 nt lds
 v_cvt_pk_bf16_f32 v197,v78,v79
 v_mfma_f32_16x16x32_bf16 a[84:87],a[236:239],v[212:215],a[84:87]
 v_exp_f32 v110,v110
 v_mfma_f32_16x16x32_bf16 a[88:91],a[232:235],v[236:239],a[88:91]
 v_exp_f32 v111,v111
 v_mfma_f32_16x16x32_bf16 a[88:91],a[236:239],v[216:219],a[88:91]
 s_waitcnt vmcnt(63)
 s_waitcnt lgkmcnt(0)
 s_barrier
 v_mfma_f32_16x16x32_bf16 a[96:99],a[240:243],v[204:207],a[96:99]
 ds_read_b128 a[192:195],v2 offset:16384
 v_cvt_pk_bf16_f32 v198,v108,v109
 v_mfma_f32_16x16x32_bf16 a[96:99],a[244:247],v[208:211],a[96:99]
 s_add_u32 s34,s27,0
 s_mov_b32 m0,0
 ds_read_b128 a[196:199],v3 offset:16384
 v_mfma_f32_16x16x32_bf16 a[100:103],a[240:243],v[220:223],a[100:103]
 ds_read_b128 a[200:203],v4 offset:16384
 buffer_load_dwordx4 v26,s[12:15],s34 offen offset:0 sc1 nt lds
 v_mfma_f32_16x16x32_bf16 a[100:103],a[244:247],v[212:215],a[100:103]
 v_exp_f32 v84,v84
 v_mfma_f32_16x16x32_bf16 a[104:107],a[240:243],v[236:239],a[104:107]
 v_exp_f32 v85,v85
 v_mfma_f32_16x16x32_bf16 a[104:107],a[244:247],v[216:219],a[104:107]
 buffer_load_dwordx4 v27,s[12:15],s34 offen offset:1024 sc1 nt lds
 v_cvt_pk_bf16_f32 v199,v110,v111
 v_mfma_f32_16x16x32_bf16 a[112:115],a[248:251],v[204:207],a[112:115]
 v_exp_f32 v86,v86
 v_mfma_f32_16x16x32_bf16 a[112:115],a[252:255],v[208:211],a[112:115]
 v_exp_f32 v87,v87
 v_mfma_f32_16x16x32_bf16 a[116:119],a[248:251],v[220:223],a[116:119]
 ds_read_b128 a[204:207],v5 offset:16384
 v_cvt_pk_bf16_f32 v200,v84,v85
 v_mfma_f32_16x16x32_bf16 a[116:119],a[252:255],v[212:215],a[116:119]
 v_exp_f32 v116,v116
 v_mfma_f32_16x16x32_bf16 a[120:123],a[248:251],v[236:239],a[120:123]
 ds_read_b128 a[208:211],v2 offset:20480
 ds_read_b128 a[212:215],v3 offset:20480
 v_mfma_f32_16x16x32_bf16 a[120:123],a[252:255],v[216:219],a[120:123]
 v_exp_f32 v117,v117
 v_mfma_f32_16x16x32_bf16 v[248:251],a[188:191],v[204:207],v[248:251]
 buffer_load_dwordx4 v28,s[12:15],s34 offen offset:2048 sc1 nt lds
 v_cvt_pk_bf16_f32 v201,v86,v87
 v_mfma_f32_16x16x32_bf16 v[248:251],a[188:191],v[208:211],v[248:251]
 v_exp_f32 v118,v118
 v_mfma_f32_16x16x32_bf16 v[240:243],a[188:191],v[220:223],v[240:243]
 ds_read_b128 a[216:219],v4 offset:20480
 ds_read_b128 a[220:223],v5 offset:20480
 v_mfma_f32_16x16x32_bf16 v[240:243],a[188:191],v[212:215],v[240:243]
 v_exp_f32 v119,v119
 v_mfma_f32_16x16x32_bf16 v[244:247],a[188:191],v[236:239],v[244:247]
 buffer_load_dwordx4 v29,s[12:15],s34 offen offset:3072 sc1 nt lds
 v_cvt_pk_bf16_f32 v202,v116,v117
 v_mfma_f32_16x16x32_bf16 v[244:247],a[188:191],v[216:219],v[244:247]
 s_waitcnt lgkmcnt(7)
 v_cvt_pk_bf16_f32 v203,v118,v119
 v_mfma_f32_16x16x32_bf16 v[68:71],a[192:195],v[64:67],v[224:227]
 s_waitcnt lgkmcnt(6)
 ds_read_b64_tr_b16 a[224:225],v6 offset:0
 v_exp_f32 v132,v132
 v_mfma_f32_16x16x32_bf16 v[68:71],a[196:199],v[96:99],v[68:71]
 s_waitcnt lgkmcnt(6)
 v_exp_f32 v133,v133
 v_mfma_f32_16x16x32_bf16 v[68:71],a[200:203],v[128:131],v[68:71]
 s_waitcnt lgkmcnt(5)
 ds_read_b64_tr_b16 a[226:227],v6 offset:4096
 v_exp_f32 v134,v134
 v_mfma_f32_16x16x32_bf16 v[68:71],a[204:207],v[160:163],v[68:71]
 s_add_u32 s34,s27,4096
 s_mov_b32 m0,4096
 ds_read_b64_tr_b16 a[228:229],v6 offset:8192
 v_mfma_f32_16x16x32_bf16 v[76:79],a[192:195],v[72:75],v[228:231]
 buffer_load_dwordx4 v26,s[12:15],s34 offen offset:0 sc1 nt lds
 v_exp_f32 v135,v135
 v_mfma_f32_16x16x32_bf16 v[76:79],a[196:199],v[104:107],v[76:79]
 ds_read_b64_tr_b16 a[230:231],v6 offset:12288
 v_cvt_pk_bf16_f32 v208,v132,v133
 v_mfma_f32_16x16x32_bf16 v[76:79],a[200:203],v[136:139],v[76:79]
 v_exp_f32 v140,v140
 v_mfma_f32_16x16x32_bf16 v[76:79],a[204:207],v[168:171],v[76:79]
 ds_read_b64_tr_b16 a[232:233],v7 offset:0
 buffer_load_dwordx4 v27,s[12:15],s34 offen offset:1024 sc1 nt lds
 v_mfma_f32_16x16x32_bf16 v[84:87],a[192:195],v[80:83],v[232:235]
 v_exp_f32 v141,v141
 v_mfma_f32_16x16x32_bf16 v[84:87],a[196:199],v[112:115],v[84:87]
 buffer_load_dwordx4 v28,s[12:15],s34 offen offset:2048 sc1 nt lds
 v_cvt_pk_bf16_f32 v209,v134,v135
 v_mfma_f32_16x16x32_bf16 v[84:87],a[200:203],v[144:147],v[84:87]
 v_exp_f32 v142,v142
 v_mfma_f32_16x16x32_bf16 v[84:87],a[204:207],v[176:179],v[84:87]
 s_waitcnt lgkmcnt(8)
 ds_read_b64_tr_b16 a[234:235],v7 offset:4096
 buffer_load_dwordx4 v29,s[12:15],s34 offen offset:3072 sc1 nt lds
 v_mfma_f32_16x16x32_bf16 v[100:103],a[208:211],v[64:67],v[224:227]
 s_waitcnt lgkmcnt(8)
 v_exp_f32 v143,v143
 v_mfma_f32_16x16x32_bf16 v[100:103],a[212:215],v[96:99],v[100:103]
 s_waitcnt lgkmcnt(7)
 ds_read_b128 a[192:195],v2 offset:24576
 v_cvt_pk_bf16_f32 v212,v140,v141
 v_mfma_f32_16x16x32_bf16 v[100:103],a[216:219],v[128:131],v[100:103]
 s_waitcnt lgkmcnt(7)
 v_exp_f32 v148,v148
 v_mfma_f32_16x16x32_bf16 v[100:103],a[220:223],v[160:163],v[100:103]
 s_add_u32 s34,s27,8192
 s_mov_b32 m0,8192
 ds_read_b128 a[196:199],v3 offset:24576
 ds_read_b128 a[200:203],v4 offset:24576
 v_mfma_f32_16x16x32_bf16 v[108:111],a[208:211],v[72:75],v[228:231]
 ds_read_b128 a[204:207],v5 offset:24576
 buffer_load_dwordx4 v26,s[12:15],s34 offen offset:0 sc1 nt lds
 v_mfma_f32_16x16x32_bf16 v[108:111],a[212:215],v[104:107],v[108:111]
 v_exp_f32 v149,v149
 v_mfma_f32_16x16x32_bf16 v[108:111],a[216:219],v[136:139],v[108:111]
 buffer_load_dwordx4 v27,s[12:15],s34 offen offset:1024 sc1 nt lds
 v_cvt_pk_bf16_f32 v213,v142,v143
 v_mfma_f32_16x16x32_bf16 v[108:111],a[220:223],v[168:171],v[108:111]
 v_exp_f32 v150,v150
 v_mfma_f32_16x16x32_bf16 v[116:119],a[208:211],v[80:83],v[232:235]
 ds_read_b64_tr_b16 a[236:237],v7 offset:8192
 buffer_load_dwordx4 v28,s[12:15],s34 offen offset:2048 sc1 nt lds
 v_mfma_f32_16x16x32_bf16 v[116:119],a[212:215],v[112:115],v[116:119]
 v_exp_f32 v151,v151
 v_mfma_f32_16x16x32_bf16 v[116:119],a[216:219],v[144:147],v[116:119]
 ds_read_b64_tr_b16 a[238:239],v7 offset:12288
 v_cvt_pk_bf16_f32 v216,v148,v149
 v_mfma_f32_16x16x32_bf16 v[116:119],a[220:223],v[176:179],v[116:119]
 s_waitcnt lgkmcnt(5)
 v_exp_f32 v164,v164
 v_mfma_f32_16x16x32_bf16 v[132:135],a[192:195],v[64:67],v[224:227]
 s_waitcnt lgkmcnt(4)
 ds_read_b128 a[208:211],v2 offset:28672
 buffer_load_dwordx4 v29,s[12:15],s34 offen offset:3072 sc1 nt lds
 v_mfma_f32_16x16x32_bf16 v[132:135],a[196:199],v[96:99],v[132:135]
 s_waitcnt lgkmcnt(4)
 s_add_u32 s34,s27,12288
 s_mov_b32 m0,12288
 v_mfma_f32_16x16x32_bf16 v[132:135],a[200:203],v[128:131],v[132:135]
 s_waitcnt lgkmcnt(3)
 v_exp_f32 v165,v165
 v_cvt_pk_bf16_f32 v217,v150,v151
 v_mfma_f32_16x16x32_bf16 v[132:135],a[204:207],v[160:163],v[132:135]
 ds_read_b128 a[212:215],v3 offset:28672
 buffer_load_dwordx4 v26,s[12:15],s34 offen offset:0 sc1 nt lds
 v_mfma_f32_16x16x32_bf16 v[140:143],a[192:195],v[72:75],v[228:231]
 ds_read_b128 a[216:219],v4 offset:28672
 ds_read_b128 a[220:223],v5 offset:28672
 v_mfma_f32_16x16x32_bf16 v[140:143],a[196:199],v[104:107],v[140:143]
 v_exp_f32 v166,v166
 v_mfma_f32_16x16x32_bf16 v[140:143],a[200:203],v[136:139],v[140:143]
 buffer_load_dwordx4 v27,s[12:15],s34 offen offset:1024 sc1 nt lds
 v_exp_f32 v167,v167
 v_cvt_pk_bf16_f32 v210,v164,v165
 v_mfma_f32_16x16x32_bf16 v[140:143],a[204:207],v[168:171],v[140:143]
 v_exp_f32 v172,v172
 v_mfma_f32_16x16x32_bf16 v[148:151],a[192:195],v[80:83],v[232:235]
 v_exp_f32 v173,v173
 v_mfma_f32_16x16x32_bf16 v[148:151],a[196:199],v[112:115],v[148:151]
 s_add_u32 s27,s27,16384
 buffer_load_dwordx4 v28,s[12:15],s34 offen offset:2048 sc1 nt lds
 buffer_load_dwordx4 v29,s[12:15],s34 offen offset:3072 sc1 nt lds
 v_mfma_f32_16x16x32_bf16 v[148:151],a[200:203],v[144:147],v[148:151]
 s_add_u32 s34,s28,0
 s_mov_b32 m0,114688
 v_cvt_pk_bf16_f32 v211,v166,v167
 v_mfma_f32_16x16x32_bf16 v[148:151],a[204:207],v[176:179],v[148:151]
 s_waitcnt lgkmcnt(3)
 v_exp_f32 v174,v174
 v_mfma_f32_16x16x32_bf16 v[164:167],a[208:211],v[64:67],v[224:227]
 s_waitcnt lgkmcnt(2)
 v_exp_f32 v175,v175
 v_mfma_f32_16x16x32_bf16 v[164:167],a[212:215],v[96:99],v[164:167]
 s_waitcnt lgkmcnt(1)
 buffer_load_dwordx4 v30,s[16:19],s34 offen offset:0 sc1 nt lds
 v_cvt_pk_bf16_f32 v214,v172,v173
 v_mfma_f32_16x16x32_bf16 v[164:167],a[216:219],v[128:131],v[164:167]
 s_waitcnt lgkmcnt(0)
 v_exp_f32 v180,v180
 v_mfma_f32_16x16x32_bf16 v[164:167],a[220:223],v[160:163],v[164:167]
 v_exp_f32 v181,v181
 v_cvt_pk_bf16_f32 v215,v174,v175
 v_mfma_f32_16x16x32_bf16 v[172:175],a[208:211],v[72:75],v[228:231]
 ds_read_b64_tr_b16 a[240:241],v8 offset:0
 buffer_load_dwordx4 v31,s[16:19],s34 offen offset:1024 sc1 nt lds
 v_mfma_f32_16x16x32_bf16 v[172:175],a[212:215],v[104:107],v[172:175]
 v_exp_f32 v182,v182
 v_mfma_f32_16x16x32_bf16 v[172:175],a[216:219],v[136:139],v[172:175]
 v_exp_f32 v183,v183
 v_mfma_f32_16x16x32_bf16 v[172:175],a[220:223],v[168:171],v[172:175]
 v_cvt_pk_bf16_f32 v218,v180,v181
 v_cvt_pk_bf16_f32 v219,v182,v183
 v_mfma_f32_16x16x32_bf16 v[180:183],a[208:211],v[80:83],v[232:235]
 ds_read_b64_tr_b16 a[242:243],v8 offset:4096
 buffer_load_dwordx4 v30,s[16:19],s34 offen offset:2048 sc1 nt lds
 v_mfma_f32_16x16x32_bf16 v[180:183],a[212:215],v[112:115],v[180:183]
 ds_read_b64_tr_b16 a[244:245],v8 offset:8192
 ds_read_b64_tr_b16 a[246:247],v8 offset:12288
 v_mfma_f32_16x16x32_bf16 v[180:183],a[216:219],v[144:147],v[180:183]
 buffer_load_dwordx4 v31,s[16:19],s34 offen offset:3072 sc1 nt lds
 s_add_u32 s34,s28,4096
 s_mov_b32 m0,118784
 v_mfma_f32_16x16x32_bf16 v[180:183],a[220:223],v[176:179],v[180:183]
 ds_read_b64_tr_b16 a[248:249],v9 offset:0
 ds_read_b64_tr_b16 a[250:251],v9 offset:4096
 v_mfma_f32_16x16x32_bf16 a[0:3],a[224:227],v[192:195],a[0:3]
 ds_read_b64_tr_b16 a[252:253],v9 offset:8192
 buffer_load_dwordx4 v30,s[16:19],s34 offen offset:0 sc1 nt lds
 v_mfma_f32_16x16x32_bf16 a[0:3],a[228:231],v[208:211],a[0:3]
 v_exp_f32 v68,v68
 v_mfma_f32_16x16x32_bf16 a[4:7],a[224:227],v[196:199],a[4:7]
 v_exp_f32 v69,v69
 v_mfma_f32_16x16x32_bf16 a[4:7],a[228:231],v[212:215],a[4:7]
 ds_read_b64_tr_b16 a[254:255],v9 offset:12288
 buffer_load_dwordx4 v31,s[16:19],s34 offen offset:1024 sc1 nt lds
 v_mfma_f32_16x16x32_bf16 a[8:11],a[224:227],v[200:203],a[8:11]
 v_exp_f32 v70,v70
 v_mfma_f32_16x16x32_bf16 a[8:11],a[228:231],v[216:219],a[8:11]
 v_exp_f32 v71,v71
 v_mfma_f32_16x16x32_bf16 a[16:19],a[232:235],v[192:195],a[16:19]
 ds_read_b64_tr_b16 a[224:225],v10 offset:0
 buffer_load_dwordx4 v30,s[16:19],s34 offen offset:2048 sc1 nt lds
 v_mfma_f32_16x16x32_bf16 a[16:19],a[236:239],v[208:211],a[16:19]
 ds_read_b64_tr_b16 a[226:227],v10 offset:4096
 v_cvt_pk_bf16_f32 v204,v68,v69
 v_mfma_f32_16x16x32_bf16 a[20:23],a[232:235],v[196:199],a[20:23]
 v_exp_f32 v100,v100
 v_mfma_f32_16x16x32_bf16 a[20:23],a[236:239],v[212:215],a[20:23]
 ds_read_b64_tr_b16 a[228:229],v10 offset:8192
 buffer_load_dwordx4 v31,s[16:19],s34 offen offset:3072 sc1 nt lds
 v_mfma_f32_16x16x32_bf16 a[24:27],a[232:235],v[200:203],a[24:27]
 s_add_u32 s34,s28,8192
 s_mov_b32 m0,122880
 ds_read_b64_tr_b16 a[230:231],v10 offset:12288
 v_mfma_f32_16x16x32_bf16 a[24:27],a[236:239],v[216:219],a[24:27]
 s_waitcnt lgkmcnt(10)
 ds_read_b64_tr_b16 a[232:233],v11 offset:0
 buffer_load_dwordx4 v30,s[16:19],s34 offen offset:0 sc1 nt lds
 v_mfma_f32_16x16x32_bf16 a[32:35],a[240:243],v[192:195],a[32:35]
 s_waitcnt lgkmcnt(9)
 v_exp_f32 v101,v101
 v_mfma_f32_16x16x32_bf16 a[32:35],a[244:247],v[208:211],a[32:35]
 ds_read_b64_tr_b16 a[234:235],v11 offset:4096
 v_cvt_pk_bf16_f32 v205,v70,v71
 v_mfma_f32_16x16x32_bf16 a[36:39],a[240:243],v[196:199],a[36:39]
 ds_read_b64_tr_b16 a[236:237],v11 offset:8192
 buffer_load_dwordx4 v31,s[16:19],s34 offen offset:1024 sc1 nt lds
 v_mfma_f32_16x16x32_bf16 a[36:39],a[244:247],v[212:215],a[36:39]
 v_exp_f32 v102,v102
 v_mfma_f32_16x16x32_bf16 a[40:43],a[240:243],v[200:203],a[40:43]
 v_exp_f32 v103,v103
 v_mfma_f32_16x16x32_bf16 a[40:43],a[244:247],v[216:219],a[40:43]
 s_waitcnt lgkmcnt(9)
 buffer_load_dwordx4 v30,s[16:19],s34 offen offset:2048 sc1 nt lds
 v_cvt_pk_bf16_f32 v206,v100,v101
 v_mfma_f32_16x16x32_bf16 a[48:51],a[248:251],v[192:195],a[48:51]
 s_waitcnt lgkmcnt(7)
 ds_read_b64_tr_b16 a[238:239],v11 offset:12288
 ds_read_b64_tr_b16 a[240:241],v12 offset:0
 v_mfma_f32_16x16x32_bf16 a[48:51],a[252:255],v[208:211],a[48:51]
 v_exp_f32 v76,v76
 v_mfma_f32_16x16x32_bf16 a[52:55],a[248:251],v[196:199],a[52:55]
 ds_read_b64_tr_b16 a[242:243],v12 offset:4096
 buffer_load_dwordx4 v31,s[16:19],s34 offen offset:3072 sc1 nt lds
 v_mfma_f32_16x16x32_bf16 a[52:55],a[252:255],v[212:215],a[52:55]
 v_exp_f32 v77,v77
 v_mfma_f32_16x16x32_bf16 a[56:59],a[248:251],v[200:203],a[56:59]
 s_add_u32 s34,s28,12288
 s_mov_b32 m0,126976
 v_cvt_pk_bf16_f32 v207,v102,v103
 v_mfma_f32_16x16x32_bf16 a[56:59],a[252:255],v[216:219],a[56:59]
 s_waitcnt lgkmcnt(8)
 ds_read_b64_tr_b16 a[244:245],v12 offset:8192
 buffer_load_dwordx4 v30,s[16:19],s34 offen offset:0 sc1 nt lds
 v_mfma_f32_16x16x32_bf16 a[64:67],a[224:227],v[192:195],a[64:67]
 s_waitcnt lgkmcnt(7)
 ds_read_b64_tr_b16 a[246:247],v12 offset:12288
 ds_read_b64_tr_b16 a[248:249],v13 offset:0
 v_mfma_f32_16x16x32_bf16 a[64:67],a[228:231],v[208:211],a[64:67]
 ds_read_b64_tr_b16 a[250:251],v13 offset:4096
 buffer_load_dwordx4 v31,s[16:19],s34 offen offset:1024 sc1 nt lds
 v_mfma_f32_16x16x32_bf16 a[68:71],a[224:227],v[196:199],a[68:71]
 v_exp_f32 v78,v78
 v_mfma_f32_16x16x32_bf16 a[68:71],a[228:231],v[212:215],a[68:71]
 v_exp_f32 v79,v79
 v_mfma_f32_16x16x32_bf16 a[72:75],a[224:227],v[200:203],a[72:75]
 ds_read_b64_tr_b16 a[252:253],v13 offset:8192
 v_cvt_pk_bf16_f32 v220,v76,v77
 v_mfma_f32_16x16x32_bf16 a[72:75],a[228:231],v[216:219],a[72:75]
 s_waitcnt lgkmcnt(9)
 ds_read_b64_tr_b16 a[254:255],v13 offset:12288
 buffer_load_dwordx4 v30,s[16:19],s34 offen offset:2048 sc1 nt lds
 v_mfma_f32_16x16x32_bf16 a[80:83],a[232:235],v[192:195],a[80:83]
 s_waitcnt lgkmcnt(8)
 v_exp_f32 v108,v108
 v_mfma_f32_16x16x32_bf16 a[80:83],a[236:239],v[208:211],a[80:83]
 v_exp_f32 v109,v109
 v_mfma_f32_16x16x32_bf16 a[84:87],a[232:235],v[196:199],a[84:87]
 s_add_u32 s28,s28,16384
 buffer_load_dwordx4 v31,s[16:19],s34 offen offset:3072 sc1 nt lds
 v_cvt_pk_bf16_f32 v221,v78,v79
 v_mfma_f32_16x16x32_bf16 a[84:87],a[236:239],v[212:215],a[84:87]
 v_exp_f32 v110,v110
 v_mfma_f32_16x16x32_bf16 a[88:91],a[232:235],v[200:203],a[88:91]
 v_exp_f32 v111,v111
 v_mfma_f32_16x16x32_bf16 a[88:91],a[236:239],v[216:219],a[88:91]
 s_waitcnt vmcnt(63)
 s_waitcnt lgkmcnt(0)
 s_barrier
 v_mfma_f32_16x16x32_bf16 a[96:99],a[240:243],v[192:195],a[96:99]
 ds_read_b128 a[192:195],v2 offset:32768
 v_cvt_pk_bf16_f32 v222,v108,v109
 v_mfma_f32_16x16x32_bf16 a[96:99],a[244:247],v[208:211],a[96:99]
 s_add_u32 s34,s27,0
 s_mov_b32 m0,16384
 ds_read_b128 a[196:199],v3 offset:32768
 v_mfma_f32_16x16x32_bf16 a[100:103],a[240:243],v[196:199],a[100:103]
 ds_read_b128 a[200:203],v4 offset:32768
 buffer_load_dwordx4 v26,s[12:15],s34 offen offset:0 sc1 nt lds
 v_mfma_f32_16x16x32_bf16 a[100:103],a[244:247],v[212:215],a[100:103]
 v_exp_f32 v84,v84
 v_mfma_f32_16x16x32_bf16 a[104:107],a[240:243],v[200:203],a[104:107]
 v_exp_f32 v85,v85
 v_mfma_f32_16x16x32_bf16 a[104:107],a[244:247],v[216:219],a[104:107]
 buffer_load_dwordx4 v27,s[12:15],s34 offen offset:1024 sc1 nt lds
 v_cvt_pk_bf16_f32 v223,v110,v111
 v_mfma_f32_16x16x32_bf16 a[112:115],a[248:251],v[192:195],a[112:115]
 v_exp_f32 v86,v86
 v_mfma_f32_16x16x32_bf16 a[112:115],a[252:255],v[208:211],a[112:115]
 v_exp_f32 v87,v87
 v_mfma_f32_16x16x32_bf16 a[116:119],a[248:251],v[196:199],a[116:119]
 ds_read_b128 a[204:207],v5 offset:32768
 v_cvt_pk_bf16_f32 v236,v84,v85
 v_mfma_f32_16x16x32_bf16 a[116:119],a[252:255],v[212:215],a[116:119]
 v_exp_f32 v116,v116
 v_mfma_f32_16x16x32_bf16 a[120:123],a[248:251],v[200:203],a[120:123]
 ds_read_b128 a[208:211],v2 offset:36864
 ds_read_b128 a[212:215],v3 offset:36864
 v_mfma_f32_16x16x32_bf16 a[120:123],a[252:255],v[216:219],a[120:123]
 v_exp_f32 v117,v117
 v_mfma_f32_16x16x32_bf16 v[248:251],a[188:191],v[192:195],v[248:251]
 buffer_load_dwordx4 v28,s[12:15],s34 offen offset:2048 sc1 nt lds
 v_cvt_pk_bf16_f32 v237,v86,v87
 v_mfma_f32_16x16x32_bf16 v[248:251],a[188:191],v[208:211],v[248:251]
 v_exp_f32 v118,v118
 v_mfma_f32_16x16x32_bf16 v[240:243],a[188:191],v[196:199],v[240:243]
 ds_read_b128 a[216:219],v4 offset:36864
 ds_read_b128 a[220:223],v5 offset:36864
 v_mfma_f32_16x16x32_bf16 v[240:243],a[188:191],v[212:215],v[240:243]
 v_exp_f32 v119,v119
 v_mfma_f32_16x16x32_bf16 v[244:247],a[188:191],v[200:203],v[244:247]
 buffer_load_dwordx4 v29,s[12:15],s34 offen offset:3072 sc1 nt lds
 v_cvt_pk_bf16_f32 v238,v116,v117
 v_mfma_f32_16x16x32_bf16 v[244:247],a[188:191],v[216:219],v[244:247]
 v_cvt_pk_bf16_f32 v239,v118,v119
 s_sub_u32 s32,s32,1
 s_cmp_eq_u32 s32,2
 s_cselect_b32 s98,s66,1073741824
 s_cmp_lg_u32 s32,0
 s_cbranch_scc1 K1_loopc
K1_tailc:
 s_cmp_lg_u32 s33,0
 s_cbranch_scc1 K1_finc
 s_waitcnt lgkmcnt(7)
 v_mfma_f32_16x16x32_bf16 v[68:71],a[192:195],v[64:67],v[224:227]
 s_waitcnt lgkmcnt(6)
 v_exp_f32 v132,v132
 v_mfma_f32_16x16x32_bf16 v[68:71],a[196:199],v[96:99],v[68:71]
 s_waitcnt lgkmcnt(5)
 ds_read_b64_tr_b16 a[224:225],v6 offset:16384
 ds_read_b64_tr_b16 a[226:227],v6 offset:20480
 v_mfma_f32_16x16x32_bf16 v[68:71],a[200:203],v[128:131],v[68:71]
 s_waitcnt lgkmcnt(6)
 v_exp_f32 v133,v133
 v_mfma_f32_16x16x32_bf16 v[68:71],a[204:207],v[160:163],v[68:71]
 s_add_u32 s34,s27,4096
 s_mov_b32 m0,20480
 ds_read_b64_tr_b16 a[228:229],v6 offset:24576
 v_mfma_f32_16x16x32_bf16 v[76:79],a[192:195],v[72:75],v[228:231]
 ds_read_b64_tr_b16 a[230:231],v6 offset:28672
 buffer_load_dwordx4 v26,s[12:15],s34 offen offset:0 sc1 nt lds
 v_mfma_f32_16x16x32_bf16 v[76:79],a[196:199],v[104:107],v[76:79]
 v_exp_f32 v134,v134
 v_mfma_f32_16x16x32_bf16 v[76:79],a[200:203],v[136:139],v[76:79]
 v_exp_f32 v135,v135
 v_mfma_f32_16x16x32_bf16 v[76:79],a[204:207],v[168:171],v[76:79]
 buffer_load_dwordx4 v27,s[12:15],s34 offen offset:1024 sc1 nt lds
 v_cvt_pk_bf16_f32 v208,v132,v133
 v_mfma_f32_16x16x32_bf16 v[84:87],a[192:195],v[80:83],v[232:235]
 v_exp_f32 v140,v140
 v_mfma_f32_16x16x32_bf16 v[84:87],a[196:199],v[112:115],v[84:87]
 ds_read_b64_tr_b16 a[232:233],v7 offset:16384
 ds_read_b64_tr_b16 a[234:235],v7 offset:20480
 v_mfma_f32_16x16x32_bf16 v[84:87],a[200:203],v[144:147],v[84:87]
 v_exp_f32 v141,v141
 v_mfma_f32_16x16x32_bf16 v[84:87],a[204:207],v[176:179],v[84:87]
 s_waitcnt lgkmcnt(9)
 buffer_load_dwordx4 v28,s[12:15],s34 offen offset:2048 sc1 nt lds
 v_cvt_pk_bf16_f32 v209,v134,v135
 v_mfma_f32_16x16x32_bf16 v[100:103],a[208:211],v[64:67],v[224:227]
 s_waitcnt lgkmcnt(8)
 v_exp_f32 v142,v142
 v_mfma_f32_16x16x32_bf16 v[100:103],a[212:215],v[96:99],v[100:103]
 s_waitcnt lgkmcnt(7)
 ds_read_b128 a[192:195],v2 offset:40960
 buffer_load_dwordx4 v29,s[12:15],s34 offen offset:3072 sc1 nt lds
 v_mfma_f32_16x16x32_bf16 v[100:103],a[216:219],v[128:131],v[100:103]
 s_waitcnt lgkmcnt(7)
 v_exp_f32 v143,v143
 v_mfma_f32_16x16x32_bf16 v[100:103],a[220:223],v[160:163],v[100:103]
 ds_read_b128 a[196:199],v3 offset:40960
 ds_read_b128 a[200:203],v4 offset:40960
 v_mfma_f32_16x16x32_bf16 v[108:111],a[208:211],v[72:75],v[228:231]
 s_add_u32 s34,s27,8192
 s_mov_b32 m0,24576
 ds_read_b128 a[204:207],v5 offset:40960
 v_mfma_f32_16x16x32_bf16 v[108:111],a[212:215],v[104:107],v[108:111]
 buffer_load_dwordx4 v26,s[12:15],s34 offen offset:0 sc1 nt lds
 v_cvt_pk_bf16_f32 v212,v140,v141
 v_mfma_f32_16x16x32_bf16 v[108:111],a[216:219],v[136:139],v[108:111]
 v_exp_f32 v148,v148
 v_mfma_f32_16x16x32_bf16 v[108:111],a[220:223],v[168:171],v[108:111]
 v_exp_f32 v149,v149
 v_mfma_f32_16x16x32_bf16 v[116:119],a[208:211],v[80:83],v[232:235]
 buffer_load_dwordx4 v27,s[12:15],s34 offen offset:1024 sc1 nt lds
 v_cvt_pk_bf16_f32 v213,v142,v143
 v_mfma_f32_16x16x32_bf16 v[116:119],a[212:215],v[112:115],v[116:119]
 v_exp_f32 v150,v150
 v_mfma_f32_16x16x32_bf16 v[116:119],a[216:219],v[144:147],v[116:119]
 ds_read_b64_tr_b16 a[236:237],v7 offset:24576
 ds_read_b64_tr_b16 a[238:239],v7 offset:28672
 v_mfma_f32_16x16x32_bf16 v[116:119],a[220:223],v[176:179],v[116:119]
 s_waitcnt lgkmcnt(5)
 v_exp_f32 v151,v151
 v_mfma_f32_16x16x32_bf16 v[132:135],a[192:195],v[64:67],v[224:227]
 s_waitcnt lgkmcnt(4)
 buffer_load_dwordx4 v28,s[12:15],s34 offen offset:2048 sc1 nt lds
 v_cvt_pk_bf16_f32 v216,v148,v149
 v_mfma_f32_16x16x32_bf16 v[132:135],a[196:199],v[96:99],v[132:135]
 s_waitcnt lgkmcnt(3)
 ds_read_b128 a[208:211],v2 offset:45056
 ds_read_b128 a[212:215],v3 offset:45056
 v_mfma_f32_16x16x32_bf16 v[132:135],a[200:203],v[128:131],v[132:135]
 s_waitcnt lgkmcnt(4)
 v_exp_f32 v164,v164
 v_mfma_f32_16x16x32_bf16 v[132:135],a[204:207],v[160:163],v[132:135]
 ds_read_b128 a[216:219],v4 offset:45056
 buffer_load_dwordx4 v29,s[12:15],s34 offen offset:3072 sc1 nt lds
 v_mfma_f32_16x16x32_bf16 v[140:143],a[192:195],v[72:75],v[228:231]
 v_exp_f32 v165,v165
 v_mfma_f32_16x16x32_bf16 v[140:143],a[196:199],v[104:107],v[140:143]
 ds_read_b128 a[220:223],v5 offset:45056
 v_cvt_pk_bf16_f32 v217,v150,v151
 v_mfma_f32_16x16x32_bf16 v[140:143],a[200:203],v[136:139],v[140:143]
 s_add_u32 s34,s27,12288
 s_mov_b32 m0,28672
 v_exp_f32 v166,v166
 v_exp_f32 v167,v167
 v_mfma_f32_16x16x32_bf16 v[140:143],a[204:207],v[168:171],v[140:143]
 buffer_load_dwordx4 v26,s[12:15],s34 offen offset:0 sc1 nt lds
 v_cvt_pk_bf16_f32 v210,v164,v165
 v_exp_f32 v172,v172
 v_mfma_f32_16x16x32_bf16 v[148:151],a[192:195],v[80:83],v[232:235]
 v_exp_f32 v173,v173
 v_mfma_f32_16x16x32_bf16 v[148:151],a[196:199],v[112:115],v[148:151]
 buffer_load_dwordx4 v27,s[12:15],s34 offen offset:1024 sc1 nt lds
 v_cvt_pk_bf16_f32 v211,v166,v167
 v_mfma_f32_16x16x32_bf16 v[148:151],a[200:203],v[144:147],v[148:151]
 v_exp_f32 v174,v174
 v_mfma_f32_16x16x32_bf16 v[148:151],a[204:207],v[176:179],v[148:151]
 s_waitcnt lgkmcnt(3)
 v_exp_f32 v175,v175
 v_mfma_f32_16x16x32_bf16 v[164:167],a[208:211],v[64:67],v[224:227]
 s_waitcnt lgkmcnt(2)
 buffer_load_dwordx4 v28,s[12:15],s34 offen offset:2048 sc1 nt lds
 v_cvt_pk_bf16_f32 v214,v172,v173
 v_mfma_f32_16x16x32_bf16 v[164:167],a[212:215],v[96:99],v[164:167]
 s_waitcnt lgkmcnt(1)
 v_exp_f32 v180,v180
 v_mfma_f32_16x16x32_bf16 v[164:167],a[216:219],v[128:131],v[164:167]
 s_waitcnt lgkmcnt(0)
 v_exp_f32 v181,v181
 v_mfma_f32_16x16x32_bf16 v[164:167],a[220:223],v[160:163],v[164:167]
 s_add_u32 s27,s27,16384
 buffer_load_dwordx4 v29,s[12:15],s34 offen offset:3072 sc1 nt lds
 v_cvt_pk_bf16_f32 v215,v174,v175
 v_mfma_f32_16x16x32_bf16 v[172:175],a[208:211],v[72:75],v[228:231]
 v_exp_f32 v182,v182
 v_mfma_f32_16x16x32_bf16 v[172:175],a[212:215],v[104:107],v[172:175]
 v_exp_f32 v183,v183
 v_mfma_f32_16x16x32_bf16 v[172:175],a[216:219],v[136:139],v[172:175]
 s_add_u32 s34,s28,12288
 s_add_u32 m0,s25,65536
 v_cvt_pk_bf16_f32 v218,v180,v181
 v_mfma_f32_16x16x32_bf16 v[172:175],a[220:223],v[168:171],v[172:175]
 buffer_load_dwordx4 v30,s[16:19],s34 offen offset:0 sc1 nt lds
 v_cvt_pk_bf16_f32 v219,v182,v183
 v_mfma_f32_16x16x32_bf16 v[180:183],a[208:211],v[80:83],v[232:235]
 ds_read_b64_tr_b16 a[240:241],v8 offset:16384
 ds_read_b64_tr_b16 a[242:243],v8 offset:20480
 v_mfma_f32_16x16x32_bf16 v[180:183],a[212:215],v[112:115],v[180:183]
 ds_read_b64_tr_b16 a[244:245],v8 offset:24576
 ds_read_b64_tr_b16 a[246:247],v8 offset:28672
 v_mfma_f32_16x16x32_bf16 v[180:183],a[216:219],v[144:147],v[180:183]
 ds_read_b64_tr_b16 a[248:249],v9 offset:16384
 buffer_load_dwordx4 v31,s[16:19],s34 offen offset:1024 sc1 nt lds
 v_mfma_f32_16x16x32_bf16 v[180:183],a[220:223],v[176:179],v[180:183]
 v_exp_f32 v68,v68
 v_mfma_f32_16x16x32_bf16 a[0:3],a[224:227],v[204:207],a[0:3]
 v_exp_f32 v69,v69
 v_mfma_f32_16x16x32_bf16 a[0:3],a[228:231],v[208:211],a[0:3]
 ds_read_b64_tr_b16 a[250:251],v9 offset:20480
 buffer_load_dwordx4 v30,s[16:19],s34 offen offset:2048 sc1 nt lds
 v_mfma_f32_16x16x32_bf16 a[4:7],a[224:227],v[220:223],a[4:7]
 v_exp_f32 v70,v70
 v_mfma_f32_16x16x32_bf16 a[4:7],a[228:231],v[212:215],a[4:7]
 v_exp_f32 v71,v71
 v_mfma_f32_16x16x32_bf16 a[8:11],a[224:227],v[236:239],a[8:11]
 s_add_u32 s28,s28,16384
 buffer_load_dwordx4 v31,s[16:19],s34 offen offset:3072 sc1 nt lds
 v_cvt_pk_bf16_f32 v192,v68,v69
 v_mfma_f32_16x16x32_bf16 a[8:11],a[228:231],v[216:219],a[8:11]
 ds_read_b64_tr_b16 a[252:253],v9 offset:24576
 ds_read_b64_tr_b16 a[254:255],v9 offset:28672
 v_mfma_f32_16x16x32_bf16 a[16:19],a[232:235],v[204:207],a[16:19]
 v_exp_f32 v100,v100
 v_mfma_f32_16x16x32_bf16 a[16:19],a[236:239],v[208:211],a[16:19]
 s_add_u32 m0,s26,131072
 ds_read_b64_tr_b16 a[224:225],v10 offset:16384
 ds_read_b64_tr_b16 a[226:227],v10 offset:20480
 v_mfma_f32_16x16x32_bf16 a[20:23],a[232:235],v[220:223],a[20:23]
 s_add_u32 s35,s30,0
 ds_read_b64_tr_b16 a[228:229],v10 offset:24576
 buffer_load_dwordx4 v34,s[4:7],s35 offen offset:0 lds
 v_mfma_f32_16x16x32_bf16 a[20:23],a[236:239],v[212:215],a[20:23]
 v_exp_f32 v101,v101
 v_mfma_f32_16x16x32_bf16 a[24:27],a[232:235],v[236:239],a[24:27]
 ds_read_b64_tr_b16 a[230:231],v10 offset:28672
 v_cvt_pk_bf16_f32 v193,v70,v71
 v_mfma_f32_16x16x32_bf16 a[24:27],a[236:239],v[216:219],a[24:27]
 s_waitcnt lgkmcnt(10)
 v_exp_f32 v102,v102
 v_mfma_f32_16x16x32_bf16 a[32:35],a[240:243],v[204:207],a[32:35]
 s_waitcnt lgkmcnt(8)
 v_exp_f32 v103,v103
 v_mfma_f32_16x16x32_bf16 a[32:35],a[244:247],v[208:211],a[32:35]
 s_add_u32 s35,s30,8192
 buffer_load_dwordx4 v35,s[4:7],s35 offen offset:1024 lds
 v_cvt_pk_bf16_f32 v194,v100,v101
 v_mfma_f32_16x16x32_bf16 a[36:39],a[240:243],v[220:223],a[36:39]
 ds_read_b64_tr_b16 a[232:233],v11 offset:16384
 ds_read_b64_tr_b16 a[234:235],v11 offset:20480
 v_mfma_f32_16x16x32_bf16 a[36:39],a[244:247],v[212:215],a[36:39]
 s_add_u32 s35,s30,16384
 ds_read_b64_tr_b16 a[236:237],v11 offset:24576
 buffer_load_dwordx4 v34,s[4:7],s35 offen offset:2048 lds
 v_mfma_f32_16x16x32_bf16 a[40:43],a[240:243],v[236:239],a[40:43]
 v_exp_f32 v76,v76
 v_mfma_f32_16x16x32_bf16 a[40:43],a[244:247],v[216:219],a[40:43]
 s_waitcnt lgkmcnt(9)
 ds_read_b64_tr_b16 a[238:239],v11 offset:28672
 ds_read_b64_tr_b16 a[240:241],v12 offset:16384
 v_mfma_f32_16x16x32_bf16 a[48:51],a[248:251],v[204:207],a[48:51]
 s_waitcnt lgkmcnt(9)
 v_exp_f32 v77,v77
 v_mfma_f32_16x16x32_bf16 a[48:51],a[252:255],v[208:211],a[48:51]
 s_add_u32 s35,s30,24576
 buffer_load_dwordx4 v35,s[4:7],s35 offen offset:3072 lds
 v_cvt_pk_bf16_f32 v195,v102,v103
 v_mfma_f32_16x16x32_bf16 a[52:55],a[248:251],v[220:223],a[52:55]
 s_add_u32 m0,s26,135168
 ds_read_b64_tr_b16 a[242:243],v12 offset:20480
 ds_read_b64_tr_b16 a[244:245],v12 offset:24576
 v_mfma_f32_16x16x32_bf16 a[52:55],a[252:255],v[212:215],a[52:55]
 v_exp_f32 v78,v78
 v_mfma_f32_16x16x32_bf16 a[56:59],a[248:251],v[236:239],a[56:59]
 s_add_u32 s35,s30,36864
 ds_read_b64_tr_b16 a[246:247],v12 offset:28672
 buffer_load_dwordx4 v34,s[4:7],s35 offen offset:0 lds
 v_mfma_f32_16x16x32_bf16 a[56:59],a[252:255],v[216:219],a[56:59]
 s_waitcnt lgkmcnt(10)
 v_exp_f32 v79,v79
 v_mfma_f32_16x16x32_bf16 a[64:67],a[224:227],v[204:207],a[64:67]
 s_waitcnt lgkmcnt(8)
 ds_read_b64_tr_b16 a[248:249],v13 offset:16384
 v_cvt_pk_bf16_f32 v196,v76,v77
 v_mfma_f32_16x16x32_bf16 a[64:67],a[228:231],v[208:211],a[64:67]
 s_add_u32 s35,s30,45056
 ds_read_b64_tr_b16 a[250:251],v13 offset:20480
 buffer_load_dwordx4 v35,s[4:7],s35 offen offset:1024 lds
 v_mfma_f32_16x16x32_bf16 a[68:71],a[224:227],v[220:223],a[68:71]
 v_exp_f32 v108,v108
 v_mfma_f32_16x16x32_bf16 a[68:71],a[228:231],v[212:215],a[68:71]
 s_mov_b32 m0,162816
 v_exp_f32 v109,v109
 v_mfma_f32_16x16x32_bf16 a[72:75],a[224:227],v[236:239],a[72:75]
 s_add_u32 s35,s29,1048576
 buffer_load_dwordx4 v38,s[8:11],s35 offen lds
 v_cvt_pk_bf16_f32 v197,v78,v79
 v_mfma_f32_16x16x32_bf16 a[72:75],a[228:231],v[216:219],a[72:75]
 s_waitcnt lgkmcnt(8)
 ds_read_b64_tr_b16 a[252:253],v13 offset:24576
 ds_read_b64_tr_b16 a[254:255],v13 offset:28672
 v_mfma_f32_16x16x32_bf16 a[80:83],a[232:235],v[204:207],a[80:83]
 s_waitcnt lgkmcnt(8)
 v_exp_f32 v110,v110
 v_mfma_f32_16x16x32_bf16 a[80:83],a[236:239],v[208:211],a[80:83]
 v_exp_f32 v111,v111
 v_mfma_f32_16x16x32_bf16 a[84:87],a[232:235],v[220:223],a[84:87]
 s_add_u32 s35,s29,1572864
 buffer_load_dwordx4 v38,s[8:11],s35 offen lds
 v_cvt_pk_bf16_f32 v198,v108,v109
 v_mfma_f32_16x16x32_bf16 a[84:87],a[236:239],v[212:215],a[84:87]
 v_exp_f32 v84,v84
 v_mfma_f32_16x16x32_bf16 a[88:91],a[232:235],v[236:239],a[88:91]
 v_exp_f32 v85,v85
 v_mfma_f32_16x16x32_bf16 a[88:91],a[236:239],v[216:219],a[88:91]
 s_waitcnt vmcnt(60)
 s_waitcnt lgkmcnt(0)
 s_barrier
 v_mfma_f32_16x16x32_bf16 a[96:99],a[240:243],v[204:207],a[96:99]
 s_mov_b32 m0,162816
 ds_read_b128 a[192:195],v2 offset:49152
 v_mfma_f32_16x16x32_bf16 a[96:99],a[244:247],v[208:211],a[96:99]
 s_add_u32 s35,s29,2097152
 buffer_load_dwordx4 v38,s[8:11],s35 offen lds
 v_cvt_pk_bf16_f32 v199,v110,v111
 v_mfma_f32_16x16x32_bf16 a[100:103],a[240:243],v[220:223],a[100:103]
 v_exp_f32 v86,v86
 v_mfma_f32_16x16x32_bf16 a[100:103],a[244:247],v[212:215],a[100:103]
 ds_read_b128 a[196:199],v3 offset:49152
 v_mfma_f32_16x16x32_bf16 a[104:107],a[240:243],v[236:239],a[104:107]
 ds_read_b128 a[200:203],v4 offset:49152
 v_mfma_f32_16x16x32_bf16 a[104:107],a[244:247],v[216:219],a[104:107]
 v_exp_f32 v87,v87
 v_mfma_f32_16x16x32_bf16 a[112:115],a[248:251],v[204:207],a[112:115]
 ds_read_b128 a[204:207],v5 offset:49152
 v_cvt_pk_bf16_f32 v200,v84,v85
 v_mfma_f32_16x16x32_bf16 a[112:115],a[252:255],v[208:211],a[112:115]
 v_exp_f32 v116,v116
 v_mfma_f32_16x16x32_bf16 a[116:119],a[248:251],v[220:223],a[116:119]
 ds_read_b128 a[208:211],v2 offset:53248
 v_mfma_f32_16x16x32_bf16 a[116:119],a[252:255],v[212:215],a[116:119]
 v_exp_f32 v117,v117
 v_mfma_f32_16x16x32_bf16 a[120:123],a[248:251],v[236:239],a[120:123]
 ds_read_b128 a[212:215],v3 offset:53248
 v_mfma_f32_16x16x32_bf16 a[120:123],a[252:255],v[216:219],a[120:123]
 v_cvt_pk_bf16_f32 v201,v86,v87
 v_mfma_f32_16x16x32_bf16 v[248:251],a[188:191],v[204:207],v[248:251]
 ds_read_b128 a[216:219],v4 offset:53248
 v_mfma_f32_16x16x32_bf16 v[248:251],a[188:191],v[208:211],v[248:251]
 v_exp_f32 v118,v118
 v_mfma_f32_16x16x32_bf16 v[240:243],a[188:191],v[220:223],v[240:243]
 v_exp_f32 v119,v119
 v_mfma_f32_16x16x32_bf16 v[240:243],a[188:191],v[212:215],v[240:243]
 s_add_u32 s35,s29,2621440
 ds_read_b128 a[220:223],v5 offset:53248
 buffer_load_dwordx4 v38,s[8:11],s35 offen lds
 v_mfma_f32_16x16x32_bf16 v[244:247],a[188:191],v[236:239],v[244:247]
 v_cvt_pk_bf16_f32 v202,v116,v117
 v_mfma_f32_16x16x32_bf16 v[244:247],a[188:191],v[216:219],v[244:247]
 s_waitcnt lgkmcnt(7)
 v_cvt_pk_bf16_f32 v203,v118,v119
 v_mfma_f32_16x16x32_bf16 v[68:71],a[192:195],v[64:67],v[224:227]
 s_waitcnt lgkmcnt(6)
 v_exp_f32 v132,v132
 v_mfma_f32_16x16x32_bf16 v[68:71],a[196:199],v[96:99],v[68:71]
 s_waitcnt lgkmcnt(5)
 ds_read_b64_tr_b16 a[224:225],v6 offset:32768
 ds_read_b64_tr_b16 a[226:227],v6 offset:36864
 v_mfma_f32_16x16x32_bf16 v[68:71],a[200:203],v[128:131],v[68:71]
 s_waitcnt lgkmcnt(6)
 v_exp_f32 v133,v133
 v_mfma_f32_16x16x32_bf16 v[68:71],a[204:207],v[160:163],v[68:71]
 v_exp_f32 v134,v134
 v_mfma_f32_16x16x32_bf16 v[76:79],a[192:195],v[72:75],v[228:231]
 ds_read_b64_tr_b16 a[228:229],v7 offset:32768
 ds_read_b64_tr_b16 a[230:231],v7 offset:36864
 v_mfma_f32_16x16x32_bf16 v[76:79],a[196:199],v[104:107],v[76:79]
 s_add_u32 m0,s25,81920
 v_exp_f32 v135,v135
 v_mfma_f32_16x16x32_bf16 v[76:79],a[200:203],v[136:139],v[76:79]
 s_add_u32 s34,s29,0
 ds_read_b64_tr_b16 a[232:233],v8 offset:32768
 buffer_load_dwordx4 v32,s[8:11],s34 offen offset:0 lds
 v_mfma_f32_16x16x32_bf16 v[76:79],a[204:207],v[168:171],v[76:79]
 ds_read_b64_tr_b16 a[234:235],v8 offset:36864
 v_cvt_pk_bf16_f32 v208,v132,v133
 v_mfma_f32_16x16x32_bf16 v[84:87],a[192:195],v[80:83],v[232:235]
 v_exp_f32 v164,v164
 v_mfma_f32_16x16x32_bf16 v[84:87],a[196:199],v[112:115],v[84:87]
 v_exp_f32 v165,v165
 v_mfma_f32_16x16x32_bf16 v[84:87],a[200:203],v[144:147],v[84:87]
 ds_read_b64_tr_b16 a[236:237],v9 offset:32768
 ds_read_b64_tr_b16 a[238:239],v9 offset:36864
 v_mfma_f32_16x16x32_bf16 v[84:87],a[204:207],v[176:179],v[84:87]
 s_waitcnt lgkmcnt(11)
 ds_read_b64_tr_b16 a[240:241],v10 offset:32768
 v_cvt_pk_bf16_f32 v209,v134,v135
 v_mfma_f32_16x16x32_bf16 v[100:103],a[208:211],v[64:67],v[224:227]
 s_waitcnt lgkmcnt(11)
 v_exp_f32 v166,v166
 v_mfma_f32_16x16x32_bf16 v[100:103],a[212:215],v[96:99],v[100:103]
 s_waitcnt lgkmcnt(10)
 v_exp_f32 v167,v167
 v_mfma_f32_16x16x32_bf16 v[100:103],a[216:219],v[128:131],v[100:103]
 s_waitcnt lgkmcnt(9)
 ds_read_b64_tr_b16 a[242:243],v10 offset:36864
 ds_read_b64_tr_b16 a[244:245],v11 offset:32768
 v_mfma_f32_16x16x32_bf16 v[100:103],a[220:223],v[160:163],v[100:103]
 ds_read_b64_tr_b16 a[246:247],v11 offset:36864
 v_cvt_pk_bf16_f32 v210,v164,v165
 v_mfma_f32_16x16x32_bf16 v[108:111],a[208:211],v[72:75],v[228:231]
 v_exp_f32 v140,v140
 v_mfma_f32_16x16x32_bf16 v[108:111],a[212:215],v[104:107],v[108:111]
 v_exp_f32 v141,v141
 v_mfma_f32_16x16x32_bf16 v[108:111],a[216:219],v[136:139],v[108:111]
 ds_read_b64_tr_b16 a[248:249],v12 offset:32768
 ds_read_b64_tr_b16 a[250:251],v12 offset:36864
 v_mfma_f32_16x16x32_bf16 v[108:111],a[220:223],v[168:171],v[108:111]
 s_add_u32 s34,s29,31744
 buffer_load_dwordx4 v32,s[8:11],s34 offen offset:1024 lds
 v_cvt_pk_bf16_f32 v211,v166,v167
 v_mfma_f32_16x16x32_bf16 v[116:119],a[208:211],v[80:83],v[232:235]
 v_exp_f32 v142,v142
 v_mfma_f32_16x16x32_bf16 v[116:119],a[212:215],v[112:115],v[116:119]
 ds_read_b64_tr_b16 a[252:253],v13 offset:32768
 ds_read_b64_tr_b16 a[254:255],v13 offset:36864
 v_mfma_f32_16x16x32_bf16 v[116:119],a[216:219],v[144:147],v[116:119]
 v_exp_f32 v143,v143
 v_mfma_f32_16x16x32_bf16 v[116:119],a[220:223],v[176:179],v[116:119]
 s_waitcnt lgkmcnt(14)
 v_cvt_pk_bf16_f32 v212,v140,v141
 v_mfma_f32_16x16x32_bf16 a[0:3],a[224:227],v[192:195],a[0:3]
 v_exp_f32 v172,v172
 v_mfma_f32_16x16x32_bf16 a[4:7],a[224:227],v[196:199],a[4:7]
 v_exp_f32 v173,v173
 v_mfma_f32_16x16x32_bf16 a[8:11],a[224:227],v[200:203],a[8:11]
 s_waitcnt lgkmcnt(12)
 v_cvt_pk_bf16_f32 v213,v142,v143
 v_mfma_f32_16x16x32_bf16 a[16:19],a[228:231],v[192:195],a[16:19]
 v_exp_f32 v174,v174
 v_mfma_f32_16x16x32_bf16 a[20:23],a[228:231],v[196:199],a[20:23]
 s_add_u32 s34,s29,63488
 ds_read_b128 a[192:195],v2 offset:57344
 buffer_load_dwordx4 v33,s[8:11],s34 offen offset:2048 lds
 v_mfma_f32_16x16x32_bf16 a[24:27],a[228:231],v[200:203],a[24:27]
 s_waitcnt lgkmcnt(11)
 v_exp_f32 v175,v175
 v_mfma_f32_16x16x32_bf16 a[32:35],a[232:235],v[192:195],a[32:35]
 ds_read_b128 a[196:199],v3 offset:57344
 v_cvt_pk_bf16_f32 v214,v172,v173
 v_mfma_f32_16x16x32_bf16 a[36:39],a[232:235],v[196:199],a[36:39]
 ds_read_b128 a[200:203],v4 offset:57344
 v_mfma_f32_16x16x32_bf16 a[40:43],a[232:235],v[200:203],a[40:43]
 s_waitcnt lgkmcnt(11)
 v_exp_f32 v148,v148
 v_mfma_f32_16x16x32_bf16 a[48:51],a[236:239],v[192:195],a[48:51]
 v_exp_f32 v149,v149
 v_mfma_f32_16x16x32_bf16 a[52:55],a[236:239],v[196:199],a[52:55]
 ds_read_b128 a[204:207],v5 offset:57344
 v_cvt_pk_bf16_f32 v215,v174,v175
 v_mfma_f32_16x16x32_bf16 a[56:59],a[236:239],v[200:203],a[56:59]
 s_waitcnt lgkmcnt(10)
 ds_read_b128 a[208:211],v2 offset:61440
 v_mfma_f32_16x16x32_bf16 a[64:67],a[240:243],v[192:195],a[64:67]
 v_exp_f32 v150,v150
 v_mfma_f32_16x16x32_bf16 a[68:71],a[240:243],v[196:199],a[68:71]
 v_exp_f32 v151,v151
 v_mfma_f32_16x16x32_bf16 a[72:75],a[240:243],v[200:203],a[72:75]
 s_waitcnt lgkmcnt(9)
 ds_read_b128 a[212:215],v3 offset:61440
 v_cvt_pk_bf16_f32 v216,v148,v149
 v_mfma_f32_16x16x32_bf16 a[80:83],a[244:247],v[192:195],a[80:83]
 s_add_u32 s34,s29,95232
 ds_read_b128 a[216:219],v4 offset:61440
 buffer_load_dwordx4 v33,s[8:11],s34 offen offset:3072 lds
 v_mfma_f32_16x16x32_bf16 a[84:87],a[244:247],v[196:199],a[84:87]
 v_exp_f32 v180,v180
 v_mfma_f32_16x16x32_bf16 a[88:91],a[244:247],v[200:203],a[88:91]
 s_waitcnt lgkmcnt(9)
 v_exp_f32 v181,v181
 v_mfma_f32_16x16x32_bf16 a[96:99],a[248:251],v[192:195],a[96:99]
 ds_read_b128 a[220:223],v5 offset:61440
 v_cvt_pk_bf16_f32 v217,v150,v151
 v_mfma_f32_16x16x32_bf16 a[100:103],a[248:251],v[196:199],a[100:103]
 v_exp_f32 v182,v182
 v_mfma_f32_16x16x32_bf16 a[104:107],a[248:251],v[200:203],a[104:107]
 s_waitcnt lgkmcnt(8)
 v_exp_f32 v183,v183
 v_mfma_f32_16x16x32_bf16 a[112:115],a[252:255],v[192:195],a[112:115]
 ds_read_b64_tr_b16 a[224:225],v6 offset:40960
 v_mfma_f32_16x16x32_bf16 a[116:119],a[252:255],v[196:199],a[116:119]
 v_cvt_pk_bf16_f32 v218,v180,v181
 v_mfma_f32_16x16x32_bf16 a[120:123],a[252:255],v[200:203],a[120:123]
 ds_read_b64_tr_b16 a[226:227],v6 offset:45056
 v_mfma_f32_16x16x32_bf16 v[248:251],a[188:191],v[192:195],v[248:251]
 v_mfma_f32_16x16x32_bf16 v[240:243],a[188:191],v[196:199],v[240:243]
 v_mfma_f32_16x16x32_bf16 v[244:247],a[188:191],v[200:203],v[244:247]
 s_waitcnt lgkmcnt(9)
 ds_read_b64_tr_b16 a[228:229],v7 offset:40960
 v_cvt_pk_bf16_f32 v219,v182,v183
 v_mfma_f32_16x16x32_bf16 v[132:135],a[192:195],v[64:67],v[224:227]
 s_waitcnt lgkmcnt(9)
 v_exp_f32 v68,v68
 v_mfma_f32_16x16x32_bf16 v[132:135],a[196:199],v[96:99],v[132:135]
 s_waitcnt lgkmcnt(8)
 v_exp_f32 v69,v69
 v_mfma_f32_16x16x32_bf16 v[132:135],a[200:203],v[128:131],v[132:135]
 s_waitcnt lgkmcnt(7)
 ds_read_b64_tr_b16 a[230:231],v7 offset:45056
 ds_read_b64_tr_b16 a[232:233],v8 offset:40960
 v_mfma_f32_16x16x32_bf16 v[132:135],a[204:207],v[160:163],v[132:135]
 s_mov_b32 m0,162816
 v_exp_f32 v70,v70
 v_mfma_f32_16x16x32_bf16 v[140:143],a[192:195],v[72:75],v[228:231]
 s_add_u32 s35,s29,3145728
 ds_read_b64_tr_b16 a[234:235],v8 offset:45056
 buffer_load_dwordx4 v38,s[8:11],s35 offen lds
 v_mfma_f32_16x16x32_bf16 v[140:143],a[196:199],v[104:107],v[140:143]
 v_exp_f32 v71,v71
 v_mfma_f32_16x16x32_bf16 v[140:143],a[200:203],v[136:139],v[140:143]
 ds_read_b64_tr_b16 a[236:237],v9 offset:40960
 v_cvt_pk_bf16_f32 v192,v68,v69
 v_mfma_f32_16x16x32_bf16 v[140:143],a[204:207],v[168:171],v[140:143]
 v_exp_f32 v100,v100
 v_mfma_f32_16x16x32_bf16 v[148:151],a[192:195],v[80:83],v[232:235]
 ds_read_b64_tr_b16 a[238:239],v9 offset:45056
 ds_read_b64_tr_b16 a[240:241],v10 offset:40960
 v_mfma_f32_16x16x32_bf16 v[148:151],a[196:199],v[112:115],v[148:151]
 v_exp_f32 v101,v101
 v_mfma_f32_16x16x32_bf16 v[148:151],a[200:203],v[144:147],v[148:151]
 ds_read_b64_tr_b16 a[242:243],v10 offset:45056
 v_cvt_pk_bf16_f32 v193,v70,v71
 v_mfma_f32_16x16x32_bf16 v[148:151],a[204:207],v[176:179],v[148:151]
 s_waitcnt lgkmcnt(13)
 v_exp_f32 v102,v102
 v_mfma_f32_16x16x32_bf16 v[164:167],a[208:211],v[64:67],v[224:227]
 s_waitcnt lgkmcnt(12)
 v_exp_f32 v103,v103
 v_mfma_f32_16x16x32_bf16 v[164:167],a[212:215],v[96:99],v[164:167]
 s_waitcnt lgkmcnt(11)
 ds_read_b64_tr_b16 a[244:245],v11 offset:40960
 v_cvt_pk_bf16_f32 v194,v100,v101
 v_mfma_f32_16x16x32_bf16 v[164:167],a[216:219],v[128:131],v[164:167]
 s_waitcnt lgkmcnt(11)
 v_exp_f32 v76,v76
 v_mfma_f32_16x16x32_bf16 v[164:167],a[220:223],v[160:163],v[164:167]
 ds_read_b64_tr_b16 a[246:247],v11 offset:45056
 ds_read_b64_tr_b16 a[248:249],v12 offset:40960
 v_mfma_f32_16x16x32_bf16 v[172:175],a[208:211],v[72:75],v[228:231]
 s_add_u32 s35,s29,3670016
 ds_read_b64_tr_b16 a[250:251],v12 offset:45056
 buffer_load_dwordx4 v38,s[8:11],s35 offen lds
 v_mfma_f32_16x16x32_bf16 v[172:175],a[212:215],v[104:107],v[172:175]
 v_exp_f32 v77,v77
 v_mfma_f32_16x16x32_bf16 v[172:175],a[216:219],v[136:139],v[172:175]
 ds_read_b64_tr_b16 a[252:253],v13 offset:40960
 v_cvt_pk_bf16_f32 v195,v102,v103
 v_mfma_f32_16x16x32_bf16 v[172:175],a[220:223],v[168:171],v[172:175]
 v_exp_f32 v78,v78
 v_mfma_f32_16x16x32_bf16 v[180:183],a[208:211],v[80:83],v[232:235]
 v_exp_f32 v79,v79
 v_mfma_f32_16x16x32_bf16 v[180:183],a[212:215],v[112:115],v[180:183]
 ds_read_b64_tr_b16 a[254:255],v13 offset:45056
 v_cvt_pk_bf16_f32 v196,v76,v77
 v_mfma_f32_16x16x32_bf16 v[180:183],a[216:219],v[144:147],v[180:183]
 v_exp_f32 v108,v108
 v_mfma_f32_16x16x32_bf16 v[180:183],a[220:223],v[176:179],v[180:183]
 s_waitcnt lgkmcnt(14)
 v_exp_f32 v109,v109
 v_mfma_f32_16x16x32_bf16 a[0:3],a[224:227],v[208:211],a[0:3]
 s_add_u32 s35,s29,4194304
 buffer_load_dwordx4 v38,s[8:11],s35 offen lds
 v_cvt_pk_bf16_f32 v197,v78,v79
 v_mfma_f32_16x16x32_bf16 a[4:7],a[224:227],v[212:215],a[4:7]
 v_exp_f32 v110,v110
 v_mfma_f32_16x16x32_bf16 a[8:11],a[224:227],v[216:219],a[8:11]
 s_waitcnt lgkmcnt(12)
 v_exp_f32 v111,v111
 v_mfma_f32_16x16x32_bf16 a[16:19],a[228:231],v[208:211],a[16:19]
 v_cvt_pk_bf16_f32 v198,v108,v109
 v_mfma_f32_16x16x32_bf16 a[20:23],a[228:231],v[212:215],a[20:23]
 v_exp_f32 v84,v84
 v_mfma_f32_16x16x32_bf16 a[24:27],a[228:231],v[216:219],a[24:27]
 s_waitcnt vmcnt(37)
 s_waitcnt lgkmcnt(0)
 s_barrier
 v_mfma_f32_16x16x32_bf16 a[32:35],a[232:235],v[208:211],a[32:35]
 ds_read_b64_tr_b16 a[192:193],v6 offset:49152
 ds_read_b64_tr_b16 a[194:195],v6 offset:53248
 v_mfma_f32_16x16x32_bf16 a[36:39],a[232:235],v[212:215],a[36:39]
 s_add_u32 m0,s26,32768
 v_exp_f32 v85,v85
 v_mfma_f32_16x16x32_bf16 a[40:43],a[232:235],v[216:219],a[40:43]
 ds_read_b64_tr_b16 a[196:197],v7 offset:49152
 ds_read_b64_tr_b16 a[198:199],v7 offset:53248
 v_mfma_f32_16x16x32_bf16 a[48:51],a[236:239],v[208:211],a[48:51]
 s_add_u32 s35,s30,128
 ds_read_b64_tr_b16 a[200:201],v8 offset:49152
 buffer_load_dwordx4 v34,s[4:7],s35 offen offset:0 lds
 v_mfma_f32_16x16x32_bf16 a[52:55],a[236:239],v[212:215],a[52:55]
 s_add_u32 s35,s30,8320
 ds_read_b64_tr_b16 a[202:203],v8 offset:53248
 buffer_load_dwordx4 v35,s[4:7],s35 offen offset:1024 lds
 v_mfma_f32_16x16x32_bf16 a[56:59],a[236:239],v[216:219],a[56:59]
 ds_read_b64_tr_b16 a[204:205],v9 offset:49152
 v_cvt_pk_bf16_f32 v199,v110,v111
 v_mfma_f32_16x16x32_bf16 a[64:67],a[240:243],v[208:211],a[64:67]
 s_add_u32 s35,s30,16512
 ds_read_b64_tr_b16 a[206:207],v9 offset:53248
 buffer_load_dwordx4 v34,s[4:7],s35 offen offset:2048 lds
 v_mfma_f32_16x16x32_bf16 a[68:71],a[240:243],v[212:215],a[68:71]
 s_add_u32 s35,s30,24704
 ds_read_b64_tr_b16 a[208:209],v10 offset:49152
 buffer_load_dwordx4 v35,s[4:7],s35 offen offset:3072 lds
 v_mfma_f32_16x16x32_bf16 a[72:75],a[240:243],v[216:219],a[72:75]
 v_exp_f32 v86,v86
 v_mfma_f32_16x16x32_bf16 a[80:83],a[244:247],v[208:211],a[80:83]
 s_add_u32 m0,s26,36864
 ds_read_b64_tr_b16 a[210:211],v10 offset:53248
 ds_read_b64_tr_b16 a[212:213],v11 offset:49152
 v_mfma_f32_16x16x32_bf16 a[84:87],a[244:247],v[212:215],a[84:87]
 s_add_u32 s35,s30,36992
 ds_read_b64_tr_b16 a[214:215],v11 offset:53248
 buffer_load_dwordx4 v34,s[4:7],s35 offen offset:0 lds
 v_mfma_f32_16x16x32_bf16 a[88:91],a[244:247],v[216:219],a[88:91]
 ds_read_b64_tr_b16 a[216:217],v12 offset:49152
 ds_read_b64_tr_b16 a[218:219],v12 offset:53248
 v_mfma_f32_16x16x32_bf16 a[96:99],a[248:251],v[208:211],a[96:99]
 s_add_u32 s35,s30,45184
 ds_read_b64_tr_b16 a[220:221],v13 offset:49152
 buffer_load_dwordx4 v35,s[4:7],s35 offen offset:1024 lds
 v_mfma_f32_16x16x32_bf16 a[100:103],a[248:251],v[212:215],a[100:103]
 v_exp_f32 v87,v87
 v_mfma_f32_16x16x32_bf16 a[104:107],a[248:251],v[216:219],a[104:107]
 ds_read_b64_tr_b16 a[222:223],v13 offset:53248
 v_cvt_pk_bf16_f32 v200,v84,v85
 v_mfma_f32_16x16x32_bf16 a[112:115],a[252:255],v[208:211],a[112:115]
 v_exp_f32 v116,v116
 v_mfma_f32_16x16x32_bf16 a[116:119],a[252:255],v[212:215],a[116:119]
 v_exp_f32 v117,v117
 v_mfma_f32_16x16x32_bf16 a[120:123],a[252:255],v[216:219],a[120:123]
 v_cvt_pk_bf16_f32 v201,v86,v87
 v_mfma_f32_16x16x32_bf16 v[248:251],a[188:191],v[208:211],v[248:251]
 v_exp_f32 v118,v118
 v_mfma_f32_16x16x32_bf16 v[240:243],a[188:191],v[212:215],v[240:243]
 v_exp_f32 v119,v119
 v_mfma_f32_16x16x32_bf16 v[244:247],a[188:191],v[216:219],v[244:247]
 s_waitcnt lgkmcnt(14)
 v_cvt_pk_bf16_f32 v202,v116,v117
 v_cvt_pk_bf16_f32 v203,v118,v119
 v_mfma_f32_16x16x32_bf16 a[0:3],a[192:195],v[192:195],a[0:3]
 ds_read_b64_tr_b16 a[224:225],v6 offset:57344
 v_exp_f32 v132,v132
 v_mfma_f32_16x16x32_bf16 a[4:7],a[192:195],v[196:199],a[4:7]
 ds_read_b64_tr_b16 a[226:227],v6 offset:61440
 ds_read_b64_tr_b16 a[228:229],v7 offset:57344
 v_exp_f32 v133,v133
 v_mfma_f32_16x16x32_bf16 a[8:11],a[192:195],v[200:203],a[8:11]
 s_waitcnt lgkmcnt(15)
 s_add_u32 m0,s25,98304
 ds_read_b64_tr_b16 a[230:231],v7 offset:61440
 v_exp_f32 v134,v134
 v_mfma_f32_16x16x32_bf16 a[16:19],a[196:199],v[192:195],a[16:19]
 s_add_u32 s34,s29,524288
 ds_read_b64_tr_b16 a[232:233],v8 offset:57344
 buffer_load_dwordx4 v32,s[8:11],s34 offen offset:0 lds
 v_mfma_f32_16x16x32_bf16 a[20:23],a[196:199],v[196:199],a[20:23]
 ds_read_b64_tr_b16 a[234:235],v8 offset:61440
 ds_read_b64_tr_b16 a[236:237],v9 offset:57344
 v_mfma_f32_16x16x32_bf16 a[24:27],a[196:199],v[200:203],a[24:27]
 s_waitcnt lgkmcnt(15)
 ds_read_b64_tr_b16 a[238:239],v9 offset:61440
 ds_read_b64_tr_b16 a[240:241],v10 offset:57344
 v_mfma_f32_16x16x32_bf16 a[32:35],a[200:203],v[192:195],a[32:35]
 v_exp_f32 v135,v135
 v_mfma_f32_16x16x32_bf16 a[36:39],a[200:203],v[196:199],a[36:39]
 ds_read_b64_tr_b16 a[242:243],v10 offset:61440
 ds_read_b64_tr_b16 a[244:245],v11 offset:57344
 v_mfma_f32_16x16x32_bf16 a[40:43],a[200:203],v[200:203],a[40:43]
 s_waitcnt lgkmcnt(15)
 ds_read_b64_tr_b16 a[246:247],v11 offset:61440
 ds_read_b64_tr_b16 a[248:249],v12 offset:57344
 v_mfma_f32_16x16x32_bf16 a[48:51],a[204:207],v[192:195],a[48:51]
 s_add_u32 s34,s29,556032
 ds_read_b64_tr_b16 a[250:251],v12 offset:61440
 buffer_load_dwordx4 v32,s[8:11],s34 offen offset:1024 lds
 v_mfma_f32_16x16x32_bf16 a[52:55],a[204:207],v[196:199],a[52:55]
 ds_read_b64_tr_b16 a[252:253],v13 offset:57344
 v_cvt_pk_bf16_f32 v208,v132,v133
 v_mfma_f32_16x16x32_bf16 a[56:59],a[204:207],v[200:203],a[56:59]
 s_waitcnt lgkmcnt(15)
 v_exp_f32 v164,v164
 v_mfma_f32_16x16x32_bf16 a[64:67],a[208:211],v[192:195],a[64:67]
 ds_read_b64_tr_b16 a[254:255],v13 offset:61440
 v_exp_f32 v165,v165
 v_mfma_f32_16x16x32_bf16 a[68:71],a[208:211],v[196:199],a[68:71]
 s_add_u32 s34,s29,587776
 buffer_load_dwordx4 v33,s[8:11],s34 offen offset:2048 lds
 v_cvt_pk_bf16_f32 v209,v134,v135
 v_mfma_f32_16x16x32_bf16 a[72:75],a[208:211],v[200:203],a[72:75]
 s_waitcnt lgkmcnt(15)
 v_exp_f32 v166,v166
 v_mfma_f32_16x16x32_bf16 a[80:83],a[212:215],v[192:195],a[80:83]
 v_exp_f32 v167,v167
 v_mfma_f32_16x16x32_bf16 a[84:87],a[212:215],v[196:199],a[84:87]
 s_add_u32 s34,s29,619520
 buffer_load_dwordx4 v33,s[8:11],s34 offen offset:3072 lds
 v_cvt_pk_bf16_f32 v210,v164,v165
 v_mfma_f32_16x16x32_bf16 a[88:91],a[212:215],v[200:203],a[88:91]
 s_waitcnt lgkmcnt(15)
 v_exp_f32 v140,v140
 v_mfma_f32_16x16x32_bf16 a[96:99],a[216:219],v[192:195],a[96:99]
 s_waitcnt vmcnt(13)
 s_waitcnt lgkmcnt(0)
 s_barrier
 ds_read_b128 a[128:131],v22 offset:0
 v_mfma_f32_16x16x32_bf16 a[100:103],a[216:219],v[196:199],a[100:103]
 v_exp_f32 v141,v141
 v_mfma_f32_16x16x32_bf16 a[104:107],a[216:219],v[200:203],a[104:107]
 ds_read_b128 a[144:147],v23 offset:0
 v_cvt_pk_bf16_f32 v211,v166,v167
 v_mfma_f32_16x16x32_bf16 a[112:115],a[220:223],v[192:195],a[112:115]
 v_exp_f32 v142,v142
 v_mfma_f32_16x16x32_bf16 a[116:119],a[220:223],v[196:199],a[116:119]
 v_exp_f32 v143,v143
 v_mfma_f32_16x16x32_bf16 a[120:123],a[220:223],v[200:203],a[120:123]
 ds_read_b128 a[132:135],v22 offset:2048
 v_cvt_pk_bf16_f32 v212,v140,v141
 v_mfma_f32_16x16x32_bf16 v[248:251],a[188:191],v[192:195],v[248:251]
 v_exp_f32 v172,v172
 v_mfma_f32_16x16x32_bf16 v[240:243],a[188:191],v[196:199],v[240:243]
 v_exp_f32 v173,v173
 v_mfma_f32_16x16x32_bf16 v[244:247],a[188:191],v[200:203],v[244:247]
 ds_read_b128 a[148:151],v23 offset:2048
 v_cvt_pk_bf16_f32 v213,v142,v143
 v_mfma_f32_16x16x32_bf16 a[0:3],a[224:227],v[208:211],a[0:3]
 ds_read_b128 a[136:139],v22 offset:4096
 ds_read_b128 a[152:155],v23 offset:4096
 v_mfma_f32_16x16x32_bf16 a[16:19],a[228:231],v[208:211],a[16:19]
 v_exp_f32 v174,v174
 v_mfma_f32_16x16x32_bf16 a[32:35],a[232:235],v[208:211],a[32:35]
 v_exp_f32 v175,v175
 v_cvt_pk_bf16_f32 v214,v172,v173
 v_mfma_f32_16x16x32_bf16 a[48:51],a[236:239],v[208:211],a[48:51]
 v_exp_f32 v148,v148
 v_mfma_f32_16x16x32_bf16 a[64:67],a[240:243],v[208:211],a[64:67]
 v_exp_f32 v149,v149
 v_cvt_pk_bf16_f32 v215,v174,v175
 v_mfma_f32_16x16x32_bf16 a[80:83],a[244:247],v[208:211],a[80:83]
 v_exp_f32 v150,v150
 v_mfma_f32_16x16x32_bf16 a[96:99],a[248:251],v[208:211],a[96:99]
 v_exp_f32 v151,v151
 v_mfma_f32_16x16x32_bf16 a[112:115],a[252:255],v[208:211],a[112:115]
 s_waitcnt lgkmcnt(0)
 s_add_u32 m0,s26,131072
 v_cvt_pk_bf16_f32 v216,v148,v149
 v_mfma_f32_16x16x32_bf16 a[4:7],a[224:227],v[212:215],a[4:7]
 s_add_u32 s35,s30,256
 buffer_load_dwordx4 v34,s[4:7],s35 offen offset:0 lds
 v_exp_f32 v180,v180
 v_mfma_f32_16x16x32_bf16 a[20:23],a[228:231],v[212:215],a[20:23]
 v_exp_f32 v181,v181
 v_mfma_f32_16x16x32_bf16 a[36:39],a[232:235],v[212:215],a[36:39]
 s_add_u32 s35,s30,8448
 buffer_load_dwordx4 v35,s[4:7],s35 offen offset:1024 lds
 v_cvt_pk_bf16_f32 v217,v150,v151
 v_mfma_f32_16x16x32_bf16 a[52:55],a[236:239],v[212:215],a[52:55]
 v_exp_f32 v182,v182
 v_mfma_f32_16x16x32_bf16 a[68:71],a[240:243],v[212:215],a[68:71]
 v_exp_f32 v183,v183
 v_mfma_f32_16x16x32_bf16 a[84:87],a[244:247],v[212:215],a[84:87]
 v_cvt_pk_bf16_f32 v218,v180,v181
 v_cvt_pk_bf16_f32 v219,v182,v183
 v_mfma_f32_16x16x32_bf16 a[100:103],a[248:251],v[212:215],a[100:103]
 ds_read_b64_tr_b16 a[192:193],v14 offset:16384
 ds_read_b64_tr_b16 a[194:195],v14 offset:17408
 v_mfma_f32_16x16x32_bf16 a[116:119],a[252:255],v[212:215],a[116:119]
 ds_read_b64_tr_b16 a[196:197],v14 offset:24576
 ds_read_b64_tr_b16 a[198:199],v14 offset:25600
 v_mfma_f32_16x16x32_bf16 v[248:251],a[188:191],v[208:211],v[248:251]
 s_add_u32 s35,s30,16640
 ds_read_b64_tr_b16 a[200:201],v15 offset:16384
 buffer_load_dwordx4 v34,s[4:7],s35 offen offset:2048 lds
 v_mfma_f32_16x16x32_bf16 v[240:243],a[188:191],v[212:215],v[240:243]
 ds_read_b64_tr_b16 a[202:203],v15 offset:17408
 ds_read_b64_tr_b16 a[204:205],v15 offset:24576
 v_mfma_f32_16x16x32_bf16 v[244:247],a[188:191],v[216:219],v[244:247]
 ds_read_b64_tr_b16 a[206:207],v15 offset:25600
 ds_read_b64_tr_b16 a[208:209],v16 offset:16384
 v_mfma_f32_16x16x32_bf16 a[8:11],a[224:227],v[216:219],a[8:11]
 s_add_u32 s35,s30,24832
 buffer_load_dwordx4 v35,s[4:7],s35 offen offset:3072 lds
 v_mfma_f32_16x16x32_bf16 a[24:27],a[228:231],v[216:219],a[24:27]
 ds_read_b64_tr_b16 a[210:211],v16 offset:17408
 v_mfma_f32_16x16x32_bf16 a[40:43],a[232:235],v[216:219],a[40:43]
 s_add_u32 m0,s26,135168
 v_mfma_f32_16x16x32_bf16 a[56:59],a[236:239],v[216:219],a[56:59]
 s_add_u32 s35,s30,37120
 ds_read_b64_tr_b16 a[212:213],v16 offset:24576
 buffer_load_dwordx4 v34,s[4:7],s35 offen offset:0 lds
 v_mfma_f32_16x16x32_bf16 a[72:75],a[240:243],v[216:219],a[72:75]
 v_mfma_f32_16x16x32_bf16 a[88:91],a[244:247],v[216:219],a[88:91]
 ds_read_b64_tr_b16 a[214:215],v16 offset:25600
 s_nop 0
 v_mfma_f32_16x16x32_bf16 a[104:107],a[248:251],v[216:219],a[104:107]
 s_add_u32 s35,s30,45312
 buffer_load_dwordx4 v35,s[4:7],s35 offen offset:1024 lds
 s_nop 0
 v_mfma_f32_16x16x32_bf16 a[120:123],a[252:255],v[216:219],a[120:123]
 s_mov_b32 s68,0x4e800000
 v_mov_b32 v249,v240
 v_mov_b32 v250,v244
 v_add_f32 v41,v248,v249
 v_add_f32 v41,v41,v250
 v_cmp_ngt_f32 vcc,s68,v41
 s_nop 0
 s_cbranch_vccnz K1_slowc
K1_backc:
 v_rcp_f32 v248,v248
 v_rcp_f32 v249,v249
 v_rcp_f32 v250,v250
 s_waitcnt lgkmcnt(10)
 v_mfma_f32_16x16x32_bf16 v[64:67],a[192:195],a[128:131],0
 s_waitcnt lgkmcnt(8)
 ds_read_b64_tr_b16 a[216:217],v17 offset:16384
 v_accvgpr_read_b32 v40,a0
 v_mfma_f32_16x16x32_bf16 v[64:67],a[196:199],a[144:147],v[64:67]
 s_waitcnt lgkmcnt(7)
 s_add_u32 m0,s25,114688
 ds_read_b64_tr_b16 a[218:219],v17 offset:17408
 v_accvgpr_read_b32 v41,a1
 v_mfma_f32_16x16x32_bf16 v[68:71],a[200:203],a[128:131],0
 s_waitcnt lgkmcnt(6)
 s_add_u32 s34,s29,1048576
 ds_read_b64_tr_b16 a[220:221],v17 offset:24576
 buffer_load_dwordx4 v32,s[8:11],s34 offen offset:0 lds
 v_accvgpr_read_b32 v42,a2
 v_accvgpr_read_b32 v43,a3
 v_mfma_f32_16x16x32_bf16 v[68:71],a[204:207],a[144:147],v[68:71]
 ds_read_b64_tr_b16 a[222:223],v17 offset:25600
 v_accvgpr_read_b32 v44,a16
 v_mfma_f32_16x16x32_bf16 v[72:75],a[192:195],a[132:135],0
 ds_read_b64_tr_b16 a[224:225],v18 offset:16384
 v_accvgpr_read_b32 v45,a17
 v_mfma_f32_16x16x32_bf16 v[72:75],a[196:199],a[148:151],v[72:75]
 s_add_u32 s34,s29,1080320
 ds_read_b64_tr_b16 a[226:227],v18 offset:17408
 buffer_load_dwordx4 v32,s[8:11],s34 offen offset:1024 lds
 v_accvgpr_read_b32 v46,a18
 v_mfma_f32_16x16x32_bf16 v[76:79],a[200:203],a[132:135],0
 ds_read_b64_tr_b16 a[228:229],v18 offset:24576
 ds_read_b64_tr_b16 a[230:231],v18 offset:25600
 s_waitcnt vmcnt(12)
 ds_read_b128 a[160:163],v24 offset:0
 v_accvgpr_read_b32 v47,a19
 v_mfma_f32_16x16x32_bf16 v[76:79],a[204:207],a[148:151],v[76:79]
 v_mul_f32 v40,v248,v40
 v_mul_f32 v41,v248,v41
 v_mfma_f32_16x16x32_bf16 v[80:83],a[192:195],a[136:139],0
 ds_read_b128 a[176:179],v25 offset:0
 v_mul_f32 v42,v248,v42
 v_mfma_f32_16x16x32_bf16 v[80:83],a[196:199],a[152:155],v[80:83]
 ds_read_b128 a[164:167],v24 offset:2048
 v_mul_f32 v43,v248,v43
 v_mfma_f32_16x16x32_bf16 v[84:87],a[200:203],a[136:139],0
 s_add_u32 s34,s29,1112064
 ds_read_b128 a[180:183],v25 offset:2048
 buffer_load_dwordx4 v33,s[8:11],s34 offen offset:2048 lds
 v_mul_f32 v44,v248,v44
 v_mul_f32 v45,v248,v45
 v_mfma_f32_16x16x32_bf16 v[84:87],a[204:207],a[152:155],v[84:87]
 s_waitcnt lgkmcnt(14)
 ds_read_b128 a[168:171],v24 offset:4096
 v_mul_f32 v46,v248,v46
 v_mfma_f32_16x16x32_bf16 v[96:99],a[208:211],a[128:131],0
 s_waitcnt lgkmcnt(13)
 ds_read_b128 a[184:187],v25 offset:4096
 v_mul_f32 v47,v248,v47
 v_mfma_f32_16x16x32_bf16 v[96:99],a[212:215],a[144:147],v[96:99]
 s_waitcnt lgkmcnt(12)
 ds_read_b64_tr_b16 a[232:233],v19 offset:16384
 v_cvt_pk_bf16_f32 v192,v40,v41
 v_mfma_f32_16x16x32_bf16 v[100:103],a[216:219],a[128:131],0
 s_waitcnt lgkmcnt(11)
 ds_read_b64_tr_b16 a[234:235],v19 offset:17408
 v_cvt_pk_bf16_f32 v193,v42,v43
 v_cvt_pk_bf16_f32 v194,v44,v45
 v_mfma_f32_16x16x32_bf16 v[100:103],a[220:223],a[144:147],v[100:103]
 s_add_u32 s34,s29,1143808
 ds_read_b64_tr_b16 a[236:237],v19 offset:24576
 buffer_load_dwordx4 v33,s[8:11],s34 offen offset:3072 lds
 v_cvt_pk_bf16_f32 v195,v46,v47
 v_mfma_f32_16x16x32_bf16 v[104:107],a[208:211],a[132:135],0
 ds_read_b64_tr_b16 a[238:239],v19 offset:25600
 v_accvgpr_read_b32 v40,a32
 v_mfma_f32_16x16x32_bf16 v[104:107],a[212:215],a[148:151],v[104:107]
 ds_read_b64_tr_b16 a[240:241],v20 offset:16384
 ds_read_b64_tr_b16 a[242:243],v20 offset:17408
 v_accvgpr_read_b32 v41,a33
 v_mfma_f32_16x16x32_bf16 v[108:111],a[216:219],a[132:135],0
 ds_read_b64_tr_b16 a[244:245],v20 offset:24576
 v_accvgpr_read_b32 v42,a34
 v_accvgpr_read_b32 v43,a35
 v_mfma_f32_16x16x32_bf16 v[108:111],a[220:223],a[148:151],v[108:111]
 ds_read_b64_tr_b16 a[246:247],v20 offset:25600
 s_waitcnt lgkmcnt(8)
 s_add_u32 m0,s26,32768
 v_accvgpr_read_b32 v44,a48
 v_mfma_f32_16x16x32_bf16 v[112:115],a[208:211],a[136:139],0
 ds_read_b64_tr_b16 a[248:249],v21 offset:16384
 v_accvgpr_read_b32 v45,a49
 v_mfma_f32_16x16x32_bf16 v[112:115],a[212:215],a[152:155],v[112:115]
 s_add_u32 s35,s30,384
 buffer_load_dwordx4 v34,s[4:7],s35 offen offset:0 lds
 v_accvgpr_read_b32 v46,a50
 v_mfma_f32_16x16x32_bf16 v[116:119],a[216:219],a[136:139],0
 ds_read_b64_tr_b16 a[250:251],v21 offset:17408
 v_accvgpr_read_b32 v47,a51
 v_mfma_f32_16x16x32_bf16 v[116:119],a[220:223],a[152:155],v[116:119]
 ds_read_b64_tr_b16 a[252:253],v21 offset:24576
 v_mul_f32 v40,v248,v40
 v_mfma_f32_16x16x32_bf16 v[128:131],a[224:227],a[128:131],0
 v_mul_f32 v41,v248,v41
 v_mul_f32 v42,v248,v42
 v_mfma_f32_16x16x32_bf16 v[128:131],a[228:231],a[144:147],v[128:131]
 s_waitcnt lgkmcnt(9)
 ds_read_b64_tr_b16 a[254:255],v21 offset:25600
 v_mul_f32 v43,v248,v43
 v_mfma_f32_16x16x32_bf16 v[132:135],a[232:235],a[128:131],0
 s_waitcnt lgkmcnt(8)
 v_mul_f32 v44,v248,v44
 v_mul_f32 v45,v248,v45
 v_mfma_f32_16x16x32_bf16 v[132:135],a[236:239],a[144:147],v[132:135]
 s_add_u32 s35,s30,8576
 buffer_load_dwordx4 v35,s[4:7],s35 offen offset:1024 lds
 v_mul_f32 v46,v248,v46
 v_mfma_f32_16x16x32_bf16 v[136:139],a[224:227],a[132:135],0
 v_mul_f32 v47,v248,v47
 v_cvt_pk_bf16_f32 v196,v40,v41
 v_mfma_f32_16x16x32_bf16 v[136:139],a[228:231],a[148:151],v[136:139]
 v_cvt_pk_bf16_f32 v197,v42,v43
 v_cvt_pk_bf16_f32 v198,v44,v45
 v_mfma_f32_16x16x32_bf16 v[140:143],a[232:235],a[132:135],0
 s_add_u32 s35,s30,16768
 buffer_load_dwordx4 v34,s[4:7],s35 offen offset:2048 lds
 v_cvt_pk_bf16_f32 v199,v46,v47
 v_mfma_f32_16x16x32_bf16 v[140:143],a[236:239],a[148:151],v[140:143]
 s_waitcnt vmcnt(13)
 s_waitcnt lgkmcnt(0)
 s_barrier
 v_accvgpr_read_b32 v40,a64
 v_mfma_f32_16x16x32_bf16 v[144:147],a[224:227],a[136:139],0
 ds_read_b64_tr_b16 a[192:193],v14 offset:32768
 v_accvgpr_read_b32 v41,a65
 v_mfma_f32_16x16x32_bf16 v[144:147],a[228:231],a[152:155],v[144:147]
 ds_read_b64_tr_b16 a[194:195],v14 offset:33792
 v_accvgpr_read_b32 v42,a66
 v_mfma_f32_16x16x32_bf16 v[148:151],a[232:235],a[136:139],0
 ds_read_b64_tr_b16 a[196:197],v14 offset:40960
 v_accvgpr_read_b32 v43,a67
 v_mfma_f32_16x16x32_bf16 v[148:151],a[236:239],a[152:155],v[148:151]
 ds_read_b64_tr_b16 a[198:199],v14 offset:41984
 v_accvgpr_read_b32 v44,a80
 v_mfma_f32_16x16x32_bf16 v[160:163],a[240:243],a[128:131],0
 s_add_u32 s35,s30,24960
 buffer_load_dwordx4 v35,s[4:7],s35 offen offset:3072 lds
 v_accvgpr_read_b32 v45,a81
 v_mfma_f32_16x16x32_bf16 v[160:163],a[244:247],a[144:147],v[160:163]
 ds_read_b64_tr_b16 a[200:201],v15 offset:32768
 v_accvgpr_read_b32 v46,a82
 v_mfma_f32_16x16x32_bf16 v[164:167],a[248:251],a[128:131],0
 ds_read_b64_tr_b16 a[202:203],v15 offset:33792
 v_accvgpr_read_b32 v47,a83
 v_mul_f32 v40,v248,v40
 v_mfma_f32_16x16x32_bf16 v[164:167],a[252:255],a[144:147],v[164:167]
 ds_read_b64_tr_b16 a[204:205],v15 offset:40960
 v_mul_f32 v41,v248,v41
 v_mfma_f32_16x16x32_bf16 v[168:171],a[240:243],a[132:135],0
 ds_read_b64_tr_b16 a[206:207],v15 offset:41984
 v_mul_f32 v42,v248,v42
 v_mfma_f32_16x16x32_bf16 v[168:171],a[244:247],a[148:151],v[168:171]
 s_add_u32 m0,s26,36864
 ds_read_b64_tr_b16 a[208:209],v16 offset:32768
 v_mul_f32 v43,v248,v43
 v_mfma_f32_16x16x32_bf16 v[172:175],a[248:251],a[132:135],0
 s_add_u32 s35,s30,37248
 buffer_load_dwordx4 v34,s[4:7],s35 offen offset:0 lds
 v_mul_f32 v44,v248,v44
 v_mul_f32 v45,v248,v45
 v_mfma_f32_16x16x32_bf16 v[172:175],a[252:255],a[148:151],v[172:175]
 ds_read_b64_tr_b16 a[210:211],v16 offset:33792
 v_mul_f32 v46,v248,v46
 v_mfma_f32_16x16x32_bf16 v[176:179],a[240:243],a[136:139],0
 ds_read_b64_tr_b16 a[212:213],v16 offset:40960
 v_mul_f32 v47,v248,v47
 v_mfma_f32_16x16x32_bf16 v[176:179],a[244:247],a[152:155],v[176:179]
 ds_read_b64_tr_b16 a[214:215],v16 offset:41984
 v_cvt_pk_bf16_f32 v200,v40,v41
 v_mfma_f32_16x16x32_bf16 v[180:183],a[248:251],a[136:139],0
 s_add_u32 s35,s30,45440
 buffer_load_dwordx4 v35,s[4:7],s35 offen offset:1024 lds
 v_cvt_pk_bf16_f32 v201,v42,v43
 v_mfma_f32_16x16x32_bf16 v[180:183],a[252:255],a[152:155],v[180:183]
 s_waitcnt lgkmcnt(10)
 v_cvt_pk_bf16_f32 v202,v44,v45
 v_cvt_pk_bf16_f32 v203,v46,v47
 v_mfma_f32_16x16x32_bf16 v[64:67],a[192:195],a[160:163],v[64:67]
 s_waitcnt lgkmcnt(8)
 ds_read_b64_tr_b16 a[216:217],v17 offset:32768
 v_accvgpr_read_b32 v40,a96
 v_mfma_f32_16x16x32_bf16 v[64:67],a[196:199],a[176:179],v[64:67]
 s_waitcnt lgkmcnt(7)
 s_add_u32 m0,s25,81920
 ds_read_b64_tr_b16 a[218:219],v17 offset:33792
 v_accvgpr_read_b32 v41,a97
 v_mfma_f32_16x16x32_bf16 v[68:71],a[200:203],a[160:163],v[68:71]
 s_waitcnt lgkmcnt(6)
 s_add_u32 s34,s29,1572864
 ds_read_b64_tr_b16 a[220:221],v17 offset:40960
 buffer_load_dwordx4 v32,s[8:11],s34 offen offset:0 lds
 v_accvgpr_read_b32 v42,a98
 v_accvgpr_read_b32 v43,a99
 v_mfma_f32_16x16x32_bf16 v[68:71],a[204:207],a[176:179],v[68:71]
 ds_read_b64_tr_b16 a[222:223],v17 offset:41984
 v_accvgpr_read_b32 v44,a112
 v_mfma_f32_16x16x32_bf16 v[72:75],a[192:195],a[164:167],v[72:75]
 ds_read_b64_tr_b16 a[224:225],v18 offset:32768
 v_accvgpr_read_b32 v45,a113
 v_mfma_f32_16x16x32_bf16 v[72:75],a[196:199],a[180:183],v[72:75]
 s_add_u32 s34,s29,1604608
 ds_read_b64_tr_b16 a[226:227],v18 offset:33792
 buffer_load_dwordx4 v32,s[8:11],s34 offen offset:1024 lds
 v_accvgpr_read_b32 v46,a114
 v_mfma_f32_16x16x32_bf16 v[76:79],a[200:203],a[164:167],v[76:79]
 ds_read_b64_tr_b16 a[228:229],v18 offset:40960
 ds_read_b64_tr_b16 a[230:231],v18 offset:41984
 s_waitcnt vmcnt(12)
 ds_read_b128 a[128:131],v22 offset:0
 v_accvgpr_read_b32 v47,a115
 v_mfma_f32_16x16x32_bf16 v[76:79],a[204:207],a[180:183],v[76:79]
 v_mul_f32 v40,v248,v40
 v_mul_f32 v41,v248,v41
 v_mfma_f32_16x16x32_bf16 v[80:83],a[192:195],a[168:171],v[80:83]
 ds_read_b128 a[144:147],v23 offset:0
 v_mul_f32 v42,v248,v42
 v_mfma_f32_16x16x32_bf16 v[80:83],a[196:199],a[184:187],v[80:83]
 ds_read_b128 a[132:135],v22 offset:2048
 v_mul_f32 v43,v248,v43
 v_mfma_f32_16x16x32_bf16 v[84:87],a[200:203],a[168:171],v[84:87]
 s_add_u32 s34,s29,1636352
 ds_read_b128 a[148:151],v23 offset:2048
 buffer_load_dwordx4 v33,s[8:11],s34 offen offset:2048 lds
 v_mul_f32 v44,v248,v44
 v_mul_f32 v45,v248,v45
 v_mfma_f32_16x16x32_bf16 v[84:87],a[204:207],a[184:187],v[84:87]
 s_waitcnt lgkmcnt(14)
 ds_read_b128 a[136:139],v22 offset:4096
 v_mul_f32 v46,v248,v46
 v_mfma_f32_16x16x32_bf16 v[96:99],a[208:211],a[160:163],v[96:99]
 s_waitcnt lgkmcnt(13)
 ds_read_b128 a[152:155],v23 offset:4096
 v_mul_f32 v47,v248,v47
 v_mfma_f32_16x16x32_bf16 v[96:99],a[212:215],a[176:179],v[96:99]
 s_waitcnt lgkmcnt(12)
 ds_read_b64_tr_b16 a[232:233],v19 offset:32768
 v_cvt_pk_bf16_f32 v204,v40,v41
 v_mfma_f32_16x16x32_bf16 v[100:103],a[216:219],a[160:163],v[100:103]
 s_waitcnt lgkmcnt(11)
 ds_read_b64_tr_b16 a[234:235],v19 offset:33792
 v_cvt_pk_bf16_f32 v205,v42,v43
 v_cvt_pk_bf16_f32 v206,v44,v45
 v_mfma_f32_16x16x32_bf16 v[100:103],a[220:223],a[176:179],v[100:103]
 s_add_u32 s34,s29,1668096
 ds_read_b64_tr_b16 a[236:237],v19 offset:40960
 buffer_load_dwordx4 v33,s[8:11],s34 offen offset:3072 lds
 v_cvt_pk_bf16_f32 v207,v46,v47
 v_mfma_f32_16x16x32_bf16 v[104:107],a[208:211],a[164:167],v[104:107]
 ds_read_b64_tr_b16 a[238:239],v19 offset:41984
 v_accvgpr_read_b32 v40,a4
 v_mfma_f32_16x16x32_bf16 v[104:107],a[212:215],a[180:183],v[104:107]
 ds_read_b64_tr_b16 a[240:241],v20 offset:32768
 ds_read_b64_tr_b16 a[242:243],v20 offset:33792
 v_accvgpr_read_b32 v41,a5
 v_mfma_f32_16x16x32_bf16 v[108:111],a[216:219],a[164:167],v[108:111]
 ds_read_b64_tr_b16 a[244:245],v20 offset:40960
 v_accvgpr_read_b32 v42,a6
 v_accvgpr_read_b32 v43,a7
 v_mfma_f32_16x16x32_bf16 v[108:111],a[220:223],a[180:183],v[108:111]
 ds_read_b64_tr_b16 a[246:247],v20 offset:41984
 s_waitcnt lgkmcnt(8)
 s_add_u32 m0,s26,131072
 v_accvgpr_read_b32 v44,a20
 v_mfma_f32_16x16x32_bf16 v[112:115],a[208:211],a[168:171],v[112:115]
 ds_read_b64_tr_b16 a[248:249],v21 offset:32768
 v_accvgpr_read_b32 v45,a21
 v_mfma_f32_16x16x32_bf16 v[112:115],a[212:215],a[184:187],v[112:115]
 s_add_u32 s35,s30,512
 buffer_load_dwordx4 v34,s[4:7],s35 offen offset:0 lds
 v_accvgpr_read_b32 v46,a22
 v_mfma_f32_16x16x32_bf16 v[116:119],a[216:219],a[168:171],v[116:119]
 ds_read_b64_tr_b16 a[250:251],v21 offset:33792
 v_accvgpr_read_b32 v47,a23
 v_mfma_f32_16x16x32_bf16 v[116:119],a[220:223],a[184:187],v[116:119]
 ds_read_b64_tr_b16 a[252:253],v21 offset:40960
 v_mul_f32 v40,v249,v40
 v_mfma_f32_16x16x32_bf16 v[128:131],a[224:227],a[160:163],v[128:131]
 v_mul_f32 v41,v249,v41
 v_mul_f32 v42,v249,v42
 v_mfma_f32_16x16x32_bf16 v[128:131],a[228:231],a[176:179],v[128:131]
 s_waitcnt lgkmcnt(9)
 ds_read_b64_tr_b16 a[254:255],v21 offset:41984
 v_mul_f32 v43,v249,v43
 v_mfma_f32_16x16x32_bf16 v[132:135],a[232:235],a[160:163],v[132:135]
 s_waitcnt lgkmcnt(8)
 v_mul_f32 v44,v249,v44
 v_mul_f32 v45,v249,v45
 v_mfma_f32_16x16x32_bf16 v[132:135],a[236:239],a[176:179],v[132:135]
 s_add_u32 s35,s30,8704
 buffer_load_dwordx4 v35,s[4:7],s35 offen offset:1024 lds
 v_mul_f32 v46,v249,v46
 v_mfma_f32_16x16x32_bf16 v[136:139],a[224:227],a[164:167],v[136:139]
 v_mul_f32 v47,v249,v47
 v_cvt_pk_bf16_f32 v208,v40,v41
 v_mfma_f32_16x16x32_bf16 v[136:139],a[228:231],a[180:183],v[136:139]
 v_cvt_pk_bf16_f32 v209,v42,v43
 v_cvt_pk_bf16_f32 v210,v44,v45
 v_mfma_f32_16x16x32_bf16 v[140:143],a[232:235],a[164:167],v[140:143]
 s_add_u32 s35,s30,16896
 buffer_load_dwordx4 v34,s[4:7],s35 offen offset:2048 lds
 v_cvt_pk_bf16_f32 v211,v46,v47
 v_mfma_f32_16x16x32_bf16 v[140:143],a[236:239],a[180:183],v[140:143]
 s_waitcnt vmcnt(13)
 s_waitcnt lgkmcnt(0)
 s_barrier
 v_accvgpr_read_b32 v40,a36
 v_mfma_f32_16x16x32_bf16 v[144:147],a[224:227],a[168:171],v[144:147]
 ds_read_b64_tr_b16 a[192:193],v14 offset:49152
 v_accvgpr_read_b32 v41,a37
 v_mfma_f32_16x16x32_bf16 v[144:147],a[228:231],a[184:187],v[144:147]
 ds_read_b64_tr_b16 a[194:195],v14 offset:50176
 v_accvgpr_read_b32 v42,a38
 v_mfma_f32_16x16x32_bf16 v[148:151],a[232:235],a[168:171],v[148:151]
 ds_read_b64_tr_b16 a[196:197],v14 offset:57344
 v_accvgpr_read_b32 v43,a39
 v_mfma_f32_16x16x32_bf16 v[148:151],a[236:239],a[184:187],v[148:151]
 ds_read_b64_tr_b16 a[198:199],v14 offset:58368
 v_accvgpr_read_b32 v44,a52
 v_mfma_f32_16x16x32_bf16 v[160:163],a[240:243],a[160:163],v[160:163]
 s_add_u32 s35,s30,25088
 buffer_load_dwordx4 v35,s[4:7],s35 offen offset:3072 lds
 v_accvgpr_read_b32 v45,a53
 v_mfma_f32_16x16x32_bf16 v[160:163],a[244:247],a[176:179],v[160:163]
 ds_read_b64_tr_b16 a[200:201],v15 offset:49152
 v_accvgpr_read_b32 v46,a54
 v_mfma_f32_16x16x32_bf16 v[164:167],a[248:251],a[160:163],v[164:167]
 ds_read_b64_tr_b16 a[202:203],v15 offset:50176
 v_accvgpr_read_b32 v47,a55
 v_mul_f32 v40,v249,v40
 v_mfma_f32_16x16x32_bf16 v[164:167],a[252:255],a[176:179],v[164:167]
 ds_read_b64_tr_b16 a[204:205],v15 offset:57344
 v_mul_f32 v41,v249,v41
 v_mfma_f32_16x16x32_bf16 v[168:171],a[240:243],a[164:167],v[168:171]
 ds_read_b64_tr_b16 a[206:207],v15 offset:58368
 v_mul_f32 v42,v249,v42
 v_mfma_f32_16x16x32_bf16 v[168:171],a[244:247],a[180:183],v[168:171]
 s_add_u32 m0,s26,135168
 ds_read_b64_tr_b16 a[208:209],v16 offset:49152
 v_mul_f32 v43,v249,v43
 v_mfma_f32_16x16x32_bf16 v[172:175],a[248:251],a[164:167],v[172:175]
 s_add_u32 s35,s30,37376
 buffer_load_dwordx4 v34,s[4:7],s35 offen offset:0 lds
 v_mul_f32 v44,v249,v44
 v_mul_f32 v45,v249,v45
 v_mfma_f32_16x16x32_bf16 v[172:175],a[252:255],a[180:183],v[172:175]
 ds_read_b64_tr_b16 a[210:211],v16 offset:50176
 v_mul_f32 v46,v249,v46
 v_mfma_f32_16x16x32_bf16 v[176:179],a[240:243],a[168:171],v[176:179]
 ds_read_b64_tr_b16 a[212:213],v16 offset:57344
 v_mul_f32 v47,v249,v47
 v_mfma_f32_16x16x32_bf16 v[176:179],a[244:247],a[184:187],v[176:179]
 ds_read_b64_tr_b16 a[214:215],v16 offset:58368
 v_cvt_pk_bf16_f32 v212,v40,v41
 v_mfma_f32_16x16x32_bf16 v[180:183],a[248:251],a[168:171],v[180:183]
 s_add_u32 s35,s30,45568
 buffer_load_dwordx4 v35,s[4:7],s35 offen offset:1024 lds
 v_cvt_pk_bf16_f32 v213,v42,v43
 v_mfma_f32_16x16x32_bf16 v[180:183],a[252:255],a[184:187],v[180:183]
 s_waitcnt lgkmcnt(10)
 v_cvt_pk_bf16_f32 v214,v44,v45
 v_cvt_pk_bf16_f32 v215,v46,v47
 v_mfma_f32_16x16x32_bf16 v[64:67],a[192:195],a[128:131],v[64:67]
 s_waitcnt lgkmcnt(8)
 ds_read_b64_tr_b16 a[216:217],v17 offset:49152
 v_accvgpr_read_b32 v40,a68
 v_mfma_f32_16x16x32_bf16 v[64:67],a[196:199],a[144:147],v[64:67]
 s_waitcnt lgkmcnt(7)
 s_add_u32 m0,s25,98304
 ds_read_b64_tr_b16 a[218:219],v17 offset:50176
 v_accvgpr_read_b32 v41,a69
 v_mfma_f32_16x16x32_bf16 v[68:71],a[200:203],a[128:131],v[68:71]
 s_waitcnt lgkmcnt(6)
 s_add_u32 s34,s29,2097152
 ds_read_b64_tr_b16 a[220:221],v17 offset:57344
 buffer_load_dwordx4 v32,s[8:11],s34 offen offset:0 lds
 v_accvgpr_read_b32 v42,a70
 v_accvgpr_read_b32 v43,a71
 v_mfma_f32_16x16x32_bf16 v[68:71],a[204:207],a[144:147],v[68:71]
 ds_read_b64_tr_b16 a[222:223],v17 offset:58368
 v_accvgpr_read_b32 v44,a84
 v_mfma_f32_16x16x32_bf16 v[72:75],a[192:195],a[132:135],v[72:75]
 ds_read_b64_tr_b16 a[224:225],v18 offset:49152
 v_accvgpr_read_b32 v45,a85
 v_mfma_f32_16x16x32_bf16 v[72:75],a[196:199],a[148:151],v[72:75]
 s_add_u32 s34,s29,2128896
 ds_read_b64_tr_b16 a[226:227],v18 offset:50176
 buffer_load_dwordx4 v32,s[8:11],s34 offen offset:1024 lds
 v_accvgpr_read_b32 v46,a86
 v_mfma_f32_16x16x32_bf16 v[76:79],a[200:203],a[132:135],v[76:79]
 ds_read_b64_tr_b16 a[228:229],v18 offset:57344
 ds_read_b64_tr_b16 a[230:231],v18 offset:58368
 s_waitcnt vmcnt(12)
 ds_read_b128 a[160:163],v24 offset:0
 v_accvgpr_read_b32 v47,a87
 v_mfma_f32_16x16x32_bf16 v[76:79],a[204:207],a[148:151],v[76:79]
 v_mul_f32 v40,v249,v40
 v_mul_f32 v41,v249,v41
 v_mfma_f32_16x16x32_bf16 v[80:83],a[192:195],a[136:139],v[80:83]
 ds_read_b128 a[176:179],v25 offset:0
 v_mul_f32 v42,v249,v42
 v_mfma_f32_16x16x32_bf16 v[80:83],a[196:199],a[152:155],v[80:83]
 s_add_u32 s34,s29,2160640
 ds_read_b128 a[164:167],v24 offset:2048
 buffer_load_dwordx4 v33,s[8:11],s34 offen offset:2048 lds
 v_mul_f32 v43,v249,v43
 v_mfma_f32_16x16x32_bf16 v[84:87],a[200:203],a[136:139],v[84:87]
 s_add_u32 s34,s29,2192384
 ds_read_b128 a[180:183],v25 offset:2048
 buffer_load_dwordx4 v33,s[8:11],s34 offen offset:3072 lds
 v_mul_f32 v44,v249,v44
 v_mul_f32 v45,v249,v45
 v_mfma_f32_16x16x32_bf16 v[84:87],a[204:207],a[152:155],v[84:87]
 s_waitcnt lgkmcnt(14)
 ds_read_b128 a[168:171],v24 offset:4096
 v_mul_f32 v46,v249,v46
 v_mfma_f32_16x16x32_bf16 v[96:99],a[208:211],a[128:131],v[96:99]
 s_waitcnt lgkmcnt(13)
 ds_read_b128 a[184:187],v25 offset:4096
 v_mul_f32 v47,v249,v47
 v_mfma_f32_16x16x32_bf16 v[96:99],a[212:215],a[144:147],v[96:99]
 s_waitcnt lgkmcnt(12)
 ds_read_b64_tr_b16 a[232:233],v19 offset:49152
 v_cvt_pk_bf16_f32 v216,v40,v41
 v_mfma_f32_16x16x32_bf16 v[100:103],a[216:219],a[128:131],v[100:103]
 s_waitcnt lgkmcnt(11)
 ds_read_b64_tr_b16 a[234:235],v19 offset:50176
 v_cvt_pk_bf16_f32 v217,v42,v43
 v_cvt_pk_bf16_f32 v218,v44,v45
 v_mfma_f32_16x16x32_bf16 v[100:103],a[220:223],a[144:147],v[100:103]
 s_add_u32 s38,s31,0
 ds_read_b64_tr_b16 a[236:237],v19 offset:57344
 buffer_store_dwordx4 v[192:195],v36,s[20:23],s38 offen offset:0 sc0 sc1
 v_cvt_pk_bf16_f32 v219,v46,v47
 v_mfma_f32_16x16x32_bf16 v[104:107],a[208:211],a[132:135],v[104:107]
 ds_read_b64_tr_b16 a[238:239],v19 offset:58368
 v_accvgpr_read_b32 v40,a100
 v_mfma_f32_16x16x32_bf16 v[104:107],a[212:215],a[148:151],v[104:107]
 ds_read_b64_tr_b16 a[240:241],v20 offset:49152
 ds_read_b64_tr_b16 a[242:243],v20 offset:50176
 v_accvgpr_read_b32 v41,a101
 v_mfma_f32_16x16x32_bf16 v[108:111],a[216:219],a[132:135],v[108:111]
 ds_read_b64_tr_b16 a[244:245],v20 offset:57344
 v_accvgpr_read_b32 v42,a102
 v_accvgpr_read_b32 v43,a103
 v_mfma_f32_16x16x32_bf16 v[108:111],a[220:223],a[148:151],v[108:111]
 s_add_u32 s38,s31,0
 ds_read_b64_tr_b16 a[246:247],v20 offset:58368
 buffer_store_dwordx4 v[196:199],v36,s[20:23],s38 offen offset:1024 sc0 sc1
 v_accvgpr_read_b32 v44,a116
 v_mfma_f32_16x16x32_bf16 v[112:115],a[208:211],a[136:139],v[112:115]
 ds_read_b64_tr_b16 a[248:249],v21 offset:49152
 v_accvgpr_read_b32 v45,a117
 v_mfma_f32_16x16x32_bf16 v[112:115],a[212:215],a[152:155],v[112:115]
 s_add_u32 s38,s31,0
 ds_read_b64_tr_b16 a[250:251],v21 offset:50176
 buffer_store_dwordx4 v[200:203],v36,s[20:23],s38 offen offset:2048 sc0 sc1
 v_accvgpr_read_b32 v46,a118
 v_mfma_f32_16x16x32_bf16 v[116:119],a[216:219],a[136:139],v[116:119]
 ds_read_b64_tr_b16 a[252:253],v21 offset:57344
 v_accvgpr_read_b32 v47,a119
 v_mul_f32 v40,v249,v40
 v_mfma_f32_16x16x32_bf16 v[116:119],a[220:223],a[152:155],v[116:119]
 s_waitcnt lgkmcnt(15)
 ds_read_b64_tr_b16 a[254:255],v21 offset:58368
 v_mul_f32 v41,v249,v41
 v_mfma_f32_16x16x32_bf16 v[128:131],a[224:227],a[128:131],v[128:131]
 s_waitcnt lgkmcnt(15)
 v_mul_f32 v42,v249,v42
 v_mul_f32 v43,v249,v43
 v_mfma_f32_16x16x32_bf16 v[128:131],a[228:231],a[144:147],v[128:131]
 s_waitcnt lgkmcnt(10)
 s_add_u32 s38,s31,0
 buffer_store_dwordx4 v[204:207],v36,s[20:23],s38 offen offset:3072 sc0 sc1
 v_mfma_f32_16x16x32_bf16 v[132:135],a[232:235],a[128:131],v[132:135]
 s_waitcnt lgkmcnt(8)
 v_mul_f32 v44,v249,v44
 v_mul_f32 v45,v249,v45
 v_mfma_f32_16x16x32_bf16 v[132:135],a[236:239],a[144:147],v[132:135]
 s_waitcnt lgkmcnt(15)
 s_add_u32 m0,s26,32768
 v_mul_f32 v46,v249,v46
 v_mfma_f32_16x16x32_bf16 v[136:139],a[224:227],a[132:135],v[136:139]
 s_add_u32 s35,s30,640
 buffer_load_dwordx4 v34,s[4:7],s35 offen offset:0 lds
 v_mul_f32 v47,v249,v47
 v_mfma_f32_16x16x32_bf16 v[136:139],a[228:231],a[148:151],v[136:139]
 v_cvt_pk_bf16_f32 v220,v40,v41
 v_cvt_pk_bf16_f32 v221,v42,v43
 v_mfma_f32_16x16x32_bf16 v[140:143],a[232:235],a[132:135],v[140:143]
 s_add_u32 s35,s30,8832
 buffer_load_dwordx4 v35,s[4:7],s35 offen offset:1024 lds
 v_cvt_pk_bf16_f32 v222,v44,v45
 v_mfma_f32_16x16x32_bf16 v[140:143],a[236:239],a[148:151],v[140:143]
 s_waitcnt vmcnt(16)
 s_waitcnt lgkmcnt(0)
 s_barrier
 v_cvt_pk_bf16_f32 v223,v46,v47
 v_mfma_f32_16x16x32_bf16 v[144:147],a[224:227],a[136:139],v[144:147]
 ds_read_b64_tr_b16 a[192:193],v14 offset:16384
 v_accvgpr_read_b32 v40,a8
 v_mfma_f32_16x16x32_bf16 v[144:147],a[228:231],a[152:155],v[144:147]
 ds_read_b64_tr_b16 a[194:195],v14 offset:17408
 v_accvgpr_read_b32 v41,a9
 v_mfma_f32_16x16x32_bf16 v[148:151],a[232:235],a[136:139],v[148:151]
 ds_read_b64_tr_b16 a[196:197],v14 offset:24576
 v_accvgpr_read_b32 v42,a10
 v_accvgpr_read_b32 v43,a11
 v_mfma_f32_16x16x32_bf16 v[148:151],a[236:239],a[152:155],v[148:151]
 s_add_u32 s35,s30,17024
 buffer_load_dwordx4 v34,s[4:7],s35 offen offset:2048 lds
 v_accvgpr_read_b32 v44,a24
 v_mfma_f32_16x16x32_bf16 v[160:163],a[240:243],a[128:131],v[160:163]
 ds_read_b64_tr_b16 a[198:199],v14 offset:25600
 v_accvgpr_read_b32 v45,a25
 v_mfma_f32_16x16x32_bf16 v[160:163],a[244:247],a[144:147],v[160:163]
 ds_read_b64_tr_b16 a[200:201],v15 offset:16384
 v_accvgpr_read_b32 v46,a26
 v_mfma_f32_16x16x32_bf16 v[164:167],a[248:251],a[128:131],v[164:167]
 ds_read_b64_tr_b16 a[202:203],v15 offset:17408
 v_accvgpr_read_b32 v47,a27
 v_mul_f32 v40,v250,v40
 v_mfma_f32_16x16x32_bf16 v[164:167],a[252:255],a[144:147],v[164:167]
 s_add_u32 s35,s30,25216
 ds_read_b64_tr_b16 a[204:205],v15 offset:24576
 buffer_load_dwordx4 v35,s[4:7],s35 offen offset:3072 lds
 v_mul_f32 v41,v250,v41
 v_mfma_f32_16x16x32_bf16 v[168:171],a[240:243],a[132:135],v[168:171]
 ds_read_b64_tr_b16 a[206:207],v15 offset:25600
 v_mul_f32 v42,v250,v42
 v_mfma_f32_16x16x32_bf16 v[168:171],a[244:247],a[148:151],v[168:171]
 s_add_u32 m0,s26,36864
 ds_read_b64_tr_b16 a[208:209],v16 offset:16384
 v_mul_f32 v43,v250,v43
 v_mfma_f32_16x16x32_bf16 v[172:175],a[248:251],a[132:135],v[172:175]
 s_add_u32 s35,s30,37504
 buffer_load_dwordx4 v34,s[4:7],s35 offen offset:0 lds
 v_mul_f32 v44,v250,v44
 v_mul_f32 v45,v250,v45
 v_mfma_f32_16x16x32_bf16 v[172:175],a[252:255],a[148:151],v[172:175]
 ds_read_b64_tr_b16 a[210:211],v16 offset:17408
 v_mul_f32 v46,v250,v46
 v_mfma_f32_16x16x32_bf16 v[176:179],a[240:243],a[136:139],v[176:179]
 ds_read_b64_tr_b16 a[212:213],v16 offset:24576
 v_mul_f32 v47,v250,v47
 v_mfma_f32_16x16x32_bf16 v[176:179],a[244:247],a[152:155],v[176:179]
 ds_read_b64_tr_b16 a[214:215],v16 offset:25600
 v_cvt_pk_bf16_f32 v224,v40,v41
 v_mfma_f32_16x16x32_bf16 v[180:183],a[248:251],a[136:139],v[180:183]
 s_add_u32 s35,s30,45696
 buffer_load_dwordx4 v35,s[4:7],s35 offen offset:1024 lds
 v_cvt_pk_bf16_f32 v225,v42,v43
 v_mfma_f32_16x16x32_bf16 v[180:183],a[252:255],a[152:155],v[180:183]
 s_waitcnt lgkmcnt(10)
 v_cvt_pk_bf16_f32 v226,v44,v45
 v_cvt_pk_bf16_f32 v227,v46,v47
 v_mfma_f32_16x16x32_bf16 v[64:67],a[192:195],a[160:163],v[64:67]
 s_waitcnt lgkmcnt(8)
 ds_read_b64_tr_b16 a[216:217],v17 offset:16384
 v_accvgpr_read_b32 v40,a40
 v_mfma_f32_16x16x32_bf16 v[64:67],a[196:199],a[176:179],v[64:67]
 s_waitcnt lgkmcnt(7)
 s_add_u32 m0,s25,114688
 ds_read_b64_tr_b16 a[218:219],v17 offset:17408
 v_accvgpr_read_b32 v41,a41
 v_mfma_f32_16x16x32_bf16 v[68:71],a[200:203],a[160:163],v[68:71]
 s_waitcnt lgkmcnt(6)
 s_add_u32 s34,s29,2621440
 ds_read_b64_tr_b16 a[220:221],v17 offset:24576
 buffer_load_dwordx4 v32,s[8:11],s34 offen offset:0 lds
 v_accvgpr_read_b32 v42,a42
 v_accvgpr_read_b32 v43,a43
 v_mfma_f32_16x16x32_bf16 v[68:71],a[204:207],a[176:179],v[68:71]
 ds_read_b64_tr_b16 a[222:223],v17 offset:25600
 v_accvgpr_read_b32 v44,a56
 v_mfma_f32_16x16x32_bf16 v[72:75],a[192:195],a[164:167],v[72:75]
 ds_read_b64_tr_b16 a[224:225],v18 offset:16384
 v_accvgpr_read_b32 v45,a57
 v_mfma_f32_16x16x32_bf16 v[72:75],a[196:199],a[180:183],v[72:75]
 s_add_u32 s34,s29,2653184
 ds_read_b64_tr_b16 a[226:227],v18 offset:17408
 buffer_load_dwordx4 v32,s[8:11],s34 offen offset:1024 lds
 v_accvgpr_read_b32 v46,a58
 v_mfma_f32_16x16x32_bf16 v[76:79],a[200:203],a[164:167],v[76:79]
 ds_read_b64_tr_b16 a[228:229],v18 offset:24576
 ds_read_b64_tr_b16 a[230:231],v18 offset:25600
 s_waitcnt vmcnt(16)
 ds_read_b128 a[128:131],v22 offset:0
 v_accvgpr_read_b32 v47,a59
 v_mfma_f32_16x16x32_bf16 v[76:79],a[204:207],a[180:183],v[76:79]
 v_mul_f32 v40,v250,v40
 v_mul_f32 v41,v250,v41
 v_mfma_f32_16x16x32_bf16 v[80:83],a[192:195],a[168:171],v[80:83]
 ds_read_b128 a[144:147],v23 offset:0
 v_mul_f32 v42,v250,v42
 v_mfma_f32_16x16x32_bf16 v[80:83],a[196:199],a[184:187],v[80:83]
 s_add_u32 s34,s29,2684928
 ds_read_b128 a[132:135],v22 offset:2048
 buffer_load_dwordx4 v33,s[8:11],s34 offen offset:2048 lds
 v_mul_f32 v43,v250,v43
 v_mfma_f32_16x16x32_bf16 v[84:87],a[200:203],a[168:171],v[84:87]
 s_add_u32 s34,s29,2716672
 ds_read_b128 a[148:151],v23 offset:2048
 buffer_load_dwordx4 v33,s[8:11],s34 offen offset:3072 lds
 v_mul_f32 v44,v250,v44
 v_mul_f32 v45,v250,v45
 v_mfma_f32_16x16x32_bf16 v[84:87],a[204:207],a[184:187],v[84:87]
 s_waitcnt lgkmcnt(14)
 ds_read_b128 a[136:139],v22 offset:4096
 v_mul_f32 v46,v250,v46
 v_mfma_f32_16x16x32_bf16 v[96:99],a[208:211],a[160:163],v[96:99]
 s_waitcnt lgkmcnt(13)
 ds_read_b128 a[152:155],v23 offset:4096
 v_mul_f32 v47,v250,v47
 v_mfma_f32_16x16x32_bf16 v[96:99],a[212:215],a[176:179],v[96:99]
 s_waitcnt lgkmcnt(12)
 ds_read_b64_tr_b16 a[232:233],v19 offset:16384
 v_cvt_pk_bf16_f32 v228,v40,v41
 v_mfma_f32_16x16x32_bf16 v[100:103],a[216:219],a[160:163],v[100:103]
 s_waitcnt lgkmcnt(11)
 ds_read_b64_tr_b16 a[234:235],v19 offset:17408
 v_cvt_pk_bf16_f32 v229,v42,v43
 v_cvt_pk_bf16_f32 v230,v44,v45
 v_mfma_f32_16x16x32_bf16 v[100:103],a[220:223],a[176:179],v[100:103]
 s_add_u32 s38,s31,131072
 ds_read_b64_tr_b16 a[236:237],v19 offset:24576
 buffer_store_dwordx4 v[208:211],v36,s[20:23],s38 offen offset:0 sc0 sc1
 v_cvt_pk_bf16_f32 v231,v46,v47
 v_mfma_f32_16x16x32_bf16 v[104:107],a[208:211],a[164:167],v[104:107]
 ds_read_b64_tr_b16 a[238:239],v19 offset:25600
 v_accvgpr_read_b32 v40,a72
 v_mfma_f32_16x16x32_bf16 v[104:107],a[212:215],a[180:183],v[104:107]
 ds_read_b64_tr_b16 a[240:241],v20 offset:16384
 ds_read_b64_tr_b16 a[242:243],v20 offset:17408
 v_accvgpr_read_b32 v41,a73
 v_mfma_f32_16x16x32_bf16 v[108:111],a[216:219],a[164:167],v[108:111]
 ds_read_b64_tr_b16 a[244:245],v20 offset:24576
 v_accvgpr_read_b32 v42,a74
 v_accvgpr_read_b32 v43,a75
 v_mfma_f32_16x16x32_bf16 v[108:111],a[220:223],a[180:183],v[108:111]
 s_add_u32 s38,s31,131072
 ds_read_b64_tr_b16 a[246:247],v20 offset:25600
 buffer_store_dwordx4 v[212:215],v36,s[20:23],s38 offen offset:1024 sc0 sc1
 v_accvgpr_read_b32 v44,a88
 v_mfma_f32_16x16x32_bf16 v[112:115],a[208:211],a[168:171],v[112:115]
 ds_read_b64_tr_b16 a[248:249],v21 offset:16384
 v_accvgpr_read_b32 v45,a89
 v_mfma_f32_16x16x32_bf16 v[112:115],a[212:215],a[184:187],v[112:115]
 s_add_u32 s38,s31,131072
 ds_read_b64_tr_b16 a[250:251],v21 offset:17408
 buffer_store_dwordx4 v[216:219],v36,s[20:23],s38 offen offset:2048 sc0 sc1
 v_accvgpr_read_b32 v46,a90
 v_mfma_f32_16x16x32_bf16 v[116:119],a[216:219],a[168:171],v[116:119]
 ds_read_b64_tr_b16 a[252:253],v21 offset:24576
 v_accvgpr_read_b32 v47,a91
 v_mul_f32 v40,v250,v40
 v_mfma_f32_16x16x32_bf16 v[116:119],a[220:223],a[184:187],v[116:119]
 s_waitcnt lgkmcnt(15)
 ds_read_b64_tr_b16 a[254:255],v21 offset:25600
 v_mul_f32 v41,v250,v41
 v_mfma_f32_16x16x32_bf16 v[128:131],a[224:227],a[160:163],v[128:131]
 s_waitcnt lgkmcnt(15)
 v_mul_f32 v42,v250,v42
 v_mul_f32 v43,v250,v43
 v_mfma_f32_16x16x32_bf16 v[128:131],a[228:231],a[176:179],v[128:131]
 s_waitcnt lgkmcnt(10)
 s_add_u32 s38,s31,131072
 buffer_store_dwordx4 v[220:223],v36,s[20:23],s38 offen offset:3072 sc0 sc1
 v_mfma_f32_16x16x32_bf16 v[132:135],a[232:235],a[160:163],v[132:135]
 s_waitcnt lgkmcnt(8)
 v_mul_f32 v44,v250,v44
 v_mul_f32 v45,v250,v45
 v_mfma_f32_16x16x32_bf16 v[132:135],a[236:239],a[176:179],v[132:135]
 s_waitcnt lgkmcnt(15)
 s_add_u32 m0,s26,131072
 v_mul_f32 v46,v250,v46
 v_mfma_f32_16x16x32_bf16 v[136:139],a[224:227],a[164:167],v[136:139]
 s_add_u32 s35,s30,768
 buffer_load_dwordx4 v34,s[4:7],s35 offen offset:0 lds
 v_mul_f32 v47,v250,v47
 v_mfma_f32_16x16x32_bf16 v[136:139],a[228:231],a[180:183],v[136:139]
 v_cvt_pk_bf16_f32 v232,v40,v41
 v_cvt_pk_bf16_f32 v233,v42,v43
 v_mfma_f32_16x16x32_bf16 v[140:143],a[232:235],a[164:167],v[140:143]
 s_add_u32 s35,s30,8960
 buffer_load_dwordx4 v35,s[4:7],s35 offen offset:1024 lds
 v_cvt_pk_bf16_f32 v234,v44,v45
 v_mfma_f32_16x16x32_bf16 v[140:143],a[236:239],a[180:183],v[140:143]
 s_waitcnt vmcnt(20)
 s_waitcnt lgkmcnt(0)
 s_barrier
 v_cvt_pk_bf16_f32 v235,v46,v47
 v_mfma_f32_16x16x32_bf16 v[144:147],a[224:227],a[168:171],v[144:147]
 ds_read_b64_tr_b16 a[192:193],v14 offset:32768
 v_accvgpr_read_b32 v40,a104
 v_mfma_f32_16x16x32_bf16 v[144:147],a[228:231],a[184:187],v[144:147]
 ds_read_b64_tr_b16 a[194:195],v14 offset:33792
 v_accvgpr_read_b32 v41,a105
 v_mfma_f32_16x16x32_bf16 v[148:151],a[232:235],a[168:171],v[148:151]
 ds_read_b64_tr_b16 a[196:197],v14 offset:40960
 v_accvgpr_read_b32 v42,a106
 v_accvgpr_read_b32 v43,a107
 v_mfma_f32_16x16x32_bf16 v[148:151],a[236:239],a[184:187],v[148:151]
 s_add_u32 s35,s30,17152
 buffer_load_dwordx4 v34,s[4:7],s35 offen offset:2048 lds
 v_accvgpr_read_b32 v44,a120
 v_mfma_f32_16x16x32_bf16 v[160:163],a[240:243],a[160:163],v[160:163]
 ds_read_b64_tr_b16 a[198:199],v14 offset:41984
 v_accvgpr_read_b32 v45,a121
 v_mfma_f32_16x16x32_bf16 v[160:163],a[244:247],a[176:179],v[160:163]
 ds_read_b64_tr_b16 a[200:201],v15 offset:32768
 v_accvgpr_read_b32 v46,a122
 v_mfma_f32_16x16x32_bf16 v[164:167],a[248:251],a[160:163],v[164:167]
 ds_read_b64_tr_b16 a[202:203],v15 offset:33792
 v_accvgpr_read_b32 v47,a123
 v_mul_f32 v40,v250,v40
 v_mfma_f32_16x16x32_bf16 v[164:167],a[252:255],a[176:179],v[164:167]
 s_add_u32 s35,s30,25344
 ds_read_b64_tr_b16 a[204:205],v15 offset:40960
 buffer_load_dwordx4 v35,s[4:7],s35 offen offset:3072 lds
 v_mul_f32 v41,v250,v41
 v_mfma_f32_16x16x32_bf16 v[168:171],a[240:243],a[164:167],v[168:171]
 ds_read_b64_tr_b16 a[206:207],v15 offset:41984
 v_mul_f32 v42,v250,v42
 v_mfma_f32_16x16x32_bf16 v[168:171],a[244:247],a[180:183],v[168:171]
 s_add_u32 m0,s26,135168
 ds_read_b64_tr_b16 a[208:209],v16 offset:32768
 v_mul_f32 v43,v250,v43
 v_mfma_f32_16x16x32_bf16 v[172:175],a[248:251],a[164:167],v[172:175]
 s_add_u32 s35,s30,37632
 buffer_load_dwordx4 v34,s[4:7],s35 offen offset:0 lds
 v_mul_f32 v44,v250,v44
 v_mul_f32 v45,v250,v45
 v_mfma_f32_16x16x32_bf16 v[172:175],a[252:255],a[180:183],v[172:175]
 ds_read_b64_tr_b16 a[210:211],v16 offset:33792
 v_mul_f32 v46,v250,v46
 v_mfma_f32_16x16x32_bf16 v[176:179],a[240:243],a[168:171],v[176:179]
 ds_read_b64_tr_b16 a[212:213],v16 offset:40960
 v_mul_f32 v47,v250,v47
 v_mfma_f32_16x16x32_bf16 v[176:179],a[244:247],a[184:187],v[176:179]
 ds_read_b64_tr_b16 a[214:215],v16 offset:41984
 v_cvt_pk_bf16_f32 v236,v40,v41
 v_mfma_f32_16x16x32_bf16 v[180:183],a[248:251],a[168:171],v[180:183]
 s_add_u32 s35,s30,45824
 buffer_load_dwordx4 v35,s[4:7],s35 offen offset:1024 lds
 v_cvt_pk_bf16_f32 v237,v42,v43
 v_mfma_f32_16x16x32_bf16 v[180:183],a[252:255],a[184:187],v[180:183]
 s_waitcnt lgkmcnt(10)
 v_cvt_pk_bf16_f32 v238,v44,v45
 v_cvt_pk_bf16_f32 v239,v46,v47
 v_mfma_f32_16x16x32_bf16 v[64:67],a[192:195],a[128:131],v[64:67]
 s_waitcnt lgkmcnt(8)
 ds_read_b64_tr_b16 a[216:217],v17 offset:32768
 v_mfma_f32_16x16x32_bf16 v[64:67],a[196:199],a[144:147],v[64:67]
 s_waitcnt lgkmcnt(7)
 s_add_u32 m0,s25,81920
 ds_read_b64_tr_b16 a[218:219],v17 offset:33792
 v_mfma_f32_16x16x32_bf16 v[68:71],a[200:203],a[128:131],v[68:71]
 s_waitcnt lgkmcnt(6)
 s_add_u32 s34,s29,3145728
 buffer_load_dwordx4 v32,s[8:11],s34 offen offset:0 lds
 v_mfma_f32_16x16x32_bf16 v[68:71],a[204:207],a[144:147],v[68:71]
 ds_read_b64_tr_b16 a[220:221],v17 offset:40960
 ds_read_b64_tr_b16 a[222:223],v17 offset:41984
 v_mfma_f32_16x16x32_bf16 v[72:75],a[192:195],a[132:135],v[72:75]
 ds_read_b64_tr_b16 a[224:225],v18 offset:32768
 v_mfma_f32_16x16x32_bf16 v[72:75],a[196:199],a[148:151],v[72:75]
 s_add_u32 s34,s29,3177472
 ds_read_b64_tr_b16 a[226:227],v18 offset:33792
 buffer_load_dwordx4 v32,s[8:11],s34 offen offset:1024 lds
 v_mfma_f32_16x16x32_bf16 v[76:79],a[200:203],a[132:135],v[76:79]
 ds_read_b64_tr_b16 a[228:229],v18 offset:40960
 ds_read_b64_tr_b16 a[230:231],v18 offset:41984
 v_mfma_f32_16x16x32_bf16 v[76:79],a[204:207],a[148:151],v[76:79]
 s_waitcnt vmcnt(16)
 ds_read_b128 a[160:163],v24 offset:0
 v_mfma_f32_16x16x32_bf16 v[80:83],a[192:195],a[136:139],v[80:83]
 ds_read_b128 a[176:179],v25 offset:0
 v_mfma_f32_16x16x32_bf16 v[80:83],a[196:199],a[152:155],v[80:83]
 s_add_u32 s34,s29,3209216
 ds_read_b128 a[164:167],v24 offset:2048
 buffer_load_dwordx4 v33,s[8:11],s34 offen offset:2048 lds
 v_mfma_f32_16x16x32_bf16 v[84:87],a[200:203],a[136:139],v[84:87]
 ds_read_b128 a[180:183],v25 offset:2048
 v_mfma_f32_16x16x32_bf16 v[84:87],a[204:207],a[152:155],v[84:87]
 s_waitcnt lgkmcnt(14)
 ds_read_b128 a[168:171],v24 offset:4096
 ds_read_b128 a[184:187],v25 offset:4096
 v_mfma_f32_16x16x32_bf16 v[96:99],a[208:211],a[128:131],v[96:99]
 s_waitcnt lgkmcnt(14)
 s_add_u32 s34,s29,3240960
 buffer_load_dwordx4 v33,s[8:11],s34 offen offset:3072 lds
 v_mfma_f32_16x16x32_bf16 v[96:99],a[212:215],a[144:147],v[96:99]
 s_waitcnt lgkmcnt(12)
 ds_read_b64_tr_b16 a[232:233],v19 offset:32768
 v_mfma_f32_16x16x32_bf16 v[100:103],a[216:219],a[128:131],v[100:103]
 s_waitcnt lgkmcnt(11)
 ds_read_b64_tr_b16 a[234:235],v19 offset:33792
 v_mfma_f32_16x16x32_bf16 v[100:103],a[220:223],a[144:147],v[100:103]
 s_add_u32 s38,s31,262144
 ds_read_b64_tr_b16 a[236:237],v19 offset:40960
 buffer_store_dwordx4 v[224:227],v36,s[20:23],s38 offen offset:0 sc0 sc1
 v_mfma_f32_16x16x32_bf16 v[104:107],a[208:211],a[132:135],v[104:107]
 ds_read_b64_tr_b16 a[238:239],v19 offset:41984
 v_mfma_f32_16x16x32_bf16 v[104:107],a[212:215],a[148:151],v[104:107]
 ds_read_b64_tr_b16 a[240:241],v20 offset:32768
 ds_read_b64_tr_b16 a[242:243],v20 offset:33792
 v_mfma_f32_16x16x32_bf16 v[108:111],a[216:219],a[132:135],v[108:111]
 s_add_u32 s38,s31,262144
 buffer_store_dwordx4 v[228:231],v36,s[20:23],s38 offen offset:1024 sc0 sc1
 v_mfma_f32_16x16x32_bf16 v[108:111],a[220:223],a[148:151],v[108:111]
 ds_read_b64_tr_b16 a[244:245],v20 offset:40960
 ds_read_b64_tr_b16 a[246:247],v20 offset:41984
 v_mfma_f32_16x16x32_bf16 v[112:115],a[208:211],a[136:139],v[112:115]
 ds_read_b64_tr_b16 a[248:249],v21 offset:32768
 v_mfma_f32_16x16x32_bf16 v[112:115],a[212:215],a[152:155],v[112:115]
 s_add_u32 s38,s31,262144
 ds_read_b64_tr_b16 a[250:251],v21 offset:33792
 buffer_store_dwordx4 v[232:235],v36,s[20:23],s38 offen offset:2048 sc0 sc1
 v_mfma_f32_16x16x32_bf16 v[116:119],a[216:219],a[136:139],v[116:119]
 ds_read_b64_tr_b16 a[252:253],v21 offset:40960
 v_mfma_f32_16x16x32_bf16 v[116:119],a[220:223],a[152:155],v[116:119]
 s_waitcnt lgkmcnt(15)
 ds_read_b64_tr_b16 a[254:255],v21 offset:41984
 v_mfma_f32_16x16x32_bf16 v[128:131],a[224:227],a[128:131],v[128:131]
 s_waitcnt lgkmcnt(15)
 v_mfma_f32_16x16x32_bf16 v[128:131],a[228:231],a[144:147],v[128:131]
 s_waitcnt lgkmcnt(10)
 s_add_u32 s38,s31,262144
 buffer_store_dwordx4 v[236:239],v36,s[20:23],s38 offen offset:3072 sc0 sc1
 v_mfma_f32_16x16x32_bf16 v[132:135],a[232:235],a[128:131],v[132:135]
 s_waitcnt lgkmcnt(8)
 v_mfma_f32_16x16x32_bf16 v[132:135],a[236:239],a[144:147],v[132:135]
 s_waitcnt lgkmcnt(15)
 s_add_u32 m0,s26,32768
 v_mfma_f32_16x16x32_bf16 v[136:139],a[224:227],a[132:135],v[136:139]
 s_add_u32 s35,s30,896
 buffer_load_dwordx4 v34,s[4:7],s35 offen offset:0 lds
 v_mfma_f32_16x16x32_bf16 v[136:139],a[228:231],a[148:151],v[136:139]
 v_mfma_f32_16x16x32_bf16 v[140:143],a[232:235],a[132:135],v[140:143]
 s_add_u32 s35,s30,9088
 buffer_load_dwordx4 v35,s[4:7],s35 offen offset:1024 lds
 v_mfma_f32_16x16x32_bf16 v[140:143],a[236:239],a[148:151],v[140:143]
 s_waitcnt vmcnt(20)
 s_waitcnt lgkmcnt(0)
 s_barrier
 v_mfma_f32_16x16x32_bf16 v[144:147],a[224:227],a[136:139],v[144:147]
 ds_read_b64_tr_b16 a[192:193],v14 offset:49152
 v_mfma_f32_16x16x32_bf16 v[144:147],a[228:231],a[152:155],v[144:147]
 ds_read_b64_tr_b16 a[194:195],v14 offset:50176
 v_mfma_f32_16x16x32_bf16 v[148:151],a[232:235],a[136:139],v[148:151]
 ds_read_b64_tr_b16 a[196:197],v14 offset:57344
 v_mfma_f32_16x16x32_bf16 v[148:151],a[236:239],a[152:155],v[148:151]
 s_add_u32 s35,s30,17280
 buffer_load_dwordx4 v34,s[4:7],s35 offen offset:2048 lds
 v_mfma_f32_16x16x32_bf16 v[160:163],a[240:243],a[128:131],v[160:163]
 ds_read_b64_tr_b16 a[198:199],v14 offset:58368
 v_mfma_f32_16x16x32_bf16 v[160:163],a[244:247],a[144:147],v[160:163]
 ds_read_b64_tr_b16 a[200:201],v15 offset:49152
 v_mfma_f32_16x16x32_bf16 v[164:167],a[248:251],a[128:131],v[164:167]
 ds_read_b64_tr_b16 a[202:203],v15 offset:50176
 v_mfma_f32_16x16x32_bf16 v[164:167],a[252:255],a[144:147],v[164:167]
 s_add_u32 s35,s30,25472
 buffer_load_dwordx4 v35,s[4:7],s35 offen offset:3072 lds
 v_mfma_f32_16x16x32_bf16 v[168:171],a[240:243],a[132:135],v[168:171]
 ds_read_b64_tr_b16 a[204:205],v15 offset:57344
 ds_read_b64_tr_b16 a[206:207],v15 offset:58368
 v_mfma_f32_16x16x32_bf16 v[168:171],a[244:247],a[148:151],v[168:171]
 s_add_u32 m0,s26,36864
 ds_read_b64_tr_b16 a[208:209],v16 offset:49152
 v_mfma_f32_16x16x32_bf16 v[172:175],a[248:251],a[132:135],v[172:175]
 s_add_u32 s35,s30,37760
 buffer_load_dwordx4 v34,s[4:7],s35 offen offset:0 lds
 v_mfma_f32_16x16x32_bf16 v[172:175],a[252:255],a[148:151],v[172:175]
 ds_read_b64_tr_b16 a[210:211],v16 offset:50176
 v_mfma_f32_16x16x32_bf16 v[176:179],a[240:243],a[136:139],v[176:179]
 ds_read_b64_tr_b16 a[212:213],v16 offset:57344
 v_mfma_f32_16x16x32_bf16 v[176:179],a[244:247],a[152:155],v[176:179]
 ds_read_b64_tr_b16 a[214:215],v16 offset:58368
 v_mfma_f32_16x16x32_bf16 v[180:183],a[248:251],a[136:139],v[180:183]
 s_add_u32 s35,s30,45952
 buffer_load_dwordx4 v35,s[4:7],s35 offen offset:1024 lds
 v_mfma_f32_16x16x32_bf16 v[180:183],a[252:255],a[152:155],v[180:183]
 s_waitcnt lgkmcnt(10)
 v_mfma_f32_16x16x32_bf16 v[64:67],a[192:195],a[160:163],v[64:67]
 s_waitcnt lgkmcnt(8)
 ds_read_b64_tr_b16 a[216:217],v17 offset:49152
 v_mfma_f32_16x16x32_bf16 v[64:67],a[196:199],a[176:179],v[64:67]
 s_waitcnt lgkmcnt(7)
 s_add_u32 m0,s25,98304
 ds_read_b64_tr_b16 a[218:219],v17 offset:50176
 v_mfma_f32_16x16x32_bf16 v[68:71],a[200:203],a[160:163],v[68:71]
 s_waitcnt lgkmcnt(6)
 s_add_u32 s34,s29,3670016
 buffer_load_dwordx4 v32,s[8:11],s34 offen offset:0 lds
 v_mfma_f32_16x16x32_bf16 v[68:71],a[204:207],a[176:179],v[68:71]
 ds_read_b64_tr_b16 a[220:221],v17 offset:57344
 ds_read_b64_tr_b16 a[222:223],v17 offset:58368
 v_mfma_f32_16x16x32_bf16 v[72:75],a[192:195],a[164:167],v[72:75]
 ds_read_b64_tr_b16 a[224:225],v18 offset:49152
 v_mfma_f32_16x16x32_bf16 v[72:75],a[196:199],a[180:183],v[72:75]
 ds_read_b64_tr_b16 a[226:227],v18 offset:50176
 ds_read_b64_tr_b16 a[228:229],v18 offset:57344
 v_mfma_f32_16x16x32_bf16 v[76:79],a[200:203],a[164:167],v[76:79]
 s_add_u32 s34,s29,3701760
 ds_read_b64_tr_b16 a[230:231],v18 offset:58368
 buffer_load_dwordx4 v32,s[8:11],s34 offen offset:1024 lds
 v_mfma_f32_16x16x32_bf16 v[76:79],a[204:207],a[180:183],v[76:79]
 s_waitcnt vmcnt(16)
 ds_read_b128 a[128:131],v22 offset:0
 v_mfma_f32_16x16x32_bf16 v[80:83],a[192:195],a[168:171],v[80:83]
 ds_read_b128 a[144:147],v23 offset:0
 v_mfma_f32_16x16x32_bf16 v[80:83],a[196:199],a[184:187],v[80:83]
 ds_read_b128 a[132:135],v22 offset:2048
 v_mfma_f32_16x16x32_bf16 v[84:87],a[200:203],a[168:171],v[84:87]
 ds_read_b128 a[148:151],v23 offset:2048
 v_mfma_f32_16x16x32_bf16 v[84:87],a[204:207],a[184:187],v[84:87]
 s_waitcnt lgkmcnt(14)
 s_add_u32 s34,s29,3733504
 buffer_load_dwordx4 v33,s[8:11],s34 offen offset:2048 lds
 v_mfma_f32_16x16x32_bf16 v[96:99],a[208:211],a[160:163],v[96:99]
 s_waitcnt lgkmcnt(12)
 ds_read_b128 a[136:139],v22 offset:4096
 ds_read_b128 a[152:155],v23 offset:4096
 v_mfma_f32_16x16x32_bf16 v[96:99],a[212:215],a[176:179],v[96:99]
 s_waitcnt lgkmcnt(12)
 ds_read_b64_tr_b16 a[232:233],v19 offset:49152
 v_mfma_f32_16x16x32_bf16 v[100:103],a[216:219],a[160:163],v[100:103]
 s_waitcnt lgkmcnt(11)
 ds_read_b64_tr_b16 a[234:235],v19 offset:50176
 v_mfma_f32_16x16x32_bf16 v[100:103],a[220:223],a[176:179],v[100:103]
 s_add_u32 s34,s29,3765248
 ds_read_b64_tr_b16 a[236:237],v19 offset:57344
 buffer_load_dwordx4 v33,s[8:11],s34 offen offset:3072 lds
 v_mfma_f32_16x16x32_bf16 v[104:107],a[208:211],a[164:167],v[104:107]
 ds_read_b64_tr_b16 a[238:239],v19 offset:58368
 v_mfma_f32_16x16x32_bf16 v[104:107],a[212:215],a[180:183],v[104:107]
 ds_read_b64_tr_b16 a[240:241],v20 offset:49152
 ds_read_b64_tr_b16 a[242:243],v20 offset:50176
 v_mfma_f32_16x16x32_bf16 v[108:111],a[216:219],a[164:167],v[108:111]
 ds_read_b64_tr_b16 a[244:245],v20 offset:57344
 v_mfma_f32_16x16x32_bf16 v[108:111],a[220:223],a[180:183],v[108:111]
 s_waitcnt lgkmcnt(7)
 s_add_u32 m0,s26,131072
 v_mfma_f32_16x16x32_bf16 v[112:115],a[208:211],a[168:171],v[112:115]
 ds_read_b64_tr_b16 a[246:247],v20 offset:58368
 ds_read_b64_tr_b16 a[248:249],v21 offset:49152
 v_mfma_f32_16x16x32_bf16 v[112:115],a[212:215],a[184:187],v[112:115]
 s_add_u32 s35,s30,1024
 ds_read_b64_tr_b16 a[250:251],v21 offset:50176
 buffer_load_dwordx4 v34,s[4:7],s35 offen offset:0 lds
 v_mfma_f32_16x16x32_bf16 v[116:119],a[216:219],a[168:171],v[116:119]
 ds_read_b64_tr_b16 a[252:253],v21 offset:57344
 v_mfma_f32_16x16x32_bf16 v[116:119],a[220:223],a[184:187],v[116:119]
 ds_read_b64_tr_b16 a[254:255],v21 offset:58368
 v_mfma_f32_16x16x32_bf16 v[128:131],a[224:227],a[160:163],v[128:131]
 v_mfma_f32_16x16x32_bf16 v[128:131],a[228:231],a[176:179],v[128:131]
 s_waitcnt lgkmcnt(10)
 s_add_u32 s35,s30,9216
 buffer_load_dwordx4 v35,s[4:7],s35 offen offset:1024 lds
 v_mfma_f32_16x16x32_bf16 v[132:135],a[232:235],a[160:163],v[132:135]
 s_waitcnt lgkmcnt(8)
 v_mfma_f32_16x16x32_bf16 v[132:135],a[236:239],a[176:179],v[132:135]
 v_mfma_f32_16x16x32_bf16 v[136:139],a[224:227],a[164:167],v[136:139]
 v_mfma_f32_16x16x32_bf16 v[136:139],a[228:231],a[180:183],v[136:139]
 v_mfma_f32_16x16x32_bf16 v[140:143],a[232:235],a[164:167],v[140:143]
 s_add_u32 s35,s30,17408
 buffer_load_dwordx4 v34,s[4:7],s35 offen offset:2048 lds
 v_mfma_f32_16x16x32_bf16 v[140:143],a[236:239],a[180:183],v[140:143]
 s_waitcnt vmcnt(17)
 s_waitcnt lgkmcnt(0)
 s_barrier
 v_mfma_f32_16x16x32_bf16 v[144:147],a[224:227],a[168:171],v[144:147]
 ds_read_b64_tr_b16 a[192:193],v14 offset:16384
 v_mfma_f32_16x16x32_bf16 v[144:147],a[228:231],a[184:187],v[144:147]
 ds_read_b64_tr_b16 a[194:195],v14 offset:17408
 v_mfma_f32_16x16x32_bf16 v[148:151],a[232:235],a[168:171],v[148:151]
 ds_read_b64_tr_b16 a[196:197],v14 offset:24576
 v_mfma_f32_16x16x32_bf16 v[148:151],a[236:239],a[184:187],v[148:151]
 ds_read_b64_tr_b16 a[198:199],v14 offset:25600
 v_mfma_f32_16x16x32_bf16 v[160:163],a[240:243],a[160:163],v[160:163]
 s_add_u32 s35,s30,25600
 buffer_load_dwordx4 v35,s[4:7],s35 offen offset:3072 lds
 v_mfma_f32_16x16x32_bf16 v[160:163],a[244:247],a[176:179],v[160:163]
 ds_read_b64_tr_b16 a[200:201],v15 offset:16384
 v_mfma_f32_16x16x32_bf16 v[164:167],a[248:251],a[160:163],v[164:167]
 ds_read_b64_tr_b16 a[202:203],v15 offset:17408
 v_mfma_f32_16x16x32_bf16 v[164:167],a[252:255],a[176:179],v[164:167]
 ds_read_b64_tr_b16 a[204:205],v15 offset:24576
 v_mfma_f32_16x16x32_bf16 v[168:171],a[240:243],a[164:167],v[168:171]
 s_add_u32 m0,s26,135168
 ds_read_b64_tr_b16 a[206:207],v15 offset:25600
 v_mfma_f32_16x16x32_bf16 v[168:171],a[244:247],a[180:183],v[168:171]
 s_add_u32 s35,s30,37888
 ds_read_b64_tr_b16 a[208:209],v16 offset:16384
 buffer_load_dwordx4 v34,s[4:7],s35 offen offset:0 lds
 v_mfma_f32_16x16x32_bf16 v[172:175],a[248:251],a[164:167],v[172:175]
 v_mfma_f32_16x16x32_bf16 v[172:175],a[252:255],a[180:183],v[172:175]
 ds_read_b64_tr_b16 a[210:211],v16 offset:17408
 v_mfma_f32_16x16x32_bf16 v[176:179],a[240:243],a[168:171],v[176:179]
 ds_read_b64_tr_b16 a[212:213],v16 offset:24576
 v_mfma_f32_16x16x32_bf16 v[176:179],a[244:247],a[184:187],v[176:179]
 ds_read_b64_tr_b16 a[214:215],v16 offset:25600
 v_mfma_f32_16x16x32_bf16 v[180:183],a[248:251],a[168:171],v[180:183]
 s_add_u32 s35,s30,46080
 buffer_load_dwordx4 v35,s[4:7],s35 offen offset:1024 lds
 v_mfma_f32_16x16x32_bf16 v[180:183],a[252:255],a[184:187],v[180:183]
 s_waitcnt lgkmcnt(10)
 v_mfma_f32_16x16x32_bf16 v[64:67],a[192:195],a[128:131],v[64:67]
 s_waitcnt lgkmcnt(8)
 ds_read_b64_tr_b16 a[216:217],v17 offset:16384
 v_mfma_f32_16x16x32_bf16 v[64:67],a[196:199],a[144:147],v[64:67]
 s_waitcnt lgkmcnt(7)
 s_add_u32 m0,s25,114688
 ds_read_b64_tr_b16 a[218:219],v17 offset:17408
 v_mfma_f32_16x16x32_bf16 v[68:71],a[200:203],a[128:131],v[68:71]
 s_waitcnt lgkmcnt(6)
 s_add_u32 s34,s29,4194304
 buffer_load_dwordx4 v32,s[8:11],s34 offen offset:0 lds
 v_mfma_f32_16x16x32_bf16 v[68:71],a[204:207],a[144:147],v[68:71]
 ds_read_b64_tr_b16 a[220:221],v17 offset:24576
 ds_read_b64_tr_b16 a[222:223],v17 offset:25600
 v_mfma_f32_16x16x32_bf16 v[72:75],a[192:195],a[132:135],v[72:75]
 ds_read_b64_tr_b16 a[224:225],v18 offset:16384
 v_mfma_f32_16x16x32_bf16 v[72:75],a[196:199],a[148:151],v[72:75]
 ds_read_b64_tr_b16 a[226:227],v18 offset:17408
 v_mfma_f32_16x16x32_bf16 v[76:79],a[200:203],a[132:135],v[76:79]
 ds_read_b64_tr_b16 a[228:229],v18 offset:24576
 ds_read_b64_tr_b16 a[230:231],v18 offset:25600
 v_mfma_f32_16x16x32_bf16 v[76:79],a[204:207],a[148:151],v[76:79]
 s_waitcnt vmcnt(11)
 ds_read_b128 a[160:163],v24 offset:0
 v_mfma_f32_16x16x32_bf16 v[80:83],a[192:195],a[136:139],v[80:83]
 ds_read_b128 a[176:179],v25 offset:0
 v_mfma_f32_16x16x32_bf16 v[80:83],a[196:199],a[152:155],v[80:83]
 ds_read_b128 a[164:167],v24 offset:2048
 v_mfma_f32_16x16x32_bf16 v[84:87],a[200:203],a[136:139],v[84:87]
 s_add_u32 s34,s29,4226048
 ds_read_b128 a[180:183],v25 offset:2048
 buffer_load_dwordx4 v32,s[8:11],s34 offen offset:1024 lds
 v_mfma_f32_16x16x32_bf16 v[84:87],a[204:207],a[152:155],v[84:87]
 s_waitcnt lgkmcnt(14)
 ds_read_b128 a[168:171],v24 offset:4096
 v_mfma_f32_16x16x32_bf16 v[96:99],a[208:211],a[128:131],v[96:99]
 s_waitcnt lgkmcnt(13)
 ds_read_b128 a[184:187],v25 offset:4096
 v_mfma_f32_16x16x32_bf16 v[96:99],a[212:215],a[144:147],v[96:99]
 s_waitcnt lgkmcnt(12)
 ds_read_b64_tr_b16 a[232:233],v19 offset:16384
 v_mfma_f32_16x16x32_bf16 v[100:103],a[216:219],a[128:131],v[100:103]
 s_waitcnt lgkmcnt(11)
 ds_read_b64_tr_b16 a[234:235],v19 offset:17408
 v_mfma_f32_16x16x32_bf16 v[100:103],a[220:223],a[144:147],v[100:103]
 ds_read_b64_tr_b16 a[236:237],v19 offset:24576
 v_mfma_f32_16x16x32_bf16 v[104:107],a[208:211],a[132:135],v[104:107]
 ds_read_b64_tr_b16 a[238:239],v19 offset:25600
 v_mfma_f32_16x16x32_bf16 v[104:107],a[212:215],a[148:151],v[104:107]
 ds_read_b64_tr_b16 a[240:241],v20 offset:16384
 ds_read_b64_tr_b16 a[242:243],v20 offset:17408
 v_mfma_f32_16x16x32_bf16 v[108:111],a[216:219],a[132:135],v[108:111]
 s_add_u32 s34,s29,4257792
 buffer_load_dwordx4 v33,s[8:11],s34 offen offset:2048 lds
 v_mfma_f32_16x16x32_bf16 v[108:111],a[220:223],a[148:151],v[108:111]
 ds_read_b64_tr_b16 a[244:245],v20 offset:24576
 ds_read_b64_tr_b16 a[246:247],v20 offset:25600
 v_mfma_f32_16x16x32_bf16 v[112:115],a[208:211],a[136:139],v[112:115]
 ds_read_b64_tr_b16 a[248:249],v21 offset:16384
 v_mfma_f32_16x16x32_bf16 v[112:115],a[212:215],a[152:155],v[112:115]
 ds_read_b64_tr_b16 a[250:251],v21 offset:17408
 v_mfma_f32_16x16x32_bf16 v[116:119],a[216:219],a[136:139],v[116:119]
 ds_read_b64_tr_b16 a[252:253],v21 offset:24576
 v_mfma_f32_16x16x32_bf16 v[116:119],a[220:223],a[152:155],v[116:119]
 s_waitcnt lgkmcnt(15)
 ds_read_b64_tr_b16 a[254:255],v21 offset:25600
 v_mfma_f32_16x16x32_bf16 v[128:131],a[224:227],a[128:131],v[128:131]
 s_waitcnt lgkmcnt(15)
 v_mfma_f32_16x16x32_bf16 v[128:131],a[228:231],a[144:147],v[128:131]
 s_waitcnt lgkmcnt(10)
 v_mfma_f32_16x16x32_bf16 v[132:135],a[232:235],a[128:131],v[132:135]
 s_waitcnt lgkmcnt(8)
 s_add_u32 s34,s29,4289536
 buffer_load_dwordx4 v33,s[8:11],s34 offen offset:3072 lds
 v_mfma_f32_16x16x32_bf16 v[132:135],a[236:239],a[144:147],v[132:135]
 v_mfma_f32_16x16x32_bf16 v[136:139],a[224:227],a[132:135],v[136:139]
 v_mfma_f32_16x16x32_bf16 v[136:139],a[228:231],a[148:151],v[136:139]
 v_mfma_f32_16x16x32_bf16 v[140:143],a[232:235],a[132:135],v[140:143]
 v_mfma_f32_16x16x32_bf16 v[140:143],a[236:239],a[148:151],v[140:143]
 s_waitcnt vmcnt(10)
 s_waitcnt lgkmcnt(0)
 s_barrier
 v_mfma_f32_16x16x32_bf16 v[144:147],a[224:227],a[136:139],v[144:147]
 ds_read_b64_tr_b16 a[192:193],v14 offset:32768
 v_mfma_f32_16x16x32_bf16 v[144:147],a[228:231],a[152:155],v[144:147]
 ds_read_b64_tr_b16 a[194:195],v14 offset:33792
 v_mfma_f32_16x16x32_bf16 v[148:151],a[232:235],a[136:139],v[148:151]
 ds_read_b64_tr_b16 a[196:197],v14 offset:40960
 v_mfma_f32_16x16x32_bf16 v[148:151],a[236:239],a[152:155],v[148:151]
 v_mfma_f32_16x16x32_bf16 v[160:163],a[240:243],a[128:131],v[160:163]
 ds_read_b64_tr_b16 a[198:199],v14 offset:41984
 v_mfma_f32_16x16x32_bf16 v[160:163],a[244:247],a[144:147],v[160:163]
 ds_read_b64_tr_b16 a[200:201],v15 offset:32768
 v_mfma_f32_16x16x32_bf16 v[164:167],a[248:251],a[128:131],v[164:167]
 ds_read_b64_tr_b16 a[202:203],v15 offset:33792
 v_mfma_f32_16x16x32_bf16 v[164:167],a[252:255],a[144:147],v[164:167]
 ds_read_b64_tr_b16 a[204:205],v15 offset:40960
 v_mfma_f32_16x16x32_bf16 v[168:171],a[240:243],a[132:135],v[168:171]
 ds_read_b64_tr_b16 a[206:207],v15 offset:41984
 v_mfma_f32_16x16x32_bf16 v[168:171],a[244:247],a[148:151],v[168:171]
 ds_read_b64_tr_b16 a[208:209],v16 offset:32768
 v_mfma_f32_16x16x32_bf16 v[172:175],a[248:251],a[132:135],v[172:175]
 v_mfma_f32_16x16x32_bf16 v[172:175],a[252:255],a[148:151],v[172:175]
 ds_read_b64_tr_b16 a[210:211],v16 offset:33792
 v_mfma_f32_16x16x32_bf16 v[176:179],a[240:243],a[136:139],v[176:179]
 ds_read_b64_tr_b16 a[212:213],v16 offset:40960
 v_mfma_f32_16x16x32_bf16 v[176:179],a[244:247],a[152:155],v[176:179]
 ds_read_b64_tr_b16 a[214:215],v16 offset:41984
 v_mfma_f32_16x16x32_bf16 v[180:183],a[248:251],a[136:139],v[180:183]
 v_mfma_f32_16x16x32_bf16 v[180:183],a[252:255],a[152:155],v[180:183]
 s_waitcnt lgkmcnt(10)
 v_mfma_f32_16x16x32_bf16 v[64:67],a[192:195],a[160:163],v[64:67]
 s_waitcnt lgkmcnt(8)
 ds_read_b64_tr_b16 a[216:217],v17 offset:32768
 ds_read_b64_tr_b16 a[218:219],v17 offset:33792
 v_mfma_f32_16x16x32_bf16 v[64:67],a[196:199],a[176:179],v[64:67]
 s_waitcnt lgkmcnt(8)
 s_add_u32 s34,s28,12288
 s_add_u32 m0,s25,81920
 v_mfma_f32_16x16x32_bf16 v[68:71],a[200:203],a[160:163],v[68:71]
 s_waitcnt lgkmcnt(6)
 ds_read_b64_tr_b16 a[220:221],v17 offset:40960
 buffer_load_dwordx4 v30,s[16:19],s34 offen offset:0 sc1 nt lds
 v_mfma_f32_16x16x32_bf16 v[68:71],a[204:207],a[176:179],v[68:71]
 ds_read_b64_tr_b16 a[222:223],v17 offset:41984
 v_mfma_f32_16x16x32_bf16 v[72:75],a[192:195],a[164:167],v[72:75]
 ds_read_b64_tr_b16 a[224:225],v18 offset:32768
 v_mfma_f32_16x16x32_bf16 v[72:75],a[196:199],a[180:183],v[72:75]
 ds_read_b64_tr_b16 a[226:227],v18 offset:33792
 v_mfma_f32_16x16x32_bf16 v[76:79],a[200:203],a[164:167],v[76:79]
 ds_read_b64_tr_b16 a[228:229],v18 offset:40960
 ds_read_b64_tr_b16 a[230:231],v18 offset:41984
 v_mfma_f32_16x16x32_bf16 v[76:79],a[204:207],a[180:183],v[76:79]
 s_waitcnt vmcnt(5)
 ds_read_b128 a[128:131],v22 offset:0
 v_mfma_f32_16x16x32_bf16 v[80:83],a[192:195],a[168:171],v[80:83]
 ds_read_b128 a[144:147],v23 offset:0
 buffer_load_dwordx4 v31,s[16:19],s34 offen offset:1024 sc1 nt lds
 v_mfma_f32_16x16x32_bf16 v[80:83],a[196:199],a[184:187],v[80:83]
 ds_read_b128 a[132:135],v22 offset:2048
 v_mfma_f32_16x16x32_bf16 v[84:87],a[200:203],a[168:171],v[84:87]
 ds_read_b128 a[148:151],v23 offset:2048
 v_mfma_f32_16x16x32_bf16 v[84:87],a[204:207],a[184:187],v[84:87]
 s_waitcnt lgkmcnt(14)
 ds_read_b128 a[136:139],v22 offset:4096
 v_mfma_f32_16x16x32_bf16 v[96:99],a[208:211],a[160:163],v[96:99]
 s_waitcnt lgkmcnt(13)
 ds_read_b128 a[152:155],v23 offset:4096
 v_mfma_f32_16x16x32_bf16 v[96:99],a[212:215],a[176:179],v[96:99]
 s_waitcnt lgkmcnt(12)
 ds_read_b64_tr_b16 a[232:233],v19 offset:32768
 buffer_load_dwordx4 v30,s[16:19],s34 offen offset:2048 sc1 nt lds
 v_mfma_f32_16x16x32_bf16 v[100:103],a[216:219],a[160:163],v[100:103]
 s_waitcnt lgkmcnt(11)
 ds_read_b64_tr_b16 a[234:235],v19 offset:33792
 v_mfma_f32_16x16x32_bf16 v[100:103],a[220:223],a[176:179],v[100:103]
 ds_read_b64_tr_b16 a[236:237],v19 offset:40960
 v_mfma_f32_16x16x32_bf16 v[104:107],a[208:211],a[164:167],v[104:107]
 ds_read_b64_tr_b16 a[238:239],v19 offset:41984
 v_mfma_f32_16x16x32_bf16 v[104:107],a[212:215],a[180:183],v[104:107]
 ds_read_b64_tr_b16 a[240:241],v20 offset:32768
 ds_read_b64_tr_b16 a[242:243],v20 offset:33792
 v_mfma_f32_16x16x32_bf16 v[108:111],a[216:219],a[164:167],v[108:111]
 ds_read_b64_tr_b16 a[244:245],v20 offset:40960
 v_mfma_f32_16x16x32_bf16 v[108:111],a[220:223],a[180:183],v[108:111]
 s_add_u32 s28,s28,16384
 buffer_load_dwordx4 v31,s[16:19],s34 offen offset:3072 sc1 nt lds
 v_mfma_f32_16x16x32_bf16 v[112:115],a[208:211],a[168:171],v[112:115]
 ds_read_b64_tr_b16 a[246:247],v20 offset:41984
 ds_read_b64_tr_b16 a[248:249],v21 offset:32768
 v_mfma_f32_16x16x32_bf16 v[112:115],a[212:215],a[184:187],v[112:115]
 ds_read_b64_tr_b16 a[250:251],v21 offset:33792
 v_mfma_f32_16x16x32_bf16 v[116:119],a[216:219],a[168:171],v[116:119]
 ds_read_b64_tr_b16 a[252:253],v21 offset:40960
 v_mfma_f32_16x16x32_bf16 v[116:119],a[220:223],a[184:187],v[116:119]
 s_waitcnt lgkmcnt(15)
 ds_read_b64_tr_b16 a[254:255],v21 offset:41984
 v_mfma_f32_16x16x32_bf16 v[128:131],a[224:227],a[160:163],v[128:131]
 s_waitcnt lgkmcnt(15)
 s_add_u32 s34,s27,12288
 s_add_u32 m0,s25,32768
 v_mfma_f32_16x16x32_bf16 v[128:131],a[228:231],a[176:179],v[128:131]
 s_waitcnt lgkmcnt(10)
 buffer_load_dwordx4 v26,s[12:15],s34 offen offset:0 sc1 nt lds
 v_mfma_f32_16x16x32_bf16 v[132:135],a[232:235],a[160:163],v[132:135]
 s_waitcnt lgkmcnt(8)
 v_mfma_f32_16x16x32_bf16 v[132:135],a[236:239],a[176:179],v[132:135]
 v_mfma_f32_16x16x32_bf16 v[136:139],a[224:227],a[164:167],v[136:139]
 v_mfma_f32_16x16x32_bf16 v[136:139],a[228:231],a[180:183],v[136:139]
 v_mfma_f32_16x16x32_bf16 v[140:143],a[232:235],a[164:167],v[140:143]
 buffer_load_dwordx4 v27,s[12:15],s34 offen offset:1024 sc1 nt lds
 v_mfma_f32_16x16x32_bf16 v[140:143],a[236:239],a[180:183],v[140:143]
 s_waitcnt vmcnt(6)
 s_waitcnt lgkmcnt(0)
 s_barrier
 v_mfma_f32_16x16x32_bf16 v[144:147],a[224:227],a[168:171],v[144:147]
 ds_read_b64_tr_b16 a[192:193],v14 offset:49152
 v_mfma_f32_16x16x32_bf16 v[144:147],a[228:231],a[184:187],v[144:147]
 ds_read_b64_tr_b16 a[194:195],v14 offset:50176
 v_mfma_f32_16x16x32_bf16 v[148:151],a[232:235],a[168:171],v[148:151]
 ds_read_b64_tr_b16 a[196:197],v14 offset:57344
 v_mfma_f32_16x16x32_bf16 v[148:151],a[236:239],a[184:187],v[148:151]
 v_mfma_f32_16x16x32_bf16 v[160:163],a[240:243],a[160:163],v[160:163]
 ds_read_b64_tr_b16 a[198:199],v14 offset:58368
 buffer_load_dwordx4 v28,s[12:15],s34 offen offset:2048 sc1 nt lds
 v_mfma_f32_16x16x32_bf16 v[160:163],a[244:247],a[176:179],v[160:163]
 ds_read_b64_tr_b16 a[200:201],v15 offset:49152
 v_mfma_f32_16x16x32_bf16 v[164:167],a[248:251],a[160:163],v[164:167]
 ds_read_b64_tr_b16 a[202:203],v15 offset:50176
 v_mfma_f32_16x16x32_bf16 v[164:167],a[252:255],a[176:179],v[164:167]
 ds_read_b64_tr_b16 a[204:205],v15 offset:57344
 v_mfma_f32_16x16x32_bf16 v[168:171],a[240:243],a[164:167],v[168:171]
 ds_read_b64_tr_b16 a[206:207],v15 offset:58368
 v_mfma_f32_16x16x32_bf16 v[168:171],a[244:247],a[180:183],v[168:171]
 s_add_u32 s27,s27,16384
 ds_read_b64_tr_b16 a[208:209],v16 offset:49152
 buffer_load_dwordx4 v29,s[12:15],s34 offen offset:3072 sc1 nt lds
 v_mfma_f32_16x16x32_bf16 v[172:175],a[248:251],a[164:167],v[172:175]
 v_mfma_f32_16x16x32_bf16 v[172:175],a[252:255],a[180:183],v[172:175]
 ds_read_b64_tr_b16 a[210:211],v16 offset:50176
 v_mfma_f32_16x16x32_bf16 v[176:179],a[240:243],a[168:171],v[176:179]
 ds_read_b64_tr_b16 a[212:213],v16 offset:57344
 v_mfma_f32_16x16x32_bf16 v[176:179],a[244:247],a[184:187],v[176:179]
 ds_read_b64_tr_b16 a[214:215],v16 offset:58368
 v_mfma_f32_16x16x32_bf16 v[180:183],a[248:251],a[168:171],v[180:183]
 v_mfma_f32_16x16x32_bf16 v[180:183],a[252:255],a[184:187],v[180:183]
 s_waitcnt lgkmcnt(10)
 v_mfma_f32_16x16x32_bf16 v[64:67],a[192:195],a[128:131],v[64:67]
 s_waitcnt lgkmcnt(8)
 ds_read_b64_tr_b16 a[216:217],v17 offset:49152
 ds_read_b64_tr_b16 a[218:219],v17 offset:50176
 v_mfma_f32_16x16x32_bf16 v[64:67],a[196:199],a[144:147],v[64:67]
 s_waitcnt lgkmcnt(8)
 s_add_u32 s34,s28,12288
 s_add_u32 m0,s25,98304
 ds_read_b64_tr_b16 a[220:221],v17 offset:57344
 v_mfma_f32_16x16x32_bf16 v[68:71],a[200:203],a[128:131],v[68:71]
 s_waitcnt lgkmcnt(7)
 ds_read_b64_tr_b16 a[222:223],v17 offset:58368
 buffer_load_dwordx4 v30,s[16:19],s34 offen offset:0 sc1 nt lds
 v_mfma_f32_16x16x32_bf16 v[68:71],a[204:207],a[144:147],v[68:71]
 ds_read_b64_tr_b16 a[224:225],v18 offset:49152
 ds_read_b64_tr_b16 a[226:227],v18 offset:50176
 v_mfma_f32_16x16x32_bf16 v[72:75],a[192:195],a[132:135],v[72:75]
 ds_read_b64_tr_b16 a[228:229],v18 offset:57344
 ds_read_b64_tr_b16 a[230:231],v18 offset:58368
 v_mfma_f32_16x16x32_bf16 v[72:75],a[196:199],a[148:151],v[72:75]
 ds_read_b64_tr_b16 a[232:233],v19 offset:49152
 ds_read_b64_tr_b16 a[234:235],v19 offset:50176
 v_mfma_f32_16x16x32_bf16 v[76:79],a[200:203],a[132:135],v[76:79]
 ds_read_b64_tr_b16 a[236:237],v19 offset:57344
 buffer_load_dwordx4 v31,s[16:19],s34 offen offset:1024 sc1 nt lds
 v_mfma_f32_16x16x32_bf16 v[76:79],a[204:207],a[148:151],v[76:79]
 s_waitcnt lgkmcnt(13)
 v_mul_f32 v64,s36,v64
 v_mul_f32 v65,s36,v65
 v_mul_f32 v66,s36,v66
 v_mul_f32 v67,s36,v67
 v_mfma_f32_16x16x32_bf16 v[96:99],a[208:211],a[128:131],v[96:99]
 s_waitcnt lgkmcnt(11)
 v_mul_f32 v68,s36,v68
 v_mul_f32 v69,s36,v69
 v_mul_f32 v70,s36,v70
 v_mul_f32 v71,s36,v71
 v_mfma_f32_16x16x32_bf16 v[96:99],a[212:215],a[144:147],v[96:99]
 s_waitcnt lgkmcnt(9)
 v_cvt_pk_bf16_f32 v64,v64,v65
 v_cvt_pk_bf16_f32 v65,v66,v67
 v_cvt_pk_bf16_f32 v66,v68,v69
 v_cvt_pk_bf16_f32 v67,v70,v71
 v_mfma_f32_16x16x32_bf16 v[100:103],a[216:219],a[128:131],v[100:103]
 s_waitcnt lgkmcnt(7)
 ds_read_b64_tr_b16 a[238:239],v19 offset:58368
 ds_read_b64_tr_b16 a[240:241],v20 offset:49152
 ds_read_b64_tr_b16 a[242:243],v20 offset:50176
 ds_read_b64_tr_b16 a[244:245],v20 offset:57344
 v_mfma_f32_16x16x32_bf16 v[100:103],a[220:223],a[144:147],v[100:103]
 v_mul_f32 v72,s36,v72
 v_mul_f32 v73,s36,v73
 v_mul_f32 v74,s36,v74
 v_mul_f32 v75,s36,v75
 v_mfma_f32_16x16x32_bf16 v[104:107],a[208:211],a[132:135],v[104:107]
 v_mul_f32 v76,s36,v76
 v_mul_f32 v77,s36,v77
 v_mul_f32 v78,s36,v78
 v_mul_f32 v79,s36,v79
 v_mfma_f32_16x16x32_bf16 v[104:107],a[212:215],a[148:151],v[104:107]
 ds_read_b64_tr_b16 a[246:247],v20 offset:58368
 buffer_load_dwordx4 v30,s[16:19],s34 offen offset:2048 sc1 nt lds
 v_permlane32_swap_b32 v64,v66
 v_mfma_f32_16x16x32_bf16 v[108:111],a[216:219],a[132:135],v[108:111]
 v_permlane32_swap_b32 v65,v67
 v_cvt_pk_bf16_f32 v72,v72,v73
 v_cvt_pk_bf16_f32 v73,v74,v75
 v_mfma_f32_16x16x32_bf16 v[108:111],a[220:223],a[148:151],v[108:111]
 s_waitcnt lgkmcnt(10)
 ds_read_b64_tr_b16 a[248:249],v21 offset:49152
 ds_read_b64_tr_b16 a[250:251],v21 offset:50176
 v_cvt_pk_bf16_f32 v74,v76,v77
 v_cvt_pk_bf16_f32 v75,v78,v79
 v_mfma_f32_16x16x32_bf16 v[128:131],a[224:227],a[128:131],v[128:131]
 s_waitcnt lgkmcnt(10)
 ds_read_b64_tr_b16 a[252:253],v21 offset:57344
 ds_read_b64_tr_b16 a[254:255],v21 offset:58368
 v_permlane16_swap_b32 v64,v66
 v_mfma_f32_16x16x32_bf16 v[128:131],a[228:231],a[144:147],v[128:131]
 s_waitcnt lgkmcnt(10)
 v_permlane16_swap_b32 v65,v67
 v_mul_f32 v96,s36,v96
 v_mul_f32 v97,s36,v97
 v_mfma_f32_16x16x32_bf16 v[132:135],a[232:235],a[128:131],v[132:135]
 s_waitcnt lgkmcnt(8)
 v_mul_f32 v98,s36,v98
 v_mul_f32 v99,s36,v99
 v_mul_f32 v100,s36,v100
 v_mul_f32 v101,s36,v101
 v_mfma_f32_16x16x32_bf16 v[132:135],a[236:239],a[144:147],v[132:135]
 v_mul_f32 v102,s36,v102
 v_mul_f32 v103,s36,v103
 v_permlane32_swap_b32 v72,v74
 v_mfma_f32_16x16x32_bf16 v[136:139],a[224:227],a[132:135],v[136:139]
 v_permlane32_swap_b32 v73,v75
 v_cvt_pk_bf16_f32 v96,v96,v97
 v_cvt_pk_bf16_f32 v97,v98,v99
 v_mfma_f32_16x16x32_bf16 v[136:139],a[228:231],a[148:151],v[136:139]
 s_add_u32 s28,s28,16384
 buffer_load_dwordx4 v31,s[16:19],s34 offen offset:3072 sc1 nt lds
 v_cvt_pk_bf16_f32 v98,v100,v101
 v_cvt_pk_bf16_f32 v99,v102,v103
 v_mfma_f32_16x16x32_bf16 v[140:143],a[232:235],a[132:135],v[140:143]
 v_permlane16_swap_b32 v72,v74
 v_permlane16_swap_b32 v73,v75
 v_mfma_f32_16x16x32_bf16 v[140:143],a[236:239],a[148:151],v[140:143]
 s_waitcnt lgkmcnt(6)
 v_mul_f32 v104,s36,v104
 v_mul_f32 v105,s36,v105
 v_mfma_f32_16x16x32_bf16 v[160:163],a[240:243],a[128:131],v[160:163]
 s_waitcnt lgkmcnt(4)
 v_mul_f32 v106,s36,v106
 v_mul_f32 v107,s36,v107
 v_mfma_f32_16x16x32_bf16 v[160:163],a[244:247],a[144:147],v[160:163]
 s_waitcnt lgkmcnt(2)
 s_add_u32 s34,s27,12288
 s_add_u32 m0,s25,49152
 v_mul_f32 v108,s36,v108
 v_mfma_f32_16x16x32_bf16 v[164:167],a[248:251],a[128:131],v[164:167]
 s_waitcnt vmcnt(63)
 s_waitcnt lgkmcnt(0)
 s_barrier
 buffer_load_dwordx4 v26,s[12:15],s34 offen offset:0 sc1 nt lds
 v_mfma_f32_16x16x32_bf16 v[164:167],a[252:255],a[144:147],v[164:167]
 v_mul_f32 v109,s36,v109
 v_mul_f32 v110,s36,v110
 v_mfma_f32_16x16x32_bf16 v[168:171],a[240:243],a[132:135],v[168:171]
 ds_read_b128 a[160:163],v2 offset:0
 ds_read_b128 a[164:167],v3 offset:0
 v_mfma_f32_16x16x32_bf16 v[168:171],a[244:247],a[148:151],v[168:171]
 ds_read_b128 a[168:171],v4 offset:0
 buffer_load_dwordx4 v27,s[12:15],s34 offen offset:1024 sc1 nt lds
 v_mfma_f32_16x16x32_bf16 v[172:175],a[248:251],a[132:135],v[172:175]
 ds_read_b128 a[172:175],v5 offset:0
 ds_read_b128 a[176:179],v2 offset:4096
 v_mfma_f32_16x16x32_bf16 v[172:175],a[252:255],a[148:151],v[172:175]
 v_mul_f32 v111,s36,v111
 v_permlane32_swap_b32 v96,v98
 v_mfma_f32_16x16x32_bf16 v[80:83],a[192:195],a[136:139],v[80:83]
 v_permlane32_swap_b32 v97,v99
 v_cvt_pk_bf16_f32 v104,v104,v105
 v_cvt_pk_bf16_f32 v105,v106,v107
 v_mfma_f32_16x16x32_bf16 v[80:83],a[196:199],a[152:155],v[80:83]
 v_cvt_pk_bf16_f32 v106,v108,v109
 v_cvt_pk_bf16_f32 v107,v110,v111
 v_mfma_f32_16x16x32_bf16 v[84:87],a[200:203],a[136:139],v[84:87]
 v_permlane16_swap_b32 v96,v98
 v_mfma_f32_16x16x32_bf16 v[84:87],a[204:207],a[152:155],v[84:87]
 ds_read_b128 a[180:183],v3 offset:4096
 buffer_load_dwordx4 v28,s[12:15],s34 offen offset:2048 sc1 nt lds
 v_mfma_f32_16x16x32_bf16 v[112:115],a[208:211],a[136:139],v[112:115]
 v_permlane16_swap_b32 v97,v99
 v_mul_f32 v128,s36,v128
 v_mfma_f32_16x16x32_bf16 v[112:115],a[212:215],a[152:155],v[112:115]
 ds_read_b128 a[184:187],v4 offset:4096
 v_mul_f32 v129,s36,v129
 v_mul_f32 v130,s36,v130
 v_mfma_f32_16x16x32_bf16 v[116:119],a[216:219],a[136:139],v[116:119]
 ds_read_b128 a[188:191],v5 offset:4096
 v_mul_f32 v131,s36,v131
 v_mul_f32 v132,s36,v132
 v_mul_f32 v133,s36,v133
 v_mfma_f32_16x16x32_bf16 v[116:119],a[220:223],a[152:155],v[116:119]
 v_mul_f32 v134,s36,v134
 v_mul_f32 v135,s36,v135
 v_permlane32_swap_b32 v104,v106
 v_mfma_f32_16x16x32_bf16 v[144:147],a[224:227],a[136:139],v[144:147]
 v_permlane32_swap_b32 v105,v107
 v_cvt_pk_bf16_f32 v128,v128,v129
 v_cvt_pk_bf16_f32 v129,v130,v131
 v_mfma_f32_16x16x32_bf16 v[144:147],a[228:231],a[152:155],v[144:147]
 v_cvt_pk_bf16_f32 v130,v132,v133
 v_cvt_pk_bf16_f32 v131,v134,v135
 v_permlane16_swap_b32 v104,v106
 v_mfma_f32_16x16x32_bf16 v[148:151],a[232:235],a[136:139],v[148:151]
 s_add_u32 s27,s27,16384
 buffer_load_dwordx4 v29,s[12:15],s34 offen offset:3072 sc1 nt lds
 v_permlane16_swap_b32 v105,v107
 v_mfma_f32_16x16x32_bf16 v[148:151],a[236:239],a[152:155],v[148:151]
 v_mul_f32 v136,s36,v136
 v_mul_f32 v137,s36,v137
 v_mfma_f32_16x16x32_bf16 v[176:179],a[240:243],a[136:139],v[176:179]
 ds_read_b128 a[224:227],v2 offset:8192
 v_mul_f32 v138,s36,v138
 v_mfma_f32_16x16x32_bf16 v[176:179],a[244:247],a[152:155],v[176:179]
 ds_read_b128 a[228:231],v3 offset:8192
 v_mul_f32 v139,s36,v139
 v_mfma_f32_16x16x32_bf16 v[180:183],a[248:251],a[136:139],v[180:183]
 ds_read_b128 a[232:235],v4 offset:8192
 ds_read_b128 a[236:239],v5 offset:8192
 v_mul_f32 v140,s36,v140
 v_mul_f32 v141,s36,v141
 v_mul_f32 v142,s36,v142
 v_mul_f32 v143,s36,v143
 v_permlane32_swap_b32 v128,v130
 v_permlane32_swap_b32 v129,v131
 v_cvt_pk_bf16_f32 v136,v136,v137
 v_cvt_pk_bf16_f32 v137,v138,v139
 v_cvt_pk_bf16_f32 v138,v140,v141
 v_cvt_pk_bf16_f32 v139,v142,v143
 v_permlane16_swap_b32 v128,v130
 v_permlane16_swap_b32 v129,v131
 v_mul_f32 v160,s36,v160
 v_mul_f32 v161,s36,v161
 v_mul_f32 v162,s36,v162
 v_mul_f32 v163,s36,v163
 v_mul_f32 v164,s36,v164
 v_mul_f32 v165,s36,v165
 v_mul_f32 v166,s36,v166
 v_mul_f32 v167,s36,v167
 v_permlane32_swap_b32 v136,v138
 v_permlane32_swap_b32 v137,v139
 v_cvt_pk_bf16_f32 v160,v160,v161
 v_cvt_pk_bf16_f32 v161,v162,v163
 v_cvt_pk_bf16_f32 v162,v164,v165
 v_cvt_pk_bf16_f32 v163,v166,v167
 v_permlane16_swap_b32 v136,v138
 v_permlane16_swap_b32 v137,v139
 v_mul_f32 v168,s36,v168
 v_mul_f32 v169,s36,v169
 v_mul_f32 v170,s36,v170
 v_mul_f32 v171,s36,v171
 v_mul_f32 v172,s36,v172
 v_mul_f32 v173,s36,v173
 v_mul_f32 v174,s36,v174
 v_mul_f32 v175,s36,v175
 v_permlane32_swap_b32 v160,v162
 v_permlane32_swap_b32 v161,v163
 v_cvt_pk_bf16_f32 v168,v168,v169
 v_cvt_pk_bf16_f32 v169,v170,v171
 v_cvt_pk_bf16_f32 v170,v172,v173
 v_cvt_pk_bf16_f32 v171,v174,v175
 v_permlane16_swap_b32 v160,v162
 v_permlane16_swap_b32 v161,v163
 v_mfma_f32_16x16x32_bf16 v[180:183],a[252:255],a[152:155],v[180:183]
 s_waitcnt lgkmcnt(11)
 v_mul_f32 v80,s36,v80
 v_mul_f32 v81,s36,v81
 v_mul_f32 v82,s36,v82
 v_mul_f32 v83,s36,v83
 v_mfma_f32_16x16x32_bf16 v[68:71],a[160:163],v[64:67],0
 s_waitcnt lgkmcnt(10)
 v_mul_f32 v84,s36,v84
 v_mul_f32 v85,s36,v85
 v_mul_f32 v86,s36,v86
 v_mul_f32 v87,s36,v87
 v_mfma_f32_16x16x32_bf16 v[68:71],a[164:167],v[96:99],v[68:71]
 s_waitcnt lgkmcnt(9)
 ds_read_b128 a[240:243],v2 offset:12288
 ds_read_b128 a[244:247],v3 offset:12288
 v_permlane32_swap_b32 v168,v170
 v_mfma_f32_16x16x32_bf16 v[68:71],a[168:171],v[128:131],v[68:71]
 s_waitcnt lgkmcnt(10)
 ds_read_b128 a[248:251],v4 offset:12288
 v_permlane32_swap_b32 v169,v171
 v_cvt_pk_bf16_f32 v80,v80,v81
 v_mfma_f32_16x16x32_bf16 v[68:71],a[172:175],v[160:163],v[68:71]
 s_waitcnt lgkmcnt(10)
 ds_read_b128 a[252:255],v5 offset:12288
 v_cvt_pk_bf16_f32 v81,v82,v83
 v_cvt_pk_bf16_f32 v82,v84,v85
 v_cvt_pk_bf16_f32 v83,v86,v87
 v_mfma_f32_16x16x32_bf16 v[100:103],a[176:179],v[64:67],0
 s_waitcnt lgkmcnt(10)
 v_permlane16_swap_b32 v168,v170
 v_permlane16_swap_b32 v169,v171
 v_mfma_f32_16x16x32_bf16 v[100:103],a[180:183],v[96:99],v[100:103]
 s_waitcnt lgkmcnt(9)
 v_mul_f32 v112,s36,v112
 v_mul_f32 v113,s36,v113
 v_mul_f32 v114,s36,v114
 v_mul_f32 v115,s36,v115
 v_mfma_f32_16x16x32_bf16 v[100:103],a[184:187],v[128:131],v[100:103]
 s_waitcnt lgkmcnt(8)
 v_mul_f32 v116,s36,v116
 v_mul_f32 v117,s36,v117
 v_mul_f32 v118,s36,v118
 v_mul_f32 v119,s36,v119
 v_mfma_f32_16x16x32_bf16 v[100:103],a[188:191],v[160:163],v[100:103]
 v_permlane32_swap_b32 v80,v82
 v_permlane32_swap_b32 v81,v83
 v_mfma_f32_16x16x32_bf16 v[76:79],a[160:163],v[72:75],0
 v_cvt_pk_bf16_f32 v112,v112,v113
 v_cvt_pk_bf16_f32 v113,v114,v115
 v_cvt_pk_bf16_f32 v114,v116,v117
 v_cvt_pk_bf16_f32 v115,v118,v119
 v_mfma_f32_16x16x32_bf16 v[76:79],a[164:167],v[104:107],v[76:79]
 v_permlane16_swap_b32 v80,v82
 v_permlane16_swap_b32 v81,v83
 v_mfma_f32_16x16x32_bf16 v[76:79],a[168:171],v[136:139],v[76:79]
 v_mul_f32 v144,s36,v144
 v_mul_f32 v145,s36,v145
 v_mul_f32 v146,s36,v146
 v_mfma_f32_16x16x32_bf16 v[76:79],a[172:175],v[168:171],v[76:79]
 s_waitcnt vmcnt(63)
 s_waitcnt lgkmcnt(0)
 s_barrier
 v_mul_f32 v147,s36,v147
 v_mfma_f32_16x16x32_bf16 v[108:111],a[176:179],v[72:75],0
 v_mul_f32 v148,s36,v148
 v_mul_f32 v149,s36,v149
 v_mfma_f32_16x16x32_bf16 v[108:111],a[180:183],v[104:107],v[108:111]
 v_mul_f32 v150,s36,v150
 v_mul_f32 v151,s36,v151
 v_mfma_f32_16x16x32_bf16 v[108:111],a[184:187],v[136:139],v[108:111]
 v_permlane32_swap_b32 v112,v114
 v_permlane32_swap_b32 v113,v115
 v_cvt_pk_bf16_f32 v144,v144,v145
 v_cvt_pk_bf16_f32 v145,v146,v147
 v_cvt_pk_bf16_f32 v146,v148,v149
 v_cvt_pk_bf16_f32 v147,v150,v151
 v_permlane16_swap_b32 v112,v114
 v_permlane16_swap_b32 v113,v115
 v_mul_f32 v176,s36,v176
 v_mul_f32 v177,s36,v177
 v_mul_f32 v178,s36,v178
 v_mul_f32 v179,s36,v179
 v_mul_f32 v180,s36,v180
 v_mul_f32 v181,s36,v181
 v_mul_f32 v182,s36,v182
 v_mul_f32 v183,s36,v183
 v_permlane32_swap_b32 v144,v146
 v_permlane32_swap_b32 v145,v147
 v_cvt_pk_bf16_f32 v176,v176,v177
 v_cvt_pk_bf16_f32 v177,v178,v179
 v_cvt_pk_bf16_f32 v178,v180,v181
 v_cvt_pk_bf16_f32 v179,v182,v183
 v_permlane16_swap_b32 v144,v146
 v_permlane16_swap_b32 v145,v147
 s_nop 1
 v_permlane32_swap_b32 v176,v178
 v_permlane32_swap_b32 v177,v179
 s_nop 1
 v_permlane16_swap_b32 v176,v178
 v_permlane16_swap_b32 v177,v179
 s_nop 0
 v_mfma_f32_16x16x32_bf16 v[108:111],a[188:191],v[168:171],v[108:111]
 s_add_u32 s34,s27,0
 s_mov_b32 m0,0
 ds_read_b128 a[192:195],v2 offset:16384
 v_mfma_f32_16x16x32_bf16 v[84:87],a[160:163],v[80:83],0
 ds_read_b128 a[196:199],v3 offset:16384
 buffer_load_dwordx4 v26,s[12:15],s34 offen offset:0 sc1 nt lds
 v_mfma_f32_16x16x32_bf16 v[84:87],a[164:167],v[112:115],v[84:87]
 ds_read_b128 a[200:203],v4 offset:16384
 ds_read_b128 a[204:207],v5 offset:16384
 v_mfma_f32_16x16x32_bf16 v[84:87],a[168:171],v[144:147],v[84:87]
 ds_read_b128 a[208:211],v2 offset:20480
 ds_read_b128 a[212:215],v3 offset:20480
 v_mfma_f32_16x16x32_bf16 v[84:87],a[172:175],v[176:179],v[84:87]
 ds_read_b128 a[216:219],v4 offset:20480
 ds_read_b128 a[220:223],v5 offset:20480
 v_mfma_f32_16x16x32_bf16 v[116:119],a[176:179],v[80:83],0
 v_max3_f32 v40,v68,v69,v70
 v_max3_f32 v41,v76,v77,v78
 v_max3_f32 v44,v71,v100,v101
 v_max3_f32 v45,v79,v108,v109
 v_mfma_f32_16x16x32_bf16 v[116:119],a[180:183],v[112:115],v[116:119]
 v_max3_f32 v40,v40,v102,v103
 v_max3_f32 v41,v41,v110,v111
 v_max_f32 v40,v40,v44
 v_max_f32 v41,v41,v45
 v_mov_b32 v44,v40
 v_mov_b32 v45,v41
 s_nop 0
 v_permlane32_swap_b32 v40,v44
 v_permlane32_swap_b32 v41,v45
 v_max_f32 v40,v40,v44
 v_max_f32 v41,v41,v45
 v_mov_b32 v44,v40
 v_mov_b32 v45,v41
 s_nop 0
 v_permlane16_swap_b32 v40,v44
 v_permlane16_swap_b32 v41,v45
 v_max_f32 v40,v40,v44
 v_max_f32 v41,v41,v45
 v_sub_f32 v224,0,v40
 v_sub_f32 v225,0,v40
 v_sub_f32 v226,0,v40
 v_sub_f32 v227,0,v40
 v_mfma_f32_16x16x32_bf16 v[116:119],a[184:187],v[144:147],v[116:119]
 v_sub_f32 v228,0,v41
 v_sub_f32 v229,0,v41
 v_sub_f32 v230,0,v41
 v_sub_f32 v231,0,v41
 v_mfma_f32_16x16x32_bf16 v[116:119],a[188:191],v[176:179],v[116:119]
 v_sub_f32 v68,v68,v40
 v_sub_f32 v69,v69,v40
 v_sub_f32 v70,v70,v40
 v_mfma_f32_16x16x32_bf16 v[132:135],a[224:227],v[64:67],v[224:227]
 buffer_load_dwordx4 v27,s[12:15],s34 offen offset:1024 sc1 nt lds
 v_exp_f32 v68,v68
 v_sub_f32 v71,v71,v40
 v_mfma_f32_16x16x32_bf16 v[132:135],a[228:231],v[96:99],v[132:135]
 v_exp_f32 v69,v69
 v_sub_f32 v100,v100,v40
 v_mfma_f32_16x16x32_bf16 v[132:135],a[232:235],v[128:131],v[132:135]
 v_exp_f32 v70,v70
 v_sub_f32 v101,v101,v40
 v_mfma_f32_16x16x32_bf16 v[132:135],a[236:239],v[160:163],v[132:135]
 v_exp_f32 v71,v71
 v_mfma_f32_16x16x32_bf16 v[164:167],a[240:243],v[64:67],v[224:227]
 v_mov_b32 v48,0x3f803f80
 v_accvgpr_write_b32 a188,v48
 v_accvgpr_write_b32 a189,v48
 v_accvgpr_write_b32 a190,v48
 v_mfma_f32_16x16x32_bf16 v[164:167],a[244:247],v[96:99],v[164:167]
 v_accvgpr_write_b32 a191,v48
 v_max3_f32 v42,v84,v85,v86
 v_max3_f32 v46,v87,v116,v117
 v_max3_f32 v42,v42,v118,v119
 v_mfma_f32_16x16x32_bf16 v[164:167],a[248:251],v[128:131],v[164:167]
 v_max_f32 v42,v42,v46
 v_mov_b32 v46,v42
 s_nop 1
 v_permlane32_swap_b32 v42,v46
 v_mfma_f32_16x16x32_bf16 v[164:167],a[252:255],v[160:163],v[164:167]
 v_max_f32 v42,v42,v46
 v_mov_b32 v46,v42
 s_nop 1
 v_mfma_f32_16x16x32_bf16 v[140:143],a[224:227],v[72:75],v[228:231]
 v_permlane16_swap_b32 v42,v46
 v_mfma_f32_16x16x32_bf16 v[140:143],a[228:231],v[104:107],v[140:143]
 buffer_load_dwordx4 v28,s[12:15],s34 offen offset:2048 sc1 nt lds
 v_max_f32 v42,v42,v46
 v_sub_f32 v232,0,v42
 v_mfma_f32_16x16x32_bf16 v[140:143],a[232:235],v[136:139],v[140:143]
 v_sub_f32 v233,0,v42
 v_sub_f32 v234,0,v42
 v_sub_f32 v235,0,v42
 v_sub_f32 v84,v84,v42
 v_mfma_f32_16x16x32_bf16 v[140:143],a[236:239],v[168:171],v[140:143]
 v_sub_f32 v85,v85,v42
 v_sub_f32 v86,v86,v42
 v_exp_f32 v84,v84
 v_mfma_f32_16x16x32_bf16 v[172:175],a[240:243],v[72:75],v[228:231]
 v_sub_f32 v87,v87,v42
 v_exp_f32 v85,v85
 v_mfma_f32_16x16x32_bf16 v[172:175],a[244:247],v[104:107],v[172:175]
 v_sub_f32 v116,v116,v42
 v_exp_f32 v86,v86
 v_sub_f32 v117,v117,v42
 v_mfma_f32_16x16x32_bf16 v[172:175],a[248:251],v[136:139],v[172:175]
 v_exp_f32 v87,v87
 v_cvt_pk_bf16_f32 v200,v84,v85
 v_sub_f32 v118,v118,v42
 v_mfma_f32_16x16x32_bf16 v[172:175],a[252:255],v[168:171],v[172:175]
 v_exp_f32 v116,v116
 v_sub_f32 v119,v119,v42
 v_mfma_f32_16x16x32_bf16 v[148:151],a[224:227],v[80:83],v[232:235]
 v_exp_f32 v117,v117
 v_cvt_pk_bf16_f32 v201,v86,v87
 v_mfma_f32_16x16x32_bf16 v[148:151],a[228:231],v[112:115],v[148:151]
 v_exp_f32 v118,v118
 v_exp_f32 v119,v119
 v_mfma_f32_16x16x32_bf16 v[148:151],a[232:235],v[144:147],v[148:151]
 buffer_load_dwordx4 v29,s[12:15],s34 offen offset:3072 sc1 nt lds
 v_cvt_pk_bf16_f32 v202,v116,v117
 v_cvt_pk_bf16_f32 v203,v118,v119
 v_mfma_f32_16x16x32_bf16 v[148:151],a[236:239],v[176:179],v[148:151]
 v_cvt_pk_bf16_f32 v192,v68,v69
 v_sub_f32 v102,v102,v40
 v_mfma_f32_16x16x32_bf16 v[180:183],a[240:243],v[80:83],v[232:235]
 v_exp_f32 v100,v100
 v_sub_f32 v103,v103,v40
 v_mfma_f32_16x16x32_bf16 v[180:183],a[244:247],v[112:115],v[180:183]
 v_exp_f32 v101,v101
 v_mfma_f32_16x16x32_bf16 v[180:183],a[248:251],v[144:147],v[180:183]
 v_cvt_pk_bf16_f32 v193,v70,v71
 v_sub_f32 v76,v76,v41
 v_mfma_f32_16x16x32_bf16 v[180:183],a[252:255],v[176:179],v[180:183]
 v_exp_f32 v102,v102
 v_sub_f32 v77,v77,v41
 v_exp_f32 v103,v103
 v_cvt_pk_bf16_f32 v194,v100,v101
 v_sub_f32 v78,v78,v41
 v_exp_f32 v76,v76
 v_sub_f32 v79,v79,v41
 v_exp_f32 v77,v77
 v_cvt_pk_bf16_f32 v195,v102,v103
 v_sub_f32 v108,v108,v41
 v_exp_f32 v78,v78
 v_sub_f32 v109,v109,v41
 v_exp_f32 v79,v79
 v_cvt_pk_bf16_f32 v196,v76,v77
 v_sub_f32 v110,v110,v41
 v_exp_f32 v108,v108
 v_sub_f32 v111,v111,v41
 v_exp_f32 v109,v109
 v_cvt_pk_bf16_f32 v197,v78,v79
 v_exp_f32 v110,v110
 v_exp_f32 v111,v111
 v_cvt_pk_bf16_f32 v198,v108,v109
 v_cvt_pk_bf16_f32 v199,v110,v111
 s_add_u32 s31,s31,4096
 s_mov_b32 s33,1
 s_mov_b32 s29,1073741824
 s_mov_b32 s30,1073741824
 s_mov_b32 s66,s58
 s_mov_b32 s94,s93
 s_bfe_u32 s68,s2,0x10003
 s_lshl_b32 s68,s68,13
 s_add_u32 s95,s68,K1_op-K1_pc
 s_add_u32 s95,s95,s26
 s_branch K1_attnc
K1_finc:
 s_waitcnt lgkmcnt(7)
 v_mfma_f32_16x16x32_bf16 v[68:71],a[192:195],v[64:67],v[224:227]
 s_waitcnt lgkmcnt(6)
 ds_read_b64_tr_b16 a[224:225],v6 offset:16384
 v_exp_f32 v132,v132
 v_mfma_f32_16x16x32_bf16 v[68:71],a[196:199],v[96:99],v[68:71]
 s_waitcnt lgkmcnt(6)
 v_exp_f32 v133,v133
 v_mfma_f32_16x16x32_bf16 v[68:71],a[200:203],v[128:131],v[68:71]
 s_waitcnt lgkmcnt(5)
 ds_read_b64_tr_b16 a[226:227],v6 offset:20480
 ds_read_b64_tr_b16 a[228:229],v6 offset:24576
 v_mfma_f32_16x16x32_bf16 v[68:71],a[204:207],v[160:163],v[68:71]
 s_mov_b32 m0,162816
 v_exp_f32 v134,v134
 v_mfma_f32_16x16x32_bf16 v[76:79],a[192:195],v[72:75],v[228:231]
 s_add_u32 s35,s93,0
 buffer_load_dwordx4 v252,s[88:91],s35 offen lds
 v_add_u32 v22,0,v0
 v_mfma_f32_16x16x32_bf16 v[76:79],a[196:199],v[104:107],v[76:79]
 ds_read_b64_tr_b16 a[230:231],v6 offset:28672
 v_exp_f32 v135,v135
 v_mfma_f32_16x16x32_bf16 v[76:79],a[200:203],v[136:139],v[76:79]
 v_cvt_pk_bf16_f32 v208,v132,v133
 v_mul_u32_u24 v23,2731,v22
 v_mfma_f32_16x16x32_bf16 v[76:79],a[204:207],v[168:171],v[76:79]
 ds_read_b64_tr_b16 a[232:233],v7 offset:16384
 v_exp_f32 v140,v140
 v_mfma_f32_16x16x32_bf16 v[84:87],a[192:195],v[80:83],v[232:235]
 v_exp_f32 v141,v141
 v_lshrrev_b32 v23,16,v23
 v_mfma_f32_16x16x32_bf16 v[84:87],a[196:199],v[112:115],v[84:87]
 s_add_u32 s35,s93,1024
 ds_read_b64_tr_b16 a[234:235],v7 offset:20480
 buffer_load_dwordx4 v252,s[88:91],s35 offen lds
 v_cvt_pk_bf16_f32 v209,v134,v135
 v_mfma_f32_16x16x32_bf16 v[84:87],a[200:203],v[144:147],v[84:87]
 v_exp_f32 v142,v142
 v_mul_u32_u24 v24,24,v23
 v_mfma_f32_16x16x32_bf16 v[84:87],a[204:207],v[176:179],v[84:87]
 s_waitcnt lgkmcnt(9)
 v_exp_f32 v143,v143
 v_mfma_f32_16x16x32_bf16 v[100:103],a[208:211],v[64:67],v[224:227]
 s_waitcnt lgkmcnt(8)
 ds_read_b128 a[192:195],v2 offset:40960
 v_sub_u32 v22,v22,v24
 v_mfma_f32_16x16x32_bf16 v[100:103],a[212:215],v[96:99],v[100:103]
 s_waitcnt lgkmcnt(8)
 ds_read_b128 a[196:199],v3 offset:40960
 v_cvt_pk_bf16_f32 v212,v140,v141
 v_exp_f32 v148,v148
 v_mfma_f32_16x16x32_bf16 v[100:103],a[216:219],v[128:131],v[100:103]
 s_waitcnt lgkmcnt(8)
 ds_read_b128 a[200:203],v4 offset:40960
 v_and_b32 v24,6,v23
 v_mfma_f32_16x16x32_bf16 v[100:103],a[220:223],v[160:163],v[100:103]
 v_exp_f32 v149,v149
 v_mfma_f32_16x16x32_bf16 v[108:111],a[208:211],v[72:75],v[228:231]
 s_add_u32 s35,s93,2048
 ds_read_b128 a[204:207],v5 offset:40960
 buffer_load_dwordx4 v252,s[88:91],s35 offen lds
 v_cvt_pk_bf16_f32 v213,v142,v143
 v_xor_b32 v22,v22,v24
 v_mfma_f32_16x16x32_bf16 v[108:111],a[212:215],v[104:107],v[108:111]
 v_exp_f32 v150,v150
 v_mfma_f32_16x16x32_bf16 v[108:111],a[216:219],v[136:139],v[108:111]
 v_exp_f32 v151,v151
 v_add_u32 v22,s101,v22
 v_mfma_f32_16x16x32_bf16 v[108:111],a[220:223],v[168:171],v[108:111]
 ds_read_b64_tr_b16 a[236:237],v7 offset:24576
 v_cvt_pk_bf16_f32 v216,v148,v149
 v_mfma_f32_16x16x32_bf16 v[116:119],a[208:211],v[80:83],v[232:235]
 v_exp_f32 v164,v164
 v_subrev_u32 v24,24,v22
 v_mfma_f32_16x16x32_bf16 v[116:119],a[212:215],v[112:115],v[116:119]
 v_exp_f32 v165,v165
 v_mfma_f32_16x16x32_bf16 v[116:119],a[216:219],v[144:147],v[116:119]
 s_add_u32 s35,s93,3072
 ds_read_b64_tr_b16 a[238:239],v7 offset:28672
 buffer_load_dwordx4 v252,s[88:91],s35 offen lds
 v_mfma_f32_16x16x32_bf16 v[116:119],a[220:223],v[176:179],v[116:119]
 s_waitcnt lgkmcnt(5)
 v_cvt_pk_bf16_f32 v217,v150,v151
 v_min_u32 v22,v22,v24
 v_mfma_f32_16x16x32_bf16 v[132:135],a[192:195],v[64:67],v[224:227]
 s_waitcnt lgkmcnt(4)
 ds_read_b128 a[208:211],v2 offset:45056
 v_exp_f32 v166,v166
 v_mul_u32_u24 v23,1152,v23
 v_mfma_f32_16x16x32_bf16 v[132:135],a[196:199],v[96:99],v[132:135]
 s_waitcnt lgkmcnt(4)
 ds_read_b128 a[212:215],v3 offset:45056
 v_exp_f32 v167,v167
 v_mfma_f32_16x16x32_bf16 v[132:135],a[200:203],v[128:131],v[132:135]
 s_waitcnt lgkmcnt(4)
 v_cvt_pk_bf16_f32 v210,v164,v165
 v_lshl_add_u32 v14,v22,4,v23
 v_mfma_f32_16x16x32_bf16 v[132:135],a[204:207],v[160:163],v[132:135]
 ds_read_b128 a[216:219],v4 offset:45056
 v_exp_f32 v172,v172
 v_mfma_f32_16x16x32_bf16 v[140:143],a[192:195],v[72:75],v[228:231]
 s_add_u32 s35,s93,4096
 ds_read_b128 a[220:223],v5 offset:45056
 buffer_load_dwordx4 v252,s[88:91],s35 offen lds
 v_add_u32 v22,64,v0
 v_mfma_f32_16x16x32_bf16 v[140:143],a[196:199],v[104:107],v[140:143]
 v_exp_f32 v173,v173
 v_mfma_f32_16x16x32_bf16 v[140:143],a[200:203],v[136:139],v[140:143]
 v_cvt_pk_bf16_f32 v211,v166,v167
 v_mul_u32_u24 v23,2731,v22
 v_mfma_f32_16x16x32_bf16 v[140:143],a[204:207],v[168:171],v[140:143]
 v_exp_f32 v174,v174
 v_mfma_f32_16x16x32_bf16 v[148:151],a[192:195],v[80:83],v[232:235]
 ds_read_b64_tr_b16 a[240:241],v8 offset:16384
 v_lshrrev_b32 v23,16,v23
 v_mfma_f32_16x16x32_bf16 v[148:151],a[196:199],v[112:115],v[148:151]
 v_exp_f32 v175,v175
 v_mfma_f32_16x16x32_bf16 v[148:151],a[200:203],v[144:147],v[148:151]
 s_add_u32 s35,s93,5120
 buffer_load_dwordx4 v252,s[88:91],s35 offen lds
 v_cvt_pk_bf16_f32 v214,v172,v173
 v_mfma_f32_16x16x32_bf16 v[148:151],a[204:207],v[176:179],v[148:151]
 s_waitcnt lgkmcnt(4)
 ds_read_b64_tr_b16 a[242:243],v8 offset:20480
 v_mul_u32_u24 v24,24,v23
 v_mfma_f32_16x16x32_bf16 v[164:167],a[208:211],v[64:67],v[224:227]
 s_waitcnt lgkmcnt(4)
 v_exp_f32 v180,v180
 v_mfma_f32_16x16x32_bf16 v[164:167],a[212:215],v[96:99],v[164:167]
 s_waitcnt lgkmcnt(3)
 ds_read_b64_tr_b16 a[244:245],v8 offset:24576
 v_sub_u32 v22,v22,v24
 v_mfma_f32_16x16x32_bf16 v[164:167],a[216:219],v[128:131],v[164:167]
 s_waitcnt lgkmcnt(3)
 v_exp_f32 v181,v181
 v_mfma_f32_16x16x32_bf16 v[164:167],a[220:223],v[160:163],v[164:167]
 v_cvt_pk_bf16_f32 v215,v174,v175
 v_and_b32 v24,6,v23
 v_mfma_f32_16x16x32_bf16 v[172:175],a[208:211],v[72:75],v[228:231]
 v_exp_f32 v182,v182
 v_mfma_f32_16x16x32_bf16 v[172:175],a[212:215],v[104:107],v[172:175]
 s_add_u32 s35,s93,6144
 buffer_load_dwordx4 v252,s[88:91],s35 offen lds
 v_xor_b32 v22,v22,v24
 v_mfma_f32_16x16x32_bf16 v[172:175],a[216:219],v[136:139],v[172:175]
 v_exp_f32 v183,v183
 v_mfma_f32_16x16x32_bf16 v[172:175],a[220:223],v[168:171],v[172:175]
 v_cvt_pk_bf16_f32 v218,v180,v181
 v_cvt_pk_bf16_f32 v219,v182,v183
 v_mfma_f32_16x16x32_bf16 v[180:183],a[208:211],v[80:83],v[232:235]
 ds_read_b64_tr_b16 a[246:247],v8 offset:28672
 ds_read_b64_tr_b16 a[248:249],v9 offset:16384
 v_mfma_f32_16x16x32_bf16 v[180:183],a[212:215],v[112:115],v[180:183]
 v_add_u32 v22,s101,v22
 v_subrev_u32 v24,24,v22
 v_mfma_f32_16x16x32_bf16 v[180:183],a[216:219],v[144:147],v[180:183]
 v_exp_f32 v68,v68
 v_mfma_f32_16x16x32_bf16 v[180:183],a[220:223],v[176:179],v[180:183]
 ds_read_b64_tr_b16 a[250:251],v9 offset:20480
 v_min_u32 v22,v22,v24
 v_mfma_f32_16x16x32_bf16 a[0:3],a[224:227],v[204:207],a[0:3]
 v_exp_f32 v69,v69
 v_mfma_f32_16x16x32_bf16 a[0:3],a[228:231],v[208:211],a[0:3]
 s_add_u32 s35,s93,7168
 buffer_load_dwordx4 v252,s[88:91],s35 offen lds
 v_mul_u32_u24 v23,1152,v23
 v_mfma_f32_16x16x32_bf16 a[4:7],a[224:227],v[220:223],a[4:7]
 v_exp_f32 v70,v70
 v_mfma_f32_16x16x32_bf16 a[4:7],a[228:231],v[212:215],a[4:7]
 ds_read_b64_tr_b16 a[252:253],v9 offset:24576
 v_lshl_add_u32 v15,v22,4,v23
 v_mfma_f32_16x16x32_bf16 a[8:11],a[224:227],v[236:239],a[8:11]
 v_exp_f32 v71,v71
 v_mfma_f32_16x16x32_bf16 a[8:11],a[228:231],v[216:219],a[8:11]
 ds_read_b64_tr_b16 a[254:255],v9 offset:28672
 v_cvt_pk_bf16_f32 v192,v68,v69
 v_mfma_f32_16x16x32_bf16 a[16:19],a[232:235],v[204:207],a[16:19]
 ds_read_b64_tr_b16 a[224:225],v10 offset:16384
 v_add_u32 v22,128,v0
 v_mfma_f32_16x16x32_bf16 a[16:19],a[236:239],v[208:211],a[16:19]
 s_add_u32 s35,s93,8192
 buffer_load_dwordx4 v252,s[88:91],s35 offen lds
 v_mul_u32_u24 v23,2731,v22
 v_mfma_f32_16x16x32_bf16 a[20:23],a[232:235],v[220:223],a[20:23]
 ds_read_b64_tr_b16 a[226:227],v10 offset:20480
 ds_read_b64_tr_b16 a[228:229],v10 offset:24576
 v_mfma_f32_16x16x32_bf16 a[20:23],a[236:239],v[212:215],a[20:23]
 v_exp_f32 v100,v100
 v_mfma_f32_16x16x32_bf16 a[24:27],a[232:235],v[236:239],a[24:27]
 ds_read_b64_tr_b16 a[230:231],v10 offset:28672
 v_lshrrev_b32 v23,16,v23
 v_mfma_f32_16x16x32_bf16 a[24:27],a[236:239],v[216:219],a[24:27]
 s_waitcnt lgkmcnt(10)
 ds_read_b64_tr_b16 a[232:233],v11 offset:16384
 v_mul_u32_u24 v24,24,v23
 v_mfma_f32_16x16x32_bf16 a[32:35],a[240:243],v[204:207],a[32:35]
 s_waitcnt lgkmcnt(9)
 v_exp_f32 v101,v101
 v_mfma_f32_16x16x32_bf16 a[32:35],a[244:247],v[208:211],a[32:35]
 s_add_u32 s35,s93,9216
 buffer_load_dwordx4 v252,s[88:91],s35 offen lds
 v_sub_u32 v22,v22,v24
 v_mfma_f32_16x16x32_bf16 a[36:39],a[240:243],v[220:223],a[36:39]
 ds_read_b64_tr_b16 a[234:235],v11 offset:20480
 v_cvt_pk_bf16_f32 v193,v70,v71
 v_mfma_f32_16x16x32_bf16 a[36:39],a[244:247],v[212:215],a[36:39]
 ds_read_b64_tr_b16 a[236:237],v11 offset:24576
 v_and_b32 v24,6,v23
 v_mfma_f32_16x16x32_bf16 a[40:43],a[240:243],v[236:239],a[40:43]
 v_exp_f32 v102,v102
 v_mfma_f32_16x16x32_bf16 a[40:43],a[244:247],v[216:219],a[40:43]
 s_waitcnt lgkmcnt(9)
 ds_read_b64_tr_b16 a[238:239],v11 offset:28672
 v_xor_b32 v22,v22,v24
 v_mfma_f32_16x16x32_bf16 a[48:51],a[248:251],v[204:207],a[48:51]
 s_waitcnt lgkmcnt(8)
 ds_read_b64_tr_b16 a[240:241],v12 offset:16384
 ds_read_b64_tr_b16 a[242:243],v12 offset:20480
 v_mfma_f32_16x16x32_bf16 a[48:51],a[252:255],v[208:211],a[48:51]
 s_add_u32 s35,s93,10240
 buffer_load_dwordx4 v252,s[88:91],s35 offen lds
 v_add_u32 v22,s101,v22
 v_mfma_f32_16x16x32_bf16 a[52:55],a[248:251],v[220:223],a[52:55]
 v_exp_f32 v103,v103
 v_mfma_f32_16x16x32_bf16 a[52:55],a[252:255],v[212:215],a[52:55]
 ds_read_b64_tr_b16 a[244:245],v12 offset:24576
 v_subrev_u32 v24,24,v22
 v_mfma_f32_16x16x32_bf16 a[56:59],a[248:251],v[236:239],a[56:59]
 ds_read_b64_tr_b16 a[246:247],v12 offset:28672
 v_cvt_pk_bf16_f32 v194,v100,v101
 v_mfma_f32_16x16x32_bf16 a[56:59],a[252:255],v[216:219],a[56:59]
 s_waitcnt lgkmcnt(10)
 ds_read_b64_tr_b16 a[248:249],v13 offset:16384
 v_min_u32 v22,v22,v24
 v_mfma_f32_16x16x32_bf16 a[64:67],a[224:227],v[204:207],a[64:67]
 s_waitcnt lgkmcnt(9)
 v_exp_f32 v76,v76
 v_mfma_f32_16x16x32_bf16 a[64:67],a[228:231],v[208:211],a[64:67]
 s_add_u32 s35,s93,11264
 buffer_load_dwordx4 v252,s[88:91],s35 offen lds
 v_mul_u32_u24 v23,1152,v23
 v_mfma_f32_16x16x32_bf16 a[68:71],a[224:227],v[220:223],a[68:71]
 ds_read_b64_tr_b16 a[250:251],v13 offset:20480
 v_exp_f32 v77,v77
 v_mfma_f32_16x16x32_bf16 a[68:71],a[228:231],v[212:215],a[68:71]
 ds_read_b64_tr_b16 a[252:253],v13 offset:24576
 v_cvt_pk_bf16_f32 v195,v102,v103
 v_mfma_f32_16x16x32_bf16 a[72:75],a[224:227],v[236:239],a[72:75]
 ds_read_b64_tr_b16 a[254:255],v13 offset:28672
 v_lshl_add_u32 v16,v22,4,v23
 v_mfma_f32_16x16x32_bf16 a[72:75],a[228:231],v[216:219],a[72:75]
 s_waitcnt lgkmcnt(10)
 v_exp_f32 v78,v78
 v_mfma_f32_16x16x32_bf16 a[80:83],a[232:235],v[204:207],a[80:83]
 s_waitcnt lgkmcnt(8)
 v_exp_f32 v79,v79
 v_cvt_pk_bf16_f32 v196,v76,v77
 v_mfma_f32_16x16x32_bf16 a[80:83],a[236:239],v[208:211],a[80:83]
 s_add_u32 s35,s93,12288
 buffer_load_dwordx4 v252,s[88:91],s35 offen lds
 v_exp_f32 v108,v108
 v_mfma_f32_16x16x32_bf16 a[84:87],a[232:235],v[220:223],a[84:87]
 v_exp_f32 v109,v109
 v_cvt_pk_bf16_f32 v197,v78,v79
 v_mfma_f32_16x16x32_bf16 a[84:87],a[236:239],v[212:215],a[84:87]
 v_exp_f32 v110,v110
 v_mfma_f32_16x16x32_bf16 a[88:91],a[232:235],v[236:239],a[88:91]
 v_exp_f32 v111,v111
 v_cvt_pk_bf16_f32 v198,v108,v109
 v_mfma_f32_16x16x32_bf16 a[88:91],a[236:239],v[216:219],a[88:91]
 s_waitcnt vmcnt(13)
 s_waitcnt lgkmcnt(0)
 s_barrier
 v_mfma_f32_16x16x32_bf16 a[96:99],a[240:243],v[204:207],a[96:99]
 ds_read_b128 a[192:195],v2 offset:49152
 v_exp_f32 v84,v84
 v_mfma_f32_16x16x32_bf16 a[96:99],a[244:247],v[208:211],a[96:99]
 s_add_u32 m0,s92,0
 s_add_u32 s34,s56,0
 buffer_load_dwordx4 v14,s[44:47],s34 offen lds
 v_mfma_f32_16x16x32_bf16 a[100:103],a[240:243],v[220:223],a[100:103]
 v_exp_f32 v85,v85
 v_mfma_f32_16x16x32_bf16 a[100:103],a[244:247],v[212:215],a[100:103]
 ds_read_b128 a[196:199],v3 offset:49152
 v_cvt_pk_bf16_f32 v199,v110,v111
 v_mfma_f32_16x16x32_bf16 a[104:107],a[240:243],v[236:239],a[104:107]
 v_exp_f32 v86,v86
 v_mfma_f32_16x16x32_bf16 a[104:107],a[244:247],v[216:219],a[104:107]
 v_exp_f32 v87,v87
 v_mfma_f32_16x16x32_bf16 a[112:115],a[248:251],v[204:207],a[112:115]
 ds_read_b128 a[200:203],v4 offset:49152
 v_cvt_pk_bf16_f32 v200,v84,v85
 v_mfma_f32_16x16x32_bf16 a[112:115],a[252:255],v[208:211],a[112:115]
 s_add_u32 m0,s92,1024
 s_add_u32 s34,s56,0
 buffer_load_dwordx4 v15,s[44:47],s34 offen lds
 v_mfma_f32_16x16x32_bf16 a[116:119],a[248:251],v[220:223],a[116:119]
 ds_read_b128 a[204:207],v5 offset:49152
 ds_read_b128 a[208:211],v2 offset:53248
 v_mfma_f32_16x16x32_bf16 a[116:119],a[252:255],v[212:215],a[116:119]
 v_exp_f32 v116,v116
 v_mfma_f32_16x16x32_bf16 a[120:123],a[248:251],v[236:239],a[120:123]
 v_exp_f32 v117,v117
 v_mfma_f32_16x16x32_bf16 a[120:123],a[252:255],v[216:219],a[120:123]
 ds_read_b128 a[212:215],v3 offset:53248
 v_cvt_pk_bf16_f32 v201,v86,v87
 v_mfma_f32_16x16x32_bf16 v[248:251],a[188:191],v[204:207],v[248:251]
 s_add_u32 m0,s92,2048
 s_add_u32 s34,s56,0
 buffer_load_dwordx4 v16,s[44:47],s34 offen lds
 v_mfma_f32_16x16x32_bf16 v[248:251],a[188:191],v[208:211],v[248:251]
 v_exp_f32 v118,v118
 v_mfma_f32_16x16x32_bf16 v[240:243],a[188:191],v[220:223],v[240:243]
 ds_read_b128 a[216:219],v4 offset:53248
 ds_read_b128 a[220:223],v5 offset:53248
 v_mfma_f32_16x16x32_bf16 v[240:243],a[188:191],v[212:215],v[240:243]
 v_exp_f32 v119,v119
 v_mfma_f32_16x16x32_bf16 v[244:247],a[188:191],v[236:239],v[244:247]
 s_add_u32 m0,s92,3072
 s_add_u32 s34,s56,9216
 buffer_load_dwordx4 v14,s[44:47],s34 offen lds
 v_mfma_f32_16x16x32_bf16 v[244:247],a[188:191],v[216:219],v[244:247]
 s_waitcnt lgkmcnt(7)
 v_cvt_pk_bf16_f32 v202,v116,v117
 v_cvt_pk_bf16_f32 v203,v118,v119
 v_mfma_f32_16x16x32_bf16 v[68:71],a[192:195],v[64:67],v[224:227]
 s_waitcnt lgkmcnt(6)
 v_exp_f32 v132,v132
 v_mfma_f32_16x16x32_bf16 v[68:71],a[196:199],v[96:99],v[68:71]
 s_waitcnt lgkmcnt(5)
 ds_read_b64_tr_b16 a[224:225],v6 offset:32768
 ds_read_b64_tr_b16 a[226:227],v6 offset:36864
 v_mfma_f32_16x16x32_bf16 v[68:71],a[200:203],v[128:131],v[68:71]
 s_waitcnt lgkmcnt(6)
 v_exp_f32 v133,v133
 v_mfma_f32_16x16x32_bf16 v[68:71],a[204:207],v[160:163],v[68:71]
 s_add_u32 m0,s92,4096
 s_add_u32 s34,s56,9216
 buffer_load_dwordx4 v15,s[44:47],s34 offen lds
 v_mfma_f32_16x16x32_bf16 v[76:79],a[192:195],v[72:75],v[228:231]
 ds_read_b64_tr_b16 a[228:229],v7 offset:32768
 ds_read_b64_tr_b16 a[230:231],v7 offset:36864
 v_mfma_f32_16x16x32_bf16 v[76:79],a[196:199],v[104:107],v[76:79]
 v_exp_f32 v134,v134
 v_mfma_f32_16x16x32_bf16 v[76:79],a[200:203],v[136:139],v[76:79]
 v_exp_f32 v135,v135
 v_mfma_f32_16x16x32_bf16 v[76:79],a[204:207],v[168:171],v[76:79]
 ds_read_b64_tr_b16 a[232:233],v8 offset:32768
 v_cvt_pk_bf16_f32 v208,v132,v133
 v_mfma_f32_16x16x32_bf16 v[84:87],a[192:195],v[80:83],v[232:235]
 ds_read_b64_tr_b16 a[234:235],v8 offset:36864
 ds_read_b64_tr_b16 a[236:237],v9 offset:32768
 v_mfma_f32_16x16x32_bf16 v[84:87],a[196:199],v[112:115],v[84:87]
 v_exp_f32 v164,v164
 v_mfma_f32_16x16x32_bf16 v[84:87],a[200:203],v[144:147],v[84:87]
 s_add_u32 m0,s92,5120
 s_add_u32 s34,s56,9216
 buffer_load_dwordx4 v16,s[44:47],s34 offen lds
 v_mfma_f32_16x16x32_bf16 v[84:87],a[204:207],v[176:179],v[84:87]
 s_waitcnt lgkmcnt(10)
 ds_read_b64_tr_b16 a[238:239],v9 offset:36864
 ds_read_b64_tr_b16 a[240:241],v10 offset:32768
 v_mfma_f32_16x16x32_bf16 v[100:103],a[208:211],v[64:67],v[224:227]
 s_waitcnt lgkmcnt(11)
 v_exp_f32 v165,v165
 v_mfma_f32_16x16x32_bf16 v[100:103],a[212:215],v[96:99],v[100:103]
 s_waitcnt lgkmcnt(10)
 ds_read_b64_tr_b16 a[242:243],v10 offset:36864
 v_cvt_pk_bf16_f32 v209,v134,v135
 v_mfma_f32_16x16x32_bf16 v[100:103],a[216:219],v[128:131],v[100:103]
 s_waitcnt lgkmcnt(10)
 v_exp_f32 v166,v166
 v_mfma_f32_16x16x32_bf16 v[100:103],a[220:223],v[160:163],v[100:103]
 s_add_u32 m0,s92,6144
 s_add_u32 s34,s56,18432
 buffer_load_dwordx4 v14,s[44:47],s34 offen lds
 v_mfma_f32_16x16x32_bf16 v[108:111],a[208:211],v[72:75],v[228:231]
 ds_read_b64_tr_b16 a[244:245],v11 offset:32768
 ds_read_b64_tr_b16 a[246:247],v11 offset:36864
 v_mfma_f32_16x16x32_bf16 v[108:111],a[212:215],v[104:107],v[108:111]
 v_exp_f32 v167,v167
 v_mfma_f32_16x16x32_bf16 v[108:111],a[216:219],v[136:139],v[108:111]
 ds_read_b64_tr_b16 a[248:249],v12 offset:32768
 v_cvt_pk_bf16_f32 v210,v164,v165
 v_mfma_f32_16x16x32_bf16 v[108:111],a[220:223],v[168:171],v[108:111]
 v_exp_f32 v140,v140
 v_mfma_f32_16x16x32_bf16 v[116:119],a[208:211],v[80:83],v[232:235]
 ds_read_b64_tr_b16 a[250:251],v12 offset:36864
 ds_read_b64_tr_b16 a[252:253],v13 offset:32768
 v_mfma_f32_16x16x32_bf16 v[116:119],a[212:215],v[112:115],v[116:119]
 v_exp_f32 v141,v141
 v_cvt_pk_bf16_f32 v211,v166,v167
 v_mfma_f32_16x16x32_bf16 v[116:119],a[216:219],v[144:147],v[116:119]
 s_add_u32 m0,s92,7168
 s_add_u32 s34,s56,18432
 buffer_load_dwordx4 v15,s[44:47],s34 offen lds
 v_mfma_f32_16x16x32_bf16 v[116:119],a[220:223],v[176:179],v[116:119]
 s_waitcnt lgkmcnt(13)
 v_exp_f32 v142,v142
 v_mfma_f32_16x16x32_bf16 a[0:3],a[224:227],v[192:195],a[0:3]
 v_exp_f32 v143,v143
 v_mfma_f32_16x16x32_bf16 a[4:7],a[224:227],v[196:199],a[4:7]
 ds_read_b64_tr_b16 a[254:255],v13 offset:36864
 v_cvt_pk_bf16_f32 v212,v140,v141
 v_mfma_f32_16x16x32_bf16 a[8:11],a[224:227],v[200:203],a[8:11]
 s_waitcnt lgkmcnt(12)
 v_exp_f32 v172,v172
 v_mfma_f32_16x16x32_bf16 a[16:19],a[228:231],v[192:195],a[16:19]
 v_exp_f32 v173,v173
 v_mfma_f32_16x16x32_bf16 a[20:23],a[228:231],v[196:199],a[20:23]
 s_add_u32 m0,s92,8192
 s_add_u32 s34,s56,18432
 buffer_load_dwordx4 v16,s[44:47],s34 offen lds
 v_mfma_f32_16x16x32_bf16 a[24:27],a[228:231],v[200:203],a[24:27]
 s_waitcnt lgkmcnt(10)
 ds_read_b128 a[192:195],v2 offset:57344
 v_cvt_pk_bf16_f32 v213,v142,v143
 v_mfma_f32_16x16x32_bf16 a[32:35],a[232:235],v[192:195],a[32:35]
 v_exp_f32 v174,v174
 v_mfma_f32_16x16x32_bf16 a[36:39],a[232:235],v[196:199],a[36:39]
 ds_read_b128 a[196:199],v3 offset:57344
 ds_read_b128 a[200:203],v4 offset:57344
 v_mfma_f32_16x16x32_bf16 a[40:43],a[232:235],v[200:203],a[40:43]
 s_waitcnt lgkmcnt(11)
 v_exp_f32 v175,v175
 v_mfma_f32_16x16x32_bf16 a[48:51],a[236:239],v[192:195],a[48:51]
 ds_read_b128 a[204:207],v5 offset:57344
 v_cvt_pk_bf16_f32 v214,v172,v173
 v_mfma_f32_16x16x32_bf16 a[52:55],a[236:239],v[196:199],a[52:55]
 s_add_u32 m0,s92,9216
 s_add_u32 s34,s56,27648
 buffer_load_dwordx4 v14,s[44:47],s34 offen lds
 v_mfma_f32_16x16x32_bf16 a[56:59],a[236:239],v[200:203],a[56:59]
 s_waitcnt lgkmcnt(10)
 ds_read_b128 a[208:211],v2 offset:61440
 v_exp_f32 v148,v148
 v_mfma_f32_16x16x32_bf16 a[64:67],a[240:243],v[192:195],a[64:67]
 v_exp_f32 v149,v149
 v_mfma_f32_16x16x32_bf16 a[68:71],a[240:243],v[196:199],a[68:71]
 ds_read_b128 a[212:215],v3 offset:61440
 v_cvt_pk_bf16_f32 v215,v174,v175
 v_mfma_f32_16x16x32_bf16 a[72:75],a[240:243],v[200:203],a[72:75]
 s_waitcnt lgkmcnt(10)
 v_exp_f32 v150,v150
 v_mfma_f32_16x16x32_bf16 a[80:83],a[244:247],v[192:195],a[80:83]
 s_add_u32 m0,s92,10240
 s_add_u32 s34,s56,27648
 buffer_load_dwordx4 v15,s[44:47],s34 offen lds
 v_mfma_f32_16x16x32_bf16 a[84:87],a[244:247],v[196:199],a[84:87]
 v_exp_f32 v151,v151
 v_mfma_f32_16x16x32_bf16 a[88:91],a[244:247],v[200:203],a[88:91]
 s_waitcnt lgkmcnt(8)
 ds_read_b128 a[216:219],v4 offset:61440
 v_cvt_pk_bf16_f32 v216,v148,v149
 v_mfma_f32_16x16x32_bf16 a[96:99],a[248:251],v[192:195],a[96:99]
 v_exp_f32 v180,v180
 v_mfma_f32_16x16x32_bf16 a[100:103],a[248:251],v[196:199],a[100:103]
 v_exp_f32 v181,v181
 v_mfma_f32_16x16x32_bf16 a[104:107],a[248:251],v[200:203],a[104:107]
 s_waitcnt lgkmcnt(7)
 ds_read_b128 a[220:223],v5 offset:61440
 v_cvt_pk_bf16_f32 v217,v150,v151
 v_mfma_f32_16x16x32_bf16 a[112:115],a[252:255],v[192:195],a[112:115]
 s_add_u32 m0,s92,11264
 s_add_u32 s34,s56,27648
 buffer_load_dwordx4 v16,s[44:47],s34 offen lds
 v_mfma_f32_16x16x32_bf16 a[116:119],a[252:255],v[196:199],a[116:119]
 v_exp_f32 v182,v182
 v_mfma_f32_16x16x32_bf16 a[120:123],a[252:255],v[200:203],a[120:123]
 ds_read_b64_tr_b16 a[224:225],v6 offset:40960
 ds_read_b64_tr_b16 a[226:227],v6 offset:45056
 v_mfma_f32_16x16x32_bf16 v[248:251],a[188:191],v[192:195],v[248:251]
 v_exp_f32 v183,v183
 v_mfma_f32_16x16x32_bf16 v[240:243],a[188:191],v[196:199],v[240:243]
 v_cvt_pk_bf16_f32 v218,v180,v181
 v_cvt_pk_bf16_f32 v219,v182,v183
 v_mfma_f32_16x16x32_bf16 v[244:247],a[188:191],v[200:203],v[244:247]
 s_waitcnt lgkmcnt(9)
 v_exp_f32 v68,v68
 v_mfma_f32_16x16x32_bf16 v[132:135],a[192:195],v[64:67],v[224:227]
 s_waitcnt lgkmcnt(8)
 s_mov_b32 m0,162816
 ds_read_b64_tr_b16 a[228:229],v7 offset:40960
 v_mfma_f32_16x16x32_bf16 v[132:135],a[196:199],v[96:99],v[132:135]
 s_waitcnt lgkmcnt(8)
 v_exp_f32 v69,v69
 v_mfma_f32_16x16x32_bf16 v[132:135],a[200:203],v[128:131],v[132:135]
 s_waitcnt lgkmcnt(7)
 v_exp_f32 v70,v70
 v_mfma_f32_16x16x32_bf16 v[132:135],a[204:207],v[160:163],v[132:135]
 s_add_u32 s35,s93,13312
 ds_read_b64_tr_b16 a[230:231],v7 offset:45056
 buffer_load_dwordx4 v252,s[88:91],s35 offen lds
 v_mfma_f32_16x16x32_bf16 v[140:143],a[192:195],v[72:75],v[228:231]
 ds_read_b64_tr_b16 a[232:233],v8 offset:40960
 ds_read_b64_tr_b16 a[234:235],v8 offset:45056
 v_mfma_f32_16x16x32_bf16 v[140:143],a[196:199],v[104:107],v[140:143]
 v_exp_f32 v71,v71
 v_mfma_f32_16x16x32_bf16 v[140:143],a[200:203],v[136:139],v[140:143]
 ds_read_b64_tr_b16 a[236:237],v9 offset:40960
 v_cvt_pk_bf16_f32 v192,v68,v69
 v_mfma_f32_16x16x32_bf16 v[140:143],a[204:207],v[168:171],v[140:143]
 v_exp_f32 v100,v100
 v_mfma_f32_16x16x32_bf16 v[148:151],a[192:195],v[80:83],v[232:235]
 s_add_u32 s35,s93,14336
 ds_read_b64_tr_b16 a[238:239],v9 offset:45056
 buffer_load_dwordx4 v252,s[88:91],s35 offen lds
 v_mfma_f32_16x16x32_bf16 v[148:151],a[196:199],v[112:115],v[148:151]
 v_exp_f32 v101,v101
 v_mfma_f32_16x16x32_bf16 v[148:151],a[200:203],v[144:147],v[148:151]
 ds_read_b64_tr_b16 a[240:241],v10 offset:40960
 v_cvt_pk_bf16_f32 v193,v70,v71
 v_mfma_f32_16x16x32_bf16 v[148:151],a[204:207],v[176:179],v[148:151]
 s_waitcnt lgkmcnt(12)
 v_exp_f32 v102,v102
 v_mfma_f32_16x16x32_bf16 v[164:167],a[208:211],v[64:67],v[224:227]
 s_waitcnt lgkmcnt(11)
 ds_read_b64_tr_b16 a[242:243],v10 offset:45056
 ds_read_b64_tr_b16 a[244:245],v11 offset:40960
 v_mfma_f32_16x16x32_bf16 v[164:167],a[212:215],v[96:99],v[164:167]
 s_waitcnt lgkmcnt(12)
 v_exp_f32 v103,v103
 v_mfma_f32_16x16x32_bf16 v[164:167],a[216:219],v[128:131],v[164:167]
 s_waitcnt lgkmcnt(11)
 s_add_u32 s35,s93,15360
 buffer_load_dwordx4 v252,s[88:91],s35 offen lds
 v_mfma_f32_16x16x32_bf16 v[164:167],a[220:223],v[160:163],v[164:167]
 ds_read_b64_tr_b16 a[246:247],v11 offset:45056
 v_cvt_pk_bf16_f32 v194,v100,v101
 v_mfma_f32_16x16x32_bf16 v[172:175],a[208:211],v[72:75],v[228:231]
 ds_read_b64_tr_b16 a[248:249],v12 offset:40960
 v_exp_f32 v76,v76
 v_mfma_f32_16x16x32_bf16 v[172:175],a[212:215],v[104:107],v[172:175]
 v_exp_f32 v77,v77
 v_mfma_f32_16x16x32_bf16 v[172:175],a[216:219],v[136:139],v[172:175]
 ds_read_b64_tr_b16 a[250:251],v12 offset:45056
 v_cvt_pk_bf16_f32 v195,v102,v103
 v_mfma_f32_16x16x32_bf16 v[172:175],a[220:223],v[168:171],v[172:175]
 s_add_u32 s35,s93,16384
 ds_read_b64_tr_b16 a[252:253],v13 offset:40960
 buffer_load_dwordx4 v252,s[88:91],s35 offen lds
 v_mfma_f32_16x16x32_bf16 v[180:183],a[208:211],v[80:83],v[232:235]
 v_exp_f32 v78,v78
 v_mfma_f32_16x16x32_bf16 v[180:183],a[212:215],v[112:115],v[180:183]
 v_exp_f32 v79,v79
 v_mfma_f32_16x16x32_bf16 v[180:183],a[216:219],v[144:147],v[180:183]
 ds_read_b64_tr_b16 a[254:255],v13 offset:45056
 v_cvt_pk_bf16_f32 v196,v76,v77
 v_mfma_f32_16x16x32_bf16 v[180:183],a[220:223],v[176:179],v[180:183]
 s_waitcnt lgkmcnt(14)
 v_exp_f32 v108,v108
 v_mfma_f32_16x16x32_bf16 a[0:3],a[224:227],v[208:211],a[0:3]
 v_exp_f32 v109,v109
 v_mfma_f32_16x16x32_bf16 a[4:7],a[224:227],v[212:215],a[4:7]
 s_add_u32 s35,s93,17408
 buffer_load_dwordx4 v252,s[88:91],s35 offen lds
 v_cvt_pk_bf16_f32 v197,v78,v79
 v_mfma_f32_16x16x32_bf16 a[8:11],a[224:227],v[216:219],a[8:11]
 s_waitcnt lgkmcnt(12)
 v_exp_f32 v110,v110
 v_mfma_f32_16x16x32_bf16 a[16:19],a[228:231],v[208:211],a[16:19]
 v_exp_f32 v111,v111
 v_mfma_f32_16x16x32_bf16 a[20:23],a[228:231],v[212:215],a[20:23]
 v_cvt_pk_bf16_f32 v198,v108,v109
 v_exp_f32 v84,v84
 v_mfma_f32_16x16x32_bf16 a[24:27],a[228:231],v[216:219],a[24:27]
 s_waitcnt vmcnt(34)
 s_waitcnt lgkmcnt(0)
 s_barrier
 v_mfma_f32_16x16x32_bf16 a[32:35],a[232:235],v[208:211],a[32:35]
 ds_read_b64_tr_b16 a[192:193],v6 offset:49152
 ds_read_b64_tr_b16 a[194:195],v6 offset:53248
 v_mfma_f32_16x16x32_bf16 a[36:39],a[232:235],v[212:215],a[36:39]
 s_add_u32 m0,s92,49152
 s_add_u32 s34,s56,589824
 buffer_load_dwordx4 v14,s[44:47],s34 offen lds
 v_mfma_f32_16x16x32_bf16 a[40:43],a[232:235],v[216:219],a[40:43]
 ds_read_b64_tr_b16 a[196:197],v7 offset:49152
 ds_read_b64_tr_b16 a[198:199],v7 offset:53248
 v_mfma_f32_16x16x32_bf16 a[48:51],a[236:239],v[208:211],a[48:51]
 ds_read_b64_tr_b16 a[200:201],v8 offset:49152
 v_exp_f32 v85,v85
 v_mfma_f32_16x16x32_bf16 a[52:55],a[236:239],v[212:215],a[52:55]
 s_add_u32 m0,s92,50176
 s_add_u32 s34,s56,589824
 buffer_load_dwordx4 v15,s[44:47],s34 offen lds
 v_mfma_f32_16x16x32_bf16 a[56:59],a[236:239],v[216:219],a[56:59]
 ds_read_b64_tr_b16 a[202:203],v8 offset:53248
 v_cvt_pk_bf16_f32 v199,v110,v111
 v_mfma_f32_16x16x32_bf16 a[64:67],a[240:243],v[208:211],a[64:67]
 ds_read_b64_tr_b16 a[204:205],v9 offset:49152
 ds_read_b64_tr_b16 a[206:207],v9 offset:53248
 v_mfma_f32_16x16x32_bf16 a[68:71],a[240:243],v[212:215],a[68:71]
 s_add_u32 m0,s92,51200
 s_add_u32 s34,s56,589824
 ds_read_b64_tr_b16 a[208:209],v10 offset:49152
 buffer_load_dwordx4 v16,s[44:47],s34 offen lds
 v_mfma_f32_16x16x32_bf16 a[72:75],a[240:243],v[216:219],a[72:75]
 v_exp_f32 v86,v86
 v_mfma_f32_16x16x32_bf16 a[80:83],a[244:247],v[208:211],a[80:83]
 ds_read_b64_tr_b16 a[210:211],v10 offset:53248
 ds_read_b64_tr_b16 a[212:213],v11 offset:49152
 v_mfma_f32_16x16x32_bf16 a[84:87],a[244:247],v[212:215],a[84:87]
 s_add_u32 m0,s92,52224
 s_add_u32 s34,s56,599040
 buffer_load_dwordx4 v14,s[44:47],s34 offen lds
 v_mfma_f32_16x16x32_bf16 a[88:91],a[244:247],v[216:219],a[88:91]
 ds_read_b64_tr_b16 a[214:215],v11 offset:53248
 ds_read_b64_tr_b16 a[216:217],v12 offset:49152
 v_mfma_f32_16x16x32_bf16 a[96:99],a[248:251],v[208:211],a[96:99]
 ds_read_b64_tr_b16 a[218:219],v12 offset:53248
 buffer_load_dword v63,v252,s[40:43],0 offen sc1
 v_mfma_f32_16x16x32_bf16 a[100:103],a[248:251],v[212:215],a[100:103]
 v_exp_f32 v87,v87
 v_mfma_f32_16x16x32_bf16 a[104:107],a[248:251],v[216:219],a[104:107]
 ds_read_b64_tr_b16 a[220:221],v13 offset:49152
 v_cvt_pk_bf16_f32 v200,v84,v85
 v_mfma_f32_16x16x32_bf16 a[112:115],a[252:255],v[208:211],a[112:115]
 v_exp_f32 v116,v116
 v_mfma_f32_16x16x32_bf16 a[116:119],a[252:255],v[212:215],a[116:119]
 v_exp_f32 v117,v117
 v_mfma_f32_16x16x32_bf16 a[120:123],a[252:255],v[216:219],a[120:123]
 ds_read_b64_tr_b16 a[222:223],v13 offset:53248
 v_cvt_pk_bf16_f32 v201,v86,v87
 v_mfma_f32_16x16x32_bf16 v[248:251],a[188:191],v[208:211],v[248:251]
 v_exp_f32 v118,v118
 v_mfma_f32_16x16x32_bf16 v[240:243],a[188:191],v[212:215],v[240:243]
 v_exp_f32 v119,v119
 v_mfma_f32_16x16x32_bf16 v[244:247],a[188:191],v[216:219],v[244:247]
 s_waitcnt lgkmcnt(14)
 v_cvt_pk_bf16_f32 v202,v116,v117
 v_cvt_pk_bf16_f32 v203,v118,v119
 v_mfma_f32_16x16x32_bf16 a[0:3],a[192:195],v[192:195],a[0:3]
 ds_read_b64_tr_b16 a[224:225],v6 offset:57344
 v_exp_f32 v132,v132
 v_mfma_f32_16x16x32_bf16 a[4:7],a[192:195],v[196:199],a[4:7]
 s_add_u32 m0,s92,53248
 s_add_u32 s34,s56,599040
 ds_read_b64_tr_b16 a[226:227],v6 offset:61440
 buffer_load_dwordx4 v15,s[44:47],s34 offen lds
 v_exp_f32 v133,v133
 v_mfma_f32_16x16x32_bf16 a[8:11],a[192:195],v[200:203],a[8:11]
 s_waitcnt lgkmcnt(14)
 ds_read_b64_tr_b16 a[228:229],v7 offset:57344
 ds_read_b64_tr_b16 a[230:231],v7 offset:61440
 v_exp_f32 v134,v134
 v_mfma_f32_16x16x32_bf16 a[16:19],a[196:199],v[192:195],a[16:19]
 ds_read_b64_tr_b16 a[232:233],v8 offset:57344
 ds_read_b64_tr_b16 a[234:235],v8 offset:61440
 v_mfma_f32_16x16x32_bf16 a[20:23],a[196:199],v[196:199],a[20:23]
 ds_read_b64_tr_b16 a[236:237],v9 offset:57344
 v_exp_f32 v135,v135
 v_mfma_f32_16x16x32_bf16 a[24:27],a[196:199],v[200:203],a[24:27]
 s_waitcnt lgkmcnt(15)
 ds_read_b64_tr_b16 a[238:239],v9 offset:61440
 v_cvt_pk_bf16_f32 v208,v132,v133
 v_mfma_f32_16x16x32_bf16 a[32:35],a[200:203],v[192:195],a[32:35]
 ds_read_b64_tr_b16 a[240:241],v10 offset:57344
 ds_read_b64_tr_b16 a[242:243],v10 offset:61440
 v_mfma_f32_16x16x32_bf16 a[36:39],a[200:203],v[196:199],a[36:39]
 ds_read_b64_tr_b16 a[244:245],v11 offset:57344
 ds_read_b64_tr_b16 a[246:247],v11 offset:61440
 v_mfma_f32_16x16x32_bf16 a[40:43],a[200:203],v[200:203],a[40:43]
 s_waitcnt lgkmcnt(15)
 v_exp_f32 v164,v164
 v_mfma_f32_16x16x32_bf16 a[48:51],a[204:207],v[192:195],a[48:51]
 ds_read_b64_tr_b16 a[248:249],v12 offset:57344
 ds_read_b64_tr_b16 a[250:251],v12 offset:61440
 v_mfma_f32_16x16x32_bf16 a[52:55],a[204:207],v[196:199],a[52:55]
 ds_read_b64_tr_b16 a[252:253],v13 offset:57344
 ds_read_b64_tr_b16 a[254:255],v13 offset:61440
 v_mfma_f32_16x16x32_bf16 a[56:59],a[204:207],v[200:203],a[56:59]
 s_waitcnt lgkmcnt(15)
 s_add_u32 m0,s92,54272
 s_add_u32 s34,s56,599040
 buffer_load_dwordx4 v16,s[44:47],s34 offen lds
 v_mfma_f32_16x16x32_bf16 a[64:67],a[208:211],v[192:195],a[64:67]
 s_add_u32 m0,s92,55296
 s_add_u32 s34,s56,608256
 buffer_load_dwordx4 v14,s[44:47],s34 offen lds
 v_exp_f32 v165,v165
 v_cvt_pk_bf16_f32 v209,v134,v135
 v_mfma_f32_16x16x32_bf16 a[68:71],a[208:211],v[196:199],a[68:71]
 s_add_u32 m0,s92,56320
 s_add_u32 s34,s56,608256
 buffer_load_dwordx4 v15,s[44:47],s34 offen lds
 v_exp_f32 v166,v166
 v_mfma_f32_16x16x32_bf16 a[72:75],a[208:211],v[200:203],a[72:75]
 s_waitcnt lgkmcnt(15)
 s_add_u32 m0,s92,57344
 s_add_u32 s34,s56,608256
 buffer_load_dwordx4 v16,s[44:47],s34 offen lds
 v_exp_f32 v167,v167
 v_cvt_pk_bf16_f32 v210,v164,v165
 v_mfma_f32_16x16x32_bf16 a[80:83],a[212:215],v[192:195],a[80:83]
 s_add_u32 m0,s92,58368
 s_add_u32 s34,s56,617472
 buffer_load_dwordx4 v14,s[44:47],s34 offen lds
 v_mfma_f32_16x16x32_bf16 a[84:87],a[212:215],v[196:199],a[84:87]
 s_add_u32 m0,s92,59392
 s_add_u32 s34,s56,617472
 buffer_load_dwordx4 v15,s[44:47],s34 offen lds
 v_mfma_f32_16x16x32_bf16 a[88:91],a[212:215],v[200:203],a[88:91]
 s_waitcnt lgkmcnt(15)
 s_add_u32 m0,s92,60416
 s_add_u32 s34,s56,617472
 buffer_load_dwordx4 v16,s[44:47],s34 offen lds
 v_mfma_f32_16x16x32_bf16 a[96:99],a[216:219],v[192:195],a[96:99]
 s_waitcnt lgkmcnt(0)
 s_barrier
 v_exp_f32 v140,v140
 v_mfma_f32_16x16x32_bf16 a[100:103],a[216:219],v[196:199],a[100:103]
 v_exp_f32 v141,v141
 v_cvt_pk_bf16_f32 v211,v166,v167
 v_mfma_f32_16x16x32_bf16 a[104:107],a[216:219],v[200:203],a[104:107]
 v_exp_f32 v142,v142
 v_mfma_f32_16x16x32_bf16 a[112:115],a[220:223],v[192:195],a[112:115]
 v_exp_f32 v143,v143
 v_cvt_pk_bf16_f32 v212,v140,v141
 v_mfma_f32_16x16x32_bf16 a[116:119],a[220:223],v[196:199],a[116:119]
 v_exp_f32 v172,v172
 v_mfma_f32_16x16x32_bf16 a[120:123],a[220:223],v[200:203],a[120:123]
 v_exp_f32 v173,v173
 v_cvt_pk_bf16_f32 v213,v142,v143
 v_mfma_f32_16x16x32_bf16 v[248:251],a[188:191],v[192:195],v[248:251]
 v_exp_f32 v174,v174
 v_mfma_f32_16x16x32_bf16 v[240:243],a[188:191],v[196:199],v[240:243]
 v_exp_f32 v175,v175
 v_cvt_pk_bf16_f32 v214,v172,v173
 v_mfma_f32_16x16x32_bf16 v[244:247],a[188:191],v[200:203],v[244:247]
 v_exp_f32 v148,v148
 v_mfma_f32_16x16x32_bf16 a[0:3],a[224:227],v[208:211],a[0:3]
 v_exp_f32 v149,v149
 v_cvt_pk_bf16_f32 v215,v174,v175
 v_mfma_f32_16x16x32_bf16 a[16:19],a[228:231],v[208:211],a[16:19]
 s_add_u32 m0,s92,98304
 s_add_u32 s34,s56,1179648
 buffer_load_dwordx4 v14,s[44:47],s34 offen lds
 v_mfma_f32_16x16x32_bf16 a[32:35],a[232:235],v[208:211],a[32:35]
 v_exp_f32 v150,v150
 v_mfma_f32_16x16x32_bf16 a[48:51],a[236:239],v[208:211],a[48:51]
 v_exp_f32 v151,v151
 v_cvt_pk_bf16_f32 v216,v148,v149
 v_mfma_f32_16x16x32_bf16 a[64:67],a[240:243],v[208:211],a[64:67]
 v_exp_f32 v180,v180
 v_mfma_f32_16x16x32_bf16 a[80:83],a[244:247],v[208:211],a[80:83]
 v_exp_f32 v181,v181
 v_mfma_f32_16x16x32_bf16 a[96:99],a[248:251],v[208:211],a[96:99]
 s_add_u32 m0,s92,99328
 s_add_u32 s34,s56,1179648
 buffer_load_dwordx4 v15,s[44:47],s34 offen lds
 v_cvt_pk_bf16_f32 v217,v150,v151
 v_mfma_f32_16x16x32_bf16 a[112:115],a[252:255],v[208:211],a[112:115]
 v_exp_f32 v182,v182
 v_mfma_f32_16x16x32_bf16 a[4:7],a[224:227],v[212:215],a[4:7]
 v_exp_f32 v183,v183
 v_mfma_f32_16x16x32_bf16 a[20:23],a[228:231],v[212:215],a[20:23]
 v_cvt_pk_bf16_f32 v218,v180,v181
 v_cvt_pk_bf16_f32 v219,v182,v183
 v_mfma_f32_16x16x32_bf16 a[36:39],a[232:235],v[212:215],a[36:39]
 s_add_u32 m0,s92,100352
 s_add_u32 s34,s56,1179648
 buffer_load_dwordx4 v16,s[44:47],s34 offen lds
 v_mfma_f32_16x16x32_bf16 a[52:55],a[236:239],v[212:215],a[52:55]
 s_add_u32 m0,s92,101376
 s_add_u32 s34,s56,1188864
 buffer_load_dwordx4 v14,s[44:47],s34 offen lds
 v_mfma_f32_16x16x32_bf16 a[68:71],a[240:243],v[212:215],a[68:71]
 s_add_u32 m0,s92,102400
 s_add_u32 s34,s56,1188864
 buffer_load_dwordx4 v15,s[44:47],s34 offen lds
 v_mfma_f32_16x16x32_bf16 a[84:87],a[244:247],v[212:215],a[84:87]
 s_add_u32 m0,s92,103424
 s_add_u32 s34,s56,1188864
 buffer_load_dwordx4 v16,s[44:47],s34 offen lds
 v_mfma_f32_16x16x32_bf16 a[100:103],a[248:251],v[212:215],a[100:103]
 v_bfe_u32 v22,v0,2,4
 v_and_b32 v23,6,v22
 v_mfma_f32_16x16x32_bf16 a[116:119],a[252:255],v[212:215],a[116:119]
 v_bfe_u32 v24,v0,1,1
 v_xor_b32 v23,v23,v24
 v_mul_u32_u24 v22,384,v22
 v_mfma_f32_16x16x32_bf16 v[248:251],a[188:191],v[208:211],v[248:251]
 v_and_b32 v24,1,v0
 v_lshl_add_u32 v22,v24,3,v22
 v_mfma_f32_16x16x32_bf16 v[240:243],a[188:191],v[212:215],v[240:243]
 v_add_u32 v22,s92,v22
 v_lshl_add_u32 v18,v23,4,v22
 v_mfma_f32_16x16x32_bf16 v[244:247],a[188:191],v[216:219],v[244:247]
 v_xor_b32 v19,32,v18
 v_xor_b32 v20,64,v18
 v_mfma_f32_16x16x32_bf16 a[8:11],a[224:227],v[216:219],a[8:11]
 s_add_u32 m0,s92,104448
 s_add_u32 s34,s56,1198080
 buffer_load_dwordx4 v14,s[44:47],s34 offen lds
 v_mfma_f32_16x16x32_bf16 a[24:27],a[228:231],v[216:219],a[24:27]
 s_add_u32 m0,s92,105472
 s_add_u32 s34,s56,1198080
 buffer_load_dwordx4 v15,s[44:47],s34 offen lds
 v_mfma_f32_16x16x32_bf16 a[40:43],a[232:235],v[216:219],a[40:43]
 s_add_u32 m0,s92,106496
 s_add_u32 s34,s56,1198080
 buffer_load_dwordx4 v16,s[44:47],s34 offen lds
 v_mfma_f32_16x16x32_bf16 a[56:59],a[236:239],v[216:219],a[56:59]
 s_add_u32 m0,s92,107520
 s_add_u32 s34,s56,1207296
 buffer_load_dwordx4 v14,s[44:47],s34 offen lds
 v_mfma_f32_16x16x32_bf16 a[72:75],a[240:243],v[216:219],a[72:75]
 s_add_u32 m0,s92,108544
 s_add_u32 s34,s56,1207296
 buffer_load_dwordx4 v15,s[44:47],s34 offen lds
 v_mfma_f32_16x16x32_bf16 a[88:91],a[244:247],v[216:219],a[88:91]
 v_xor_b32 v21,96,v18
 s_nop 0
 s_nop 0
 v_mfma_f32_16x16x32_bf16 a[104:107],a[248:251],v[216:219],a[104:107]
 s_add_u32 m0,s92,109568
 s_add_u32 s34,s56,1207296
 buffer_load_dwordx4 v16,s[44:47],s34 offen lds
 v_mfma_f32_16x16x32_bf16 a[120:123],a[252:255],v[216:219],a[120:123]
 s_mov_b32 s68,0x4e800000
 v_mov_b32 v249,v240
 v_mov_b32 v250,v244
 v_add_f32 v41,v248,v249
 v_add_f32 v41,v41,v250
 v_cmp_ngt_f32 vcc,s68,v41
 s_nop 0
 s_cbranch_vccnz K1_slowc
K1_backLc:
 v_rcp_f32 v248,v248
 v_rcp_f32 v249,v249
 v_rcp_f32 v250,v250
 s_branch K1_op
K1_slowc:
 s_waitcnt vmcnt(0)
 s_lshl_b32 s70,s33,18
 v_and_b32 v48,15,v0
 v_lshrrev_b32 v49,4,v0
 v_lshlrev_b32 v50,8,v48
 v_lshlrev_b32 v51,1,v48
 v_lshl_add_u32 v48,v49,4,v50
 v_lshl_add_u32 v49,v49,10,v51
 s_mov_b32 s71,0
 v_mov_b32 v40,0xff800000
 v_mov_b32 v41,0xff800000
 v_mov_b32 v42,0xff800000
K1_s1c:
 s_add_u32 s64,s70,s71
 s_add_u32 s65,s64,4096
 buffer_load_dwordx4 v[132:135],v48,s[12:15],s64 offen offset:0
 buffer_load_dwordx4 v[140:143],v48,s[12:15],s64 offen offset:64
 buffer_load_dwordx4 v[148:151],v48,s[12:15],s64 offen offset:128
 buffer_load_dwordx4 v[156:159],v48,s[12:15],s64 offen offset:192
 buffer_load_dwordx4 v[164:167],v48,s[12:15],s65 offen offset:0
 buffer_load_dwordx4 v[172:175],v48,s[12:15],s65 offen offset:64
 buffer_load_dwordx4 v[180:183],v48,s[12:15],s65 offen offset:128
 buffer_load_dwordx4 v[188:191],v48,s[12:15],s65 offen offset:192
 s_waitcnt vmcnt(0)
 v_mfma_f32_16x16x32_bf16 v[68:71],v[132:135],v[64:67],0
 v_mfma_f32_16x16x32_bf16 v[68:71],v[140:143],v[96:99],v[68:71]
 v_mfma_f32_16x16x32_bf16 v[68:71],v[148:151],v[128:131],v[68:71]
 v_mfma_f32_16x16x32_bf16 v[68:71],v[156:159],v[160:163],v[68:71]
 v_mfma_f32_16x16x32_bf16 v[76:79],v[132:135],v[72:75],0
 v_mfma_f32_16x16x32_bf16 v[76:79],v[140:143],v[104:107],v[76:79]
 v_mfma_f32_16x16x32_bf16 v[76:79],v[148:151],v[136:139],v[76:79]
 v_mfma_f32_16x16x32_bf16 v[76:79],v[156:159],v[168:171],v[76:79]
 v_mfma_f32_16x16x32_bf16 v[84:87],v[132:135],v[80:83],0
 v_mfma_f32_16x16x32_bf16 v[84:87],v[140:143],v[112:115],v[84:87]
 v_mfma_f32_16x16x32_bf16 v[84:87],v[148:151],v[144:147],v[84:87]
 v_mfma_f32_16x16x32_bf16 v[84:87],v[156:159],v[176:179],v[84:87]
 v_mfma_f32_16x16x32_bf16 v[100:103],v[164:167],v[64:67],0
 v_mfma_f32_16x16x32_bf16 v[100:103],v[172:175],v[96:99],v[100:103]
 v_mfma_f32_16x16x32_bf16 v[100:103],v[180:183],v[128:131],v[100:103]
 v_mfma_f32_16x16x32_bf16 v[100:103],v[188:191],v[160:163],v[100:103]
 v_mfma_f32_16x16x32_bf16 v[108:111],v[164:167],v[72:75],0
 v_mfma_f32_16x16x32_bf16 v[108:111],v[172:175],v[104:107],v[108:111]
 v_mfma_f32_16x16x32_bf16 v[108:111],v[180:183],v[136:139],v[108:111]
 v_mfma_f32_16x16x32_bf16 v[108:111],v[188:191],v[168:171],v[108:111]
 v_mfma_f32_16x16x32_bf16 v[116:119],v[164:167],v[80:83],0
 v_mfma_f32_16x16x32_bf16 v[116:119],v[172:175],v[112:115],v[116:119]
 v_mfma_f32_16x16x32_bf16 v[116:119],v[180:183],v[144:147],v[116:119]
 v_mfma_f32_16x16x32_bf16 v[116:119],v[188:191],v[176:179],v[116:119]
 s_nop 7
 v_max3_f32 v40,v40,v68,v69
 v_max3_f32 v40,v40,v70,v71
 v_max3_f32 v40,v40,v100,v101
 v_max3_f32 v40,v40,v102,v103
 v_max3_f32 v41,v41,v76,v77
 v_max3_f32 v41,v41,v78,v79
 v_max3_f32 v41,v41,v108,v109
 v_max3_f32 v41,v41,v110,v111
 v_max3_f32 v42,v42,v84,v85
 v_max3_f32 v42,v42,v86,v87
 v_max3_f32 v42,v42,v116,v117
 v_max3_f32 v42,v42,v118,v119
 s_add_u32 s71,s71,8192
 s_cmp_lt_u32 s71,262144
 s_cbranch_scc1 K1_s1c
 v_mov_b32 v44,v40
 s_nop 1
 v_permlane32_swap_b32 v40,v44
 s_nop 0
 v_max_f32 v40,v40,v44
 v_mov_b32 v44,v40
 s_nop 1
 v_permlane16_swap_b32 v40,v44
 s_nop 0
 v_max_f32 v40,v40,v44
 v_mov_b32 v45,v41
 s_nop 1
 v_permlane32_swap_b32 v41,v45
 s_nop 0
 v_max_f32 v41,v41,v45
 v_mov_b32 v45,v41
 s_nop 1
 v_permlane16_swap_b32 v41,v45
 s_nop 0
 v_max_f32 v41,v41,v45
 v_mov_b32 v46,v42
 s_nop 1
 v_permlane32_swap_b32 v42,v46
 s_nop 0
 v_max_f32 v42,v42,v46
 v_mov_b32 v46,v42
 s_nop 1
 v_permlane16_swap_b32 v42,v46
 s_nop 0
 v_max_f32 v42,v42,v46
 v_sub_f32 v224,0,v40
 v_sub_f32 v225,0,v40
 v_sub_f32 v226,0,v40
 v_sub_f32 v227,0,v40
 v_mov_b32 v248,0
 v_sub_f32 v228,0,v41
 v_sub_f32 v229,0,v41
 v_sub_f32 v230,0,v41
 v_sub_f32 v231,0,v41
 v_mov_b32 v249,0
 v_sub_f32 v232,0,v42
 v_sub_f32 v233,0,v42
 v_sub_f32 v234,0,v42
 v_sub_f32 v235,0,v42
 v_mov_b32 v250,0
 v_accvgpr_write_b32 a0,0
 v_accvgpr_write_b32 a1,0
 v_accvgpr_write_b32 a2,0
 v_accvgpr_write_b32 a3,0
 v_accvgpr_write_b32 a4,0
 v_accvgpr_write_b32 a5,0
 v_accvgpr_write_b32 a6,0
 v_accvgpr_write_b32 a7,0
 v_accvgpr_write_b32 a8,0
 v_accvgpr_write_b32 a9,0
 v_accvgpr_write_b32 a10,0
 v_accvgpr_write_b32 a11,0
 v_accvgpr_write_b32 a12,0
 v_accvgpr_write_b32 a13,0
 v_accvgpr_write_b32 a14,0
 v_accvgpr_write_b32 a15,0
 v_accvgpr_write_b32 a16,0
 v_accvgpr_write_b32 a17,0
 v_accvgpr_write_b32 a18,0
 v_accvgpr_write_b32 a19,0
 v_accvgpr_write_b32 a20,0
 v_accvgpr_write_b32 a21,0
 v_accvgpr_write_b32 a22,0
 v_accvgpr_write_b32 a23,0
 v_accvgpr_write_b32 a24,0
 v_accvgpr_write_b32 a25,0
 v_accvgpr_write_b32 a26,0
 v_accvgpr_write_b32 a27,0
 v_accvgpr_write_b32 a28,0
 v_accvgpr_write_b32 a29,0
 v_accvgpr_write_b32 a30,0
 v_accvgpr_write_b32 a31,0
 v_accvgpr_write_b32 a32,0
 v_accvgpr_write_b32 a33,0
 v_accvgpr_write_b32 a34,0
 v_accvgpr_write_b32 a35,0
 v_accvgpr_write_b32 a36,0
 v_accvgpr_write_b32 a37,0
 v_accvgpr_write_b32 a38,0
 v_accvgpr_write_b32 a39,0
 v_accvgpr_write_b32 a40,0
 v_accvgpr_write_b32 a41,0
 v_accvgpr_write_b32 a42,0
 v_accvgpr_write_b32 a43,0
 v_accvgpr_write_b32 a44,0
 v_accvgpr_write_b32 a45,0
 v_accvgpr_write_b32 a46,0
 v_accvgpr_write_b32 a47,0
 v_accvgpr_write_b32 a48,0
 v_accvgpr_write_b32 a49,0
 v_accvgpr_write_b32 a50,0
 v_accvgpr_write_b32 a51,0
 v_accvgpr_write_b32 a52,0
 v_accvgpr_write_b32 a53,0
 v_accvgpr_write_b32 a54,0
 v_accvgpr_write_b32 a55,0
 v_accvgpr_write_b32 a56,0
 v_accvgpr_write_b32 a57,0
 v_accvgpr_write_b32 a58,0
 v_accvgpr_write_b32 a59,0
 v_accvgpr_write_b32 a60,0
 v_accvgpr_write_b32 a61,0
 v_accvgpr_write_b32 a62,0
 v_accvgpr_write_b32 a63,0
 v_accvgpr_write_b32 a64,0
 v_accvgpr_write_b32 a65,0
 v_accvgpr_write_b32 a66,0
 v_accvgpr_write_b32 a67,0
 v_accvgpr_write_b32 a68,0
 v_accvgpr_write_b32 a69,0
 v_accvgpr_write_b32 a70,0
 v_accvgpr_write_b32 a71,0
 v_accvgpr_write_b32 a72,0
 v_accvgpr_write_b32 a73,0
 v_accvgpr_write_b32 a74,0
 v_accvgpr_write_b32 a75,0
 v_accvgpr_write_b32 a76,0
 v_accvgpr_write_b32 a77,0
 v_accvgpr_write_b32 a78,0
 v_accvgpr_write_b32 a79,0
 v_accvgpr_write_b32 a80,0
 v_accvgpr_write_b32 a81,0
 v_accvgpr_write_b32 a82,0
 v_accvgpr_write_b32 a83,0
 v_accvgpr_write_b32 a84,0
 v_accvgpr_write_b32 a85,0
 v_accvgpr_write_b32 a86,0
 v_accvgpr_write_b32 a87,0
 v_accvgpr_write_b32 a88,0
 v_accvgpr_write_b32 a89,0
 v_accvgpr_write_b32 a90,0
 v_accvgpr_write_b32 a91,0
 v_accvgpr_write_b32 a92,0
 v_accvgpr_write_b32 a93,0
 v_accvgpr_write_b32 a94,0
 v_accvgpr_write_b32 a95,0
 v_accvgpr_write_b32 a96,0
 v_accvgpr_write_b32 a97,0
 v_accvgpr_write_b32 a98,0
 v_accvgpr_write_b32 a99,0
 v_accvgpr_write_b32 a100,0
 v_accvgpr_write_b32 a101,0
 v_accvgpr_write_b32 a102,0
 v_accvgpr_write_b32 a103,0
 v_accvgpr_write_b32 a104,0
 v_accvgpr_write_b32 a105,0
 v_accvgpr_write_b32 a106,0
 v_accvgpr_write_b32 a107,0
 v_accvgpr_write_b32 a108,0
 v_accvgpr_write_b32 a109,0
 v_accvgpr_write_b32 a110,0
 v_accvgpr_write_b32 a111,0
 v_accvgpr_write_b32 a112,0
 v_accvgpr_write_b32 a113,0
 v_accvgpr_write_b32 a114,0
 v_accvgpr_write_b32 a115,0
 v_accvgpr_write_b32 a116,0
 v_accvgpr_write_b32 a117,0
 v_accvgpr_write_b32 a118,0
 v_accvgpr_write_b32 a119,0
 v_accvgpr_write_b32 a120,0
 v_accvgpr_write_b32 a121,0
 v_accvgpr_write_b32 a122,0
 v_accvgpr_write_b32 a123,0
 v_accvgpr_write_b32 a124,0
 v_accvgpr_write_b32 a125,0
 v_accvgpr_write_b32 a126,0
 v_accvgpr_write_b32 a127,0
 s_mov_b32 s71,0
K1_s2c:
 s_add_u32 s64,s70,s71
 s_add_u32 s65,s64,4096
 buffer_load_dwordx4 v[132:135],v48,s[12:15],s64 offen offset:0
 buffer_load_dwordx4 v[140:143],v48,s[12:15],s64 offen offset:64
 buffer_load_dwordx4 v[148:151],v48,s[12:15],s64 offen offset:128
 buffer_load_dwordx4 v[156:159],v48,s[12:15],s64 offen offset:192
 buffer_load_dwordx4 v[164:167],v48,s[12:15],s65 offen offset:0
 buffer_load_dwordx4 v[172:175],v48,s[12:15],s65 offen offset:64
 buffer_load_dwordx4 v[180:183],v48,s[12:15],s65 offen offset:128
 buffer_load_dwordx4 v[188:191],v48,s[12:15],s65 offen offset:192
 s_waitcnt vmcnt(0)
 v_mfma_f32_16x16x32_bf16 v[68:71],v[132:135],v[64:67],v[224:227]
 v_mfma_f32_16x16x32_bf16 v[68:71],v[140:143],v[96:99],v[68:71]
 v_mfma_f32_16x16x32_bf16 v[68:71],v[148:151],v[128:131],v[68:71]
 v_mfma_f32_16x16x32_bf16 v[68:71],v[156:159],v[160:163],v[68:71]
 v_mfma_f32_16x16x32_bf16 v[76:79],v[132:135],v[72:75],v[228:231]
 v_mfma_f32_16x16x32_bf16 v[76:79],v[140:143],v[104:107],v[76:79]
 v_mfma_f32_16x16x32_bf16 v[76:79],v[148:151],v[136:139],v[76:79]
 v_mfma_f32_16x16x32_bf16 v[76:79],v[156:159],v[168:171],v[76:79]
 v_mfma_f32_16x16x32_bf16 v[84:87],v[132:135],v[80:83],v[232:235]
 v_mfma_f32_16x16x32_bf16 v[84:87],v[140:143],v[112:115],v[84:87]
 v_mfma_f32_16x16x32_bf16 v[84:87],v[148:151],v[144:147],v[84:87]
 v_mfma_f32_16x16x32_bf16 v[84:87],v[156:159],v[176:179],v[84:87]
 v_mfma_f32_16x16x32_bf16 v[100:103],v[164:167],v[64:67],v[224:227]
 v_mfma_f32_16x16x32_bf16 v[100:103],v[172:175],v[96:99],v[100:103]
 v_mfma_f32_16x16x32_bf16 v[100:103],v[180:183],v[128:131],v[100:103]
 v_mfma_f32_16x16x32_bf16 v[100:103],v[188:191],v[160:163],v[100:103]
 v_mfma_f32_16x16x32_bf16 v[108:111],v[164:167],v[72:75],v[228:231]
 v_mfma_f32_16x16x32_bf16 v[108:111],v[172:175],v[104:107],v[108:111]
 v_mfma_f32_16x16x32_bf16 v[108:111],v[180:183],v[136:139],v[108:111]
 v_mfma_f32_16x16x32_bf16 v[108:111],v[188:191],v[168:171],v[108:111]
 v_mfma_f32_16x16x32_bf16 v[116:119],v[164:167],v[80:83],v[232:235]
 v_mfma_f32_16x16x32_bf16 v[116:119],v[172:175],v[112:115],v[116:119]
 v_mfma_f32_16x16x32_bf16 v[116:119],v[180:183],v[144:147],v[116:119]
 v_mfma_f32_16x16x32_bf16 v[116:119],v[188:191],v[176:179],v[116:119]
 s_nop 7
 v_exp_f32 v68,v68
 v_exp_f32 v69,v69
 v_exp_f32 v70,v70
 v_exp_f32 v71,v71
 s_nop 0
 v_add_f32 v248,v248,v68
 v_add_f32 v248,v248,v69
 v_add_f32 v248,v248,v70
 v_add_f32 v248,v248,v71
 v_cvt_pk_bf16_f32 v192,v68,v69
 v_cvt_pk_bf16_f32 v193,v70,v71
 v_exp_f32 v100,v100
 v_exp_f32 v101,v101
 v_exp_f32 v102,v102
 v_exp_f32 v103,v103
 s_nop 0
 v_add_f32 v248,v248,v100
 v_add_f32 v248,v248,v101
 v_add_f32 v248,v248,v102
 v_add_f32 v248,v248,v103
 v_cvt_pk_bf16_f32 v194,v100,v101
 v_cvt_pk_bf16_f32 v195,v102,v103
 v_exp_f32 v76,v76
 v_exp_f32 v77,v77
 v_exp_f32 v78,v78
 v_exp_f32 v79,v79
 s_nop 0
 v_add_f32 v249,v249,v76
 v_add_f32 v249,v249,v77
 v_add_f32 v249,v249,v78
 v_add_f32 v249,v249,v79
 v_cvt_pk_bf16_f32 v196,v76,v77
 v_cvt_pk_bf16_f32 v197,v78,v79
 v_exp_f32 v108,v108
 v_exp_f32 v109,v109
 v_exp_f32 v110,v110
 v_exp_f32 v111,v111
 s_nop 0
 v_add_f32 v249,v249,v108
 v_add_f32 v249,v249,v109
 v_add_f32 v249,v249,v110
 v_add_f32 v249,v249,v111
 v_cvt_pk_bf16_f32 v198,v108,v109
 v_cvt_pk_bf16_f32 v199,v110,v111
 v_exp_f32 v84,v84
 v_exp_f32 v85,v85
 v_exp_f32 v86,v86
 v_exp_f32 v87,v87
 s_nop 0
 v_add_f32 v250,v250,v84
 v_add_f32 v250,v250,v85
 v_add_f32 v250,v250,v86
 v_add_f32 v250,v250,v87
 v_cvt_pk_bf16_f32 v200,v84,v85
 v_cvt_pk_bf16_f32 v201,v86,v87
 v_exp_f32 v116,v116
 v_exp_f32 v117,v117
 v_exp_f32 v118,v118
 v_exp_f32 v119,v119
 s_nop 0
 v_add_f32 v250,v250,v116
 v_add_f32 v250,v250,v117
 v_add_f32 v250,v250,v118
 v_add_f32 v250,v250,v119
 v_cvt_pk_bf16_f32 v202,v116,v117
 v_cvt_pk_bf16_f32 v203,v118,v119
 buffer_load_ushort v208,v49,s[16:19],s64 offen offset:0
 buffer_load_ushort v209,v49,s[16:19],s64 offen offset:256
 buffer_load_ushort v210,v49,s[16:19],s64 offen offset:512
 buffer_load_ushort v211,v49,s[16:19],s64 offen offset:768
 buffer_load_ushort v212,v49,s[16:19],s65 offen offset:0
 buffer_load_ushort v213,v49,s[16:19],s65 offen offset:256
 buffer_load_ushort v214,v49,s[16:19],s65 offen offset:512
 buffer_load_ushort v215,v49,s[16:19],s65 offen offset:768
 s_waitcnt vmcnt(0)
 v_lshl_or_b32 v216,v209,16,v208
 v_lshl_or_b32 v217,v211,16,v210
 v_lshl_or_b32 v218,v213,16,v212
 v_lshl_or_b32 v219,v215,16,v214
 s_nop 1
 v_mfma_f32_16x16x32_bf16 a[0:3],v[216:219],v[192:195],a[0:3]
 v_mfma_f32_16x16x32_bf16 a[4:7],v[216:219],v[196:199],a[4:7]
 v_mfma_f32_16x16x32_bf16 a[8:11],v[216:219],v[200:203],a[8:11]
 buffer_load_ushort v208,v49,s[16:19],s64 offen offset:32
 buffer_load_ushort v209,v49,s[16:19],s64 offen offset:288
 buffer_load_ushort v210,v49,s[16:19],s64 offen offset:544
 buffer_load_ushort v211,v49,s[16:19],s64 offen offset:800
 buffer_load_ushort v212,v49,s[16:19],s65 offen offset:32
 buffer_load_ushort v213,v49,s[16:19],s65 offen offset:288
 buffer_load_ushort v214,v49,s[16:19],s65 offen offset:544
 buffer_load_ushort v215,v49,s[16:19],s65 offen offset:800
 s_waitcnt vmcnt(0)
 v_lshl_or_b32 v216,v209,16,v208
 v_lshl_or_b32 v217,v211,16,v210
 v_lshl_or_b32 v218,v213,16,v212
 v_lshl_or_b32 v219,v215,16,v214
 s_nop 1
 v_mfma_f32_16x16x32_bf16 a[16:19],v[216:219],v[192:195],a[16:19]
 v_mfma_f32_16x16x32_bf16 a[20:23],v[216:219],v[196:199],a[20:23]
 v_mfma_f32_16x16x32_bf16 a[24:27],v[216:219],v[200:203],a[24:27]
 buffer_load_ushort v208,v49,s[16:19],s64 offen offset:64
 buffer_load_ushort v209,v49,s[16:19],s64 offen offset:320
 buffer_load_ushort v210,v49,s[16:19],s64 offen offset:576
 buffer_load_ushort v211,v49,s[16:19],s64 offen offset:832
 buffer_load_ushort v212,v49,s[16:19],s65 offen offset:64
 buffer_load_ushort v213,v49,s[16:19],s65 offen offset:320
 buffer_load_ushort v214,v49,s[16:19],s65 offen offset:576
 buffer_load_ushort v215,v49,s[16:19],s65 offen offset:832
 s_waitcnt vmcnt(0)
 v_lshl_or_b32 v216,v209,16,v208
 v_lshl_or_b32 v217,v211,16,v210
 v_lshl_or_b32 v218,v213,16,v212
 v_lshl_or_b32 v219,v215,16,v214
 s_nop 1
 v_mfma_f32_16x16x32_bf16 a[32:35],v[216:219],v[192:195],a[32:35]
 v_mfma_f32_16x16x32_bf16 a[36:39],v[216:219],v[196:199],a[36:39]
 v_mfma_f32_16x16x32_bf16 a[40:43],v[216:219],v[200:203],a[40:43]
 buffer_load_ushort v208,v49,s[16:19],s64 offen offset:96
 buffer_load_ushort v209,v49,s[16:19],s64 offen offset:352
 buffer_load_ushort v210,v49,s[16:19],s64 offen offset:608
 buffer_load_ushort v211,v49,s[16:19],s64 offen offset:864
 buffer_load_ushort v212,v49,s[16:19],s65 offen offset:96
 buffer_load_ushort v213,v49,s[16:19],s65 offen offset:352
 buffer_load_ushort v214,v49,s[16:19],s65 offen offset:608
 buffer_load_ushort v215,v49,s[16:19],s65 offen offset:864
 s_waitcnt vmcnt(0)
 v_lshl_or_b32 v216,v209,16,v208
 v_lshl_or_b32 v217,v211,16,v210
 v_lshl_or_b32 v218,v213,16,v212
 v_lshl_or_b32 v219,v215,16,v214
 s_nop 1
 v_mfma_f32_16x16x32_bf16 a[48:51],v[216:219],v[192:195],a[48:51]
 v_mfma_f32_16x16x32_bf16 a[52:55],v[216:219],v[196:199],a[52:55]
 v_mfma_f32_16x16x32_bf16 a[56:59],v[216:219],v[200:203],a[56:59]
 buffer_load_ushort v208,v49,s[16:19],s64 offen offset:128
 buffer_load_ushort v209,v49,s[16:19],s64 offen offset:384
 buffer_load_ushort v210,v49,s[16:19],s64 offen offset:640
 buffer_load_ushort v211,v49,s[16:19],s64 offen offset:896
 buffer_load_ushort v212,v49,s[16:19],s65 offen offset:128
 buffer_load_ushort v213,v49,s[16:19],s65 offen offset:384
 buffer_load_ushort v214,v49,s[16:19],s65 offen offset:640
 buffer_load_ushort v215,v49,s[16:19],s65 offen offset:896
 s_waitcnt vmcnt(0)
 v_lshl_or_b32 v216,v209,16,v208
 v_lshl_or_b32 v217,v211,16,v210
 v_lshl_or_b32 v218,v213,16,v212
 v_lshl_or_b32 v219,v215,16,v214
 s_nop 1
 v_mfma_f32_16x16x32_bf16 a[64:67],v[216:219],v[192:195],a[64:67]
 v_mfma_f32_16x16x32_bf16 a[68:71],v[216:219],v[196:199],a[68:71]
 v_mfma_f32_16x16x32_bf16 a[72:75],v[216:219],v[200:203],a[72:75]
 buffer_load_ushort v208,v49,s[16:19],s64 offen offset:160
 buffer_load_ushort v209,v49,s[16:19],s64 offen offset:416
 buffer_load_ushort v210,v49,s[16:19],s64 offen offset:672
 buffer_load_ushort v211,v49,s[16:19],s64 offen offset:928
 buffer_load_ushort v212,v49,s[16:19],s65 offen offset:160
 buffer_load_ushort v213,v49,s[16:19],s65 offen offset:416
 buffer_load_ushort v214,v49,s[16:19],s65 offen offset:672
 buffer_load_ushort v215,v49,s[16:19],s65 offen offset:928
 s_waitcnt vmcnt(0)
 v_lshl_or_b32 v216,v209,16,v208
 v_lshl_or_b32 v217,v211,16,v210
 v_lshl_or_b32 v218,v213,16,v212
 v_lshl_or_b32 v219,v215,16,v214
 s_nop 1
 v_mfma_f32_16x16x32_bf16 a[80:83],v[216:219],v[192:195],a[80:83]
 v_mfma_f32_16x16x32_bf16 a[84:87],v[216:219],v[196:199],a[84:87]
 v_mfma_f32_16x16x32_bf16 a[88:91],v[216:219],v[200:203],a[88:91]
 buffer_load_ushort v208,v49,s[16:19],s64 offen offset:192
 buffer_load_ushort v209,v49,s[16:19],s64 offen offset:448
 buffer_load_ushort v210,v49,s[16:19],s64 offen offset:704
 buffer_load_ushort v211,v49,s[16:19],s64 offen offset:960
 buffer_load_ushort v212,v49,s[16:19],s65 offen offset:192
 buffer_load_ushort v213,v49,s[16:19],s65 offen offset:448
 buffer_load_ushort v214,v49,s[16:19],s65 offen offset:704
 buffer_load_ushort v215,v49,s[16:19],s65 offen offset:960
 s_waitcnt vmcnt(0)
 v_lshl_or_b32 v216,v209,16,v208
 v_lshl_or_b32 v217,v211,16,v210
 v_lshl_or_b32 v218,v213,16,v212
 v_lshl_or_b32 v219,v215,16,v214
 s_nop 1
 v_mfma_f32_16x16x32_bf16 a[96:99],v[216:219],v[192:195],a[96:99]
 v_mfma_f32_16x16x32_bf16 a[100:103],v[216:219],v[196:199],a[100:103]
 v_mfma_f32_16x16x32_bf16 a[104:107],v[216:219],v[200:203],a[104:107]
 buffer_load_ushort v208,v49,s[16:19],s64 offen offset:224
 buffer_load_ushort v209,v49,s[16:19],s64 offen offset:480
 buffer_load_ushort v210,v49,s[16:19],s64 offen offset:736
 buffer_load_ushort v211,v49,s[16:19],s64 offen offset:992
 buffer_load_ushort v212,v49,s[16:19],s65 offen offset:224
 buffer_load_ushort v213,v49,s[16:19],s65 offen offset:480
 buffer_load_ushort v214,v49,s[16:19],s65 offen offset:736
 buffer_load_ushort v215,v49,s[16:19],s65 offen offset:992
 s_waitcnt vmcnt(0)
 v_lshl_or_b32 v216,v209,16,v208
 v_lshl_or_b32 v217,v211,16,v210
 v_lshl_or_b32 v218,v213,16,v212
 v_lshl_or_b32 v219,v215,16,v214
 s_nop 1
 v_mfma_f32_16x16x32_bf16 a[112:115],v[216:219],v[192:195],a[112:115]
 v_mfma_f32_16x16x32_bf16 a[116:119],v[216:219],v[196:199],a[116:119]
 v_mfma_f32_16x16x32_bf16 a[120:123],v[216:219],v[200:203],a[120:123]
 s_nop 7
 s_add_u32 s71,s71,8192
 s_cmp_lt_u32 s71,262144
 s_cbranch_scc1 K1_s2c
 v_mov_b32 v44,v248
 s_nop 1
 v_permlane32_swap_b32 v248,v44
 s_nop 0
 v_add_f32 v248,v248,v44
 v_mov_b32 v44,v248
 s_nop 1
 v_permlane16_swap_b32 v248,v44
 s_nop 0
 v_add_f32 v248,v248,v44
 v_mov_b32 v45,v249
 s_nop 1
 v_permlane32_swap_b32 v249,v45
 s_nop 0
 v_add_f32 v249,v249,v45
 v_mov_b32 v45,v249
 s_nop 1
 v_permlane16_swap_b32 v249,v45
 s_nop 0
 v_add_f32 v249,v249,v45
 v_mov_b32 v46,v250
 s_nop 1
 v_permlane32_swap_b32 v250,v46
 s_nop 0
 v_add_f32 v250,v250,v46
 v_mov_b32 v46,v250
 s_nop 1
 v_permlane16_swap_b32 v250,v46
 s_nop 0
 v_add_f32 v250,v250,v46
 s_cmp_lg_u32 s33,0
 s_cbranch_scc1 K1_backLc
 s_branch K1_backc
 .p2align 6
K1_op:
 v_mov_b32 v2,v252
 v_cmp_eq_u32 vcc,8,v0
 v_mov_b32 v12,v253
 v_mov_b32 v13,v36
 v_cndmask_b32 v3,0,v1,vcc
 v_lshlrev_b32 v3,7,v3
 v_mov_b32 v8,v248
 v_mov_b32 v9,v249
 v_mov_b32 v10,v250
 v_mov_b32 v11,v251
 s_waitcnt vmcnt(20)
 v_cmp_lt_u32 vcc,v63,v3
 s_nop 1
 s_cbranch_vccnz OP_spin0
OP_back0:
 s_add_u32 s35,s57,0
 buffer_load_dwordx4 v[40:43],v2,s[48:51],s35 offen sc0 sc1
 s_add_u32 s35,s57,131072
 buffer_load_dwordx4 v[44:47],v2,s[48:51],s35 offen sc0 sc1
 s_add_u32 s35,s57,262144
 buffer_load_dwordx4 v[48:51],v2,s[48:51],s35 offen sc0 sc1
 s_add_u32 s35,s57,393216
 buffer_load_dwordx4 v[52:55],v2,s[48:51],s35 offen sc0 sc1
 s_add_u32 s35,s57,524288
 buffer_load_dwordx4 v[56:59],v2,s[48:51],s35 offen sc0 sc1
 s_add_u32 s35,s57,655360
 buffer_load_dwordx4 v[60:63],v2,s[48:51],s35 offen sc0 sc1
 s_add_u32 s35,s57,16384
 buffer_load_dwordx4 v[64:67],v2,s[48:51],s35 offen sc0 sc1
 s_add_u32 s35,s57,147456
 buffer_load_dwordx4 v[68:71],v2,s[48:51],s35 offen sc0 sc1
 s_add_u32 s35,s57,278528
 buffer_load_dwordx4 v[72:75],v2,s[48:51],s35 offen sc0 sc1
 s_add_u32 s35,s57,409600
 buffer_load_dwordx4 v[76:79],v2,s[48:51],s35 offen sc0 sc1
 s_add_u32 s35,s57,540672
 buffer_load_dwordx4 v[80:83],v2,s[48:51],s35 offen sc0 sc1
 s_add_u32 s35,s57,671744
 buffer_load_dwordx4 v[84:87],v2,s[48:51],s35 offen sc0 sc1
 s_add_u32 s35,s57,32768
 buffer_load_dwordx4 v[88:91],v2,s[48:51],s35 offen sc0 sc1
 s_add_u32 s35,s57,163840
 buffer_load_dwordx4 v[92:95],v2,s[48:51],s35 offen sc0 sc1
 s_add_u32 s35,s57,294912
 buffer_load_dwordx4 v[96:99],v2,s[48:51],s35 offen sc0 sc1
 s_add_u32 s35,s57,425984
 buffer_load_dwordx4 v[100:103],v2,s[48:51],s35 offen sc0 sc1
 s_add_u32 s35,s57,557056
 buffer_load_dwordx4 v[104:107],v2,s[48:51],s35 offen sc0 sc1
 s_add_u32 s35,s57,688128
 buffer_load_dwordx4 v[108:111],v2,s[48:51],s35 offen sc0 sc1
 v_cmp_le_u32 vcc,s62,v0
 v_cmp_ge_u32 s[68:69],s63,v0
 s_nop 1
 s_and_b64 vcc,vcc,s[68:69]
 v_cndmask_b32 v4,0,v1,vcc
 v_lshlrev_b32 v4,4,v4
 v_add_u32 v220,98304,v18
 v_add_u32 v221,98304,v19
 v_add_u32 v222,98304,v20
 v_add_u32 v223,98304,v21
 v_accvgpr_read_b32 v24,a0
 v_accvgpr_read_b32 v25,a1
 v_accvgpr_read_b32 v26,a2
 v_accvgpr_read_b32 v27,a3
 v_accvgpr_read_b32 v28,a16
 v_accvgpr_read_b32 v29,a17
 v_accvgpr_read_b32 v30,a18
 v_accvgpr_read_b32 v31,a19
 v_mul_f32 v24,v8,v24
 v_mul_f32 v25,v8,v25
 v_mul_f32 v26,v8,v26
 v_mul_f32 v27,v8,v27
 v_mul_f32 v28,v8,v28
 v_mul_f32 v29,v8,v29
 v_mul_f32 v30,v8,v30
 v_mul_f32 v31,v8,v31
 v_cvt_pk_bf16_f32 v24,v24,v25
 v_cvt_pk_bf16_f32 v25,v26,v27
 v_cvt_pk_bf16_f32 v26,v28,v29
 v_cvt_pk_bf16_f32 v27,v30,v31
 s_add_u32 s38,s31,0
 buffer_store_dwordx4 v[24:27],v13,s[20:23],s38 offen offset:0 sc0 sc1
 v_accvgpr_read_b32 v32,a4
 v_accvgpr_read_b32 v33,a5
 v_accvgpr_read_b32 v34,a6
 v_accvgpr_read_b32 v35,a7
 v_accvgpr_read_b32 v36,a20
 v_accvgpr_read_b32 v37,a21
 v_accvgpr_read_b32 v38,a22
 v_accvgpr_read_b32 v39,a23
 v_mul_f32 v32,v9,v32
 v_mul_f32 v33,v9,v33
 v_mul_f32 v34,v9,v34
 v_mul_f32 v35,v9,v35
 v_mul_f32 v36,v9,v36
 v_mul_f32 v37,v9,v37
 v_mul_f32 v38,v9,v38
 v_mul_f32 v39,v9,v39
 v_cvt_pk_bf16_f32 v32,v32,v33
 v_cvt_pk_bf16_f32 v33,v34,v35
 v_cvt_pk_bf16_f32 v34,v36,v37
 v_cvt_pk_bf16_f32 v35,v38,v39
 s_add_u32 s38,s31,131072
 buffer_store_dwordx4 v[32:35],v13,s[20:23],s38 offen offset:0 sc0 sc1
 v_accvgpr_read_b32 v192,a8
 v_accvgpr_read_b32 v193,a9
 v_accvgpr_read_b32 v194,a10
 v_accvgpr_read_b32 v195,a11
 v_accvgpr_read_b32 v196,a24
 v_accvgpr_read_b32 v197,a25
 v_accvgpr_read_b32 v198,a26
 v_accvgpr_read_b32 v199,a27
 v_mul_f32 v192,v10,v192
 v_mul_f32 v193,v10,v193
 v_mul_f32 v194,v10,v194
 v_mul_f32 v195,v10,v195
 v_mul_f32 v196,v10,v196
 v_mul_f32 v197,v10,v197
 v_mul_f32 v198,v10,v198
 v_mul_f32 v199,v10,v199
 v_cvt_pk_bf16_f32 v192,v192,v193
 v_cvt_pk_bf16_f32 v193,v194,v195
 v_cvt_pk_bf16_f32 v194,v196,v197
 v_cvt_pk_bf16_f32 v195,v198,v199
 s_add_u32 s38,s31,262144
 buffer_store_dwordx4 v[192:195],v13,s[20:23],s38 offen offset:0 sc0 sc1
 v_accvgpr_read_b32 v24,a12
 v_accvgpr_read_b32 v25,a13
 v_accvgpr_read_b32 v26,a14
 v_accvgpr_read_b32 v27,a15
 v_accvgpr_read_b32 v28,a28
 v_accvgpr_read_b32 v29,a29
 v_accvgpr_read_b32 v30,a30
 v_accvgpr_read_b32 v31,a31
 v_mul_f32 v24,v11,v24
 v_mul_f32 v25,v11,v25
 v_mul_f32 v26,v11,v26
 v_mul_f32 v27,v11,v27
 v_mul_f32 v28,v11,v28
 v_mul_f32 v29,v11,v29
 v_mul_f32 v30,v11,v30
 v_mul_f32 v31,v11,v31
 v_cvt_pk_bf16_f32 v24,v24,v25
 v_cvt_pk_bf16_f32 v25,v26,v27
 v_cvt_pk_bf16_f32 v26,v28,v29
 v_cvt_pk_bf16_f32 v27,v30,v31
 s_add_u32 s38,s31,393216
 buffer_store_dwordx4 v[24:27],v13,s[20:23],s38 offen offset:0 sc0 sc1
 s_waitcnt vmcnt(52)
 ds_read_b64_tr_b16 v[112:113],v20 offset:128
 ds_read_b64_tr_b16 v[114:115],v20 offset:6272
 ds_read_b64_tr_b16 v[116:117],v21 offset:128
 ds_read_b64_tr_b16 v[118:119],v21 offset:6272
 ds_read_b64_tr_b16 v[120:121],v18 offset:256
 ds_read_b64_tr_b16 v[122:123],v18 offset:6400
 ds_read_b64_tr_b16 v[124:125],v19 offset:256
 ds_read_b64_tr_b16 v[126:127],v19 offset:6400
 s_waitcnt vmcnt(16)
 s_waitcnt lgkmcnt(6)
 v_mfma_f32_16x16x32_bf16 a[144:147],v[112:115],v[40:43],0
 v_accvgpr_read_b32 v32,a32
 v_accvgpr_read_b32 v33,a33
 v_accvgpr_read_b32 v34,a34
 v_accvgpr_read_b32 v35,a35
 v_mfma_f32_16x16x32_bf16 a[148:151],v[112:115],v[44:47],0
 ds_read_b64_tr_b16 v[128:129],v20 offset:256
 v_accvgpr_read_b32 v36,a48
 v_accvgpr_read_b32 v37,a49
 v_accvgpr_read_b32 v38,a50
 v_accvgpr_read_b32 v39,a51
 v_mfma_f32_16x16x32_bf16 a[152:155],v[112:115],v[48:51],0
 ds_read_b64_tr_b16 v[130:131],v20 offset:6400
 v_mul_f32 v32,v8,v32
 v_mul_f32 v33,v8,v33
 v_mul_f32 v34,v8,v34
 v_mfma_f32_16x16x32_bf16 a[156:159],v[112:115],v[52:55],0
 v_mul_f32 v35,v8,v35
 v_mul_f32 v36,v8,v36
 v_mul_f32 v37,v8,v37
 v_mul_f32 v38,v8,v38
 v_mfma_f32_16x16x32_bf16 a[160:163],v[112:115],v[56:59],0
 v_mul_f32 v39,v8,v39
 v_cvt_pk_bf16_f32 v32,v32,v33
 v_cvt_pk_bf16_f32 v33,v34,v35
 v_mfma_f32_16x16x32_bf16 a[164:167],v[112:115],v[60:63],0
 s_waitcnt lgkmcnt(6)
 v_cvt_pk_bf16_f32 v34,v36,v37
 v_cvt_pk_bf16_f32 v35,v38,v39
 s_add_u32 s38,s31,0
 buffer_store_dwordx4 v[32:35],v13,s[20:23],s38 offen offset:1024 sc0 sc1
 v_accvgpr_read_b32 v192,a36
 v_mfma_f32_16x16x32_bf16 a[168:171],v[116:119],v[40:43],0
 v_accvgpr_read_b32 v193,a37
 v_accvgpr_read_b32 v194,a38
 v_accvgpr_read_b32 v195,a39
 v_accvgpr_read_b32 v196,a52
 v_mfma_f32_16x16x32_bf16 a[172:175],v[116:119],v[44:47],0
 ds_read_b64_tr_b16 v[132:133],v21 offset:256
 v_accvgpr_read_b32 v197,a53
 v_accvgpr_read_b32 v198,a54
 v_accvgpr_read_b32 v199,a55
 v_mfma_f32_16x16x32_bf16 a[176:179],v[116:119],v[48:51],0
 ds_read_b64_tr_b16 v[134:135],v21 offset:6400
 v_mul_f32 v192,v9,v192
 v_mul_f32 v193,v9,v193
 v_mul_f32 v194,v9,v194
 v_mul_f32 v195,v9,v195
 v_mfma_f32_16x16x32_bf16 a[180:183],v[116:119],v[52:55],0
 v_mul_f32 v196,v9,v196
 v_mul_f32 v197,v9,v197
 v_mul_f32 v198,v9,v198
 v_mfma_f32_16x16x32_bf16 a[184:187],v[116:119],v[56:59],0
 v_mul_f32 v199,v9,v199
 v_cvt_pk_bf16_f32 v192,v192,v193
 v_cvt_pk_bf16_f32 v193,v194,v195
 v_cvt_pk_bf16_f32 v194,v196,v197
 v_mfma_f32_16x16x32_bf16 a[188:191],v[116:119],v[60:63],0
 s_waitcnt lgkmcnt(6)
 v_cvt_pk_bf16_f32 v195,v198,v199
 s_add_u32 s38,s31,131072
 buffer_store_dwordx4 v[192:195],v13,s[20:23],s38 offen offset:1024 sc0 sc1
 v_accvgpr_read_b32 v24,a40
 v_accvgpr_read_b32 v25,a41
 v_mfma_f32_16x16x32_bf16 a[192:195],v[120:123],v[40:43],0
 v_accvgpr_read_b32 v26,a42
 v_accvgpr_read_b32 v27,a43
 v_accvgpr_read_b32 v28,a56
 v_mfma_f32_16x16x32_bf16 a[196:199],v[120:123],v[44:47],0
 s_waitcnt vmcnt(36)
 ds_read_b64_tr_b16 v[136:137],v20 offset:49280
 v_accvgpr_read_b32 v29,a57
 v_accvgpr_read_b32 v30,a58
 v_accvgpr_read_b32 v31,a59
 v_mul_f32 v24,v10,v24
 v_mfma_f32_16x16x32_bf16 a[200:203],v[120:123],v[48:51],0
 ds_read_b64_tr_b16 v[138:139],v20 offset:55424
 v_mul_f32 v25,v10,v25
 v_mul_f32 v26,v10,v26
 v_mul_f32 v27,v10,v27
 v_mfma_f32_16x16x32_bf16 a[204:207],v[120:123],v[52:55],0
 v_mul_f32 v28,v10,v28
 v_mul_f32 v29,v10,v29
 v_mul_f32 v30,v10,v30
 v_mul_f32 v31,v10,v31
 v_mfma_f32_16x16x32_bf16 a[208:211],v[120:123],v[56:59],0
 v_cvt_pk_bf16_f32 v24,v24,v25
 v_cvt_pk_bf16_f32 v25,v26,v27
 v_cvt_pk_bf16_f32 v26,v28,v29
 v_cvt_pk_bf16_f32 v27,v30,v31
 v_mfma_f32_16x16x32_bf16 a[212:215],v[120:123],v[60:63],0
 s_waitcnt lgkmcnt(6)
 s_add_u32 s38,s31,262144
 buffer_store_dwordx4 v[24:27],v13,s[20:23],s38 offen offset:1024 sc0 sc1
 v_accvgpr_read_b32 v32,a44
 v_accvgpr_read_b32 v33,a45
 v_mfma_f32_16x16x32_bf16 a[216:219],v[124:127],v[40:43],0
 v_accvgpr_read_b32 v34,a46
 v_accvgpr_read_b32 v35,a47
 v_accvgpr_read_b32 v36,a60
 v_accvgpr_read_b32 v37,a61
 v_mfma_f32_16x16x32_bf16 a[220:223],v[124:127],v[44:47],0
 ds_read_b64_tr_b16 v[140:141],v21 offset:49280
 v_accvgpr_read_b32 v38,a62
 v_accvgpr_read_b32 v39,a63
 v_mul_f32 v32,v11,v32
 v_mfma_f32_16x16x32_bf16 a[224:227],v[124:127],v[48:51],0
 ds_read_b64_tr_b16 v[142:143],v21 offset:55424
 v_mul_f32 v33,v11,v33
 v_mul_f32 v34,v11,v34
 v_mul_f32 v35,v11,v35
 v_mul_f32 v36,v11,v36
 v_mfma_f32_16x16x32_bf16 a[228:231],v[124:127],v[52:55],0
 v_mul_f32 v37,v11,v37
 v_mul_f32 v38,v11,v38
 v_mul_f32 v39,v11,v39
 v_cvt_pk_bf16_f32 v32,v32,v33
 v_mfma_f32_16x16x32_bf16 a[232:235],v[124:127],v[56:59],0
 v_cvt_pk_bf16_f32 v33,v34,v35
 v_cvt_pk_bf16_f32 v34,v36,v37
 v_cvt_pk_bf16_f32 v35,v38,v39
 v_mfma_f32_16x16x32_bf16 a[236:239],v[124:127],v[60:63],0
 s_waitcnt lgkmcnt(6)
 s_add_u32 s38,s31,393216
 buffer_store_dwordx4 v[32:35],v13,s[20:23],s38 offen offset:1024 sc0 sc1
 v_accvgpr_read_b32 v192,a64
 v_accvgpr_read_b32 v193,a65
 v_accvgpr_read_b32 v194,a66
 v_mfma_f32_16x16x32_bf16 a[240:243],v[128:131],v[40:43],0
 v_accvgpr_read_b32 v195,a67
 v_accvgpr_read_b32 v196,a80
 v_accvgpr_read_b32 v197,a81
 v_mfma_f32_16x16x32_bf16 a[244:247],v[128:131],v[44:47],0
 ds_read_b64_tr_b16 v[112:113],v18 offset:49408
 v_accvgpr_read_b32 v198,a82
 v_accvgpr_read_b32 v199,a83
 v_mul_f32 v192,v8,v192
 v_mul_f32 v193,v8,v193
 v_mfma_f32_16x16x32_bf16 a[248:251],v[128:131],v[48:51],0
 ds_read_b64_tr_b16 v[114:115],v18 offset:55552
 v_mul_f32 v194,v8,v194
 v_mul_f32 v195,v8,v195
 v_mul_f32 v196,v8,v196
 v_mul_f32 v197,v8,v197
 v_mfma_f32_16x16x32_bf16 a[252:255],v[128:131],v[52:55],0
 v_mul_f32 v198,v8,v198
 v_mul_f32 v199,v8,v199
 v_cvt_pk_bf16_f32 v192,v192,v193
 v_mfma_f32_16x16x32_bf16 v[224:227],v[128:131],v[56:59],0
 v_cvt_pk_bf16_f32 v193,v194,v195
 v_cvt_pk_bf16_f32 v194,v196,v197
 v_cvt_pk_bf16_f32 v195,v198,v199
 s_add_u32 s38,s31,0
 buffer_store_dwordx4 v[192:195],v13,s[20:23],s38 offen offset:2048 sc0 sc1
 v_mfma_f32_16x16x32_bf16 v[228:231],v[128:131],v[60:63],0
 s_waitcnt lgkmcnt(6)
 v_accvgpr_read_b32 v24,a68
 v_accvgpr_read_b32 v25,a69
 v_accvgpr_read_b32 v26,a70
 v_mfma_f32_16x16x32_bf16 v[232:235],v[132:135],v[40:43],0
 v_accvgpr_read_b32 v27,a71
 v_accvgpr_read_b32 v28,a84
 v_accvgpr_read_b32 v29,a85
 v_accvgpr_read_b32 v30,a86
 v_mfma_f32_16x16x32_bf16 v[236:239],v[132:135],v[44:47],0
 ds_read_b64_tr_b16 v[116:117],v19 offset:49408
 v_accvgpr_read_b32 v31,a87
 v_mul_f32 v24,v9,v24
 v_mul_f32 v25,v9,v25
 v_mul_f32 v26,v9,v26
 v_mfma_f32_16x16x32_bf16 v[240:243],v[132:135],v[48:51],0
 ds_read_b64_tr_b16 v[118:119],v19 offset:55552
 v_mul_f32 v27,v9,v27
 v_mul_f32 v28,v9,v28
 v_mul_f32 v29,v9,v29
 v_mfma_f32_16x16x32_bf16 v[244:247],v[132:135],v[52:55],0
 v_mul_f32 v30,v9,v30
 v_mul_f32 v31,v9,v31
 v_cvt_pk_bf16_f32 v24,v24,v25
 v_cvt_pk_bf16_f32 v25,v26,v27
 v_mfma_f32_16x16x32_bf16 v[248:251],v[132:135],v[56:59],0
 v_cvt_pk_bf16_f32 v26,v28,v29
 v_cvt_pk_bf16_f32 v27,v30,v31
 s_add_u32 s38,s31,131072
 buffer_store_dwordx4 v[24:27],v13,s[20:23],s38 offen offset:2048 sc0 sc1
 v_mfma_f32_16x16x32_bf16 v[252:255],v[132:135],v[60:63],0
 s_waitcnt lgkmcnt(6)
 v_accvgpr_read_b32 v32,a72
 v_accvgpr_read_b32 v33,a73
 v_accvgpr_read_b32 v34,a74
 v_accvgpr_read_b32 v35,a75
 s_waitcnt vmcnt(16)
 v_mfma_f32_16x16x32_bf16 a[144:147],v[136:139],v[64:67],a[144:147]
 v_accvgpr_read_b32 v36,a88
 v_accvgpr_read_b32 v37,a89
 v_accvgpr_read_b32 v38,a90
 v_accvgpr_read_b32 v39,a91
 v_mfma_f32_16x16x32_bf16 a[148:151],v[136:139],v[68:71],a[148:151]
 ds_read_b64_tr_b16 v[120:121],v20 offset:49408
 v_mul_f32 v32,v10,v32
 v_mul_f32 v33,v10,v33
 v_mul_f32 v34,v10,v34
 v_mfma_f32_16x16x32_bf16 a[152:155],v[136:139],v[72:75],a[152:155]
 ds_read_b64_tr_b16 v[122:123],v20 offset:55552
 v_mul_f32 v35,v10,v35
 v_mul_f32 v36,v10,v36
 v_mul_f32 v37,v10,v37
 v_mul_f32 v38,v10,v38
 v_mfma_f32_16x16x32_bf16 a[156:159],v[136:139],v[76:79],a[156:159]
 v_mul_f32 v39,v10,v39
 v_cvt_pk_bf16_f32 v32,v32,v33
 v_cvt_pk_bf16_f32 v33,v34,v35
 v_mfma_f32_16x16x32_bf16 a[160:163],v[136:139],v[80:83],a[160:163]
 v_cvt_pk_bf16_f32 v34,v36,v37
 v_cvt_pk_bf16_f32 v35,v38,v39
 s_add_u32 s38,s31,262144
 buffer_store_dwordx4 v[32:35],v13,s[20:23],s38 offen offset:2048 sc0 sc1
 v_accvgpr_read_b32 v192,a76
 v_mfma_f32_16x16x32_bf16 a[164:167],v[136:139],v[84:87],a[164:167]
 s_waitcnt lgkmcnt(6)
 v_accvgpr_read_b32 v193,a77
 v_accvgpr_read_b32 v194,a78
 v_accvgpr_read_b32 v195,a79
 v_accvgpr_read_b32 v196,a92
 v_mfma_f32_16x16x32_bf16 a[168:171],v[140:143],v[64:67],a[168:171]
 v_accvgpr_read_b32 v197,a93
 v_accvgpr_read_b32 v198,a94
 v_accvgpr_read_b32 v199,a95
 v_mfma_f32_16x16x32_bf16 a[172:175],v[140:143],v[68:71],a[172:175]
 ds_read_b64_tr_b16 v[124:125],v21 offset:49408
 v_mul_f32 v192,v11,v192
 v_mul_f32 v193,v11,v193
 v_mul_f32 v194,v11,v194
 v_mul_f32 v195,v11,v195
 v_mfma_f32_16x16x32_bf16 a[176:179],v[140:143],v[72:75],a[176:179]
 ds_read_b64_tr_b16 v[126:127],v21 offset:55552
 v_mul_f32 v196,v11,v196
 v_mul_f32 v197,v11,v197
 v_mul_f32 v198,v11,v198
 v_mfma_f32_16x16x32_bf16 a[180:183],v[140:143],v[76:79],a[180:183]
 v_mul_f32 v199,v11,v199
 v_cvt_pk_bf16_f32 v192,v192,v193
 v_cvt_pk_bf16_f32 v193,v194,v195
 v_cvt_pk_bf16_f32 v194,v196,v197
 v_mfma_f32_16x16x32_bf16 a[184:187],v[140:143],v[80:83],a[184:187]
 v_cvt_pk_bf16_f32 v195,v198,v199
 s_add_u32 s38,s31,393216
 buffer_store_dwordx4 v[192:195],v13,s[20:23],s38 offen offset:2048 sc0 sc1
 v_accvgpr_read_b32 v24,a96
 v_accvgpr_read_b32 v25,a97
 v_mfma_f32_16x16x32_bf16 a[188:191],v[140:143],v[84:87],a[188:191]
 s_waitcnt lgkmcnt(6)
 v_accvgpr_read_b32 v26,a98
 v_accvgpr_read_b32 v27,a99
 v_accvgpr_read_b32 v28,a112
 v_mfma_f32_16x16x32_bf16 a[192:195],v[112:115],v[64:67],a[192:195]
 v_accvgpr_read_b32 v29,a113
 v_accvgpr_read_b32 v30,a114
 v_accvgpr_read_b32 v31,a115
 v_mul_f32 v24,v8,v24
 v_mfma_f32_16x16x32_bf16 a[196:199],v[112:115],v[68:71],a[196:199]
 ds_read_b64_tr_b16 v[128:129],v18 offset:0
 v_mul_f32 v25,v8,v25
 v_mul_f32 v26,v8,v26
 v_mul_f32 v27,v8,v27
 v_mfma_f32_16x16x32_bf16 a[200:203],v[112:115],v[72:75],a[200:203]
 ds_read_b64_tr_b16 v[130:131],v18 offset:6144
 v_mul_f32 v28,v8,v28
 v_mul_f32 v29,v8,v29
 v_mul_f32 v30,v8,v30
 v_mul_f32 v31,v8,v31
 v_mfma_f32_16x16x32_bf16 a[204:207],v[112:115],v[76:79],a[204:207]
 v_cvt_pk_bf16_f32 v24,v24,v25
 v_cvt_pk_bf16_f32 v25,v26,v27
 v_cvt_pk_bf16_f32 v26,v28,v29
 v_cvt_pk_bf16_f32 v27,v30,v31
 v_mfma_f32_16x16x32_bf16 a[208:211],v[112:115],v[80:83],a[208:211]
 s_add_u32 s38,s31,0
 buffer_store_dwordx4 v[24:27],v13,s[20:23],s38 offen offset:3072 sc0 sc1
 v_accvgpr_read_b32 v32,a100
 v_accvgpr_read_b32 v33,a101
 v_mfma_f32_16x16x32_bf16 a[212:215],v[112:115],v[84:87],a[212:215]
 s_waitcnt lgkmcnt(6)
 v_accvgpr_read_b32 v34,a102
 v_accvgpr_read_b32 v35,a103
 v_accvgpr_read_b32 v36,a116
 v_accvgpr_read_b32 v37,a117
 v_mfma_f32_16x16x32_bf16 a[216:219],v[116:119],v[64:67],a[216:219]
 v_accvgpr_read_b32 v38,a118
 v_accvgpr_read_b32 v39,a119
 v_mul_f32 v32,v9,v32
 v_mfma_f32_16x16x32_bf16 a[220:223],v[116:119],v[68:71],a[220:223]
 ds_read_b64_tr_b16 v[132:133],v19 offset:0
 v_mul_f32 v33,v9,v33
 v_mul_f32 v34,v9,v34
 v_mul_f32 v35,v9,v35
 v_mul_f32 v36,v9,v36
 v_mfma_f32_16x16x32_bf16 a[224:227],v[116:119],v[72:75],a[224:227]
 ds_read_b64_tr_b16 v[134:135],v19 offset:6144
 v_mul_f32 v37,v9,v37
 v_mul_f32 v38,v9,v38
 v_mul_f32 v39,v9,v39
 v_cvt_pk_bf16_f32 v32,v32,v33
 v_mfma_f32_16x16x32_bf16 a[228:231],v[116:119],v[76:79],a[228:231]
 v_cvt_pk_bf16_f32 v33,v34,v35
 v_cvt_pk_bf16_f32 v34,v36,v37
 v_cvt_pk_bf16_f32 v35,v38,v39
 v_mfma_f32_16x16x32_bf16 a[232:235],v[116:119],v[80:83],a[232:235]
 s_add_u32 s38,s31,131072
 buffer_store_dwordx4 v[32:35],v13,s[20:23],s38 offen offset:3072 sc0 sc1
 v_accvgpr_read_b32 v192,a104
 v_accvgpr_read_b32 v193,a105
 v_accvgpr_read_b32 v194,a106
 v_mfma_f32_16x16x32_bf16 a[236:239],v[116:119],v[84:87],a[236:239]
 s_waitcnt lgkmcnt(6)
 v_accvgpr_read_b32 v195,a107
 v_accvgpr_read_b32 v196,a120
 v_accvgpr_read_b32 v197,a121
 v_mfma_f32_16x16x32_bf16 a[240:243],v[120:123],v[64:67],a[240:243]
 v_accvgpr_read_b32 v198,a122
 v_accvgpr_read_b32 v199,a123
 v_mul_f32 v192,v10,v192
 v_mul_f32 v193,v10,v193
 v_mfma_f32_16x16x32_bf16 a[244:247],v[120:123],v[68:71],a[244:247]
 ds_read_b64_tr_b16 v[136:137],v20 offset:0
 v_mul_f32 v194,v10,v194
 v_mul_f32 v195,v10,v195
 v_mul_f32 v196,v10,v196
 v_mul_f32 v197,v10,v197
 v_mfma_f32_16x16x32_bf16 a[248:251],v[120:123],v[72:75],a[248:251]
 ds_read_b64_tr_b16 v[138:139],v20 offset:6144
 v_mul_f32 v198,v10,v198
 v_mul_f32 v199,v10,v199
 v_cvt_pk_bf16_f32 v192,v192,v193
 v_mfma_f32_16x16x32_bf16 a[252:255],v[120:123],v[76:79],a[252:255]
 v_cvt_pk_bf16_f32 v193,v194,v195
 v_cvt_pk_bf16_f32 v194,v196,v197
 v_cvt_pk_bf16_f32 v195,v198,v199
 s_add_u32 s38,s31,262144
 buffer_store_dwordx4 v[192:195],v13,s[20:23],s38 offen offset:3072 sc0 sc1
 v_mfma_f32_16x16x32_bf16 v[224:227],v[120:123],v[80:83],v[224:227]
 v_accvgpr_read_b32 v24,a108
 v_accvgpr_read_b32 v25,a109
 v_accvgpr_read_b32 v26,a110
 v_mfma_f32_16x16x32_bf16 v[228:231],v[120:123],v[84:87],v[228:231]
 s_waitcnt lgkmcnt(6)
 v_accvgpr_read_b32 v27,a111
 v_accvgpr_read_b32 v28,a124
 v_accvgpr_read_b32 v29,a125
 v_accvgpr_read_b32 v30,a126
 v_mfma_f32_16x16x32_bf16 v[232:235],v[124:127],v[64:67],v[232:235]
 v_accvgpr_read_b32 v31,a127
 v_mul_f32 v24,v11,v24
 v_mul_f32 v25,v11,v25
 v_mul_f32 v26,v11,v26
 v_mfma_f32_16x16x32_bf16 v[236:239],v[124:127],v[68:71],v[236:239]
 ds_read_b64_tr_b16 v[140:141],v21 offset:0
 v_mul_f32 v27,v11,v27
 v_mul_f32 v28,v11,v28
 v_mul_f32 v29,v11,v29
 v_mfma_f32_16x16x32_bf16 v[240:243],v[124:127],v[72:75],v[240:243]
 ds_read_b64_tr_b16 v[142:143],v21 offset:6144
 v_mul_f32 v30,v11,v30
 v_mul_f32 v31,v11,v31
 v_cvt_pk_bf16_f32 v24,v24,v25
 v_cvt_pk_bf16_f32 v25,v26,v27
 v_mfma_f32_16x16x32_bf16 v[244:247],v[124:127],v[76:79],v[244:247]
 v_cvt_pk_bf16_f32 v26,v28,v29
 v_cvt_pk_bf16_f32 v27,v30,v31
 s_add_u32 s38,s31,393216
 buffer_store_dwordx4 v[24:27],v13,s[20:23],s38 offen offset:3072 sc0 sc1
 v_mfma_f32_16x16x32_bf16 v[248:251],v[124:127],v[80:83],v[248:251]
 v_mfma_f32_16x16x32_bf16 v[252:255],v[124:127],v[84:87],v[252:255]
 s_waitcnt lgkmcnt(6)
 v_mfma_f32_16x16x32_bf16 a[0:3],v[128:131],v[40:43],0
 v_mfma_f32_16x16x32_bf16 a[4:7],v[128:131],v[44:47],0
 ds_read_b64_tr_b16 v[112:113],v18 offset:128
 v_mfma_f32_16x16x32_bf16 a[8:11],v[128:131],v[48:51],0
 ds_read_b64_tr_b16 v[114:115],v18 offset:6272
 v_mfma_f32_16x16x32_bf16 a[12:15],v[128:131],v[52:55],0
 v_mfma_f32_16x16x32_bf16 a[16:19],v[128:131],v[56:59],0
 v_mfma_f32_16x16x32_bf16 a[20:23],v[128:131],v[60:63],0
 s_waitcnt lgkmcnt(6)
 v_mfma_f32_16x16x32_bf16 a[24:27],v[132:135],v[40:43],0
 v_mfma_f32_16x16x32_bf16 a[28:31],v[132:135],v[44:47],0
 ds_read_b64_tr_b16 v[116:117],v19 offset:128
 v_mfma_f32_16x16x32_bf16 a[32:35],v[132:135],v[48:51],0
 ds_read_b64_tr_b16 v[118:119],v19 offset:6272
 v_mfma_f32_16x16x32_bf16 a[36:39],v[132:135],v[52:55],0
 v_mfma_f32_16x16x32_bf16 a[40:43],v[132:135],v[56:59],0
 v_mfma_f32_16x16x32_bf16 a[44:47],v[132:135],v[60:63],0
 s_waitcnt lgkmcnt(6)
 v_mfma_f32_16x16x32_bf16 a[48:51],v[136:139],v[40:43],0
 v_mfma_f32_16x16x32_bf16 a[52:55],v[136:139],v[44:47],0
 ds_read_b64_tr_b16 v[120:121],v18 offset:49152
 v_mfma_f32_16x16x32_bf16 a[56:59],v[136:139],v[48:51],0
 ds_read_b64_tr_b16 v[122:123],v18 offset:55296
 v_mfma_f32_16x16x32_bf16 a[60:63],v[136:139],v[52:55],0
 v_mfma_f32_16x16x32_bf16 a[64:67],v[136:139],v[56:59],0
 s_waitcnt lgkmcnt(2)
 s_add_u32 m0,s92,0
 s_add_u32 s34,s56,1769472
 buffer_load_dwordx4 v14,s[44:47],s34 offen lds
 v_mfma_f32_16x16x32_bf16 a[68:71],v[136:139],v[60:63],0
 v_mfma_f32_16x16x32_bf16 a[72:75],v[140:143],v[40:43],0
 v_mfma_f32_16x16x32_bf16 a[76:79],v[140:143],v[44:47],0
 ds_read_b64_tr_b16 v[124:125],v19 offset:49152
 s_add_u32 m0,s92,1024
 s_add_u32 s34,s56,1769472
 buffer_load_dwordx4 v15,s[44:47],s34 offen lds
 v_mfma_f32_16x16x32_bf16 a[80:83],v[140:143],v[48:51],0
 ds_read_b64_tr_b16 v[126:127],v19 offset:55296
 v_mfma_f32_16x16x32_bf16 a[84:87],v[140:143],v[52:55],0
 v_mfma_f32_16x16x32_bf16 a[88:91],v[140:143],v[56:59],0
 s_add_u32 m0,s92,2048
 s_add_u32 s34,s56,1769472
 buffer_load_dwordx4 v16,s[44:47],s34 offen lds
 v_mfma_f32_16x16x32_bf16 a[92:95],v[140:143],v[60:63],0
 v_mfma_f32_16x16x32_bf16 a[96:99],v[112:115],v[40:43],0
 v_mfma_f32_16x16x32_bf16 a[100:103],v[112:115],v[44:47],0
 ds_read_b64_tr_b16 v[128:129],v20 offset:49152
 s_add_u32 m0,s92,3072
 s_add_u32 s34,s56,1778688
 buffer_load_dwordx4 v14,s[44:47],s34 offen lds
 v_mfma_f32_16x16x32_bf16 a[104:107],v[112:115],v[48:51],0
 ds_read_b64_tr_b16 v[130:131],v20 offset:55296
 v_mfma_f32_16x16x32_bf16 a[108:111],v[112:115],v[52:55],0
 v_mfma_f32_16x16x32_bf16 a[112:115],v[112:115],v[56:59],0
 s_add_u32 m0,s92,4096
 s_add_u32 s34,s56,1778688
 buffer_load_dwordx4 v15,s[44:47],s34 offen lds
 v_mfma_f32_16x16x32_bf16 a[116:119],v[112:115],v[60:63],0
 v_mfma_f32_16x16x32_bf16 a[120:123],v[116:119],v[40:43],0
 v_mfma_f32_16x16x32_bf16 a[124:127],v[116:119],v[44:47],0
 ds_read_b64_tr_b16 v[132:133],v21 offset:49152
 s_add_u32 m0,s92,5120
 s_add_u32 s34,s56,1778688
 buffer_load_dwordx4 v16,s[44:47],s34 offen lds
 v_mfma_f32_16x16x32_bf16 a[128:131],v[116:119],v[48:51],0
 ds_read_b64_tr_b16 v[134:135],v21 offset:55296
 v_mfma_f32_16x16x32_bf16 a[132:135],v[116:119],v[52:55],0
 v_mfma_f32_16x16x32_bf16 a[136:139],v[116:119],v[56:59],0
 s_add_u32 m0,s92,6144
 s_add_u32 s34,s56,1787904
 buffer_load_dwordx4 v14,s[44:47],s34 offen lds
 v_mfma_f32_16x16x32_bf16 a[140:143],v[116:119],v[60:63],0
 s_waitcnt lgkmcnt(6)
 v_mfma_f32_16x16x32_bf16 a[0:3],v[120:123],v[64:67],a[0:3]
 v_mfma_f32_16x16x32_bf16 a[4:7],v[120:123],v[68:71],a[4:7]
 ds_read_b64_tr_b16 v[136:137],v18 offset:49280
 s_add_u32 m0,s92,7168
 s_add_u32 s34,s56,1787904
 buffer_load_dwordx4 v15,s[44:47],s34 offen lds
 v_mfma_f32_16x16x32_bf16 a[8:11],v[120:123],v[72:75],a[8:11]
 ds_read_b64_tr_b16 v[138:139],v18 offset:55424
 v_mfma_f32_16x16x32_bf16 a[12:15],v[120:123],v[76:79],a[12:15]
 v_mfma_f32_16x16x32_bf16 a[16:19],v[120:123],v[80:83],a[16:19]
 s_add_u32 m0,s92,8192
 s_add_u32 s34,s56,1787904
 buffer_load_dwordx4 v16,s[44:47],s34 offen lds
 v_mfma_f32_16x16x32_bf16 a[20:23],v[120:123],v[84:87],a[20:23]
 s_waitcnt lgkmcnt(6)
 v_mfma_f32_16x16x32_bf16 a[24:27],v[124:127],v[64:67],a[24:27]
 v_mfma_f32_16x16x32_bf16 a[28:31],v[124:127],v[68:71],a[28:31]
 ds_read_b64_tr_b16 v[140:141],v19 offset:49280
 s_add_u32 m0,s92,9216
 s_add_u32 s34,s56,1797120
 buffer_load_dwordx4 v14,s[44:47],s34 offen lds
 v_mfma_f32_16x16x32_bf16 a[32:35],v[124:127],v[72:75],a[32:35]
 ds_read_b64_tr_b16 v[142:143],v19 offset:55424
 v_mfma_f32_16x16x32_bf16 a[36:39],v[124:127],v[76:79],a[36:39]
 v_mfma_f32_16x16x32_bf16 a[40:43],v[124:127],v[80:83],a[40:43]
 s_add_u32 m0,s92,10240
 s_add_u32 s34,s56,1797120
 buffer_load_dwordx4 v15,s[44:47],s34 offen lds
 v_mfma_f32_16x16x32_bf16 a[44:47],v[124:127],v[84:87],a[44:47]
 s_waitcnt lgkmcnt(6)
 v_mfma_f32_16x16x32_bf16 a[48:51],v[128:131],v[64:67],a[48:51]
 v_mfma_f32_16x16x32_bf16 a[52:55],v[128:131],v[68:71],a[52:55]
 s_waitcnt vmcnt(45)
 ds_read_b64_tr_b16 v[112:113],v220 offset:0
 s_add_u32 m0,s92,11264
 s_add_u32 s34,s56,1797120
 buffer_load_dwordx4 v16,s[44:47],s34 offen lds
 v_mfma_f32_16x16x32_bf16 a[56:59],v[128:131],v[72:75],a[56:59]
 ds_read_b64_tr_b16 v[114:115],v220 offset:6144
 v_mfma_f32_16x16x32_bf16 a[60:63],v[128:131],v[76:79],a[60:63]
 v_mfma_f32_16x16x32_bf16 a[64:67],v[128:131],v[80:83],a[64:67]
 s_add_u32 s35,s57,49152
 buffer_load_dwordx4 v[40:43],v2,s[48:51],s35 offen sc0 sc1
 v_mfma_f32_16x16x32_bf16 a[68:71],v[128:131],v[84:87],a[68:71]
 s_waitcnt lgkmcnt(6)
 v_mfma_f32_16x16x32_bf16 a[72:75],v[132:135],v[64:67],a[72:75]
 v_mfma_f32_16x16x32_bf16 a[76:79],v[132:135],v[68:71],a[76:79]
 ds_read_b64_tr_b16 v[116:117],v221 offset:0
 s_add_u32 s35,s57,180224
 buffer_load_dwordx4 v[44:47],v2,s[48:51],s35 offen sc0 sc1
 v_mfma_f32_16x16x32_bf16 a[80:83],v[132:135],v[72:75],a[80:83]
 ds_read_b64_tr_b16 v[118:119],v221 offset:6144
 v_mfma_f32_16x16x32_bf16 a[84:87],v[132:135],v[76:79],a[84:87]
 v_mfma_f32_16x16x32_bf16 a[88:91],v[132:135],v[80:83],a[88:91]
 s_add_u32 s35,s57,311296
 buffer_load_dwordx4 v[48:51],v2,s[48:51],s35 offen sc0 sc1
 v_mfma_f32_16x16x32_bf16 a[92:95],v[132:135],v[84:87],a[92:95]
 s_waitcnt lgkmcnt(6)
 v_mfma_f32_16x16x32_bf16 a[96:99],v[136:139],v[64:67],a[96:99]
 v_mfma_f32_16x16x32_bf16 a[100:103],v[136:139],v[68:71],a[100:103]
 ds_read_b64_tr_b16 v[120:121],v222 offset:0
 s_add_u32 s35,s57,442368
 buffer_load_dwordx4 v[52:55],v2,s[48:51],s35 offen sc0 sc1
 v_mfma_f32_16x16x32_bf16 a[104:107],v[136:139],v[72:75],a[104:107]
 ds_read_b64_tr_b16 v[122:123],v222 offset:6144
 v_mfma_f32_16x16x32_bf16 a[108:111],v[136:139],v[76:79],a[108:111]
 v_mfma_f32_16x16x32_bf16 a[112:115],v[136:139],v[80:83],a[112:115]
 s_add_u32 s35,s57,573440
 buffer_load_dwordx4 v[56:59],v2,s[48:51],s35 offen sc0 sc1
 v_mfma_f32_16x16x32_bf16 a[116:119],v[136:139],v[84:87],a[116:119]
 s_waitcnt lgkmcnt(6)
 v_mfma_f32_16x16x32_bf16 a[120:123],v[140:143],v[64:67],a[120:123]
 v_mfma_f32_16x16x32_bf16 a[124:127],v[140:143],v[68:71],a[124:127]
 ds_read_b64_tr_b16 v[124:125],v223 offset:0
 s_add_u32 s35,s57,704512
 buffer_load_dwordx4 v[60:63],v2,s[48:51],s35 offen sc0 sc1
 v_mfma_f32_16x16x32_bf16 a[128:131],v[140:143],v[72:75],a[128:131]
 ds_read_b64_tr_b16 v[126:127],v223 offset:6144
 v_mfma_f32_16x16x32_bf16 a[132:135],v[140:143],v[76:79],a[132:135]
 v_mfma_f32_16x16x32_bf16 a[136:139],v[140:143],v[80:83],a[136:139]
 s_waitcnt lgkmcnt(15)
 s_add_u32 m0,s92,49152
 s_add_u32 s34,s56,2359296
 buffer_load_dwordx4 v14,s[44:47],s34 offen lds
 v_mfma_f32_16x16x32_bf16 a[140:143],v[140:143],v[84:87],a[140:143]
 s_waitcnt vmcnt(19)
 s_barrier
 buffer_atomic_add v1,v12,s[40:43],s100 offen sc1
 s_cmp_eq_u32 s59,0
 s_cbranch_scc1 K1_end
 s_waitcnt vmcnt(36)
 s_waitcnt lgkmcnt(6)
 v_mfma_f32_16x16x32_bf16 a[0:3],v[112:115],v[88:91],a[0:3]
 v_mfma_f32_16x16x32_bf16 a[4:7],v[112:115],v[92:95],a[4:7]
 ds_read_b64_tr_b16 v[128:129],v220 offset:128
 s_add_u32 m0,s92,50176
 s_add_u32 s34,s56,2359296
 buffer_load_dwordx4 v15,s[44:47],s34 offen lds
 v_mfma_f32_16x16x32_bf16 a[8:11],v[112:115],v[96:99],a[8:11]
 ds_read_b64_tr_b16 v[130:131],v220 offset:6272
 v_mfma_f32_16x16x32_bf16 a[12:15],v[112:115],v[100:103],a[12:15]
 v_mfma_f32_16x16x32_bf16 a[16:19],v[112:115],v[104:107],a[16:19]
 s_add_u32 m0,s92,51200
 s_add_u32 s34,s56,2359296
 buffer_load_dwordx4 v16,s[44:47],s34 offen lds
 v_mfma_f32_16x16x32_bf16 a[20:23],v[112:115],v[108:111],a[20:23]
 s_waitcnt lgkmcnt(6)
 v_mfma_f32_16x16x32_bf16 a[24:27],v[116:119],v[88:91],a[24:27]
 v_mfma_f32_16x16x32_bf16 a[28:31],v[116:119],v[92:95],a[28:31]
 ds_read_b64_tr_b16 v[132:133],v221 offset:128
 s_add_u32 m0,s92,52224
 s_add_u32 s34,s56,2368512
 buffer_load_dwordx4 v14,s[44:47],s34 offen lds
 v_mfma_f32_16x16x32_bf16 a[32:35],v[116:119],v[96:99],a[32:35]
 ds_read_b64_tr_b16 v[134:135],v221 offset:6272
 v_mfma_f32_16x16x32_bf16 a[36:39],v[116:119],v[100:103],a[36:39]
 v_mfma_f32_16x16x32_bf16 a[40:43],v[116:119],v[104:107],a[40:43]
 s_add_u32 m0,s92,53248
 s_add_u32 s34,s56,2368512
 buffer_load_dwordx4 v15,s[44:47],s34 offen lds
 v_mfma_f32_16x16x32_bf16 a[44:47],v[116:119],v[108:111],a[44:47]
 s_waitcnt lgkmcnt(6)
 v_mfma_f32_16x16x32_bf16 a[48:51],v[120:123],v[88:91],a[48:51]
 v_mfma_f32_16x16x32_bf16 a[52:55],v[120:123],v[92:95],a[52:55]
 ds_read_b64_tr_b16 v[136:137],v222 offset:128
 s_add_u32 m0,s92,54272
 s_add_u32 s34,s56,2368512
 buffer_load_dwordx4 v16,s[44:47],s34 offen lds
 v_mfma_f32_16x16x32_bf16 a[56:59],v[120:123],v[96:99],a[56:59]
 ds_read_b64_tr_b16 v[138:139],v222 offset:6272
 v_mfma_f32_16x16x32_bf16 a[60:63],v[120:123],v[100:103],a[60:63]
 v_mfma_f32_16x16x32_bf16 a[64:67],v[120:123],v[104:107],a[64:67]
 s_add_u32 m0,s92,55296
 s_add_u32 s34,s56,2377728
 buffer_load_dwordx4 v14,s[44:47],s34 offen lds
 v_mfma_f32_16x16x32_bf16 a[68:71],v[120:123],v[108:111],a[68:71]
 s_waitcnt lgkmcnt(6)
 v_mfma_f32_16x16x32_bf16 a[72:75],v[124:127],v[88:91],a[72:75]
 v_mfma_f32_16x16x32_bf16 a[76:79],v[124:127],v[92:95],a[76:79]
 ds_read_b64_tr_b16 v[140:141],v223 offset:128
 s_add_u32 m0,s92,56320
 s_add_u32 s34,s56,2377728
 buffer_load_dwordx4 v15,s[44:47],s34 offen lds
 v_mfma_f32_16x16x32_bf16 a[80:83],v[124:127],v[96:99],a[80:83]
 ds_read_b64_tr_b16 v[142:143],v223 offset:6272
 v_mfma_f32_16x16x32_bf16 a[84:87],v[124:127],v[100:103],a[84:87]
 v_mfma_f32_16x16x32_bf16 a[88:91],v[124:127],v[104:107],a[88:91]
 s_add_u32 m0,s92,57344
 s_add_u32 s34,s56,2377728
 buffer_load_dwordx4 v16,s[44:47],s34 offen lds
 v_mfma_f32_16x16x32_bf16 a[92:95],v[124:127],v[108:111],a[92:95]
 s_waitcnt lgkmcnt(6)
 v_mfma_f32_16x16x32_bf16 a[96:99],v[128:131],v[88:91],a[96:99]
 v_mfma_f32_16x16x32_bf16 a[100:103],v[128:131],v[92:95],a[100:103]
 ds_read_b64_tr_b16 v[112:113],v220 offset:256
 s_add_u32 m0,s92,58368
 s_add_u32 s34,s56,2386944
 buffer_load_dwordx4 v14,s[44:47],s34 offen lds
 v_mfma_f32_16x16x32_bf16 a[104:107],v[128:131],v[96:99],a[104:107]
 ds_read_b64_tr_b16 v[114:115],v220 offset:6400
 v_mfma_f32_16x16x32_bf16 a[108:111],v[128:131],v[100:103],a[108:111]
 v_mfma_f32_16x16x32_bf16 a[112:115],v[128:131],v[104:107],a[112:115]
 s_add_u32 m0,s92,59392
 s_add_u32 s34,s56,2386944
 buffer_load_dwordx4 v15,s[44:47],s34 offen lds
 v_mfma_f32_16x16x32_bf16 a[116:119],v[128:131],v[108:111],a[116:119]
 s_waitcnt lgkmcnt(6)
 v_mfma_f32_16x16x32_bf16 a[120:123],v[132:135],v[88:91],a[120:123]
 v_mfma_f32_16x16x32_bf16 a[124:127],v[132:135],v[92:95],a[124:127]
 ds_read_b64_tr_b16 v[116:117],v221 offset:256
 s_add_u32 m0,s92,60416
 s_add_u32 s34,s56,2386944
 buffer_load_dwordx4 v16,s[44:47],s34 offen lds
 v_mfma_f32_16x16x32_bf16 a[128:131],v[132:135],v[96:99],a[128:131]
 ds_read_b64_tr_b16 v[118:119],v221 offset:6400
 v_mfma_f32_16x16x32_bf16 a[132:135],v[132:135],v[100:103],a[132:135]
 v_mfma_f32_16x16x32_bf16 a[136:139],v[132:135],v[104:107],a[136:139]
 s_add_u32 s35,s57,65536
 buffer_load_dwordx4 v[64:67],v2,s[48:51],s35 offen sc0 sc1
 v_mfma_f32_16x16x32_bf16 a[140:143],v[132:135],v[108:111],a[140:143]
 s_waitcnt lgkmcnt(6)
 v_mfma_f32_16x16x32_bf16 a[144:147],v[136:139],v[88:91],a[144:147]
 v_mfma_f32_16x16x32_bf16 a[148:151],v[136:139],v[92:95],a[148:151]
 ds_read_b64_tr_b16 v[120:121],v222 offset:256
 s_add_u32 s35,s57,196608
 buffer_load_dwordx4 v[68:71],v2,s[48:51],s35 offen sc0 sc1
 v_mfma_f32_16x16x32_bf16 a[152:155],v[136:139],v[96:99],a[152:155]
 ds_read_b64_tr_b16 v[122:123],v222 offset:6400
 v_mfma_f32_16x16x32_bf16 a[156:159],v[136:139],v[100:103],a[156:159]
 v_mfma_f32_16x16x32_bf16 a[160:163],v[136:139],v[104:107],a[160:163]
 s_add_u32 s35,s57,327680
 buffer_load_dwordx4 v[72:75],v2,s[48:51],s35 offen sc0 sc1
 v_mfma_f32_16x16x32_bf16 a[164:167],v[136:139],v[108:111],a[164:167]
 s_waitcnt lgkmcnt(6)
 v_mfma_f32_16x16x32_bf16 a[168:171],v[140:143],v[88:91],a[168:171]
 v_mfma_f32_16x16x32_bf16 a[172:175],v[140:143],v[92:95],a[172:175]
 ds_read_b64_tr_b16 v[124:125],v223 offset:256
 s_add_u32 s35,s57,458752
 buffer_load_dwordx4 v[76:79],v2,s[48:51],s35 offen sc0 sc1
 v_mfma_f32_16x16x32_bf16 a[176:179],v[140:143],v[96:99],a[176:179]
 ds_read_b64_tr_b16 v[126:127],v223 offset:6400
 v_mfma_f32_16x16x32_bf16 a[180:183],v[140:143],v[100:103],a[180:183]
 v_mfma_f32_16x16x32_bf16 a[184:187],v[140:143],v[104:107],a[184:187]
 s_add_u32 s35,s57,589824
 buffer_load_dwordx4 v[80:83],v2,s[48:51],s35 offen sc0 sc1
 v_mfma_f32_16x16x32_bf16 a[188:191],v[140:143],v[108:111],a[188:191]
 s_waitcnt lgkmcnt(6)
 v_mfma_f32_16x16x32_bf16 a[192:195],v[112:115],v[88:91],a[192:195]
 v_mfma_f32_16x16x32_bf16 a[196:199],v[112:115],v[92:95],a[196:199]
 s_waitcnt vmcnt(24)
 ds_read_b64_tr_b16 v[128:129],v18 offset:0
 s_add_u32 s35,s57,720896
 buffer_load_dwordx4 v[84:87],v2,s[48:51],s35 offen sc0 sc1
 v_mfma_f32_16x16x32_bf16 a[200:203],v[112:115],v[96:99],a[200:203]
 ds_read_b64_tr_b16 v[130:131],v18 offset:6144
 v_mfma_f32_16x16x32_bf16 a[204:207],v[112:115],v[100:103],a[204:207]
 v_mfma_f32_16x16x32_bf16 a[208:211],v[112:115],v[104:107],a[208:211]
 s_waitcnt lgkmcnt(2)
 s_add_u32 m0,s92,98304
 s_add_u32 s34,s56,2949120
 buffer_load_dwordx4 v14,s[44:47],s34 offen lds
 v_mfma_f32_16x16x32_bf16 a[212:215],v[112:115],v[108:111],a[212:215]
 v_mfma_f32_16x16x32_bf16 a[216:219],v[116:119],v[88:91],a[216:219]
 v_mfma_f32_16x16x32_bf16 a[220:223],v[116:119],v[92:95],a[220:223]
 ds_read_b64_tr_b16 v[132:133],v19 offset:0
 s_add_u32 m0,s92,99328
 s_add_u32 s34,s56,2949120
 buffer_load_dwordx4 v15,s[44:47],s34 offen lds
 v_mfma_f32_16x16x32_bf16 a[224:227],v[116:119],v[96:99],a[224:227]
 ds_read_b64_tr_b16 v[134:135],v19 offset:6144
 v_mfma_f32_16x16x32_bf16 a[228:231],v[116:119],v[100:103],a[228:231]
 v_mfma_f32_16x16x32_bf16 a[232:235],v[116:119],v[104:107],a[232:235]
 s_add_u32 m0,s92,100352
 s_add_u32 s34,s56,2949120
 buffer_load_dwordx4 v16,s[44:47],s34 offen lds
 v_mfma_f32_16x16x32_bf16 a[236:239],v[116:119],v[108:111],a[236:239]
 v_mfma_f32_16x16x32_bf16 a[240:243],v[120:123],v[88:91],a[240:243]
 v_mfma_f32_16x16x32_bf16 a[244:247],v[120:123],v[92:95],a[244:247]
 ds_read_b64_tr_b16 v[136:137],v20 offset:0
 s_add_u32 m0,s92,101376
 s_add_u32 s34,s56,2958336
 buffer_load_dwordx4 v14,s[44:47],s34 offen lds
 v_mfma_f32_16x16x32_bf16 a[248:251],v[120:123],v[96:99],a[248:251]
 ds_read_b64_tr_b16 v[138:139],v20 offset:6144
 v_mfma_f32_16x16x32_bf16 a[252:255],v[120:123],v[100:103],a[252:255]
 v_mfma_f32_16x16x32_bf16 v[224:227],v[120:123],v[104:107],v[224:227]
 s_add_u32 m0,s92,102400
 s_add_u32 s34,s56,2958336
 buffer_load_dwordx4 v15,s[44:47],s34 offen lds
 v_mfma_f32_16x16x32_bf16 v[228:231],v[120:123],v[108:111],v[228:231]
 v_mfma_f32_16x16x32_bf16 v[232:235],v[124:127],v[88:91],v[232:235]
 v_mfma_f32_16x16x32_bf16 v[236:239],v[124:127],v[92:95],v[236:239]
 ds_read_b64_tr_b16 v[140:141],v21 offset:0
 s_add_u32 m0,s92,103424
 s_add_u32 s34,s56,2958336
 buffer_load_dwordx4 v16,s[44:47],s34 offen lds
 v_mfma_f32_16x16x32_bf16 v[240:243],v[124:127],v[96:99],v[240:243]
 ds_read_b64_tr_b16 v[142:143],v21 offset:6144
 v_mfma_f32_16x16x32_bf16 v[244:247],v[124:127],v[100:103],v[244:247]
 v_mfma_f32_16x16x32_bf16 v[248:251],v[124:127],v[104:107],v[248:251]
 s_add_u32 m0,s92,104448
 s_add_u32 s34,s56,2967552
 buffer_load_dwordx4 v14,s[44:47],s34 offen lds
 v_mfma_f32_16x16x32_bf16 v[252:255],v[124:127],v[108:111],v[252:255]
 s_waitcnt lgkmcnt(6)
 s_waitcnt vmcnt(26)
 v_mfma_f32_16x16x32_bf16 a[0:3],v[128:131],v[40:43],a[0:3]
 v_mfma_f32_16x16x32_bf16 a[4:7],v[128:131],v[44:47],a[4:7]
 ds_read_b64_tr_b16 v[112:113],v18 offset:128
 s_add_u32 m0,s92,105472
 s_add_u32 s34,s56,2967552
 buffer_load_dwordx4 v15,s[44:47],s34 offen lds
 v_mfma_f32_16x16x32_bf16 a[8:11],v[128:131],v[48:51],a[8:11]
 ds_read_b64_tr_b16 v[114:115],v18 offset:6272
 v_mfma_f32_16x16x32_bf16 a[12:15],v[128:131],v[52:55],a[12:15]
 v_mfma_f32_16x16x32_bf16 a[16:19],v[128:131],v[56:59],a[16:19]
 s_add_u32 m0,s92,106496
 s_add_u32 s34,s56,2967552
 buffer_load_dwordx4 v16,s[44:47],s34 offen lds
 v_mfma_f32_16x16x32_bf16 a[20:23],v[128:131],v[60:63],a[20:23]
 s_waitcnt lgkmcnt(6)
 v_mfma_f32_16x16x32_bf16 a[24:27],v[132:135],v[40:43],a[24:27]
 v_mfma_f32_16x16x32_bf16 a[28:31],v[132:135],v[44:47],a[28:31]
 ds_read_b64_tr_b16 v[116:117],v19 offset:128
 s_add_u32 m0,s92,107520
 s_add_u32 s34,s56,2976768
 buffer_load_dwordx4 v14,s[44:47],s34 offen lds
 v_mfma_f32_16x16x32_bf16 a[32:35],v[132:135],v[48:51],a[32:35]
 ds_read_b64_tr_b16 v[118:119],v19 offset:6272
 v_mfma_f32_16x16x32_bf16 a[36:39],v[132:135],v[52:55],a[36:39]
 v_mfma_f32_16x16x32_bf16 a[40:43],v[132:135],v[56:59],a[40:43]
 s_add_u32 m0,s92,108544
 s_add_u32 s34,s56,2976768
 buffer_load_dwordx4 v15,s[44:47],s34 offen lds
 v_mfma_f32_16x16x32_bf16 a[44:47],v[132:135],v[60:63],a[44:47]
 s_waitcnt lgkmcnt(6)
 v_mfma_f32_16x16x32_bf16 a[48:51],v[136:139],v[40:43],a[48:51]
 v_mfma_f32_16x16x32_bf16 a[52:55],v[136:139],v[44:47],a[52:55]
 ds_read_b64_tr_b16 v[120:121],v20 offset:128
 s_add_u32 m0,s92,109568
 s_add_u32 s34,s56,2976768
 buffer_load_dwordx4 v16,s[44:47],s34 offen lds
 v_mfma_f32_16x16x32_bf16 a[56:59],v[136:139],v[48:51],a[56:59]
 ds_read_b64_tr_b16 v[122:123],v20 offset:6272
 v_mfma_f32_16x16x32_bf16 a[60:63],v[136:139],v[52:55],a[60:63]
 v_mfma_f32_16x16x32_bf16 a[64:67],v[136:139],v[56:59],a[64:67]
 s_add_u32 s35,s57,81920
 buffer_load_dwordx4 v[88:91],v2,s[48:51],s35 offen sc0 sc1
 v_mfma_f32_16x16x32_bf16 a[68:71],v[136:139],v[60:63],a[68:71]
 s_waitcnt lgkmcnt(6)
 v_mfma_f32_16x16x32_bf16 a[72:75],v[140:143],v[40:43],a[72:75]
 v_mfma_f32_16x16x32_bf16 a[76:79],v[140:143],v[44:47],a[76:79]
 ds_read_b64_tr_b16 v[124:125],v21 offset:128
 s_add_u32 s35,s57,212992
 buffer_load_dwordx4 v[92:95],v2,s[48:51],s35 offen sc0 sc1
 v_mfma_f32_16x16x32_bf16 a[80:83],v[140:143],v[48:51],a[80:83]
 ds_read_b64_tr_b16 v[126:127],v21 offset:6272
 v_mfma_f32_16x16x32_bf16 a[84:87],v[140:143],v[52:55],a[84:87]
 v_mfma_f32_16x16x32_bf16 a[88:91],v[140:143],v[56:59],a[88:91]
 s_add_u32 s35,s57,344064
 buffer_load_dwordx4 v[96:99],v2,s[48:51],s35 offen sc0 sc1
 v_mfma_f32_16x16x32_bf16 a[92:95],v[140:143],v[60:63],a[92:95]
 s_waitcnt lgkmcnt(6)
 v_mfma_f32_16x16x32_bf16 a[96:99],v[112:115],v[40:43],a[96:99]
 v_mfma_f32_16x16x32_bf16 a[100:103],v[112:115],v[44:47],a[100:103]
 ds_read_b64_tr_b16 v[128:129],v18 offset:256
 s_add_u32 s35,s57,475136
 buffer_load_dwordx4 v[100:103],v2,s[48:51],s35 offen sc0 sc1
 v_mfma_f32_16x16x32_bf16 a[104:107],v[112:115],v[48:51],a[104:107]
 ds_read_b64_tr_b16 v[130:131],v18 offset:6400
 v_mfma_f32_16x16x32_bf16 a[108:111],v[112:115],v[52:55],a[108:111]
 v_mfma_f32_16x16x32_bf16 a[112:115],v[112:115],v[56:59],a[112:115]
 s_add_u32 s35,s57,606208
 buffer_load_dwordx4 v[104:107],v2,s[48:51],s35 offen sc0 sc1
 v_mfma_f32_16x16x32_bf16 a[116:119],v[112:115],v[60:63],a[116:119]
 s_waitcnt lgkmcnt(6)
 v_mfma_f32_16x16x32_bf16 a[120:123],v[116:119],v[40:43],a[120:123]
 v_mfma_f32_16x16x32_bf16 a[124:127],v[116:119],v[44:47],a[124:127]
 ds_read_b64_tr_b16 v[132:133],v19 offset:256
 s_add_u32 s35,s57,737280
 buffer_load_dwordx4 v[108:111],v2,s[48:51],s35 offen sc0 sc1
 v_mfma_f32_16x16x32_bf16 a[128:131],v[116:119],v[48:51],a[128:131]
 ds_read_b64_tr_b16 v[134:135],v19 offset:6400
 v_mfma_f32_16x16x32_bf16 a[132:135],v[116:119],v[52:55],a[132:135]
 v_mfma_f32_16x16x32_bf16 a[136:139],v[116:119],v[56:59],a[136:139]
 v_mfma_f32_16x16x32_bf16 a[140:143],v[116:119],v[60:63],a[140:143]
 s_waitcnt lgkmcnt(6)
 v_mfma_f32_16x16x32_bf16 a[144:147],v[120:123],v[40:43],a[144:147]
 v_mfma_f32_16x16x32_bf16 a[148:151],v[120:123],v[44:47],a[148:151]
 ds_read_b64_tr_b16 v[136:137],v20 offset:256
 v_mfma_f32_16x16x32_bf16 a[152:155],v[120:123],v[48:51],a[152:155]
 ds_read_b64_tr_b16 v[138:139],v20 offset:6400
 v_mfma_f32_16x16x32_bf16 a[156:159],v[120:123],v[52:55],a[156:159]
 v_mfma_f32_16x16x32_bf16 a[160:163],v[120:123],v[56:59],a[160:163]
 v_mfma_f32_16x16x32_bf16 a[164:167],v[120:123],v[60:63],a[164:167]
 s_waitcnt lgkmcnt(6)
 v_mfma_f32_16x16x32_bf16 a[168:171],v[124:127],v[40:43],a[168:171]
 v_mfma_f32_16x16x32_bf16 a[172:175],v[124:127],v[44:47],a[172:175]
 ds_read_b64_tr_b16 v[140:141],v21 offset:256
 v_mfma_f32_16x16x32_bf16 a[176:179],v[124:127],v[48:51],a[176:179]
 ds_read_b64_tr_b16 v[142:143],v21 offset:6400
 v_mfma_f32_16x16x32_bf16 a[180:183],v[124:127],v[52:55],a[180:183]
 v_mfma_f32_16x16x32_bf16 a[184:187],v[124:127],v[56:59],a[184:187]
 v_mfma_f32_16x16x32_bf16 a[188:191],v[124:127],v[60:63],a[188:191]
 s_waitcnt lgkmcnt(6)
 v_mfma_f32_16x16x32_bf16 a[192:195],v[128:131],v[40:43],a[192:195]
 v_mfma_f32_16x16x32_bf16 a[196:199],v[128:131],v[44:47],a[196:199]
 s_waitcnt vmcnt(24)
 ds_read_b64_tr_b16 v[112:113],v18 offset:49152
 v_mfma_f32_16x16x32_bf16 a[200:203],v[128:131],v[48:51],a[200:203]
 ds_read_b64_tr_b16 v[114:115],v18 offset:55296
 v_mfma_f32_16x16x32_bf16 a[204:207],v[128:131],v[52:55],a[204:207]
 v_mfma_f32_16x16x32_bf16 a[208:211],v[128:131],v[56:59],a[208:211]
 s_waitcnt lgkmcnt(2)
 s_add_u32 m0,s92,0
 s_add_u32 s34,s56,3538944
 buffer_load_dwordx4 v14,s[44:47],s34 offen lds
 v_mfma_f32_16x16x32_bf16 a[212:215],v[128:131],v[60:63],a[212:215]
 v_mfma_f32_16x16x32_bf16 a[216:219],v[132:135],v[40:43],a[216:219]
 v_mfma_f32_16x16x32_bf16 a[220:223],v[132:135],v[44:47],a[220:223]
 ds_read_b64_tr_b16 v[116:117],v19 offset:49152
 s_add_u32 m0,s92,1024
 s_add_u32 s34,s56,3538944
 buffer_load_dwordx4 v15,s[44:47],s34 offen lds
 v_mfma_f32_16x16x32_bf16 a[224:227],v[132:135],v[48:51],a[224:227]
 ds_read_b64_tr_b16 v[118:119],v19 offset:55296
 v_mfma_f32_16x16x32_bf16 a[228:231],v[132:135],v[52:55],a[228:231]
 v_mfma_f32_16x16x32_bf16 a[232:235],v[132:135],v[56:59],a[232:235]
 s_add_u32 m0,s92,2048
 s_add_u32 s34,s56,3538944
 buffer_load_dwordx4 v16,s[44:47],s34 offen lds
 v_mfma_f32_16x16x32_bf16 a[236:239],v[132:135],v[60:63],a[236:239]
 v_mfma_f32_16x16x32_bf16 a[240:243],v[136:139],v[40:43],a[240:243]
 v_mfma_f32_16x16x32_bf16 a[244:247],v[136:139],v[44:47],a[244:247]
 ds_read_b64_tr_b16 v[120:121],v20 offset:49152
 s_add_u32 m0,s92,3072
 s_add_u32 s34,s56,3548160
 buffer_load_dwordx4 v14,s[44:47],s34 offen lds
 v_mfma_f32_16x16x32_bf16 a[248:251],v[136:139],v[48:51],a[248:251]
 ds_read_b64_tr_b16 v[122:123],v20 offset:55296
 v_mfma_f32_16x16x32_bf16 a[252:255],v[136:139],v[52:55],a[252:255]
 v_mfma_f32_16x16x32_bf16 v[224:227],v[136:139],v[56:59],v[224:227]
 s_add_u32 m0,s92,4096
 s_add_u32 s34,s56,3548160
 buffer_load_dwordx4 v15,s[44:47],s34 offen lds
 v_mfma_f32_16x16x32_bf16 v[228:231],v[136:139],v[60:63],v[228:231]
 v_mfma_f32_16x16x32_bf16 v[232:235],v[140:143],v[40:43],v[232:235]
 v_mfma_f32_16x16x32_bf16 v[236:239],v[140:143],v[44:47],v[236:239]
 ds_read_b64_tr_b16 v[124:125],v21 offset:49152
 s_add_u32 m0,s92,5120
 s_add_u32 s34,s56,3548160
 buffer_load_dwordx4 v16,s[44:47],s34 offen lds
 v_mfma_f32_16x16x32_bf16 v[240:243],v[140:143],v[48:51],v[240:243]
 ds_read_b64_tr_b16 v[126:127],v21 offset:55296
 v_mfma_f32_16x16x32_bf16 v[244:247],v[140:143],v[52:55],v[244:247]
 v_mfma_f32_16x16x32_bf16 v[248:251],v[140:143],v[56:59],v[248:251]
 s_add_u32 m0,s92,6144
 s_add_u32 s34,s56,3557376
 buffer_load_dwordx4 v14,s[44:47],s34 offen lds
 v_mfma_f32_16x16x32_bf16 v[252:255],v[140:143],v[60:63],v[252:255]
 s_waitcnt lgkmcnt(6)
 s_waitcnt vmcnt(25)
 v_mfma_f32_16x16x32_bf16 a[0:3],v[112:115],v[64:67],a[0:3]
 v_mfma_f32_16x16x32_bf16 a[4:7],v[112:115],v[68:71],a[4:7]
 ds_read_b64_tr_b16 v[128:129],v18 offset:49280
 s_add_u32 m0,s92,7168
 s_add_u32 s34,s56,3557376
 buffer_load_dwordx4 v15,s[44:47],s34 offen lds
 v_mfma_f32_16x16x32_bf16 a[8:11],v[112:115],v[72:75],a[8:11]
 ds_read_b64_tr_b16 v[130:131],v18 offset:55424
 v_mfma_f32_16x16x32_bf16 a[12:15],v[112:115],v[76:79],a[12:15]
 v_mfma_f32_16x16x32_bf16 a[16:19],v[112:115],v[80:83],a[16:19]
 s_add_u32 m0,s92,8192
 s_add_u32 s34,s56,3557376
 buffer_load_dwordx4 v16,s[44:47],s34 offen lds
 v_mfma_f32_16x16x32_bf16 a[20:23],v[112:115],v[84:87],a[20:23]
 s_waitcnt lgkmcnt(6)
 v_mfma_f32_16x16x32_bf16 a[24:27],v[116:119],v[64:67],a[24:27]
 v_mfma_f32_16x16x32_bf16 a[28:31],v[116:119],v[68:71],a[28:31]
 ds_read_b64_tr_b16 v[132:133],v19 offset:49280
 s_add_u32 m0,s92,9216
 s_add_u32 s34,s56,3566592
 buffer_load_dwordx4 v14,s[44:47],s34 offen lds
 v_mfma_f32_16x16x32_bf16 a[32:35],v[116:119],v[72:75],a[32:35]
 ds_read_b64_tr_b16 v[134:135],v19 offset:55424
 v_mfma_f32_16x16x32_bf16 a[36:39],v[116:119],v[76:79],a[36:39]
 v_mfma_f32_16x16x32_bf16 a[40:43],v[116:119],v[80:83],a[40:43]
 s_add_u32 m0,s92,10240
 s_add_u32 s34,s56,3566592
 buffer_load_dwordx4 v15,s[44:47],s34 offen lds
 v_mfma_f32_16x16x32_bf16 a[44:47],v[116:119],v[84:87],a[44:47]
 s_waitcnt lgkmcnt(6)
 v_mfma_f32_16x16x32_bf16 a[48:51],v[120:123],v[64:67],a[48:51]
 v_mfma_f32_16x16x32_bf16 a[52:55],v[120:123],v[68:71],a[52:55]
 ds_read_b64_tr_b16 v[136:137],v20 offset:49280
 s_add_u32 m0,s92,11264
 s_add_u32 s34,s56,3566592
 buffer_load_dwordx4 v16,s[44:47],s34 offen lds
 v_mfma_f32_16x16x32_bf16 a[56:59],v[120:123],v[72:75],a[56:59]
 ds_read_b64_tr_b16 v[138:139],v20 offset:55424
 v_mfma_f32_16x16x32_bf16 a[60:63],v[120:123],v[76:79],a[60:63]
 v_mfma_f32_16x16x32_bf16 a[64:67],v[120:123],v[80:83],a[64:67]
 s_add_u32 s35,s57,98304
 buffer_load_dwordx4 v[40:43],v2,s[48:51],s35 offen sc0 sc1
 v_mfma_f32_16x16x32_bf16 a[68:71],v[120:123],v[84:87],a[68:71]
 s_waitcnt lgkmcnt(6)
 v_mfma_f32_16x16x32_bf16 a[72:75],v[124:127],v[64:67],a[72:75]
 v_mfma_f32_16x16x32_bf16 a[76:79],v[124:127],v[68:71],a[76:79]
 ds_read_b64_tr_b16 v[140:141],v21 offset:49280
 s_add_u32 s35,s57,229376
 buffer_load_dwordx4 v[44:47],v2,s[48:51],s35 offen sc0 sc1
 v_mfma_f32_16x16x32_bf16 a[80:83],v[124:127],v[72:75],a[80:83]
 ds_read_b64_tr_b16 v[142:143],v21 offset:55424
 v_mfma_f32_16x16x32_bf16 a[84:87],v[124:127],v[76:79],a[84:87]
 v_mfma_f32_16x16x32_bf16 a[88:91],v[124:127],v[80:83],a[88:91]
 s_add_u32 s35,s57,360448
 buffer_load_dwordx4 v[48:51],v2,s[48:51],s35 offen sc0 sc1
 v_mfma_f32_16x16x32_bf16 a[92:95],v[124:127],v[84:87],a[92:95]
 s_waitcnt lgkmcnt(6)
 v_mfma_f32_16x16x32_bf16 a[96:99],v[128:131],v[64:67],a[96:99]
 v_mfma_f32_16x16x32_bf16 a[100:103],v[128:131],v[68:71],a[100:103]
 ds_read_b64_tr_b16 v[112:113],v18 offset:49408
 s_add_u32 s35,s57,491520
 buffer_load_dwordx4 v[52:55],v2,s[48:51],s35 offen sc0 sc1
 v_mfma_f32_16x16x32_bf16 a[104:107],v[128:131],v[72:75],a[104:107]
 ds_read_b64_tr_b16 v[114:115],v18 offset:55552
 v_mfma_f32_16x16x32_bf16 a[108:111],v[128:131],v[76:79],a[108:111]
 v_mfma_f32_16x16x32_bf16 a[112:115],v[128:131],v[80:83],a[112:115]
 s_add_u32 s35,s57,622592
 buffer_load_dwordx4 v[56:59],v2,s[48:51],s35 offen sc0 sc1
 v_mfma_f32_16x16x32_bf16 a[116:119],v[128:131],v[84:87],a[116:119]
 s_waitcnt lgkmcnt(6)
 v_mfma_f32_16x16x32_bf16 a[120:123],v[132:135],v[64:67],a[120:123]
 v_mfma_f32_16x16x32_bf16 a[124:127],v[132:135],v[68:71],a[124:127]
 ds_read_b64_tr_b16 v[116:117],v19 offset:49408
 s_add_u32 s35,s57,753664
 buffer_load_dwordx4 v[60:63],v2,s[48:51],s35 offen sc0 sc1
 v_mfma_f32_16x16x32_bf16 a[128:131],v[132:135],v[72:75],a[128:131]
 ds_read_b64_tr_b16 v[118:119],v19 offset:55552
 v_mfma_f32_16x16x32_bf16 a[132:135],v[132:135],v[76:79],a[132:135]
 v_mfma_f32_16x16x32_bf16 a[136:139],v[132:135],v[80:83],a[136:139]
 v_mfma_f32_16x16x32_bf16 a[140:143],v[132:135],v[84:87],a[140:143]
 s_waitcnt lgkmcnt(6)
 v_mfma_f32_16x16x32_bf16 a[144:147],v[136:139],v[64:67],a[144:147]
 v_mfma_f32_16x16x32_bf16 a[148:151],v[136:139],v[68:71],a[148:151]
 ds_read_b64_tr_b16 v[120:121],v20 offset:49408
 v_mfma_f32_16x16x32_bf16 a[152:155],v[136:139],v[72:75],a[152:155]
 ds_read_b64_tr_b16 v[122:123],v20 offset:55552
 v_mfma_f32_16x16x32_bf16 a[156:159],v[136:139],v[76:79],a[156:159]
 v_mfma_f32_16x16x32_bf16 a[160:163],v[136:139],v[80:83],a[160:163]
 v_mfma_f32_16x16x32_bf16 a[164:167],v[136:139],v[84:87],a[164:167]
 s_waitcnt lgkmcnt(6)
 v_mfma_f32_16x16x32_bf16 a[168:171],v[140:143],v[64:67],a[168:171]
 v_mfma_f32_16x16x32_bf16 a[172:175],v[140:143],v[68:71],a[172:175]
 ds_read_b64_tr_b16 v[124:125],v21 offset:49408
 v_mfma_f32_16x16x32_bf16 a[176:179],v[140:143],v[72:75],a[176:179]
 ds_read_b64_tr_b16 v[126:127],v21 offset:55552
 v_mfma_f32_16x16x32_bf16 a[180:183],v[140:143],v[76:79],a[180:183]
 v_mfma_f32_16x16x32_bf16 a[184:187],v[140:143],v[80:83],a[184:187]
 v_mfma_f32_16x16x32_bf16 a[188:191],v[140:143],v[84:87],a[188:191]
 s_waitcnt lgkmcnt(6)
 v_mfma_f32_16x16x32_bf16 a[192:195],v[112:115],v[64:67],a[192:195]
 v_mfma_f32_16x16x32_bf16 a[196:199],v[112:115],v[68:71],a[196:199]
 s_waitcnt vmcnt(24)
 ds_read_b64_tr_b16 v[128:129],v220 offset:0
 v_mfma_f32_16x16x32_bf16 a[200:203],v[112:115],v[72:75],a[200:203]
 ds_read_b64_tr_b16 v[130:131],v220 offset:6144
 v_mfma_f32_16x16x32_bf16 a[204:207],v[112:115],v[76:79],a[204:207]
 v_mfma_f32_16x16x32_bf16 a[208:211],v[112:115],v[80:83],a[208:211]
 s_waitcnt lgkmcnt(2)
 s_add_u32 m0,s92,49152
 s_add_u32 s34,s56,4128768
 buffer_load_dwordx4 v14,s[44:47],s34 offen lds
 v_mfma_f32_16x16x32_bf16 a[212:215],v[112:115],v[84:87],a[212:215]
 v_mfma_f32_16x16x32_bf16 a[216:219],v[116:119],v[64:67],a[216:219]
 v_mfma_f32_16x16x32_bf16 a[220:223],v[116:119],v[68:71],a[220:223]
 ds_read_b64_tr_b16 v[132:133],v221 offset:0
 s_add_u32 m0,s92,50176
 s_add_u32 s34,s56,4128768
 buffer_load_dwordx4 v15,s[44:47],s34 offen lds
 v_mfma_f32_16x16x32_bf16 a[224:227],v[116:119],v[72:75],a[224:227]
 ds_read_b64_tr_b16 v[134:135],v221 offset:6144
 v_mfma_f32_16x16x32_bf16 a[228:231],v[116:119],v[76:79],a[228:231]
 v_mfma_f32_16x16x32_bf16 a[232:235],v[116:119],v[80:83],a[232:235]
 s_add_u32 m0,s92,51200
 s_add_u32 s34,s56,4128768
 buffer_load_dwordx4 v16,s[44:47],s34 offen lds
 v_mfma_f32_16x16x32_bf16 a[236:239],v[116:119],v[84:87],a[236:239]
 v_mfma_f32_16x16x32_bf16 a[240:243],v[120:123],v[64:67],a[240:243]
 v_mfma_f32_16x16x32_bf16 a[244:247],v[120:123],v[68:71],a[244:247]
 ds_read_b64_tr_b16 v[136:137],v222 offset:0
 s_add_u32 m0,s92,52224
 s_add_u32 s34,s56,4137984
 buffer_load_dwordx4 v14,s[44:47],s34 offen lds
 v_mfma_f32_16x16x32_bf16 a[248:251],v[120:123],v[72:75],a[248:251]
 ds_read_b64_tr_b16 v[138:139],v222 offset:6144
 v_mfma_f32_16x16x32_bf16 a[252:255],v[120:123],v[76:79],a[252:255]
 v_mfma_f32_16x16x32_bf16 v[224:227],v[120:123],v[80:83],v[224:227]
 s_add_u32 m0,s92,53248
 s_add_u32 s34,s56,4137984
 buffer_load_dwordx4 v15,s[44:47],s34 offen lds
 v_mfma_f32_16x16x32_bf16 v[228:231],v[120:123],v[84:87],v[228:231]
 v_mfma_f32_16x16x32_bf16 v[232:235],v[124:127],v[64:67],v[232:235]
 v_mfma_f32_16x16x32_bf16 v[236:239],v[124:127],v[68:71],v[236:239]
 ds_read_b64_tr_b16 v[140:141],v223 offset:0
 s_add_u32 m0,s92,54272
 s_add_u32 s34,s56,4137984
 buffer_load_dwordx4 v16,s[44:47],s34 offen lds
 v_mfma_f32_16x16x32_bf16 v[240:243],v[124:127],v[72:75],v[240:243]
 ds_read_b64_tr_b16 v[142:143],v223 offset:6144
 v_mfma_f32_16x16x32_bf16 v[244:247],v[124:127],v[76:79],v[244:247]
 v_mfma_f32_16x16x32_bf16 v[248:251],v[124:127],v[80:83],v[248:251]
 s_add_u32 m0,s92,55296
 s_add_u32 s34,s56,4147200
 buffer_load_dwordx4 v14,s[44:47],s34 offen lds
 v_mfma_f32_16x16x32_bf16 v[252:255],v[124:127],v[84:87],v[252:255]
 s_waitcnt lgkmcnt(6)
 s_waitcnt vmcnt(25)
 v_mfma_f32_16x16x32_bf16 a[0:3],v[128:131],v[88:91],a[0:3]
 v_mfma_f32_16x16x32_bf16 a[4:7],v[128:131],v[92:95],a[4:7]
 ds_read_b64_tr_b16 v[112:113],v220 offset:128
 s_add_u32 m0,s92,56320
 s_add_u32 s34,s56,4147200
 buffer_load_dwordx4 v15,s[44:47],s34 offen lds
 v_mfma_f32_16x16x32_bf16 a[8:11],v[128:131],v[96:99],a[8:11]
 ds_read_b64_tr_b16 v[114:115],v220 offset:6272
 v_mfma_f32_16x16x32_bf16 a[12:15],v[128:131],v[100:103],a[12:15]
 v_mfma_f32_16x16x32_bf16 a[16:19],v[128:131],v[104:107],a[16:19]
 s_add_u32 m0,s92,57344
 s_add_u32 s34,s56,4147200
 buffer_load_dwordx4 v16,s[44:47],s34 offen lds
 v_mfma_f32_16x16x32_bf16 a[20:23],v[128:131],v[108:111],a[20:23]
 s_waitcnt lgkmcnt(6)
 v_mfma_f32_16x16x32_bf16 a[24:27],v[132:135],v[88:91],a[24:27]
 v_mfma_f32_16x16x32_bf16 a[28:31],v[132:135],v[92:95],a[28:31]
 ds_read_b64_tr_b16 v[116:117],v221 offset:128
 s_add_u32 m0,s92,58368
 s_add_u32 s34,s56,4156416
 buffer_load_dwordx4 v14,s[44:47],s34 offen lds
 v_mfma_f32_16x16x32_bf16 a[32:35],v[132:135],v[96:99],a[32:35]
 ds_read_b64_tr_b16 v[118:119],v221 offset:6272
 v_mfma_f32_16x16x32_bf16 a[36:39],v[132:135],v[100:103],a[36:39]
 v_mfma_f32_16x16x32_bf16 a[40:43],v[132:135],v[104:107],a[40:43]
 s_add_u32 m0,s92,59392
 s_add_u32 s34,s56,4156416
 buffer_load_dwordx4 v15,s[44:47],s34 offen lds
 v_mfma_f32_16x16x32_bf16 a[44:47],v[132:135],v[108:111],a[44:47]
 s_waitcnt lgkmcnt(6)
 v_mfma_f32_16x16x32_bf16 a[48:51],v[136:139],v[88:91],a[48:51]
 v_mfma_f32_16x16x32_bf16 a[52:55],v[136:139],v[92:95],a[52:55]
 ds_read_b64_tr_b16 v[120:121],v222 offset:128
 s_add_u32 m0,s92,60416
 s_add_u32 s34,s56,4156416
 buffer_load_dwordx4 v16,s[44:47],s34 offen lds
 v_mfma_f32_16x16x32_bf16 a[56:59],v[136:139],v[96:99],a[56:59]
 ds_read_b64_tr_b16 v[122:123],v222 offset:6272
 v_mfma_f32_16x16x32_bf16 a[60:63],v[136:139],v[100:103],a[60:63]
 v_mfma_f32_16x16x32_bf16 a[64:67],v[136:139],v[104:107],a[64:67]
 s_add_u32 s35,s57,114688
 buffer_load_dwordx4 v[64:67],v2,s[48:51],s35 offen sc0 sc1
 v_mfma_f32_16x16x32_bf16 a[68:71],v[136:139],v[108:111],a[68:71]
 s_waitcnt lgkmcnt(6)
 v_mfma_f32_16x16x32_bf16 a[72:75],v[140:143],v[88:91],a[72:75]
 v_mfma_f32_16x16x32_bf16 a[76:79],v[140:143],v[92:95],a[76:79]
 ds_read_b64_tr_b16 v[124:125],v223 offset:128
 s_add_u32 s35,s57,245760
 buffer_load_dwordx4 v[68:71],v2,s[48:51],s35 offen sc0 sc1
 v_mfma_f32_16x16x32_bf16 a[80:83],v[140:143],v[96:99],a[80:83]
 ds_read_b64_tr_b16 v[126:127],v223 offset:6272
 v_mfma_f32_16x16x32_bf16 a[84:87],v[140:143],v[100:103],a[84:87]
 v_mfma_f32_16x16x32_bf16 a[88:91],v[140:143],v[104:107],a[88:91]
 s_add_u32 s35,s57,376832
 buffer_load_dwordx4 v[72:75],v2,s[48:51],s35 offen sc0 sc1
 v_mfma_f32_16x16x32_bf16 a[92:95],v[140:143],v[108:111],a[92:95]
 s_waitcnt lgkmcnt(6)
 v_mfma_f32_16x16x32_bf16 a[96:99],v[112:115],v[88:91],a[96:99]
 v_mfma_f32_16x16x32_bf16 a[100:103],v[112:115],v[92:95],a[100:103]
 ds_read_b64_tr_b16 v[128:129],v220 offset:256
 s_add_u32 s35,s57,507904
 buffer_load_dwordx4 v[76:79],v2,s[48:51],s35 offen sc0 sc1
 v_mfma_f32_16x16x32_bf16 a[104:107],v[112:115],v[96:99],a[104:107]
 ds_read_b64_tr_b16 v[130:131],v220 offset:6400
 v_mfma_f32_16x16x32_bf16 a[108:111],v[112:115],v[100:103],a[108:111]
 v_mfma_f32_16x16x32_bf16 a[112:115],v[112:115],v[104:107],a[112:115]
 s_add_u32 s35,s57,638976
 buffer_load_dwordx4 v[80:83],v2,s[48:51],s35 offen sc0 sc1
 v_mfma_f32_16x16x32_bf16 a[116:119],v[112:115],v[108:111],a[116:119]
 s_waitcnt lgkmcnt(6)
 v_mfma_f32_16x16x32_bf16 a[120:123],v[116:119],v[88:91],a[120:123]
 v_mfma_f32_16x16x32_bf16 a[124:127],v[116:119],v[92:95],a[124:127]
 ds_read_b64_tr_b16 v[132:133],v221 offset:256
 s_add_u32 s35,s57,770048
 buffer_load_dwordx4 v[84:87],v2,s[48:51],s35 offen sc0 sc1
 v_mfma_f32_16x16x32_bf16 a[128:131],v[116:119],v[96:99],a[128:131]
 ds_read_b64_tr_b16 v[134:135],v221 offset:6400
 v_mfma_f32_16x16x32_bf16 a[132:135],v[116:119],v[100:103],a[132:135]
 v_mfma_f32_16x16x32_bf16 a[136:139],v[116:119],v[104:107],a[136:139]
 buffer_load_dword v5,v2,s[40:43],0 offen sc1
 v_mfma_f32_16x16x32_bf16 a[140:143],v[116:119],v[108:111],a[140:143]
 s_waitcnt lgkmcnt(6)
 v_mfma_f32_16x16x32_bf16 a[144:147],v[120:123],v[88:91],a[144:147]
 v_mfma_f32_16x16x32_bf16 a[148:151],v[120:123],v[92:95],a[148:151]
 ds_read_b64_tr_b16 v[136:137],v222 offset:256
 v_mfma_f32_16x16x32_bf16 a[152:155],v[120:123],v[96:99],a[152:155]
 ds_read_b64_tr_b16 v[138:139],v222 offset:6400
 v_mfma_f32_16x16x32_bf16 a[156:159],v[120:123],v[100:103],a[156:159]
 v_mfma_f32_16x16x32_bf16 a[160:163],v[120:123],v[104:107],a[160:163]
 v_mfma_f32_16x16x32_bf16 a[164:167],v[120:123],v[108:111],a[164:167]
 s_waitcnt lgkmcnt(6)
 v_mfma_f32_16x16x32_bf16 a[168:171],v[124:127],v[88:91],a[168:171]
 v_mfma_f32_16x16x32_bf16 a[172:175],v[124:127],v[92:95],a[172:175]
 ds_read_b64_tr_b16 v[140:141],v223 offset:256
 v_mfma_f32_16x16x32_bf16 a[176:179],v[124:127],v[96:99],a[176:179]
 ds_read_b64_tr_b16 v[142:143],v223 offset:6400
 v_mfma_f32_16x16x32_bf16 a[180:183],v[124:127],v[100:103],a[180:183]
 v_mfma_f32_16x16x32_bf16 a[184:187],v[124:127],v[104:107],a[184:187]
 v_mfma_f32_16x16x32_bf16 a[188:191],v[124:127],v[108:111],a[188:191]
 s_waitcnt lgkmcnt(6)
 v_mfma_f32_16x16x32_bf16 a[192:195],v[128:131],v[88:91],a[192:195]
 v_mfma_f32_16x16x32_bf16 a[196:199],v[128:131],v[92:95],a[196:199]
 s_waitcnt vmcnt(25)
 ds_read_b64_tr_b16 v[112:113],v18 offset:0
 v_mfma_f32_16x16x32_bf16 a[200:203],v[128:131],v[96:99],a[200:203]
 ds_read_b64_tr_b16 v[114:115],v18 offset:6144
 v_mfma_f32_16x16x32_bf16 a[204:207],v[128:131],v[100:103],a[204:207]
 v_mfma_f32_16x16x32_bf16 a[208:211],v[128:131],v[104:107],a[208:211]
 s_waitcnt lgkmcnt(2)
 s_add_u32 m0,s92,98304
 s_add_u32 s34,s56,147456
 buffer_load_dwordx4 v14,s[44:47],s34 offen lds
 v_mfma_f32_16x16x32_bf16 a[212:215],v[128:131],v[108:111],a[212:215]
 v_mfma_f32_16x16x32_bf16 a[216:219],v[132:135],v[88:91],a[216:219]
 v_mfma_f32_16x16x32_bf16 a[220:223],v[132:135],v[92:95],a[220:223]
 ds_read_b64_tr_b16 v[116:117],v19 offset:0
 s_add_u32 m0,s92,99328
 s_add_u32 s34,s56,147456
 buffer_load_dwordx4 v15,s[44:47],s34 offen lds
 v_mfma_f32_16x16x32_bf16 a[224:227],v[132:135],v[96:99],a[224:227]
 ds_read_b64_tr_b16 v[118:119],v19 offset:6144
 v_mfma_f32_16x16x32_bf16 a[228:231],v[132:135],v[100:103],a[228:231]
 v_mfma_f32_16x16x32_bf16 a[232:235],v[132:135],v[104:107],a[232:235]
 s_add_u32 m0,s92,100352
 s_add_u32 s34,s56,147456
 buffer_load_dwordx4 v16,s[44:47],s34 offen lds
 v_mfma_f32_16x16x32_bf16 a[236:239],v[132:135],v[108:111],a[236:239]
 v_mfma_f32_16x16x32_bf16 a[240:243],v[136:139],v[88:91],a[240:243]
 v_mfma_f32_16x16x32_bf16 a[244:247],v[136:139],v[92:95],a[244:247]
 ds_read_b64_tr_b16 v[120:121],v20 offset:0
 s_add_u32 m0,s92,101376
 s_add_u32 s34,s56,156672
 buffer_load_dwordx4 v14,s[44:47],s34 offen lds
 v_mfma_f32_16x16x32_bf16 a[248:251],v[136:139],v[96:99],a[248:251]
 ds_read_b64_tr_b16 v[122:123],v20 offset:6144
 v_mfma_f32_16x16x32_bf16 a[252:255],v[136:139],v[100:103],a[252:255]
 v_mfma_f32_16x16x32_bf16 v[224:227],v[136:139],v[104:107],v[224:227]
 s_add_u32 m0,s92,102400
 s_add_u32 s34,s56,156672
 buffer_load_dwordx4 v15,s[44:47],s34 offen lds
 v_mfma_f32_16x16x32_bf16 v[228:231],v[136:139],v[108:111],v[228:231]
 v_mfma_f32_16x16x32_bf16 v[232:235],v[140:143],v[88:91],v[232:235]
 v_mfma_f32_16x16x32_bf16 v[236:239],v[140:143],v[92:95],v[236:239]
 ds_read_b64_tr_b16 v[124:125],v21 offset:0
 s_add_u32 m0,s92,103424
 s_add_u32 s34,s56,156672
 buffer_load_dwordx4 v16,s[44:47],s34 offen lds
 v_mfma_f32_16x16x32_bf16 v[240:243],v[140:143],v[96:99],v[240:243]
 ds_read_b64_tr_b16 v[126:127],v21 offset:6144
 v_mfma_f32_16x16x32_bf16 v[244:247],v[140:143],v[100:103],v[244:247]
 v_mfma_f32_16x16x32_bf16 v[248:251],v[140:143],v[104:107],v[248:251]
 s_add_u32 m0,s92,104448
 s_add_u32 s34,s56,165888
 buffer_load_dwordx4 v14,s[44:47],s34 offen lds
 v_mfma_f32_16x16x32_bf16 v[252:255],v[140:143],v[108:111],v[252:255]
 s_waitcnt lgkmcnt(6)
 s_waitcnt vmcnt(26)
 v_mfma_f32_16x16x32_bf16 a[0:3],v[112:115],v[40:43],a[0:3]
 v_mfma_f32_16x16x32_bf16 a[4:7],v[112:115],v[44:47],a[4:7]
 ds_read_b64_tr_b16 v[128:129],v18 offset:128
 s_add_u32 m0,s92,105472
 s_add_u32 s34,s56,165888
 buffer_load_dwordx4 v15,s[44:47],s34 offen lds
 v_mfma_f32_16x16x32_bf16 a[8:11],v[112:115],v[48:51],a[8:11]
 ds_read_b64_tr_b16 v[130:131],v18 offset:6272
 v_mfma_f32_16x16x32_bf16 a[12:15],v[112:115],v[52:55],a[12:15]
 v_mfma_f32_16x16x32_bf16 a[16:19],v[112:115],v[56:59],a[16:19]
 s_add_u32 m0,s92,106496
 s_add_u32 s34,s56,165888
 buffer_load_dwordx4 v16,s[44:47],s34 offen lds
 v_mfma_f32_16x16x32_bf16 a[20:23],v[112:115],v[60:63],a[20:23]
 s_waitcnt lgkmcnt(6)
 v_mfma_f32_16x16x32_bf16 a[24:27],v[116:119],v[40:43],a[24:27]
 v_mfma_f32_16x16x32_bf16 a[28:31],v[116:119],v[44:47],a[28:31]
 ds_read_b64_tr_b16 v[132:133],v19 offset:128
 s_add_u32 m0,s92,107520
 s_add_u32 s34,s56,175104
 buffer_load_dwordx4 v14,s[44:47],s34 offen lds
 v_mfma_f32_16x16x32_bf16 a[32:35],v[116:119],v[48:51],a[32:35]
 ds_read_b64_tr_b16 v[134:135],v19 offset:6272
 v_mfma_f32_16x16x32_bf16 a[36:39],v[116:119],v[52:55],a[36:39]
 v_mfma_f32_16x16x32_bf16 a[40:43],v[116:119],v[56:59],a[40:43]
 s_add_u32 m0,s92,108544
 s_add_u32 s34,s56,175104
 buffer_load_dwordx4 v15,s[44:47],s34 offen lds
 v_mfma_f32_16x16x32_bf16 a[44:47],v[116:119],v[60:63],a[44:47]
 s_waitcnt lgkmcnt(6)
 v_mfma_f32_16x16x32_bf16 a[48:51],v[120:123],v[40:43],a[48:51]
 v_mfma_f32_16x16x32_bf16 a[52:55],v[120:123],v[44:47],a[52:55]
 ds_read_b64_tr_b16 v[136:137],v20 offset:128
 s_add_u32 m0,s92,109568
 s_add_u32 s34,s56,175104
 buffer_load_dwordx4 v16,s[44:47],s34 offen lds
 v_mfma_f32_16x16x32_bf16 a[56:59],v[120:123],v[48:51],a[56:59]
 ds_read_b64_tr_b16 v[138:139],v20 offset:6272
 v_mfma_f32_16x16x32_bf16 a[60:63],v[120:123],v[52:55],a[60:63]
 v_mfma_f32_16x16x32_bf16 a[64:67],v[120:123],v[56:59],a[64:67]
 v_mfma_f32_16x16x32_bf16 a[68:71],v[120:123],v[60:63],a[68:71]
 s_waitcnt lgkmcnt(6)
 v_mfma_f32_16x16x32_bf16 a[72:75],v[124:127],v[40:43],a[72:75]
 v_mfma_f32_16x16x32_bf16 a[76:79],v[124:127],v[44:47],a[76:79]
 ds_read_b64_tr_b16 v[140:141],v21 offset:128
 v_mfma_f32_16x16x32_bf16 a[80:83],v[124:127],v[48:51],a[80:83]
 ds_read_b64_tr_b16 v[142:143],v21 offset:6272
 v_mfma_f32_16x16x32_bf16 a[84:87],v[124:127],v[52:55],a[84:87]
 v_mfma_f32_16x16x32_bf16 a[88:91],v[124:127],v[56:59],a[88:91]
 v_mfma_f32_16x16x32_bf16 a[92:95],v[124:127],v[60:63],a[92:95]
 s_waitcnt lgkmcnt(6)
 v_mfma_f32_16x16x32_bf16 a[96:99],v[128:131],v[40:43],a[96:99]
 v_mfma_f32_16x16x32_bf16 a[100:103],v[128:131],v[44:47],a[100:103]
 ds_read_b64_tr_b16 v[112:113],v18 offset:256
 v_mfma_f32_16x16x32_bf16 a[104:107],v[128:131],v[48:51],a[104:107]
 ds_read_b64_tr_b16 v[114:115],v18 offset:6400
 v_mfma_f32_16x16x32_bf16 a[108:111],v[128:131],v[52:55],a[108:111]
 v_mfma_f32_16x16x32_bf16 a[112:115],v[128:131],v[56:59],a[112:115]
 v_mfma_f32_16x16x32_bf16 a[116:119],v[128:131],v[60:63],a[116:119]
 s_waitcnt lgkmcnt(6)
 v_mfma_f32_16x16x32_bf16 a[120:123],v[132:135],v[40:43],a[120:123]
 v_mfma_f32_16x16x32_bf16 a[124:127],v[132:135],v[44:47],a[124:127]
 ds_read_b64_tr_b16 v[116:117],v19 offset:256
 v_mfma_f32_16x16x32_bf16 a[128:131],v[132:135],v[48:51],a[128:131]
 ds_read_b64_tr_b16 v[118:119],v19 offset:6400
 v_mfma_f32_16x16x32_bf16 a[132:135],v[132:135],v[52:55],a[132:135]
 v_mfma_f32_16x16x32_bf16 a[136:139],v[132:135],v[56:59],a[136:139]
 v_mfma_f32_16x16x32_bf16 a[140:143],v[132:135],v[60:63],a[140:143]
 s_waitcnt lgkmcnt(6)
 v_mfma_f32_16x16x32_bf16 a[144:147],v[136:139],v[40:43],a[144:147]
 v_mfma_f32_16x16x32_bf16 a[148:151],v[136:139],v[44:47],a[148:151]
 ds_read_b64_tr_b16 v[120:121],v20 offset:256
 v_mfma_f32_16x16x32_bf16 a[152:155],v[136:139],v[48:51],a[152:155]
 ds_read_b64_tr_b16 v[122:123],v20 offset:6400
 v_mfma_f32_16x16x32_bf16 a[156:159],v[136:139],v[52:55],a[156:159]
 v_mfma_f32_16x16x32_bf16 a[160:163],v[136:139],v[56:59],a[160:163]
 v_mfma_f32_16x16x32_bf16 a[164:167],v[136:139],v[60:63],a[164:167]
 s_waitcnt lgkmcnt(6)
 v_mfma_f32_16x16x32_bf16 a[168:171],v[140:143],v[40:43],a[168:171]
 v_mfma_f32_16x16x32_bf16 a[172:175],v[140:143],v[44:47],a[172:175]
 ds_read_b64_tr_b16 v[124:125],v21 offset:256
 v_mfma_f32_16x16x32_bf16 a[176:179],v[140:143],v[48:51],a[176:179]
 ds_read_b64_tr_b16 v[126:127],v21 offset:6400
 v_mfma_f32_16x16x32_bf16 a[180:183],v[140:143],v[52:55],a[180:183]
 v_mfma_f32_16x16x32_bf16 a[184:187],v[140:143],v[56:59],a[184:187]
 v_mfma_f32_16x16x32_bf16 a[188:191],v[140:143],v[60:63],a[188:191]
 s_waitcnt lgkmcnt(6)
 v_mfma_f32_16x16x32_bf16 a[192:195],v[112:115],v[40:43],a[192:195]
 v_mfma_f32_16x16x32_bf16 a[196:199],v[112:115],v[44:47],a[196:199]
 s_waitcnt vmcnt(19)
 ds_read_b64_tr_b16 v[128:129],v18 offset:49152
 v_mfma_f32_16x16x32_bf16 a[200:203],v[112:115],v[48:51],a[200:203]
 ds_read_b64_tr_b16 v[130:131],v18 offset:55296
 v_mfma_f32_16x16x32_bf16 a[204:207],v[112:115],v[52:55],a[204:207]
 v_mfma_f32_16x16x32_bf16 a[208:211],v[112:115],v[56:59],a[208:211]
 s_waitcnt lgkmcnt(2)
 s_add_u32 m0,s92,0
 s_add_u32 s34,s56,737280
 buffer_load_dwordx4 v14,s[44:47],s34 offen lds
 v_mfma_f32_16x16x32_bf16 a[212:215],v[112:115],v[60:63],a[212:215]
 v_mfma_f32_16x16x32_bf16 a[216:219],v[116:119],v[40:43],a[216:219]
 v_mfma_f32_16x16x32_bf16 a[220:223],v[116:119],v[44:47],a[220:223]
 ds_read_b64_tr_b16 v[132:133],v19 offset:49152
 s_add_u32 m0,s92,1024
 s_add_u32 s34,s56,737280
 buffer_load_dwordx4 v15,s[44:47],s34 offen lds
 v_mfma_f32_16x16x32_bf16 a[224:227],v[116:119],v[48:51],a[224:227]
 ds_read_b64_tr_b16 v[134:135],v19 offset:55296
 v_mfma_f32_16x16x32_bf16 a[228:231],v[116:119],v[52:55],a[228:231]
 v_mfma_f32_16x16x32_bf16 a[232:235],v[116:119],v[56:59],a[232:235]
 s_add_u32 m0,s92,2048
 s_add_u32 s34,s56,737280
 buffer_load_dwordx4 v16,s[44:47],s34 offen lds
 v_mfma_f32_16x16x32_bf16 a[236:239],v[116:119],v[60:63],a[236:239]
 v_mfma_f32_16x16x32_bf16 a[240:243],v[120:123],v[40:43],a[240:243]
 v_mfma_f32_16x16x32_bf16 a[244:247],v[120:123],v[44:47],a[244:247]
 ds_read_b64_tr_b16 v[136:137],v20 offset:49152
 s_add_u32 m0,s92,3072
 s_add_u32 s34,s56,746496
 buffer_load_dwordx4 v14,s[44:47],s34 offen lds
 v_mfma_f32_16x16x32_bf16 a[248:251],v[120:123],v[48:51],a[248:251]
 ds_read_b64_tr_b16 v[138:139],v20 offset:55296
 v_mfma_f32_16x16x32_bf16 a[252:255],v[120:123],v[52:55],a[252:255]
 v_mfma_f32_16x16x32_bf16 v[224:227],v[120:123],v[56:59],v[224:227]
 s_add_u32 m0,s92,4096
 s_add_u32 s34,s56,746496
 buffer_load_dwordx4 v15,s[44:47],s34 offen lds
 v_mfma_f32_16x16x32_bf16 v[228:231],v[120:123],v[60:63],v[228:231]
 v_mfma_f32_16x16x32_bf16 v[232:235],v[124:127],v[40:43],v[232:235]
 v_mfma_f32_16x16x32_bf16 v[236:239],v[124:127],v[44:47],v[236:239]
 ds_read_b64_tr_b16 v[140:141],v21 offset:49152
 s_add_u32 m0,s92,5120
 s_add_u32 s34,s56,746496
 buffer_load_dwordx4 v16,s[44:47],s34 offen lds
 v_mfma_f32_16x16x32_bf16 v[240:243],v[124:127],v[48:51],v[240:243]
 ds_read_b64_tr_b16 v[142:143],v21 offset:55296
 v_mfma_f32_16x16x32_bf16 v[244:247],v[124:127],v[52:55],v[244:247]
 v_mfma_f32_16x16x32_bf16 v[248:251],v[124:127],v[56:59],v[248:251]
 s_add_u32 m0,s92,6144
 s_add_u32 s34,s56,755712
 buffer_load_dwordx4 v14,s[44:47],s34 offen lds
 v_mfma_f32_16x16x32_bf16 v[252:255],v[124:127],v[60:63],v[252:255]
 s_waitcnt vmcnt(19)
 v_cmp_lt_u32 vcc,v5,v4
 s_nop 1
 s_cbranch_vccnz OP_spin1
OP_back1:
 s_waitcnt vmcnt(20)
 s_waitcnt lgkmcnt(6)
 v_mfma_f32_16x16x32_bf16 a[0:3],v[128:131],v[64:67],a[0:3]
 v_mfma_f32_16x16x32_bf16 a[4:7],v[128:131],v[68:71],a[4:7]
 ds_read_b64_tr_b16 v[112:113],v18 offset:49280
 s_add_u32 s35,s57,4096
 buffer_load_dwordx4 v[88:91],v2,s[48:51],s35 offen sc0 sc1
 v_mfma_f32_16x16x32_bf16 a[8:11],v[128:131],v[72:75],a[8:11]
 ds_read_b64_tr_b16 v[114:115],v18 offset:55424
 v_mfma_f32_16x16x32_bf16 a[12:15],v[128:131],v[76:79],a[12:15]
 v_mfma_f32_16x16x32_bf16 a[16:19],v[128:131],v[80:83],a[16:19]
 s_add_u32 s35,s57,135168
 buffer_load_dwordx4 v[92:95],v2,s[48:51],s35 offen sc0 sc1
 v_mfma_f32_16x16x32_bf16 a[20:23],v[128:131],v[84:87],a[20:23]
 s_waitcnt lgkmcnt(6)
 v_mfma_f32_16x16x32_bf16 a[24:27],v[132:135],v[64:67],a[24:27]
 v_mfma_f32_16x16x32_bf16 a[28:31],v[132:135],v[68:71],a[28:31]
 ds_read_b64_tr_b16 v[116:117],v19 offset:49280
 s_add_u32 s35,s57,266240
 buffer_load_dwordx4 v[96:99],v2,s[48:51],s35 offen sc0 sc1
 v_mfma_f32_16x16x32_bf16 a[32:35],v[132:135],v[72:75],a[32:35]
 ds_read_b64_tr_b16 v[118:119],v19 offset:55424
 v_mfma_f32_16x16x32_bf16 a[36:39],v[132:135],v[76:79],a[36:39]
 v_mfma_f32_16x16x32_bf16 a[40:43],v[132:135],v[80:83],a[40:43]
 s_add_u32 s35,s57,397312
 buffer_load_dwordx4 v[100:103],v2,s[48:51],s35 offen sc0 sc1
 v_mfma_f32_16x16x32_bf16 a[44:47],v[132:135],v[84:87],a[44:47]
 s_waitcnt lgkmcnt(6)
 v_mfma_f32_16x16x32_bf16 a[48:51],v[136:139],v[64:67],a[48:51]
 v_mfma_f32_16x16x32_bf16 a[52:55],v[136:139],v[68:71],a[52:55]
 ds_read_b64_tr_b16 v[120:121],v20 offset:49280
 s_add_u32 s35,s57,528384
 buffer_load_dwordx4 v[104:107],v2,s[48:51],s35 offen sc0 sc1
 v_mfma_f32_16x16x32_bf16 a[56:59],v[136:139],v[72:75],a[56:59]
 ds_read_b64_tr_b16 v[122:123],v20 offset:55424
 v_mfma_f32_16x16x32_bf16 a[60:63],v[136:139],v[76:79],a[60:63]
 v_mfma_f32_16x16x32_bf16 a[64:67],v[136:139],v[80:83],a[64:67]
 s_add_u32 s35,s57,659456
 buffer_load_dwordx4 v[108:111],v2,s[48:51],s35 offen sc0 sc1
 v_mfma_f32_16x16x32_bf16 a[68:71],v[136:139],v[84:87],a[68:71]
 s_waitcnt lgkmcnt(6)
 v_mfma_f32_16x16x32_bf16 a[72:75],v[140:143],v[64:67],a[72:75]
 v_mfma_f32_16x16x32_bf16 a[76:79],v[140:143],v[68:71],a[76:79]
 ds_read_b64_tr_b16 v[124:125],v21 offset:49280
 s_add_u32 m0,s92,7168
 s_add_u32 s34,s56,755712
 buffer_load_dwordx4 v15,s[44:47],s34 offen lds
 v_mfma_f32_16x16x32_bf16 a[80:83],v[140:143],v[72:75],a[80:83]
 ds_read_b64_tr_b16 v[126:127],v21 offset:55424
 v_mfma_f32_16x16x32_bf16 a[84:87],v[140:143],v[76:79],a[84:87]
 v_mfma_f32_16x16x32_bf16 a[88:91],v[140:143],v[80:83],a[88:91]
 s_add_u32 m0,s92,8192
 s_add_u32 s34,s56,755712
 buffer_load_dwordx4 v16,s[44:47],s34 offen lds
 v_mfma_f32_16x16x32_bf16 a[92:95],v[140:143],v[84:87],a[92:95]
 s_waitcnt lgkmcnt(6)
 v_mfma_f32_16x16x32_bf16 a[96:99],v[112:115],v[64:67],a[96:99]
 v_mfma_f32_16x16x32_bf16 a[100:103],v[112:115],v[68:71],a[100:103]
 ds_read_b64_tr_b16 v[128:129],v18 offset:49408
 s_add_u32 m0,s92,9216
 s_add_u32 s34,s56,764928
 buffer_load_dwordx4 v14,s[44:47],s34 offen lds
 v_mfma_f32_16x16x32_bf16 a[104:107],v[112:115],v[72:75],a[104:107]
 ds_read_b64_tr_b16 v[130:131],v18 offset:55552
 v_mfma_f32_16x16x32_bf16 a[108:111],v[112:115],v[76:79],a[108:111]
 v_mfma_f32_16x16x32_bf16 a[112:115],v[112:115],v[80:83],a[112:115]
 s_add_u32 m0,s92,10240
 s_add_u32 s34,s56,764928
 buffer_load_dwordx4 v15,s[44:47],s34 offen lds
 v_mfma_f32_16x16x32_bf16 a[116:119],v[112:115],v[84:87],a[116:119]
 s_waitcnt lgkmcnt(6)
 v_mfma_f32_16x16x32_bf16 a[120:123],v[116:119],v[64:67],a[120:123]
 v_mfma_f32_16x16x32_bf16 a[124:127],v[116:119],v[68:71],a[124:127]
 ds_read_b64_tr_b16 v[132:133],v19 offset:49408
 s_add_u32 m0,s92,11264
 s_add_u32 s34,s56,764928
 buffer_load_dwordx4 v16,s[44:47],s34 offen lds
 v_mfma_f32_16x16x32_bf16 a[128:131],v[116:119],v[72:75],a[128:131]
 ds_read_b64_tr_b16 v[134:135],v19 offset:55552
 v_mfma_f32_16x16x32_bf16 a[132:135],v[116:119],v[76:79],a[132:135]
 v_mfma_f32_16x16x32_bf16 a[136:139],v[116:119],v[80:83],a[136:139]
 s_add_u32 s35,s57,20480
 buffer_load_dwordx4 v[40:43],v2,s[48:51],s35 offen sc0 sc1
 v_mfma_f32_16x16x32_bf16 a[140:143],v[116:119],v[84:87],a[140:143]
 s_waitcnt lgkmcnt(6)
 v_mfma_f32_16x16x32_bf16 a[144:147],v[120:123],v[64:67],a[144:147]
 v_mfma_f32_16x16x32_bf16 a[148:151],v[120:123],v[68:71],a[148:151]
 ds_read_b64_tr_b16 v[136:137],v20 offset:49408
 s_add_u32 s35,s57,151552
 buffer_load_dwordx4 v[44:47],v2,s[48:51],s35 offen sc0 sc1
 v_mfma_f32_16x16x32_bf16 a[152:155],v[120:123],v[72:75],a[152:155]
 ds_read_b64_tr_b16 v[138:139],v20 offset:55552
 v_mfma_f32_16x16x32_bf16 a[156:159],v[120:123],v[76:79],a[156:159]
 v_mfma_f32_16x16x32_bf16 a[160:163],v[120:123],v[80:83],a[160:163]
 s_add_u32 s35,s57,282624
 buffer_load_dwordx4 v[48:51],v2,s[48:51],s35 offen sc0 sc1
 v_mfma_f32_16x16x32_bf16 a[164:167],v[120:123],v[84:87],a[164:167]
 s_waitcnt lgkmcnt(6)
 v_mfma_f32_16x16x32_bf16 a[168:171],v[124:127],v[64:67],a[168:171]
 v_mfma_f32_16x16x32_bf16 a[172:175],v[124:127],v[68:71],a[172:175]
 ds_read_b64_tr_b16 v[140:141],v21 offset:49408
 s_add_u32 s35,s57,413696
 buffer_load_dwordx4 v[52:55],v2,s[48:51],s35 offen sc0 sc1
 v_mfma_f32_16x16x32_bf16 a[176:179],v[124:127],v[72:75],a[176:179]
 ds_read_b64_tr_b16 v[142:143],v21 offset:55552
 v_mfma_f32_16x16x32_bf16 a[180:183],v[124:127],v[76:79],a[180:183]
 v_mfma_f32_16x16x32_bf16 a[184:187],v[124:127],v[80:83],a[184:187]
 s_add_u32 s35,s57,544768
 buffer_load_dwordx4 v[56:59],v2,s[48:51],s35 offen sc0 sc1
 v_mfma_f32_16x16x32_bf16 a[188:191],v[124:127],v[84:87],a[188:191]
 s_waitcnt lgkmcnt(6)
 v_mfma_f32_16x16x32_bf16 a[192:195],v[128:131],v[64:67],a[192:195]
 v_mfma_f32_16x16x32_bf16 a[196:199],v[128:131],v[68:71],a[196:199]
 s_waitcnt vmcnt(23)
 ds_read_b64_tr_b16 v[112:113],v220 offset:0
 s_add_u32 s35,s57,675840
 buffer_load_dwordx4 v[60:63],v2,s[48:51],s35 offen sc0 sc1
 v_mfma_f32_16x16x32_bf16 a[200:203],v[128:131],v[72:75],a[200:203]
 ds_read_b64_tr_b16 v[114:115],v220 offset:6144
 v_mfma_f32_16x16x32_bf16 a[204:207],v[128:131],v[76:79],a[204:207]
 v_mfma_f32_16x16x32_bf16 a[208:211],v[128:131],v[80:83],a[208:211]
 s_waitcnt lgkmcnt(2)
 s_add_u32 m0,s92,49152
 s_add_u32 s34,s56,1327104
 buffer_load_dwordx4 v14,s[44:47],s34 offen lds
 v_mfma_f32_16x16x32_bf16 a[212:215],v[128:131],v[84:87],a[212:215]
 v_mfma_f32_16x16x32_bf16 a[216:219],v[132:135],v[64:67],a[216:219]
 v_mfma_f32_16x16x32_bf16 a[220:223],v[132:135],v[68:71],a[220:223]
 ds_read_b64_tr_b16 v[116:117],v221 offset:0
 s_add_u32 m0,s92,50176
 s_add_u32 s34,s56,1327104
 buffer_load_dwordx4 v15,s[44:47],s34 offen lds
 v_mfma_f32_16x16x32_bf16 a[224:227],v[132:135],v[72:75],a[224:227]
 ds_read_b64_tr_b16 v[118:119],v221 offset:6144
 v_mfma_f32_16x16x32_bf16 a[228:231],v[132:135],v[76:79],a[228:231]
 v_mfma_f32_16x16x32_bf16 a[232:235],v[132:135],v[80:83],a[232:235]
 s_add_u32 m0,s92,51200
 s_add_u32 s34,s56,1327104
 buffer_load_dwordx4 v16,s[44:47],s34 offen lds
 v_mfma_f32_16x16x32_bf16 a[236:239],v[132:135],v[84:87],a[236:239]
 v_mfma_f32_16x16x32_bf16 a[240:243],v[136:139],v[64:67],a[240:243]
 v_mfma_f32_16x16x32_bf16 a[244:247],v[136:139],v[68:71],a[244:247]
 ds_read_b64_tr_b16 v[120:121],v222 offset:0
 s_add_u32 m0,s92,52224
 s_add_u32 s34,s56,1336320
 buffer_load_dwordx4 v14,s[44:47],s34 offen lds
 v_mfma_f32_16x16x32_bf16 a[248:251],v[136:139],v[72:75],a[248:251]
 ds_read_b64_tr_b16 v[122:123],v222 offset:6144
 v_mfma_f32_16x16x32_bf16 a[252:255],v[136:139],v[76:79],a[252:255]
 v_mfma_f32_16x16x32_bf16 v[224:227],v[136:139],v[80:83],v[224:227]
 s_add_u32 m0,s92,53248
 s_add_u32 s34,s56,1336320
 buffer_load_dwordx4 v15,s[44:47],s34 offen lds
 v_mfma_f32_16x16x32_bf16 v[228:231],v[136:139],v[84:87],v[228:231]
 v_mfma_f32_16x16x32_bf16 v[232:235],v[140:143],v[64:67],v[232:235]
 v_mfma_f32_16x16x32_bf16 v[236:239],v[140:143],v[68:71],v[236:239]
 ds_read_b64_tr_b16 v[124:125],v223 offset:0
 s_add_u32 m0,s92,54272
 s_add_u32 s34,s56,1336320
 buffer_load_dwordx4 v16,s[44:47],s34 offen lds
 v_mfma_f32_16x16x32_bf16 v[240:243],v[140:143],v[72:75],v[240:243]
 ds_read_b64_tr_b16 v[126:127],v223 offset:6144
 v_mfma_f32_16x16x32_bf16 v[244:247],v[140:143],v[76:79],v[244:247]
 v_mfma_f32_16x16x32_bf16 v[248:251],v[140:143],v[80:83],v[248:251]
 s_add_u32 m0,s92,55296
 s_add_u32 s34,s56,1345536
 buffer_load_dwordx4 v14,s[44:47],s34 offen lds
 v_mfma_f32_16x16x32_bf16 v[252:255],v[140:143],v[84:87],v[252:255]
 s_waitcnt lgkmcnt(6)
 s_waitcnt vmcnt(18)
 v_mfma_f32_16x16x32_bf16 a[0:3],v[112:115],v[88:91],a[0:3]
 v_mfma_f32_16x16x32_bf16 a[4:7],v[112:115],v[92:95],a[4:7]
 ds_read_b64_tr_b16 v[128:129],v220 offset:128
 s_add_u32 m0,s92,56320
 s_add_u32 s34,s56,1345536
 buffer_load_dwordx4 v15,s[44:47],s34 offen lds
 v_mfma_f32_16x16x32_bf16 a[8:11],v[112:115],v[96:99],a[8:11]
 ds_read_b64_tr_b16 v[130:131],v220 offset:6272
 v_mfma_f32_16x16x32_bf16 a[12:15],v[112:115],v[100:103],a[12:15]
 v_mfma_f32_16x16x32_bf16 a[16:19],v[112:115],v[104:107],a[16:19]
 s_add_u32 m0,s92,57344
 s_add_u32 s34,s56,1345536
 buffer_load_dwordx4 v16,s[44:47],s34 offen lds
 v_mfma_f32_16x16x32_bf16 a[20:23],v[112:115],v[108:111],a[20:23]
 s_waitcnt lgkmcnt(6)
 v_mfma_f32_16x16x32_bf16 a[24:27],v[116:119],v[88:91],a[24:27]
 v_mfma_f32_16x16x32_bf16 a[28:31],v[116:119],v[92:95],a[28:31]
 ds_read_b64_tr_b16 v[132:133],v221 offset:128
 s_add_u32 m0,s92,58368
 s_add_u32 s34,s56,1354752
 buffer_load_dwordx4 v14,s[44:47],s34 offen lds
 v_mfma_f32_16x16x32_bf16 a[32:35],v[116:119],v[96:99],a[32:35]
 ds_read_b64_tr_b16 v[134:135],v221 offset:6272
 v_mfma_f32_16x16x32_bf16 a[36:39],v[116:119],v[100:103],a[36:39]
 v_mfma_f32_16x16x32_bf16 a[40:43],v[116:119],v[104:107],a[40:43]
 s_add_u32 m0,s92,59392
 s_add_u32 s34,s56,1354752
 buffer_load_dwordx4 v15,s[44:47],s34 offen lds
 v_mfma_f32_16x16x32_bf16 a[44:47],v[116:119],v[108:111],a[44:47]
 s_waitcnt lgkmcnt(6)
 v_mfma_f32_16x16x32_bf16 a[48:51],v[120:123],v[88:91],a[48:51]
 v_mfma_f32_16x16x32_bf16 a[52:55],v[120:123],v[92:95],a[52:55]
 ds_read_b64_tr_b16 v[136:137],v222 offset:128
 s_add_u32 m0,s92,60416
 s_add_u32 s34,s56,1354752
 buffer_load_dwordx4 v16,s[44:47],s34 offen lds
 v_mfma_f32_16x16x32_bf16 a[56:59],v[120:123],v[96:99],a[56:59]
 ds_read_b64_tr_b16 v[138:139],v222 offset:6272
 v_mfma_f32_16x16x32_bf16 a[60:63],v[120:123],v[100:103],a[60:63]
 v_mfma_f32_16x16x32_bf16 a[64:67],v[120:123],v[104:107],a[64:67]
 s_add_u32 s35,s57,36864
 buffer_load_dwordx4 v[64:67],v2,s[48:51],s35 offen sc0 sc1
 v_mfma_f32_16x16x32_bf16 a[68:71],v[120:123],v[108:111],a[68:71]
 s_waitcnt lgkmcnt(6)
 v_mfma_f32_16x16x32_bf16 a[72:75],v[124:127],v[88:91],a[72:75]
 v_mfma_f32_16x16x32_bf16 a[76:79],v[124:127],v[92:95],a[76:79]
 ds_read_b64_tr_b16 v[140:141],v223 offset:128
 s_add_u32 s35,s57,167936
 buffer_load_dwordx4 v[68:71],v2,s[48:51],s35 offen sc0 sc1
 v_mfma_f32_16x16x32_bf16 a[80:83],v[124:127],v[96:99],a[80:83]
 ds_read_b64_tr_b16 v[142:143],v223 offset:6272
 v_mfma_f32_16x16x32_bf16 a[84:87],v[124:127],v[100:103],a[84:87]
 v_mfma_f32_16x16x32_bf16 a[88:91],v[124:127],v[104:107],a[88:91]
 s_add_u32 s35,s57,299008
 buffer_load_dwordx4 v[72:75],v2,s[48:51],s35 offen sc0 sc1
 v_mfma_f32_16x16x32_bf16 a[92:95],v[124:127],v[108:111],a[92:95]
 s_waitcnt lgkmcnt(6)
 v_mfma_f32_16x16x32_bf16 a[96:99],v[128:131],v[88:91],a[96:99]
 v_mfma_f32_16x16x32_bf16 a[100:103],v[128:131],v[92:95],a[100:103]
 ds_read_b64_tr_b16 v[112:113],v220 offset:256
 s_add_u32 s35,s57,430080
 buffer_load_dwordx4 v[76:79],v2,s[48:51],s35 offen sc0 sc1
 v_mfma_f32_16x16x32_bf16 a[104:107],v[128:131],v[96:99],a[104:107]
 ds_read_b64_tr_b16 v[114:115],v220 offset:6400
 v_mfma_f32_16x16x32_bf16 a[108:111],v[128:131],v[100:103],a[108:111]
 v_mfma_f32_16x16x32_bf16 a[112:115],v[128:131],v[104:107],a[112:115]
 s_add_u32 s35,s57,561152
 buffer_load_dwordx4 v[80:83],v2,s[48:51],s35 offen sc0 sc1
 v_mfma_f32_16x16x32_bf16 a[116:119],v[128:131],v[108:111],a[116:119]
 s_waitcnt lgkmcnt(6)
 v_mfma_f32_16x16x32_bf16 a[120:123],v[132:135],v[88:91],a[120:123]
 v_mfma_f32_16x16x32_bf16 a[124:127],v[132:135],v[92:95],a[124:127]
 ds_read_b64_tr_b16 v[116:117],v221 offset:256
 s_add_u32 s35,s57,692224
 buffer_load_dwordx4 v[84:87],v2,s[48:51],s35 offen sc0 sc1
 v_mfma_f32_16x16x32_bf16 a[128:131],v[132:135],v[96:99],a[128:131]
 ds_read_b64_tr_b16 v[118:119],v221 offset:6400
 v_mfma_f32_16x16x32_bf16 a[132:135],v[132:135],v[100:103],a[132:135]
 v_mfma_f32_16x16x32_bf16 a[136:139],v[132:135],v[104:107],a[136:139]
 v_mfma_f32_16x16x32_bf16 a[140:143],v[132:135],v[108:111],a[140:143]
 s_waitcnt lgkmcnt(6)
 v_mfma_f32_16x16x32_bf16 a[144:147],v[136:139],v[88:91],a[144:147]
 v_mfma_f32_16x16x32_bf16 a[148:151],v[136:139],v[92:95],a[148:151]
 ds_read_b64_tr_b16 v[120:121],v222 offset:256
 v_mfma_f32_16x16x32_bf16 a[152:155],v[136:139],v[96:99],a[152:155]
 ds_read_b64_tr_b16 v[122:123],v222 offset:6400
 v_mfma_f32_16x16x32_bf16 a[156:159],v[136:139],v[100:103],a[156:159]
 v_mfma_f32_16x16x32_bf16 a[160:163],v[136:139],v[104:107],a[160:163]
 v_mfma_f32_16x16x32_bf16 a[164:167],v[136:139],v[108:111],a[164:167]
 s_waitcnt lgkmcnt(6)
 v_mfma_f32_16x16x32_bf16 a[168:171],v[140:143],v[88:91],a[168:171]
 v_mfma_f32_16x16x32_bf16 a[172:175],v[140:143],v[92:95],a[172:175]
 ds_read_b64_tr_b16 v[124:125],v223 offset:256
 v_mfma_f32_16x16x32_bf16 a[176:179],v[140:143],v[96:99],a[176:179]
 ds_read_b64_tr_b16 v[126:127],v223 offset:6400
 v_mfma_f32_16x16x32_bf16 a[180:183],v[140:143],v[100:103],a[180:183]
 v_mfma_f32_16x16x32_bf16 a[184:187],v[140:143],v[104:107],a[184:187]
 v_mfma_f32_16x16x32_bf16 a[188:191],v[140:143],v[108:111],a[188:191]
 s_waitcnt lgkmcnt(6)
 v_mfma_f32_16x16x32_bf16 a[192:195],v[112:115],v[88:91],a[192:195]
 v_mfma_f32_16x16x32_bf16 a[196:199],v[112:115],v[92:95],a[196:199]
 s_waitcnt vmcnt(24)
 ds_read_b64_tr_b16 v[128:129],v18 offset:0
 v_mfma_f32_16x16x32_bf16 a[200:203],v[112:115],v[96:99],a[200:203]
 ds_read_b64_tr_b16 v[130:131],v18 offset:6144
 v_mfma_f32_16x16x32_bf16 a[204:207],v[112:115],v[100:103],a[204:207]
 v_mfma_f32_16x16x32_bf16 a[208:211],v[112:115],v[104:107],a[208:211]
 s_waitcnt lgkmcnt(2)
 s_add_u32 m0,s92,98304
 s_add_u32 s34,s56,1916928
 buffer_load_dwordx4 v14,s[44:47],s34 offen lds
 v_mfma_f32_16x16x32_bf16 a[212:215],v[112:115],v[108:111],a[212:215]
 v_mfma_f32_16x16x32_bf16 a[216:219],v[116:119],v[88:91],a[216:219]
 v_mfma_f32_16x16x32_bf16 a[220:223],v[116:119],v[92:95],a[220:223]
 ds_read_b64_tr_b16 v[132:133],v19 offset:0
 s_add_u32 m0,s92,99328
 s_add_u32 s34,s56,1916928
 buffer_load_dwordx4 v15,s[44:47],s34 offen lds
 v_mfma_f32_16x16x32_bf16 a[224:227],v[116:119],v[96:99],a[224:227]
 ds_read_b64_tr_b16 v[134:135],v19 offset:6144
 v_mfma_f32_16x16x32_bf16 a[228:231],v[116:119],v[100:103],a[228:231]
 v_mfma_f32_16x16x32_bf16 a[232:235],v[116:119],v[104:107],a[232:235]
 s_add_u32 m0,s92,100352
 s_add_u32 s34,s56,1916928
 buffer_load_dwordx4 v16,s[44:47],s34 offen lds
 v_mfma_f32_16x16x32_bf16 a[236:239],v[116:119],v[108:111],a[236:239]
 v_mfma_f32_16x16x32_bf16 a[240:243],v[120:123],v[88:91],a[240:243]
 v_mfma_f32_16x16x32_bf16 a[244:247],v[120:123],v[92:95],a[244:247]
 ds_read_b64_tr_b16 v[136:137],v20 offset:0
 s_add_u32 m0,s92,101376
 s_add_u32 s34,s56,1926144
 buffer_load_dwordx4 v14,s[44:47],s34 offen lds
 v_mfma_f32_16x16x32_bf16 a[248:251],v[120:123],v[96:99],a[248:251]
 ds_read_b64_tr_b16 v[138:139],v20 offset:6144
 v_mfma_f32_16x16x32_bf16 a[252:255],v[120:123],v[100:103],a[252:255]
 v_mfma_f32_16x16x32_bf16 v[224:227],v[120:123],v[104:107],v[224:227]
 s_add_u32 m0,s92,102400
 s_add_u32 s34,s56,1926144
 buffer_load_dwordx4 v15,s[44:47],s34 offen lds
 v_mfma_f32_16x16x32_bf16 v[228:231],v[120:123],v[108:111],v[228:231]
 v_mfma_f32_16x16x32_bf16 v[232:235],v[124:127],v[88:91],v[232:235]
 v_mfma_f32_16x16x32_bf16 v[236:239],v[124:127],v[92:95],v[236:239]
 ds_read_b64_tr_b16 v[140:141],v21 offset:0
 s_add_u32 m0,s92,103424
 s_add_u32 s34,s56,1926144
 buffer_load_dwordx4 v16,s[44:47],s34 offen lds
 v_mfma_f32_16x16x32_bf16 v[240:243],v[124:127],v[96:99],v[240:243]
 ds_read_b64_tr_b16 v[142:143],v21 offset:6144
 v_mfma_f32_16x16x32_bf16 v[244:247],v[124:127],v[100:103],v[244:247]
 v_mfma_f32_16x16x32_bf16 v[248:251],v[124:127],v[104:107],v[248:251]
 s_add_u32 m0,s92,104448
 s_add_u32 s34,s56,1935360
 buffer_load_dwordx4 v14,s[44:47],s34 offen lds
 v_mfma_f32_16x16x32_bf16 v[252:255],v[124:127],v[108:111],v[252:255]
 s_waitcnt lgkmcnt(6)
 s_waitcnt vmcnt(25)
 v_mfma_f32_16x16x32_bf16 a[0:3],v[128:131],v[40:43],a[0:3]
 v_mfma_f32_16x16x32_bf16 a[4:7],v[128:131],v[44:47],a[4:7]
 ds_read_b64_tr_b16 v[112:113],v18 offset:128
 s_add_u32 m0,s92,105472
 s_add_u32 s34,s56,1935360
 buffer_load_dwordx4 v15,s[44:47],s34 offen lds
 v_mfma_f32_16x16x32_bf16 a[8:11],v[128:131],v[48:51],a[8:11]
 ds_read_b64_tr_b16 v[114:115],v18 offset:6272
 v_mfma_f32_16x16x32_bf16 a[12:15],v[128:131],v[52:55],a[12:15]
 v_mfma_f32_16x16x32_bf16 a[16:19],v[128:131],v[56:59],a[16:19]
 s_add_u32 m0,s92,106496
 s_add_u32 s34,s56,1935360
 buffer_load_dwordx4 v16,s[44:47],s34 offen lds
 v_mfma_f32_16x16x32_bf16 a[20:23],v[128:131],v[60:63],a[20:23]
 s_waitcnt lgkmcnt(6)
 v_mfma_f32_16x16x32_bf16 a[24:27],v[132:135],v[40:43],a[24:27]
 v_mfma_f32_16x16x32_bf16 a[28:31],v[132:135],v[44:47],a[28:31]
 ds_read_b64_tr_b16 v[116:117],v19 offset:128
 s_add_u32 m0,s92,107520
 s_add_u32 s34,s56,1944576
 buffer_load_dwordx4 v14,s[44:47],s34 offen lds
 v_mfma_f32_16x16x32_bf16 a[32:35],v[132:135],v[48:51],a[32:35]
 ds_read_b64_tr_b16 v[118:119],v19 offset:6272
 v_mfma_f32_16x16x32_bf16 a[36:39],v[132:135],v[52:55],a[36:39]
 v_mfma_f32_16x16x32_bf16 a[40:43],v[132:135],v[56:59],a[40:43]
 s_add_u32 m0,s92,108544
 s_add_u32 s34,s56,1944576
 buffer_load_dwordx4 v15,s[44:47],s34 offen lds
 v_mfma_f32_16x16x32_bf16 a[44:47],v[132:135],v[60:63],a[44:47]
 s_waitcnt lgkmcnt(6)
 v_mfma_f32_16x16x32_bf16 a[48:51],v[136:139],v[40:43],a[48:51]
 v_mfma_f32_16x16x32_bf16 a[52:55],v[136:139],v[44:47],a[52:55]
 ds_read_b64_tr_b16 v[120:121],v20 offset:128
 s_add_u32 m0,s92,109568
 s_add_u32 s34,s56,1944576
 buffer_load_dwordx4 v16,s[44:47],s34 offen lds
 v_mfma_f32_16x16x32_bf16 a[56:59],v[136:139],v[48:51],a[56:59]
 ds_read_b64_tr_b16 v[122:123],v20 offset:6272
 v_mfma_f32_16x16x32_bf16 a[60:63],v[136:139],v[52:55],a[60:63]
 v_mfma_f32_16x16x32_bf16 a[64:67],v[136:139],v[56:59],a[64:67]
 s_add_u32 s35,s57,53248
 buffer_load_dwordx4 v[88:91],v2,s[48:51],s35 offen sc0 sc1
 v_mfma_f32_16x16x32_bf16 a[68:71],v[136:139],v[60:63],a[68:71]
 s_waitcnt lgkmcnt(6)
 v_mfma_f32_16x16x32_bf16 a[72:75],v[140:143],v[40:43],a[72:75]
 v_mfma_f32_16x16x32_bf16 a[76:79],v[140:143],v[44:47],a[76:79]
 ds_read_b64_tr_b16 v[124:125],v21 offset:128
 s_add_u32 s35,s57,184320
 buffer_load_dwordx4 v[92:95],v2,s[48:51],s35 offen sc0 sc1
 v_mfma_f32_16x16x32_bf16 a[80:83],v[140:143],v[48:51],a[80:83]
 ds_read_b64_tr_b16 v[126:127],v21 offset:6272
 v_mfma_f32_16x16x32_bf16 a[84:87],v[140:143],v[52:55],a[84:87]
 v_mfma_f32_16x16x32_bf16 a[88:91],v[140:143],v[56:59],a[88:91]
 s_add_u32 s35,s57,315392
 buffer_load_dwordx4 v[96:99],v2,s[48:51],s35 offen sc0 sc1
 v_mfma_f32_16x16x32_bf16 a[92:95],v[140:143],v[60:63],a[92:95]
 s_waitcnt lgkmcnt(6)
 v_mfma_f32_16x16x32_bf16 a[96:99],v[112:115],v[40:43],a[96:99]
 v_mfma_f32_16x16x32_bf16 a[100:103],v[112:115],v[44:47],a[100:103]
 ds_read_b64_tr_b16 v[128:129],v18 offset:256
 s_add_u32 s35,s57,446464
 buffer_load_dwordx4 v[100:103],v2,s[48:51],s35 offen sc0 sc1
 v_mfma_f32_16x16x32_bf16 a[104:107],v[112:115],v[48:51],a[104:107]
 ds_read_b64_tr_b16 v[130:131],v18 offset:6400
 v_mfma_f32_16x16x32_bf16 a[108:111],v[112:115],v[52:55],a[108:111]
 v_mfma_f32_16x16x32_bf16 a[112:115],v[112:115],v[56:59],a[112:115]
 s_add_u32 s35,s57,577536
 buffer_load_dwordx4 v[104:107],v2,s[48:51],s35 offen sc0 sc1
 v_mfma_f32_16x16x32_bf16 a[116:119],v[112:115],v[60:63],a[116:119]
 s_waitcnt lgkmcnt(6)
 v_mfma_f32_16x16x32_bf16 a[120:123],v[116:119],v[40:43],a[120:123]
 v_mfma_f32_16x16x32_bf16 a[124:127],v[116:119],v[44:47],a[124:127]
 ds_read_b64_tr_b16 v[132:133],v19 offset:256
 s_add_u32 s35,s57,708608
 buffer_load_dwordx4 v[108:111],v2,s[48:51],s35 offen sc0 sc1
 v_mfma_f32_16x16x32_bf16 a[128:131],v[116:119],v[48:51],a[128:131]
 ds_read_b64_tr_b16 v[134:135],v19 offset:6400
 v_mfma_f32_16x16x32_bf16 a[132:135],v[116:119],v[52:55],a[132:135]
 v_mfma_f32_16x16x32_bf16 a[136:139],v[116:119],v[56:59],a[136:139]
 v_mfma_f32_16x16x32_bf16 a[140:143],v[116:119],v[60:63],a[140:143]
 s_waitcnt lgkmcnt(6)
 v_mfma_f32_16x16x32_bf16 a[144:147],v[120:123],v[40:43],a[144:147]
 v_mfma_f32_16x16x32_bf16 a[148:151],v[120:123],v[44:47],a[148:151]
 ds_read_b64_tr_b16 v[136:137],v20 offset:256
 v_mfma_f32_16x16x32_bf16 a[152:155],v[120:123],v[48:51],a[152:155]
 ds_read_b64_tr_b16 v[138:139],v20 offset:6400
 v_mfma_f32_16x16x32_bf16 a[156:159],v[120:123],v[52:55],a[156:159]
 v_mfma_f32_16x16x32_bf16 a[160:163],v[120:123],v[56:59],a[160:163]
 v_mfma_f32_16x16x32_bf16 a[164:167],v[120:123],v[60:63],a[164:167]
 s_waitcnt lgkmcnt(6)
 v_mfma_f32_16x16x32_bf16 a[168:171],v[124:127],v[40:43],a[168:171]
 v_mfma_f32_16x16x32_bf16 a[172:175],v[124:127],v[44:47],a[172:175]
 ds_read_b64_tr_b16 v[140:141],v21 offset:256
 v_mfma_f32_16x16x32_bf16 a[176:179],v[124:127],v[48:51],a[176:179]
 ds_read_b64_tr_b16 v[142:143],v21 offset:6400
 v_mfma_f32_16x16x32_bf16 a[180:183],v[124:127],v[52:55],a[180:183]
 v_mfma_f32_16x16x32_bf16 a[184:187],v[124:127],v[56:59],a[184:187]
 v_mfma_f32_16x16x32_bf16 a[188:191],v[124:127],v[60:63],a[188:191]
 s_waitcnt lgkmcnt(6)
 v_mfma_f32_16x16x32_bf16 a[192:195],v[128:131],v[40:43],a[192:195]
 v_mfma_f32_16x16x32_bf16 a[196:199],v[128:131],v[44:47],a[196:199]
 s_waitcnt vmcnt(24)
 ds_read_b64_tr_b16 v[112:113],v18 offset:49152
 v_mfma_f32_16x16x32_bf16 a[200:203],v[128:131],v[48:51],a[200:203]
 ds_read_b64_tr_b16 v[114:115],v18 offset:55296
 v_mfma_f32_16x16x32_bf16 a[204:207],v[128:131],v[52:55],a[204:207]
 v_mfma_f32_16x16x32_bf16 a[208:211],v[128:131],v[56:59],a[208:211]
 s_waitcnt lgkmcnt(2)
 s_add_u32 m0,s92,0
 s_add_u32 s34,s56,2506752
 buffer_load_dwordx4 v14,s[44:47],s34 offen lds
 v_mfma_f32_16x16x32_bf16 a[212:215],v[128:131],v[60:63],a[212:215]
 v_mfma_f32_16x16x32_bf16 a[216:219],v[132:135],v[40:43],a[216:219]
 v_mfma_f32_16x16x32_bf16 a[220:223],v[132:135],v[44:47],a[220:223]
 ds_read_b64_tr_b16 v[116:117],v19 offset:49152
 s_add_u32 m0,s92,1024
 s_add_u32 s34,s56,2506752
 buffer_load_dwordx4 v15,s[44:47],s34 offen lds
 v_mfma_f32_16x16x32_bf16 a[224:227],v[132:135],v[48:51],a[224:227]
 ds_read_b64_tr_b16 v[118:119],v19 offset:55296
 v_mfma_f32_16x16x32_bf16 a[228:231],v[132:135],v[52:55],a[228:231]
 v_mfma_f32_16x16x32_bf16 a[232:235],v[132:135],v[56:59],a[232:235]
 s_add_u32 m0,s92,2048
 s_add_u32 s34,s56,2506752
 buffer_load_dwordx4 v16,s[44:47],s34 offen lds
 v_mfma_f32_16x16x32_bf16 a[236:239],v[132:135],v[60:63],a[236:239]
 v_mfma_f32_16x16x32_bf16 a[240:243],v[136:139],v[40:43],a[240:243]
 v_mfma_f32_16x16x32_bf16 a[244:247],v[136:139],v[44:47],a[244:247]
 ds_read_b64_tr_b16 v[120:121],v20 offset:49152
 s_add_u32 m0,s92,3072
 s_add_u32 s34,s56,2515968
 buffer_load_dwordx4 v14,s[44:47],s34 offen lds
 v_mfma_f32_16x16x32_bf16 a[248:251],v[136:139],v[48:51],a[248:251]
 ds_read_b64_tr_b16 v[122:123],v20 offset:55296
 v_mfma_f32_16x16x32_bf16 a[252:255],v[136:139],v[52:55],a[252:255]
 v_mfma_f32_16x16x32_bf16 v[224:227],v[136:139],v[56:59],v[224:227]
 s_add_u32 m0,s92,4096
 s_add_u32 s34,s56,2515968
 buffer_load_dwordx4 v15,s[44:47],s34 offen lds
 v_mfma_f32_16x16x32_bf16 v[228:231],v[136:139],v[60:63],v[228:231]
 v_mfma_f32_16x16x32_bf16 v[232:235],v[140:143],v[40:43],v[232:235]
 v_mfma_f32_16x16x32_bf16 v[236:239],v[140:143],v[44:47],v[236:239]
 ds_read_b64_tr_b16 v[124:125],v21 offset:49152
 s_add_u32 m0,s92,5120
 s_add_u32 s34,s56,2515968
 buffer_load_dwordx4 v16,s[44:47],s34 offen lds
 v_mfma_f32_16x16x32_bf16 v[240:243],v[140:143],v[48:51],v[240:243]
 ds_read_b64_tr_b16 v[126:127],v21 offset:55296
 v_mfma_f32_16x16x32_bf16 v[244:247],v[140:143],v[52:55],v[244:247]
 v_mfma_f32_16x16x32_bf16 v[248:251],v[140:143],v[56:59],v[248:251]
 s_add_u32 m0,s92,6144
 s_add_u32 s34,s56,2525184
 buffer_load_dwordx4 v14,s[44:47],s34 offen lds
 v_mfma_f32_16x16x32_bf16 v[252:255],v[140:143],v[60:63],v[252:255]
 s_waitcnt lgkmcnt(6)
 s_waitcnt vmcnt(25)
 v_mfma_f32_16x16x32_bf16 a[0:3],v[112:115],v[64:67],a[0:3]
 v_mfma_f32_16x16x32_bf16 a[4:7],v[112:115],v[68:71],a[4:7]
 ds_read_b64_tr_b16 v[128:129],v18 offset:49280
 s_add_u32 m0,s92,7168
 s_add_u32 s34,s56,2525184
 buffer_load_dwordx4 v15,s[44:47],s34 offen lds
 v_mfma_f32_16x16x32_bf16 a[8:11],v[112:115],v[72:75],a[8:11]
 ds_read_b64_tr_b16 v[130:131],v18 offset:55424
 v_mfma_f32_16x16x32_bf16 a[12:15],v[112:115],v[76:79],a[12:15]
 v_mfma_f32_16x16x32_bf16 a[16:19],v[112:115],v[80:83],a[16:19]
 s_add_u32 m0,s92,8192
 s_add_u32 s34,s56,2525184
 buffer_load_dwordx4 v16,s[44:47],s34 offen lds
 v_mfma_f32_16x16x32_bf16 a[20:23],v[112:115],v[84:87],a[20:23]
 s_waitcnt lgkmcnt(6)
 v_mfma_f32_16x16x32_bf16 a[24:27],v[116:119],v[64:67],a[24:27]
 v_mfma_f32_16x16x32_bf16 a[28:31],v[116:119],v[68:71],a[28:31]
 ds_read_b64_tr_b16 v[132:133],v19 offset:49280
 s_add_u32 m0,s92,9216
 s_add_u32 s34,s56,2534400
 buffer_load_dwordx4 v14,s[44:47],s34 offen lds
 v_mfma_f32_16x16x32_bf16 a[32:35],v[116:119],v[72:75],a[32:35]
 ds_read_b64_tr_b16 v[134:135],v19 offset:55424
 v_mfma_f32_16x16x32_bf16 a[36:39],v[116:119],v[76:79],a[36:39]
 v_mfma_f32_16x16x32_bf16 a[40:43],v[116:119],v[80:83],a[40:43]
 s_add_u32 m0,s92,10240
 s_add_u32 s34,s56,2534400
 buffer_load_dwordx4 v15,s[44:47],s34 offen lds
 v_mfma_f32_16x16x32_bf16 a[44:47],v[116:119],v[84:87],a[44:47]
 s_waitcnt lgkmcnt(6)
 v_mfma_f32_16x16x32_bf16 a[48:51],v[120:123],v[64:67],a[48:51]
 v_mfma_f32_16x16x32_bf16 a[52:55],v[120:123],v[68:71],a[52:55]
 ds_read_b64_tr_b16 v[136:137],v20 offset:49280
 s_add_u32 m0,s92,11264
 s_add_u32 s34,s56,2534400
 buffer_load_dwordx4 v16,s[44:47],s34 offen lds
 v_mfma_f32_16x16x32_bf16 a[56:59],v[120:123],v[72:75],a[56:59]
 ds_read_b64_tr_b16 v[138:139],v20 offset:55424
 v_mfma_f32_16x16x32_bf16 a[60:63],v[120:123],v[76:79],a[60:63]
 v_mfma_f32_16x16x32_bf16 a[64:67],v[120:123],v[80:83],a[64:67]
 s_add_u32 s35,s57,69632
 buffer_load_dwordx4 v[40:43],v2,s[48:51],s35 offen sc0 sc1
 v_mfma_f32_16x16x32_bf16 a[68:71],v[120:123],v[84:87],a[68:71]
 s_waitcnt lgkmcnt(6)
 v_mfma_f32_16x16x32_bf16 a[72:75],v[124:127],v[64:67],a[72:75]
 v_mfma_f32_16x16x32_bf16 a[76:79],v[124:127],v[68:71],a[76:79]
 ds_read_b64_tr_b16 v[140:141],v21 offset:49280
 s_add_u32 s35,s57,200704
 buffer_load_dwordx4 v[44:47],v2,s[48:51],s35 offen sc0 sc1
 v_mfma_f32_16x16x32_bf16 a[80:83],v[124:127],v[72:75],a[80:83]
 ds_read_b64_tr_b16 v[142:143],v21 offset:55424
 v_mfma_f32_16x16x32_bf16 a[84:87],v[124:127],v[76:79],a[84:87]
 v_mfma_f32_16x16x32_bf16 a[88:91],v[124:127],v[80:83],a[88:91]
 s_add_u32 s35,s57,331776
 buffer_load_dwordx4 v[48:51],v2,s[48:51],s35 offen sc0 sc1
 v_mfma_f32_16x16x32_bf16 a[92:95],v[124:127],v[84:87],a[92:95]
 s_waitcnt lgkmcnt(6)
 v_mfma_f32_16x16x32_bf16 a[96:99],v[128:131],v[64:67],a[96:99]
 v_mfma_f32_16x16x32_bf16 a[100:103],v[128:131],v[68:71],a[100:103]
 ds_read_b64_tr_b16 v[112:113],v18 offset:49408
 s_add_u32 s35,s57,462848
 buffer_load_dwordx4 v[52:55],v2,s[48:51],s35 offen sc0 sc1
 v_mfma_f32_16x16x32_bf16 a[104:107],v[128:131],v[72:75],a[104:107]
 ds_read_b64_tr_b16 v[114:115],v18 offset:55552
 v_mfma_f32_16x16x32_bf16 a[108:111],v[128:131],v[76:79],a[108:111]
 v_mfma_f32_16x16x32_bf16 a[112:115],v[128:131],v[80:83],a[112:115]
 s_add_u32 s35,s57,593920
 buffer_load_dwordx4 v[56:59],v2,s[48:51],s35 offen sc0 sc1
 v_mfma_f32_16x16x32_bf16 a[116:119],v[128:131],v[84:87],a[116:119]
 s_waitcnt lgkmcnt(6)
 v_mfma_f32_16x16x32_bf16 a[120:123],v[132:135],v[64:67],a[120:123]
 v_mfma_f32_16x16x32_bf16 a[124:127],v[132:135],v[68:71],a[124:127]
 ds_read_b64_tr_b16 v[116:117],v19 offset:49408
 s_add_u32 s35,s57,724992
 buffer_load_dwordx4 v[60:63],v2,s[48:51],s35 offen sc0 sc1
 v_mfma_f32_16x16x32_bf16 a[128:131],v[132:135],v[72:75],a[128:131]
 ds_read_b64_tr_b16 v[118:119],v19 offset:55552
 v_mfma_f32_16x16x32_bf16 a[132:135],v[132:135],v[76:79],a[132:135]
 v_mfma_f32_16x16x32_bf16 a[136:139],v[132:135],v[80:83],a[136:139]
 v_mfma_f32_16x16x32_bf16 a[140:143],v[132:135],v[84:87],a[140:143]
 s_waitcnt lgkmcnt(6)
 v_mfma_f32_16x16x32_bf16 a[144:147],v[136:139],v[64:67],a[144:147]
 v_mfma_f32_16x16x32_bf16 a[148:151],v[136:139],v[68:71],a[148:151]
 ds_read_b64_tr_b16 v[120:121],v20 offset:49408
 v_mfma_f32_16x16x32_bf16 a[152:155],v[136:139],v[72:75],a[152:155]
 ds_read_b64_tr_b16 v[122:123],v20 offset:55552
 v_mfma_f32_16x16x32_bf16 a[156:159],v[136:139],v[76:79],a[156:159]
 v_mfma_f32_16x16x32_bf16 a[160:163],v[136:139],v[80:83],a[160:163]
 v_mfma_f32_16x16x32_bf16 a[164:167],v[136:139],v[84:87],a[164:167]
 s_waitcnt lgkmcnt(6)
 v_mfma_f32_16x16x32_bf16 a[168:171],v[140:143],v[64:67],a[168:171]
 v_mfma_f32_16x16x32_bf16 a[172:175],v[140:143],v[68:71],a[172:175]
 ds_read_b64_tr_b16 v[124:125],v21 offset:49408
 v_mfma_f32_16x16x32_bf16 a[176:179],v[140:143],v[72:75],a[176:179]
 ds_read_b64_tr_b16 v[126:127],v21 offset:55552
 v_mfma_f32_16x16x32_bf16 a[180:183],v[140:143],v[76:79],a[180:183]
 v_mfma_f32_16x16x32_bf16 a[184:187],v[140:143],v[80:83],a[184:187]
 v_mfma_f32_16x16x32_bf16 a[188:191],v[140:143],v[84:87],a[188:191]
 s_waitcnt lgkmcnt(6)
 v_mfma_f32_16x16x32_bf16 a[192:195],v[112:115],v[64:67],a[192:195]
 v_mfma_f32_16x16x32_bf16 a[196:199],v[112:115],v[68:71],a[196:199]
 s_waitcnt vmcnt(24)
 ds_read_b64_tr_b16 v[128:129],v220 offset:0
 v_mfma_f32_16x16x32_bf16 a[200:203],v[112:115],v[72:75],a[200:203]
 ds_read_b64_tr_b16 v[130:131],v220 offset:6144
 v_mfma_f32_16x16x32_bf16 a[204:207],v[112:115],v[76:79],a[204:207]
 v_mfma_f32_16x16x32_bf16 a[208:211],v[112:115],v[80:83],a[208:211]
 s_waitcnt lgkmcnt(2)
 s_add_u32 m0,s92,49152
 s_add_u32 s34,s56,3096576
 buffer_load_dwordx4 v14,s[44:47],s34 offen lds
 v_mfma_f32_16x16x32_bf16 a[212:215],v[112:115],v[84:87],a[212:215]
 v_mfma_f32_16x16x32_bf16 a[216:219],v[116:119],v[64:67],a[216:219]
 v_mfma_f32_16x16x32_bf16 a[220:223],v[116:119],v[68:71],a[220:223]
 ds_read_b64_tr_b16 v[132:133],v221 offset:0
 s_add_u32 m0,s92,50176
 s_add_u32 s34,s56,3096576
 buffer_load_dwordx4 v15,s[44:47],s34 offen lds
 v_mfma_f32_16x16x32_bf16 a[224:227],v[116:119],v[72:75],a[224:227]
 ds_read_b64_tr_b16 v[134:135],v221 offset:6144
 v_mfma_f32_16x16x32_bf16 a[228:231],v[116:119],v[76:79],a[228:231]
 v_mfma_f32_16x16x32_bf16 a[232:235],v[116:119],v[80:83],a[232:235]
 s_add_u32 m0,s92,51200
 s_add_u32 s34,s56,3096576
 buffer_load_dwordx4 v16,s[44:47],s34 offen lds
 v_mfma_f32_16x16x32_bf16 a[236:239],v[116:119],v[84:87],a[236:239]
 v_mfma_f32_16x16x32_bf16 a[240:243],v[120:123],v[64:67],a[240:243]
 v_mfma_f32_16x16x32_bf16 a[244:247],v[120:123],v[68:71],a[244:247]
 ds_read_b64_tr_b16 v[136:137],v222 offset:0
 s_add_u32 m0,s92,52224
 s_add_u32 s34,s56,3105792
 buffer_load_dwordx4 v14,s[44:47],s34 offen lds
 v_mfma_f32_16x16x32_bf16 a[248:251],v[120:123],v[72:75],a[248:251]
 ds_read_b64_tr_b16 v[138:139],v222 offset:6144
 v_mfma_f32_16x16x32_bf16 a[252:255],v[120:123],v[76:79],a[252:255]
 v_mfma_f32_16x16x32_bf16 v[224:227],v[120:123],v[80:83],v[224:227]
 s_add_u32 m0,s92,53248
 s_add_u32 s34,s56,3105792
 buffer_load_dwordx4 v15,s[44:47],s34 offen lds
 v_mfma_f32_16x16x32_bf16 v[228:231],v[120:123],v[84:87],v[228:231]
 v_mfma_f32_16x16x32_bf16 v[232:235],v[124:127],v[64:67],v[232:235]
 v_mfma_f32_16x16x32_bf16 v[236:239],v[124:127],v[68:71],v[236:239]
 ds_read_b64_tr_b16 v[140:141],v223 offset:0
 s_add_u32 m0,s92,54272
 s_add_u32 s34,s56,3105792
 buffer_load_dwordx4 v16,s[44:47],s34 offen lds
 v_mfma_f32_16x16x32_bf16 v[240:243],v[124:127],v[72:75],v[240:243]
 ds_read_b64_tr_b16 v[142:143],v223 offset:6144
 v_mfma_f32_16x16x32_bf16 v[244:247],v[124:127],v[76:79],v[244:247]
 v_mfma_f32_16x16x32_bf16 v[248:251],v[124:127],v[80:83],v[248:251]
 s_add_u32 m0,s92,55296
 s_add_u32 s34,s56,3115008
 buffer_load_dwordx4 v14,s[44:47],s34 offen lds
 v_mfma_f32_16x16x32_bf16 v[252:255],v[124:127],v[84:87],v[252:255]
 s_waitcnt lgkmcnt(6)
 s_waitcnt vmcnt(25)
 v_mfma_f32_16x16x32_bf16 a[0:3],v[128:131],v[88:91],a[0:3]
 v_mfma_f32_16x16x32_bf16 a[4:7],v[128:131],v[92:95],a[4:7]
 ds_read_b64_tr_b16 v[112:113],v220 offset:128
 s_add_u32 m0,s92,56320
 s_add_u32 s34,s56,3115008
 buffer_load_dwordx4 v15,s[44:47],s34 offen lds
 v_mfma_f32_16x16x32_bf16 a[8:11],v[128:131],v[96:99],a[8:11]
 ds_read_b64_tr_b16 v[114:115],v220 offset:6272
 v_mfma_f32_16x16x32_bf16 a[12:15],v[128:131],v[100:103],a[12:15]
 v_mfma_f32_16x16x32_bf16 a[16:19],v[128:131],v[104:107],a[16:19]
 s_add_u32 m0,s92,57344
 s_add_u32 s34,s56,3115008
 buffer_load_dwordx4 v16,s[44:47],s34 offen lds
 v_mfma_f32_16x16x32_bf16 a[20:23],v[128:131],v[108:111],a[20:23]
 s_waitcnt lgkmcnt(6)
 v_mfma_f32_16x16x32_bf16 a[24:27],v[132:135],v[88:91],a[24:27]
 v_mfma_f32_16x16x32_bf16 a[28:31],v[132:135],v[92:95],a[28:31]
 ds_read_b64_tr_b16 v[116:117],v221 offset:128
 s_add_u32 m0,s92,58368
 s_add_u32 s34,s56,3124224
 buffer_load_dwordx4 v14,s[44:47],s34 offen lds
 v_mfma_f32_16x16x32_bf16 a[32:35],v[132:135],v[96:99],a[32:35]
 ds_read_b64_tr_b16 v[118:119],v221 offset:6272
 v_mfma_f32_16x16x32_bf16 a[36:39],v[132:135],v[100:103],a[36:39]
 v_mfma_f32_16x16x32_bf16 a[40:43],v[132:135],v[104:107],a[40:43]
 s_add_u32 m0,s92,59392
 s_add_u32 s34,s56,3124224
 buffer_load_dwordx4 v15,s[44:47],s34 offen lds
 v_mfma_f32_16x16x32_bf16 a[44:47],v[132:135],v[108:111],a[44:47]
 s_waitcnt lgkmcnt(6)
 v_mfma_f32_16x16x32_bf16 a[48:51],v[136:139],v[88:91],a[48:51]
 v_mfma_f32_16x16x32_bf16 a[52:55],v[136:139],v[92:95],a[52:55]
 ds_read_b64_tr_b16 v[120:121],v222 offset:128
 s_add_u32 m0,s92,60416
 s_add_u32 s34,s56,3124224
 buffer_load_dwordx4 v16,s[44:47],s34 offen lds
 v_mfma_f32_16x16x32_bf16 a[56:59],v[136:139],v[96:99],a[56:59]
 ds_read_b64_tr_b16 v[122:123],v222 offset:6272
 v_mfma_f32_16x16x32_bf16 a[60:63],v[136:139],v[100:103],a[60:63]
 v_mfma_f32_16x16x32_bf16 a[64:67],v[136:139],v[104:107],a[64:67]
 s_add_u32 s35,s57,86016
 buffer_load_dwordx4 v[64:67],v2,s[48:51],s35 offen sc0 sc1
 v_mfma_f32_16x16x32_bf16 a[68:71],v[136:139],v[108:111],a[68:71]
 s_waitcnt lgkmcnt(6)
 v_mfma_f32_16x16x32_bf16 a[72:75],v[140:143],v[88:91],a[72:75]
 v_mfma_f32_16x16x32_bf16 a[76:79],v[140:143],v[92:95],a[76:79]
 ds_read_b64_tr_b16 v[124:125],v223 offset:128
 s_add_u32 s35,s57,217088
 buffer_load_dwordx4 v[68:71],v2,s[48:51],s35 offen sc0 sc1
 v_mfma_f32_16x16x32_bf16 a[80:83],v[140:143],v[96:99],a[80:83]
 ds_read_b64_tr_b16 v[126:127],v223 offset:6272
 v_mfma_f32_16x16x32_bf16 a[84:87],v[140:143],v[100:103],a[84:87]
 v_mfma_f32_16x16x32_bf16 a[88:91],v[140:143],v[104:107],a[88:91]
 s_add_u32 s35,s57,348160
 buffer_load_dwordx4 v[72:75],v2,s[48:51],s35 offen sc0 sc1
 v_mfma_f32_16x16x32_bf16 a[92:95],v[140:143],v[108:111],a[92:95]
 s_waitcnt lgkmcnt(6)
 v_mfma_f32_16x16x32_bf16 a[96:99],v[112:115],v[88:91],a[96:99]
 v_mfma_f32_16x16x32_bf16 a[100:103],v[112:115],v[92:95],a[100:103]
 ds_read_b64_tr_b16 v[128:129],v220 offset:256
 s_add_u32 s35,s57,479232
 buffer_load_dwordx4 v[76:79],v2,s[48:51],s35 offen sc0 sc1
 v_mfma_f32_16x16x32_bf16 a[104:107],v[112:115],v[96:99],a[104:107]
 ds_read_b64_tr_b16 v[130:131],v220 offset:6400
 v_mfma_f32_16x16x32_bf16 a[108:111],v[112:115],v[100:103],a[108:111]
 v_mfma_f32_16x16x32_bf16 a[112:115],v[112:115],v[104:107],a[112:115]
 s_add_u32 s35,s57,610304
 buffer_load_dwordx4 v[80:83],v2,s[48:51],s35 offen sc0 sc1
 v_mfma_f32_16x16x32_bf16 a[116:119],v[112:115],v[108:111],a[116:119]
 s_waitcnt lgkmcnt(6)
 v_mfma_f32_16x16x32_bf16 a[120:123],v[116:119],v[88:91],a[120:123]
 v_mfma_f32_16x16x32_bf16 a[124:127],v[116:119],v[92:95],a[124:127]
 ds_read_b64_tr_b16 v[132:133],v221 offset:256
 s_add_u32 s35,s57,741376
 buffer_load_dwordx4 v[84:87],v2,s[48:51],s35 offen sc0 sc1
 v_mfma_f32_16x16x32_bf16 a[128:131],v[116:119],v[96:99],a[128:131]
 ds_read_b64_tr_b16 v[134:135],v221 offset:6400
 v_mfma_f32_16x16x32_bf16 a[132:135],v[116:119],v[100:103],a[132:135]
 v_mfma_f32_16x16x32_bf16 a[136:139],v[116:119],v[104:107],a[136:139]
 v_mfma_f32_16x16x32_bf16 a[140:143],v[116:119],v[108:111],a[140:143]
 s_waitcnt lgkmcnt(6)
 v_mfma_f32_16x16x32_bf16 a[144:147],v[120:123],v[88:91],a[144:147]
 v_mfma_f32_16x16x32_bf16 a[148:151],v[120:123],v[92:95],a[148:151]
 ds_read_b64_tr_b16 v[136:137],v222 offset:256
 v_mfma_f32_16x16x32_bf16 a[152:155],v[120:123],v[96:99],a[152:155]
 ds_read_b64_tr_b16 v[138:139],v222 offset:6400
 v_mfma_f32_16x16x32_bf16 a[156:159],v[120:123],v[100:103],a[156:159]
 v_mfma_f32_16x16x32_bf16 a[160:163],v[120:123],v[104:107],a[160:163]
 v_mfma_f32_16x16x32_bf16 a[164:167],v[120:123],v[108:111],a[164:167]
 s_waitcnt lgkmcnt(6)
 v_mfma_f32_16x16x32_bf16 a[168:171],v[124:127],v[88:91],a[168:171]
 v_mfma_f32_16x16x32_bf16 a[172:175],v[124:127],v[92:95],a[172:175]
 ds_read_b64_tr_b16 v[140:141],v223 offset:256
 v_mfma_f32_16x16x32_bf16 a[176:179],v[124:127],v[96:99],a[176:179]
 ds_read_b64_tr_b16 v[142:143],v223 offset:6400
 v_mfma_f32_16x16x32_bf16 a[180:183],v[124:127],v[100:103],a[180:183]
 v_mfma_f32_16x16x32_bf16 a[184:187],v[124:127],v[104:107],a[184:187]
 v_mfma_f32_16x16x32_bf16 a[188:191],v[124:127],v[108:111],a[188:191]
 s_waitcnt lgkmcnt(6)
 v_mfma_f32_16x16x32_bf16 a[192:195],v[128:131],v[88:91],a[192:195]
 v_mfma_f32_16x16x32_bf16 a[196:199],v[128:131],v[92:95],a[196:199]
 s_waitcnt vmcnt(24)
 ds_read_b64_tr_b16 v[112:113],v18 offset:0
 v_mfma_f32_16x16x32_bf16 a[200:203],v[128:131],v[96:99],a[200:203]
 ds_read_b64_tr_b16 v[114:115],v18 offset:6144
 v_mfma_f32_16x16x32_bf16 a[204:207],v[128:131],v[100:103],a[204:207]
 v_mfma_f32_16x16x32_bf16 a[208:211],v[128:131],v[104:107],a[208:211]
 s_waitcnt lgkmcnt(2)
 s_add_u32 m0,s92,98304
 s_add_u32 s34,s56,3686400
 buffer_load_dwordx4 v14,s[44:47],s34 offen lds
 v_mfma_f32_16x16x32_bf16 a[212:215],v[128:131],v[108:111],a[212:215]
 v_mfma_f32_16x16x32_bf16 a[216:219],v[132:135],v[88:91],a[216:219]
 v_mfma_f32_16x16x32_bf16 a[220:223],v[132:135],v[92:95],a[220:223]
 ds_read_b64_tr_b16 v[116:117],v19 offset:0
 s_add_u32 m0,s92,99328
 s_add_u32 s34,s56,3686400
 buffer_load_dwordx4 v15,s[44:47],s34 offen lds
 v_mfma_f32_16x16x32_bf16 a[224:227],v[132:135],v[96:99],a[224:227]
 ds_read_b64_tr_b16 v[118:119],v19 offset:6144
 v_mfma_f32_16x16x32_bf16 a[228:231],v[132:135],v[100:103],a[228:231]
 v_mfma_f32_16x16x32_bf16 a[232:235],v[132:135],v[104:107],a[232:235]
 s_add_u32 m0,s92,100352
 s_add_u32 s34,s56,3686400
 buffer_load_dwordx4 v16,s[44:47],s34 offen lds
 v_mfma_f32_16x16x32_bf16 a[236:239],v[132:135],v[108:111],a[236:239]
 v_mfma_f32_16x16x32_bf16 a[240:243],v[136:139],v[88:91],a[240:243]
 v_mfma_f32_16x16x32_bf16 a[244:247],v[136:139],v[92:95],a[244:247]
 ds_read_b64_tr_b16 v[120:121],v20 offset:0
 s_add_u32 m0,s92,101376
 s_add_u32 s34,s56,3695616
 buffer_load_dwordx4 v14,s[44:47],s34 offen lds
 v_mfma_f32_16x16x32_bf16 a[248:251],v[136:139],v[96:99],a[248:251]
 ds_read_b64_tr_b16 v[122:123],v20 offset:6144
 v_mfma_f32_16x16x32_bf16 a[252:255],v[136:139],v[100:103],a[252:255]
 v_mfma_f32_16x16x32_bf16 v[224:227],v[136:139],v[104:107],v[224:227]
 s_add_u32 m0,s92,102400
 s_add_u32 s34,s56,3695616
 buffer_load_dwordx4 v15,s[44:47],s34 offen lds
 v_mfma_f32_16x16x32_bf16 v[228:231],v[136:139],v[108:111],v[228:231]
 v_mfma_f32_16x16x32_bf16 v[232:235],v[140:143],v[88:91],v[232:235]
 v_mfma_f32_16x16x32_bf16 v[236:239],v[140:143],v[92:95],v[236:239]
 ds_read_b64_tr_b16 v[124:125],v21 offset:0
 s_add_u32 m0,s92,103424
 s_add_u32 s34,s56,3695616
 buffer_load_dwordx4 v16,s[44:47],s34 offen lds
 v_mfma_f32_16x16x32_bf16 v[240:243],v[140:143],v[96:99],v[240:243]
 ds_read_b64_tr_b16 v[126:127],v21 offset:6144
 v_mfma_f32_16x16x32_bf16 v[244:247],v[140:143],v[100:103],v[244:247]
 v_mfma_f32_16x16x32_bf16 v[248:251],v[140:143],v[104:107],v[248:251]
 s_add_u32 m0,s92,104448
 s_add_u32 s34,s56,3704832
 buffer_load_dwordx4 v14,s[44:47],s34 offen lds
 v_mfma_f32_16x16x32_bf16 v[252:255],v[140:143],v[108:111],v[252:255]
 s_waitcnt lgkmcnt(6)
 s_waitcnt vmcnt(25)
 v_mfma_f32_16x16x32_bf16 a[0:3],v[112:115],v[40:43],a[0:3]
 v_mfma_f32_16x16x32_bf16 a[4:7],v[112:115],v[44:47],a[4:7]
 ds_read_b64_tr_b16 v[128:129],v18 offset:128
 s_add_u32 m0,s92,105472
 s_add_u32 s34,s56,3704832
 buffer_load_dwordx4 v15,s[44:47],s34 offen lds
 v_mfma_f32_16x16x32_bf16 a[8:11],v[112:115],v[48:51],a[8:11]
 ds_read_b64_tr_b16 v[130:131],v18 offset:6272
 v_mfma_f32_16x16x32_bf16 a[12:15],v[112:115],v[52:55],a[12:15]
 v_mfma_f32_16x16x32_bf16 a[16:19],v[112:115],v[56:59],a[16:19]
 s_add_u32 m0,s92,106496
 s_add_u32 s34,s56,3704832
 buffer_load_dwordx4 v16,s[44:47],s34 offen lds
 v_mfma_f32_16x16x32_bf16 a[20:23],v[112:115],v[60:63],a[20:23]
 s_waitcnt lgkmcnt(6)
 v_mfma_f32_16x16x32_bf16 a[24:27],v[116:119],v[40:43],a[24:27]
 v_mfma_f32_16x16x32_bf16 a[28:31],v[116:119],v[44:47],a[28:31]
 ds_read_b64_tr_b16 v[132:133],v19 offset:128
 s_add_u32 m0,s92,107520
 s_add_u32 s34,s56,3714048
 buffer_load_dwordx4 v14,s[44:47],s34 offen lds
 v_mfma_f32_16x16x32_bf16 a[32:35],v[116:119],v[48:51],a[32:35]
 ds_read_b64_tr_b16 v[134:135],v19 offset:6272
 v_mfma_f32_16x16x32_bf16 a[36:39],v[116:119],v[52:55],a[36:39]
 v_mfma_f32_16x16x32_bf16 a[40:43],v[116:119],v[56:59],a[40:43]
 s_add_u32 m0,s92,108544
 s_add_u32 s34,s56,3714048
 buffer_load_dwordx4 v15,s[44:47],s34 offen lds
 v_mfma_f32_16x16x32_bf16 a[44:47],v[116:119],v[60:63],a[44:47]
 s_waitcnt lgkmcnt(6)
 v_mfma_f32_16x16x32_bf16 a[48:51],v[120:123],v[40:43],a[48:51]
 v_mfma_f32_16x16x32_bf16 a[52:55],v[120:123],v[44:47],a[52:55]
 ds_read_b64_tr_b16 v[136:137],v20 offset:128
 s_add_u32 m0,s92,109568
 s_add_u32 s34,s56,3714048
 buffer_load_dwordx4 v16,s[44:47],s34 offen lds
 v_mfma_f32_16x16x32_bf16 a[56:59],v[120:123],v[48:51],a[56:59]
 ds_read_b64_tr_b16 v[138:139],v20 offset:6272
 v_mfma_f32_16x16x32_bf16 a[60:63],v[120:123],v[52:55],a[60:63]
 v_mfma_f32_16x16x32_bf16 a[64:67],v[120:123],v[56:59],a[64:67]
 s_add_u32 s35,s57,102400
 buffer_load_dwordx4 v[88:91],v2,s[48:51],s35 offen sc0 sc1
 v_mfma_f32_16x16x32_bf16 a[68:71],v[120:123],v[60:63],a[68:71]
 s_waitcnt lgkmcnt(6)
 v_mfma_f32_16x16x32_bf16 a[72:75],v[124:127],v[40:43],a[72:75]
 v_mfma_f32_16x16x32_bf16 a[76:79],v[124:127],v[44:47],a[76:79]
 ds_read_b64_tr_b16 v[140:141],v21 offset:128
 s_add_u32 s35,s57,233472
 buffer_load_dwordx4 v[92:95],v2,s[48:51],s35 offen sc0 sc1
 v_mfma_f32_16x16x32_bf16 a[80:83],v[124:127],v[48:51],a[80:83]
 ds_read_b64_tr_b16 v[142:143],v21 offset:6272
 v_mfma_f32_16x16x32_bf16 a[84:87],v[124:127],v[52:55],a[84:87]
 v_mfma_f32_16x16x32_bf16 a[88:91],v[124:127],v[56:59],a[88:91]
 s_add_u32 s35,s57,364544
 buffer_load_dwordx4 v[96:99],v2,s[48:51],s35 offen sc0 sc1
 v_mfma_f32_16x16x32_bf16 a[92:95],v[124:127],v[60:63],a[92:95]
 s_waitcnt lgkmcnt(6)
 v_mfma_f32_16x16x32_bf16 a[96:99],v[128:131],v[40:43],a[96:99]
 v_mfma_f32_16x16x32_bf16 a[100:103],v[128:131],v[44:47],a[100:103]
 ds_read_b64_tr_b16 v[112:113],v18 offset:256
 s_add_u32 s35,s57,495616
 buffer_load_dwordx4 v[100:103],v2,s[48:51],s35 offen sc0 sc1
 v_mfma_f32_16x16x32_bf16 a[104:107],v[128:131],v[48:51],a[104:107]
 ds_read_b64_tr_b16 v[114:115],v18 offset:6400
 v_mfma_f32_16x16x32_bf16 a[108:111],v[128:131],v[52:55],a[108:111]
 v_mfma_f32_16x16x32_bf16 a[112:115],v[128:131],v[56:59],a[112:115]
 s_add_u32 s35,s57,626688
 buffer_load_dwordx4 v[104:107],v2,s[48:51],s35 offen sc0 sc1
 v_mfma_f32_16x16x32_bf16 a[116:119],v[128:131],v[60:63],a[116:119]
 s_waitcnt lgkmcnt(6)
 v_mfma_f32_16x16x32_bf16 a[120:123],v[132:135],v[40:43],a[120:123]
 v_mfma_f32_16x16x32_bf16 a[124:127],v[132:135],v[44:47],a[124:127]
 ds_read_b64_tr_b16 v[116:117],v19 offset:256
 s_add_u32 s35,s57,757760
 buffer_load_dwordx4 v[108:111],v2,s[48:51],s35 offen sc0 sc1
 v_mfma_f32_16x16x32_bf16 a[128:131],v[132:135],v[48:51],a[128:131]
 ds_read_b64_tr_b16 v[118:119],v19 offset:6400
 v_mfma_f32_16x16x32_bf16 a[132:135],v[132:135],v[52:55],a[132:135]
 v_mfma_f32_16x16x32_bf16 a[136:139],v[132:135],v[56:59],a[136:139]
 v_mfma_f32_16x16x32_bf16 a[140:143],v[132:135],v[60:63],a[140:143]
 s_waitcnt lgkmcnt(6)
 v_mfma_f32_16x16x32_bf16 a[144:147],v[136:139],v[40:43],a[144:147]
 v_mfma_f32_16x16x32_bf16 a[148:151],v[136:139],v[44:47],a[148:151]
 ds_read_b64_tr_b16 v[120:121],v20 offset:256
 v_mfma_f32_16x16x32_bf16 a[152:155],v[136:139],v[48:51],a[152:155]
 ds_read_b64_tr_b16 v[122:123],v20 offset:6400
 v_mfma_f32_16x16x32_bf16 a[156:159],v[136:139],v[52:55],a[156:159]
 v_mfma_f32_16x16x32_bf16 a[160:163],v[136:139],v[56:59],a[160:163]
 v_mfma_f32_16x16x32_bf16 a[164:167],v[136:139],v[60:63],a[164:167]
 s_waitcnt lgkmcnt(6)
 v_mfma_f32_16x16x32_bf16 a[168:171],v[140:143],v[40:43],a[168:171]
 v_mfma_f32_16x16x32_bf16 a[172:175],v[140:143],v[44:47],a[172:175]
 ds_read_b64_tr_b16 v[124:125],v21 offset:256
 v_mfma_f32_16x16x32_bf16 a[176:179],v[140:143],v[48:51],a[176:179]
 ds_read_b64_tr_b16 v[126:127],v21 offset:6400
 v_mfma_f32_16x16x32_bf16 a[180:183],v[140:143],v[52:55],a[180:183]
 v_mfma_f32_16x16x32_bf16 a[184:187],v[140:143],v[56:59],a[184:187]
 v_mfma_f32_16x16x32_bf16 a[188:191],v[140:143],v[60:63],a[188:191]
 s_waitcnt lgkmcnt(6)
 v_mfma_f32_16x16x32_bf16 a[192:195],v[112:115],v[40:43],a[192:195]
 v_mfma_f32_16x16x32_bf16 a[196:199],v[112:115],v[44:47],a[196:199]
 s_waitcnt vmcnt(24)
 ds_read_b64_tr_b16 v[128:129],v18 offset:49152
 v_mfma_f32_16x16x32_bf16 a[200:203],v[112:115],v[48:51],a[200:203]
 ds_read_b64_tr_b16 v[130:131],v18 offset:55296
 v_mfma_f32_16x16x32_bf16 a[204:207],v[112:115],v[52:55],a[204:207]
 v_mfma_f32_16x16x32_bf16 a[208:211],v[112:115],v[56:59],a[208:211]
 s_waitcnt lgkmcnt(2)
 s_add_u32 m0,s92,0
 s_add_u32 s34,s56,4276224
 buffer_load_dwordx4 v14,s[44:47],s34 offen lds
 v_mfma_f32_16x16x32_bf16 a[212:215],v[112:115],v[60:63],a[212:215]
 v_mfma_f32_16x16x32_bf16 a[216:219],v[116:119],v[40:43],a[216:219]
 v_mfma_f32_16x16x32_bf16 a[220:223],v[116:119],v[44:47],a[220:223]
 ds_read_b64_tr_b16 v[132:133],v19 offset:49152
 s_add_u32 m0,s92,1024
 s_add_u32 s34,s56,4276224
 buffer_load_dwordx4 v15,s[44:47],s34 offen lds
 v_mfma_f32_16x16x32_bf16 a[224:227],v[116:119],v[48:51],a[224:227]
 ds_read_b64_tr_b16 v[134:135],v19 offset:55296
 v_mfma_f32_16x16x32_bf16 a[228:231],v[116:119],v[52:55],a[228:231]
 v_mfma_f32_16x16x32_bf16 a[232:235],v[116:119],v[56:59],a[232:235]
 s_add_u32 m0,s92,2048
 s_add_u32 s34,s56,4276224
 buffer_load_dwordx4 v16,s[44:47],s34 offen lds
 v_mfma_f32_16x16x32_bf16 a[236:239],v[116:119],v[60:63],a[236:239]
 v_mfma_f32_16x16x32_bf16 a[240:243],v[120:123],v[40:43],a[240:243]
 v_mfma_f32_16x16x32_bf16 a[244:247],v[120:123],v[44:47],a[244:247]
 ds_read_b64_tr_b16 v[136:137],v20 offset:49152
 s_add_u32 m0,s92,3072
 s_add_u32 s34,s56,4285440
 buffer_load_dwordx4 v14,s[44:47],s34 offen lds
 v_mfma_f32_16x16x32_bf16 a[248:251],v[120:123],v[48:51],a[248:251]
 ds_read_b64_tr_b16 v[138:139],v20 offset:55296
 v_mfma_f32_16x16x32_bf16 a[252:255],v[120:123],v[52:55],a[252:255]
 v_mfma_f32_16x16x32_bf16 v[224:227],v[120:123],v[56:59],v[224:227]
 s_add_u32 m0,s92,4096
 s_add_u32 s34,s56,4285440
 buffer_load_dwordx4 v15,s[44:47],s34 offen lds
 v_mfma_f32_16x16x32_bf16 v[228:231],v[120:123],v[60:63],v[228:231]
 v_mfma_f32_16x16x32_bf16 v[232:235],v[124:127],v[40:43],v[232:235]
 v_mfma_f32_16x16x32_bf16 v[236:239],v[124:127],v[44:47],v[236:239]
 ds_read_b64_tr_b16 v[140:141],v21 offset:49152
 s_add_u32 m0,s92,5120
 s_add_u32 s34,s56,4285440
 buffer_load_dwordx4 v16,s[44:47],s34 offen lds
 v_mfma_f32_16x16x32_bf16 v[240:243],v[124:127],v[48:51],v[240:243]
 ds_read_b64_tr_b16 v[142:143],v21 offset:55296
 v_mfma_f32_16x16x32_bf16 v[244:247],v[124:127],v[52:55],v[244:247]
 v_mfma_f32_16x16x32_bf16 v[248:251],v[124:127],v[56:59],v[248:251]
 s_add_u32 m0,s92,6144
 s_add_u32 s34,s56,4294656
 buffer_load_dwordx4 v14,s[44:47],s34 offen lds
 v_mfma_f32_16x16x32_bf16 v[252:255],v[124:127],v[60:63],v[252:255]
 s_waitcnt lgkmcnt(6)
 s_waitcnt vmcnt(25)
 v_mfma_f32_16x16x32_bf16 a[0:3],v[128:131],v[64:67],a[0:3]
 v_mfma_f32_16x16x32_bf16 a[4:7],v[128:131],v[68:71],a[4:7]
 ds_read_b64_tr_b16 v[112:113],v18 offset:49280
 s_add_u32 m0,s92,7168
 s_add_u32 s34,s56,4294656
 buffer_load_dwordx4 v15,s[44:47],s34 offen lds
 v_mfma_f32_16x16x32_bf16 a[8:11],v[128:131],v[72:75],a[8:11]
 ds_read_b64_tr_b16 v[114:115],v18 offset:55424
 v_mfma_f32_16x16x32_bf16 a[12:15],v[128:131],v[76:79],a[12:15]
 v_mfma_f32_16x16x32_bf16 a[16:19],v[128:131],v[80:83],a[16:19]
 s_add_u32 m0,s92,8192
 s_add_u32 s34,s56,4294656
 buffer_load_dwordx4 v16,s[44:47],s34 offen lds
 v_mfma_f32_16x16x32_bf16 a[20:23],v[128:131],v[84:87],a[20:23]
 s_waitcnt lgkmcnt(6)
 v_mfma_f32_16x16x32_bf16 a[24:27],v[132:135],v[64:67],a[24:27]
 v_mfma_f32_16x16x32_bf16 a[28:31],v[132:135],v[68:71],a[28:31]
 ds_read_b64_tr_b16 v[116:117],v19 offset:49280
 s_add_u32 m0,s92,9216
 s_add_u32 s34,s56,4303872
 buffer_load_dwordx4 v14,s[44:47],s34 offen lds
 v_mfma_f32_16x16x32_bf16 a[32:35],v[132:135],v[72:75],a[32:35]
 ds_read_b64_tr_b16 v[118:119],v19 offset:55424
 v_mfma_f32_16x16x32_bf16 a[36:39],v[132:135],v[76:79],a[36:39]
 v_mfma_f32_16x16x32_bf16 a[40:43],v[132:135],v[80:83],a[40:43]
 s_add_u32 m0,s92,10240
 s_add_u32 s34,s56,4303872
 buffer_load_dwordx4 v15,s[44:47],s34 offen lds
 v_mfma_f32_16x16x32_bf16 a[44:47],v[132:135],v[84:87],a[44:47]
 s_waitcnt lgkmcnt(6)
 v_mfma_f32_16x16x32_bf16 a[48:51],v[136:139],v[64:67],a[48:51]
 v_mfma_f32_16x16x32_bf16 a[52:55],v[136:139],v[68:71],a[52:55]
 s_waitcnt vmcnt(17)
 ds_read_b64_tr_b16 v[120:121],v220 offset:0
 s_add_u32 m0,s92,11264
 s_add_u32 s34,s56,4303872
 buffer_load_dwordx4 v16,s[44:47],s34 offen lds
 v_mfma_f32_16x16x32_bf16 a[56:59],v[136:139],v[72:75],a[56:59]
 ds_read_b64_tr_b16 v[122:123],v220 offset:6144
 v_mfma_f32_16x16x32_bf16 a[60:63],v[136:139],v[76:79],a[60:63]
 v_mfma_f32_16x16x32_bf16 a[64:67],v[136:139],v[80:83],a[64:67]
 s_add_u32 s35,s57,118784
 buffer_load_dwordx4 v[40:43],v2,s[48:51],s35 offen sc0 sc1
 v_mfma_f32_16x16x32_bf16 a[68:71],v[136:139],v[84:87],a[68:71]
 s_waitcnt lgkmcnt(6)
 v_mfma_f32_16x16x32_bf16 a[72:75],v[140:143],v[64:67],a[72:75]
 v_mfma_f32_16x16x32_bf16 a[76:79],v[140:143],v[68:71],a[76:79]
 ds_read_b64_tr_b16 v[124:125],v221 offset:0
 s_add_u32 s35,s57,249856
 buffer_load_dwordx4 v[44:47],v2,s[48:51],s35 offen sc0 sc1
 v_mfma_f32_16x16x32_bf16 a[80:83],v[140:143],v[72:75],a[80:83]
 ds_read_b64_tr_b16 v[126:127],v221 offset:6144
 v_mfma_f32_16x16x32_bf16 a[84:87],v[140:143],v[76:79],a[84:87]
 v_mfma_f32_16x16x32_bf16 a[88:91],v[140:143],v[80:83],a[88:91]
 s_add_u32 s35,s57,380928
 buffer_load_dwordx4 v[48:51],v2,s[48:51],s35 offen sc0 sc1
 v_mfma_f32_16x16x32_bf16 a[92:95],v[140:143],v[84:87],a[92:95]
 s_waitcnt lgkmcnt(6)
 v_mfma_f32_16x16x32_bf16 a[96:99],v[112:115],v[64:67],a[96:99]
 v_mfma_f32_16x16x32_bf16 a[100:103],v[112:115],v[68:71],a[100:103]
 ds_read_b64_tr_b16 v[128:129],v222 offset:0
 s_add_u32 s35,s57,512000
 buffer_load_dwordx4 v[52:55],v2,s[48:51],s35 offen sc0 sc1
 v_mfma_f32_16x16x32_bf16 a[104:107],v[112:115],v[72:75],a[104:107]
 ds_read_b64_tr_b16 v[130:131],v222 offset:6144
 v_mfma_f32_16x16x32_bf16 a[108:111],v[112:115],v[76:79],a[108:111]
 v_mfma_f32_16x16x32_bf16 a[112:115],v[112:115],v[80:83],a[112:115]
 s_add_u32 s35,s57,643072
 buffer_load_dwordx4 v[56:59],v2,s[48:51],s35 offen sc0 sc1
 v_mfma_f32_16x16x32_bf16 a[116:119],v[112:115],v[84:87],a[116:119]
 s_waitcnt lgkmcnt(6)
 v_mfma_f32_16x16x32_bf16 a[120:123],v[116:119],v[64:67],a[120:123]
 v_mfma_f32_16x16x32_bf16 a[124:127],v[116:119],v[68:71],a[124:127]
 ds_read_b64_tr_b16 v[132:133],v223 offset:0
 s_add_u32 s35,s57,774144
 buffer_load_dwordx4 v[60:63],v2,s[48:51],s35 offen sc0 sc1
 v_mfma_f32_16x16x32_bf16 a[128:131],v[116:119],v[72:75],a[128:131]
 ds_read_b64_tr_b16 v[134:135],v223 offset:6144
 v_mfma_f32_16x16x32_bf16 a[132:135],v[116:119],v[76:79],a[132:135]
 v_mfma_f32_16x16x32_bf16 a[136:139],v[116:119],v[80:83],a[136:139]
 v_mfma_f32_16x16x32_bf16 a[140:143],v[116:119],v[84:87],a[140:143]
 s_waitcnt lgkmcnt(6)
 s_waitcnt vmcnt(18)
 v_mfma_f32_16x16x32_bf16 a[0:3],v[120:123],v[88:91],a[0:3]
 v_mfma_f32_16x16x32_bf16 a[4:7],v[120:123],v[92:95],a[4:7]
 ds_read_b64_tr_b16 v[136:137],v220 offset:128
 v_mfma_f32_16x16x32_bf16 a[8:11],v[120:123],v[96:99],a[8:11]
 ds_read_b64_tr_b16 v[138:139],v220 offset:6272
 v_mfma_f32_16x16x32_bf16 a[12:15],v[120:123],v[100:103],a[12:15]
 v_mfma_f32_16x16x32_bf16 a[16:19],v[120:123],v[104:107],a[16:19]
 v_mfma_f32_16x16x32_bf16 a[20:23],v[120:123],v[108:111],a[20:23]
 s_waitcnt lgkmcnt(6)
 v_mfma_f32_16x16x32_bf16 a[24:27],v[124:127],v[88:91],a[24:27]
 v_mfma_f32_16x16x32_bf16 a[28:31],v[124:127],v[92:95],a[28:31]
 ds_read_b64_tr_b16 v[140:141],v221 offset:128
 v_mfma_f32_16x16x32_bf16 a[32:35],v[124:127],v[96:99],a[32:35]
 ds_read_b64_tr_b16 v[142:143],v221 offset:6272
 v_mfma_f32_16x16x32_bf16 a[36:39],v[124:127],v[100:103],a[36:39]
 v_mfma_f32_16x16x32_bf16 a[40:43],v[124:127],v[104:107],a[40:43]
 v_mfma_f32_16x16x32_bf16 a[44:47],v[124:127],v[108:111],a[44:47]
 s_waitcnt lgkmcnt(6)
 v_mfma_f32_16x16x32_bf16 a[48:51],v[128:131],v[88:91],a[48:51]
 v_mfma_f32_16x16x32_bf16 a[52:55],v[128:131],v[92:95],a[52:55]
 ds_read_b64_tr_b16 v[112:113],v20 offset:49280
 v_mfma_f32_16x16x32_bf16 a[56:59],v[128:131],v[96:99],a[56:59]
 ds_read_b64_tr_b16 v[114:115],v20 offset:55424
 v_mfma_f32_16x16x32_bf16 a[60:63],v[128:131],v[100:103],a[60:63]
 v_mfma_f32_16x16x32_bf16 a[64:67],v[128:131],v[104:107],a[64:67]
 v_mfma_f32_16x16x32_bf16 a[68:71],v[128:131],v[108:111],a[68:71]
 s_waitcnt lgkmcnt(6)
 v_mfma_f32_16x16x32_bf16 a[72:75],v[132:135],v[88:91],a[72:75]
 v_mfma_f32_16x16x32_bf16 a[76:79],v[132:135],v[92:95],a[76:79]
 ds_read_b64_tr_b16 v[116:117],v21 offset:49280
 v_mfma_f32_16x16x32_bf16 a[80:83],v[132:135],v[96:99],a[80:83]
 ds_read_b64_tr_b16 v[118:119],v21 offset:55424
 v_mfma_f32_16x16x32_bf16 a[84:87],v[132:135],v[100:103],a[84:87]
 v_mfma_f32_16x16x32_bf16 a[88:91],v[132:135],v[104:107],a[88:91]
 v_mfma_f32_16x16x32_bf16 a[92:95],v[132:135],v[108:111],a[92:95]
 s_waitcnt lgkmcnt(6)
 v_mfma_f32_16x16x32_bf16 a[96:99],v[136:139],v[88:91],a[96:99]
 v_mfma_f32_16x16x32_bf16 a[100:103],v[136:139],v[92:95],a[100:103]
 ds_read_b64_tr_b16 v[120:121],v18 offset:49408
 v_mfma_f32_16x16x32_bf16 a[104:107],v[136:139],v[96:99],a[104:107]
 ds_read_b64_tr_b16 v[122:123],v18 offset:55552
 v_mfma_f32_16x16x32_bf16 a[108:111],v[136:139],v[100:103],a[108:111]
 v_mfma_f32_16x16x32_bf16 a[112:115],v[136:139],v[104:107],a[112:115]
 v_mfma_f32_16x16x32_bf16 a[116:119],v[136:139],v[108:111],a[116:119]
 s_waitcnt lgkmcnt(6)
 v_mfma_f32_16x16x32_bf16 a[120:123],v[140:143],v[88:91],a[120:123]
 v_mfma_f32_16x16x32_bf16 a[124:127],v[140:143],v[92:95],a[124:127]
 ds_read_b64_tr_b16 v[124:125],v19 offset:49408
 v_mfma_f32_16x16x32_bf16 a[128:131],v[140:143],v[96:99],a[128:131]
 ds_read_b64_tr_b16 v[126:127],v19 offset:55552
 v_mfma_f32_16x16x32_bf16 a[132:135],v[140:143],v[100:103],a[132:135]
 v_mfma_f32_16x16x32_bf16 a[136:139],v[140:143],v[104:107],a[136:139]
 v_mfma_f32_16x16x32_bf16 a[140:143],v[140:143],v[108:111],a[140:143]
 s_waitcnt lgkmcnt(6)
 v_mfma_f32_16x16x32_bf16 a[144:147],v[112:115],v[64:67],a[144:147]
 v_mfma_f32_16x16x32_bf16 a[148:151],v[112:115],v[68:71],a[148:151]
 ds_read_b64_tr_b16 v[128:129],v20 offset:49408
 ds_read_b64_tr_b16 v[144:145],v222 offset:128
 v_mfma_f32_16x16x32_bf16 a[152:155],v[112:115],v[72:75],a[152:155]
 ds_read_b64_tr_b16 v[130:131],v20 offset:55552
 ds_read_b64_tr_b16 v[146:147],v222 offset:6272
 v_mfma_f32_16x16x32_bf16 a[156:159],v[112:115],v[76:79],a[156:159]
 v_mfma_f32_16x16x32_bf16 a[160:163],v[112:115],v[80:83],a[160:163]
 ds_read_b64_tr_b16 v[148:149],v223 offset:128
 v_mfma_f32_16x16x32_bf16 a[164:167],v[112:115],v[84:87],a[164:167]
 s_waitcnt lgkmcnt(9)
 ds_read_b64_tr_b16 v[150:151],v223 offset:6272
 v_mfma_f32_16x16x32_bf16 a[168:171],v[116:119],v[64:67],a[168:171]
 v_mfma_f32_16x16x32_bf16 a[172:175],v[116:119],v[68:71],a[172:175]
 ds_read_b64_tr_b16 v[132:133],v21 offset:49408
 ds_read_b64_tr_b16 v[152:153],v220 offset:256
 v_mfma_f32_16x16x32_bf16 a[176:179],v[116:119],v[72:75],a[176:179]
 ds_read_b64_tr_b16 v[134:135],v21 offset:55552
 ds_read_b64_tr_b16 v[154:155],v220 offset:6400
 v_mfma_f32_16x16x32_bf16 a[180:183],v[116:119],v[76:79],a[180:183]
 v_mfma_f32_16x16x32_bf16 a[184:187],v[116:119],v[80:83],a[184:187]
 ds_read_b64_tr_b16 v[156:157],v221 offset:256
 v_mfma_f32_16x16x32_bf16 a[188:191],v[116:119],v[84:87],a[188:191]
 s_waitcnt lgkmcnt(13)
 ds_read_b64_tr_b16 v[158:159],v221 offset:6400
 v_mfma_f32_16x16x32_bf16 a[192:195],v[120:123],v[64:67],a[192:195]
 v_mfma_f32_16x16x32_bf16 a[196:199],v[120:123],v[68:71],a[196:199]
 s_waitcnt vmcnt(6)
 ds_read_b64_tr_b16 v[136:137],v18 offset:0
 ds_read_b64_tr_b16 v[160:161],v222 offset:256
 v_mfma_f32_16x16x32_bf16 a[200:203],v[120:123],v[72:75],a[200:203]
 ds_read_b64_tr_b16 v[138:139],v18 offset:6144
 ds_read_b64_tr_b16 v[162:163],v222 offset:6400
 v_mfma_f32_16x16x32_bf16 a[204:207],v[120:123],v[76:79],a[204:207]
 v_mfma_f32_16x16x32_bf16 a[208:211],v[120:123],v[80:83],a[208:211]
 ds_read_b64_tr_b16 v[164:165],v223 offset:256
 v_mfma_f32_16x16x32_bf16 a[212:215],v[120:123],v[84:87],a[212:215]
 s_waitcnt lgkmcnt(15)
 ds_read_b64_tr_b16 v[166:167],v223 offset:6400
 v_mfma_f32_16x16x32_bf16 a[216:219],v[124:127],v[64:67],a[216:219]
 v_mfma_f32_16x16x32_bf16 a[220:223],v[124:127],v[68:71],a[220:223]
 ds_read_b64_tr_b16 v[140:141],v19 offset:0
 ds_read_b64_tr_b16 v[168:169],v20 offset:128
 v_mfma_f32_16x16x32_bf16 a[224:227],v[124:127],v[72:75],a[224:227]
 ds_read_b64_tr_b16 v[142:143],v19 offset:6144
 ds_read_b64_tr_b16 v[170:171],v20 offset:6272
 v_mfma_f32_16x16x32_bf16 a[228:231],v[124:127],v[76:79],a[228:231]
 v_mfma_f32_16x16x32_bf16 a[232:235],v[124:127],v[80:83],a[232:235]
 ds_read_b64_tr_b16 v[172:173],v21 offset:128
 v_mfma_f32_16x16x32_bf16 a[236:239],v[124:127],v[84:87],a[236:239]
 s_waitcnt lgkmcnt(15)
 ds_read_b64_tr_b16 v[174:175],v21 offset:6272
 v_mfma_f32_16x16x32_bf16 a[240:243],v[128:131],v[64:67],a[240:243]
 v_mfma_f32_16x16x32_bf16 a[244:247],v[128:131],v[68:71],a[244:247]
 ds_read_b64_tr_b16 v[112:113],v20 offset:0
 ds_read_b64_tr_b16 v[176:177],v18 offset:256
 v_mfma_f32_16x16x32_bf16 a[248:251],v[128:131],v[72:75],a[248:251]
 ds_read_b64_tr_b16 v[114:115],v20 offset:6144
 ds_read_b64_tr_b16 v[178:179],v18 offset:6400
 v_mfma_f32_16x16x32_bf16 a[252:255],v[128:131],v[76:79],a[252:255]
 v_mfma_f32_16x16x32_bf16 v[224:227],v[128:131],v[80:83],v[224:227]
 ds_read_b64_tr_b16 v[180:181],v19 offset:256
 v_mfma_f32_16x16x32_bf16 v[228:231],v[128:131],v[84:87],v[228:231]
 s_waitcnt lgkmcnt(15)
 ds_read_b64_tr_b16 v[182:183],v19 offset:6400
 v_mfma_f32_16x16x32_bf16 v[232:235],v[132:135],v[64:67],v[232:235]
 v_mfma_f32_16x16x32_bf16 v[236:239],v[132:135],v[68:71],v[236:239]
 ds_read_b64_tr_b16 v[116:117],v21 offset:0
 ds_read_b64_tr_b16 v[184:185],v20 offset:256
 v_mfma_f32_16x16x32_bf16 v[240:243],v[132:135],v[72:75],v[240:243]
 ds_read_b64_tr_b16 v[118:119],v21 offset:6144
 ds_read_b64_tr_b16 v[186:187],v20 offset:6400
 v_mfma_f32_16x16x32_bf16 v[244:247],v[132:135],v[76:79],v[244:247]
 v_mfma_f32_16x16x32_bf16 v[248:251],v[132:135],v[80:83],v[248:251]
 ds_read_b64_tr_b16 v[188:189],v21 offset:256
 v_mfma_f32_16x16x32_bf16 v[252:255],v[132:135],v[84:87],v[252:255]
 ds_read_b64_tr_b16 v[190:191],v21 offset:6400
 s_mul_i32 s68,s24,10240
 s_mul_i32 s69,s2,40960
 s_add_u32 s69,s69,s68
 s_add_u32 s69,s69,44040192
 s_add_u32 s4,s60,s69
 s_addc_u32 s5,s61,0
 s_mov_b32 s6,10240
 s_xor_b32 s69,s2,1
 s_mul_i32 s69,s69,40960
 s_add_u32 s69,s69,s68
 s_add_u32 s69,s69,44040192
 s_add_u32 s8,s60,s69
 s_addc_u32 s9,s61,0
 s_mov_b32 s10,10240
 v_add_u32 v3,s92,v2
 v_add_u32 v8,98304,v3
 v_and_b32 v4,15,v0
 v_lshrrev_b32 v5,4,v0
 v_mul_u32_u24 v4,2304,v4
 v_lshl_add_u32 v4,v5,3,v4
 s_cmp_lg_u32 s24,0
 s_cbranch_scc1 K2_r0
 s_waitcnt vmcnt(0)
 s_waitcnt lgkmcnt(15)
 v_mfma_f32_16x16x32_bf16 a[0:3],v[136:139],v[40:43],a[0:3]
 v_mfma_f32_16x16x32_bf16 a[4:7],v[136:139],v[44:47],a[4:7]
 ds_read_b64_tr_b16 v[120:121],v18 offset:128
 v_mfma_f32_16x16x32_bf16 a[8:11],v[136:139],v[48:51],a[8:11]
 ds_read_b64_tr_b16 v[122:123],v18 offset:6272
 v_add_u32 v5,12288,v2
 v_add_u32 v9,110592,v2
 v_mfma_f32_16x16x32_bf16 a[12:15],v[136:139],v[52:55],a[12:15]
 v_add_u32 v6,24576,v2
 v_add_u32 v10,122880,v2
 v_mfma_f32_16x16x32_bf16 a[16:19],v[136:139],v[56:59],a[16:19]
 v_add_u32 v7,36864,v2
 v_add_u32 v11,135168,v2
 v_mfma_f32_16x16x32_bf16 a[20:23],v[136:139],v[60:63],a[20:23]
 s_waitcnt lgkmcnt(15)
 v_mfma_f32_16x16x32_bf16 a[24:27],v[140:143],v[40:43],a[24:27]
 v_mfma_f32_16x16x32_bf16 a[28:31],v[140:143],v[44:47],a[28:31]
 ds_read_b64_tr_b16 v[124:125],v19 offset:128
 v_mfma_f32_16x16x32_bf16 a[32:35],v[140:143],v[48:51],a[32:35]
 ds_read_b64_tr_b16 v[126:127],v19 offset:6272
 v_mfma_f32_16x16x32_bf16 a[36:39],v[140:143],v[52:55],a[36:39]
 v_mfma_f32_16x16x32_bf16 a[40:43],v[140:143],v[56:59],a[40:43]
 v_mfma_f32_16x16x32_bf16 a[44:47],v[140:143],v[60:63],a[44:47]
 s_waitcnt lgkmcnt(13)
 v_mfma_f32_16x16x32_bf16 a[48:51],v[112:115],v[40:43],a[48:51]
 v_mfma_f32_16x16x32_bf16 a[52:55],v[112:115],v[44:47],a[52:55]
 v_mfma_f32_16x16x32_bf16 a[56:59],v[112:115],v[48:51],a[56:59]
 s_waitcnt lgkmcnt(0)
 v_mfma_f32_16x16x32_bf16 a[60:63],v[112:115],v[52:55],a[60:63]
 ds_write_b128 v3,a[4:7] offset:1024
 ds_write_b128 v3,a[8:11] offset:2048
 v_mfma_f32_16x16x32_bf16 a[64:67],v[112:115],v[56:59],a[64:67]
 ds_write_b128 v3,a[12:15] offset:3072
 v_mfma_f32_16x16x32_bf16 a[68:71],v[112:115],v[60:63],a[68:71]
 ds_write_b128 v3,a[20:23] offset:5120
 ds_write_b128 v3,a[28:31] offset:7168
 v_mfma_f32_16x16x32_bf16 a[72:75],v[116:119],v[40:43],a[72:75]
 ds_write_b128 v3,a[32:35] offset:8192
 v_mfma_f32_16x16x32_bf16 a[76:79],v[116:119],v[44:47],a[76:79]
 ds_write_b128 v3,a[36:39] offset:9216
 v_mfma_f32_16x16x32_bf16 a[80:83],v[116:119],v[48:51],a[80:83]
 ds_write_b128 v3,a[44:47] offset:11264
 v_mfma_f32_16x16x32_bf16 a[84:87],v[116:119],v[52:55],a[84:87]
 ds_write_b128 v3,a[48:51] offset:49152
 v_mfma_f32_16x16x32_bf16 a[88:91],v[116:119],v[56:59],a[88:91]
 ds_write_b128 v3,a[52:55] offset:50176
 v_mfma_f32_16x16x32_bf16 a[92:95],v[116:119],v[60:63],a[92:95]
 v_mfma_f32_16x16x32_bf16 a[96:99],v[120:123],v[40:43],a[96:99]
 ds_write_b128 v3,a[60:63] offset:52224
 v_mfma_f32_16x16x32_bf16 a[100:103],v[120:123],v[44:47],a[100:103]
 ds_write_b128 v3,a[64:67] offset:53248
 v_mfma_f32_16x16x32_bf16 a[104:107],v[120:123],v[48:51],a[104:107]
 ds_write_b128 v3,a[68:71] offset:54272
 v_mfma_f32_16x16x32_bf16 a[108:111],v[120:123],v[52:55],a[108:111]
 ds_write_b128 v3,a[72:75] offset:55296
 v_mfma_f32_16x16x32_bf16 a[112:115],v[120:123],v[56:59],a[112:115]
 ds_write_b128 v3,a[76:79] offset:56320
 v_mfma_f32_16x16x32_bf16 a[116:119],v[120:123],v[60:63],a[116:119]
 v_mfma_f32_16x16x32_bf16 a[120:123],v[124:127],v[40:43],a[120:123]
 ds_write_b128 v3,a[84:87] offset:58368
 v_mfma_f32_16x16x32_bf16 a[124:127],v[124:127],v[44:47],a[124:127]
 ds_write_b128 v3,a[88:91] offset:59392
 v_mfma_f32_16x16x32_bf16 a[128:131],v[124:127],v[48:51],a[128:131]
 ds_write_b128 v3,a[92:95] offset:60416
 v_mfma_f32_16x16x32_bf16 a[132:135],v[124:127],v[52:55],a[132:135]
 v_mfma_f32_16x16x32_bf16 a[136:139],v[124:127],v[56:59],a[136:139]
 ds_write_b128 v8,a[100:103] offset:1024
 v_mfma_f32_16x16x32_bf16 a[140:143],v[124:127],v[60:63],a[140:143]
 ds_write_b128 v8,a[104:107] offset:2048
 v_mfma_f32_16x16x32_bf16 a[144:147],v[144:147],v[88:91],a[144:147]
 ds_write_b128 v8,a[108:111] offset:3072
 v_mfma_f32_16x16x32_bf16 a[148:151],v[144:147],v[92:95],a[148:151]
 v_mfma_f32_16x16x32_bf16 a[152:155],v[144:147],v[96:99],a[152:155]
 ds_write_b128 v8,a[116:119] offset:5120
 v_mfma_f32_16x16x32_bf16 a[156:159],v[144:147],v[100:103],a[156:159]
 v_mfma_f32_16x16x32_bf16 a[160:163],v[144:147],v[104:107],a[160:163]
 ds_write_b128 v8,a[124:127] offset:7168
 v_mfma_f32_16x16x32_bf16 a[164:167],v[144:147],v[108:111],a[164:167]
 ds_write_b128 v8,a[128:131] offset:8192
 v_mfma_f32_16x16x32_bf16 a[168:171],v[148:151],v[88:91],a[168:171]
 ds_write_b128 v8,a[132:135] offset:9216
 v_mfma_f32_16x16x32_bf16 a[172:175],v[148:151],v[92:95],a[172:175]
 ds_write_b128 v8,a[136:139] offset:10240
 v_mfma_f32_16x16x32_bf16 a[176:179],v[148:151],v[96:99],a[176:179]
 ds_write_b128 v8,a[140:143] offset:11264
 v_mfma_f32_16x16x32_bf16 a[180:183],v[148:151],v[100:103],a[180:183]
 v_mfma_f32_16x16x32_bf16 a[184:187],v[148:151],v[104:107],a[184:187]
 v_mfma_f32_16x16x32_bf16 a[188:191],v[148:151],v[108:111],a[188:191]
 v_mfma_f32_16x16x32_bf16 a[192:195],v[152:155],v[88:91],a[192:195]
 s_waitcnt lgkmcnt(0)
 s_barrier
 v_mfma_f32_16x16x32_bf16 a[196:199],v[152:155],v[92:95],a[196:199]
 ds_read_b128 v[68:71],v5 offset:0
 ds_read_b128 v[72:75],v6 offset:0
 ds_read_b128 v[76:79],v7 offset:0
 ds_read_b128 v[84:87],v5 offset:6144
 v_mfma_f32_16x16x32_bf16 a[200:203],v[152:155],v[96:99],a[200:203]
 ds_read_b128 v[192:195],v6 offset:6144
 ds_read_b128 v[196:199],v7 offset:6144
 ds_read_b128 v[28:31],v5 offset:4096
 ds_read_b128 v[32:35],v6 offset:4096
 v_mfma_f32_16x16x32_bf16 a[204:207],v[152:155],v[100:103],a[204:207]
 ds_read_b128 v[36:39],v7 offset:4096
 ds_read_b128 v[204:207],v5 offset:10240
 ds_read_b128 v[208:211],v6 offset:10240
 ds_read_b128 v[212:215],v7 offset:10240
 v_mfma_f32_16x16x32_bf16 a[208:211],v[152:155],v[104:107],a[208:211]
 ds_read_b128 v[112:115],v5 offset:51200
 ds_read_b128 v[116:119],v6 offset:51200
 ds_read_b128 v[120:123],v7 offset:51200
 ds_read_b128 v[128:131],v5 offset:57344
 v_mfma_f32_16x16x32_bf16 a[212:215],v[152:155],v[108:111],a[212:215]
 ds_read_b128 v[132:135],v6 offset:57344
 ds_read_b128 v[136:139],v7 offset:57344
 v_accvgpr_read_b32 v64,a0
 v_accvgpr_read_b32 v65,a1
 v_mfma_f32_16x16x32_bf16 a[216:219],v[156:159],v[88:91],a[216:219]
 v_accvgpr_read_b32 v66,a2
 v_accvgpr_read_b32 v67,a3
 s_waitcnt lgkmcnt(15)
 v_add_f32 v64,v64,v68
 v_add_f32 v65,v65,v69
 v_mfma_f32_16x16x32_bf16 a[220:223],v[156:159],v[92:95],a[220:223]
 v_add_f32 v66,v66,v70
 v_add_f32 v67,v67,v71
 s_waitcnt lgkmcnt(15)
 v_add_f32 v72,v72,v76
 v_add_f32 v73,v73,v77
 v_mfma_f32_16x16x32_bf16 a[224:227],v[156:159],v[96:99],a[224:227]
 v_add_f32 v74,v74,v78
 v_add_f32 v75,v75,v79
 v_add_f32 v64,v64,v72
 v_add_f32 v65,v65,v73
 v_mfma_f32_16x16x32_bf16 a[228:231],v[156:159],v[100:103],a[228:231]
 v_add_f32 v66,v66,v74
 v_add_f32 v67,v67,v75
 s_movk_i32 s34,0
 buffer_store_dwordx4 v[64:67],v2,s[8:11],s34 offen offset:0 sc0 sc1
 ds_read_b128 v[68:71],v9 offset:0
 v_mfma_f32_16x16x32_bf16 a[232:235],v[156:159],v[104:107],a[232:235]
 ds_read_b128 v[72:75],v10 offset:0
 ds_read_b128 v[76:79],v11 offset:0
 v_accvgpr_read_b32 v80,a24
 v_accvgpr_read_b32 v81,a25
 v_mfma_f32_16x16x32_bf16 a[236:239],v[156:159],v[108:111],a[236:239]
 v_accvgpr_read_b32 v82,a26
 v_accvgpr_read_b32 v83,a27
 s_waitcnt lgkmcnt(15)
 v_add_f32 v80,v80,v84
 v_add_f32 v81,v81,v85
 v_mfma_f32_16x16x32_bf16 a[240:243],v[160:163],v[88:91],a[240:243]
 v_add_f32 v82,v82,v86
 v_add_f32 v83,v83,v87
 s_waitcnt lgkmcnt(15)
 v_add_f32 v192,v192,v196
 v_add_f32 v193,v193,v197
 v_mfma_f32_16x16x32_bf16 a[244:247],v[160:163],v[92:95],a[244:247]
 v_add_f32 v194,v194,v198
 v_add_f32 v195,v195,v199
 v_add_f32 v80,v80,v192
 v_add_f32 v81,v81,v193
 v_mfma_f32_16x16x32_bf16 a[248:251],v[160:163],v[96:99],a[248:251]
 v_add_f32 v82,v82,v194
 v_add_f32 v83,v83,v195
 buffer_store_dwordx4 v[80:83],v2,s[8:11],s34 offen offset:1024 sc0 sc1
 ds_read_b128 v[84:87],v9 offset:6144
 v_mfma_f32_16x16x32_bf16 a[252:255],v[160:163],v[100:103],a[252:255]
 ds_read_b128 v[192:195],v10 offset:6144
 ds_read_b128 v[196:199],v11 offset:6144
 v_accvgpr_read_b32 v24,a16
 v_accvgpr_read_b32 v25,a17
 v_mfma_f32_16x16x32_bf16 v[224:227],v[160:163],v[104:107],v[224:227]
 v_accvgpr_read_b32 v26,a18
 v_accvgpr_read_b32 v27,a19
 s_waitcnt lgkmcnt(15)
 v_add_f32 v24,v24,v28
 v_add_f32 v25,v25,v29
 v_mfma_f32_16x16x32_bf16 v[228:231],v[160:163],v[108:111],v[228:231]
 v_add_f32 v26,v26,v30
 v_add_f32 v27,v27,v31
 s_waitcnt lgkmcnt(15)
 v_add_f32 v32,v32,v36
 v_add_f32 v33,v33,v37
 v_mfma_f32_16x16x32_bf16 v[232:235],v[164:167],v[88:91],v[232:235]
 v_add_f32 v34,v34,v38
 v_add_f32 v35,v35,v39
 v_add_f32 v24,v24,v32
 v_add_f32 v25,v25,v33
 v_mfma_f32_16x16x32_bf16 v[236:239],v[164:167],v[92:95],v[236:239]
 v_add_f32 v26,v26,v34
 v_add_f32 v27,v27,v35
 buffer_store_dwordx4 v[24:27],v2,s[8:11],s34 offen offset:2048 sc0 sc1
 ds_read_b128 v[28:31],v9 offset:4096
 v_mfma_f32_16x16x32_bf16 v[240:243],v[164:167],v[96:99],v[240:243]
 ds_read_b128 v[32:35],v10 offset:4096
 ds_read_b128 v[36:39],v11 offset:4096
 v_accvgpr_read_b32 v200,a40
 v_accvgpr_read_b32 v201,a41
 v_mfma_f32_16x16x32_bf16 v[244:247],v[164:167],v[100:103],v[244:247]
 v_accvgpr_read_b32 v202,a42
 v_accvgpr_read_b32 v203,a43
 s_waitcnt lgkmcnt(15)
 v_add_f32 v200,v200,v204
 v_add_f32 v201,v201,v205
 v_mfma_f32_16x16x32_bf16 v[248:251],v[164:167],v[104:107],v[248:251]
 v_add_f32 v202,v202,v206
 v_add_f32 v203,v203,v207
 s_waitcnt lgkmcnt(15)
 v_add_f32 v208,v208,v212
 v_add_f32 v209,v209,v213
 v_mfma_f32_16x16x32_bf16 v[252:255],v[164:167],v[108:111],v[252:255]
 v_add_f32 v210,v210,v214
 v_add_f32 v211,v211,v215
 v_add_f32 v200,v200,v208
 v_add_f32 v201,v201,v209
 v_mfma_f32_16x16x32_bf16 a[144:147],v[168:171],v[40:43],a[144:147]
 v_add_f32 v202,v202,v210
 v_add_f32 v203,v203,v211
 buffer_store_dwordx4 v[200:203],v2,s[8:11],s34 offen offset:3072 sc0 sc1
 v_accvgpr_read_b32 v216,a56
 v_mfma_f32_16x16x32_bf16 a[148:151],v[168:171],v[44:47],a[148:151]
 v_accvgpr_read_b32 v217,a57
 v_accvgpr_read_b32 v218,a58
 v_accvgpr_read_b32 v219,a59
 s_waitcnt lgkmcnt(14)
 v_add_f32 v216,v216,v112
 s_waitcnt lgkmcnt(0)
 s_barrier
 v_mfma_f32_16x16x32_bf16 a[152:155],v[168:171],v[48:51],a[152:155]
 v_add_f32 v217,v217,v113
 v_add_f32 v218,v218,v114
 v_add_f32 v219,v219,v115
 v_add_f32 v116,v116,v120
 v_mfma_f32_16x16x32_bf16 a[156:159],v[168:171],v[52:55],a[156:159]
 v_add_f32 v117,v117,v121
 v_add_f32 v118,v118,v122
 v_add_f32 v119,v119,v123
 v_add_f32 v216,v216,v116
 v_mfma_f32_16x16x32_bf16 a[160:163],v[168:171],v[56:59],a[160:163]
 v_add_f32 v217,v217,v117
 v_add_f32 v218,v218,v118
 v_add_f32 v219,v219,v119
 s_movk_i32 s34,4096
 buffer_store_dwordx4 v[216:219],v2,s[8:11],s34 offen offset:0 sc0 sc1
 v_mfma_f32_16x16x32_bf16 a[164:167],v[168:171],v[60:63],a[164:167]
 v_accvgpr_read_b32 v124,a80
 v_accvgpr_read_b32 v125,a81
 v_accvgpr_read_b32 v126,a82
 v_accvgpr_read_b32 v127,a83
 v_mfma_f32_16x16x32_bf16 a[168:171],v[172:175],v[40:43],a[168:171]
 v_add_f32 v124,v124,v128
 v_add_f32 v125,v125,v129
 v_add_f32 v126,v126,v130
 v_add_f32 v127,v127,v131
 v_mfma_f32_16x16x32_bf16 a[172:175],v[172:175],v[44:47],a[172:175]
 v_add_f32 v132,v132,v136
 v_add_f32 v133,v133,v137
 v_add_f32 v134,v134,v138
 v_add_f32 v135,v135,v139
 v_mfma_f32_16x16x32_bf16 a[176:179],v[172:175],v[48:51],a[176:179]
 v_add_f32 v124,v124,v132
 v_add_f32 v125,v125,v133
 v_add_f32 v126,v126,v134
 v_add_f32 v127,v127,v135
 v_mfma_f32_16x16x32_bf16 a[180:183],v[172:175],v[52:55],a[180:183]
 buffer_store_dwordx4 v[124:127],v2,s[8:11],s34 offen offset:1024 sc0 sc1
 v_accvgpr_read_b32 v64,a96
 v_accvgpr_read_b32 v65,a97
 v_accvgpr_read_b32 v66,a98
 v_mfma_f32_16x16x32_bf16 a[184:187],v[172:175],v[56:59],a[184:187]
 ds_write_b128 v3,a[148:151] offset:1024
 v_accvgpr_read_b32 v67,a99
 v_add_f32 v64,v64,v68
 v_add_f32 v65,v65,v69
 v_add_f32 v66,v66,v70
 v_mfma_f32_16x16x32_bf16 a[188:191],v[172:175],v[60:63],a[188:191]
 ds_write_b128 v3,a[152:155] offset:2048
 v_add_f32 v67,v67,v71
 v_add_f32 v72,v72,v76
 v_add_f32 v73,v73,v77
 v_add_f32 v74,v74,v78
 v_mfma_f32_16x16x32_bf16 a[192:195],v[176:179],v[40:43],a[192:195]
 buffer_load_dword v22,off,s[80:83],s87 sc0 sc1
 ds_write_b128 v3,a[156:159] offset:3072
 v_add_f32 v75,v75,v79
 v_add_f32 v64,v64,v72
 v_add_f32 v65,v65,v73
 v_add_f32 v66,v66,v74
 v_mfma_f32_16x16x32_bf16 a[196:199],v[176:179],v[44:47],a[196:199]
 v_add_f32 v67,v67,v75
 buffer_store_dwordx4 v[64:67],v2,s[8:11],s34 offen offset:2048 sc0 sc1
 v_accvgpr_read_b32 v80,a120
 v_accvgpr_read_b32 v81,a121
 v_mfma_f32_16x16x32_bf16 a[200:203],v[176:179],v[48:51],a[200:203]
 ds_write_b128 v3,a[164:167] offset:5120
 v_accvgpr_read_b32 v82,a122
 v_accvgpr_read_b32 v83,a123
 v_add_f32 v80,v80,v84
 v_add_f32 v81,v81,v85
 v_mfma_f32_16x16x32_bf16 a[204:207],v[176:179],v[52:55],a[204:207]
 v_add_f32 v82,v82,v86
 v_add_f32 v83,v83,v87
 v_add_f32 v192,v192,v196
 v_add_f32 v193,v193,v197
 v_mfma_f32_16x16x32_bf16 a[208:211],v[176:179],v[56:59],a[208:211]
 ds_write_b128 v3,a[172:175] offset:7168
 v_add_f32 v194,v194,v198
 v_add_f32 v195,v195,v199
 v_add_f32 v80,v80,v192
 v_add_f32 v81,v81,v193
 v_mfma_f32_16x16x32_bf16 a[212:215],v[176:179],v[60:63],a[212:215]
 ds_write_b128 v3,a[176:179] offset:8192
 v_add_f32 v82,v82,v194
 v_add_f32 v83,v83,v195
 buffer_store_dwordx4 v[80:83],v2,s[8:11],s34 offen offset:3072 sc0 sc1
 v_accvgpr_read_b32 v24,a112
 v_mfma_f32_16x16x32_bf16 a[216:219],v[180:183],v[40:43],a[216:219]
 ds_write_b128 v3,a[180:183] offset:9216
 v_accvgpr_read_b32 v25,a113
 v_accvgpr_read_b32 v26,a114
 v_accvgpr_read_b32 v27,a115
 v_add_f32 v24,v24,v28
 v_mfma_f32_16x16x32_bf16 a[220:223],v[180:183],v[44:47],a[220:223]
 v_add_f32 v25,v25,v29
 v_add_f32 v26,v26,v30
 v_add_f32 v27,v27,v31
 v_add_f32 v32,v32,v36
 v_mfma_f32_16x16x32_bf16 a[224:227],v[180:183],v[48:51],a[224:227]
 ds_write_b128 v3,a[188:191] offset:11264
 v_add_f32 v33,v33,v37
 v_add_f32 v34,v34,v38
 v_add_f32 v35,v35,v39
 v_add_f32 v24,v24,v32
 v_mfma_f32_16x16x32_bf16 a[228:231],v[180:183],v[52:55],a[228:231]
 ds_write_b128 v3,a[192:195] offset:49152
 v_add_f32 v25,v25,v33
 v_add_f32 v26,v26,v34
 v_add_f32 v27,v27,v35
 s_movk_i32 s34,8192
 buffer_store_dwordx4 v[24:27],v2,s[8:11],s34 offen offset:0 sc0 sc1
 v_mfma_f32_16x16x32_bf16 a[232:235],v[180:183],v[56:59],a[232:235]
 ds_write_b128 v3,a[196:199] offset:50176
 v_mfma_f32_16x16x32_bf16 a[236:239],v[180:183],v[60:63],a[236:239]
 v_mfma_f32_16x16x32_bf16 a[240:243],v[184:187],v[40:43],a[240:243]
 ds_write_b128 v3,a[204:207] offset:52224
 v_mfma_f32_16x16x32_bf16 a[244:247],v[184:187],v[44:47],a[244:247]
 ds_write_b128 v3,a[208:211] offset:53248
 v_mfma_f32_16x16x32_bf16 a[248:251],v[184:187],v[48:51],a[248:251]
 ds_write_b128 v3,a[212:215] offset:54272
 v_mfma_f32_16x16x32_bf16 a[252:255],v[184:187],v[52:55],a[252:255]
 ds_write_b128 v3,a[216:219] offset:55296
 v_mfma_f32_16x16x32_bf16 v[224:227],v[184:187],v[56:59],v[224:227]
 ds_write_b128 v3,a[220:223] offset:56320
 v_mfma_f32_16x16x32_bf16 v[228:231],v[184:187],v[60:63],v[228:231]
 v_mfma_f32_16x16x32_bf16 v[232:235],v[188:191],v[40:43],v[232:235]
 ds_write_b128 v3,a[228:231] offset:58368
 v_mfma_f32_16x16x32_bf16 v[236:239],v[188:191],v[44:47],v[236:239]
 ds_write_b128 v3,a[232:235] offset:59392
 v_mfma_f32_16x16x32_bf16 v[240:243],v[188:191],v[48:51],v[240:243]
 ds_write_b128 v3,a[236:239] offset:60416
 v_mfma_f32_16x16x32_bf16 v[244:247],v[188:191],v[52:55],v[244:247]
 v_mfma_f32_16x16x32_bf16 v[248:251],v[188:191],v[56:59],v[248:251]
 ds_write_b128 v8,a[244:247] offset:1024
 v_mfma_f32_16x16x32_bf16 v[252:255],v[188:191],v[60:63],v[252:255]
 ds_write_b128 v8,a[248:251] offset:2048
 s_waitcnt vmcnt(3)
 v_cmp_eq_u32 vcc,0,v22
 s_nop 1
 s_mov_b64 s[70:71],vcc
 s_cbranch_vccnz OP_e0
 s_movk_i32 s34,0
 buffer_load_dwordx4 v[184:187],v2,s[4:7],s34 offen offset:0 sc0 sc1
 buffer_load_dwordx4 v[188:191],v2,s[4:7],s34 offen offset:1024 sc0 sc1
 buffer_load_dwordx4 v[200:203],v2,s[4:7],s34 offen offset:2048 sc0 sc1
 buffer_load_dwordx4 v[204:207],v2,s[4:7],s34 offen offset:3072 sc0 sc1
 s_movk_i32 s34,4096
 buffer_load_dwordx4 v[208:211],v2,s[4:7],s34 offen offset:0 sc0 sc1
 buffer_load_dwordx4 v[212:215],v2,s[4:7],s34 offen offset:1024 sc0 sc1
 buffer_load_dwordx4 v[216:219],v2,s[4:7],s34 offen offset:2048 sc0 sc1
 buffer_load_dwordx4 v[192:195],v2,s[4:7],s34 offen offset:3072 sc0 sc1
 s_movk_i32 s34,8192
 buffer_load_dwordx4 v[196:199],v2,s[4:7],s34 offen offset:0 sc0 sc1
OP_e0:
 s_nop 4
 ds_write_b128 v8,a[252:255] offset:3072
 ds_write_b128 v8,v[228:231] offset:5120
 ds_write_b128 v8,v[236:239] offset:7168
 ds_write_b128 v8,v[240:243] offset:8192
 ds_write_b128 v8,v[244:247] offset:9216
 ds_write_b128 v8,v[248:251] offset:10240
 s_waitcnt vmcnt(0)
 buffer_store_dword v1,v12,s[80:83],s99 offen sc0 sc1
 ds_write_b128 v8,v[252:255] offset:11264
 v_accvgpr_read_b32 v40,a144
 v_accvgpr_read_b32 v41,a145
 v_accvgpr_read_b32 v42,a146
 v_accvgpr_read_b32 v43,a147
 v_accvgpr_read_b32 v56,a168
 v_accvgpr_read_b32 v57,a169
 v_accvgpr_read_b32 v58,a170
 v_accvgpr_read_b32 v59,a171
 v_accvgpr_read_b32 v72,a160
 v_accvgpr_read_b32 v73,a161
 v_accvgpr_read_b32 v74,a162
 v_accvgpr_read_b32 v75,a163
 v_accvgpr_read_b32 v88,a184
 v_accvgpr_read_b32 v89,a185
 v_accvgpr_read_b32 v90,a186
 v_accvgpr_read_b32 v91,a187
 v_accvgpr_read_b32 v104,a200
 v_accvgpr_read_b32 v105,a201
 v_accvgpr_read_b32 v106,a202
 v_accvgpr_read_b32 v107,a203
 v_accvgpr_read_b32 v120,a224
 v_accvgpr_read_b32 v121,a225
 v_accvgpr_read_b32 v122,a226
 v_accvgpr_read_b32 v123,a227
 v_accvgpr_read_b32 v136,a240
 v_accvgpr_read_b32 v137,a241
 v_accvgpr_read_b32 v138,a242
 v_accvgpr_read_b32 v139,a243
 v_mov_b32 v152,v232
 v_mov_b32 v153,v233
 v_mov_b32 v154,v234
 v_mov_b32 v155,v235
 v_mov_b32 v168,v224
 v_mov_b32 v169,v225
 v_mov_b32 v170,v226
 v_mov_b32 v171,v227
 s_waitcnt lgkmcnt(0)
 s_barrier
 ds_read_b128 v[44:47],v5 offset:0
 ds_read_b128 v[48:51],v6 offset:0
 ds_read_b128 v[52:55],v7 offset:0
 ds_read_b128 v[60:63],v5 offset:6144
 ds_read_b128 v[64:67],v6 offset:6144
 ds_read_b128 v[68:71],v7 offset:6144
 ds_read_b128 v[76:79],v5 offset:4096
 ds_read_b128 v[80:83],v6 offset:4096
 ds_read_b128 v[84:87],v7 offset:4096
 ds_read_b128 v[92:95],v5 offset:10240
 ds_read_b128 v[96:99],v6 offset:10240
 ds_read_b128 v[100:103],v7 offset:10240
 ds_read_b128 v[108:111],v5 offset:51200
 ds_read_b128 v[112:115],v6 offset:51200
 ds_read_b128 v[116:119],v7 offset:51200
 ds_read_b128 v[124:127],v5 offset:57344
 ds_read_b128 v[128:131],v6 offset:57344
 ds_read_b128 v[132:135],v7 offset:57344
 ds_read_b128 v[140:143],v9 offset:0
 ds_read_b128 v[144:147],v10 offset:0
 ds_read_b128 v[148:151],v11 offset:0
 ds_read_b128 v[156:159],v9 offset:6144
 ds_read_b128 v[160:163],v10 offset:6144
 ds_read_b128 v[164:167],v11 offset:6144
 ds_read_b128 v[172:175],v9 offset:4096
 ds_read_b128 v[176:179],v10 offset:4096
 ds_read_b128 v[180:183],v11 offset:4096
 s_cmp_eq_u32 s70,0
 s_cbranch_scc1 OP_f0
 s_branch OP_spin2
OP_back2:
 s_movk_i32 s34,0
 buffer_load_dwordx4 v[184:187],v2,s[4:7],s34 offen offset:0 sc0 sc1
 buffer_load_dwordx4 v[188:191],v2,s[4:7],s34 offen offset:1024 sc0 sc1
 buffer_load_dwordx4 v[200:203],v2,s[4:7],s34 offen offset:2048 sc0 sc1
 buffer_load_dwordx4 v[204:207],v2,s[4:7],s34 offen offset:3072 sc0 sc1
 s_movk_i32 s34,4096
 buffer_load_dwordx4 v[208:211],v2,s[4:7],s34 offen offset:0 sc0 sc1
 buffer_load_dwordx4 v[212:215],v2,s[4:7],s34 offen offset:1024 sc0 sc1
 buffer_load_dwordx4 v[216:219],v2,s[4:7],s34 offen offset:2048 sc0 sc1
 buffer_load_dwordx4 v[192:195],v2,s[4:7],s34 offen offset:3072 sc0 sc1
 s_movk_i32 s34,8192
 buffer_load_dwordx4 v[196:199],v2,s[4:7],s34 offen offset:0 sc0 sc1
OP_f0:
 v_and_b32 v18,15,v0
 v_mul_u32_u24 v18,2304,v18
 v_bfe_u32 v19,v0,4,1
 v_lshl_add_u32 v18,v19,5,v18
 v_lshrrev_b32 v19,5,v0
 v_lshl_add_u32 v18,v19,4,v18
 s_waitcnt lgkmcnt(15)
 v_add_f32 v40,v40,v44
 v_add_f32 v41,v41,v45
 v_add_f32 v42,v42,v46
 v_add_f32 v43,v43,v47
 s_waitcnt lgkmcnt(15)
 v_add_f32 v48,v48,v52
 v_add_f32 v49,v49,v53
 v_add_f32 v50,v50,v54
 v_add_f32 v51,v51,v55
 v_add_f32 v40,v40,v48
 v_add_f32 v41,v41,v49
 v_add_f32 v42,v42,v50
 v_add_f32 v43,v43,v51
 s_waitcnt lgkmcnt(15)
 v_add_f32 v56,v56,v60
 v_add_f32 v57,v57,v61
 v_add_f32 v58,v58,v62
 v_add_f32 v59,v59,v63
 s_waitcnt lgkmcnt(15)
 v_add_f32 v64,v64,v68
 v_add_f32 v65,v65,v69
 v_add_f32 v66,v66,v70
 v_add_f32 v67,v67,v71
 v_add_f32 v56,v56,v64
 v_add_f32 v57,v57,v65
 v_add_f32 v58,v58,v66
 v_add_f32 v59,v59,v67
 s_waitcnt lgkmcnt(15)
 v_add_f32 v72,v72,v76
 v_add_f32 v73,v73,v77
 v_add_f32 v74,v74,v78
 v_add_f32 v75,v75,v79
 s_waitcnt lgkmcnt(15)
 v_add_f32 v80,v80,v84
 v_add_f32 v81,v81,v85
 v_add_f32 v82,v82,v86
 v_add_f32 v83,v83,v87
 v_add_f32 v72,v72,v80
 v_add_f32 v73,v73,v81
 v_add_f32 v74,v74,v82
 v_add_f32 v75,v75,v83
 s_waitcnt lgkmcnt(15)
 v_add_f32 v88,v88,v92
 v_add_f32 v89,v89,v93
 v_add_f32 v90,v90,v94
 v_add_f32 v91,v91,v95
 s_waitcnt lgkmcnt(15)
 v_add_f32 v96,v96,v100
 v_add_f32 v97,v97,v101
 v_add_f32 v98,v98,v102
 v_add_f32 v99,v99,v103
 v_add_f32 v88,v88,v96
 v_add_f32 v89,v89,v97
 v_add_f32 v90,v90,v98
 v_add_f32 v91,v91,v99
 s_waitcnt lgkmcnt(14)
 v_add_f32 v104,v104,v108
 v_add_f32 v105,v105,v109
 v_add_f32 v106,v106,v110
 v_add_f32 v107,v107,v111
 s_waitcnt lgkmcnt(12)
 v_add_f32 v112,v112,v116
 v_add_f32 v113,v113,v117
 v_add_f32 v114,v114,v118
 v_add_f32 v115,v115,v119
 v_add_f32 v104,v104,v112
 v_add_f32 v105,v105,v113
 v_add_f32 v106,v106,v114
 v_add_f32 v107,v107,v115
 s_waitcnt lgkmcnt(11)
 v_add_f32 v120,v120,v124
 v_add_f32 v121,v121,v125
 v_add_f32 v122,v122,v126
 v_add_f32 v123,v123,v127
 s_waitcnt lgkmcnt(9)
 v_add_f32 v128,v128,v132
 v_add_f32 v129,v129,v133
 v_add_f32 v130,v130,v134
 v_add_f32 v131,v131,v135
 v_add_f32 v120,v120,v128
 v_add_f32 v121,v121,v129
 v_add_f32 v122,v122,v130
 v_add_f32 v123,v123,v131
 s_waitcnt lgkmcnt(8)
 v_add_f32 v136,v136,v140
 v_add_f32 v137,v137,v141
 v_add_f32 v138,v138,v142
 v_add_f32 v139,v139,v143
 s_waitcnt lgkmcnt(6)
 v_add_f32 v144,v144,v148
 v_add_f32 v145,v145,v149
 v_add_f32 v146,v146,v150
 v_add_f32 v147,v147,v151
 v_add_f32 v136,v136,v144
 v_add_f32 v137,v137,v145
 v_add_f32 v138,v138,v146
 v_add_f32 v139,v139,v147
 s_waitcnt lgkmcnt(5)
 v_add_f32 v152,v152,v156
 v_add_f32 v153,v153,v157
 v_add_f32 v154,v154,v158
 v_add_f32 v155,v155,v159
 s_waitcnt lgkmcnt(3)
 v_add_f32 v160,v160,v164
 v_add_f32 v161,v161,v165
 v_add_f32 v162,v162,v166
 v_add_f32 v163,v163,v167
 v_add_f32 v152,v152,v160
 v_add_f32 v153,v153,v161
 v_add_f32 v154,v154,v162
 v_add_f32 v155,v155,v163
 s_waitcnt lgkmcnt(2)
 v_add_f32 v168,v168,v172
 v_add_f32 v169,v169,v173
 v_add_f32 v170,v170,v174
 v_add_f32 v171,v171,v175
 s_waitcnt lgkmcnt(0)
 v_add_f32 v176,v176,v180
 v_add_f32 v177,v177,v181
 v_add_f32 v178,v178,v182
 v_add_f32 v179,v179,v183
 v_add_f32 v168,v168,v176
 v_add_f32 v169,v169,v177
 v_add_f32 v170,v170,v178
 v_add_f32 v171,v171,v179
 s_waitcnt vmcnt(7)
 v_add_f32 v40,v40,v184
 v_add_f32 v41,v41,v185
 v_add_f32 v42,v42,v186
 v_add_f32 v43,v43,v187
 v_add_f32 v56,v56,v188
 v_add_f32 v57,v57,v189
 v_add_f32 v58,v58,v190
 v_add_f32 v59,v59,v191
 v_cvt_pk_bf16_f32 v44,v40,v41
 v_cvt_pk_bf16_f32 v45,v42,v43
 v_cvt_pk_bf16_f32 v46,v56,v57
 v_cvt_pk_bf16_f32 v47,v58,v59
 s_mov_b32 s34,0
 s_nop 0
 v_permlane16_swap_b32 v44,v46
 v_permlane16_swap_b32 v45,v47
 buffer_store_dwordx4 v[44:47],v18,s[52:55],s34 offen offset:0
 s_waitcnt vmcnt(6)
 v_add_f32 v72,v72,v200
 v_add_f32 v73,v73,v201
 v_add_f32 v74,v74,v202
 v_add_f32 v75,v75,v203
 v_add_f32 v88,v88,v204
 v_add_f32 v89,v89,v205
 v_add_f32 v90,v90,v206
 v_add_f32 v91,v91,v207
 v_cvt_pk_bf16_f32 v76,v72,v73
 v_cvt_pk_bf16_f32 v77,v74,v75
 v_cvt_pk_bf16_f32 v78,v88,v89
 v_cvt_pk_bf16_f32 v79,v90,v91
 s_mov_b32 s34,147456
 s_nop 0
 v_permlane16_swap_b32 v76,v78
 v_permlane16_swap_b32 v77,v79
 buffer_store_dwordx4 v[76:79],v18,s[52:55],s34 offen offset:0
 s_waitcnt vmcnt(5)
 v_add_f32 v104,v104,v208
 v_add_f32 v105,v105,v209
 v_add_f32 v106,v106,v210
 v_add_f32 v107,v107,v211
 v_add_f32 v120,v120,v212
 v_add_f32 v121,v121,v213
 v_add_f32 v122,v122,v214
 v_add_f32 v123,v123,v215
 v_cvt_pk_bf16_f32 v108,v104,v105
 v_cvt_pk_bf16_f32 v109,v106,v107
 v_cvt_pk_bf16_f32 v110,v120,v121
 v_cvt_pk_bf16_f32 v111,v122,v123
 s_mov_b32 s34,73728
 s_nop 0
 v_permlane16_swap_b32 v108,v110
 v_permlane16_swap_b32 v109,v111
 buffer_store_dwordx4 v[108:111],v18,s[52:55],s34 offen offset:64
 s_waitcnt vmcnt(4)
 v_add_f32 v136,v136,v216
 v_add_f32 v137,v137,v217
 v_add_f32 v138,v138,v218
 v_add_f32 v139,v139,v219
 v_add_f32 v152,v152,v192
 v_add_f32 v153,v153,v193
 v_add_f32 v154,v154,v194
 v_add_f32 v155,v155,v195
 v_cvt_pk_bf16_f32 v140,v136,v137
 v_cvt_pk_bf16_f32 v141,v138,v139
 v_cvt_pk_bf16_f32 v142,v152,v153
 v_cvt_pk_bf16_f32 v143,v154,v155
 s_mov_b32 s34,0
 s_nop 0
 v_permlane16_swap_b32 v140,v142
 v_permlane16_swap_b32 v141,v143
 buffer_store_dwordx4 v[140:143],v18,s[52:55],s34 offen offset:128
 s_waitcnt vmcnt(4)
 v_add_f32 v168,v168,v196
 v_add_f32 v169,v169,v197
 v_add_f32 v170,v170,v198
 v_add_f32 v171,v171,v199
 v_cvt_pk_bf16_f32 v172,v168,v169
 v_cvt_pk_bf16_f32 v173,v170,v171
 s_mov_b32 s34,147456
 buffer_store_dwordx2 v[172:173],v4,s[52:55],s34 offen offset:128
 s_endpgm
K2_r0:
 s_cmp_lg_u32 s24,1
 s_cbranch_scc1 K2_r1
 s_waitcnt vmcnt(0)
 s_waitcnt lgkmcnt(15)
 v_mfma_f32_16x16x32_bf16 a[0:3],v[136:139],v[40:43],a[0:3]
 v_mfma_f32_16x16x32_bf16 a[4:7],v[136:139],v[44:47],a[4:7]
 ds_read_b64_tr_b16 v[120:121],v18 offset:128
 v_mfma_f32_16x16x32_bf16 a[8:11],v[136:139],v[48:51],a[8:11]
 ds_read_b64_tr_b16 v[122:123],v18 offset:6272
 v_add_u32 v5,0,v2
 v_add_u32 v9,98304,v2
 v_mfma_f32_16x16x32_bf16 a[12:15],v[136:139],v[52:55],a[12:15]
 v_add_u32 v6,24576,v2
 v_add_u32 v10,122880,v2
 v_mfma_f32_16x16x32_bf16 a[16:19],v[136:139],v[56:59],a[16:19]
 v_add_u32 v7,36864,v2
 v_add_u32 v11,135168,v2
 v_mfma_f32_16x16x32_bf16 a[20:23],v[136:139],v[60:63],a[20:23]
 s_waitcnt lgkmcnt(15)
 v_mfma_f32_16x16x32_bf16 a[24:27],v[140:143],v[40:43],a[24:27]
 v_mfma_f32_16x16x32_bf16 a[28:31],v[140:143],v[44:47],a[28:31]
 ds_read_b64_tr_b16 v[124:125],v19 offset:128
 v_mfma_f32_16x16x32_bf16 a[32:35],v[140:143],v[48:51],a[32:35]
 ds_read_b64_tr_b16 v[126:127],v19 offset:6272
 v_mfma_f32_16x16x32_bf16 a[36:39],v[140:143],v[52:55],a[36:39]
 v_mfma_f32_16x16x32_bf16 a[40:43],v[140:143],v[56:59],a[40:43]
 v_mfma_f32_16x16x32_bf16 a[44:47],v[140:143],v[60:63],a[44:47]
 s_waitcnt lgkmcnt(13)
 v_mfma_f32_16x16x32_bf16 a[48:51],v[112:115],v[40:43],a[48:51]
 v_mfma_f32_16x16x32_bf16 a[52:55],v[112:115],v[44:47],a[52:55]
 v_mfma_f32_16x16x32_bf16 a[56:59],v[112:115],v[48:51],a[56:59]
 s_waitcnt lgkmcnt(0)
 v_mfma_f32_16x16x32_bf16 a[60:63],v[112:115],v[52:55],a[60:63]
 ds_write_b128 v3,a[0:3] offset:0
 ds_write_b128 v3,a[8:11] offset:2048
 v_mfma_f32_16x16x32_bf16 a[64:67],v[112:115],v[56:59],a[64:67]
 ds_write_b128 v3,a[12:15] offset:3072
 v_mfma_f32_16x16x32_bf16 a[68:71],v[112:115],v[60:63],a[68:71]
 ds_write_b128 v3,a[16:19] offset:4096
 ds_write_b128 v3,a[24:27] offset:6144
 v_mfma_f32_16x16x32_bf16 a[72:75],v[116:119],v[40:43],a[72:75]
 ds_write_b128 v3,a[32:35] offset:8192
 v_mfma_f32_16x16x32_bf16 a[76:79],v[116:119],v[44:47],a[76:79]
 ds_write_b128 v3,a[36:39] offset:9216
 ds_write_b128 v3,a[40:43] offset:10240
 v_mfma_f32_16x16x32_bf16 a[80:83],v[116:119],v[48:51],a[80:83]
 v_mfma_f32_16x16x32_bf16 a[84:87],v[116:119],v[52:55],a[84:87]
 ds_write_b128 v3,a[48:51] offset:49152
 v_mfma_f32_16x16x32_bf16 a[88:91],v[116:119],v[56:59],a[88:91]
 ds_write_b128 v3,a[52:55] offset:50176
 v_mfma_f32_16x16x32_bf16 a[92:95],v[116:119],v[60:63],a[92:95]
 ds_write_b128 v3,a[56:59] offset:51200
 v_mfma_f32_16x16x32_bf16 a[96:99],v[120:123],v[40:43],a[96:99]
 v_mfma_f32_16x16x32_bf16 a[100:103],v[120:123],v[44:47],a[100:103]
 ds_write_b128 v3,a[64:67] offset:53248
 v_mfma_f32_16x16x32_bf16 a[104:107],v[120:123],v[48:51],a[104:107]
 ds_write_b128 v3,a[68:71] offset:54272
 v_mfma_f32_16x16x32_bf16 a[108:111],v[120:123],v[52:55],a[108:111]
 ds_write_b128 v3,a[72:75] offset:55296
 v_mfma_f32_16x16x32_bf16 a[112:115],v[120:123],v[56:59],a[112:115]
 ds_write_b128 v3,a[76:79] offset:56320
 v_mfma_f32_16x16x32_bf16 a[116:119],v[120:123],v[60:63],a[116:119]
 ds_write_b128 v3,a[80:83] offset:57344
 v_mfma_f32_16x16x32_bf16 a[120:123],v[124:127],v[40:43],a[120:123]
 v_mfma_f32_16x16x32_bf16 a[124:127],v[124:127],v[44:47],a[124:127]
 ds_write_b128 v3,a[88:91] offset:59392
 v_mfma_f32_16x16x32_bf16 a[128:131],v[124:127],v[48:51],a[128:131]
 ds_write_b128 v3,a[92:95] offset:60416
 v_mfma_f32_16x16x32_bf16 a[132:135],v[124:127],v[52:55],a[132:135]
 ds_write_b128 v8,a[96:99] offset:0
 v_mfma_f32_16x16x32_bf16 a[136:139],v[124:127],v[56:59],a[136:139]
 v_mfma_f32_16x16x32_bf16 a[140:143],v[124:127],v[60:63],a[140:143]
 ds_write_b128 v8,a[104:107] offset:2048
 v_mfma_f32_16x16x32_bf16 a[144:147],v[144:147],v[88:91],a[144:147]
 ds_write_b128 v8,a[108:111] offset:3072
 v_mfma_f32_16x16x32_bf16 a[148:151],v[144:147],v[92:95],a[148:151]
 ds_write_b128 v8,a[112:115] offset:4096
 v_mfma_f32_16x16x32_bf16 a[152:155],v[144:147],v[96:99],a[152:155]
 ds_write_b128 v8,a[116:119] offset:5120
 v_mfma_f32_16x16x32_bf16 a[156:159],v[144:147],v[100:103],a[156:159]
 ds_write_b128 v8,a[120:123] offset:6144
 v_mfma_f32_16x16x32_bf16 a[160:163],v[144:147],v[104:107],a[160:163]
 v_mfma_f32_16x16x32_bf16 a[164:167],v[144:147],v[108:111],a[164:167]
 ds_write_b128 v8,a[128:131] offset:8192
 v_mfma_f32_16x16x32_bf16 a[168:171],v[148:151],v[88:91],a[168:171]
 ds_write_b128 v8,a[132:135] offset:9216
 v_mfma_f32_16x16x32_bf16 a[172:175],v[148:151],v[92:95],a[172:175]
 v_mfma_f32_16x16x32_bf16 a[176:179],v[148:151],v[96:99],a[176:179]
 ds_write_b128 v8,a[140:143] offset:11264
 v_mfma_f32_16x16x32_bf16 a[180:183],v[148:151],v[100:103],a[180:183]
 v_mfma_f32_16x16x32_bf16 a[184:187],v[148:151],v[104:107],a[184:187]
 v_mfma_f32_16x16x32_bf16 a[188:191],v[148:151],v[108:111],a[188:191]
 v_mfma_f32_16x16x32_bf16 a[192:195],v[152:155],v[88:91],a[192:195]
 s_waitcnt lgkmcnt(0)
 s_barrier
 v_mfma_f32_16x16x32_bf16 a[196:199],v[152:155],v[92:95],a[196:199]
 ds_read_b128 v[68:71],v5 offset:1024
 ds_read_b128 v[72:75],v6 offset:1024
 ds_read_b128 v[76:79],v7 offset:1024
 ds_read_b128 v[84:87],v5 offset:7168
 v_mfma_f32_16x16x32_bf16 a[200:203],v[152:155],v[96:99],a[200:203]
 ds_read_b128 v[192:195],v6 offset:7168
 ds_read_b128 v[196:199],v7 offset:7168
 ds_read_b128 v[28:31],v5 offset:5120
 ds_read_b128 v[32:35],v6 offset:5120
 v_mfma_f32_16x16x32_bf16 a[204:207],v[152:155],v[100:103],a[204:207]
 ds_read_b128 v[36:39],v7 offset:5120
 ds_read_b128 v[204:207],v5 offset:11264
 ds_read_b128 v[208:211],v6 offset:11264
 ds_read_b128 v[212:215],v7 offset:11264
 v_mfma_f32_16x16x32_bf16 a[208:211],v[152:155],v[104:107],a[208:211]
 ds_read_b128 v[112:115],v5 offset:52224
 ds_read_b128 v[116:119],v6 offset:52224
 ds_read_b128 v[120:123],v7 offset:52224
 ds_read_b128 v[128:131],v5 offset:58368
 v_mfma_f32_16x16x32_bf16 a[212:215],v[152:155],v[108:111],a[212:215]
 ds_read_b128 v[132:135],v6 offset:58368
 ds_read_b128 v[136:139],v7 offset:58368
 v_accvgpr_read_b32 v64,a4
 v_accvgpr_read_b32 v65,a5
 v_mfma_f32_16x16x32_bf16 a[216:219],v[156:159],v[88:91],a[216:219]
 v_accvgpr_read_b32 v66,a6
 v_accvgpr_read_b32 v67,a7
 s_waitcnt lgkmcnt(15)
 v_add_f32 v64,v64,v68
 v_add_f32 v65,v65,v69
 v_mfma_f32_16x16x32_bf16 a[220:223],v[156:159],v[92:95],a[220:223]
 v_add_f32 v66,v66,v70
 v_add_f32 v67,v67,v71
 s_waitcnt lgkmcnt(15)
 v_add_f32 v72,v72,v76
 v_add_f32 v73,v73,v77
 v_mfma_f32_16x16x32_bf16 a[224:227],v[156:159],v[96:99],a[224:227]
 v_add_f32 v74,v74,v78
 v_add_f32 v75,v75,v79
 v_add_f32 v64,v64,v72
 v_add_f32 v65,v65,v73
 v_mfma_f32_16x16x32_bf16 a[228:231],v[156:159],v[100:103],a[228:231]
 v_add_f32 v66,v66,v74
 v_add_f32 v67,v67,v75
 s_movk_i32 s34,0
 buffer_store_dwordx4 v[64:67],v2,s[8:11],s34 offen offset:0 sc0 sc1
 ds_read_b128 v[68:71],v9 offset:1024
 v_mfma_f32_16x16x32_bf16 a[232:235],v[156:159],v[104:107],a[232:235]
 ds_read_b128 v[72:75],v10 offset:1024
 ds_read_b128 v[76:79],v11 offset:1024
 v_accvgpr_read_b32 v80,a28
 v_accvgpr_read_b32 v81,a29
 v_mfma_f32_16x16x32_bf16 a[236:239],v[156:159],v[108:111],a[236:239]
 v_accvgpr_read_b32 v82,a30
 v_accvgpr_read_b32 v83,a31
 s_waitcnt lgkmcnt(15)
 v_add_f32 v80,v80,v84
 v_add_f32 v81,v81,v85
 v_mfma_f32_16x16x32_bf16 a[240:243],v[160:163],v[88:91],a[240:243]
 v_add_f32 v82,v82,v86
 v_add_f32 v83,v83,v87
 s_waitcnt lgkmcnt(15)
 v_add_f32 v192,v192,v196
 v_add_f32 v193,v193,v197
 v_mfma_f32_16x16x32_bf16 a[244:247],v[160:163],v[92:95],a[244:247]
 v_add_f32 v194,v194,v198
 v_add_f32 v195,v195,v199
 v_add_f32 v80,v80,v192
 v_add_f32 v81,v81,v193
 v_mfma_f32_16x16x32_bf16 a[248:251],v[160:163],v[96:99],a[248:251]
 v_add_f32 v82,v82,v194
 v_add_f32 v83,v83,v195
 buffer_store_dwordx4 v[80:83],v2,s[8:11],s34 offen offset:1024 sc0 sc1
 ds_read_b128 v[84:87],v9 offset:7168
 v_mfma_f32_16x16x32_bf16 a[252:255],v[160:163],v[100:103],a[252:255]
 ds_read_b128 v[192:195],v10 offset:7168
 ds_read_b128 v[196:199],v11 offset:7168
 v_accvgpr_read_b32 v24,a20
 v_accvgpr_read_b32 v25,a21
 v_mfma_f32_16x16x32_bf16 v[224:227],v[160:163],v[104:107],v[224:227]
 v_accvgpr_read_b32 v26,a22
 v_accvgpr_read_b32 v27,a23
 s_waitcnt lgkmcnt(15)
 v_add_f32 v24,v24,v28
 v_add_f32 v25,v25,v29
 v_mfma_f32_16x16x32_bf16 v[228:231],v[160:163],v[108:111],v[228:231]
 v_add_f32 v26,v26,v30
 v_add_f32 v27,v27,v31
 s_waitcnt lgkmcnt(15)
 v_add_f32 v32,v32,v36
 v_add_f32 v33,v33,v37
 v_mfma_f32_16x16x32_bf16 v[232:235],v[164:167],v[88:91],v[232:235]
 v_add_f32 v34,v34,v38
 v_add_f32 v35,v35,v39
 v_add_f32 v24,v24,v32
 v_add_f32 v25,v25,v33
 v_mfma_f32_16x16x32_bf16 v[236:239],v[164:167],v[92:95],v[236:239]
 v_add_f32 v26,v26,v34
 v_add_f32 v27,v27,v35
 buffer_store_dwordx4 v[24:27],v2,s[8:11],s34 offen offset:2048 sc0 sc1
 ds_read_b128 v[28:31],v9 offset:10240
 v_mfma_f32_16x16x32_bf16 v[240:243],v[164:167],v[96:99],v[240:243]
 ds_read_b128 v[32:35],v10 offset:10240
 ds_read_b128 v[36:39],v11 offset:10240
 v_accvgpr_read_b32 v200,a44
 v_accvgpr_read_b32 v201,a45
 v_mfma_f32_16x16x32_bf16 v[244:247],v[164:167],v[100:103],v[244:247]
 v_accvgpr_read_b32 v202,a46
 v_accvgpr_read_b32 v203,a47
 s_waitcnt lgkmcnt(15)
 v_add_f32 v200,v200,v204
 v_add_f32 v201,v201,v205
 v_mfma_f32_16x16x32_bf16 v[248:251],v[164:167],v[104:107],v[248:251]
 v_add_f32 v202,v202,v206
 v_add_f32 v203,v203,v207
 s_waitcnt lgkmcnt(15)
 v_add_f32 v208,v208,v212
 v_add_f32 v209,v209,v213
 v_mfma_f32_16x16x32_bf16 v[252:255],v[164:167],v[108:111],v[252:255]
 v_add_f32 v210,v210,v214
 v_add_f32 v211,v211,v215
 v_add_f32 v200,v200,v208
 v_add_f32 v201,v201,v209
 v_mfma_f32_16x16x32_bf16 a[144:147],v[168:171],v[40:43],a[144:147]
 v_add_f32 v202,v202,v210
 v_add_f32 v203,v203,v211
 buffer_store_dwordx4 v[200:203],v2,s[8:11],s34 offen offset:3072 sc0 sc1
 v_accvgpr_read_b32 v216,a60
 v_mfma_f32_16x16x32_bf16 a[148:151],v[168:171],v[44:47],a[148:151]
 v_accvgpr_read_b32 v217,a61
 v_accvgpr_read_b32 v218,a62
 v_accvgpr_read_b32 v219,a63
 s_waitcnt lgkmcnt(14)
 v_add_f32 v216,v216,v112
 s_waitcnt lgkmcnt(0)
 s_barrier
 v_mfma_f32_16x16x32_bf16 a[152:155],v[168:171],v[48:51],a[152:155]
 v_add_f32 v217,v217,v113
 v_add_f32 v218,v218,v114
 v_add_f32 v219,v219,v115
 v_add_f32 v116,v116,v120
 v_mfma_f32_16x16x32_bf16 a[156:159],v[168:171],v[52:55],a[156:159]
 v_add_f32 v117,v117,v121
 v_add_f32 v118,v118,v122
 v_add_f32 v119,v119,v123
 v_add_f32 v216,v216,v116
 v_mfma_f32_16x16x32_bf16 a[160:163],v[168:171],v[56:59],a[160:163]
 v_add_f32 v217,v217,v117
 v_add_f32 v218,v218,v118
 v_add_f32 v219,v219,v119
 s_movk_i32 s34,4096
 buffer_store_dwordx4 v[216:219],v2,s[8:11],s34 offen offset:0 sc0 sc1
 v_mfma_f32_16x16x32_bf16 a[164:167],v[168:171],v[60:63],a[164:167]
 v_accvgpr_read_b32 v124,a84
 v_accvgpr_read_b32 v125,a85
 v_accvgpr_read_b32 v126,a86
 v_accvgpr_read_b32 v127,a87
 v_mfma_f32_16x16x32_bf16 a[168:171],v[172:175],v[40:43],a[168:171]
 v_add_f32 v124,v124,v128
 v_add_f32 v125,v125,v129
 v_add_f32 v126,v126,v130
 v_add_f32 v127,v127,v131
 v_mfma_f32_16x16x32_bf16 a[172:175],v[172:175],v[44:47],a[172:175]
 v_add_f32 v132,v132,v136
 v_add_f32 v133,v133,v137
 v_add_f32 v134,v134,v138
 v_add_f32 v135,v135,v139
 v_mfma_f32_16x16x32_bf16 a[176:179],v[172:175],v[48:51],a[176:179]
 v_add_f32 v124,v124,v132
 v_add_f32 v125,v125,v133
 v_add_f32 v126,v126,v134
 v_add_f32 v127,v127,v135
 v_mfma_f32_16x16x32_bf16 a[180:183],v[172:175],v[52:55],a[180:183]
 ds_write_b128 v3,a[144:147] offset:0
 buffer_store_dwordx4 v[124:127],v2,s[8:11],s34 offen offset:1024 sc0 sc1
 v_accvgpr_read_b32 v64,a100
 v_accvgpr_read_b32 v65,a101
 v_accvgpr_read_b32 v66,a102
 v_mfma_f32_16x16x32_bf16 a[184:187],v[172:175],v[56:59],a[184:187]
 v_accvgpr_read_b32 v67,a103
 v_add_f32 v64,v64,v68
 v_add_f32 v65,v65,v69
 v_add_f32 v66,v66,v70
 v_mfma_f32_16x16x32_bf16 a[188:191],v[172:175],v[60:63],a[188:191]
 ds_write_b128 v3,a[152:155] offset:2048
 v_add_f32 v67,v67,v71
 v_add_f32 v72,v72,v76
 v_add_f32 v73,v73,v77
 v_add_f32 v74,v74,v78
 v_mfma_f32_16x16x32_bf16 a[192:195],v[176:179],v[40:43],a[192:195]
 buffer_load_dword v22,off,s[80:83],s87 sc0 sc1
 ds_write_b128 v3,a[156:159] offset:3072
 v_add_f32 v75,v75,v79
 v_add_f32 v64,v64,v72
 v_add_f32 v65,v65,v73
 v_add_f32 v66,v66,v74
 v_mfma_f32_16x16x32_bf16 a[196:199],v[176:179],v[44:47],a[196:199]
 ds_write_b128 v3,a[160:163] offset:4096
 v_add_f32 v67,v67,v75
 buffer_store_dwordx4 v[64:67],v2,s[8:11],s34 offen offset:2048 sc0 sc1
 v_accvgpr_read_b32 v80,a124
 v_accvgpr_read_b32 v81,a125
 v_mfma_f32_16x16x32_bf16 a[200:203],v[176:179],v[48:51],a[200:203]
 v_accvgpr_read_b32 v82,a126
 v_accvgpr_read_b32 v83,a127
 v_add_f32 v80,v80,v84
 v_add_f32 v81,v81,v85
 v_mfma_f32_16x16x32_bf16 a[204:207],v[176:179],v[52:55],a[204:207]
 ds_write_b128 v3,a[168:171] offset:6144
 v_add_f32 v82,v82,v86
 v_add_f32 v83,v83,v87
 v_add_f32 v192,v192,v196
 v_add_f32 v193,v193,v197
 v_mfma_f32_16x16x32_bf16 a[208:211],v[176:179],v[56:59],a[208:211]
 v_add_f32 v194,v194,v198
 v_add_f32 v195,v195,v199
 v_add_f32 v80,v80,v192
 v_add_f32 v81,v81,v193
 v_mfma_f32_16x16x32_bf16 a[212:215],v[176:179],v[60:63],a[212:215]
 ds_write_b128 v3,a[176:179] offset:8192
 v_add_f32 v82,v82,v194
 v_add_f32 v83,v83,v195
 buffer_store_dwordx4 v[80:83],v2,s[8:11],s34 offen offset:3072 sc0 sc1
 v_accvgpr_read_b32 v24,a136
 v_mfma_f32_16x16x32_bf16 a[216:219],v[180:183],v[40:43],a[216:219]
 ds_write_b128 v3,a[180:183] offset:9216
 v_accvgpr_read_b32 v25,a137
 v_accvgpr_read_b32 v26,a138
 v_accvgpr_read_b32 v27,a139
 v_add_f32 v24,v24,v28
 v_mfma_f32_16x16x32_bf16 a[220:223],v[180:183],v[44:47],a[220:223]
 ds_write_b128 v3,a[184:187] offset:10240
 v_add_f32 v25,v25,v29
 v_add_f32 v26,v26,v30
 v_add_f32 v27,v27,v31
 v_add_f32 v32,v32,v36
 v_mfma_f32_16x16x32_bf16 a[224:227],v[180:183],v[48:51],a[224:227]
 v_add_f32 v33,v33,v37
 v_add_f32 v34,v34,v38
 v_add_f32 v35,v35,v39
 v_add_f32 v24,v24,v32
 v_mfma_f32_16x16x32_bf16 a[228:231],v[180:183],v[52:55],a[228:231]
 ds_write_b128 v3,a[192:195] offset:49152
 v_add_f32 v25,v25,v33
 v_add_f32 v26,v26,v34
 v_add_f32 v27,v27,v35
 s_movk_i32 s34,8192
 buffer_store_dwordx4 v[24:27],v2,s[8:11],s34 offen offset:0 sc0 sc1
 v_mfma_f32_16x16x32_bf16 a[232:235],v[180:183],v[56:59],a[232:235]
 ds_write_b128 v3,a[196:199] offset:50176
 v_mfma_f32_16x16x32_bf16 a[236:239],v[180:183],v[60:63],a[236:239]
 ds_write_b128 v3,a[200:203] offset:51200
 v_mfma_f32_16x16x32_bf16 a[240:243],v[184:187],v[40:43],a[240:243]
 v_mfma_f32_16x16x32_bf16 a[244:247],v[184:187],v[44:47],a[244:247]
 ds_write_b128 v3,a[208:211] offset:53248
 v_mfma_f32_16x16x32_bf16 a[248:251],v[184:187],v[48:51],a[248:251]
 ds_write_b128 v3,a[212:215] offset:54272
 v_mfma_f32_16x16x32_bf16 a[252:255],v[184:187],v[52:55],a[252:255]
 ds_write_b128 v3,a[216:219] offset:55296
 v_mfma_f32_16x16x32_bf16 v[224:227],v[184:187],v[56:59],v[224:227]
 ds_write_b128 v3,a[220:223] offset:56320
 v_mfma_f32_16x16x32_bf16 v[228:231],v[184:187],v[60:63],v[228:231]
 ds_write_b128 v3,a[224:227] offset:57344
 v_mfma_f32_16x16x32_bf16 v[232:235],v[188:191],v[40:43],v[232:235]
 v_mfma_f32_16x16x32_bf16 v[236:239],v[188:191],v[44:47],v[236:239]
 ds_write_b128 v3,a[232:235] offset:59392
 v_mfma_f32_16x16x32_bf16 v[240:243],v[188:191],v[48:51],v[240:243]
 ds_write_b128 v3,a[236:239] offset:60416
 v_mfma_f32_16x16x32_bf16 v[244:247],v[188:191],v[52:55],v[244:247]
 ds_write_b128 v8,a[240:243] offset:0
 v_mfma_f32_16x16x32_bf16 v[248:251],v[188:191],v[56:59],v[248:251]
 v_mfma_f32_16x16x32_bf16 v[252:255],v[188:191],v[60:63],v[252:255]
 ds_write_b128 v8,a[248:251] offset:2048
 s_waitcnt vmcnt(3)
 v_cmp_eq_u32 vcc,0,v22
 s_nop 1
 s_mov_b64 s[70:71],vcc
 s_cbranch_vccnz OP_e1
 s_movk_i32 s34,0
 buffer_load_dwordx4 v[184:187],v2,s[4:7],s34 offen offset:0 sc0 sc1
 buffer_load_dwordx4 v[188:191],v2,s[4:7],s34 offen offset:1024 sc0 sc1
 buffer_load_dwordx4 v[200:203],v2,s[4:7],s34 offen offset:2048 sc0 sc1
 buffer_load_dwordx4 v[204:207],v2,s[4:7],s34 offen offset:3072 sc0 sc1
 s_movk_i32 s34,4096
 buffer_load_dwordx4 v[208:211],v2,s[4:7],s34 offen offset:0 sc0 sc1
 buffer_load_dwordx4 v[212:215],v2,s[4:7],s34 offen offset:1024 sc0 sc1
 buffer_load_dwordx4 v[216:219],v2,s[4:7],s34 offen offset:2048 sc0 sc1
 buffer_load_dwordx4 v[192:195],v2,s[4:7],s34 offen offset:3072 sc0 sc1
 s_movk_i32 s34,8192
 buffer_load_dwordx4 v[196:199],v2,s[4:7],s34 offen offset:0 sc0 sc1
OP_e1:
 s_nop 4
 ds_write_b128 v8,a[252:255] offset:3072
 ds_write_b128 v8,v[224:227] offset:4096
 ds_write_b128 v8,v[228:231] offset:5120
 ds_write_b128 v8,v[232:235] offset:6144
 ds_write_b128 v8,v[240:243] offset:8192
 ds_write_b128 v8,v[244:247] offset:9216
 s_waitcnt vmcnt(0)
 buffer_store_dword v1,v12,s[80:83],s99 offen sc0 sc1
 ds_write_b128 v8,v[252:255] offset:11264
 v_accvgpr_read_b32 v40,a148
 v_accvgpr_read_b32 v41,a149
 v_accvgpr_read_b32 v42,a150
 v_accvgpr_read_b32 v43,a151
 v_accvgpr_read_b32 v56,a172
 v_accvgpr_read_b32 v57,a173
 v_accvgpr_read_b32 v58,a174
 v_accvgpr_read_b32 v59,a175
 v_accvgpr_read_b32 v72,a164
 v_accvgpr_read_b32 v73,a165
 v_accvgpr_read_b32 v74,a166
 v_accvgpr_read_b32 v75,a167
 v_accvgpr_read_b32 v88,a188
 v_accvgpr_read_b32 v89,a189
 v_accvgpr_read_b32 v90,a190
 v_accvgpr_read_b32 v91,a191
 v_accvgpr_read_b32 v104,a204
 v_accvgpr_read_b32 v105,a205
 v_accvgpr_read_b32 v106,a206
 v_accvgpr_read_b32 v107,a207
 v_accvgpr_read_b32 v120,a228
 v_accvgpr_read_b32 v121,a229
 v_accvgpr_read_b32 v122,a230
 v_accvgpr_read_b32 v123,a231
 v_accvgpr_read_b32 v136,a244
 v_accvgpr_read_b32 v137,a245
 v_accvgpr_read_b32 v138,a246
 v_accvgpr_read_b32 v139,a247
 v_mov_b32 v152,v236
 v_mov_b32 v153,v237
 v_mov_b32 v154,v238
 v_mov_b32 v155,v239
 v_mov_b32 v168,v248
 v_mov_b32 v169,v249
 v_mov_b32 v170,v250
 v_mov_b32 v171,v251
 s_waitcnt lgkmcnt(0)
 s_barrier
 ds_read_b128 v[44:47],v5 offset:1024
 ds_read_b128 v[48:51],v6 offset:1024
 ds_read_b128 v[52:55],v7 offset:1024
 ds_read_b128 v[60:63],v5 offset:7168
 ds_read_b128 v[64:67],v6 offset:7168
 ds_read_b128 v[68:71],v7 offset:7168
 ds_read_b128 v[76:79],v5 offset:5120
 ds_read_b128 v[80:83],v6 offset:5120
 ds_read_b128 v[84:87],v7 offset:5120
 ds_read_b128 v[92:95],v5 offset:11264
 ds_read_b128 v[96:99],v6 offset:11264
 ds_read_b128 v[100:103],v7 offset:11264
 ds_read_b128 v[108:111],v5 offset:52224
 ds_read_b128 v[112:115],v6 offset:52224
 ds_read_b128 v[116:119],v7 offset:52224
 ds_read_b128 v[124:127],v5 offset:58368
 ds_read_b128 v[128:131],v6 offset:58368
 ds_read_b128 v[132:135],v7 offset:58368
 ds_read_b128 v[140:143],v9 offset:1024
 ds_read_b128 v[144:147],v10 offset:1024
 ds_read_b128 v[148:151],v11 offset:1024
 ds_read_b128 v[156:159],v9 offset:7168
 ds_read_b128 v[160:163],v10 offset:7168
 ds_read_b128 v[164:167],v11 offset:7168
 ds_read_b128 v[172:175],v9 offset:10240
 ds_read_b128 v[176:179],v10 offset:10240
 ds_read_b128 v[180:183],v11 offset:10240
 s_cmp_eq_u32 s70,0
 s_cbranch_scc1 OP_f1
 s_branch OP_spin3
OP_back3:
 s_movk_i32 s34,0
 buffer_load_dwordx4 v[184:187],v2,s[4:7],s34 offen offset:0 sc0 sc1
 buffer_load_dwordx4 v[188:191],v2,s[4:7],s34 offen offset:1024 sc0 sc1
 buffer_load_dwordx4 v[200:203],v2,s[4:7],s34 offen offset:2048 sc0 sc1
 buffer_load_dwordx4 v[204:207],v2,s[4:7],s34 offen offset:3072 sc0 sc1
 s_movk_i32 s34,4096
 buffer_load_dwordx4 v[208:211],v2,s[4:7],s34 offen offset:0 sc0 sc1
 buffer_load_dwordx4 v[212:215],v2,s[4:7],s34 offen offset:1024 sc0 sc1
 buffer_load_dwordx4 v[216:219],v2,s[4:7],s34 offen offset:2048 sc0 sc1
 buffer_load_dwordx4 v[192:195],v2,s[4:7],s34 offen offset:3072 sc0 sc1
 s_movk_i32 s34,8192
 buffer_load_dwordx4 v[196:199],v2,s[4:7],s34 offen offset:0 sc0 sc1
OP_f1:
 v_and_b32 v18,15,v0
 v_mul_u32_u24 v18,2304,v18
 v_bfe_u32 v19,v0,4,1
 v_lshl_add_u32 v18,v19,5,v18
 v_lshrrev_b32 v19,5,v0
 v_lshl_add_u32 v18,v19,4,v18
 s_waitcnt lgkmcnt(15)
 v_add_f32 v40,v40,v44
 v_add_f32 v41,v41,v45
 v_add_f32 v42,v42,v46
 v_add_f32 v43,v43,v47
 s_waitcnt lgkmcnt(15)
 v_add_f32 v48,v48,v52
 v_add_f32 v49,v49,v53
 v_add_f32 v50,v50,v54
 v_add_f32 v51,v51,v55
 v_add_f32 v40,v40,v48
 v_add_f32 v41,v41,v49
 v_add_f32 v42,v42,v50
 v_add_f32 v43,v43,v51
 s_waitcnt lgkmcnt(15)
 v_add_f32 v56,v56,v60
 v_add_f32 v57,v57,v61
 v_add_f32 v58,v58,v62
 v_add_f32 v59,v59,v63
 s_waitcnt lgkmcnt(15)
 v_add_f32 v64,v64,v68
 v_add_f32 v65,v65,v69
 v_add_f32 v66,v66,v70
 v_add_f32 v67,v67,v71
 v_add_f32 v56,v56,v64
 v_add_f32 v57,v57,v65
 v_add_f32 v58,v58,v66
 v_add_f32 v59,v59,v67
 s_waitcnt lgkmcnt(15)
 v_add_f32 v72,v72,v76
 v_add_f32 v73,v73,v77
 v_add_f32 v74,v74,v78
 v_add_f32 v75,v75,v79
 s_waitcnt lgkmcnt(15)
 v_add_f32 v80,v80,v84
 v_add_f32 v81,v81,v85
 v_add_f32 v82,v82,v86
 v_add_f32 v83,v83,v87
 v_add_f32 v72,v72,v80
 v_add_f32 v73,v73,v81
 v_add_f32 v74,v74,v82
 v_add_f32 v75,v75,v83
 s_waitcnt lgkmcnt(15)
 v_add_f32 v88,v88,v92
 v_add_f32 v89,v89,v93
 v_add_f32 v90,v90,v94
 v_add_f32 v91,v91,v95
 s_waitcnt lgkmcnt(15)
 v_add_f32 v96,v96,v100
 v_add_f32 v97,v97,v101
 v_add_f32 v98,v98,v102
 v_add_f32 v99,v99,v103
 v_add_f32 v88,v88,v96
 v_add_f32 v89,v89,v97
 v_add_f32 v90,v90,v98
 v_add_f32 v91,v91,v99
 s_waitcnt lgkmcnt(14)
 v_add_f32 v104,v104,v108
 v_add_f32 v105,v105,v109
 v_add_f32 v106,v106,v110
 v_add_f32 v107,v107,v111
 s_waitcnt lgkmcnt(12)
 v_add_f32 v112,v112,v116
 v_add_f32 v113,v113,v117
 v_add_f32 v114,v114,v118
 v_add_f32 v115,v115,v119
 v_add_f32 v104,v104,v112
 v_add_f32 v105,v105,v113
 v_add_f32 v106,v106,v114
 v_add_f32 v107,v107,v115
 s_waitcnt lgkmcnt(11)
 v_add_f32 v120,v120,v124
 v_add_f32 v121,v121,v125
 v_add_f32 v122,v122,v126
 v_add_f32 v123,v123,v127
 s_waitcnt lgkmcnt(9)
 v_add_f32 v128,v128,v132
 v_add_f32 v129,v129,v133
 v_add_f32 v130,v130,v134
 v_add_f32 v131,v131,v135
 v_add_f32 v120,v120,v128
 v_add_f32 v121,v121,v129
 v_add_f32 v122,v122,v130
 v_add_f32 v123,v123,v131
 s_waitcnt lgkmcnt(8)
 v_add_f32 v136,v136,v140
 v_add_f32 v137,v137,v141
 v_add_f32 v138,v138,v142
 v_add_f32 v139,v139,v143
 s_waitcnt lgkmcnt(6)
 v_add_f32 v144,v144,v148
 v_add_f32 v145,v145,v149
 v_add_f32 v146,v146,v150
 v_add_f32 v147,v147,v151
 v_add_f32 v136,v136,v144
 v_add_f32 v137,v137,v145
 v_add_f32 v138,v138,v146
 v_add_f32 v139,v139,v147
 s_waitcnt lgkmcnt(5)
 v_add_f32 v152,v152,v156
 v_add_f32 v153,v153,v157
 v_add_f32 v154,v154,v158
 v_add_f32 v155,v155,v159
 s_waitcnt lgkmcnt(3)
 v_add_f32 v160,v160,v164
 v_add_f32 v161,v161,v165
 v_add_f32 v162,v162,v166
 v_add_f32 v163,v163,v167
 v_add_f32 v152,v152,v160
 v_add_f32 v153,v153,v161
 v_add_f32 v154,v154,v162
 v_add_f32 v155,v155,v163
 s_waitcnt lgkmcnt(2)
 v_add_f32 v168,v168,v172
 v_add_f32 v169,v169,v173
 v_add_f32 v170,v170,v174
 v_add_f32 v171,v171,v175
 s_waitcnt lgkmcnt(0)
 v_add_f32 v176,v176,v180
 v_add_f32 v177,v177,v181
 v_add_f32 v178,v178,v182
 v_add_f32 v179,v179,v183
 v_add_f32 v168,v168,v176
 v_add_f32 v169,v169,v177
 v_add_f32 v170,v170,v178
 v_add_f32 v171,v171,v179
 s_waitcnt vmcnt(7)
 v_add_f32 v40,v40,v184
 v_add_f32 v41,v41,v185
 v_add_f32 v42,v42,v186
 v_add_f32 v43,v43,v187
 v_add_f32 v56,v56,v188
 v_add_f32 v57,v57,v189
 v_add_f32 v58,v58,v190
 v_add_f32 v59,v59,v191
 v_cvt_pk_bf16_f32 v44,v40,v41
 v_cvt_pk_bf16_f32 v45,v42,v43
 v_cvt_pk_bf16_f32 v46,v56,v57
 v_cvt_pk_bf16_f32 v47,v58,v59
 s_mov_b32 s34,36864
 s_nop 0
 v_permlane16_swap_b32 v44,v46
 v_permlane16_swap_b32 v45,v47
 buffer_store_dwordx4 v[44:47],v18,s[52:55],s34 offen offset:0
 s_waitcnt vmcnt(6)
 v_add_f32 v72,v72,v200
 v_add_f32 v73,v73,v201
 v_add_f32 v74,v74,v202
 v_add_f32 v75,v75,v203
 v_add_f32 v88,v88,v204
 v_add_f32 v89,v89,v205
 v_add_f32 v90,v90,v206
 v_add_f32 v91,v91,v207
 v_cvt_pk_bf16_f32 v76,v72,v73
 v_cvt_pk_bf16_f32 v77,v74,v75
 v_cvt_pk_bf16_f32 v78,v88,v89
 v_cvt_pk_bf16_f32 v79,v90,v91
 s_mov_b32 s34,184320
 s_nop 0
 v_permlane16_swap_b32 v76,v78
 v_permlane16_swap_b32 v77,v79
 buffer_store_dwordx4 v[76:79],v18,s[52:55],s34 offen offset:0
 s_waitcnt vmcnt(5)
 v_add_f32 v104,v104,v208
 v_add_f32 v105,v105,v209
 v_add_f32 v106,v106,v210
 v_add_f32 v107,v107,v211
 v_add_f32 v120,v120,v212
 v_add_f32 v121,v121,v213
 v_add_f32 v122,v122,v214
 v_add_f32 v123,v123,v215
 v_cvt_pk_bf16_f32 v108,v104,v105
 v_cvt_pk_bf16_f32 v109,v106,v107
 v_cvt_pk_bf16_f32 v110,v120,v121
 v_cvt_pk_bf16_f32 v111,v122,v123
 s_mov_b32 s34,110592
 s_nop 0
 v_permlane16_swap_b32 v108,v110
 v_permlane16_swap_b32 v109,v111
 buffer_store_dwordx4 v[108:111],v18,s[52:55],s34 offen offset:64
 s_waitcnt vmcnt(4)
 v_add_f32 v136,v136,v216
 v_add_f32 v137,v137,v217
 v_add_f32 v138,v138,v218
 v_add_f32 v139,v139,v219
 v_add_f32 v152,v152,v192
 v_add_f32 v153,v153,v193
 v_add_f32 v154,v154,v194
 v_add_f32 v155,v155,v195
 v_cvt_pk_bf16_f32 v140,v136,v137
 v_cvt_pk_bf16_f32 v141,v138,v139
 v_cvt_pk_bf16_f32 v142,v152,v153
 v_cvt_pk_bf16_f32 v143,v154,v155
 s_mov_b32 s34,36864
 s_nop 0
 v_permlane16_swap_b32 v140,v142
 v_permlane16_swap_b32 v141,v143
 buffer_store_dwordx4 v[140:143],v18,s[52:55],s34 offen offset:128
 s_waitcnt vmcnt(4)
 v_add_f32 v168,v168,v196
 v_add_f32 v169,v169,v197
 v_add_f32 v170,v170,v198
 v_add_f32 v171,v171,v199
 v_cvt_pk_bf16_f32 v172,v168,v169
 v_cvt_pk_bf16_f32 v173,v170,v171
 s_mov_b32 s34,147456
 buffer_store_dwordx2 v[172:173],v4,s[52:55],s34 offen offset:160
 s_endpgm
K2_r1:
 s_cmp_lg_u32 s24,2
 s_cbranch_scc1 K2_r2
 s_waitcnt vmcnt(0)
 s_waitcnt lgkmcnt(15)
 v_mfma_f32_16x16x32_bf16 a[0:3],v[136:139],v[40:43],a[0:3]
 v_mfma_f32_16x16x32_bf16 a[4:7],v[136:139],v[44:47],a[4:7]
 ds_read_b64_tr_b16 v[120:121],v18 offset:128
 v_mfma_f32_16x16x32_bf16 a[8:11],v[136:139],v[48:51],a[8:11]
 ds_read_b64_tr_b16 v[122:123],v18 offset:6272
 v_add_u32 v5,0,v2
 v_add_u32 v9,98304,v2
 v_mfma_f32_16x16x32_bf16 a[12:15],v[136:139],v[52:55],a[12:15]
 v_add_u32 v6,12288,v2
 v_add_u32 v10,110592,v2
 v_mfma_f32_16x16x32_bf16 a[16:19],v[136:139],v[56:59],a[16:19]
 v_add_u32 v7,36864,v2
 v_add_u32 v11,135168,v2
 v_mfma_f32_16x16x32_bf16 a[20:23],v[136:139],v[60:63],a[20:23]
 s_waitcnt lgkmcnt(15)
 v_mfma_f32_16x16x32_bf16 a[24:27],v[140:143],v[40:43],a[24:27]
 v_mfma_f32_16x16x32_bf16 a[28:31],v[140:143],v[44:47],a[28:31]
 ds_read_b64_tr_b16 v[124:125],v19 offset:128
 v_mfma_f32_16x16x32_bf16 a[32:35],v[140:143],v[48:51],a[32:35]
 ds_read_b64_tr_b16 v[126:127],v19 offset:6272
 v_mfma_f32_16x16x32_bf16 a[36:39],v[140:143],v[52:55],a[36:39]
 v_mfma_f32_16x16x32_bf16 a[40:43],v[140:143],v[56:59],a[40:43]
 v_mfma_f32_16x16x32_bf16 a[44:47],v[140:143],v[60:63],a[44:47]
 s_waitcnt lgkmcnt(13)
 v_mfma_f32_16x16x32_bf16 a[48:51],v[112:115],v[40:43],a[48:51]
 v_mfma_f32_16x16x32_bf16 a[52:55],v[112:115],v[44:47],a[52:55]
 v_mfma_f32_16x16x32_bf16 a[56:59],v[112:115],v[48:51],a[56:59]
 s_waitcnt lgkmcnt(0)
 v_mfma_f32_16x16x32_bf16 a[60:63],v[112:115],v[52:55],a[60:63]
 ds_write_b128 v3,a[0:3] offset:0
 ds_write_b128 v3,a[4:7] offset:1024
 v_mfma_f32_16x16x32_bf16 a[64:67],v[112:115],v[56:59],a[64:67]
 ds_write_b128 v3,a[12:15] offset:3072
 v_mfma_f32_16x16x32_bf16 a[68:71],v[112:115],v[60:63],a[68:71]
 ds_write_b128 v3,a[16:19] offset:4096
 ds_write_b128 v3,a[20:23] offset:5120
 v_mfma_f32_16x16x32_bf16 a[72:75],v[116:119],v[40:43],a[72:75]
 ds_write_b128 v3,a[24:27] offset:6144
 v_mfma_f32_16x16x32_bf16 a[76:79],v[116:119],v[44:47],a[76:79]
 ds_write_b128 v3,a[28:31] offset:7168
 ds_write_b128 v3,a[36:39] offset:9216
 v_mfma_f32_16x16x32_bf16 a[80:83],v[116:119],v[48:51],a[80:83]
 ds_write_b128 v3,a[40:43] offset:10240
 v_mfma_f32_16x16x32_bf16 a[84:87],v[116:119],v[52:55],a[84:87]
 ds_write_b128 v3,a[44:47] offset:11264
 v_mfma_f32_16x16x32_bf16 a[88:91],v[116:119],v[56:59],a[88:91]
 ds_write_b128 v3,a[52:55] offset:50176
 v_mfma_f32_16x16x32_bf16 a[92:95],v[116:119],v[60:63],a[92:95]
 ds_write_b128 v3,a[56:59] offset:51200
 v_mfma_f32_16x16x32_bf16 a[96:99],v[120:123],v[40:43],a[96:99]
 ds_write_b128 v3,a[60:63] offset:52224
 v_mfma_f32_16x16x32_bf16 a[100:103],v[120:123],v[44:47],a[100:103]
 v_mfma_f32_16x16x32_bf16 a[104:107],v[120:123],v[48:51],a[104:107]
 ds_write_b128 v3,a[68:71] offset:54272
 v_mfma_f32_16x16x32_bf16 a[108:111],v[120:123],v[52:55],a[108:111]
 v_mfma_f32_16x16x32_bf16 a[112:115],v[120:123],v[56:59],a[112:115]
 ds_write_b128 v3,a[76:79] offset:56320
 v_mfma_f32_16x16x32_bf16 a[116:119],v[120:123],v[60:63],a[116:119]
 ds_write_b128 v3,a[80:83] offset:57344
 v_mfma_f32_16x16x32_bf16 a[120:123],v[124:127],v[40:43],a[120:123]
 ds_write_b128 v3,a[84:87] offset:58368
 v_mfma_f32_16x16x32_bf16 a[124:127],v[124:127],v[44:47],a[124:127]
 v_mfma_f32_16x16x32_bf16 a[128:131],v[124:127],v[48:51],a[128:131]
 ds_write_b128 v3,a[92:95] offset:60416
 v_mfma_f32_16x16x32_bf16 a[132:135],v[124:127],v[52:55],a[132:135]
 ds_write_b128 v8,a[96:99] offset:0
 v_mfma_f32_16x16x32_bf16 a[136:139],v[124:127],v[56:59],a[136:139]
 ds_write_b128 v8,a[100:103] offset:1024
 v_mfma_f32_16x16x32_bf16 a[140:143],v[124:127],v[60:63],a[140:143]
 v_mfma_f32_16x16x32_bf16 a[144:147],v[144:147],v[88:91],a[144:147]
 ds_write_b128 v8,a[108:111] offset:3072
 v_mfma_f32_16x16x32_bf16 a[148:151],v[144:147],v[92:95],a[148:151]
 ds_write_b128 v8,a[112:115] offset:4096
 v_mfma_f32_16x16x32_bf16 a[152:155],v[144:147],v[96:99],a[152:155]
 v_mfma_f32_16x16x32_bf16 a[156:159],v[144:147],v[100:103],a[156:159]
 ds_write_b128 v8,a[120:123] offset:6144
 v_mfma_f32_16x16x32_bf16 a[160:163],v[144:147],v[104:107],a[160:163]
 ds_write_b128 v8,a[124:127] offset:7168
 v_mfma_f32_16x16x32_bf16 a[164:167],v[144:147],v[108:111],a[164:167]
 v_mfma_f32_16x16x32_bf16 a[168:171],v[148:151],v[88:91],a[168:171]
 ds_write_b128 v8,a[132:135] offset:9216
 v_mfma_f32_16x16x32_bf16 a[172:175],v[148:151],v[92:95],a[172:175]
 ds_write_b128 v8,a[136:139] offset:10240
 v_mfma_f32_16x16x32_bf16 a[176:179],v[148:151],v[96:99],a[176:179]
 ds_write_b128 v8,a[140:143] offset:11264
 v_mfma_f32_16x16x32_bf16 a[180:183],v[148:151],v[100:103],a[180:183]
 v_mfma_f32_16x16x32_bf16 a[184:187],v[148:151],v[104:107],a[184:187]
 v_mfma_f32_16x16x32_bf16 a[188:191],v[148:151],v[108:111],a[188:191]
 v_mfma_f32_16x16x32_bf16 a[192:195],v[152:155],v[88:91],a[192:195]
 s_waitcnt lgkmcnt(0)
 s_barrier
 v_mfma_f32_16x16x32_bf16 a[196:199],v[152:155],v[92:95],a[196:199]
 ds_read_b128 v[68:71],v5 offset:2048
 ds_read_b128 v[72:75],v6 offset:2048
 ds_read_b128 v[76:79],v7 offset:2048
 ds_read_b128 v[84:87],v5 offset:8192
 v_mfma_f32_16x16x32_bf16 a[200:203],v[152:155],v[96:99],a[200:203]
 ds_read_b128 v[192:195],v6 offset:8192
 ds_read_b128 v[196:199],v7 offset:8192
 ds_read_b128 v[28:31],v5 offset:49152
 ds_read_b128 v[32:35],v6 offset:49152
 v_mfma_f32_16x16x32_bf16 a[204:207],v[152:155],v[100:103],a[204:207]
 ds_read_b128 v[36:39],v7 offset:49152
 ds_read_b128 v[204:207],v5 offset:55296
 ds_read_b128 v[208:211],v6 offset:55296
 ds_read_b128 v[212:215],v7 offset:55296
 v_mfma_f32_16x16x32_bf16 a[208:211],v[152:155],v[104:107],a[208:211]
 ds_read_b128 v[112:115],v5 offset:53248
 ds_read_b128 v[116:119],v6 offset:53248
 ds_read_b128 v[120:123],v7 offset:53248
 ds_read_b128 v[128:131],v5 offset:59392
 v_mfma_f32_16x16x32_bf16 a[212:215],v[152:155],v[108:111],a[212:215]
 ds_read_b128 v[132:135],v6 offset:59392
 ds_read_b128 v[136:139],v7 offset:59392
 v_accvgpr_read_b32 v64,a8
 v_accvgpr_read_b32 v65,a9
 v_mfma_f32_16x16x32_bf16 a[216:219],v[156:159],v[88:91],a[216:219]
 v_accvgpr_read_b32 v66,a10
 v_accvgpr_read_b32 v67,a11
 s_waitcnt lgkmcnt(15)
 v_add_f32 v64,v64,v68
 v_add_f32 v65,v65,v69
 v_mfma_f32_16x16x32_bf16 a[220:223],v[156:159],v[92:95],a[220:223]
 v_add_f32 v66,v66,v70
 v_add_f32 v67,v67,v71
 s_waitcnt lgkmcnt(15)
 v_add_f32 v72,v72,v76
 v_add_f32 v73,v73,v77
 v_mfma_f32_16x16x32_bf16 a[224:227],v[156:159],v[96:99],a[224:227]
 v_add_f32 v74,v74,v78
 v_add_f32 v75,v75,v79
 v_add_f32 v64,v64,v72
 v_add_f32 v65,v65,v73
 v_mfma_f32_16x16x32_bf16 a[228:231],v[156:159],v[100:103],a[228:231]
 v_add_f32 v66,v66,v74
 v_add_f32 v67,v67,v75
 s_movk_i32 s34,0
 buffer_store_dwordx4 v[64:67],v2,s[8:11],s34 offen offset:0 sc0 sc1
 ds_read_b128 v[68:71],v9 offset:2048
 v_mfma_f32_16x16x32_bf16 a[232:235],v[156:159],v[104:107],a[232:235]
 ds_read_b128 v[72:75],v10 offset:2048
 ds_read_b128 v[76:79],v11 offset:2048
 v_accvgpr_read_b32 v80,a32
 v_accvgpr_read_b32 v81,a33
 v_mfma_f32_16x16x32_bf16 a[236:239],v[156:159],v[108:111],a[236:239]
 v_accvgpr_read_b32 v82,a34
 v_accvgpr_read_b32 v83,a35
 s_waitcnt lgkmcnt(15)
 v_add_f32 v80,v80,v84
 v_add_f32 v81,v81,v85
 v_mfma_f32_16x16x32_bf16 a[240:243],v[160:163],v[88:91],a[240:243]
 v_add_f32 v82,v82,v86
 v_add_f32 v83,v83,v87
 s_waitcnt lgkmcnt(15)
 v_add_f32 v192,v192,v196
 v_add_f32 v193,v193,v197
 v_mfma_f32_16x16x32_bf16 a[244:247],v[160:163],v[92:95],a[244:247]
 v_add_f32 v194,v194,v198
 v_add_f32 v195,v195,v199
 v_add_f32 v80,v80,v192
 v_add_f32 v81,v81,v193
 v_mfma_f32_16x16x32_bf16 a[248:251],v[160:163],v[96:99],a[248:251]
 v_add_f32 v82,v82,v194
 v_add_f32 v83,v83,v195
 buffer_store_dwordx4 v[80:83],v2,s[8:11],s34 offen offset:1024 sc0 sc1
 ds_read_b128 v[84:87],v9 offset:8192
 v_mfma_f32_16x16x32_bf16 a[252:255],v[160:163],v[100:103],a[252:255]
 ds_read_b128 v[192:195],v10 offset:8192
 ds_read_b128 v[196:199],v11 offset:8192
 v_accvgpr_read_b32 v24,a48
 v_accvgpr_read_b32 v25,a49
 v_mfma_f32_16x16x32_bf16 v[224:227],v[160:163],v[104:107],v[224:227]
 v_accvgpr_read_b32 v26,a50
 v_accvgpr_read_b32 v27,a51
 s_waitcnt lgkmcnt(15)
 v_add_f32 v24,v24,v28
 v_add_f32 v25,v25,v29
 v_mfma_f32_16x16x32_bf16 v[228:231],v[160:163],v[108:111],v[228:231]
 v_add_f32 v26,v26,v30
 v_add_f32 v27,v27,v31
 s_waitcnt lgkmcnt(15)
 v_add_f32 v32,v32,v36
 v_add_f32 v33,v33,v37
 v_mfma_f32_16x16x32_bf16 v[232:235],v[164:167],v[88:91],v[232:235]
 v_add_f32 v34,v34,v38
 v_add_f32 v35,v35,v39
 v_add_f32 v24,v24,v32
 v_add_f32 v25,v25,v33
 v_mfma_f32_16x16x32_bf16 v[236:239],v[164:167],v[92:95],v[236:239]
 v_add_f32 v26,v26,v34
 v_add_f32 v27,v27,v35
 buffer_store_dwordx4 v[24:27],v2,s[8:11],s34 offen offset:2048 sc0 sc1
 ds_read_b128 v[28:31],v9 offset:5120
 v_mfma_f32_16x16x32_bf16 v[240:243],v[164:167],v[96:99],v[240:243]
 ds_read_b128 v[32:35],v10 offset:5120
 ds_read_b128 v[36:39],v11 offset:5120
 v_accvgpr_read_b32 v200,a72
 v_accvgpr_read_b32 v201,a73
 v_mfma_f32_16x16x32_bf16 v[244:247],v[164:167],v[100:103],v[244:247]
 v_accvgpr_read_b32 v202,a74
 v_accvgpr_read_b32 v203,a75
 s_waitcnt lgkmcnt(15)
 v_add_f32 v200,v200,v204
 v_add_f32 v201,v201,v205
 v_mfma_f32_16x16x32_bf16 v[248:251],v[164:167],v[104:107],v[248:251]
 v_add_f32 v202,v202,v206
 v_add_f32 v203,v203,v207
 s_waitcnt lgkmcnt(15)
 v_add_f32 v208,v208,v212
 v_add_f32 v209,v209,v213
 v_mfma_f32_16x16x32_bf16 v[252:255],v[164:167],v[108:111],v[252:255]
 v_add_f32 v210,v210,v214
 v_add_f32 v211,v211,v215
 v_add_f32 v200,v200,v208
 v_add_f32 v201,v201,v209
 v_mfma_f32_16x16x32_bf16 a[144:147],v[168:171],v[40:43],a[144:147]
 v_add_f32 v202,v202,v210
 v_add_f32 v203,v203,v211
 buffer_store_dwordx4 v[200:203],v2,s[8:11],s34 offen offset:3072 sc0 sc1
 v_accvgpr_read_b32 v216,a64
 v_mfma_f32_16x16x32_bf16 a[148:151],v[168:171],v[44:47],a[148:151]
 v_accvgpr_read_b32 v217,a65
 v_accvgpr_read_b32 v218,a66
 v_accvgpr_read_b32 v219,a67
 s_waitcnt lgkmcnt(14)
 v_add_f32 v216,v216,v112
 s_waitcnt lgkmcnt(0)
 s_barrier
 v_mfma_f32_16x16x32_bf16 a[152:155],v[168:171],v[48:51],a[152:155]
 v_add_f32 v217,v217,v113
 v_add_f32 v218,v218,v114
 v_add_f32 v219,v219,v115
 v_add_f32 v116,v116,v120
 v_mfma_f32_16x16x32_bf16 a[156:159],v[168:171],v[52:55],a[156:159]
 v_add_f32 v117,v117,v121
 v_add_f32 v118,v118,v122
 v_add_f32 v119,v119,v123
 v_add_f32 v216,v216,v116
 v_mfma_f32_16x16x32_bf16 a[160:163],v[168:171],v[56:59],a[160:163]
 v_add_f32 v217,v217,v117
 v_add_f32 v218,v218,v118
 v_add_f32 v219,v219,v119
 s_movk_i32 s34,4096
 buffer_store_dwordx4 v[216:219],v2,s[8:11],s34 offen offset:0 sc0 sc1
 v_mfma_f32_16x16x32_bf16 a[164:167],v[168:171],v[60:63],a[164:167]
 v_accvgpr_read_b32 v124,a88
 v_accvgpr_read_b32 v125,a89
 v_accvgpr_read_b32 v126,a90
 v_accvgpr_read_b32 v127,a91
 v_mfma_f32_16x16x32_bf16 a[168:171],v[172:175],v[40:43],a[168:171]
 v_add_f32 v124,v124,v128
 v_add_f32 v125,v125,v129
 v_add_f32 v126,v126,v130
 v_add_f32 v127,v127,v131
 v_mfma_f32_16x16x32_bf16 a[172:175],v[172:175],v[44:47],a[172:175]
 v_add_f32 v132,v132,v136
 v_add_f32 v133,v133,v137
 v_add_f32 v134,v134,v138
 v_add_f32 v135,v135,v139
 v_mfma_f32_16x16x32_bf16 a[176:179],v[172:175],v[48:51],a[176:179]
 v_add_f32 v124,v124,v132
 v_add_f32 v125,v125,v133
 v_add_f32 v126,v126,v134
 v_add_f32 v127,v127,v135
 v_mfma_f32_16x16x32_bf16 a[180:183],v[172:175],v[52:55],a[180:183]
 ds_write_b128 v3,a[144:147] offset:0
 buffer_store_dwordx4 v[124:127],v2,s[8:11],s34 offen offset:1024 sc0 sc1
 v_accvgpr_read_b32 v64,a104
 v_accvgpr_read_b32 v65,a105
 v_accvgpr_read_b32 v66,a106
 v_mfma_f32_16x16x32_bf16 a[184:187],v[172:175],v[56:59],a[184:187]
 ds_write_b128 v3,a[148:151] offset:1024
 v_accvgpr_read_b32 v67,a107
 v_add_f32 v64,v64,v68
 v_add_f32 v65,v65,v69
 v_add_f32 v66,v66,v70
 v_mfma_f32_16x16x32_bf16 a[188:191],v[172:175],v[60:63],a[188:191]
 v_add_f32 v67,v67,v71
 v_add_f32 v72,v72,v76
 v_add_f32 v73,v73,v77
 v_add_f32 v74,v74,v78
 v_mfma_f32_16x16x32_bf16 a[192:195],v[176:179],v[40:43],a[192:195]
 buffer_load_dword v22,off,s[80:83],s87 sc0 sc1
 ds_write_b128 v3,a[156:159] offset:3072
 v_add_f32 v75,v75,v79
 v_add_f32 v64,v64,v72
 v_add_f32 v65,v65,v73
 v_add_f32 v66,v66,v74
 v_mfma_f32_16x16x32_bf16 a[196:199],v[176:179],v[44:47],a[196:199]
 ds_write_b128 v3,a[160:163] offset:4096
 v_add_f32 v67,v67,v75
 buffer_store_dwordx4 v[64:67],v2,s[8:11],s34 offen offset:2048 sc0 sc1
 v_accvgpr_read_b32 v80,a128
 v_accvgpr_read_b32 v81,a129
 v_mfma_f32_16x16x32_bf16 a[200:203],v[176:179],v[48:51],a[200:203]
 ds_write_b128 v3,a[164:167] offset:5120
 v_accvgpr_read_b32 v82,a130
 v_accvgpr_read_b32 v83,a131
 v_add_f32 v80,v80,v84
 v_add_f32 v81,v81,v85
 v_mfma_f32_16x16x32_bf16 a[204:207],v[176:179],v[52:55],a[204:207]
 ds_write_b128 v3,a[168:171] offset:6144
 v_add_f32 v82,v82,v86
 v_add_f32 v83,v83,v87
 v_add_f32 v192,v192,v196
 v_add_f32 v193,v193,v197
 v_mfma_f32_16x16x32_bf16 a[208:211],v[176:179],v[56:59],a[208:211]
 ds_write_b128 v3,a[172:175] offset:7168
 v_add_f32 v194,v194,v198
 v_add_f32 v195,v195,v199
 v_add_f32 v80,v80,v192
 v_add_f32 v81,v81,v193
 v_mfma_f32_16x16x32_bf16 a[212:215],v[176:179],v[60:63],a[212:215]
 v_add_f32 v82,v82,v194
 v_add_f32 v83,v83,v195
 buffer_store_dwordx4 v[80:83],v2,s[8:11],s34 offen offset:3072 sc0 sc1
 v_accvgpr_read_b32 v24,a116
 v_mfma_f32_16x16x32_bf16 a[216:219],v[180:183],v[40:43],a[216:219]
 ds_write_b128 v3,a[180:183] offset:9216
 v_accvgpr_read_b32 v25,a117
 v_accvgpr_read_b32 v26,a118
 v_accvgpr_read_b32 v27,a119
 v_add_f32 v24,v24,v28
 v_mfma_f32_16x16x32_bf16 a[220:223],v[180:183],v[44:47],a[220:223]
 ds_write_b128 v3,a[184:187] offset:10240
 v_add_f32 v25,v25,v29
 v_add_f32 v26,v26,v30
 v_add_f32 v27,v27,v31
 v_add_f32 v32,v32,v36
 v_mfma_f32_16x16x32_bf16 a[224:227],v[180:183],v[48:51],a[224:227]
 ds_write_b128 v3,a[188:191] offset:11264
 v_add_f32 v33,v33,v37
 v_add_f32 v34,v34,v38
 v_add_f32 v35,v35,v39
 v_add_f32 v24,v24,v32
 v_mfma_f32_16x16x32_bf16 a[228:231],v[180:183],v[52:55],a[228:231]
 v_add_f32 v25,v25,v33
 v_add_f32 v26,v26,v34
 v_add_f32 v27,v27,v35
 s_movk_i32 s34,8192
 buffer_store_dwordx4 v[24:27],v2,s[8:11],s34 offen offset:0 sc0 sc1
 v_mfma_f32_16x16x32_bf16 a[232:235],v[180:183],v[56:59],a[232:235]
 ds_write_b128 v3,a[196:199] offset:50176
 v_mfma_f32_16x16x32_bf16 a[236:239],v[180:183],v[60:63],a[236:239]
 ds_write_b128 v3,a[200:203] offset:51200
 v_mfma_f32_16x16x32_bf16 a[240:243],v[184:187],v[40:43],a[240:243]
 ds_write_b128 v3,a[204:207] offset:52224
 v_mfma_f32_16x16x32_bf16 a[244:247],v[184:187],v[44:47],a[244:247]
 v_mfma_f32_16x16x32_bf16 a[248:251],v[184:187],v[48:51],a[248:251]
 ds_write_b128 v3,a[212:215] offset:54272
 v_mfma_f32_16x16x32_bf16 a[252:255],v[184:187],v[52:55],a[252:255]
 v_mfma_f32_16x16x32_bf16 v[224:227],v[184:187],v[56:59],v[224:227]
 ds_write_b128 v3,a[220:223] offset:56320
 v_mfma_f32_16x16x32_bf16 v[228:231],v[184:187],v[60:63],v[228:231]
 ds_write_b128 v3,a[224:227] offset:57344
 v_mfma_f32_16x16x32_bf16 v[232:235],v[188:191],v[40:43],v[232:235]
 ds_write_b128 v3,a[228:231] offset:58368
 v_mfma_f32_16x16x32_bf16 v[236:239],v[188:191],v[44:47],v[236:239]
 v_mfma_f32_16x16x32_bf16 v[240:243],v[188:191],v[48:51],v[240:243]
 ds_write_b128 v3,a[236:239] offset:60416
 v_mfma_f32_16x16x32_bf16 v[244:247],v[188:191],v[52:55],v[244:247]
 ds_write_b128 v8,a[240:243] offset:0
 v_mfma_f32_16x16x32_bf16 v[248:251],v[188:191],v[56:59],v[248:251]
 ds_write_b128 v8,a[244:247] offset:1024
 v_mfma_f32_16x16x32_bf16 v[252:255],v[188:191],v[60:63],v[252:255]
 s_waitcnt vmcnt(3)
 v_cmp_eq_u32 vcc,0,v22
 s_nop 1
 s_mov_b64 s[70:71],vcc
 s_cbranch_vccnz OP_e2
 s_movk_i32 s34,0
 buffer_load_dwordx4 v[184:187],v2,s[4:7],s34 offen offset:0 sc0 sc1
 buffer_load_dwordx4 v[188:191],v2,s[4:7],s34 offen offset:1024 sc0 sc1
 buffer_load_dwordx4 v[200:203],v2,s[4:7],s34 offen offset:2048 sc0 sc1
 buffer_load_dwordx4 v[204:207],v2,s[4:7],s34 offen offset:3072 sc0 sc1
 s_movk_i32 s34,4096
 buffer_load_dwordx4 v[208:211],v2,s[4:7],s34 offen offset:0 sc0 sc1
 buffer_load_dwordx4 v[212:215],v2,s[4:7],s34 offen offset:1024 sc0 sc1
 buffer_load_dwordx4 v[216:219],v2,s[4:7],s34 offen offset:2048 sc0 sc1
 buffer_load_dwordx4 v[192:195],v2,s[4:7],s34 offen offset:3072 sc0 sc1
 s_movk_i32 s34,8192
 buffer_load_dwordx4 v[196:199],v2,s[4:7],s34 offen offset:0 sc0 sc1
OP_e2:
 s_nop 4
 ds_write_b128 v8,a[252:255] offset:3072
 ds_write_b128 v8,v[224:227] offset:4096
 ds_write_b128 v8,v[232:235] offset:6144
 ds_write_b128 v8,v[236:239] offset:7168
 ds_write_b128 v8,v[244:247] offset:9216
 ds_write_b128 v8,v[248:251] offset:10240
 s_waitcnt vmcnt(0)
 buffer_store_dword v1,v12,s[80:83],s99 offen sc0 sc1
 ds_write_b128 v8,v[252:255] offset:11264
 v_accvgpr_read_b32 v40,a152
 v_accvgpr_read_b32 v41,a153
 v_accvgpr_read_b32 v42,a154
 v_accvgpr_read_b32 v43,a155
 v_accvgpr_read_b32 v56,a176
 v_accvgpr_read_b32 v57,a177
 v_accvgpr_read_b32 v58,a178
 v_accvgpr_read_b32 v59,a179
 v_accvgpr_read_b32 v72,a192
 v_accvgpr_read_b32 v73,a193
 v_accvgpr_read_b32 v74,a194
 v_accvgpr_read_b32 v75,a195
 v_accvgpr_read_b32 v88,a216
 v_accvgpr_read_b32 v89,a217
 v_accvgpr_read_b32 v90,a218
 v_accvgpr_read_b32 v91,a219
 v_accvgpr_read_b32 v104,a208
 v_accvgpr_read_b32 v105,a209
 v_accvgpr_read_b32 v106,a210
 v_accvgpr_read_b32 v107,a211
 v_accvgpr_read_b32 v120,a232
 v_accvgpr_read_b32 v121,a233
 v_accvgpr_read_b32 v122,a234
 v_accvgpr_read_b32 v123,a235
 v_accvgpr_read_b32 v136,a248
 v_accvgpr_read_b32 v137,a249
 v_accvgpr_read_b32 v138,a250
 v_accvgpr_read_b32 v139,a251
 v_mov_b32 v152,v240
 v_mov_b32 v153,v241
 v_mov_b32 v154,v242
 v_mov_b32 v155,v243
 v_mov_b32 v168,v228
 v_mov_b32 v169,v229
 v_mov_b32 v170,v230
 v_mov_b32 v171,v231
 s_waitcnt lgkmcnt(0)
 s_barrier
 ds_read_b128 v[44:47],v5 offset:2048
 ds_read_b128 v[48:51],v6 offset:2048
 ds_read_b128 v[52:55],v7 offset:2048
 ds_read_b128 v[60:63],v5 offset:8192
 ds_read_b128 v[64:67],v6 offset:8192
 ds_read_b128 v[68:71],v7 offset:8192
 ds_read_b128 v[76:79],v5 offset:49152
 ds_read_b128 v[80:83],v6 offset:49152
 ds_read_b128 v[84:87],v7 offset:49152
 ds_read_b128 v[92:95],v5 offset:55296
 ds_read_b128 v[96:99],v6 offset:55296
 ds_read_b128 v[100:103],v7 offset:55296
 ds_read_b128 v[108:111],v5 offset:53248
 ds_read_b128 v[112:115],v6 offset:53248
 ds_read_b128 v[116:119],v7 offset:53248
 ds_read_b128 v[124:127],v5 offset:59392
 ds_read_b128 v[128:131],v6 offset:59392
 ds_read_b128 v[132:135],v7 offset:59392
 ds_read_b128 v[140:143],v9 offset:2048
 ds_read_b128 v[144:147],v10 offset:2048
 ds_read_b128 v[148:151],v11 offset:2048
 ds_read_b128 v[156:159],v9 offset:8192
 ds_read_b128 v[160:163],v10 offset:8192
 ds_read_b128 v[164:167],v11 offset:8192
 ds_read_b128 v[172:175],v9 offset:5120
 ds_read_b128 v[176:179],v10 offset:5120
 ds_read_b128 v[180:183],v11 offset:5120
 s_cmp_eq_u32 s70,0
 s_cbranch_scc1 OP_f2
 s_branch OP_spin4
OP_back4:
 s_movk_i32 s34,0
 buffer_load_dwordx4 v[184:187],v2,s[4:7],s34 offen offset:0 sc0 sc1
 buffer_load_dwordx4 v[188:191],v2,s[4:7],s34 offen offset:1024 sc0 sc1
 buffer_load_dwordx4 v[200:203],v2,s[4:7],s34 offen offset:2048 sc0 sc1
 buffer_load_dwordx4 v[204:207],v2,s[4:7],s34 offen offset:3072 sc0 sc1
 s_movk_i32 s34,4096
 buffer_load_dwordx4 v[208:211],v2,s[4:7],s34 offen offset:0 sc0 sc1
 buffer_load_dwordx4 v[212:215],v2,s[4:7],s34 offen offset:1024 sc0 sc1
 buffer_load_dwordx4 v[216:219],v2,s[4:7],s34 offen offset:2048 sc0 sc1
 buffer_load_dwordx4 v[192:195],v2,s[4:7],s34 offen offset:3072 sc0 sc1
 s_movk_i32 s34,8192
 buffer_load_dwordx4 v[196:199],v2,s[4:7],s34 offen offset:0 sc0 sc1
OP_f2:
 v_and_b32 v18,15,v0
 v_mul_u32_u24 v18,2304,v18
 v_bfe_u32 v19,v0,4,1
 v_lshl_add_u32 v18,v19,5,v18
 v_lshrrev_b32 v19,5,v0
 v_lshl_add_u32 v18,v19,4,v18
 s_waitcnt lgkmcnt(15)
 v_add_f32 v40,v40,v44
 v_add_f32 v41,v41,v45
 v_add_f32 v42,v42,v46
 v_add_f32 v43,v43,v47
 s_waitcnt lgkmcnt(15)
 v_add_f32 v48,v48,v52
 v_add_f32 v49,v49,v53
 v_add_f32 v50,v50,v54
 v_add_f32 v51,v51,v55
 v_add_f32 v40,v40,v48
 v_add_f32 v41,v41,v49
 v_add_f32 v42,v42,v50
 v_add_f32 v43,v43,v51
 s_waitcnt lgkmcnt(15)
 v_add_f32 v56,v56,v60
 v_add_f32 v57,v57,v61
 v_add_f32 v58,v58,v62
 v_add_f32 v59,v59,v63
 s_waitcnt lgkmcnt(15)
 v_add_f32 v64,v64,v68
 v_add_f32 v65,v65,v69
 v_add_f32 v66,v66,v70
 v_add_f32 v67,v67,v71
 v_add_f32 v56,v56,v64
 v_add_f32 v57,v57,v65
 v_add_f32 v58,v58,v66
 v_add_f32 v59,v59,v67
 s_waitcnt lgkmcnt(15)
 v_add_f32 v72,v72,v76
 v_add_f32 v73,v73,v77
 v_add_f32 v74,v74,v78
 v_add_f32 v75,v75,v79
 s_waitcnt lgkmcnt(15)
 v_add_f32 v80,v80,v84
 v_add_f32 v81,v81,v85
 v_add_f32 v82,v82,v86
 v_add_f32 v83,v83,v87
 v_add_f32 v72,v72,v80
 v_add_f32 v73,v73,v81
 v_add_f32 v74,v74,v82
 v_add_f32 v75,v75,v83
 s_waitcnt lgkmcnt(15)
 v_add_f32 v88,v88,v92
 v_add_f32 v89,v89,v93
 v_add_f32 v90,v90,v94
 v_add_f32 v91,v91,v95
 s_waitcnt lgkmcnt(15)
 v_add_f32 v96,v96,v100
 v_add_f32 v97,v97,v101
 v_add_f32 v98,v98,v102
 v_add_f32 v99,v99,v103
 v_add_f32 v88,v88,v96
 v_add_f32 v89,v89,v97
 v_add_f32 v90,v90,v98
 v_add_f32 v91,v91,v99
 s_waitcnt lgkmcnt(14)
 v_add_f32 v104,v104,v108
 v_add_f32 v105,v105,v109
 v_add_f32 v106,v106,v110
 v_add_f32 v107,v107,v111
 s_waitcnt lgkmcnt(12)
 v_add_f32 v112,v112,v116
 v_add_f32 v113,v113,v117
 v_add_f32 v114,v114,v118
 v_add_f32 v115,v115,v119
 v_add_f32 v104,v104,v112
 v_add_f32 v105,v105,v113
 v_add_f32 v106,v106,v114
 v_add_f32 v107,v107,v115
 s_waitcnt lgkmcnt(11)
 v_add_f32 v120,v120,v124
 v_add_f32 v121,v121,v125
 v_add_f32 v122,v122,v126
 v_add_f32 v123,v123,v127
 s_waitcnt lgkmcnt(9)
 v_add_f32 v128,v128,v132
 v_add_f32 v129,v129,v133
 v_add_f32 v130,v130,v134
 v_add_f32 v131,v131,v135
 v_add_f32 v120,v120,v128
 v_add_f32 v121,v121,v129
 v_add_f32 v122,v122,v130
 v_add_f32 v123,v123,v131
 s_waitcnt lgkmcnt(8)
 v_add_f32 v136,v136,v140
 v_add_f32 v137,v137,v141
 v_add_f32 v138,v138,v142
 v_add_f32 v139,v139,v143
 s_waitcnt lgkmcnt(6)
 v_add_f32 v144,v144,v148
 v_add_f32 v145,v145,v149
 v_add_f32 v146,v146,v150
 v_add_f32 v147,v147,v151
 v_add_f32 v136,v136,v144
 v_add_f32 v137,v137,v145
 v_add_f32 v138,v138,v146
 v_add_f32 v139,v139,v147
 s_waitcnt lgkmcnt(5)
 v_add_f32 v152,v152,v156
 v_add_f32 v153,v153,v157
 v_add_f32 v154,v154,v158
 v_add_f32 v155,v155,v159
 s_waitcnt lgkmcnt(3)
 v_add_f32 v160,v160,v164
 v_add_f32 v161,v161,v165
 v_add_f32 v162,v162,v166
 v_add_f32 v163,v163,v167
 v_add_f32 v152,v152,v160
 v_add_f32 v153,v153,v161
 v_add_f32 v154,v154,v162
 v_add_f32 v155,v155,v163
 s_waitcnt lgkmcnt(2)
 v_add_f32 v168,v168,v172
 v_add_f32 v169,v169,v173
 v_add_f32 v170,v170,v174
 v_add_f32 v171,v171,v175
 s_waitcnt lgkmcnt(0)
 v_add_f32 v176,v176,v180
 v_add_f32 v177,v177,v181
 v_add_f32 v178,v178,v182
 v_add_f32 v179,v179,v183
 v_add_f32 v168,v168,v176
 v_add_f32 v169,v169,v177
 v_add_f32 v170,v170,v178
 v_add_f32 v171,v171,v179
 s_waitcnt vmcnt(7)
 v_add_f32 v40,v40,v184
 v_add_f32 v41,v41,v185
 v_add_f32 v42,v42,v186
 v_add_f32 v43,v43,v187
 v_add_f32 v56,v56,v188
 v_add_f32 v57,v57,v189
 v_add_f32 v58,v58,v190
 v_add_f32 v59,v59,v191
 v_cvt_pk_bf16_f32 v44,v40,v41
 v_cvt_pk_bf16_f32 v45,v42,v43
 v_cvt_pk_bf16_f32 v46,v56,v57
 v_cvt_pk_bf16_f32 v47,v58,v59
 s_mov_b32 s34,73728
 s_nop 0
 v_permlane16_swap_b32 v44,v46
 v_permlane16_swap_b32 v45,v47
 buffer_store_dwordx4 v[44:47],v18,s[52:55],s34 offen offset:0
 s_waitcnt vmcnt(6)
 v_add_f32 v72,v72,v200
 v_add_f32 v73,v73,v201
 v_add_f32 v74,v74,v202
 v_add_f32 v75,v75,v203
 v_add_f32 v88,v88,v204
 v_add_f32 v89,v89,v205
 v_add_f32 v90,v90,v206
 v_add_f32 v91,v91,v207
 v_cvt_pk_bf16_f32 v76,v72,v73
 v_cvt_pk_bf16_f32 v77,v74,v75
 v_cvt_pk_bf16_f32 v78,v88,v89
 v_cvt_pk_bf16_f32 v79,v90,v91
 s_mov_b32 s34,0
 s_nop 0
 v_permlane16_swap_b32 v76,v78
 v_permlane16_swap_b32 v77,v79
 buffer_store_dwordx4 v[76:79],v18,s[52:55],s34 offen offset:64
 s_waitcnt vmcnt(5)
 v_add_f32 v104,v104,v208
 v_add_f32 v105,v105,v209
 v_add_f32 v106,v106,v210
 v_add_f32 v107,v107,v211
 v_add_f32 v120,v120,v212
 v_add_f32 v121,v121,v213
 v_add_f32 v122,v122,v214
 v_add_f32 v123,v123,v215
 v_cvt_pk_bf16_f32 v108,v104,v105
 v_cvt_pk_bf16_f32 v109,v106,v107
 v_cvt_pk_bf16_f32 v110,v120,v121
 v_cvt_pk_bf16_f32 v111,v122,v123
 s_mov_b32 s34,147456
 s_nop 0
 v_permlane16_swap_b32 v108,v110
 v_permlane16_swap_b32 v109,v111
 buffer_store_dwordx4 v[108:111],v18,s[52:55],s34 offen offset:64
 s_waitcnt vmcnt(4)
 v_add_f32 v136,v136,v216
 v_add_f32 v137,v137,v217
 v_add_f32 v138,v138,v218
 v_add_f32 v139,v139,v219
 v_add_f32 v152,v152,v192
 v_add_f32 v153,v153,v193
 v_add_f32 v154,v154,v194
 v_add_f32 v155,v155,v195
 v_cvt_pk_bf16_f32 v140,v136,v137
 v_cvt_pk_bf16_f32 v141,v138,v139
 v_cvt_pk_bf16_f32 v142,v152,v153
 v_cvt_pk_bf16_f32 v143,v154,v155
 s_mov_b32 s34,73728
 s_nop 0
 v_permlane16_swap_b32 v140,v142
 v_permlane16_swap_b32 v141,v143
 buffer_store_dwordx4 v[140:143],v18,s[52:55],s34 offen offset:128
 s_waitcnt vmcnt(4)
 v_add_f32 v168,v168,v196
 v_add_f32 v169,v169,v197
 v_add_f32 v170,v170,v198
 v_add_f32 v171,v171,v199
 v_cvt_pk_bf16_f32 v172,v168,v169
 v_cvt_pk_bf16_f32 v173,v170,v171
 s_mov_b32 s34,184320
 buffer_store_dwordx2 v[172:173],v4,s[52:55],s34 offen offset:128
 s_endpgm
K2_r2:
 s_waitcnt vmcnt(0)
 s_waitcnt lgkmcnt(15)
 v_mfma_f32_16x16x32_bf16 a[0:3],v[136:139],v[40:43],a[0:3]
 v_mfma_f32_16x16x32_bf16 a[4:7],v[136:139],v[44:47],a[4:7]
 ds_read_b64_tr_b16 v[120:121],v18 offset:128
 v_mfma_f32_16x16x32_bf16 a[8:11],v[136:139],v[48:51],a[8:11]
 ds_read_b64_tr_b16 v[122:123],v18 offset:6272
 v_add_u32 v5,0,v2
 v_add_u32 v9,98304,v2
 v_mfma_f32_16x16x32_bf16 a[12:15],v[136:139],v[52:55],a[12:15]
 v_add_u32 v6,12288,v2
 v_add_u32 v10,110592,v2
 v_mfma_f32_16x16x32_bf16 a[16:19],v[136:139],v[56:59],a[16:19]
 v_add_u32 v7,24576,v2
 v_add_u32 v11,122880,v2
 v_mfma_f32_16x16x32_bf16 a[20:23],v[136:139],v[60:63],a[20:23]
 s_waitcnt lgkmcnt(15)
 v_mfma_f32_16x16x32_bf16 a[24:27],v[140:143],v[40:43],a[24:27]
 v_mfma_f32_16x16x32_bf16 a[28:31],v[140:143],v[44:47],a[28:31]
 ds_read_b64_tr_b16 v[124:125],v19 offset:128
 v_mfma_f32_16x16x32_bf16 a[32:35],v[140:143],v[48:51],a[32:35]
 ds_read_b64_tr_b16 v[126:127],v19 offset:6272
 v_mfma_f32_16x16x32_bf16 a[36:39],v[140:143],v[52:55],a[36:39]
 v_mfma_f32_16x16x32_bf16 a[40:43],v[140:143],v[56:59],a[40:43]
 v_mfma_f32_16x16x32_bf16 a[44:47],v[140:143],v[60:63],a[44:47]
 s_waitcnt lgkmcnt(13)
 v_mfma_f32_16x16x32_bf16 a[48:51],v[112:115],v[40:43],a[48:51]
 v_mfma_f32_16x16x32_bf16 a[52:55],v[112:115],v[44:47],a[52:55]
 v_mfma_f32_16x16x32_bf16 a[56:59],v[112:115],v[48:51],a[56:59]
 s_waitcnt lgkmcnt(0)
 v_mfma_f32_16x16x32_bf16 a[60:63],v[112:115],v[52:55],a[60:63]
 ds_write_b128 v3,a[0:3] offset:0
 ds_write_b128 v3,a[4:7] offset:1024
 v_mfma_f32_16x16x32_bf16 a[64:67],v[112:115],v[56:59],a[64:67]
 ds_write_b128 v3,a[8:11] offset:2048
 v_mfma_f32_16x16x32_bf16 a[68:71],v[112:115],v[60:63],a[68:71]
 ds_write_b128 v3,a[16:19] offset:4096
 ds_write_b128 v3,a[20:23] offset:5120
 v_mfma_f32_16x16x32_bf16 a[72:75],v[116:119],v[40:43],a[72:75]
 ds_write_b128 v3,a[24:27] offset:6144
 v_mfma_f32_16x16x32_bf16 a[76:79],v[116:119],v[44:47],a[76:79]
 ds_write_b128 v3,a[28:31] offset:7168
 ds_write_b128 v3,a[32:35] offset:8192
 v_mfma_f32_16x16x32_bf16 a[80:83],v[116:119],v[48:51],a[80:83]
 ds_write_b128 v3,a[40:43] offset:10240
 v_mfma_f32_16x16x32_bf16 a[84:87],v[116:119],v[52:55],a[84:87]
 ds_write_b128 v3,a[44:47] offset:11264
 ds_write_b128 v3,a[48:51] offset:49152
 v_mfma_f32_16x16x32_bf16 a[88:91],v[116:119],v[56:59],a[88:91]
 v_mfma_f32_16x16x32_bf16 a[92:95],v[116:119],v[60:63],a[92:95]
 ds_write_b128 v3,a[56:59] offset:51200
 v_mfma_f32_16x16x32_bf16 a[96:99],v[120:123],v[40:43],a[96:99]
 ds_write_b128 v3,a[60:63] offset:52224
 v_mfma_f32_16x16x32_bf16 a[100:103],v[120:123],v[44:47],a[100:103]
 ds_write_b128 v3,a[64:67] offset:53248
 v_mfma_f32_16x16x32_bf16 a[104:107],v[120:123],v[48:51],a[104:107]
 v_mfma_f32_16x16x32_bf16 a[108:111],v[120:123],v[52:55],a[108:111]
 ds_write_b128 v3,a[72:75] offset:55296
 v_mfma_f32_16x16x32_bf16 a[112:115],v[120:123],v[56:59],a[112:115]
 v_mfma_f32_16x16x32_bf16 a[116:119],v[120:123],v[60:63],a[116:119]
 ds_write_b128 v3,a[80:83] offset:57344
 v_mfma_f32_16x16x32_bf16 a[120:123],v[124:127],v[40:43],a[120:123]
 ds_write_b128 v3,a[84:87] offset:58368
 v_mfma_f32_16x16x32_bf16 a[124:127],v[124:127],v[44:47],a[124:127]
 ds_write_b128 v3,a[88:91] offset:59392
 v_mfma_f32_16x16x32_bf16 a[128:131],v[124:127],v[48:51],a[128:131]
 v_mfma_f32_16x16x32_bf16 a[132:135],v[124:127],v[52:55],a[132:135]
 ds_write_b128 v8,a[96:99] offset:0
 v_mfma_f32_16x16x32_bf16 a[136:139],v[124:127],v[56:59],a[136:139]
 ds_write_b128 v8,a[100:103] offset:1024
 v_mfma_f32_16x16x32_bf16 a[140:143],v[124:127],v[60:63],a[140:143]
 ds_write_b128 v8,a[104:107] offset:2048
 v_mfma_f32_16x16x32_bf16 a[144:147],v[144:147],v[88:91],a[144:147]
 v_mfma_f32_16x16x32_bf16 a[148:151],v[144:147],v[92:95],a[148:151]
 ds_write_b128 v8,a[112:115] offset:4096
 v_mfma_f32_16x16x32_bf16 a[152:155],v[144:147],v[96:99],a[152:155]
 ds_write_b128 v8,a[116:119] offset:5120
 v_mfma_f32_16x16x32_bf16 a[156:159],v[144:147],v[100:103],a[156:159]
 ds_write_b128 v8,a[120:123] offset:6144
 v_mfma_f32_16x16x32_bf16 a[160:163],v[144:147],v[104:107],a[160:163]
 ds_write_b128 v8,a[124:127] offset:7168
 v_mfma_f32_16x16x32_bf16 a[164:167],v[144:147],v[108:111],a[164:167]
 ds_write_b128 v8,a[128:131] offset:8192
 v_mfma_f32_16x16x32_bf16 a[168:171],v[148:151],v[88:91],a[168:171]
 v_mfma_f32_16x16x32_bf16 a[172:175],v[148:151],v[92:95],a[172:175]
 ds_write_b128 v8,a[136:139] offset:10240
 v_mfma_f32_16x16x32_bf16 a[176:179],v[148:151],v[96:99],a[176:179]
 v_mfma_f32_16x16x32_bf16 a[180:183],v[148:151],v[100:103],a[180:183]
 v_mfma_f32_16x16x32_bf16 a[184:187],v[148:151],v[104:107],a[184:187]
 v_mfma_f32_16x16x32_bf16 a[188:191],v[148:151],v[108:111],a[188:191]
 s_waitcnt lgkmcnt(0)
 s_barrier
 v_mfma_f32_16x16x32_bf16 a[192:195],v[152:155],v[88:91],a[192:195]
 ds_read_b128 v[68:71],v5 offset:3072
 ds_read_b128 v[72:75],v6 offset:3072
 ds_read_b128 v[76:79],v7 offset:3072
 ds_read_b128 v[84:87],v5 offset:9216
 v_mfma_f32_16x16x32_bf16 a[196:199],v[152:155],v[92:95],a[196:199]
 ds_read_b128 v[192:195],v6 offset:9216
 ds_read_b128 v[196:199],v7 offset:9216
 ds_read_b128 v[28:31],v5 offset:50176
 ds_read_b128 v[32:35],v6 offset:50176
 v_mfma_f32_16x16x32_bf16 a[200:203],v[152:155],v[96:99],a[200:203]
 ds_read_b128 v[36:39],v7 offset:50176
 ds_read_b128 v[204:207],v5 offset:56320
 ds_read_b128 v[208:211],v6 offset:56320
 ds_read_b128 v[212:215],v7 offset:56320
 v_mfma_f32_16x16x32_bf16 a[204:207],v[152:155],v[100:103],a[204:207]
 ds_read_b128 v[112:115],v5 offset:54272
 ds_read_b128 v[116:119],v6 offset:54272
 ds_read_b128 v[120:123],v7 offset:54272
 ds_read_b128 v[128:131],v5 offset:60416
 v_mfma_f32_16x16x32_bf16 a[208:211],v[152:155],v[104:107],a[208:211]
 ds_read_b128 v[132:135],v6 offset:60416
 ds_read_b128 v[136:139],v7 offset:60416
 v_accvgpr_read_b32 v64,a12
 v_accvgpr_read_b32 v65,a13
 v_mfma_f32_16x16x32_bf16 a[212:215],v[152:155],v[108:111],a[212:215]
 v_accvgpr_read_b32 v66,a14
 v_accvgpr_read_b32 v67,a15
 s_waitcnt lgkmcnt(15)
 v_add_f32 v64,v64,v68
 v_add_f32 v65,v65,v69
 v_mfma_f32_16x16x32_bf16 a[216:219],v[156:159],v[88:91],a[216:219]
 v_add_f32 v66,v66,v70
 v_add_f32 v67,v67,v71
 s_waitcnt lgkmcnt(15)
 v_add_f32 v72,v72,v76
 v_add_f32 v73,v73,v77
 v_mfma_f32_16x16x32_bf16 a[220:223],v[156:159],v[92:95],a[220:223]
 v_add_f32 v74,v74,v78
 v_add_f32 v75,v75,v79
 v_add_f32 v64,v64,v72
 v_add_f32 v65,v65,v73
 v_mfma_f32_16x16x32_bf16 a[224:227],v[156:159],v[96:99],a[224:227]
 v_add_f32 v66,v66,v74
 v_add_f32 v67,v67,v75
 s_movk_i32 s34,0
 buffer_store_dwordx4 v[64:67],v2,s[8:11],s34 offen offset:0 sc0 sc1
 ds_read_b128 v[68:71],v9 offset:3072
 v_mfma_f32_16x16x32_bf16 a[228:231],v[156:159],v[100:103],a[228:231]
 ds_read_b128 v[72:75],v10 offset:3072
 ds_read_b128 v[76:79],v11 offset:3072
 v_accvgpr_read_b32 v80,a36
 v_accvgpr_read_b32 v81,a37
 v_mfma_f32_16x16x32_bf16 a[232:235],v[156:159],v[104:107],a[232:235]
 v_accvgpr_read_b32 v82,a38
 v_accvgpr_read_b32 v83,a39
 s_waitcnt lgkmcnt(15)
 v_add_f32 v80,v80,v84
 v_add_f32 v81,v81,v85
 v_mfma_f32_16x16x32_bf16 a[236:239],v[156:159],v[108:111],a[236:239]
 v_add_f32 v82,v82,v86
 v_add_f32 v83,v83,v87
 s_waitcnt lgkmcnt(15)
 v_add_f32 v192,v192,v196
 v_add_f32 v193,v193,v197
 v_mfma_f32_16x16x32_bf16 a[240:243],v[160:163],v[88:91],a[240:243]
 v_add_f32 v194,v194,v198
 v_add_f32 v195,v195,v199
 v_add_f32 v80,v80,v192
 v_add_f32 v81,v81,v193
 v_mfma_f32_16x16x32_bf16 a[244:247],v[160:163],v[92:95],a[244:247]
 v_add_f32 v82,v82,v194
 v_add_f32 v83,v83,v195
 buffer_store_dwordx4 v[80:83],v2,s[8:11],s34 offen offset:1024 sc0 sc1
 ds_read_b128 v[84:87],v9 offset:9216
 v_mfma_f32_16x16x32_bf16 a[248:251],v[160:163],v[96:99],a[248:251]
 ds_read_b128 v[192:195],v10 offset:9216
 ds_read_b128 v[196:199],v11 offset:9216
 v_accvgpr_read_b32 v24,a52
 v_accvgpr_read_b32 v25,a53
 v_mfma_f32_16x16x32_bf16 a[252:255],v[160:163],v[100:103],a[252:255]
 v_accvgpr_read_b32 v26,a54
 v_accvgpr_read_b32 v27,a55
 s_waitcnt lgkmcnt(15)
 v_add_f32 v24,v24,v28
 v_add_f32 v25,v25,v29
 v_mfma_f32_16x16x32_bf16 v[224:227],v[160:163],v[104:107],v[224:227]
 v_add_f32 v26,v26,v30
 v_add_f32 v27,v27,v31
 s_waitcnt lgkmcnt(15)
 v_add_f32 v32,v32,v36
 v_add_f32 v33,v33,v37
 v_mfma_f32_16x16x32_bf16 v[228:231],v[160:163],v[108:111],v[228:231]
 v_add_f32 v34,v34,v38
 v_add_f32 v35,v35,v39
 v_add_f32 v24,v24,v32
 v_add_f32 v25,v25,v33
 v_mfma_f32_16x16x32_bf16 v[232:235],v[164:167],v[88:91],v[232:235]
 v_add_f32 v26,v26,v34
 v_add_f32 v27,v27,v35
 buffer_store_dwordx4 v[24:27],v2,s[8:11],s34 offen offset:2048 sc0 sc1
 ds_read_b128 v[28:31],v9 offset:11264
 v_mfma_f32_16x16x32_bf16 v[236:239],v[164:167],v[92:95],v[236:239]
 ds_read_b128 v[32:35],v10 offset:11264
 ds_read_b128 v[36:39],v11 offset:11264
 v_accvgpr_read_b32 v200,a76
 v_accvgpr_read_b32 v201,a77
 v_mfma_f32_16x16x32_bf16 v[240:243],v[164:167],v[96:99],v[240:243]
 v_accvgpr_read_b32 v202,a78
 v_accvgpr_read_b32 v203,a79
 s_waitcnt lgkmcnt(15)
 v_add_f32 v200,v200,v204
 v_add_f32 v201,v201,v205
 v_mfma_f32_16x16x32_bf16 v[244:247],v[164:167],v[100:103],v[244:247]
 v_add_f32 v202,v202,v206
 v_add_f32 v203,v203,v207
 s_waitcnt lgkmcnt(15)
 v_add_f32 v208,v208,v212
 v_add_f32 v209,v209,v213
 v_mfma_f32_16x16x32_bf16 v[248:251],v[164:167],v[104:107],v[248:251]
 v_add_f32 v210,v210,v214
 v_add_f32 v211,v211,v215
 v_add_f32 v200,v200,v208
 v_add_f32 v201,v201,v209
 v_mfma_f32_16x16x32_bf16 v[252:255],v[164:167],v[108:111],v[252:255]
 v_add_f32 v202,v202,v210
 v_add_f32 v203,v203,v211
 buffer_store_dwordx4 v[200:203],v2,s[8:11],s34 offen offset:3072 sc0 sc1
 v_accvgpr_read_b32 v216,a68
 v_mfma_f32_16x16x32_bf16 a[144:147],v[168:171],v[40:43],a[144:147]
 v_accvgpr_read_b32 v217,a69
 v_accvgpr_read_b32 v218,a70
 v_accvgpr_read_b32 v219,a71
 s_waitcnt lgkmcnt(14)
 v_add_f32 v216,v216,v112
 s_waitcnt lgkmcnt(0)
 s_barrier
 v_mfma_f32_16x16x32_bf16 a[148:151],v[168:171],v[44:47],a[148:151]
 v_add_f32 v217,v217,v113
 v_add_f32 v218,v218,v114
 v_add_f32 v219,v219,v115
 v_add_f32 v116,v116,v120
 v_mfma_f32_16x16x32_bf16 a[152:155],v[168:171],v[48:51],a[152:155]
 v_add_f32 v117,v117,v121
 v_add_f32 v118,v118,v122
 v_add_f32 v119,v119,v123
 v_add_f32 v216,v216,v116
 v_mfma_f32_16x16x32_bf16 a[156:159],v[168:171],v[52:55],a[156:159]
 v_add_f32 v217,v217,v117
 v_add_f32 v218,v218,v118
 v_add_f32 v219,v219,v119
 s_movk_i32 s34,4096
 buffer_store_dwordx4 v[216:219],v2,s[8:11],s34 offen offset:0 sc0 sc1
 v_mfma_f32_16x16x32_bf16 a[160:163],v[168:171],v[56:59],a[160:163]
 v_accvgpr_read_b32 v124,a92
 v_accvgpr_read_b32 v125,a93
 v_accvgpr_read_b32 v126,a94
 v_accvgpr_read_b32 v127,a95
 v_mfma_f32_16x16x32_bf16 a[164:167],v[168:171],v[60:63],a[164:167]
 v_add_f32 v124,v124,v128
 v_add_f32 v125,v125,v129
 v_add_f32 v126,v126,v130
 v_add_f32 v127,v127,v131
 v_mfma_f32_16x16x32_bf16 a[168:171],v[172:175],v[40:43],a[168:171]
 v_add_f32 v132,v132,v136
 v_add_f32 v133,v133,v137
 v_add_f32 v134,v134,v138
 v_add_f32 v135,v135,v139
 v_mfma_f32_16x16x32_bf16 a[172:175],v[172:175],v[44:47],a[172:175]
 v_add_f32 v124,v124,v132
 v_add_f32 v125,v125,v133
 v_add_f32 v126,v126,v134
 v_add_f32 v127,v127,v135
 v_mfma_f32_16x16x32_bf16 a[176:179],v[172:175],v[48:51],a[176:179]
 buffer_store_dwordx4 v[124:127],v2,s[8:11],s34 offen offset:1024 sc0 sc1
 v_accvgpr_read_b32 v64,a108
 v_accvgpr_read_b32 v65,a109
 v_accvgpr_read_b32 v66,a110
 v_mfma_f32_16x16x32_bf16 a[180:183],v[172:175],v[52:55],a[180:183]
 ds_write_b128 v3,a[144:147] offset:0
 v_accvgpr_read_b32 v67,a111
 v_add_f32 v64,v64,v68
 v_add_f32 v65,v65,v69
 v_add_f32 v66,v66,v70
 v_mfma_f32_16x16x32_bf16 a[184:187],v[172:175],v[56:59],a[184:187]
 ds_write_b128 v3,a[148:151] offset:1024
 v_add_f32 v67,v67,v71
 v_add_f32 v72,v72,v76
 v_add_f32 v73,v73,v77
 v_add_f32 v74,v74,v78
 v_mfma_f32_16x16x32_bf16 a[188:191],v[172:175],v[60:63],a[188:191]
 ds_write_b128 v3,a[152:155] offset:2048
 v_add_f32 v75,v75,v79
 v_add_f32 v64,v64,v72
 v_add_f32 v65,v65,v73
 v_add_f32 v66,v66,v74
 v_mfma_f32_16x16x32_bf16 a[192:195],v[176:179],v[40:43],a[192:195]
 buffer_load_dword v22,off,s[80:83],s87 sc0 sc1
 v_add_f32 v67,v67,v75
 buffer_store_dwordx4 v[64:67],v2,s[8:11],s34 offen offset:2048 sc0 sc1
 v_accvgpr_read_b32 v80,a132
 v_accvgpr_read_b32 v81,a133
 v_mfma_f32_16x16x32_bf16 a[196:199],v[176:179],v[44:47],a[196:199]
 ds_write_b128 v3,a[160:163] offset:4096
 v_accvgpr_read_b32 v82,a134
 v_accvgpr_read_b32 v83,a135
 v_add_f32 v80,v80,v84
 v_add_f32 v81,v81,v85
 v_mfma_f32_16x16x32_bf16 a[200:203],v[176:179],v[48:51],a[200:203]
 ds_write_b128 v3,a[164:167] offset:5120
 v_add_f32 v82,v82,v86
 v_add_f32 v83,v83,v87
 v_add_f32 v192,v192,v196
 v_add_f32 v193,v193,v197
 v_mfma_f32_16x16x32_bf16 a[204:207],v[176:179],v[52:55],a[204:207]
 ds_write_b128 v3,a[168:171] offset:6144
 v_add_f32 v194,v194,v198
 v_add_f32 v195,v195,v199
 v_add_f32 v80,v80,v192
 v_add_f32 v81,v81,v193
 v_mfma_f32_16x16x32_bf16 a[208:211],v[176:179],v[56:59],a[208:211]
 ds_write_b128 v3,a[172:175] offset:7168
 v_add_f32 v82,v82,v194
 v_add_f32 v83,v83,v195
 buffer_store_dwordx4 v[80:83],v2,s[8:11],s34 offen offset:3072 sc0 sc1
 v_accvgpr_read_b32 v24,a140
 v_mfma_f32_16x16x32_bf16 a[212:215],v[176:179],v[60:63],a[212:215]
 ds_write_b128 v3,a[176:179] offset:8192
 v_accvgpr_read_b32 v25,a141
 v_accvgpr_read_b32 v26,a142
 v_accvgpr_read_b32 v27,a143
 v_add_f32 v24,v24,v28
 v_mfma_f32_16x16x32_bf16 a[216:219],v[180:183],v[40:43],a[216:219]
 v_add_f32 v25,v25,v29
 v_add_f32 v26,v26,v30
 v_add_f32 v27,v27,v31
 v_add_f32 v32,v32,v36
 v_mfma_f32_16x16x32_bf16 a[220:223],v[180:183],v[44:47],a[220:223]
 ds_write_b128 v3,a[184:187] offset:10240
 v_add_f32 v33,v33,v37
 v_add_f32 v34,v34,v38
 v_add_f32 v35,v35,v39
 v_add_f32 v24,v24,v32
 v_mfma_f32_16x16x32_bf16 a[224:227],v[180:183],v[48:51],a[224:227]
 ds_write_b128 v3,a[188:191] offset:11264
 v_add_f32 v25,v25,v33
 v_add_f32 v26,v26,v34
 v_add_f32 v27,v27,v35
 s_movk_i32 s34,8192
 buffer_store_dwordx4 v[24:27],v2,s[8:11],s34 offen offset:0 sc0 sc1
 v_mfma_f32_16x16x32_bf16 a[228:231],v[180:183],v[52:55],a[228:231]
 ds_write_b128 v3,a[192:195] offset:49152
 v_mfma_f32_16x16x32_bf16 a[232:235],v[180:183],v[56:59],a[232:235]
 v_mfma_f32_16x16x32_bf16 a[236:239],v[180:183],v[60:63],a[236:239]
 ds_write_b128 v3,a[200:203] offset:51200
 v_mfma_f32_16x16x32_bf16 a[240:243],v[184:187],v[40:43],a[240:243]
 ds_write_b128 v3,a[204:207] offset:52224
 v_mfma_f32_16x16x32_bf16 a[244:247],v[184:187],v[44:47],a[244:247]
 ds_write_b128 v3,a[208:211] offset:53248
 v_mfma_f32_16x16x32_bf16 a[248:251],v[184:187],v[48:51],a[248:251]
 v_mfma_f32_16x16x32_bf16 a[252:255],v[184:187],v[52:55],a[252:255]
 ds_write_b128 v3,a[216:219] offset:55296
 v_mfma_f32_16x16x32_bf16 v[224:227],v[184:187],v[56:59],v[224:227]
 v_mfma_f32_16x16x32_bf16 v[228:231],v[184:187],v[60:63],v[228:231]
 ds_write_b128 v3,a[224:227] offset:57344
 v_mfma_f32_16x16x32_bf16 v[232:235],v[188:191],v[40:43],v[232:235]
 ds_write_b128 v3,a[228:231] offset:58368
 v_mfma_f32_16x16x32_bf16 v[236:239],v[188:191],v[44:47],v[236:239]
 ds_write_b128 v3,a[232:235] offset:59392
 v_mfma_f32_16x16x32_bf16 v[240:243],v[188:191],v[48:51],v[240:243]
 v_mfma_f32_16x16x32_bf16 v[244:247],v[188:191],v[52:55],v[244:247]
 ds_write_b128 v8,a[240:243] offset:0
 v_mfma_f32_16x16x32_bf16 v[248:251],v[188:191],v[56:59],v[248:251]
 ds_write_b128 v8,a[244:247] offset:1024
 v_mfma_f32_16x16x32_bf16 v[252:255],v[188:191],v[60:63],v[252:255]
 ds_write_b128 v8,a[248:251] offset:2048
 s_waitcnt vmcnt(3)
 v_cmp_eq_u32 vcc,0,v22
 s_nop 1
 s_mov_b64 s[70:71],vcc
 s_cbranch_vccnz OP_e3
 s_movk_i32 s34,0
 buffer_load_dwordx4 v[184:187],v2,s[4:7],s34 offen offset:0 sc0 sc1
 buffer_load_dwordx4 v[188:191],v2,s[4:7],s34 offen offset:1024 sc0 sc1
 buffer_load_dwordx4 v[200:203],v2,s[4:7],s34 offen offset:2048 sc0 sc1
 buffer_load_dwordx4 v[204:207],v2,s[4:7],s34 offen offset:3072 sc0 sc1
 s_movk_i32 s34,4096
 buffer_load_dwordx4 v[208:211],v2,s[4:7],s34 offen offset:0 sc0 sc1
 buffer_load_dwordx4 v[212:215],v2,s[4:7],s34 offen offset:1024 sc0 sc1
 buffer_load_dwordx4 v[216:219],v2,s[4:7],s34 offen offset:2048 sc0 sc1
 buffer_load_dwordx4 v[192:195],v2,s[4:7],s34 offen offset:3072 sc0 sc1
 s_movk_i32 s34,8192
 buffer_load_dwordx4 v[196:199],v2,s[4:7],s34 offen offset:0 sc0 sc1
OP_e3:
 s_nop 4
 ds_write_b128 v8,v[224:227] offset:4096
 ds_write_b128 v8,v[228:231] offset:5120
 ds_write_b128 v8,v[232:235] offset:6144
 ds_write_b128 v8,v[236:239] offset:7168
 ds_write_b128 v8,v[240:243] offset:8192
 s_waitcnt vmcnt(0)
 buffer_store_dword v1,v12,s[80:83],s99 offen sc0 sc1
 ds_write_b128 v8,v[248:251] offset:10240
 v_accvgpr_read_b32 v40,a156
 v_accvgpr_read_b32 v41,a157
 v_accvgpr_read_b32 v42,a158
 v_accvgpr_read_b32 v43,a159
 v_accvgpr_read_b32 v56,a180
 v_accvgpr_read_b32 v57,a181
 v_accvgpr_read_b32 v58,a182
 v_accvgpr_read_b32 v59,a183
 v_accvgpr_read_b32 v72,a196
 v_accvgpr_read_b32 v73,a197
 v_accvgpr_read_b32 v74,a198
 v_accvgpr_read_b32 v75,a199
 v_accvgpr_read_b32 v88,a220
 v_accvgpr_read_b32 v89,a221
 v_accvgpr_read_b32 v90,a222
 v_accvgpr_read_b32 v91,a223
 v_accvgpr_read_b32 v104,a212
 v_accvgpr_read_b32 v105,a213
 v_accvgpr_read_b32 v106,a214
 v_accvgpr_read_b32 v107,a215
 v_accvgpr_read_b32 v120,a236
 v_accvgpr_read_b32 v121,a237
 v_accvgpr_read_b32 v122,a238
 v_accvgpr_read_b32 v123,a239
 v_accvgpr_read_b32 v136,a252
 v_accvgpr_read_b32 v137,a253
 v_accvgpr_read_b32 v138,a254
 v_accvgpr_read_b32 v139,a255
 v_mov_b32 v152,v244
 v_mov_b32 v153,v245
 v_mov_b32 v154,v246
 v_mov_b32 v155,v247
 v_mov_b32 v168,v252
 v_mov_b32 v169,v253
 v_mov_b32 v170,v254
 v_mov_b32 v171,v255
 s_waitcnt lgkmcnt(0)
 s_barrier
 ds_read_b128 v[44:47],v5 offset:3072
 ds_read_b128 v[48:51],v6 offset:3072
 ds_read_b128 v[52:55],v7 offset:3072
 ds_read_b128 v[60:63],v5 offset:9216
 ds_read_b128 v[64:67],v6 offset:9216
 ds_read_b128 v[68:71],v7 offset:9216
 ds_read_b128 v[76:79],v5 offset:50176
 ds_read_b128 v[80:83],v6 offset:50176
 ds_read_b128 v[84:87],v7 offset:50176
 ds_read_b128 v[92:95],v5 offset:56320
 ds_read_b128 v[96:99],v6 offset:56320
 ds_read_b128 v[100:103],v7 offset:56320
 ds_read_b128 v[108:111],v5 offset:54272
 ds_read_b128 v[112:115],v6 offset:54272
 ds_read_b128 v[116:119],v7 offset:54272
 ds_read_b128 v[124:127],v5 offset:60416
 ds_read_b128 v[128:131],v6 offset:60416
 ds_read_b128 v[132:135],v7 offset:60416
 ds_read_b128 v[140:143],v9 offset:3072
 ds_read_b128 v[144:147],v10 offset:3072
 ds_read_b128 v[148:151],v11 offset:3072
 ds_read_b128 v[156:159],v9 offset:9216
 ds_read_b128 v[160:163],v10 offset:9216
 ds_read_b128 v[164:167],v11 offset:9216
 ds_read_b128 v[172:175],v9 offset:11264
 ds_read_b128 v[176:179],v10 offset:11264
 ds_read_b128 v[180:183],v11 offset:11264
 s_cmp_eq_u32 s70,0
 s_cbranch_scc1 OP_f3
 s_branch OP_spin5
OP_back5:
 s_movk_i32 s34,0
 buffer_load_dwordx4 v[184:187],v2,s[4:7],s34 offen offset:0 sc0 sc1
 buffer_load_dwordx4 v[188:191],v2,s[4:7],s34 offen offset:1024 sc0 sc1
 buffer_load_dwordx4 v[200:203],v2,s[4:7],s34 offen offset:2048 sc0 sc1
 buffer_load_dwordx4 v[204:207],v2,s[4:7],s34 offen offset:3072 sc0 sc1
 s_movk_i32 s34,4096
 buffer_load_dwordx4 v[208:211],v2,s[4:7],s34 offen offset:0 sc0 sc1
 buffer_load_dwordx4 v[212:215],v2,s[4:7],s34 offen offset:1024 sc0 sc1
 buffer_load_dwordx4 v[216:219],v2,s[4:7],s34 offen offset:2048 sc0 sc1
 buffer_load_dwordx4 v[192:195],v2,s[4:7],s34 offen offset:3072 sc0 sc1
 s_movk_i32 s34,8192
 buffer_load_dwordx4 v[196:199],v2,s[4:7],s34 offen offset:0 sc0 sc1
OP_f3:
 v_and_b32 v18,15,v0
 v_mul_u32_u24 v18,2304,v18
 v_bfe_u32 v19,v0,4,1
 v_lshl_add_u32 v18,v19,5,v18
 v_lshrrev_b32 v19,5,v0
 v_lshl_add_u32 v18,v19,4,v18
 s_waitcnt lgkmcnt(15)
 v_add_f32 v40,v40,v44
 v_add_f32 v41,v41,v45
 v_add_f32 v42,v42,v46
 v_add_f32 v43,v43,v47
 s_waitcnt lgkmcnt(15)
 v_add_f32 v48,v48,v52
 v_add_f32 v49,v49,v53
 v_add_f32 v50,v50,v54
 v_add_f32 v51,v51,v55
 v_add_f32 v40,v40,v48
 v_add_f32 v41,v41,v49
 v_add_f32 v42,v42,v50
 v_add_f32 v43,v43,v51
 s_waitcnt lgkmcnt(15)
 v_add_f32 v56,v56,v60
 v_add_f32 v57,v57,v61
 v_add_f32 v58,v58,v62
 v_add_f32 v59,v59,v63
 s_waitcnt lgkmcnt(15)
 v_add_f32 v64,v64,v68
 v_add_f32 v65,v65,v69
 v_add_f32 v66,v66,v70
 v_add_f32 v67,v67,v71
 v_add_f32 v56,v56,v64
 v_add_f32 v57,v57,v65
 v_add_f32 v58,v58,v66
 v_add_f32 v59,v59,v67
 s_waitcnt lgkmcnt(15)
 v_add_f32 v72,v72,v76
 v_add_f32 v73,v73,v77
 v_add_f32 v74,v74,v78
 v_add_f32 v75,v75,v79
 s_waitcnt lgkmcnt(15)
 v_add_f32 v80,v80,v84
 v_add_f32 v81,v81,v85
 v_add_f32 v82,v82,v86
 v_add_f32 v83,v83,v87
 v_add_f32 v72,v72,v80
 v_add_f32 v73,v73,v81
 v_add_f32 v74,v74,v82
 v_add_f32 v75,v75,v83
 s_waitcnt lgkmcnt(15)
 v_add_f32 v88,v88,v92
 v_add_f32 v89,v89,v93
 v_add_f32 v90,v90,v94
 v_add_f32 v91,v91,v95
 s_waitcnt lgkmcnt(15)
 v_add_f32 v96,v96,v100
 v_add_f32 v97,v97,v101
 v_add_f32 v98,v98,v102
 v_add_f32 v99,v99,v103
 v_add_f32 v88,v88,v96
 v_add_f32 v89,v89,v97
 v_add_f32 v90,v90,v98
 v_add_f32 v91,v91,v99
 s_waitcnt lgkmcnt(14)
 v_add_f32 v104,v104,v108
 v_add_f32 v105,v105,v109
 v_add_f32 v106,v106,v110
 v_add_f32 v107,v107,v111
 s_waitcnt lgkmcnt(12)
 v_add_f32 v112,v112,v116
 v_add_f32 v113,v113,v117
 v_add_f32 v114,v114,v118
 v_add_f32 v115,v115,v119
 v_add_f32 v104,v104,v112
 v_add_f32 v105,v105,v113
 v_add_f32 v106,v106,v114
 v_add_f32 v107,v107,v115
 s_waitcnt lgkmcnt(11)
 v_add_f32 v120,v120,v124
 v_add_f32 v121,v121,v125
 v_add_f32 v122,v122,v126
 v_add_f32 v123,v123,v127
 s_waitcnt lgkmcnt(9)
 v_add_f32 v128,v128,v132
 v_add_f32 v129,v129,v133
 v_add_f32 v130,v130,v134
 v_add_f32 v131,v131,v135
 v_add_f32 v120,v120,v128
 v_add_f32 v121,v121,v129
 v_add_f32 v122,v122,v130
 v_add_f32 v123,v123,v131
 s_waitcnt lgkmcnt(8)
 v_add_f32 v136,v136,v140
 v_add_f32 v137,v137,v141
 v_add_f32 v138,v138,v142
 v_add_f32 v139,v139,v143
 s_waitcnt lgkmcnt(6)
 v_add_f32 v144,v144,v148
 v_add_f32 v145,v145,v149
 v_add_f32 v146,v146,v150
 v_add_f32 v147,v147,v151
 v_add_f32 v136,v136,v144
 v_add_f32 v137,v137,v145
 v_add_f32 v138,v138,v146
 v_add_f32 v139,v139,v147
 s_waitcnt lgkmcnt(5)
 v_add_f32 v152,v152,v156
 v_add_f32 v153,v153,v157
 v_add_f32 v154,v154,v158
 v_add_f32 v155,v155,v159
 s_waitcnt lgkmcnt(3)
 v_add_f32 v160,v160,v164
 v_add_f32 v161,v161,v165
 v_add_f32 v162,v162,v166
 v_add_f32 v163,v163,v167
 v_add_f32 v152,v152,v160
 v_add_f32 v153,v153,v161
 v_add_f32 v154,v154,v162
 v_add_f32 v155,v155,v163
 s_waitcnt lgkmcnt(2)
 v_add_f32 v168,v168,v172
 v_add_f32 v169,v169,v173
 v_add_f32 v170,v170,v174
 v_add_f32 v171,v171,v175
 s_waitcnt lgkmcnt(0)
 v_add_f32 v176,v176,v180
 v_add_f32 v177,v177,v181
 v_add_f32 v178,v178,v182
 v_add_f32 v179,v179,v183
 v_add_f32 v168,v168,v176
 v_add_f32 v169,v169,v177
 v_add_f32 v170,v170,v178
 v_add_f32 v171,v171,v179
 s_waitcnt vmcnt(7)
 v_add_f32 v40,v40,v184
 v_add_f32 v41,v41,v185
 v_add_f32 v42,v42,v186
 v_add_f32 v43,v43,v187
 v_add_f32 v56,v56,v188
 v_add_f32 v57,v57,v189
 v_add_f32 v58,v58,v190
 v_add_f32 v59,v59,v191
 v_cvt_pk_bf16_f32 v44,v40,v41
 v_cvt_pk_bf16_f32 v45,v42,v43
 v_cvt_pk_bf16_f32 v46,v56,v57
 v_cvt_pk_bf16_f32 v47,v58,v59
 s_mov_b32 s34,110592
 s_nop 0
 v_permlane16_swap_b32 v44,v46
 v_permlane16_swap_b32 v45,v47
 buffer_store_dwordx4 v[44:47],v18,s[52:55],s34 offen offset:0
 s_waitcnt vmcnt(6)
 v_add_f32 v72,v72,v200
 v_add_f32 v73,v73,v201
 v_add_f32 v74,v74,v202
 v_add_f32 v75,v75,v203
 v_add_f32 v88,v88,v204
 v_add_f32 v89,v89,v205
 v_add_f32 v90,v90,v206
 v_add_f32 v91,v91,v207
 v_cvt_pk_bf16_f32 v76,v72,v73
 v_cvt_pk_bf16_f32 v77,v74,v75
 v_cvt_pk_bf16_f32 v78,v88,v89
 v_cvt_pk_bf16_f32 v79,v90,v91
 s_mov_b32 s34,36864
 s_nop 0
 v_permlane16_swap_b32 v76,v78
 v_permlane16_swap_b32 v77,v79
 buffer_store_dwordx4 v[76:79],v18,s[52:55],s34 offen offset:64
 s_waitcnt vmcnt(5)
 v_add_f32 v104,v104,v208
 v_add_f32 v105,v105,v209
 v_add_f32 v106,v106,v210
 v_add_f32 v107,v107,v211
 v_add_f32 v120,v120,v212
 v_add_f32 v121,v121,v213
 v_add_f32 v122,v122,v214
 v_add_f32 v123,v123,v215
 v_cvt_pk_bf16_f32 v108,v104,v105
 v_cvt_pk_bf16_f32 v109,v106,v107
 v_cvt_pk_bf16_f32 v110,v120,v121
 v_cvt_pk_bf16_f32 v111,v122,v123
 s_mov_b32 s34,184320
 s_nop 0
 v_permlane16_swap_b32 v108,v110
 v_permlane16_swap_b32 v109,v111
 buffer_store_dwordx4 v[108:111],v18,s[52:55],s34 offen offset:64
 s_waitcnt vmcnt(4)
 v_add_f32 v136,v136,v216
 v_add_f32 v137,v137,v217
 v_add_f32 v138,v138,v218
 v_add_f32 v139,v139,v219
 v_add_f32 v152,v152,v192
 v_add_f32 v153,v153,v193
 v_add_f32 v154,v154,v194
 v_add_f32 v155,v155,v195
 v_cvt_pk_bf16_f32 v140,v136,v137
 v_cvt_pk_bf16_f32 v141,v138,v139
 v_cvt_pk_bf16_f32 v142,v152,v153
 v_cvt_pk_bf16_f32 v143,v154,v155
 s_mov_b32 s34,110592
 s_nop 0
 v_permlane16_swap_b32 v140,v142
 v_permlane16_swap_b32 v141,v143
 buffer_store_dwordx4 v[140:143],v18,s[52:55],s34 offen offset:128
 s_waitcnt vmcnt(4)
 v_add_f32 v168,v168,v196
 v_add_f32 v169,v169,v197
 v_add_f32 v170,v170,v198
 v_add_f32 v171,v171,v199
 v_cvt_pk_bf16_f32 v172,v168,v169
 v_cvt_pk_bf16_f32 v173,v170,v171
 s_mov_b32 s34,184320
 buffer_store_dwordx2 v[172:173],v4,s[52:55],s34 offen offset:160
 s_endpgm
OP_spin0:
 s_mov_b32 s68,0
OP_sl0:
 buffer_load_dword v5,v2,s[40:43],0 offen sc1
 s_waitcnt vmcnt(0)
 v_cmp_lt_u32 vcc,v5,v3
 s_add_u32 s68,s68,1
 s_cbranch_vccz OP_back0
 s_sleep 16
 s_cmp_lt_u32 s68,0x8000
 s_cbranch_scc1 OP_sl0
 s_branch OP_back0
OP_spin1:
 s_mov_b32 s68,0
OP_sl1:
 buffer_load_dword v5,v2,s[40:43],0 offen sc1
 s_waitcnt vmcnt(0)
 v_cmp_lt_u32 vcc,v5,v4
 s_add_u32 s68,s68,1
 s_cbranch_vccz OP_back1
 s_sleep 16
 s_cmp_lt_u32 s68,0x8000
 s_cbranch_scc1 OP_sl1
 s_branch OP_back1
OP_spin2:
 s_mov_b32 s68,0
OP_sl2:
 buffer_load_dword v22,off,s[80:83],s87 sc0 sc1
 s_waitcnt vmcnt(0)
 v_cmp_eq_u32 vcc,0,v22
 s_add_u32 s68,s68,1
 s_cbranch_vccz OP_back2
 s_sleep 2
 s_cmp_lt_u32 s68,0x8000
 s_cbranch_scc1 OP_sl2
 s_branch OP_back2
OP_spin3:
 s_mov_b32 s68,0
OP_sl3:
 buffer_load_dword v22,off,s[80:83],s87 sc0 sc1
 s_waitcnt vmcnt(0)
 v_cmp_eq_u32 vcc,0,v22
 s_add_u32 s68,s68,1
 s_cbranch_vccz OP_back3
 s_sleep 2
 s_cmp_lt_u32 s68,0x8000
 s_cbranch_scc1 OP_sl3
 s_branch OP_back3
OP_spin4:
 s_mov_b32 s68,0
OP_sl4:
 buffer_load_dword v22,off,s[80:83],s87 sc0 sc1
 s_waitcnt vmcnt(0)
 v_cmp_eq_u32 vcc,0,v22
 s_add_u32 s68,s68,1
 s_cbranch_vccz OP_back4
 s_sleep 2
 s_cmp_lt_u32 s68,0x8000
 s_cbranch_scc1 OP_sl4
 s_branch OP_back4
OP_spin5:
 s_mov_b32 s68,0
OP_sl5:
 buffer_load_dword v22,off,s[80:83],s87 sc0 sc1
 s_waitcnt vmcnt(0)
 v_cmp_eq_u32 vcc,0,v22
 s_add_u32 s68,s68,1
 s_cbranch_vccz OP_back5
 s_sleep 2
 s_cmp_lt_u32 s68,0x8000
 s_cbranch_scc1 OP_sl5
 s_branch OP_back5
K1_end:
 s_endpgm
.section .rodata,"a"
.p2align 6
.amdhsa_kernel concat_heads__mha_block_cached__mha_block_cached__near_ridge_kernel
  .amdhsa_next_free_vgpr 512
  .amdhsa_next_free_sgpr 102
  .amdhsa_accum_offset 256
  .amdhsa_group_segment_fixed_size 0
  .amdhsa_kernarg_size 104
  .amdhsa_user_sgpr_count 2
  .amdhsa_user_sgpr_kernarg_segment_ptr 1
  .amdhsa_system_sgpr_workgroup_id_x 1
.end_amdhsa_kernel
```
